```python
import torch

def _softmax(x, axis=-1):
    return torch.softmax(x, dim=axis)
def _gelu(x):
    return torch.nn.functional.gelu(x, approximate="tanh")
def _silu(x):
    return torch.nn.functional.silu(x)
def _sigmoid(x):
    return torch.sigmoid(x)
def _layernorm(x, axis=-1, eps=1e-5):
    m = x.mean(dim=axis, keepdim=True)
    v = x.var(dim=axis, keepdim=True, unbiased=False)
    return (x - m) / torch.sqrt(v + eps)
def _scatter_add(tgt, idx, src, axis=0):
    return tgt.clone().index_add_(axis, idx, src)
def _segment_sum(src, seg, n):
    out = torch.zeros((n,) + src.shape[1:], dtype=src.dtype)
    return out.index_add_(0, seg, src)
def _pad(x, pw):
    flat = tuple(v for pair in reversed(pw) for v in pair)
    return torch.nn.functional.pad(x, flat)

kernel_name = 'interleave_layers__sliding_local_dilated__mixer_token_mlp__prompt'

def setup_inputs():

    _w = (lambda a: (lambda t: t.to(torch.bfloat16) if t.is_floating_point() else t)(torch.as_tensor(a)))
    def _A_setup():
        B, S, D = 1, 2048, 1024
        return {
            "x": _w((lambda *s: torch.randn(*s, dtype=torch.bfloat16) * 0.05)(B, S, D)),
            "wqkv": _w((lambda *s: torch.randn(*s, dtype=torch.bfloat16) * 0.05)(D, 3 * D)),
            "wo": _w((lambda *s: torch.randn(*s, dtype=torch.bfloat16) * 0.05)(D, D)),
        }
    _A_in = _A_setup()

    def _B_setup():
        B, S, D, F = 1, 2048, 1024, 3584
        return {
            "x": _w((lambda *s: torch.randn(*s, dtype=torch.bfloat16) * 0.05)(B, S, D)),
            "w1": _w((lambda *s: torch.randn(*s, dtype=torch.bfloat16) * 1.6)(S, F) * (S ** -0.5)),
            "b1": _w((lambda *s: torch.randn(*s, dtype=torch.bfloat16) * 1.6)(F) * 0.02),
            "w2": _w((lambda *s: torch.randn(*s, dtype=torch.bfloat16) * 1.6)(F, S) * (F ** -0.5)),
            "b2": _w((lambda *s: torch.randn(*s, dtype=torch.bfloat16) * 1.6)(S) * 0.02),
        }
    _B_in = _B_setup()

    return {
        "A_x": _A_in["x"],
        "A_wqkv": _A_in["wqkv"],
        "A_wo": _A_in["wo"],
        "B_x": _B_in["x"],
        "B_w1": _B_in["w1"],
        "B_b1": _B_in["b1"],
        "B_w2": _B_in["w2"],
        "B_b2": _B_in["b2"],
    }

def reference(A_x, A_wqkv, A_wo, B_x, B_w1, B_b1, B_w2, B_b2):
    def _A_ref(x, wqkv, wo):
        B, S, D = x.shape
        H = 32; Dh = D // H
        W, dil = 8, 2
        qkv = (lambda x, *d: x.permute(*d))((x @ wqkv).reshape(B, S, 3, H, Dh), 2, 0, 3, 1, 4)
        q, k, v = qkv[0], qkv[1], qkv[2]
        scale = Dh ** -0.5
        pos = torch.arange(S)
        off = torch.arange(W) * dil
        idx = pos[:, None] - off[None, :]
        mask = idx >= 0
        idx_c = torch.where(mask, idx, 0).reshape(-1)
        kg = k[:, :, idx_c, :].reshape(B, H, S, W, Dh)
        vg = v[:, :, idx_c, :].reshape(B, H, S, W, Dh)
        logits = torch.einsum("bhsd,bhswd->bhsw", q, kg) * scale
        logits = torch.where(mask[None, None, :, :], logits, -1e9)
        attn = _softmax(logits, axis=-1)
        o = torch.einsum("bhsw,bhswd->bhsd", attn, vg)
        return (lambda x, *d: x.permute(*d))(o, 0, 2, 1, 3).reshape(B, S, D) @ wo

    def _B_ref(x, w1, b1, w2, b2):
        B, S, D = x.shape
        h = _layernorm(x, axis=-1)
        u = torch.einsum("bsd,sf->bdf", h, w1) + b1
        u = _gelu(u)
        y = torch.einsum("bdf,fs->bds", u, w2) + b2
        return (lambda x, *d: x.permute(*d))(y, 0, 2, 1)

    x = A_x
    x = x + _A_ref(_layernorm(x, axis=-1), A_wqkv, A_wo)
    x = x + _B_ref(_layernorm(x, axis=-1), B_w1, B_b1, B_w2, B_b2)
    x = x + _A_ref(_layernorm(x, axis=-1), A_wqkv, A_wo)
    x = x + _B_ref(_layernorm(x, axis=-1), B_w1, B_b1, B_w2, B_b2)
    return x
```

```asm
; @launch kernel=ln0_kernel grid=(512,1,1) block=(256,1,1) lds=0
; @launch kernel=g1_kernel grid=(256,1,1) block=(512,1,1) lds=129024
; @launch kernel=g2a_kernel grid=(256,1,1) block=(512,1,1) lds=98304
; @launch kernel=ln3_kernel grid=(512,1,1) block=(256,1,1) lds=0
; @launch kernel=g3_kernel grid=(224,1,1) block=(512,1,1) lds=131072
; @launch kernel=g4_kernel grid=(256,1,1) block=(512,1,1) lds=131072
; @launch kernel=ln6_kernel grid=(512,1,1) block=(256,1,1) lds=0
; @launch kernel=g1_kernel grid=(256,1,1) block=(512,1,1) lds=129024
; @launch kernel=g2b_kernel grid=(256,1,1) block=(512,1,1) lds=98304
; @launch kernel=ln3_kernel grid=(512,1,1) block=(256,1,1) lds=0
; @launch kernel=g3_kernel grid=(224,1,1) block=(512,1,1) lds=131072
; @launch kernel=g4_kernel grid=(256,1,1) block=(512,1,1) lds=131072
; @launch kernel=fin_kernel grid=(512,1,1) block=(256,1,1) lds=0
.amdgcn_target "amdgcn-amd-amdhsa--gfx950"
.text
.globl ln0_kernel
.p2align 8
.type ln0_kernel,@function
ln0_kernel:
    s_cmp_ge_u32 s2, 512
    s_cbranch_scc1 ln0_kernel_done
    s_load_dwordx2 s[4:5], s[0:1], 80
    s_load_dwordx2 s[6:7], s[0:1], 0
    v_lshrrev_b32 v1, 6, v0
    v_and_b32 v2, 63, v0
    s_lshl_b32 s3, s2, 2
    v_add_u32 v1, s3, v1
    v_lshlrev_b32 v3, 11, v1
    v_lshl_add_u32 v3, v2, 4, v3
    v_lshlrev_b32 v4, 1, v1
    s_waitcnt lgkmcnt(0)
    s_mov_b32 s8, s6
    s_mov_b32 s9, s7
    s_mov_b32 s10, 0x400000
    s_mov_b32 s11, 0x20000
    s_mov_b32 s12, s4
    s_mov_b32 s13, s5
    s_mov_b32 s14, 0x400000
    s_mov_b32 s15, 0x20000
    buffer_load_dwordx4 v[8:11], v3, s[8:11], 0 offen
    buffer_load_dwordx4 v[12:15], v3, s[8:11], 0 offen offset:1024
    s_waitcnt vmcnt(0)
    v_lshlrev_b32 v16, 16, v8
    v_and_b32 v17, 0xffff0000, v8
    v_lshlrev_b32 v18, 16, v9
    v_and_b32 v19, 0xffff0000, v9
    v_lshlrev_b32 v20, 16, v10
    v_and_b32 v21, 0xffff0000, v10
    v_lshlrev_b32 v22, 16, v11
    v_and_b32 v23, 0xffff0000, v11
    v_lshlrev_b32 v24, 16, v12
    v_and_b32 v25, 0xffff0000, v12
    v_lshlrev_b32 v26, 16, v13
    v_and_b32 v27, 0xffff0000, v13
    v_lshlrev_b32 v28, 16, v14
    v_and_b32 v29, 0xffff0000, v14
    v_lshlrev_b32 v30, 16, v15
    v_and_b32 v31, 0xffff0000, v15
    v_pk_add_f32 v[32:33], v[16:17], v[18:19]
    v_pk_add_f32 v[34:35], v[20:21], v[22:23]
    v_pk_add_f32 v[36:37], v[24:25], v[26:27]
    v_pk_add_f32 v[38:39], v[28:29], v[30:31]
    v_pk_add_f32 v[32:33], v[32:33], v[34:35]
    v_pk_add_f32 v[36:37], v[36:37], v[38:39]
    v_pk_add_f32 v[32:33], v[32:33], v[36:37]
    v_add_f32 v48, v32, v33
    s_nop 1
    v_add_f32_dpp v48, v48, v48 quad_perm:[1,0,3,2] row_mask:0xf bank_mask:0xf
    s_nop 1
    v_add_f32_dpp v48, v48, v48 quad_perm:[2,3,0,1] row_mask:0xf bank_mask:0xf
    s_nop 1
    v_add_f32_dpp v48, v48, v48 row_half_mirror row_mask:0xf bank_mask:0xf
    s_nop 1
    v_add_f32_dpp v48, v48, v48 row_mirror row_mask:0xf bank_mask:0xf
    s_nop 1
    v_add_f32_dpp v48, v48, v48 row_bcast:15 row_mask:0xa bank_mask:0xf
    s_nop 1
    v_add_f32_dpp v48, v48, v48 row_bcast:31 row_mask:0xc bank_mask:0xf
    s_nop 1
    v_readlane_b32 s40, v48, 63
    s_nop 1
    v_mov_b32 v49, 0xba800000
    v_mul_f32 v48, s40, v49
    v_mov_b32 v49, v48
    v_pk_add_f32 v[32:33], v[16:17], v[48:49]
    v_pk_add_f32 v[34:35], v[18:19], v[48:49]
    v_pk_add_f32 v[36:37], v[20:21], v[48:49]
    v_pk_add_f32 v[38:39], v[22:23], v[48:49]
    v_pk_add_f32 v[40:41], v[24:25], v[48:49]
    v_pk_add_f32 v[42:43], v[26:27], v[48:49]
    v_pk_add_f32 v[44:45], v[28:29], v[48:49]
    v_pk_add_f32 v[46:47], v[30:31], v[48:49]
    v_pk_mul_f32 v[50:51], v[32:33], v[32:33]
    v_pk_fma_f32 v[50:51], v[34:35], v[34:35], v[50:51]
    v_pk_fma_f32 v[50:51], v[36:37], v[36:37], v[50:51]
    v_pk_fma_f32 v[50:51], v[38:39], v[38:39], v[50:51]
    v_pk_fma_f32 v[50:51], v[40:41], v[40:41], v[50:51]
    v_pk_fma_f32 v[50:51], v[42:43], v[42:43], v[50:51]
    v_pk_fma_f32 v[50:51], v[44:45], v[44:45], v[50:51]
    v_pk_fma_f32 v[50:51], v[46:47], v[46:47], v[50:51]
    v_add_f32 v50, v50, v51
    v_cvt_pk_bf16_f32 v48, v48, v48
    v_lshlrev_b32 v48, 16, v48
    v_mov_b32 v49, v48
    s_nop 1
    v_add_f32_dpp v50, v50, v50 quad_perm:[1,0,3,2] row_mask:0xf bank_mask:0xf
    s_nop 1
    v_add_f32_dpp v50, v50, v50 quad_perm:[2,3,0,1] row_mask:0xf bank_mask:0xf
    s_nop 1
    v_add_f32_dpp v50, v50, v50 row_half_mirror row_mask:0xf bank_mask:0xf
    s_nop 1
    v_add_f32_dpp v50, v50, v50 row_mirror row_mask:0xf bank_mask:0xf
    s_nop 1
    v_add_f32_dpp v50, v50, v50 row_bcast:15 row_mask:0xa bank_mask:0xf
    s_nop 1
    v_add_f32_dpp v50, v50, v50 row_bcast:31 row_mask:0xc bank_mask:0xf
    s_nop 1
    v_readlane_b32 s41, v50, 63
    s_nop 1
    v_pk_add_f32 v[32:33], v[16:17], v[48:49]
    v_pk_add_f32 v[34:35], v[18:19], v[48:49]
    v_pk_add_f32 v[36:37], v[20:21], v[48:49]
    v_pk_add_f32 v[38:39], v[22:23], v[48:49]
    v_pk_add_f32 v[40:41], v[24:25], v[48:49]
    v_pk_add_f32 v[42:43], v[26:27], v[48:49]
    v_pk_add_f32 v[44:45], v[28:29], v[48:49]
    v_pk_add_f32 v[46:47], v[30:31], v[48:49]
    v_mov_b32 v50, 0x3a800000
    v_mul_f32 v50, s41, v50
    v_cvt_pk_bf16_f32 v50, v50, v50
    v_lshlrev_b32 v50, 16, v50
    v_add_f32 v50, 0x3727c5ac, v50
    v_cvt_pk_bf16_f32 v50, v50, v50
    v_lshlrev_b32 v50, 16, v50
    v_sqrt_f32 v50, v50
    v_cvt_pk_bf16_f32 v8, v32, v33
    v_cvt_pk_bf16_f32 v9, v34, v35
    v_cvt_pk_bf16_f32 v10, v36, v37
    v_cvt_pk_bf16_f32 v11, v38, v39
    v_cvt_pk_bf16_f32 v12, v40, v41
    v_cvt_pk_bf16_f32 v13, v42, v43
    v_cvt_pk_bf16_f32 v14, v44, v45
    v_cvt_pk_bf16_f32 v15, v46, v47
    v_cvt_pk_bf16_f32 v50, v50, v50
    v_lshlrev_b32 v50, 16, v50
    v_rcp_f32 v50, v50
    v_lshlrev_b32 v32, 16, v8
    v_and_b32 v33, 0xffff0000, v8
    v_lshlrev_b32 v34, 16, v9
    v_and_b32 v35, 0xffff0000, v9
    v_lshlrev_b32 v36, 16, v10
    v_and_b32 v37, 0xffff0000, v10
    v_lshlrev_b32 v38, 16, v11
    v_and_b32 v39, 0xffff0000, v11
    v_lshlrev_b32 v40, 16, v12
    v_and_b32 v41, 0xffff0000, v12
    v_lshlrev_b32 v42, 16, v13
    v_and_b32 v43, 0xffff0000, v13
    v_lshlrev_b32 v44, 16, v14
    v_and_b32 v45, 0xffff0000, v14
    v_lshlrev_b32 v46, 16, v15
    v_and_b32 v47, 0xffff0000, v15
    v_mov_b32 v51, v50
    v_pk_mul_f32 v[32:33], v[32:33], v[50:51]
    v_pk_mul_f32 v[34:35], v[34:35], v[50:51]
    v_pk_mul_f32 v[36:37], v[36:37], v[50:51]
    v_pk_mul_f32 v[38:39], v[38:39], v[50:51]
    v_pk_mul_f32 v[40:41], v[40:41], v[50:51]
    v_pk_mul_f32 v[42:43], v[42:43], v[50:51]
    v_pk_mul_f32 v[44:45], v[44:45], v[50:51]
    v_pk_mul_f32 v[46:47], v[46:47], v[50:51]
    v_cvt_pk_bf16_f32 v8, v32, v33
    v_cvt_pk_bf16_f32 v9, v34, v35
    v_cvt_pk_bf16_f32 v10, v36, v37
    v_cvt_pk_bf16_f32 v11, v38, v39
    v_cvt_pk_bf16_f32 v12, v40, v41
    v_cvt_pk_bf16_f32 v13, v42, v43
    v_cvt_pk_bf16_f32 v14, v44, v45
    v_cvt_pk_bf16_f32 v15, v46, v47
    buffer_store_dwordx4 v[8:11], v3, s[12:15], 0 offen
    buffer_store_dwordx4 v[12:15], v3, s[12:15], 0 offen offset:1024
ln0_kernel_done:
    s_endpgm
.section .rodata,"a"
.p2align 6
.amdhsa_kernel ln0_kernel
  .amdhsa_next_free_vgpr 68
  .amdhsa_next_free_sgpr 48
  .amdhsa_accum_offset 68
  .amdhsa_group_segment_fixed_size 0
  .amdhsa_kernarg_size 88
  .amdhsa_user_sgpr_count 2
  .amdhsa_user_sgpr_kernarg_segment_ptr 1
  .amdhsa_system_sgpr_workgroup_id_x 1
.end_amdhsa_kernel
.text
.globl g1_kernel
.p2align 8
.type g1_kernel,@function
g1_kernel:
    s_cmp_ge_u32 s2, 256
    s_cbranch_scc1 g1_kernel_done
    s_load_dwordx2 s[4:5], s[0:1], 80
    s_load_dwordx2 s[6:7], s[0:1], 8
    v_lshrrev_b32 v1, 6, v0
    v_and_b32 v2, 63, v0
    s_and_b32 s40, s2, 1
    s_lshl_b32 s40, s40, 3
    s_bfe_u32 s41, s2, 0x30003
    s_add_u32 s25, s40, s41
    s_bfe_u32 s40, s2, 0x20001
    s_lshl_b32 s40, s40, 2
    s_lshr_b32 s42, s2, 6
    s_add_u32 s24, s40, s42
    s_add_u32 s27, s41, s42
    s_mov_b32 s26, 0
    v_readfirstlane_b32 s28, v1
    s_waitcnt lgkmcnt(0)
    s_mov_b32 s8, s6
    s_mov_b32 s9, s7
    s_mov_b32 s10, 0x600000
    s_mov_b32 s11, 0x20000
    s_mov_b32 s12, s4
    s_mov_b32 s13, s5
    s_mov_b32 s14, 0x400000
    s_mov_b32 s15, 0x20000
    s_add_u32 s16, s4, 0x400000
    s_addc_u32 s17, s5, 0
    s_mov_b32 s18, 0x400000
    s_mov_b32 s19, 0x20000
    v_lshrrev_b32 v5, 4, v2
    v_bfe_u32 v6, v2, 2, 2
    v_and_b32 v7, 3, v2
    v_and_b32 v8, 15, v2
    s_cmp_ge_u32 s28, 4
    s_cbranch_scc1 g1_kernel_loader
    s_and_b32 s44, s28, 1
    s_lshr_b32 s45, s28, 1
    s_lshl_b32 s42, s44, 1
    s_mov_b32 s43, 0
    v_and_b32 v3, 1, v5
    v_lshlrev_b32 v3, 1, v3
    v_lshrrev_b32 v4, 1, v6
    v_or_b32 v3, v3, v4
    s_add_u32 s40, s42, 0
    v_xor_b32 v3, s40, v3
    v_lshlrev_b32 v3, 5, v3
    v_lshl_add_u32 v3, v7, 3, v3
    v_lshl_add_u32 v4, v5, 3, v6
    v_lshl_add_u32 v3, v4, 7, v3
    v_add_u32 v10, s43, v3
    v_and_b32 v3, 1, v5
    v_lshlrev_b32 v3, 1, v3
    v_lshrrev_b32 v4, 1, v6
    v_or_b32 v3, v3, v4
    s_add_u32 s40, s42, 1
    v_xor_b32 v3, s40, v3
    v_lshlrev_b32 v3, 5, v3
    v_lshl_add_u32 v3, v7, 3, v3
    v_lshl_add_u32 v4, v5, 3, v6
    v_lshl_add_u32 v3, v4, 7, v3
    v_add_u32 v11, s43, v3
    s_xor_b32 s43, s45, 1
    s_add_u32 s43, s43, 1
    s_mul_i32 s43, s43, 8192
    v_and_b32 v3, 1, v5
    v_lshlrev_b32 v3, 1, v3
    v_lshrrev_b32 v4, 1, v6
    v_or_b32 v3, v3, v4
    s_add_u32 s40, s42, 0
    v_xor_b32 v3, s40, v3
    v_lshlrev_b32 v3, 5, v3
    v_lshl_add_u32 v3, v7, 3, v3
    v_lshl_add_u32 v4, v5, 3, v6
    v_lshl_add_u32 v3, v4, 7, v3
    v_add_u32 v12, s43, v3
    v_and_b32 v3, 1, v5
    v_lshlrev_b32 v3, 1, v3
    v_lshrrev_b32 v4, 1, v6
    v_or_b32 v3, v3, v4
    s_add_u32 s40, s42, 1
    v_xor_b32 v3, s40, v3
    v_lshlrev_b32 v3, 5, v3
    v_lshl_add_u32 v3, v7, 3, v3
    v_lshl_add_u32 v4, v5, 3, v6
    v_lshl_add_u32 v3, v4, 7, v3
    v_add_u32 v13, s43, v3
    s_xor_b32 s43, s45, 0
    s_add_u32 s43, s43, 1
    s_mul_i32 s43, s43, 8192
    v_and_b32 v3, 1, v5
    v_lshlrev_b32 v3, 1, v3
    v_lshrrev_b32 v4, 1, v6
    v_or_b32 v3, v3, v4
    s_add_u32 s40, s42, 0
    v_xor_b32 v3, s40, v3
    v_lshlrev_b32 v3, 5, v3
    v_lshl_add_u32 v3, v7, 3, v3
    v_lshl_add_u32 v4, v5, 3, v6
    v_lshl_add_u32 v3, v4, 7, v3
    v_add_u32 v14, s43, v3
    v_and_b32 v3, 1, v5
    v_lshlrev_b32 v3, 1, v3
    v_lshrrev_b32 v4, 1, v6
    v_or_b32 v3, v3, v4
    s_add_u32 s40, s42, 1
    v_xor_b32 v3, s40, v3
    v_lshlrev_b32 v3, 5, v3
    v_lshl_add_u32 v3, v7, 3, v3
    v_lshl_add_u32 v4, v5, 3, v6
    v_lshl_add_u32 v3, v4, 7, v3
    v_add_u32 v15, s43, v3
    s_mul_i32 s42, s45, 64
    s_add_u32 s42, s42, 16
    v_lshrrev_b32 v3, 1, v8
    v_xor_b32 v3, v3, v5
    v_lshlrev_b32 v3, 4, v3
    v_lshl_add_u32 v3, v8, 7, v3
    s_lshl_b32 s40, s42, 7
    s_add_u32 s40, s40, 24576
    v_add_u32 v16, s40, v3
    v_xor_b32 v17, 64, v16
    v_lshrrev_b32 v3, 1, v8
    v_xor_b32 v3, v3, v5
    v_lshlrev_b32 v3, 4, v3
    v_lshl_add_u32 v3, v8, 7, v3
    v_add_u32 v18, 24576, v3
    v_xor_b32 v19, 64, v18
    v_mov_b32 v24, 0
    v_mov_b32 v25, 0
    v_mov_b32 v26, 0
    v_mov_b32 v27, 0
    v_mov_b32 v28, 0
    v_mov_b32 v29, 0
    v_mov_b32 v30, 0
    v_mov_b32 v31, 0
    v_mov_b32 v32, 0
    v_mov_b32 v33, 0
    v_mov_b32 v34, 0
    v_mov_b32 v35, 0
    v_mov_b32 v36, 0
    v_mov_b32 v37, 0
    v_mov_b32 v38, 0
    v_mov_b32 v39, 0
    v_mov_b32 v40, 0
    v_mov_b32 v41, 0
    v_mov_b32 v42, 0
    v_mov_b32 v43, 0
    v_mov_b32 v44, 0
    v_mov_b32 v45, 0
    v_mov_b32 v46, 0
    v_mov_b32 v47, 0
    v_mov_b32 v48, 0
    v_mov_b32 v49, 0
    v_mov_b32 v50, 0
    v_mov_b32 v51, 0
    v_mov_b32 v52, 0
    v_mov_b32 v53, 0
    v_mov_b32 v54, 0
    v_mov_b32 v55, 0
    v_mov_b32 v56, 0
    v_mov_b32 v57, 0
    v_mov_b32 v58, 0
    v_mov_b32 v59, 0
    v_mov_b32 v60, 0
    v_mov_b32 v61, 0
    v_mov_b32 v62, 0
    v_mov_b32 v63, 0
    v_mov_b32 v64, 0
    v_mov_b32 v65, 0
    v_mov_b32 v66, 0
    v_mov_b32 v67, 0
    v_mov_b32 v68, 0
    v_mov_b32 v69, 0
    v_mov_b32 v70, 0
    v_mov_b32 v71, 0
    v_mov_b32 v72, 0
    v_mov_b32 v73, 0
    v_mov_b32 v74, 0
    v_mov_b32 v75, 0
    v_mov_b32 v76, 0
    v_mov_b32 v77, 0
    v_mov_b32 v78, 0
    v_mov_b32 v79, 0
    v_mov_b32 v80, 0
    v_mov_b32 v81, 0
    v_mov_b32 v82, 0
    v_mov_b32 v83, 0
    v_mov_b32 v84, 0
    v_mov_b32 v85, 0
    v_mov_b32 v86, 0
    v_mov_b32 v87, 0
    v_mov_b32 v88, 0
    v_mov_b32 v89, 0
    v_mov_b32 v90, 0
    v_mov_b32 v91, 0
    v_mov_b32 v92, 0
    v_mov_b32 v93, 0
    v_mov_b32 v94, 0
    v_mov_b32 v95, 0
    v_mov_b32 v96, 0
    v_mov_b32 v97, 0
    v_mov_b32 v98, 0
    v_mov_b32 v99, 0
    v_mov_b32 v100, 0
    v_mov_b32 v101, 0
    v_mov_b32 v102, 0
    v_mov_b32 v103, 0
    v_mov_b32 v104, 0
    v_mov_b32 v105, 0
    v_mov_b32 v106, 0
    v_mov_b32 v107, 0
    v_mov_b32 v108, 0
    v_mov_b32 v109, 0
    v_mov_b32 v110, 0
    v_mov_b32 v111, 0
    v_mov_b32 v112, 0
    v_mov_b32 v113, 0
    v_mov_b32 v114, 0
    v_mov_b32 v115, 0
    v_mov_b32 v116, 0
    v_mov_b32 v117, 0
    v_mov_b32 v118, 0
    v_mov_b32 v119, 0
    v_mov_b32 v120, 0
    v_mov_b32 v121, 0
    v_mov_b32 v122, 0
    v_mov_b32 v123, 0
    v_mov_b32 v124, 0
    v_mov_b32 v125, 0
    v_mov_b32 v126, 0
    v_mov_b32 v127, 0
    v_mov_b32 v172, 0
    v_mov_b32 v173, 0
    v_mov_b32 v174, 0
    v_mov_b32 v175, 0
    v_mov_b32 v176, 0
    v_mov_b32 v177, 0
    v_mov_b32 v178, 0
    v_mov_b32 v179, 0
    v_mov_b32 v180, 0
    v_mov_b32 v181, 0
    v_mov_b32 v182, 0
    v_mov_b32 v183, 0
    v_mov_b32 v184, 0
    v_mov_b32 v185, 0
    v_mov_b32 v186, 0
    v_mov_b32 v187, 0
    v_mov_b32 v188, 0
    v_mov_b32 v189, 0
    v_mov_b32 v190, 0
    v_mov_b32 v191, 0
    v_mov_b32 v192, 0
    v_mov_b32 v193, 0
    v_mov_b32 v194, 0
    v_mov_b32 v195, 0
    v_mov_b32 v196, 0
    v_mov_b32 v197, 0
    v_mov_b32 v198, 0
    v_mov_b32 v199, 0
    v_mov_b32 v200, 0
    v_mov_b32 v201, 0
    v_mov_b32 v202, 0
    v_mov_b32 v203, 0
    v_mov_b32 v204, 0
    v_mov_b32 v205, 0
    v_mov_b32 v206, 0
    v_mov_b32 v207, 0
    v_mov_b32 v208, 0
    v_mov_b32 v209, 0
    v_mov_b32 v210, 0
    v_mov_b32 v211, 0
    v_mov_b32 v212, 0
    v_mov_b32 v213, 0
    v_mov_b32 v214, 0
    v_mov_b32 v215, 0
    s_mov_b32 s48, 16
    s_mov_b32 s50, 0
    s_mov_b32 s60, 43008
    s_mov_b32 s61, 0xfffeb000
.p2align 3
g1_kernel_cloop:
    s_barrier
    v_mfma_f32_16x16x32_bf16 v[24:27], v[172:175], v[196:199], v[24:27]
    ds_read_b64_tr_b16 v[128:129], v10 offset:0
    ds_read_b64_tr_b16 v[130:131], v10 offset:512
    v_mfma_f32_16x16x32_bf16 v[28:31], v[172:175], v[200:203], v[28:31]
    ds_read_b128 v[152:155], v16 offset:0
    v_mfma_f32_16x16x32_bf16 v[32:35], v[172:175], v[204:207], v[32:35]
    ds_read_b128 v[156:159], v16 offset:2048
    v_mfma_f32_16x16x32_bf16 v[36:39], v[172:175], v[208:211], v[36:39]
    ds_read_b128 v[160:163], v16 offset:4096
    v_mfma_f32_16x16x32_bf16 v[40:43], v[176:179], v[196:199], v[40:43]
    ds_read_b128 v[164:167], v16 offset:6144
    v_mfma_f32_16x16x32_bf16 v[44:47], v[176:179], v[200:203], v[44:47]
    ds_read_b64_tr_b16 v[132:133], v11 offset:0
    ds_read_b64_tr_b16 v[134:135], v11 offset:512
    v_mfma_f32_16x16x32_bf16 v[48:51], v[176:179], v[204:207], v[48:51]
    ds_read_b64_tr_b16 v[136:137], v12 offset:0
    ds_read_b64_tr_b16 v[138:139], v12 offset:512
    v_mfma_f32_16x16x32_bf16 v[52:55], v[176:179], v[208:211], v[52:55]
    ds_read_b64_tr_b16 v[140:141], v13 offset:0
    ds_read_b64_tr_b16 v[142:143], v13 offset:512
    v_mfma_f32_16x16x32_bf16 v[56:59], v[180:183], v[196:199], v[56:59]
    ds_read_b64_tr_b16 v[144:145], v14 offset:0
    ds_read_b64_tr_b16 v[146:147], v14 offset:512
    v_mfma_f32_16x16x32_bf16 v[60:63], v[180:183], v[200:203], v[60:63]
    ds_read_b64_tr_b16 v[148:149], v15 offset:0
    ds_read_b64_tr_b16 v[150:151], v15 offset:512
    v_mfma_f32_16x16x32_bf16 v[64:67], v[180:183], v[204:207], v[64:67]
    ds_read_b128 v[168:171], v18 offset:0
    v_mfma_f32_16x16x32_bf16 v[68:71], v[180:183], v[208:211], v[68:71]
    v_mfma_f32_16x16x32_bf16 v[72:75], v[184:187], v[196:199], v[72:75]
    v_mfma_f32_16x16x32_bf16 v[76:79], v[184:187], v[200:203], v[76:79]
    v_mfma_f32_16x16x32_bf16 v[80:83], v[184:187], v[204:207], v[80:83]
    v_mfma_f32_16x16x32_bf16 v[84:87], v[184:187], v[208:211], v[84:87]
    v_mfma_f32_16x16x32_bf16 v[88:91], v[188:191], v[196:199], v[88:91]
    v_mfma_f32_16x16x32_bf16 v[92:95], v[188:191], v[200:203], v[92:95]
    v_mfma_f32_16x16x32_bf16 v[96:99], v[188:191], v[204:207], v[96:99]
    v_mfma_f32_16x16x32_bf16 v[100:103], v[188:191], v[208:211], v[100:103]
    v_mfma_f32_16x16x32_bf16 v[104:107], v[192:195], v[196:199], v[104:107]
    v_mfma_f32_16x16x32_bf16 v[108:111], v[192:195], v[200:203], v[108:111]
    v_mfma_f32_16x16x32_bf16 v[112:115], v[192:195], v[204:207], v[112:115]
    v_mfma_f32_16x16x32_bf16 v[116:119], v[192:195], v[208:211], v[116:119]
    v_mfma_f32_16x16x32_bf16 v[120:123], v[188:191], v[212:215], v[120:123]
    v_mfma_f32_16x16x32_bf16 v[124:127], v[192:195], v[212:215], v[124:127]
    s_waitcnt lgkmcnt(0)
    v_mfma_f32_16x16x32_bf16 v[24:27], v[128:131], v[152:155], v[24:27]
    ds_read_b64_tr_b16 v[172:173], v10 offset:4096
    ds_read_b64_tr_b16 v[174:175], v10 offset:4608
    v_mfma_f32_16x16x32_bf16 v[28:31], v[128:131], v[156:159], v[28:31]
    ds_read_b128 v[196:199], v17 offset:0
    v_mfma_f32_16x16x32_bf16 v[32:35], v[128:131], v[160:163], v[32:35]
    ds_read_b128 v[200:203], v17 offset:2048
    v_mfma_f32_16x16x32_bf16 v[36:39], v[128:131], v[164:167], v[36:39]
    ds_read_b128 v[204:207], v17 offset:4096
    v_mfma_f32_16x16x32_bf16 v[40:43], v[132:135], v[152:155], v[40:43]
    ds_read_b128 v[208:211], v17 offset:6144
    v_mfma_f32_16x16x32_bf16 v[44:47], v[132:135], v[156:159], v[44:47]
    ds_read_b64_tr_b16 v[176:177], v11 offset:4096
    ds_read_b64_tr_b16 v[178:179], v11 offset:4608
    v_mfma_f32_16x16x32_bf16 v[48:51], v[132:135], v[160:163], v[48:51]
    ds_read_b64_tr_b16 v[180:181], v12 offset:4096
    ds_read_b64_tr_b16 v[182:183], v12 offset:4608
    v_mfma_f32_16x16x32_bf16 v[52:55], v[132:135], v[164:167], v[52:55]
    ds_read_b64_tr_b16 v[184:185], v13 offset:4096
    ds_read_b64_tr_b16 v[186:187], v13 offset:4608
    v_mfma_f32_16x16x32_bf16 v[56:59], v[136:139], v[152:155], v[56:59]
    ds_read_b64_tr_b16 v[188:189], v14 offset:4096
    ds_read_b64_tr_b16 v[190:191], v14 offset:4608
    v_mfma_f32_16x16x32_bf16 v[60:63], v[136:139], v[156:159], v[60:63]
    ds_read_b64_tr_b16 v[192:193], v15 offset:4096
    ds_read_b64_tr_b16 v[194:195], v15 offset:4608
    v_mfma_f32_16x16x32_bf16 v[64:67], v[136:139], v[160:163], v[64:67]
    ds_read_b128 v[212:215], v19 offset:0
    v_mfma_f32_16x16x32_bf16 v[68:71], v[136:139], v[164:167], v[68:71]
    s_add_u32 s50, s50, 1
    s_cmp_eq_u32 s50, 3
    v_mfma_f32_16x16x32_bf16 v[72:75], v[140:143], v[152:155], v[72:75]
    s_cselect_b32 s49, s61, s60
    s_cselect_b32 s50, 0, s50
    v_mfma_f32_16x16x32_bf16 v[76:79], v[140:143], v[156:159], v[76:79]
    v_add_u32 v10, s49, v10
    v_add_u32 v11, s49, v11
    v_mfma_f32_16x16x32_bf16 v[80:83], v[140:143], v[160:163], v[80:83]
    v_add_u32 v12, s49, v12
    v_add_u32 v13, s49, v13
    v_mfma_f32_16x16x32_bf16 v[84:87], v[140:143], v[164:167], v[84:87]
    v_add_u32 v14, s49, v14
    v_add_u32 v15, s49, v15
    v_mfma_f32_16x16x32_bf16 v[88:91], v[144:147], v[152:155], v[88:91]
    v_add_u32 v16, s49, v16
    v_add_u32 v17, s49, v17
    v_mfma_f32_16x16x32_bf16 v[92:95], v[144:147], v[156:159], v[92:95]
    v_add_u32 v18, s49, v18
    v_add_u32 v19, s49, v19
    v_mfma_f32_16x16x32_bf16 v[96:99], v[144:147], v[160:163], v[96:99]
    s_sub_u32 s48, s48, 1
    s_cmp_lg_u32 s48, 0
    v_mfma_f32_16x16x32_bf16 v[100:103], v[144:147], v[164:167], v[100:103]
    v_mfma_f32_16x16x32_bf16 v[104:107], v[148:151], v[152:155], v[104:107]
    v_mfma_f32_16x16x32_bf16 v[108:111], v[148:151], v[156:159], v[108:111]
    v_mfma_f32_16x16x32_bf16 v[112:115], v[148:151], v[160:163], v[112:115]
    v_mfma_f32_16x16x32_bf16 v[116:119], v[148:151], v[164:167], v[116:119]
    v_mfma_f32_16x16x32_bf16 v[120:123], v[144:147], v[168:171], v[120:123]
    v_mfma_f32_16x16x32_bf16 v[124:127], v[148:151], v[168:171], v[124:127]
    s_waitcnt lgkmcnt(0)
    s_cbranch_scc1 g1_kernel_cloop
    v_mfma_f32_16x16x32_bf16 v[24:27], v[172:175], v[196:199], v[24:27]
    v_mfma_f32_16x16x32_bf16 v[28:31], v[172:175], v[200:203], v[28:31]
    v_mfma_f32_16x16x32_bf16 v[32:35], v[172:175], v[204:207], v[32:35]
    v_mfma_f32_16x16x32_bf16 v[36:39], v[172:175], v[208:211], v[36:39]
    v_mfma_f32_16x16x32_bf16 v[40:43], v[176:179], v[196:199], v[40:43]
    v_mfma_f32_16x16x32_bf16 v[44:47], v[176:179], v[200:203], v[44:47]
    v_mfma_f32_16x16x32_bf16 v[48:51], v[176:179], v[204:207], v[48:51]
    v_mfma_f32_16x16x32_bf16 v[52:55], v[176:179], v[208:211], v[52:55]
    v_mfma_f32_16x16x32_bf16 v[56:59], v[180:183], v[196:199], v[56:59]
    v_mfma_f32_16x16x32_bf16 v[60:63], v[180:183], v[200:203], v[60:63]
    v_mfma_f32_16x16x32_bf16 v[64:67], v[180:183], v[204:207], v[64:67]
    v_mfma_f32_16x16x32_bf16 v[68:71], v[180:183], v[208:211], v[68:71]
    v_mfma_f32_16x16x32_bf16 v[72:75], v[184:187], v[196:199], v[72:75]
    v_mfma_f32_16x16x32_bf16 v[76:79], v[184:187], v[200:203], v[76:79]
    v_mfma_f32_16x16x32_bf16 v[80:83], v[184:187], v[204:207], v[80:83]
    v_mfma_f32_16x16x32_bf16 v[84:87], v[184:187], v[208:211], v[84:87]
    v_mfma_f32_16x16x32_bf16 v[88:91], v[188:191], v[196:199], v[88:91]
    v_mfma_f32_16x16x32_bf16 v[92:95], v[188:191], v[200:203], v[92:95]
    v_mfma_f32_16x16x32_bf16 v[96:99], v[188:191], v[204:207], v[96:99]
    v_mfma_f32_16x16x32_bf16 v[100:103], v[188:191], v[208:211], v[100:103]
    v_mfma_f32_16x16x32_bf16 v[104:107], v[192:195], v[196:199], v[104:107]
    v_mfma_f32_16x16x32_bf16 v[108:111], v[192:195], v[200:203], v[108:111]
    v_mfma_f32_16x16x32_bf16 v[112:115], v[192:195], v[204:207], v[112:115]
    v_mfma_f32_16x16x32_bf16 v[116:119], v[192:195], v[208:211], v[116:119]
    v_mfma_f32_16x16x32_bf16 v[120:123], v[188:191], v[212:215], v[120:123]
    v_mfma_f32_16x16x32_bf16 v[124:127], v[192:195], v[212:215], v[124:127]
    v_and_b32 v3, 1, v5
    v_lshlrev_b32 v3, 1, v3
    v_lshrrev_b32 v4, 1, v5
    v_add_u32 v3, v3, v4
    s_lshl_b32 s40, s44, 2
    v_add_u32 v3, s40, v3
    v_lshrrev_b32 v4, 1, v8
    v_xor_b32 v3, v3, v4
    v_lshlrev_b32 v3, 4, v3
    v_lshl_add_u32 v3, v8, 7, v3
    s_mul_i32 s42, s45, 8192
    s_add_u32 s42, s42, 45056
    s_mov_b32 s43, 0
    s_add_u32 s40, s42, s43
    v_add_u32 v10, s40, v3
    s_xor_b32 s43, s45, 1
    s_add_u32 s43, s43, 1
    s_mul_i32 s43, s43, 18432
    s_add_u32 s40, s42, s43
    v_add_u32 v11, s40, v3
    s_xor_b32 s43, s45, 0
    s_add_u32 s43, s43, 1
    s_mul_i32 s43, s43, 18432
    s_add_u32 s40, s42, s43
    v_add_u32 v12, s40, v3
    s_add_u32 s40, s43, 43008
    v_add_u32 v13, s40, v3
    v_cvt_pk_bf16_f32 v128, v24, v25
    v_cvt_pk_bf16_f32 v129, v26, v27
    v_cvt_pk_bf16_f32 v130, v40, v41
    v_cvt_pk_bf16_f32 v131, v42, v43
    s_nop 1
    v_permlane16_swap_b32 v128, v130
    v_permlane16_swap_b32 v129, v131
    ds_write_b128 v10, v[128:131] offset:0
    v_cvt_pk_bf16_f32 v132, v28, v29
    v_cvt_pk_bf16_f32 v133, v30, v31
    v_cvt_pk_bf16_f32 v134, v44, v45
    v_cvt_pk_bf16_f32 v135, v46, v47
    s_nop 1
    v_permlane16_swap_b32 v132, v134
    v_permlane16_swap_b32 v133, v135
    ds_write_b128 v10, v[132:135] offset:2048
    v_cvt_pk_bf16_f32 v136, v32, v33
    v_cvt_pk_bf16_f32 v137, v34, v35
    v_cvt_pk_bf16_f32 v138, v48, v49
    v_cvt_pk_bf16_f32 v139, v50, v51
    s_nop 1
    v_permlane16_swap_b32 v136, v138
    v_permlane16_swap_b32 v137, v139
    ds_write_b128 v10, v[136:139] offset:4096
    v_cvt_pk_bf16_f32 v140, v36, v37
    v_cvt_pk_bf16_f32 v141, v38, v39
    v_cvt_pk_bf16_f32 v142, v52, v53
    v_cvt_pk_bf16_f32 v143, v54, v55
    s_nop 1
    v_permlane16_swap_b32 v140, v142
    v_permlane16_swap_b32 v141, v143
    ds_write_b128 v10, v[140:143] offset:6144
    v_cvt_pk_bf16_f32 v128, v56, v57
    v_cvt_pk_bf16_f32 v129, v58, v59
    v_cvt_pk_bf16_f32 v130, v72, v73
    v_cvt_pk_bf16_f32 v131, v74, v75
    s_nop 1
    v_permlane16_swap_b32 v128, v130
    v_permlane16_swap_b32 v129, v131
    ds_write_b128 v11, v[128:131] offset:0
    v_cvt_pk_bf16_f32 v132, v60, v61
    v_cvt_pk_bf16_f32 v133, v62, v63
    v_cvt_pk_bf16_f32 v134, v76, v77
    v_cvt_pk_bf16_f32 v135, v78, v79
    s_nop 1
    v_permlane16_swap_b32 v132, v134
    v_permlane16_swap_b32 v133, v135
    ds_write_b128 v11, v[132:135] offset:2048
    v_cvt_pk_bf16_f32 v136, v64, v65
    v_cvt_pk_bf16_f32 v137, v66, v67
    v_cvt_pk_bf16_f32 v138, v80, v81
    v_cvt_pk_bf16_f32 v139, v82, v83
    s_nop 1
    v_permlane16_swap_b32 v136, v138
    v_permlane16_swap_b32 v137, v139
    ds_write_b128 v11, v[136:139] offset:4096
    v_cvt_pk_bf16_f32 v140, v68, v69
    v_cvt_pk_bf16_f32 v141, v70, v71
    v_cvt_pk_bf16_f32 v142, v84, v85
    v_cvt_pk_bf16_f32 v143, v86, v87
    s_nop 1
    v_permlane16_swap_b32 v140, v142
    v_permlane16_swap_b32 v141, v143
    ds_write_b128 v11, v[140:143] offset:6144
    v_cvt_pk_bf16_f32 v128, v88, v89
    v_cvt_pk_bf16_f32 v129, v90, v91
    v_cvt_pk_bf16_f32 v130, v104, v105
    v_cvt_pk_bf16_f32 v131, v106, v107
    s_nop 1
    v_permlane16_swap_b32 v128, v130
    v_permlane16_swap_b32 v129, v131
    ds_write_b128 v12, v[128:131] offset:0
    v_cvt_pk_bf16_f32 v132, v92, v93
    v_cvt_pk_bf16_f32 v133, v94, v95
    v_cvt_pk_bf16_f32 v134, v108, v109
    v_cvt_pk_bf16_f32 v135, v110, v111
    s_nop 1
    v_permlane16_swap_b32 v132, v134
    v_permlane16_swap_b32 v133, v135
    ds_write_b128 v12, v[132:135] offset:2048
    v_cvt_pk_bf16_f32 v136, v96, v97
    v_cvt_pk_bf16_f32 v137, v98, v99
    v_cvt_pk_bf16_f32 v138, v112, v113
    v_cvt_pk_bf16_f32 v139, v114, v115
    s_nop 1
    v_permlane16_swap_b32 v136, v138
    v_permlane16_swap_b32 v137, v139
    ds_write_b128 v12, v[136:139] offset:4096
    v_cvt_pk_bf16_f32 v140, v100, v101
    v_cvt_pk_bf16_f32 v141, v102, v103
    v_cvt_pk_bf16_f32 v142, v116, v117
    v_cvt_pk_bf16_f32 v143, v118, v119
    s_nop 1
    v_permlane16_swap_b32 v140, v142
    v_permlane16_swap_b32 v141, v143
    ds_write_b128 v12, v[140:143] offset:6144
    v_cvt_pk_bf16_f32 v128, v120, v121
    v_cvt_pk_bf16_f32 v129, v122, v123
    v_cvt_pk_bf16_f32 v130, v124, v125
    v_cvt_pk_bf16_f32 v131, v126, v127
    s_nop 1
    v_permlane16_swap_b32 v128, v130
    v_permlane16_swap_b32 v129, v131
    ds_write_b128 v13, v[128:131]
    s_waitcnt lgkmcnt(0)
    s_branch g1_kernel_attn
g1_kernel_loader:
    s_sub_u32 s28, s28, 4
    s_mov_b32 s40, 6144
    v_lshrrev_b32 v3, 3, v2
    v_mul_lo_u32 v3, v3, s40
    v_bfe_u32 v4, v2, 4, 1
    v_lshlrev_b32 v4, 1, v4
    v_xor_b32 v4, v4, v2
    v_and_b32 v4, 7, v4
    v_lshl_add_u32 v3, v4, 4, v3
    s_mul_i32 s41, s24, 128
    s_mul_i32 s42, s28, 98304
    s_add_u32 s41, s41, s42
    v_xor_b32 v4, 64, v3
    s_add_u32 s42, s41, 0
    v_add_u32 v10, s42, v3
    s_add_u32 s42, s41, 49152
    v_add_u32 v11, s42, v4
    s_mov_b32 s40, 6144
    v_lshrrev_b32 v3, 3, v2
    v_mul_lo_u32 v3, v3, s40
    v_bfe_u32 v4, v2, 4, 1
    v_lshlrev_b32 v4, 1, v4
    v_xor_b32 v4, v4, v2
    v_and_b32 v4, 7, v4
    v_lshl_add_u32 v3, v4, 4, v3
    s_mul_i32 s41, s24, 128
    s_mul_i32 s42, s28, 98304
    s_add_u32 s41, s41, s42
    v_xor_b32 v4, 64, v3
    s_add_u32 s42, s41, 2048
    v_add_u32 v12, s42, v3
    s_add_u32 s42, s41, 51200
    v_add_u32 v13, s42, v4
    s_mov_b32 s40, 6144
    v_lshrrev_b32 v3, 3, v2
    v_mul_lo_u32 v3, v3, s40
    v_bfe_u32 v4, v2, 4, 1
    v_lshlrev_b32 v4, 1, v4
    v_xor_b32 v4, v4, v2
    v_and_b32 v4, 7, v4
    v_lshl_add_u32 v3, v4, 4, v3
    s_mul_i32 s41, s24, 128
    s_mul_i32 s42, s28, 98304
    s_add_u32 s41, s41, s42
    v_xor_b32 v4, 64, v3
    s_add_u32 s42, s41, 4096
    v_add_u32 v14, s42, v3
    s_add_u32 s42, s41, 53248
    v_add_u32 v15, s42, v4
    s_mov_b32 s40, 2048
    v_lshrrev_b32 v3, 3, v2
    v_mul_lo_u32 v3, v3, s40
    v_lshrrev_b32 v4, 4, v2
    v_xor_b32 v4, v4, v2
    v_and_b32 v4, 7, v4
    v_lshl_add_u32 v3, v4, 4, v3
    s_mul_i32 s41, s25, 262144
    s_mul_i32 s42, s28, 65536
    s_add_u32 s41, s41, s42
    v_xor_b32 v4, 64, v3
    s_add_u32 s42, s41, 0
    v_add_u32 v16, s42, v3
    s_add_u32 s42, s41, 16384
    v_add_u32 v17, s42, v4
    s_add_u32 s42, s41, 32768
    v_add_u32 v18, s42, v3
    s_add_u32 s42, s41, 49152
    v_add_u32 v19, s42, v4
    v_lshrrev_b32 v3, 3, v2
    s_lshl_b32 s40, s28, 2
    v_add_u32 v3, s40, v3
    v_lshrrev_b32 v4, 1, v3
    v_xor_b32 v4, v4, v2
    v_and_b32 v4, 7, v4
    s_lshl_b32 s40, s25, 7
    s_sub_u32 s40, s40, 16
    v_add_u32 v3, s40, v3
    v_max_i32 v3, 0, v3
    v_lshlrev_b32 v3, 11, v3
    v_lshl_add_u32 v20, v4, 4, v3
    s_mul_i32 s36, s28, 2048
    s_mul_i32 s37, s28, 4096
    s_add_u32 s37, s37, 26624
    s_mul_i32 s46, s28, 512
    s_add_u32 s46, s46, 24576
    s_mov_b32 s32, 0
    s_mov_b32 s33, 0
g1_kernel_ld_loop:
    s_cmp_lt_u32 s32, 2
    s_cbranch_scc1 g1_kernel_ld_issue
    s_waitcnt vmcnt(11)
    s_barrier
g1_kernel_ld_issue:
    s_add_u32 s40, s32, s27
    s_and_b32 s40, s40, 3
    s_andn2_b32 s41, s32, 3
    s_or_b32 s40, s40, s41
    s_add_u32 s40, s40, s26
    s_mul_i32 s34, s40, 393216
    s_mul_i32 s35, s40, 128
    s_add_u32 s38, s33, s36
    s_add_u32 s39, s33, s37
    s_add_u32 m0, s39, 0
    s_nop 0
    buffer_load_dwordx4 v16, s[12:15], s35 offen lds
    s_add_u32 m0, s39, 1024
    s_nop 0
    buffer_load_dwordx4 v17, s[12:15], s35 offen lds
    s_add_u32 m0, s39, 2048
    s_nop 0
    buffer_load_dwordx4 v18, s[12:15], s35 offen lds
    s_add_u32 m0, s39, 3072
    s_nop 0
    buffer_load_dwordx4 v19, s[12:15], s35 offen lds
    s_add_u32 m0, s38, 0
    s_nop 0
    buffer_load_dwordx4 v10, s[8:11], s34 offen lds
    s_add_u32 m0, s38, 1024
    s_nop 0
    buffer_load_dwordx4 v11, s[8:11], s34 offen lds
    s_add_u32 m0, s38, 8192
    s_nop 0
    buffer_load_dwordx4 v12, s[8:11], s34 offen lds
    s_add_u32 m0, s38, 9216
    s_nop 0
    buffer_load_dwordx4 v13, s[8:11], s34 offen lds
    s_add_u32 m0, s38, 16384
    s_nop 0
    buffer_load_dwordx4 v14, s[8:11], s34 offen lds
    s_add_u32 m0, s38, 17408
    s_nop 0
    buffer_load_dwordx4 v15, s[8:11], s34 offen lds
    s_add_u32 m0, s33, s46
    s_mov_b32 exec_hi, 0
    buffer_load_dwordx4 v20, s[12:15], s35 offen lds
    s_mov_b32 exec_hi, -1
    s_add_u32 s33, s33, 43008
    s_cmp_eq_u32 s33, 129024
    s_cselect_b32 s33, 0, s33
    s_add_u32 s32, s32, 1
    s_cmp_lt_u32 s32, 16
    s_cbranch_scc1 g1_kernel_ld_loop
    s_waitcnt vmcnt(11)
    s_barrier
    s_waitcnt vmcnt(0)
    s_barrier
    s_add_u32 s28, s28, 4
g1_kernel_attn:
    s_and_b32 s44, s28, 1
    s_lshr_b32 s45, s28, 1
    s_lshl_b32 s40, s44, 2
    v_add_u32 v3, s40, v5
    v_and_b32 v4, 7, v8
    v_xor_b32 v3, v3, v4
    v_lshlrev_b32 v3, 4, v3
    v_lshl_add_u32 v3, v8, 8, v3
    s_mul_i32 s41, s45, 4096
    s_add_u32 s41, s41, 43008
    v_add_u32 v10, s41, v3
    v_lshl_add_u32 v3, v5, 2, v6
    v_and_b32 v4, 7, v3
    v_add_u32 v12, s40, v7
    v_xor_b32 v4, v4, v12
    v_lshlrev_b32 v4, 4, v4
    v_lshl_add_u32 v3, v3, 8, v4
    s_add_u32 s41, s41, 36864
    v_add_u32 v11, s41, v3
    v_and_b32 v3, 7, v8
    v_add_u32 v4, 1, v3
    s_or_b32 s40, s25, s45
    s_cmp_eq_u32 s40, 0
    s_cselect_b32 s40, 8, 0
    v_cmp_gt_u32 vcc, 8, v8
    v_mov_b32 v16, s40
    s_mov_b64 s[56:57], vcc
    v_cndmask_b32 v16, 0, v16, vcc
    v_max_u32 v4, v4, v16
    v_add_u32 v3, 8, v3
    v_sub_u32 v3, v3, v4
    v_lshlrev_b32 v16, 2, v5
    v_sub_u32 v16, v16, v4
    v_mov_b32 v17, 0xf149f2ca
    v_add_u32 v18, 0, v16
    v_cmp_ge_u32 vcc, v3, v18
    s_nop 1
    v_cndmask_b32 v12, v17, 0, vcc
    v_add_u32 v18, 1, v16
    v_cmp_ge_u32 vcc, v3, v18
    s_nop 1
    v_cndmask_b32 v13, v17, 0, vcc
    v_add_u32 v18, 2, v16
    v_cmp_ge_u32 vcc, v3, v18
    s_nop 1
    v_cndmask_b32 v14, v17, 0, vcc
    v_add_u32 v18, 3, v16
    v_cmp_ge_u32 vcc, v3, v18
    s_nop 1
    v_cndmask_b32 v15, v17, 0, vcc
    s_lshl_b32 s40, s25, 7
    s_lshl_b32 s41, s45, 5
    s_add_u32 s40, s40, s41
    s_lshl_b32 s40, s40, 11
    s_lshl_b32 s41, s24, 7
    s_add_u32 s40, s40, s41
    s_lshl_b32 s41, s44, 6
    s_add_u32 s40, s40, s41
    v_lshlrev_b32 v9, 12, v8
    v_lshl_add_u32 v9, v5, 4, v9
    v_add_u32 v9, s40, v9
    s_mov_b32 s58, 0x3e3504f3
    s_mov_b32 s59, 0x3fb8aa3b
    s_barrier
    ds_read_b128 v[24:27], v10 offset:2048
    ds_read_b128 v[28:31], v10 offset:18432
    ds_read_b128 v[32:35], v10 offset:20480
    ds_read_b128 v[72:75], v10 offset:2176
    ds_read_b128 v[76:79], v10 offset:18560
    ds_read_b128 v[80:83], v10 offset:20608
    ds_read_b64_tr_b16 v[36:37], v11 offset:0
    ds_read_b64_tr_b16 v[38:39], v11 offset:2048
    ds_read_b64_tr_b16 v[40:41], v11 offset:8
    ds_read_b64_tr_b16 v[42:43], v11 offset:2056
    ds_read_b64_tr_b16 v[84:85], v11 offset:128
    ds_read_b64_tr_b16 v[86:87], v11 offset:2176
    ds_read_b64_tr_b16 v[88:89], v11 offset:136
    ds_read_b64_tr_b16 v[90:91], v11 offset:2184
    s_waitcnt lgkmcnt(8)
    v_mfma_f32_16x16x32_bf16 v[44:47], v[28:31], v[24:27], 0
    v_mfma_f32_16x16x32_bf16 v[48:51], v[32:35], v[24:27], 0
    v_mfma_f32_16x16x32_bf16 v[92:95], v[76:79], v[72:75], 0
    v_mfma_f32_16x16x32_bf16 v[96:99], v[80:83], v[72:75], 0
    s_nop 7
    v_cndmask_b32 v44, v48, v44, s[56:57]
    v_cndmask_b32 v45, v49, v45, s[56:57]
    v_cndmask_b32 v46, v50, v46, s[56:57]
    v_cndmask_b32 v47, v51, v47, s[56:57]
    v_cndmask_b32 v92, v96, v92, s[56:57]
    v_cndmask_b32 v93, v97, v93, s[56:57]
    v_cndmask_b32 v94, v98, v94, s[56:57]
    v_cndmask_b32 v95, v99, v95, s[56:57]
    v_cvt_pk_bf16_f32 v48, v44, v45
    v_cvt_pk_bf16_f32 v49, v46, v47
    v_cvt_pk_bf16_f32 v96, v92, v93
    v_cvt_pk_bf16_f32 v97, v94, v95
    v_lshlrev_b32 v44, 16, v48
    v_and_b32 v45, 0xffff0000, v48
    v_lshlrev_b32 v46, 16, v49
    v_and_b32 v47, 0xffff0000, v49
    v_lshlrev_b32 v92, 16, v96
    v_and_b32 v93, 0xffff0000, v96
    v_lshlrev_b32 v94, 16, v97
    v_and_b32 v95, 0xffff0000, v97
    v_mul_f32 v44, s58, v44
    v_mul_f32 v45, s58, v45
    v_mul_f32 v46, s58, v46
    v_mul_f32 v47, s58, v47
    v_mul_f32 v92, s58, v92
    v_mul_f32 v93, s58, v93
    v_mul_f32 v94, s58, v94
    v_mul_f32 v95, s58, v95
    v_cvt_pk_bf16_f32 v48, v44, v45
    v_cvt_pk_bf16_f32 v49, v46, v47
    v_cvt_pk_bf16_f32 v96, v92, v93
    v_cvt_pk_bf16_f32 v97, v94, v95
    v_lshlrev_b32 v44, 16, v48
    v_and_b32 v45, 0xffff0000, v48
    v_lshlrev_b32 v46, 16, v49
    v_and_b32 v47, 0xffff0000, v49
    v_lshlrev_b32 v92, 16, v96
    v_and_b32 v93, 0xffff0000, v96
    v_lshlrev_b32 v94, 16, v97
    v_and_b32 v95, 0xffff0000, v97
    v_fma_f32 v44, v44, s59, v12
    v_fma_f32 v45, v45, s59, v13
    v_fma_f32 v46, v46, s59, v14
    v_fma_f32 v47, v47, s59, v15
    v_fma_f32 v92, v92, s59, v12
    v_fma_f32 v93, v93, s59, v13
    v_fma_f32 v94, v94, s59, v14
    v_fma_f32 v95, v95, s59, v15
    v_max3_f32 v48, v44, v45, v46
    v_max3_f32 v96, v92, v93, v94
    v_max_f32 v48, v48, v47
    v_max_f32 v96, v96, v95
    v_mov_b32 v49, v48
    v_mov_b32 v97, v96
    s_nop 1
    v_permlane16_swap_b32 v48, v49
    v_permlane16_swap_b32 v96, v97
    s_nop 0
    v_max_f32 v48, v48, v49
    v_max_f32 v96, v96, v97
    v_mov_b32 v49, v48
    v_mov_b32 v97, v96
    s_nop 1
    v_permlane32_swap_b32 v48, v49
    v_permlane32_swap_b32 v96, v97
    s_nop 0
    v_max_f32 v48, v48, v49
    v_max_f32 v96, v96, v97
    v_sub_f32 v44, v44, v48
    v_sub_f32 v45, v45, v48
    v_sub_f32 v46, v46, v48
    v_sub_f32 v47, v47, v48
    v_sub_f32 v92, v92, v96
    v_sub_f32 v93, v93, v96
    v_sub_f32 v94, v94, v96
    v_sub_f32 v95, v95, v96
    v_exp_f32 v44, v44
    v_exp_f32 v45, v45
    v_exp_f32 v46, v46
    v_exp_f32 v47, v47
    v_exp_f32 v92, v92
    v_exp_f32 v93, v93
    v_exp_f32 v94, v94
    v_exp_f32 v95, v95
    v_add_f32 v48, v44, v45
    v_add_f32 v49, v46, v47
    v_add_f32 v96, v92, v93
    v_add_f32 v97, v94, v95
    v_add_f32 v48, v48, v49
    v_add_f32 v96, v96, v97
    v_mov_b32 v49, v48
    v_mov_b32 v97, v96
    s_nop 1
    v_permlane16_swap_b32 v48, v49
    v_permlane16_swap_b32 v96, v97
    s_nop 0
    v_add_f32 v48, v48, v49
    v_add_f32 v96, v96, v97
    v_mov_b32 v49, v48
    v_mov_b32 v97, v96
    s_nop 1
    v_permlane32_swap_b32 v48, v49
    v_permlane32_swap_b32 v96, v97
    s_nop 0
    v_add_f32 v48, v48, v49
    v_add_f32 v96, v96, v97
    v_rcp_f32 v48, v48
    v_rcp_f32 v96, v96
    s_nop 0
    v_mul_f32 v44, v44, v48
    v_mul_f32 v45, v45, v48
    v_mul_f32 v46, v46, v48
    v_mul_f32 v47, v47, v48
    v_mul_f32 v92, v92, v96
    v_mul_f32 v93, v93, v96
    v_mul_f32 v94, v94, v96
    v_mul_f32 v95, v95, v96
    v_cvt_pk_bf16_f32 v48, v44, v45
    v_cvt_pk_bf16_f32 v49, v46, v47
    v_cvt_pk_bf16_f32 v96, v92, v93
    v_cvt_pk_bf16_f32 v97, v94, v95
    v_cndmask_b32 v52, 0, v48, s[56:57]
    v_cndmask_b32 v53, 0, v49, s[56:57]
    v_cndmask_b32 v54, v48, 0, s[56:57]
    v_cndmask_b32 v55, v49, 0, s[56:57]
    v_cndmask_b32 v100, 0, v96, s[56:57]
    v_cndmask_b32 v101, 0, v97, s[56:57]
    v_cndmask_b32 v102, v96, 0, s[56:57]
    v_cndmask_b32 v103, v97, 0, s[56:57]
    s_waitcnt lgkmcnt(0)
    s_nop 0
    v_mfma_f32_16x16x32_bf16 v[56:59], v[36:39], v[52:55], 0
    v_mfma_f32_16x16x32_bf16 v[60:63], v[40:43], v[52:55], 0
    v_mfma_f32_16x16x32_bf16 v[104:107], v[84:87], v[100:103], 0
    v_mfma_f32_16x16x32_bf16 v[108:111], v[88:91], v[100:103], 0
    s_nop 7
    v_cvt_pk_bf16_f32 v64, v56, v57
    v_cvt_pk_bf16_f32 v65, v58, v59
    v_cvt_pk_bf16_f32 v66, v60, v61
    v_cvt_pk_bf16_f32 v67, v62, v63
    buffer_store_dwordx4 v[64:67], v9, s[16:19], 0 offen offset:0
    v_cvt_pk_bf16_f32 v112, v104, v105
    v_cvt_pk_bf16_f32 v113, v106, v107
    v_cvt_pk_bf16_f32 v114, v108, v109
    v_cvt_pk_bf16_f32 v115, v110, v111
    buffer_store_dwordx4 v[112:115], v9, s[16:19], 0 offen offset:2048
g1_kernel_done:
    s_endpgm
.section .rodata,"a"
.p2align 6
.amdhsa_kernel g1_kernel
  .amdhsa_next_free_vgpr 216
  .amdhsa_next_free_sgpr 64
  .amdhsa_accum_offset 216
  .amdhsa_group_segment_fixed_size 0
  .amdhsa_kernarg_size 88
  .amdhsa_user_sgpr_count 2
  .amdhsa_user_sgpr_kernarg_segment_ptr 1
  .amdhsa_system_sgpr_workgroup_id_x 1
.end_amdhsa_kernel
.text
.globl g2a_kernel
.p2align 8
.type g2a_kernel,@function
g2a_kernel:
    s_load_dwordx2 s[6:7], s[0:1], 0
    s_mov_b32 s47, 0
    s_branch g2_body
.text
.globl g2b_kernel
.p2align 8
.type g2b_kernel,@function
g2b_kernel:
    s_load_dwordx2 s[6:7], s[0:1], 80
    s_mov_b32 s47, 0x2000000
    s_branch g2_body
g2_body:
    s_cmp_ge_u32 s2, 256
    s_cbranch_scc1 g2_done
    s_load_dwordx2 s[4:5], s[0:1], 80
    s_load_dwordx2 s[30:31], s[0:1], 16
    v_lshrrev_b32 v1, 6, v0
    v_and_b32 v2, 63, v0
    s_and_b32 s40, s2, 3
    s_lshl_b32 s40, s40, 2
    s_bfe_u32 s41, s2, 0x20003
    s_add_u32 s25, s40, s41
    s_bfe_u32 s40, s2, 0x10002
    s_lshl_b32 s40, s40, 3
    s_lshr_b32 s42, s2, 5
    s_add_u32 s24, s40, s42
    s_add_u32 s27, s41, s42
    s_mov_b32 s26, 0
    v_readfirstlane_b32 s28, v1
    s_waitcnt lgkmcnt(0)
    s_mov_b32 s8, s30
    s_mov_b32 s9, s31
    s_mov_b32 s10, 0x200000
    s_mov_b32 s11, 0x20000
    s_add_u32 s12, s4, 0x400000
    s_addc_u32 s13, s5, 0
    s_mov_b32 s14, 0x400000
    s_mov_b32 s15, 0x20000
    s_add_u32 s16, s4, 0x800000
    s_addc_u32 s17, s5, 0
    s_mov_b32 s18, 0x400000
    s_mov_b32 s19, 0x20000
    s_add_u32 s20, s6, s47
    s_addc_u32 s21, s7, 0
    s_mov_b32 s22, 0x400000
    s_mov_b32 s23, 0x20000
    s_cmp_ge_u32 s28, 4
    s_cbranch_scc1 g2_loader
    v_lshrrev_b32 v5, 4, v2
    v_bfe_u32 v6, v2, 2, 2
    v_and_b32 v7, 3, v2
    v_and_b32 v8, 15, v2
    s_and_b32 s44, s28, 0
    s_lshr_b32 s45, s28, 0
    s_mul_i32 s40, s25, 128
    s_mul_i32 s41, s45, 32
    s_add_u32 s40, s40, s41
    v_add_u32 v3, s40, v8
    s_mov_b32 s41, 2048
    v_mul_lo_u32 v9, v3, s41
    s_mul_i32 s40, s24, 128
    s_mul_i32 s41, s44, 128
    s_add_u32 s40, s40, s41
    v_and_b32 v3, 1, v5
    v_lshlrev_b32 v3, 5, v3
    v_lshrrev_b32 v4, 1, v5
    v_lshl_add_u32 v3, v4, 4, v3
    v_add3_u32 v9, v9, v3, s40
    s_mov_b32 s52, 0
    s_mov_b32 s53, 32768
    buffer_load_dwordx4 v[96:99], v9, s[20:23], s52 offen offset:0
    buffer_load_dwordx4 v[100:103], v9, s[20:23], s52 offen offset:64
    buffer_load_dwordx4 v[104:107], v9, s[20:23], s53 offen offset:0
    buffer_load_dwordx4 v[108:111], v9, s[20:23], s53 offen offset:64
    s_mul_i32 s42, s44, 4
    s_mov_b32 s43, 0
    v_and_b32 v3, 1, v5
    v_lshlrev_b32 v3, 1, v3
    v_lshrrev_b32 v4, 1, v6
    v_or_b32 v3, v3, v4
    s_add_u32 s40, s42, 0
    v_xor_b32 v3, s40, v3
    v_lshlrev_b32 v3, 5, v3
    v_lshl_add_u32 v3, v7, 3, v3
    v_lshl_add_u32 v4, v5, 3, v6
    v_lshl_add_u32 v3, v4, 7, v3
    v_add_u32 v10, s43, v3
    v_and_b32 v3, 1, v5
    v_lshlrev_b32 v3, 1, v3
    v_lshrrev_b32 v4, 1, v6
    v_or_b32 v3, v3, v4
    s_add_u32 s40, s42, 1
    v_xor_b32 v3, s40, v3
    v_lshlrev_b32 v3, 5, v3
    v_lshl_add_u32 v3, v7, 3, v3
    v_lshl_add_u32 v4, v5, 3, v6
    v_lshl_add_u32 v3, v4, 7, v3
    v_add_u32 v11, s43, v3
    v_and_b32 v3, 1, v5
    v_lshlrev_b32 v3, 1, v3
    v_lshrrev_b32 v4, 1, v6
    v_or_b32 v3, v3, v4
    s_add_u32 s40, s42, 2
    v_xor_b32 v3, s40, v3
    v_lshlrev_b32 v3, 5, v3
    v_lshl_add_u32 v3, v7, 3, v3
    v_lshl_add_u32 v4, v5, 3, v6
    v_lshl_add_u32 v3, v4, 7, v3
    v_add_u32 v12, s43, v3
    v_and_b32 v3, 1, v5
    v_lshlrev_b32 v3, 1, v3
    v_lshrrev_b32 v4, 1, v6
    v_or_b32 v3, v3, v4
    s_add_u32 s40, s42, 3
    v_xor_b32 v3, s40, v3
    v_lshlrev_b32 v3, 5, v3
    v_lshl_add_u32 v3, v7, 3, v3
    v_lshl_add_u32 v4, v5, 3, v6
    v_lshl_add_u32 v3, v4, 7, v3
    v_add_u32 v13, s43, v3
    s_mul_i32 s42, s45, 32
    v_lshrrev_b32 v3, 1, v8
    v_xor_b32 v3, v3, v5
    v_lshlrev_b32 v3, 4, v3
    v_lshl_add_u32 v3, v8, 7, v3
    s_lshl_b32 s40, s42, 7
    s_add_u32 s40, s40, 8192
    v_add_u32 v14, s40, v3
    v_xor_b32 v15, 64, v14
    s_waitcnt vmcnt(0)
    v_permlane16_swap_b32 v96, v98
    v_permlane16_swap_b32 v97, v99
    v_permlane16_swap_b32 v100, v102
    v_permlane16_swap_b32 v101, v103
    v_permlane16_swap_b32 v104, v106
    v_permlane16_swap_b32 v105, v107
    v_permlane16_swap_b32 v108, v110
    v_permlane16_swap_b32 v109, v111
    v_lshlrev_b32 v64, 16, v96
    v_and_b32 v65, 0xffff0000, v96
    v_lshlrev_b32 v66, 16, v97
    v_and_b32 v67, 0xffff0000, v97
    v_lshlrev_b32 v72, 16, v98
    v_and_b32 v73, 0xffff0000, v98
    v_lshlrev_b32 v74, 16, v99
    v_and_b32 v75, 0xffff0000, v99
    v_lshlrev_b32 v80, 16, v100
    v_and_b32 v81, 0xffff0000, v100
    v_lshlrev_b32 v82, 16, v101
    v_and_b32 v83, 0xffff0000, v101
    v_lshlrev_b32 v88, 16, v102
    v_and_b32 v89, 0xffff0000, v102
    v_lshlrev_b32 v90, 16, v103
    v_and_b32 v91, 0xffff0000, v103
    v_lshlrev_b32 v68, 16, v104
    v_and_b32 v69, 0xffff0000, v104
    v_lshlrev_b32 v70, 16, v105
    v_and_b32 v71, 0xffff0000, v105
    v_lshlrev_b32 v76, 16, v106
    v_and_b32 v77, 0xffff0000, v106
    v_lshlrev_b32 v78, 16, v107
    v_and_b32 v79, 0xffff0000, v107
    v_lshlrev_b32 v84, 16, v108
    v_and_b32 v85, 0xffff0000, v108
    v_lshlrev_b32 v86, 16, v109
    v_and_b32 v87, 0xffff0000, v109
    v_lshlrev_b32 v92, 16, v110
    v_and_b32 v93, 0xffff0000, v110
    v_lshlrev_b32 v94, 16, v111
    v_and_b32 v95, 0xffff0000, v111
    v_mov_b32 v120, 0
    v_mov_b32 v121, 0
    v_mov_b32 v122, 0
    v_mov_b32 v123, 0
    v_mov_b32 v124, 0
    v_mov_b32 v125, 0
    v_mov_b32 v126, 0
    v_mov_b32 v127, 0
    v_mov_b32 v128, 0
    v_mov_b32 v129, 0
    v_mov_b32 v130, 0
    v_mov_b32 v131, 0
    v_mov_b32 v132, 0
    v_mov_b32 v133, 0
    v_mov_b32 v134, 0
    v_mov_b32 v135, 0
    v_mov_b32 v136, 0
    v_mov_b32 v137, 0
    v_mov_b32 v138, 0
    v_mov_b32 v139, 0
    v_mov_b32 v140, 0
    v_mov_b32 v141, 0
    v_mov_b32 v142, 0
    v_mov_b32 v143, 0
    s_mov_b32 s48, 16
    s_mov_b32 s50, 0
    s_mov_b32 s60, 24576
    s_mov_b32 s61, 0xfffee000
.p2align 3
g2_cloop:
    s_barrier
    v_mfma_f32_16x16x32_bf16 v[64:67], v[120:123], v[136:139], v[64:67]
    ds_read_b64_tr_b16 v[96:97], v10 offset:0
    ds_read_b64_tr_b16 v[98:99], v10 offset:512
    v_mfma_f32_16x16x32_bf16 v[68:71], v[120:123], v[140:143], v[68:71]
    ds_read_b128 v[112:115], v14 offset:0
    v_mfma_f32_16x16x32_bf16 v[72:75], v[124:127], v[136:139], v[72:75]
    ds_read_b128 v[116:119], v14 offset:2048
    v_mfma_f32_16x16x32_bf16 v[76:79], v[124:127], v[140:143], v[76:79]
    ds_read_b64_tr_b16 v[100:101], v11 offset:0
    ds_read_b64_tr_b16 v[102:103], v11 offset:512
    v_mfma_f32_16x16x32_bf16 v[80:83], v[128:131], v[136:139], v[80:83]
    ds_read_b64_tr_b16 v[104:105], v12 offset:0
    ds_read_b64_tr_b16 v[106:107], v12 offset:512
    v_mfma_f32_16x16x32_bf16 v[84:87], v[128:131], v[140:143], v[84:87]
    ds_read_b64_tr_b16 v[108:109], v13 offset:0
    ds_read_b64_tr_b16 v[110:111], v13 offset:512
    v_mfma_f32_16x16x32_bf16 v[88:91], v[132:135], v[136:139], v[88:91]
    v_mfma_f32_16x16x32_bf16 v[92:95], v[132:135], v[140:143], v[92:95]
    s_waitcnt lgkmcnt(0)
    v_mfma_f32_16x16x32_bf16 v[64:67], v[96:99], v[112:115], v[64:67]
    ds_read_b64_tr_b16 v[120:121], v10 offset:4096
    ds_read_b64_tr_b16 v[122:123], v10 offset:4608
    v_mfma_f32_16x16x32_bf16 v[68:71], v[96:99], v[116:119], v[68:71]
    ds_read_b128 v[136:139], v15 offset:0
    v_mfma_f32_16x16x32_bf16 v[72:75], v[100:103], v[112:115], v[72:75]
    ds_read_b128 v[140:143], v15 offset:2048
    v_mfma_f32_16x16x32_bf16 v[76:79], v[100:103], v[116:119], v[76:79]
    ds_read_b64_tr_b16 v[124:125], v11 offset:4096
    ds_read_b64_tr_b16 v[126:127], v11 offset:4608
    v_mfma_f32_16x16x32_bf16 v[80:83], v[104:107], v[112:115], v[80:83]
    ds_read_b64_tr_b16 v[128:129], v12 offset:4096
    ds_read_b64_tr_b16 v[130:131], v12 offset:4608
    v_mfma_f32_16x16x32_bf16 v[84:87], v[104:107], v[116:119], v[84:87]
    ds_read_b64_tr_b16 v[132:133], v13 offset:4096
    ds_read_b64_tr_b16 v[134:135], v13 offset:4608
    v_mfma_f32_16x16x32_bf16 v[88:91], v[108:111], v[112:115], v[88:91]
    s_add_u32 s50, s50, 1
    s_cmp_eq_u32 s50, 4
    v_mfma_f32_16x16x32_bf16 v[92:95], v[108:111], v[116:119], v[92:95]
    s_cselect_b32 s49, s61, s60
    s_cselect_b32 s50, 0, s50
    v_add_u32 v10, s49, v10
    v_add_u32 v11, s49, v11
    v_add_u32 v12, s49, v12
    v_add_u32 v13, s49, v13
    v_add_u32 v14, s49, v14
    v_add_u32 v15, s49, v15
    s_sub_u32 s48, s48, 1
    s_cmp_lg_u32 s48, 0
    s_waitcnt lgkmcnt(0)
    s_cbranch_scc1 g2_cloop
    v_mfma_f32_16x16x32_bf16 v[64:67], v[120:123], v[136:139], v[64:67]
    v_mfma_f32_16x16x32_bf16 v[68:71], v[120:123], v[140:143], v[68:71]
    v_mfma_f32_16x16x32_bf16 v[72:75], v[124:127], v[136:139], v[72:75]
    v_mfma_f32_16x16x32_bf16 v[76:79], v[124:127], v[140:143], v[76:79]
    v_mfma_f32_16x16x32_bf16 v[80:83], v[128:131], v[136:139], v[80:83]
    v_mfma_f32_16x16x32_bf16 v[84:87], v[128:131], v[140:143], v[84:87]
    v_mfma_f32_16x16x32_bf16 v[88:91], v[132:135], v[136:139], v[88:91]
    v_mfma_f32_16x16x32_bf16 v[92:95], v[132:135], v[140:143], v[92:95]
    s_nop 7
    v_cvt_pk_bf16_f32 v96, v64, v65
    v_cvt_pk_bf16_f32 v97, v66, v67
    v_cvt_pk_bf16_f32 v98, v72, v73
    v_cvt_pk_bf16_f32 v99, v74, v75
    s_nop 1
    v_permlane16_swap_b32 v96, v98
    v_permlane16_swap_b32 v97, v99
    buffer_store_dwordx4 v[96:99], v9, s[16:19], s52 offen offset:0
    v_cvt_pk_bf16_f32 v100, v80, v81
    v_cvt_pk_bf16_f32 v101, v82, v83
    v_cvt_pk_bf16_f32 v102, v88, v89
    v_cvt_pk_bf16_f32 v103, v90, v91
    s_nop 1
    v_permlane16_swap_b32 v100, v102
    v_permlane16_swap_b32 v101, v103
    buffer_store_dwordx4 v[100:103], v9, s[16:19], s52 offen offset:64
    v_cvt_pk_bf16_f32 v104, v68, v69
    v_cvt_pk_bf16_f32 v105, v70, v71
    v_cvt_pk_bf16_f32 v106, v76, v77
    v_cvt_pk_bf16_f32 v107, v78, v79
    s_nop 1
    v_permlane16_swap_b32 v104, v106
    v_permlane16_swap_b32 v105, v107
    buffer_store_dwordx4 v[104:107], v9, s[16:19], s53 offen offset:0
    v_cvt_pk_bf16_f32 v108, v84, v85
    v_cvt_pk_bf16_f32 v109, v86, v87
    v_cvt_pk_bf16_f32 v110, v92, v93
    v_cvt_pk_bf16_f32 v111, v94, v95
    s_nop 1
    v_permlane16_swap_b32 v108, v110
    v_permlane16_swap_b32 v109, v111
    buffer_store_dwordx4 v[108:111], v9, s[16:19], s53 offen offset:64
    s_endpgm
g2_loader:
    s_sub_u32 s28, s28, 4
    s_mov_b32 s40, 2048
    v_lshrrev_b32 v3, 3, v2
    v_mul_lo_u32 v3, v3, s40
    v_bfe_u32 v4, v2, 4, 1
    v_lshlrev_b32 v4, 1, v4
    v_xor_b32 v4, v4, v2
    v_and_b32 v4, 7, v4
    v_lshl_add_u32 v3, v4, 4, v3
    s_mul_i32 s41, s24, 128
    s_mul_i32 s42, s28, 32768
    s_add_u32 s41, s41, s42
    v_xor_b32 v4, 64, v3
    s_add_u32 s42, s41, 0
    v_add_u32 v10, s42, v3
    s_add_u32 s42, s41, 16384
    v_add_u32 v11, s42, v4
    s_mov_b32 s40, 2048
    v_lshrrev_b32 v3, 3, v2
    v_mul_lo_u32 v3, v3, s40
    v_lshrrev_b32 v4, 4, v2
    v_xor_b32 v4, v4, v2
    v_and_b32 v4, 7, v4
    v_lshl_add_u32 v3, v4, 4, v3
    s_mul_i32 s41, s25, 262144
    s_mul_i32 s42, s28, 65536
    s_add_u32 s41, s41, s42
    v_xor_b32 v4, 64, v3
    s_add_u32 s42, s41, 0
    v_add_u32 v12, s42, v3
    s_add_u32 s42, s41, 16384
    v_add_u32 v13, s42, v4
    s_add_u32 s42, s41, 32768
    v_add_u32 v14, s42, v3
    s_add_u32 s42, s41, 49152
    v_add_u32 v15, s42, v4
    s_mul_i32 s36, s28, 2048
    s_mul_i32 s37, s28, 4096
    s_add_u32 s37, s37, 8192
    s_mov_b32 s32, 0
    s_mov_b32 s33, 0
g2_ld_loop:
    s_cmp_lt_u32 s32, 3
    s_cbranch_scc1 g2_ld_issue
    s_waitcnt vmcnt(12)
    s_barrier
g2_ld_issue:
    s_add_u32 s40, s32, s27
    s_and_b32 s40, s40, 3
    s_andn2_b32 s41, s32, 3
    s_or_b32 s40, s40, s41
    s_add_u32 s40, s40, s26
    s_mul_i32 s34, s40, 131072
    s_mul_i32 s35, s40, 128
    s_add_u32 s38, s33, s36
    s_add_u32 s39, s33, s37
    s_add_u32 m0, s38, 0
    s_nop 0
    buffer_load_dwordx4 v10, s[8:11], s34 offen lds
    s_add_u32 m0, s38, 1024
    s_nop 0
    buffer_load_dwordx4 v11, s[8:11], s34 offen lds
    s_add_u32 m0, s39, 0
    s_nop 0
    buffer_load_dwordx4 v12, s[12:15], s35 offen lds
    s_add_u32 m0, s39, 1024
    s_nop 0
    buffer_load_dwordx4 v13, s[12:15], s35 offen lds
    s_add_u32 m0, s39, 2048
    s_nop 0
    buffer_load_dwordx4 v14, s[12:15], s35 offen lds
    s_add_u32 m0, s39, 3072
    s_nop 0
    buffer_load_dwordx4 v15, s[12:15], s35 offen lds
    s_add_u32 s33, s33, 24576
    s_cmp_eq_u32 s33, 98304
    s_cselect_b32 s33, 0, s33
    s_add_u32 s32, s32, 1
    s_cmp_lt_u32 s32, 16
    s_cbranch_scc1 g2_ld_loop
    s_waitcnt vmcnt(12)
    s_barrier
    s_waitcnt vmcnt(6)
    s_barrier
    s_waitcnt vmcnt(0)
    s_barrier
g2_done:
    s_endpgm
.section .rodata,"a"
.p2align 6
.amdhsa_kernel g2a_kernel
  .amdhsa_next_free_vgpr 144
  .amdhsa_next_free_sgpr 64
  .amdhsa_accum_offset 144
  .amdhsa_group_segment_fixed_size 0
  .amdhsa_kernarg_size 88
  .amdhsa_user_sgpr_count 2
  .amdhsa_user_sgpr_kernarg_segment_ptr 1
  .amdhsa_system_sgpr_workgroup_id_x 1
.end_amdhsa_kernel
.section .rodata,"a"
.p2align 6
.amdhsa_kernel g2b_kernel
  .amdhsa_next_free_vgpr 144
  .amdhsa_next_free_sgpr 64
  .amdhsa_accum_offset 144
  .amdhsa_group_segment_fixed_size 0
  .amdhsa_kernarg_size 88
  .amdhsa_user_sgpr_count 2
  .amdhsa_user_sgpr_kernarg_segment_ptr 1
  .amdhsa_system_sgpr_workgroup_id_x 1
.end_amdhsa_kernel
.text
.globl ln3_kernel
.p2align 8
.type ln3_kernel,@function
ln3_kernel:
    s_cmp_ge_u32 s2, 512
    s_cbranch_scc1 ln3_kernel_done
    s_load_dwordx2 s[4:5], s[0:1], 80
    v_lshrrev_b32 v1, 6, v0
    v_and_b32 v2, 63, v0
    s_lshl_b32 s3, s2, 2
    v_add_u32 v1, s3, v1
    v_lshlrev_b32 v3, 11, v1
    v_lshl_add_u32 v3, v2, 4, v3
    v_lshlrev_b32 v4, 1, v1
    s_waitcnt lgkmcnt(0)
    s_add_u32 s8, s4, 0x800000
    s_addc_u32 s9, s5, 0
    s_mov_b32 s10, 0x400000
    s_mov_b32 s11, 0x20000
    s_add_u32 s12, s4, 0xc00000
    s_addc_u32 s13, s5, 0
    s_mov_b32 s14, 0x400000
    s_mov_b32 s15, 0x20000
    buffer_load_dwordx4 v[8:11], v3, s[8:11], 0 offen
    buffer_load_dwordx4 v[12:15], v3, s[8:11], 0 offen offset:1024
    s_waitcnt vmcnt(0)
    v_lshlrev_b32 v16, 16, v8
    v_and_b32 v17, 0xffff0000, v8
    v_lshlrev_b32 v18, 16, v9
    v_and_b32 v19, 0xffff0000, v9
    v_lshlrev_b32 v20, 16, v10
    v_and_b32 v21, 0xffff0000, v10
    v_lshlrev_b32 v22, 16, v11
    v_and_b32 v23, 0xffff0000, v11
    v_lshlrev_b32 v24, 16, v12
    v_and_b32 v25, 0xffff0000, v12
    v_lshlrev_b32 v26, 16, v13
    v_and_b32 v27, 0xffff0000, v13
    v_lshlrev_b32 v28, 16, v14
    v_and_b32 v29, 0xffff0000, v14
    v_lshlrev_b32 v30, 16, v15
    v_and_b32 v31, 0xffff0000, v15
    v_pk_add_f32 v[32:33], v[16:17], v[18:19]
    v_pk_add_f32 v[34:35], v[20:21], v[22:23]
    v_pk_add_f32 v[36:37], v[24:25], v[26:27]
    v_pk_add_f32 v[38:39], v[28:29], v[30:31]
    v_pk_add_f32 v[32:33], v[32:33], v[34:35]
    v_pk_add_f32 v[36:37], v[36:37], v[38:39]
    v_pk_add_f32 v[32:33], v[32:33], v[36:37]
    v_add_f32 v48, v32, v33
    s_nop 1
    v_add_f32_dpp v48, v48, v48 quad_perm:[1,0,3,2] row_mask:0xf bank_mask:0xf
    s_nop 1
    v_add_f32_dpp v48, v48, v48 quad_perm:[2,3,0,1] row_mask:0xf bank_mask:0xf
    s_nop 1
    v_add_f32_dpp v48, v48, v48 row_half_mirror row_mask:0xf bank_mask:0xf
    s_nop 1
    v_add_f32_dpp v48, v48, v48 row_mirror row_mask:0xf bank_mask:0xf
    s_nop 1
    v_add_f32_dpp v48, v48, v48 row_bcast:15 row_mask:0xa bank_mask:0xf
    s_nop 1
    v_add_f32_dpp v48, v48, v48 row_bcast:31 row_mask:0xc bank_mask:0xf
    s_nop 1
    v_readlane_b32 s40, v48, 63
    s_nop 1
    v_mov_b32 v49, 0xba800000
    v_mul_f32 v48, s40, v49
    v_mov_b32 v49, v48
    v_pk_add_f32 v[32:33], v[16:17], v[48:49]
    v_pk_add_f32 v[34:35], v[18:19], v[48:49]
    v_pk_add_f32 v[36:37], v[20:21], v[48:49]
    v_pk_add_f32 v[38:39], v[22:23], v[48:49]
    v_pk_add_f32 v[40:41], v[24:25], v[48:49]
    v_pk_add_f32 v[42:43], v[26:27], v[48:49]
    v_pk_add_f32 v[44:45], v[28:29], v[48:49]
    v_pk_add_f32 v[46:47], v[30:31], v[48:49]
    v_pk_mul_f32 v[50:51], v[32:33], v[32:33]
    v_pk_fma_f32 v[50:51], v[34:35], v[34:35], v[50:51]
    v_pk_fma_f32 v[50:51], v[36:37], v[36:37], v[50:51]
    v_pk_fma_f32 v[50:51], v[38:39], v[38:39], v[50:51]
    v_pk_fma_f32 v[50:51], v[40:41], v[40:41], v[50:51]
    v_pk_fma_f32 v[50:51], v[42:43], v[42:43], v[50:51]
    v_pk_fma_f32 v[50:51], v[44:45], v[44:45], v[50:51]
    v_pk_fma_f32 v[50:51], v[46:47], v[46:47], v[50:51]
    v_add_f32 v50, v50, v51
    v_cvt_pk_bf16_f32 v48, v48, v48
    v_lshlrev_b32 v48, 16, v48
    v_mov_b32 v49, v48
    s_nop 1
    v_add_f32_dpp v50, v50, v50 quad_perm:[1,0,3,2] row_mask:0xf bank_mask:0xf
    s_nop 1
    v_add_f32_dpp v50, v50, v50 quad_perm:[2,3,0,1] row_mask:0xf bank_mask:0xf
    s_nop 1
    v_add_f32_dpp v50, v50, v50 row_half_mirror row_mask:0xf bank_mask:0xf
    s_nop 1
    v_add_f32_dpp v50, v50, v50 row_mirror row_mask:0xf bank_mask:0xf
    s_nop 1
    v_add_f32_dpp v50, v50, v50 row_bcast:15 row_mask:0xa bank_mask:0xf
    s_nop 1
    v_add_f32_dpp v50, v50, v50 row_bcast:31 row_mask:0xc bank_mask:0xf
    s_nop 1
    v_readlane_b32 s41, v50, 63
    s_nop 1
    v_pk_add_f32 v[32:33], v[16:17], v[48:49]
    v_pk_add_f32 v[34:35], v[18:19], v[48:49]
    v_pk_add_f32 v[36:37], v[20:21], v[48:49]
    v_pk_add_f32 v[38:39], v[22:23], v[48:49]
    v_pk_add_f32 v[40:41], v[24:25], v[48:49]
    v_pk_add_f32 v[42:43], v[26:27], v[48:49]
    v_pk_add_f32 v[44:45], v[28:29], v[48:49]
    v_pk_add_f32 v[46:47], v[30:31], v[48:49]
    v_mov_b32 v50, 0x3a800000
    v_mul_f32 v50, s41, v50
    v_cvt_pk_bf16_f32 v50, v50, v50
    v_lshlrev_b32 v50, 16, v50
    v_add_f32 v50, 0x3727c5ac, v50
    v_cvt_pk_bf16_f32 v50, v50, v50
    v_lshlrev_b32 v50, 16, v50
    v_sqrt_f32 v50, v50
    v_cvt_pk_bf16_f32 v8, v32, v33
    v_cvt_pk_bf16_f32 v9, v34, v35
    v_cvt_pk_bf16_f32 v10, v36, v37
    v_cvt_pk_bf16_f32 v11, v38, v39
    v_cvt_pk_bf16_f32 v12, v40, v41
    v_cvt_pk_bf16_f32 v13, v42, v43
    v_cvt_pk_bf16_f32 v14, v44, v45
    v_cvt_pk_bf16_f32 v15, v46, v47
    v_cvt_pk_bf16_f32 v50, v50, v50
    v_lshlrev_b32 v50, 16, v50
    v_rcp_f32 v50, v50
    v_lshlrev_b32 v32, 16, v8
    v_and_b32 v33, 0xffff0000, v8
    v_lshlrev_b32 v34, 16, v9
    v_and_b32 v35, 0xffff0000, v9
    v_lshlrev_b32 v36, 16, v10
    v_and_b32 v37, 0xffff0000, v10
    v_lshlrev_b32 v38, 16, v11
    v_and_b32 v39, 0xffff0000, v11
    v_lshlrev_b32 v40, 16, v12
    v_and_b32 v41, 0xffff0000, v12
    v_lshlrev_b32 v42, 16, v13
    v_and_b32 v43, 0xffff0000, v13
    v_lshlrev_b32 v44, 16, v14
    v_and_b32 v45, 0xffff0000, v14
    v_lshlrev_b32 v46, 16, v15
    v_and_b32 v47, 0xffff0000, v15
    v_mov_b32 v51, v50
    v_pk_mul_f32 v[32:33], v[32:33], v[50:51]
    v_pk_mul_f32 v[34:35], v[34:35], v[50:51]
    v_pk_mul_f32 v[36:37], v[36:37], v[50:51]
    v_pk_mul_f32 v[38:39], v[38:39], v[50:51]
    v_pk_mul_f32 v[40:41], v[40:41], v[50:51]
    v_pk_mul_f32 v[42:43], v[42:43], v[50:51]
    v_pk_mul_f32 v[44:45], v[44:45], v[50:51]
    v_pk_mul_f32 v[46:47], v[46:47], v[50:51]
    v_cvt_pk_bf16_f32 v8, v32, v33
    v_cvt_pk_bf16_f32 v9, v34, v35
    v_cvt_pk_bf16_f32 v10, v36, v37
    v_cvt_pk_bf16_f32 v11, v38, v39
    v_cvt_pk_bf16_f32 v12, v40, v41
    v_cvt_pk_bf16_f32 v13, v42, v43
    v_cvt_pk_bf16_f32 v14, v44, v45
    v_cvt_pk_bf16_f32 v15, v46, v47
    v_lshlrev_b32 v16, 16, v8
    v_and_b32 v17, 0xffff0000, v8
    v_lshlrev_b32 v18, 16, v9
    v_and_b32 v19, 0xffff0000, v9
    v_lshlrev_b32 v20, 16, v10
    v_and_b32 v21, 0xffff0000, v10
    v_lshlrev_b32 v22, 16, v11
    v_and_b32 v23, 0xffff0000, v11
    v_lshlrev_b32 v24, 16, v12
    v_and_b32 v25, 0xffff0000, v12
    v_lshlrev_b32 v26, 16, v13
    v_and_b32 v27, 0xffff0000, v13
    v_lshlrev_b32 v28, 16, v14
    v_and_b32 v29, 0xffff0000, v14
    v_lshlrev_b32 v30, 16, v15
    v_and_b32 v31, 0xffff0000, v15
    v_pk_add_f32 v[32:33], v[16:17], v[18:19]
    v_pk_add_f32 v[34:35], v[20:21], v[22:23]
    v_pk_add_f32 v[36:37], v[24:25], v[26:27]
    v_pk_add_f32 v[38:39], v[28:29], v[30:31]
    v_pk_add_f32 v[32:33], v[32:33], v[34:35]
    v_pk_add_f32 v[36:37], v[36:37], v[38:39]
    v_pk_add_f32 v[32:33], v[32:33], v[36:37]
    v_add_f32 v48, v32, v33
    s_nop 1
    v_add_f32_dpp v48, v48, v48 quad_perm:[1,0,3,2] row_mask:0xf bank_mask:0xf
    s_nop 1
    v_add_f32_dpp v48, v48, v48 quad_perm:[2,3,0,1] row_mask:0xf bank_mask:0xf
    s_nop 1
    v_add_f32_dpp v48, v48, v48 row_half_mirror row_mask:0xf bank_mask:0xf
    s_nop 1
    v_add_f32_dpp v48, v48, v48 row_mirror row_mask:0xf bank_mask:0xf
    s_nop 1
    v_add_f32_dpp v48, v48, v48 row_bcast:15 row_mask:0xa bank_mask:0xf
    s_nop 1
    v_add_f32_dpp v48, v48, v48 row_bcast:31 row_mask:0xc bank_mask:0xf
    s_nop 1
    v_readlane_b32 s40, v48, 63
    s_nop 1
    v_mov_b32 v49, 0xba800000
    v_mul_f32 v48, s40, v49
    v_mov_b32 v49, v48
    v_pk_add_f32 v[32:33], v[16:17], v[48:49]
    v_pk_add_f32 v[34:35], v[18:19], v[48:49]
    v_pk_add_f32 v[36:37], v[20:21], v[48:49]
    v_pk_add_f32 v[38:39], v[22:23], v[48:49]
    v_pk_add_f32 v[40:41], v[24:25], v[48:49]
    v_pk_add_f32 v[42:43], v[26:27], v[48:49]
    v_pk_add_f32 v[44:45], v[28:29], v[48:49]
    v_pk_add_f32 v[46:47], v[30:31], v[48:49]
    v_pk_mul_f32 v[50:51], v[32:33], v[32:33]
    v_pk_fma_f32 v[50:51], v[34:35], v[34:35], v[50:51]
    v_pk_fma_f32 v[50:51], v[36:37], v[36:37], v[50:51]
    v_pk_fma_f32 v[50:51], v[38:39], v[38:39], v[50:51]
    v_pk_fma_f32 v[50:51], v[40:41], v[40:41], v[50:51]
    v_pk_fma_f32 v[50:51], v[42:43], v[42:43], v[50:51]
    v_pk_fma_f32 v[50:51], v[44:45], v[44:45], v[50:51]
    v_pk_fma_f32 v[50:51], v[46:47], v[46:47], v[50:51]
    v_add_f32 v50, v50, v51
    v_cvt_pk_bf16_f32 v48, v48, v48
    v_lshlrev_b32 v48, 16, v48
    v_mov_b32 v49, v48
    s_nop 1
    v_add_f32_dpp v50, v50, v50 quad_perm:[1,0,3,2] row_mask:0xf bank_mask:0xf
    s_nop 1
    v_add_f32_dpp v50, v50, v50 quad_perm:[2,3,0,1] row_mask:0xf bank_mask:0xf
    s_nop 1
    v_add_f32_dpp v50, v50, v50 row_half_mirror row_mask:0xf bank_mask:0xf
    s_nop 1
    v_add_f32_dpp v50, v50, v50 row_mirror row_mask:0xf bank_mask:0xf
    s_nop 1
    v_add_f32_dpp v50, v50, v50 row_bcast:15 row_mask:0xa bank_mask:0xf
    s_nop 1
    v_add_f32_dpp v50, v50, v50 row_bcast:31 row_mask:0xc bank_mask:0xf
    s_nop 1
    v_readlane_b32 s41, v50, 63
    s_nop 1
    v_pk_add_f32 v[32:33], v[16:17], v[48:49]
    v_pk_add_f32 v[34:35], v[18:19], v[48:49]
    v_pk_add_f32 v[36:37], v[20:21], v[48:49]
    v_pk_add_f32 v[38:39], v[22:23], v[48:49]
    v_pk_add_f32 v[40:41], v[24:25], v[48:49]
    v_pk_add_f32 v[42:43], v[26:27], v[48:49]
    v_pk_add_f32 v[44:45], v[28:29], v[48:49]
    v_pk_add_f32 v[46:47], v[30:31], v[48:49]
    v_mov_b32 v50, 0x3a800000
    v_mul_f32 v50, s41, v50
    v_cvt_pk_bf16_f32 v50, v50, v50
    v_lshlrev_b32 v50, 16, v50
    v_add_f32 v50, 0x3727c5ac, v50
    v_cvt_pk_bf16_f32 v50, v50, v50
    v_lshlrev_b32 v50, 16, v50
    v_sqrt_f32 v50, v50
    v_cvt_pk_bf16_f32 v8, v32, v33
    v_cvt_pk_bf16_f32 v9, v34, v35
    v_cvt_pk_bf16_f32 v10, v36, v37
    v_cvt_pk_bf16_f32 v11, v38, v39
    v_cvt_pk_bf16_f32 v12, v40, v41
    v_cvt_pk_bf16_f32 v13, v42, v43
    v_cvt_pk_bf16_f32 v14, v44, v45
    v_cvt_pk_bf16_f32 v15, v46, v47
    v_cvt_pk_bf16_f32 v50, v50, v50
    v_lshlrev_b32 v50, 16, v50
    v_rcp_f32 v50, v50
    v_lshlrev_b32 v32, 16, v8
    v_and_b32 v33, 0xffff0000, v8
    v_lshlrev_b32 v34, 16, v9
    v_and_b32 v35, 0xffff0000, v9
    v_lshlrev_b32 v36, 16, v10
    v_and_b32 v37, 0xffff0000, v10
    v_lshlrev_b32 v38, 16, v11
    v_and_b32 v39, 0xffff0000, v11
    v_lshlrev_b32 v40, 16, v12
    v_and_b32 v41, 0xffff0000, v12
    v_lshlrev_b32 v42, 16, v13
    v_and_b32 v43, 0xffff0000, v13
    v_lshlrev_b32 v44, 16, v14
    v_and_b32 v45, 0xffff0000, v14
    v_lshlrev_b32 v46, 16, v15
    v_and_b32 v47, 0xffff0000, v15
    v_mov_b32 v51, v50
    v_pk_mul_f32 v[32:33], v[32:33], v[50:51]
    v_pk_mul_f32 v[34:35], v[34:35], v[50:51]
    v_pk_mul_f32 v[36:37], v[36:37], v[50:51]
    v_pk_mul_f32 v[38:39], v[38:39], v[50:51]
    v_pk_mul_f32 v[40:41], v[40:41], v[50:51]
    v_pk_mul_f32 v[42:43], v[42:43], v[50:51]
    v_pk_mul_f32 v[44:45], v[44:45], v[50:51]
    v_pk_mul_f32 v[46:47], v[46:47], v[50:51]
    v_cvt_pk_bf16_f32 v8, v32, v33
    v_cvt_pk_bf16_f32 v9, v34, v35
    v_cvt_pk_bf16_f32 v10, v36, v37
    v_cvt_pk_bf16_f32 v11, v38, v39
    v_cvt_pk_bf16_f32 v12, v40, v41
    v_cvt_pk_bf16_f32 v13, v42, v43
    v_cvt_pk_bf16_f32 v14, v44, v45
    v_cvt_pk_bf16_f32 v15, v46, v47
    buffer_store_dwordx4 v[8:11], v3, s[12:15], 0 offen
    buffer_store_dwordx4 v[12:15], v3, s[12:15], 0 offen offset:1024
ln3_kernel_done:
    s_endpgm
.section .rodata,"a"
.p2align 6
.amdhsa_kernel ln3_kernel
  .amdhsa_next_free_vgpr 68
  .amdhsa_next_free_sgpr 48
  .amdhsa_accum_offset 68
  .amdhsa_group_segment_fixed_size 0
  .amdhsa_kernarg_size 88
  .amdhsa_user_sgpr_count 2
  .amdhsa_user_sgpr_kernarg_segment_ptr 1
  .amdhsa_system_sgpr_workgroup_id_x 1
.end_amdhsa_kernel
.text
.globl g3_kernel
.p2align 8
.type g3_kernel,@function
g3_kernel:
    s_cmp_ge_u32 s2, 224
    s_cbranch_scc1 g3_kernel_done
    s_load_dwordx2 s[4:5], s[0:1], 80
    s_load_dwordx2 s[30:31], s[0:1], 32
    s_load_dwordx2 s[6:7], s[0:1], 40
    v_lshrrev_b32 v1, 6, v0
    v_and_b32 v2, 63, v0
    s_and_b32 s40, s2, 1
    s_lshl_b32 s40, s40, 2
    s_bfe_u32 s41, s2, 0x20003
    s_add_u32 s25, s40, s41
    s_bfe_u32 s40, s2, 0x20001
    s_mul_i32 s40, s40, 7
    s_lshr_b32 s42, s2, 5
    s_add_u32 s24, s40, s42
    s_add_u32 s27, s41, s42
    s_mov_b32 s26, 0
    v_readfirstlane_b32 s28, v1
    s_waitcnt lgkmcnt(0)
    s_mov_b32 s8, s30
    s_mov_b32 s9, s31
    s_mov_b32 s10, 0xe00000
    s_mov_b32 s11, 0x20000
    s_add_u32 s12, s4, 0xc00000
    s_addc_u32 s13, s5, 0
    s_mov_b32 s14, 0x400000
    s_mov_b32 s15, 0x20000
    s_add_u32 s16, s4, 0x1000000
    s_addc_u32 s17, s5, 0
    s_mov_b32 s18, 0x700000
    s_mov_b32 s19, 0x20000
    s_mov_b32 s20, s6
    s_mov_b32 s21, s7
    s_mov_b32 s22, 0x1c00
    s_mov_b32 s23, 0x20000
    s_cmp_ge_u32 s28, 4
    s_cbranch_scc1 g3_kernel_loader
    v_lshrrev_b32 v5, 4, v2
    v_bfe_u32 v6, v2, 2, 2
    v_and_b32 v7, 3, v2
    v_and_b32 v8, 15, v2
    s_and_b32 s44, s28, 1
    s_lshr_b32 s45, s28, 1
    s_mul_i32 s40, s25, 128
    s_mul_i32 s41, s45, 64
    s_add_u32 s40, s40, s41
    v_add_u32 v3, s40, v8
    s_mov_b32 s41, 7168
    v_mul_lo_u32 v9, v3, s41
    s_mul_i32 s40, s24, 256
    s_mul_i32 s41, s44, 128
    s_add_u32 s40, s40, s41
    v_and_b32 v3, 1, v5
    v_lshlrev_b32 v3, 5, v3
    v_lshrrev_b32 v4, 1, v5
    v_lshl_add_u32 v3, v4, 4, v3
    v_add3_u32 v9, v9, v3, s40
    s_mov_b32 s52, 0
    s_mov_b32 s53, 114688
    s_mov_b32 s54, 229376
    s_mov_b32 s55, 344064
    v_lshl_add_u32 v3, v5, 3, s40
    buffer_load_dwordx2 v[128:129], v3, s[20:23], 0 offen offset:0
    buffer_load_dwordx2 v[130:131], v3, s[20:23], 0 offen offset:32
    buffer_load_dwordx2 v[132:133], v3, s[20:23], 0 offen offset:64
    buffer_load_dwordx2 v[134:135], v3, s[20:23], 0 offen offset:96
    s_mul_i32 s42, s44, 4
    s_mov_b32 s43, 0
    v_and_b32 v3, 1, v5
    v_lshl_or_b32 v3, v3, 2, v6
    s_add_u32 s40, s42, 0
    v_xor_b32 v3, s40, v3
    v_lshlrev_b32 v3, 5, v3
    v_lshl_add_u32 v3, v7, 3, v3
    v_lshl_add_u32 v4, v5, 3, v6
    v_lshl_add_u32 v3, v4, 8, v3
    v_add_u32 v10, s43, v3
    v_and_b32 v3, 1, v5
    v_lshl_or_b32 v3, v3, 2, v6
    s_add_u32 s40, s42, 1
    v_xor_b32 v3, s40, v3
    v_lshlrev_b32 v3, 5, v3
    v_lshl_add_u32 v3, v7, 3, v3
    v_lshl_add_u32 v4, v5, 3, v6
    v_lshl_add_u32 v3, v4, 8, v3
    v_add_u32 v11, s43, v3
    v_and_b32 v3, 1, v5
    v_lshl_or_b32 v3, v3, 2, v6
    s_add_u32 s40, s42, 2
    v_xor_b32 v3, s40, v3
    v_lshlrev_b32 v3, 5, v3
    v_lshl_add_u32 v3, v7, 3, v3
    v_lshl_add_u32 v4, v5, 3, v6
    v_lshl_add_u32 v3, v4, 8, v3
    v_add_u32 v12, s43, v3
    v_and_b32 v3, 1, v5
    v_lshl_or_b32 v3, v3, 2, v6
    s_add_u32 s40, s42, 3
    v_xor_b32 v3, s40, v3
    v_lshlrev_b32 v3, 5, v3
    v_lshl_add_u32 v3, v7, 3, v3
    v_lshl_add_u32 v4, v5, 3, v6
    v_lshl_add_u32 v3, v4, 8, v3
    v_add_u32 v13, s43, v3
    s_mul_i32 s42, s45, 4
    s_mov_b32 s43, 16384
    v_and_b32 v3, 1, v5
    v_lshl_or_b32 v3, v3, 2, v6
    s_add_u32 s40, s42, 0
    v_xor_b32 v3, s40, v3
    v_lshlrev_b32 v3, 5, v3
    v_lshl_add_u32 v3, v7, 3, v3
    v_lshl_add_u32 v4, v5, 3, v6
    v_lshl_add_u32 v3, v4, 8, v3
    v_add_u32 v14, s43, v3
    v_and_b32 v3, 1, v5
    v_lshl_or_b32 v3, v3, 2, v6
    s_add_u32 s40, s42, 1
    v_xor_b32 v3, s40, v3
    v_lshlrev_b32 v3, 5, v3
    v_lshl_add_u32 v3, v7, 3, v3
    v_lshl_add_u32 v4, v5, 3, v6
    v_lshl_add_u32 v3, v4, 8, v3
    v_add_u32 v15, s43, v3
    v_and_b32 v3, 1, v5
    v_lshl_or_b32 v3, v3, 2, v6
    s_add_u32 s40, s42, 2
    v_xor_b32 v3, s40, v3
    v_lshlrev_b32 v3, 5, v3
    v_lshl_add_u32 v3, v7, 3, v3
    v_lshl_add_u32 v4, v5, 3, v6
    v_lshl_add_u32 v3, v4, 8, v3
    v_add_u32 v16, s43, v3
    v_and_b32 v3, 1, v5
    v_lshl_or_b32 v3, v3, 2, v6
    s_add_u32 s40, s42, 3
    v_xor_b32 v3, s40, v3
    v_lshlrev_b32 v3, 5, v3
    v_lshl_add_u32 v3, v7, 3, v3
    v_lshl_add_u32 v4, v5, 3, v6
    v_lshl_add_u32 v3, v4, 8, v3
    v_add_u32 v17, s43, v3
    s_waitcnt vmcnt(0)
    v_lshlrev_b32 v64, 16, v128
    v_and_b32 v65, 0xffff0000, v128
    v_lshlrev_b32 v66, 16, v129
    v_and_b32 v67, 0xffff0000, v129
    v_lshlrev_b32 v68, 16, v128
    v_and_b32 v69, 0xffff0000, v128
    v_lshlrev_b32 v70, 16, v129
    v_and_b32 v71, 0xffff0000, v129
    v_lshlrev_b32 v72, 16, v128
    v_and_b32 v73, 0xffff0000, v128
    v_lshlrev_b32 v74, 16, v129
    v_and_b32 v75, 0xffff0000, v129
    v_lshlrev_b32 v76, 16, v128
    v_and_b32 v77, 0xffff0000, v128
    v_lshlrev_b32 v78, 16, v129
    v_and_b32 v79, 0xffff0000, v129
    v_lshlrev_b32 v80, 16, v130
    v_and_b32 v81, 0xffff0000, v130
    v_lshlrev_b32 v82, 16, v131
    v_and_b32 v83, 0xffff0000, v131
    v_lshlrev_b32 v84, 16, v130
    v_and_b32 v85, 0xffff0000, v130
    v_lshlrev_b32 v86, 16, v131
    v_and_b32 v87, 0xffff0000, v131
    v_lshlrev_b32 v88, 16, v130
    v_and_b32 v89, 0xffff0000, v130
    v_lshlrev_b32 v90, 16, v131
    v_and_b32 v91, 0xffff0000, v131
    v_lshlrev_b32 v92, 16, v130
    v_and_b32 v93, 0xffff0000, v130
    v_lshlrev_b32 v94, 16, v131
    v_and_b32 v95, 0xffff0000, v131
    v_lshlrev_b32 v96, 16, v132
    v_and_b32 v97, 0xffff0000, v132
    v_lshlrev_b32 v98, 16, v133
    v_and_b32 v99, 0xffff0000, v133
    v_lshlrev_b32 v100, 16, v132
    v_and_b32 v101, 0xffff0000, v132
    v_lshlrev_b32 v102, 16, v133
    v_and_b32 v103, 0xffff0000, v133
    v_lshlrev_b32 v104, 16, v132
    v_and_b32 v105, 0xffff0000, v132
    v_lshlrev_b32 v106, 16, v133
    v_and_b32 v107, 0xffff0000, v133
    v_lshlrev_b32 v108, 16, v132
    v_and_b32 v109, 0xffff0000, v132
    v_lshlrev_b32 v110, 16, v133
    v_and_b32 v111, 0xffff0000, v133
    v_lshlrev_b32 v112, 16, v134
    v_and_b32 v113, 0xffff0000, v134
    v_lshlrev_b32 v114, 16, v135
    v_and_b32 v115, 0xffff0000, v135
    v_lshlrev_b32 v116, 16, v134
    v_and_b32 v117, 0xffff0000, v134
    v_lshlrev_b32 v118, 16, v135
    v_and_b32 v119, 0xffff0000, v135
    v_lshlrev_b32 v120, 16, v134
    v_and_b32 v121, 0xffff0000, v134
    v_lshlrev_b32 v122, 16, v135
    v_and_b32 v123, 0xffff0000, v135
    v_lshlrev_b32 v124, 16, v134
    v_and_b32 v125, 0xffff0000, v134
    v_lshlrev_b32 v126, 16, v135
    v_and_b32 v127, 0xffff0000, v135
    v_mov_b32 v160, 0
    v_mov_b32 v161, 0
    v_mov_b32 v162, 0
    v_mov_b32 v163, 0
    v_mov_b32 v164, 0
    v_mov_b32 v165, 0
    v_mov_b32 v166, 0
    v_mov_b32 v167, 0
    v_mov_b32 v168, 0
    v_mov_b32 v169, 0
    v_mov_b32 v170, 0
    v_mov_b32 v171, 0
    v_mov_b32 v172, 0
    v_mov_b32 v173, 0
    v_mov_b32 v174, 0
    v_mov_b32 v175, 0
    v_mov_b32 v176, 0
    v_mov_b32 v177, 0
    v_mov_b32 v178, 0
    v_mov_b32 v179, 0
    v_mov_b32 v180, 0
    v_mov_b32 v181, 0
    v_mov_b32 v182, 0
    v_mov_b32 v183, 0
    v_mov_b32 v184, 0
    v_mov_b32 v185, 0
    v_mov_b32 v186, 0
    v_mov_b32 v187, 0
    v_mov_b32 v188, 0
    v_mov_b32 v189, 0
    v_mov_b32 v190, 0
    v_mov_b32 v191, 0
    s_mov_b32 s48, 32
    s_mov_b32 s50, 0
    s_mov_b32 s60, 32768
    s_mov_b32 s61, 0xfffe8000
.p2align 3
g3_kernel_cloop:
    s_barrier
    v_mfma_f32_16x16x32_bf16 v[64:67], v[160:163], v[176:179], v[64:67]
    ds_read_b64_tr_b16 v[128:129], v10 offset:0
    ds_read_b64_tr_b16 v[130:131], v10 offset:1024
    v_mfma_f32_16x16x32_bf16 v[68:71], v[160:163], v[180:183], v[68:71]
    ds_read_b64_tr_b16 v[144:145], v14 offset:0
    ds_read_b64_tr_b16 v[146:147], v14 offset:1024
    v_mfma_f32_16x16x32_bf16 v[72:75], v[160:163], v[184:187], v[72:75]
    ds_read_b64_tr_b16 v[148:149], v15 offset:0
    ds_read_b64_tr_b16 v[150:151], v15 offset:1024
    v_mfma_f32_16x16x32_bf16 v[76:79], v[160:163], v[188:191], v[76:79]
    ds_read_b64_tr_b16 v[152:153], v16 offset:0
    ds_read_b64_tr_b16 v[154:155], v16 offset:1024
    v_mfma_f32_16x16x32_bf16 v[80:83], v[164:167], v[176:179], v[80:83]
    ds_read_b64_tr_b16 v[156:157], v17 offset:0
    ds_read_b64_tr_b16 v[158:159], v17 offset:1024
    v_mfma_f32_16x16x32_bf16 v[84:87], v[164:167], v[180:183], v[84:87]
    ds_read_b64_tr_b16 v[132:133], v11 offset:0
    ds_read_b64_tr_b16 v[134:135], v11 offset:1024
    v_mfma_f32_16x16x32_bf16 v[88:91], v[164:167], v[184:187], v[88:91]
    ds_read_b64_tr_b16 v[136:137], v12 offset:0
    ds_read_b64_tr_b16 v[138:139], v12 offset:1024
    v_mfma_f32_16x16x32_bf16 v[92:95], v[164:167], v[188:191], v[92:95]
    ds_read_b64_tr_b16 v[140:141], v13 offset:0
    ds_read_b64_tr_b16 v[142:143], v13 offset:1024
    v_mfma_f32_16x16x32_bf16 v[96:99], v[168:171], v[176:179], v[96:99]
    v_mfma_f32_16x16x32_bf16 v[100:103], v[168:171], v[180:183], v[100:103]
    v_mfma_f32_16x16x32_bf16 v[104:107], v[168:171], v[184:187], v[104:107]
    v_mfma_f32_16x16x32_bf16 v[108:111], v[168:171], v[188:191], v[108:111]
    v_mfma_f32_16x16x32_bf16 v[112:115], v[172:175], v[176:179], v[112:115]
    v_mfma_f32_16x16x32_bf16 v[116:119], v[172:175], v[180:183], v[116:119]
    v_mfma_f32_16x16x32_bf16 v[120:123], v[172:175], v[184:187], v[120:123]
    v_mfma_f32_16x16x32_bf16 v[124:127], v[172:175], v[188:191], v[124:127]
    s_waitcnt lgkmcnt(0)
    v_mfma_f32_16x16x32_bf16 v[64:67], v[128:131], v[144:147], v[64:67]
    ds_read_b64_tr_b16 v[160:161], v10 offset:8192
    ds_read_b64_tr_b16 v[162:163], v10 offset:9216
    v_mfma_f32_16x16x32_bf16 v[68:71], v[128:131], v[148:151], v[68:71]
    ds_read_b64_tr_b16 v[176:177], v14 offset:8192
    ds_read_b64_tr_b16 v[178:179], v14 offset:9216
    v_mfma_f32_16x16x32_bf16 v[72:75], v[128:131], v[152:155], v[72:75]
    ds_read_b64_tr_b16 v[180:181], v15 offset:8192
    ds_read_b64_tr_b16 v[182:183], v15 offset:9216
    v_mfma_f32_16x16x32_bf16 v[76:79], v[128:131], v[156:159], v[76:79]
    ds_read_b64_tr_b16 v[184:185], v16 offset:8192
    ds_read_b64_tr_b16 v[186:187], v16 offset:9216
    v_mfma_f32_16x16x32_bf16 v[80:83], v[132:135], v[144:147], v[80:83]
    ds_read_b64_tr_b16 v[188:189], v17 offset:8192
    ds_read_b64_tr_b16 v[190:191], v17 offset:9216
    v_mfma_f32_16x16x32_bf16 v[84:87], v[132:135], v[148:151], v[84:87]
    ds_read_b64_tr_b16 v[164:165], v11 offset:8192
    ds_read_b64_tr_b16 v[166:167], v11 offset:9216
    v_mfma_f32_16x16x32_bf16 v[88:91], v[132:135], v[152:155], v[88:91]
    ds_read_b64_tr_b16 v[168:169], v12 offset:8192
    ds_read_b64_tr_b16 v[170:171], v12 offset:9216
    v_mfma_f32_16x16x32_bf16 v[92:95], v[132:135], v[156:159], v[92:95]
    ds_read_b64_tr_b16 v[172:173], v13 offset:8192
    ds_read_b64_tr_b16 v[174:175], v13 offset:9216
    v_mfma_f32_16x16x32_bf16 v[96:99], v[136:139], v[144:147], v[96:99]
    s_add_u32 s50, s50, 1
    s_cmp_eq_u32 s50, 4
    v_mfma_f32_16x16x32_bf16 v[100:103], v[136:139], v[148:151], v[100:103]
    s_cselect_b32 s49, s61, s60
    s_cselect_b32 s50, 0, s50
    v_mfma_f32_16x16x32_bf16 v[104:107], v[136:139], v[152:155], v[104:107]
    v_add_u32 v10, s49, v10
    v_add_u32 v11, s49, v11
    v_mfma_f32_16x16x32_bf16 v[108:111], v[136:139], v[156:159], v[108:111]
    v_add_u32 v12, s49, v12
    v_add_u32 v13, s49, v13
    v_mfma_f32_16x16x32_bf16 v[112:115], v[140:143], v[144:147], v[112:115]
    v_add_u32 v14, s49, v14
    v_add_u32 v15, s49, v15
    v_mfma_f32_16x16x32_bf16 v[116:119], v[140:143], v[148:151], v[116:119]
    v_add_u32 v16, s49, v16
    v_add_u32 v17, s49, v17
    v_mfma_f32_16x16x32_bf16 v[120:123], v[140:143], v[152:155], v[120:123]
    s_sub_u32 s48, s48, 1
    s_cmp_lg_u32 s48, 0
    v_mfma_f32_16x16x32_bf16 v[124:127], v[140:143], v[156:159], v[124:127]
    s_waitcnt lgkmcnt(0)
    s_cbranch_scc1 g3_kernel_cloop
    v_mfma_f32_16x16x32_bf16 v[64:67], v[160:163], v[176:179], v[64:67]
    v_mfma_f32_16x16x32_bf16 v[68:71], v[160:163], v[180:183], v[68:71]
    v_mfma_f32_16x16x32_bf16 v[72:75], v[160:163], v[184:187], v[72:75]
    v_mfma_f32_16x16x32_bf16 v[76:79], v[160:163], v[188:191], v[76:79]
    v_mfma_f32_16x16x32_bf16 v[80:83], v[164:167], v[176:179], v[80:83]
    v_mfma_f32_16x16x32_bf16 v[84:87], v[164:167], v[180:183], v[84:87]
    v_mfma_f32_16x16x32_bf16 v[88:91], v[164:167], v[184:187], v[88:91]
    v_mfma_f32_16x16x32_bf16 v[92:95], v[164:167], v[188:191], v[92:95]
    v_mfma_f32_16x16x32_bf16 v[96:99], v[168:171], v[176:179], v[96:99]
    v_mfma_f32_16x16x32_bf16 v[100:103], v[168:171], v[180:183], v[100:103]
    v_mfma_f32_16x16x32_bf16 v[104:107], v[168:171], v[184:187], v[104:107]
    v_mfma_f32_16x16x32_bf16 v[108:111], v[168:171], v[188:191], v[108:111]
    v_mfma_f32_16x16x32_bf16 v[112:115], v[172:175], v[176:179], v[112:115]
    v_mfma_f32_16x16x32_bf16 v[116:119], v[172:175], v[180:183], v[116:119]
    v_mfma_f32_16x16x32_bf16 v[120:123], v[172:175], v[184:187], v[120:123]
    v_mfma_f32_16x16x32_bf16 v[124:127], v[172:175], v[188:191], v[124:127]
    v_mov_b32 v10, 0xbdd2d3e8
    v_mov_b32 v11, 0xbdd2d3e8
    v_mov_b32 v12, 0xc0135761
    v_mov_b32 v13, 0xc0135761
    v_mov_b32 v14, 0x3f800000
    v_mov_b32 v15, 0x3f800000
    s_nop 7
    v_pk_mul_f32 v[144:145], v[64:65], v[64:65]
    v_pk_mul_f32 v[146:147], v[66:67], v[66:67]
    v_pk_mul_f32 v[148:149], v[80:81], v[80:81]
    v_pk_mul_f32 v[150:151], v[82:83], v[82:83]
    v_pk_fma_f32 v[144:145], v[144:145], v[10:11], v[12:13]
    v_pk_fma_f32 v[146:147], v[146:147], v[10:11], v[12:13]
    v_pk_fma_f32 v[148:149], v[148:149], v[10:11], v[12:13]
    v_pk_fma_f32 v[150:151], v[150:151], v[10:11], v[12:13]
    v_pk_mul_f32 v[144:145], v[144:145], v[64:65]
    v_pk_mul_f32 v[146:147], v[146:147], v[66:67]
    v_pk_mul_f32 v[148:149], v[148:149], v[80:81]
    v_pk_mul_f32 v[150:151], v[150:151], v[82:83]
    v_exp_f32 v144, v144
    v_exp_f32 v145, v145
    v_exp_f32 v146, v146
    v_exp_f32 v147, v147
    v_exp_f32 v148, v148
    v_exp_f32 v149, v149
    v_exp_f32 v150, v150
    v_exp_f32 v151, v151
    v_pk_add_f32 v[144:145], v[144:145], v[14:15]
    v_pk_add_f32 v[146:147], v[146:147], v[14:15]
    v_pk_add_f32 v[148:149], v[148:149], v[14:15]
    v_pk_add_f32 v[150:151], v[150:151], v[14:15]
    v_rcp_f32 v144, v144
    v_rcp_f32 v145, v145
    v_rcp_f32 v146, v146
    v_rcp_f32 v147, v147
    v_rcp_f32 v148, v148
    v_rcp_f32 v149, v149
    v_rcp_f32 v150, v150
    v_rcp_f32 v151, v151
    v_pk_mul_f32 v[64:65], v[64:65], v[144:145]
    v_pk_mul_f32 v[66:67], v[66:67], v[146:147]
    v_pk_mul_f32 v[80:81], v[80:81], v[148:149]
    v_pk_mul_f32 v[82:83], v[82:83], v[150:151]
    v_cvt_pk_bf16_f32 v128, v64, v65
    v_cvt_pk_bf16_f32 v129, v66, v67
    v_cvt_pk_bf16_f32 v130, v80, v81
    v_cvt_pk_bf16_f32 v131, v82, v83
    s_nop 1
    v_permlane16_swap_b32 v128, v130
    v_permlane16_swap_b32 v129, v131
    buffer_store_dwordx4 v[128:131], v9, s[16:19], s52 offen offset:0
    v_pk_mul_f32 v[144:145], v[96:97], v[96:97]
    v_pk_mul_f32 v[146:147], v[98:99], v[98:99]
    v_pk_mul_f32 v[148:149], v[112:113], v[112:113]
    v_pk_mul_f32 v[150:151], v[114:115], v[114:115]
    v_pk_fma_f32 v[144:145], v[144:145], v[10:11], v[12:13]
    v_pk_fma_f32 v[146:147], v[146:147], v[10:11], v[12:13]
    v_pk_fma_f32 v[148:149], v[148:149], v[10:11], v[12:13]
    v_pk_fma_f32 v[150:151], v[150:151], v[10:11], v[12:13]
    v_pk_mul_f32 v[144:145], v[144:145], v[96:97]
    v_pk_mul_f32 v[146:147], v[146:147], v[98:99]
    v_pk_mul_f32 v[148:149], v[148:149], v[112:113]
    v_pk_mul_f32 v[150:151], v[150:151], v[114:115]
    v_exp_f32 v144, v144
    v_exp_f32 v145, v145
    v_exp_f32 v146, v146
    v_exp_f32 v147, v147
    v_exp_f32 v148, v148
    v_exp_f32 v149, v149
    v_exp_f32 v150, v150
    v_exp_f32 v151, v151
    v_pk_add_f32 v[144:145], v[144:145], v[14:15]
    v_pk_add_f32 v[146:147], v[146:147], v[14:15]
    v_pk_add_f32 v[148:149], v[148:149], v[14:15]
    v_pk_add_f32 v[150:151], v[150:151], v[14:15]
    v_rcp_f32 v144, v144
    v_rcp_f32 v145, v145
    v_rcp_f32 v146, v146
    v_rcp_f32 v147, v147
    v_rcp_f32 v148, v148
    v_rcp_f32 v149, v149
    v_rcp_f32 v150, v150
    v_rcp_f32 v151, v151
    v_pk_mul_f32 v[96:97], v[96:97], v[144:145]
    v_pk_mul_f32 v[98:99], v[98:99], v[146:147]
    v_pk_mul_f32 v[112:113], v[112:113], v[148:149]
    v_pk_mul_f32 v[114:115], v[114:115], v[150:151]
    v_cvt_pk_bf16_f32 v132, v96, v97
    v_cvt_pk_bf16_f32 v133, v98, v99
    v_cvt_pk_bf16_f32 v134, v112, v113
    v_cvt_pk_bf16_f32 v135, v114, v115
    s_nop 1
    v_permlane16_swap_b32 v132, v134
    v_permlane16_swap_b32 v133, v135
    buffer_store_dwordx4 v[132:135], v9, s[16:19], s52 offen offset:64
    v_pk_mul_f32 v[144:145], v[68:69], v[68:69]
    v_pk_mul_f32 v[146:147], v[70:71], v[70:71]
    v_pk_mul_f32 v[148:149], v[84:85], v[84:85]
    v_pk_mul_f32 v[150:151], v[86:87], v[86:87]
    v_pk_fma_f32 v[144:145], v[144:145], v[10:11], v[12:13]
    v_pk_fma_f32 v[146:147], v[146:147], v[10:11], v[12:13]
    v_pk_fma_f32 v[148:149], v[148:149], v[10:11], v[12:13]
    v_pk_fma_f32 v[150:151], v[150:151], v[10:11], v[12:13]
    v_pk_mul_f32 v[144:145], v[144:145], v[68:69]
    v_pk_mul_f32 v[146:147], v[146:147], v[70:71]
    v_pk_mul_f32 v[148:149], v[148:149], v[84:85]
    v_pk_mul_f32 v[150:151], v[150:151], v[86:87]
    v_exp_f32 v144, v144
    v_exp_f32 v145, v145
    v_exp_f32 v146, v146
    v_exp_f32 v147, v147
    v_exp_f32 v148, v148
    v_exp_f32 v149, v149
    v_exp_f32 v150, v150
    v_exp_f32 v151, v151
    v_pk_add_f32 v[144:145], v[144:145], v[14:15]
    v_pk_add_f32 v[146:147], v[146:147], v[14:15]
    v_pk_add_f32 v[148:149], v[148:149], v[14:15]
    v_pk_add_f32 v[150:151], v[150:151], v[14:15]
    v_rcp_f32 v144, v144
    v_rcp_f32 v145, v145
    v_rcp_f32 v146, v146
    v_rcp_f32 v147, v147
    v_rcp_f32 v148, v148
    v_rcp_f32 v149, v149
    v_rcp_f32 v150, v150
    v_rcp_f32 v151, v151
    v_pk_mul_f32 v[68:69], v[68:69], v[144:145]
    v_pk_mul_f32 v[70:71], v[70:71], v[146:147]
    v_pk_mul_f32 v[84:85], v[84:85], v[148:149]
    v_pk_mul_f32 v[86:87], v[86:87], v[150:151]
    v_cvt_pk_bf16_f32 v136, v68, v69
    v_cvt_pk_bf16_f32 v137, v70, v71
    v_cvt_pk_bf16_f32 v138, v84, v85
    v_cvt_pk_bf16_f32 v139, v86, v87
    s_nop 1
    v_permlane16_swap_b32 v136, v138
    v_permlane16_swap_b32 v137, v139
    buffer_store_dwordx4 v[136:139], v9, s[16:19], s53 offen offset:0
    v_pk_mul_f32 v[144:145], v[100:101], v[100:101]
    v_pk_mul_f32 v[146:147], v[102:103], v[102:103]
    v_pk_mul_f32 v[148:149], v[116:117], v[116:117]
    v_pk_mul_f32 v[150:151], v[118:119], v[118:119]
    v_pk_fma_f32 v[144:145], v[144:145], v[10:11], v[12:13]
    v_pk_fma_f32 v[146:147], v[146:147], v[10:11], v[12:13]
    v_pk_fma_f32 v[148:149], v[148:149], v[10:11], v[12:13]
    v_pk_fma_f32 v[150:151], v[150:151], v[10:11], v[12:13]
    v_pk_mul_f32 v[144:145], v[144:145], v[100:101]
    v_pk_mul_f32 v[146:147], v[146:147], v[102:103]
    v_pk_mul_f32 v[148:149], v[148:149], v[116:117]
    v_pk_mul_f32 v[150:151], v[150:151], v[118:119]
    v_exp_f32 v144, v144
    v_exp_f32 v145, v145
    v_exp_f32 v146, v146
    v_exp_f32 v147, v147
    v_exp_f32 v148, v148
    v_exp_f32 v149, v149
    v_exp_f32 v150, v150
    v_exp_f32 v151, v151
    v_pk_add_f32 v[144:145], v[144:145], v[14:15]
    v_pk_add_f32 v[146:147], v[146:147], v[14:15]
    v_pk_add_f32 v[148:149], v[148:149], v[14:15]
    v_pk_add_f32 v[150:151], v[150:151], v[14:15]
    v_rcp_f32 v144, v144
    v_rcp_f32 v145, v145
    v_rcp_f32 v146, v146
    v_rcp_f32 v147, v147
    v_rcp_f32 v148, v148
    v_rcp_f32 v149, v149
    v_rcp_f32 v150, v150
    v_rcp_f32 v151, v151
    v_pk_mul_f32 v[100:101], v[100:101], v[144:145]
    v_pk_mul_f32 v[102:103], v[102:103], v[146:147]
    v_pk_mul_f32 v[116:117], v[116:117], v[148:149]
    v_pk_mul_f32 v[118:119], v[118:119], v[150:151]
    v_cvt_pk_bf16_f32 v140, v100, v101
    v_cvt_pk_bf16_f32 v141, v102, v103
    v_cvt_pk_bf16_f32 v142, v116, v117
    v_cvt_pk_bf16_f32 v143, v118, v119
    s_nop 1
    v_permlane16_swap_b32 v140, v142
    v_permlane16_swap_b32 v141, v143
    buffer_store_dwordx4 v[140:143], v9, s[16:19], s53 offen offset:64
    v_pk_mul_f32 v[144:145], v[72:73], v[72:73]
    v_pk_mul_f32 v[146:147], v[74:75], v[74:75]
    v_pk_mul_f32 v[148:149], v[88:89], v[88:89]
    v_pk_mul_f32 v[150:151], v[90:91], v[90:91]
    v_pk_fma_f32 v[144:145], v[144:145], v[10:11], v[12:13]
    v_pk_fma_f32 v[146:147], v[146:147], v[10:11], v[12:13]
    v_pk_fma_f32 v[148:149], v[148:149], v[10:11], v[12:13]
    v_pk_fma_f32 v[150:151], v[150:151], v[10:11], v[12:13]
    v_pk_mul_f32 v[144:145], v[144:145], v[72:73]
    v_pk_mul_f32 v[146:147], v[146:147], v[74:75]
    v_pk_mul_f32 v[148:149], v[148:149], v[88:89]
    v_pk_mul_f32 v[150:151], v[150:151], v[90:91]
    v_exp_f32 v144, v144
    v_exp_f32 v145, v145
    v_exp_f32 v146, v146
    v_exp_f32 v147, v147
    v_exp_f32 v148, v148
    v_exp_f32 v149, v149
    v_exp_f32 v150, v150
    v_exp_f32 v151, v151
    v_pk_add_f32 v[144:145], v[144:145], v[14:15]
    v_pk_add_f32 v[146:147], v[146:147], v[14:15]
    v_pk_add_f32 v[148:149], v[148:149], v[14:15]
    v_pk_add_f32 v[150:151], v[150:151], v[14:15]
    v_rcp_f32 v144, v144
    v_rcp_f32 v145, v145
    v_rcp_f32 v146, v146
    v_rcp_f32 v147, v147
    v_rcp_f32 v148, v148
    v_rcp_f32 v149, v149
    v_rcp_f32 v150, v150
    v_rcp_f32 v151, v151
    v_pk_mul_f32 v[72:73], v[72:73], v[144:145]
    v_pk_mul_f32 v[74:75], v[74:75], v[146:147]
    v_pk_mul_f32 v[88:89], v[88:89], v[148:149]
    v_pk_mul_f32 v[90:91], v[90:91], v[150:151]
    v_cvt_pk_bf16_f32 v128, v72, v73
    v_cvt_pk_bf16_f32 v129, v74, v75
    v_cvt_pk_bf16_f32 v130, v88, v89
    v_cvt_pk_bf16_f32 v131, v90, v91
    s_nop 1
    v_permlane16_swap_b32 v128, v130
    v_permlane16_swap_b32 v129, v131
    buffer_store_dwordx4 v[128:131], v9, s[16:19], s54 offen offset:0
    v_pk_mul_f32 v[144:145], v[104:105], v[104:105]
    v_pk_mul_f32 v[146:147], v[106:107], v[106:107]
    v_pk_mul_f32 v[148:149], v[120:121], v[120:121]
    v_pk_mul_f32 v[150:151], v[122:123], v[122:123]
    v_pk_fma_f32 v[144:145], v[144:145], v[10:11], v[12:13]
    v_pk_fma_f32 v[146:147], v[146:147], v[10:11], v[12:13]
    v_pk_fma_f32 v[148:149], v[148:149], v[10:11], v[12:13]
    v_pk_fma_f32 v[150:151], v[150:151], v[10:11], v[12:13]
    v_pk_mul_f32 v[144:145], v[144:145], v[104:105]
    v_pk_mul_f32 v[146:147], v[146:147], v[106:107]
    v_pk_mul_f32 v[148:149], v[148:149], v[120:121]
    v_pk_mul_f32 v[150:151], v[150:151], v[122:123]
    v_exp_f32 v144, v144
    v_exp_f32 v145, v145
    v_exp_f32 v146, v146
    v_exp_f32 v147, v147
    v_exp_f32 v148, v148
    v_exp_f32 v149, v149
    v_exp_f32 v150, v150
    v_exp_f32 v151, v151
    v_pk_add_f32 v[144:145], v[144:145], v[14:15]
    v_pk_add_f32 v[146:147], v[146:147], v[14:15]
    v_pk_add_f32 v[148:149], v[148:149], v[14:15]
    v_pk_add_f32 v[150:151], v[150:151], v[14:15]
    v_rcp_f32 v144, v144
    v_rcp_f32 v145, v145
    v_rcp_f32 v146, v146
    v_rcp_f32 v147, v147
    v_rcp_f32 v148, v148
    v_rcp_f32 v149, v149
    v_rcp_f32 v150, v150
    v_rcp_f32 v151, v151
    v_pk_mul_f32 v[104:105], v[104:105], v[144:145]
    v_pk_mul_f32 v[106:107], v[106:107], v[146:147]
    v_pk_mul_f32 v[120:121], v[120:121], v[148:149]
    v_pk_mul_f32 v[122:123], v[122:123], v[150:151]
    v_cvt_pk_bf16_f32 v132, v104, v105
    v_cvt_pk_bf16_f32 v133, v106, v107
    v_cvt_pk_bf16_f32 v134, v120, v121
    v_cvt_pk_bf16_f32 v135, v122, v123
    s_nop 1
    v_permlane16_swap_b32 v132, v134
    v_permlane16_swap_b32 v133, v135
    buffer_store_dwordx4 v[132:135], v9, s[16:19], s54 offen offset:64
    v_pk_mul_f32 v[144:145], v[76:77], v[76:77]
    v_pk_mul_f32 v[146:147], v[78:79], v[78:79]
    v_pk_mul_f32 v[148:149], v[92:93], v[92:93]
    v_pk_mul_f32 v[150:151], v[94:95], v[94:95]
    v_pk_fma_f32 v[144:145], v[144:145], v[10:11], v[12:13]
    v_pk_fma_f32 v[146:147], v[146:147], v[10:11], v[12:13]
    v_pk_fma_f32 v[148:149], v[148:149], v[10:11], v[12:13]
    v_pk_fma_f32 v[150:151], v[150:151], v[10:11], v[12:13]
    v_pk_mul_f32 v[144:145], v[144:145], v[76:77]
    v_pk_mul_f32 v[146:147], v[146:147], v[78:79]
    v_pk_mul_f32 v[148:149], v[148:149], v[92:93]
    v_pk_mul_f32 v[150:151], v[150:151], v[94:95]
    v_exp_f32 v144, v144
    v_exp_f32 v145, v145
    v_exp_f32 v146, v146
    v_exp_f32 v147, v147
    v_exp_f32 v148, v148
    v_exp_f32 v149, v149
    v_exp_f32 v150, v150
    v_exp_f32 v151, v151
    v_pk_add_f32 v[144:145], v[144:145], v[14:15]
    v_pk_add_f32 v[146:147], v[146:147], v[14:15]
    v_pk_add_f32 v[148:149], v[148:149], v[14:15]
    v_pk_add_f32 v[150:151], v[150:151], v[14:15]
    v_rcp_f32 v144, v144
    v_rcp_f32 v145, v145
    v_rcp_f32 v146, v146
    v_rcp_f32 v147, v147
    v_rcp_f32 v148, v148
    v_rcp_f32 v149, v149
    v_rcp_f32 v150, v150
    v_rcp_f32 v151, v151
    v_pk_mul_f32 v[76:77], v[76:77], v[144:145]
    v_pk_mul_f32 v[78:79], v[78:79], v[146:147]
    v_pk_mul_f32 v[92:93], v[92:93], v[148:149]
    v_pk_mul_f32 v[94:95], v[94:95], v[150:151]
    v_cvt_pk_bf16_f32 v136, v76, v77
    v_cvt_pk_bf16_f32 v137, v78, v79
    v_cvt_pk_bf16_f32 v138, v92, v93
    v_cvt_pk_bf16_f32 v139, v94, v95
    s_nop 1
    v_permlane16_swap_b32 v136, v138
    v_permlane16_swap_b32 v137, v139
    buffer_store_dwordx4 v[136:139], v9, s[16:19], s55 offen offset:0
    v_pk_mul_f32 v[144:145], v[108:109], v[108:109]
    v_pk_mul_f32 v[146:147], v[110:111], v[110:111]
    v_pk_mul_f32 v[148:149], v[124:125], v[124:125]
    v_pk_mul_f32 v[150:151], v[126:127], v[126:127]
    v_pk_fma_f32 v[144:145], v[144:145], v[10:11], v[12:13]
    v_pk_fma_f32 v[146:147], v[146:147], v[10:11], v[12:13]
    v_pk_fma_f32 v[148:149], v[148:149], v[10:11], v[12:13]
    v_pk_fma_f32 v[150:151], v[150:151], v[10:11], v[12:13]
    v_pk_mul_f32 v[144:145], v[144:145], v[108:109]
    v_pk_mul_f32 v[146:147], v[146:147], v[110:111]
    v_pk_mul_f32 v[148:149], v[148:149], v[124:125]
    v_pk_mul_f32 v[150:151], v[150:151], v[126:127]
    v_exp_f32 v144, v144
    v_exp_f32 v145, v145
    v_exp_f32 v146, v146
    v_exp_f32 v147, v147
    v_exp_f32 v148, v148
    v_exp_f32 v149, v149
    v_exp_f32 v150, v150
    v_exp_f32 v151, v151
    v_pk_add_f32 v[144:145], v[144:145], v[14:15]
    v_pk_add_f32 v[146:147], v[146:147], v[14:15]
    v_pk_add_f32 v[148:149], v[148:149], v[14:15]
    v_pk_add_f32 v[150:151], v[150:151], v[14:15]
    v_rcp_f32 v144, v144
    v_rcp_f32 v145, v145
    v_rcp_f32 v146, v146
    v_rcp_f32 v147, v147
    v_rcp_f32 v148, v148
    v_rcp_f32 v149, v149
    v_rcp_f32 v150, v150
    v_rcp_f32 v151, v151
    v_pk_mul_f32 v[108:109], v[108:109], v[144:145]
    v_pk_mul_f32 v[110:111], v[110:111], v[146:147]
    v_pk_mul_f32 v[124:125], v[124:125], v[148:149]
    v_pk_mul_f32 v[126:127], v[126:127], v[150:151]
    v_cvt_pk_bf16_f32 v140, v108, v109
    v_cvt_pk_bf16_f32 v141, v110, v111
    v_cvt_pk_bf16_f32 v142, v124, v125
    v_cvt_pk_bf16_f32 v143, v126, v127
    s_nop 1
    v_permlane16_swap_b32 v140, v142
    v_permlane16_swap_b32 v141, v143
    buffer_store_dwordx4 v[140:143], v9, s[16:19], s55 offen offset:64
    s_endpgm
g3_kernel_loader:
    s_sub_u32 s28, s28, 4
    s_mov_b32 s40, 7168
    v_lshrrev_b32 v4, 4, v2
    v_mul_lo_u32 v3, v4, s40
    v_lshlrev_b32 v4, 1, v4
    v_xor_b32 v4, v4, v2
    v_and_b32 v4, 15, v4
    v_lshl_add_u32 v3, v4, 4, v3
    s_mul_i32 s41, s24, 256
    s_mul_i32 s42, s28, 114688
    s_add_u32 s41, s41, s42
    v_xor_b32 v4, 128, v3
    s_add_u32 s42, s41, 0
    v_add_u32 v10, s42, v3
    s_add_u32 s42, s41, 28672
    v_add_u32 v11, s42, v3
    s_add_u32 s42, s41, 57344
    v_add_u32 v12, s42, v4
    s_add_u32 s42, s41, 86016
    v_add_u32 v13, s42, v4
    s_mov_b32 s40, 2048
    v_lshrrev_b32 v4, 4, v2
    v_mul_lo_u32 v3, v4, s40
    v_lshlrev_b32 v4, 1, v4
    v_xor_b32 v4, v4, v2
    v_and_b32 v4, 15, v4
    v_lshl_add_u32 v3, v4, 4, v3
    s_mul_i32 s41, s25, 256
    s_mul_i32 s42, s28, 32768
    s_add_u32 s41, s41, s42
    v_xor_b32 v4, 128, v3
    s_add_u32 s42, s41, 0
    v_add_u32 v14, s42, v3
    s_add_u32 s42, s41, 8192
    v_add_u32 v15, s42, v3
    s_add_u32 s42, s41, 16384
    v_add_u32 v16, s42, v4
    s_add_u32 s42, s41, 24576
    v_add_u32 v17, s42, v4
    s_mul_i32 s36, s28, 4096
    s_mul_i32 s37, s28, 4096
    s_add_u32 s37, s37, 16384
    s_mov_b32 s32, 0
    s_mov_b32 s33, 0
g3_kernel_ld_loop:
    s_cmp_lt_u32 s32, 3
    s_cbranch_scc1 g3_kernel_ld_issue
    s_waitcnt vmcnt(16)
    s_barrier
g3_kernel_ld_issue:
    s_add_u32 s40, s32, s27
    s_and_b32 s40, s40, 3
    s_andn2_b32 s41, s32, 3
    s_or_b32 s40, s40, s41
    s_add_u32 s40, s40, s26
    s_mul_i32 s34, s40, 458752
    s_mul_i32 s35, s40, 131072
    s_add_u32 s38, s33, s36
    s_add_u32 s39, s33, s37
    s_add_u32 m0, s38, 0
    s_nop 0
    buffer_load_dwordx4 v10, s[8:11], s34 offen lds
    s_add_u32 m0, s38, 1024
    s_nop 0
    buffer_load_dwordx4 v11, s[8:11], s34 offen lds
    s_add_u32 m0, s38, 2048
    s_nop 0
    buffer_load_dwordx4 v12, s[8:11], s34 offen lds
    s_add_u32 m0, s38, 3072
    s_nop 0
    buffer_load_dwordx4 v13, s[8:11], s34 offen lds
    s_add_u32 m0, s39, 0
    s_nop 0
    buffer_load_dwordx4 v14, s[12:15], s35 offen lds
    s_add_u32 m0, s39, 1024
    s_nop 0
    buffer_load_dwordx4 v15, s[12:15], s35 offen lds
    s_add_u32 m0, s39, 2048
    s_nop 0
    buffer_load_dwordx4 v16, s[12:15], s35 offen lds
    s_add_u32 m0, s39, 3072
    s_nop 0
    buffer_load_dwordx4 v17, s[12:15], s35 offen lds
    s_add_u32 s33, s33, 32768
    s_cmp_eq_u32 s33, 131072
    s_cselect_b32 s33, 0, s33
    s_add_u32 s32, s32, 1
    s_cmp_lt_u32 s32, 32
    s_cbranch_scc1 g3_kernel_ld_loop
    s_waitcnt vmcnt(16)
    s_barrier
    s_waitcnt vmcnt(8)
    s_barrier
    s_waitcnt vmcnt(0)
    s_barrier
g3_kernel_done:
    s_endpgm
.section .rodata,"a"
.p2align 6
.amdhsa_kernel g3_kernel
  .amdhsa_next_free_vgpr 192
  .amdhsa_next_free_sgpr 64
  .amdhsa_accum_offset 192
  .amdhsa_group_segment_fixed_size 0
  .amdhsa_kernarg_size 88
  .amdhsa_user_sgpr_count 2
  .amdhsa_user_sgpr_kernarg_segment_ptr 1
  .amdhsa_system_sgpr_workgroup_id_x 1
.end_amdhsa_kernel
.text
.globl g4_kernel
.p2align 8
.type g4_kernel,@function
g4_kernel:
    s_cmp_ge_u32 s2, 256
    s_cbranch_scc1 g4_kernel_done
    s_load_dwordx2 s[4:5], s[0:1], 80
    s_load_dwordx2 s[30:31], s[0:1], 48
    v_lshrrev_b32 v1, 6, v0
    v_and_b32 v2, 63, v0
    s_bfe_u32 s40, s2, 0x10001
    s_lshl_b32 s40, s40, 2
    s_bfe_u32 s41, s2, 0x20003
    s_add_u32 s24, s40, s41
    s_bfe_u32 s40, s2, 0x10002
    s_lshl_b32 s40, s40, 3
    s_lshr_b32 s42, s2, 5
    s_add_u32 s25, s40, s42
    s_add_u32 s27, s41, s42
    s_and_b32 s26, s2, 1
    s_mul_i32 s26, s26, 28
    v_readfirstlane_b32 s28, v1
    s_waitcnt lgkmcnt(0)
    s_add_u32 s8, s4, 0x1000000
    s_addc_u32 s9, s5, 0
    s_mov_b32 s10, 0x700000
    s_mov_b32 s11, 0x20000
    s_mov_b32 s12, s30
    s_mov_b32 s13, s31
    s_mov_b32 s14, 0xe00000
    s_mov_b32 s15, 0x20000
    s_and_b32 s40, s2, 1
    s_lshl_b32 s40, s40, 22
    s_add_u32 s40, s40, 0x1800000
    s_add_u32 s16, s4, s40
    s_addc_u32 s17, s5, 0
    s_mov_b32 s18, 0x400000
    s_mov_b32 s19, 0x20000
    s_cmp_ge_u32 s28, 4
    s_cbranch_scc1 g4_kernel_loader
    v_lshrrev_b32 v5, 4, v2
    v_bfe_u32 v6, v2, 2, 2
    v_and_b32 v7, 3, v2
    v_and_b32 v8, 15, v2
    s_and_b32 s44, s28, 1
    s_lshr_b32 s45, s28, 1
    s_mul_i32 s40, s25, 128
    s_mul_i32 s41, s45, 64
    s_add_u32 s40, s40, s41
    v_add_u32 v3, s40, v8
    s_mov_b32 s41, 2048
    v_mul_lo_u32 v9, v3, s41
    s_mul_i32 s40, s24, 256
    s_mul_i32 s41, s44, 128
    s_add_u32 s40, s40, s41
    v_and_b32 v3, 1, v5
    v_lshlrev_b32 v3, 5, v3
    v_lshrrev_b32 v4, 1, v5
    v_lshl_add_u32 v3, v4, 4, v3
    v_add3_u32 v9, v9, v3, s40
    s_mov_b32 s52, 0
    s_mov_b32 s53, 32768
    s_mov_b32 s54, 65536
    s_mov_b32 s55, 98304
    s_mul_i32 s42, s44, 64
    v_lshrrev_b32 v3, 1, v8
    v_xor_b32 v3, v3, v5
    v_lshlrev_b32 v3, 4, v3
    v_lshl_add_u32 v3, v8, 7, v3
    s_lshl_b32 s40, s42, 7
    s_add_u32 s40, s40, 0
    v_add_u32 v10, s40, v3
    v_xor_b32 v11, 64, v10
    s_mul_i32 s42, s45, 4
    s_mov_b32 s43, 16384
    v_and_b32 v3, 1, v5
    v_lshl_or_b32 v3, v3, 2, v6
    s_add_u32 s40, s42, 0
    v_xor_b32 v3, s40, v3
    v_lshlrev_b32 v3, 5, v3
    v_lshl_add_u32 v3, v7, 3, v3
    v_lshl_add_u32 v4, v5, 3, v6
    v_lshl_add_u32 v3, v4, 8, v3
    v_add_u32 v12, s43, v3
    v_and_b32 v3, 1, v5
    v_lshl_or_b32 v3, v3, 2, v6
    s_add_u32 s40, s42, 1
    v_xor_b32 v3, s40, v3
    v_lshlrev_b32 v3, 5, v3
    v_lshl_add_u32 v3, v7, 3, v3
    v_lshl_add_u32 v4, v5, 3, v6
    v_lshl_add_u32 v3, v4, 8, v3
    v_add_u32 v13, s43, v3
    v_and_b32 v3, 1, v5
    v_lshl_or_b32 v3, v3, 2, v6
    s_add_u32 s40, s42, 2
    v_xor_b32 v3, s40, v3
    v_lshlrev_b32 v3, 5, v3
    v_lshl_add_u32 v3, v7, 3, v3
    v_lshl_add_u32 v4, v5, 3, v6
    v_lshl_add_u32 v3, v4, 8, v3
    v_add_u32 v14, s43, v3
    v_and_b32 v3, 1, v5
    v_lshl_or_b32 v3, v3, 2, v6
    s_add_u32 s40, s42, 3
    v_xor_b32 v3, s40, v3
    v_lshlrev_b32 v3, 5, v3
    v_lshl_add_u32 v3, v7, 3, v3
    v_lshl_add_u32 v4, v5, 3, v6
    v_lshl_add_u32 v3, v4, 8, v3
    v_add_u32 v15, s43, v3
    v_mov_b32 v64, 0
    v_mov_b32 v65, 0
    v_mov_b32 v66, 0
    v_mov_b32 v67, 0
    v_mov_b32 v68, 0
    v_mov_b32 v69, 0
    v_mov_b32 v70, 0
    v_mov_b32 v71, 0
    v_mov_b32 v72, 0
    v_mov_b32 v73, 0
    v_mov_b32 v74, 0
    v_mov_b32 v75, 0
    v_mov_b32 v76, 0
    v_mov_b32 v77, 0
    v_mov_b32 v78, 0
    v_mov_b32 v79, 0
    v_mov_b32 v80, 0
    v_mov_b32 v81, 0
    v_mov_b32 v82, 0
    v_mov_b32 v83, 0
    v_mov_b32 v84, 0
    v_mov_b32 v85, 0
    v_mov_b32 v86, 0
    v_mov_b32 v87, 0
    v_mov_b32 v88, 0
    v_mov_b32 v89, 0
    v_mov_b32 v90, 0
    v_mov_b32 v91, 0
    v_mov_b32 v92, 0
    v_mov_b32 v93, 0
    v_mov_b32 v94, 0
    v_mov_b32 v95, 0
    v_mov_b32 v96, 0
    v_mov_b32 v97, 0
    v_mov_b32 v98, 0
    v_mov_b32 v99, 0
    v_mov_b32 v100, 0
    v_mov_b32 v101, 0
    v_mov_b32 v102, 0
    v_mov_b32 v103, 0
    v_mov_b32 v104, 0
    v_mov_b32 v105, 0
    v_mov_b32 v106, 0
    v_mov_b32 v107, 0
    v_mov_b32 v108, 0
    v_mov_b32 v109, 0
    v_mov_b32 v110, 0
    v_mov_b32 v111, 0
    v_mov_b32 v112, 0
    v_mov_b32 v113, 0
    v_mov_b32 v114, 0
    v_mov_b32 v115, 0
    v_mov_b32 v116, 0
    v_mov_b32 v117, 0
    v_mov_b32 v118, 0
    v_mov_b32 v119, 0
    v_mov_b32 v120, 0
    v_mov_b32 v121, 0
    v_mov_b32 v122, 0
    v_mov_b32 v123, 0
    v_mov_b32 v124, 0
    v_mov_b32 v125, 0
    v_mov_b32 v126, 0
    v_mov_b32 v127, 0
    v_mov_b32 v160, 0
    v_mov_b32 v161, 0
    v_mov_b32 v162, 0
    v_mov_b32 v163, 0
    v_mov_b32 v164, 0
    v_mov_b32 v165, 0
    v_mov_b32 v166, 0
    v_mov_b32 v167, 0
    v_mov_b32 v168, 0
    v_mov_b32 v169, 0
    v_mov_b32 v170, 0
    v_mov_b32 v171, 0
    v_mov_b32 v172, 0
    v_mov_b32 v173, 0
    v_mov_b32 v174, 0
    v_mov_b32 v175, 0
    v_mov_b32 v176, 0
    v_mov_b32 v177, 0
    v_mov_b32 v178, 0
    v_mov_b32 v179, 0
    v_mov_b32 v180, 0
    v_mov_b32 v181, 0
    v_mov_b32 v182, 0
    v_mov_b32 v183, 0
    v_mov_b32 v184, 0
    v_mov_b32 v185, 0
    v_mov_b32 v186, 0
    v_mov_b32 v187, 0
    v_mov_b32 v188, 0
    v_mov_b32 v189, 0
    v_mov_b32 v190, 0
    v_mov_b32 v191, 0
    s_mov_b32 s48, 28
    s_mov_b32 s50, 0
    s_mov_b32 s60, 32768
    s_mov_b32 s61, 0xfffe8000
.p2align 3
g4_kernel_cloop:
    s_barrier
    v_mfma_f32_16x16x32_bf16 v[64:67], v[160:163], v[176:179], v[64:67]
    ds_read_b128 v[128:131], v10 offset:0
    v_mfma_f32_16x16x32_bf16 v[68:71], v[160:163], v[180:183], v[68:71]
    ds_read_b64_tr_b16 v[144:145], v12 offset:0
    ds_read_b64_tr_b16 v[146:147], v12 offset:1024
    v_mfma_f32_16x16x32_bf16 v[72:75], v[160:163], v[184:187], v[72:75]
    ds_read_b64_tr_b16 v[148:149], v13 offset:0
    ds_read_b64_tr_b16 v[150:151], v13 offset:1024
    v_mfma_f32_16x16x32_bf16 v[76:79], v[160:163], v[188:191], v[76:79]
    ds_read_b64_tr_b16 v[152:153], v14 offset:0
    ds_read_b64_tr_b16 v[154:155], v14 offset:1024
    v_mfma_f32_16x16x32_bf16 v[80:83], v[164:167], v[176:179], v[80:83]
    ds_read_b64_tr_b16 v[156:157], v15 offset:0
    ds_read_b64_tr_b16 v[158:159], v15 offset:1024
    v_mfma_f32_16x16x32_bf16 v[84:87], v[164:167], v[180:183], v[84:87]
    ds_read_b128 v[132:135], v10 offset:2048
    v_mfma_f32_16x16x32_bf16 v[88:91], v[164:167], v[184:187], v[88:91]
    ds_read_b128 v[136:139], v10 offset:4096
    v_mfma_f32_16x16x32_bf16 v[92:95], v[164:167], v[188:191], v[92:95]
    ds_read_b128 v[140:143], v10 offset:6144
    v_mfma_f32_16x16x32_bf16 v[96:99], v[168:171], v[176:179], v[96:99]
    v_mfma_f32_16x16x32_bf16 v[100:103], v[168:171], v[180:183], v[100:103]
    v_mfma_f32_16x16x32_bf16 v[104:107], v[168:171], v[184:187], v[104:107]
    v_mfma_f32_16x16x32_bf16 v[108:111], v[168:171], v[188:191], v[108:111]
    v_mfma_f32_16x16x32_bf16 v[112:115], v[172:175], v[176:179], v[112:115]
    v_mfma_f32_16x16x32_bf16 v[116:119], v[172:175], v[180:183], v[116:119]
    v_mfma_f32_16x16x32_bf16 v[120:123], v[172:175], v[184:187], v[120:123]
    v_mfma_f32_16x16x32_bf16 v[124:127], v[172:175], v[188:191], v[124:127]
    s_waitcnt lgkmcnt(0)
    v_mfma_f32_16x16x32_bf16 v[64:67], v[128:131], v[144:147], v[64:67]
    ds_read_b128 v[160:163], v11 offset:0
    v_mfma_f32_16x16x32_bf16 v[68:71], v[128:131], v[148:151], v[68:71]
    ds_read_b64_tr_b16 v[176:177], v12 offset:8192
    ds_read_b64_tr_b16 v[178:179], v12 offset:9216
    v_mfma_f32_16x16x32_bf16 v[72:75], v[128:131], v[152:155], v[72:75]
    ds_read_b64_tr_b16 v[180:181], v13 offset:8192
    ds_read_b64_tr_b16 v[182:183], v13 offset:9216
    v_mfma_f32_16x16x32_bf16 v[76:79], v[128:131], v[156:159], v[76:79]
    ds_read_b64_tr_b16 v[184:185], v14 offset:8192
    ds_read_b64_tr_b16 v[186:187], v14 offset:9216
    v_mfma_f32_16x16x32_bf16 v[80:83], v[132:135], v[144:147], v[80:83]
    ds_read_b64_tr_b16 v[188:189], v15 offset:8192
    ds_read_b64_tr_b16 v[190:191], v15 offset:9216
    v_mfma_f32_16x16x32_bf16 v[84:87], v[132:135], v[148:151], v[84:87]
    ds_read_b128 v[164:167], v11 offset:2048
    v_mfma_f32_16x16x32_bf16 v[88:91], v[132:135], v[152:155], v[88:91]
    ds_read_b128 v[168:171], v11 offset:4096
    v_mfma_f32_16x16x32_bf16 v[92:95], v[132:135], v[156:159], v[92:95]
    ds_read_b128 v[172:175], v11 offset:6144
    v_mfma_f32_16x16x32_bf16 v[96:99], v[136:139], v[144:147], v[96:99]
    s_add_u32 s50, s50, 1
    s_cmp_eq_u32 s50, 4
    v_mfma_f32_16x16x32_bf16 v[100:103], v[136:139], v[148:151], v[100:103]
    s_cselect_b32 s49, s61, s60
    s_cselect_b32 s50, 0, s50
    v_mfma_f32_16x16x32_bf16 v[104:107], v[136:139], v[152:155], v[104:107]
    v_add_u32 v10, s49, v10
    v_add_u32 v11, s49, v11
    v_mfma_f32_16x16x32_bf16 v[108:111], v[136:139], v[156:159], v[108:111]
    v_add_u32 v12, s49, v12
    v_add_u32 v13, s49, v13
    v_mfma_f32_16x16x32_bf16 v[112:115], v[140:143], v[144:147], v[112:115]
    v_add_u32 v14, s49, v14
    v_add_u32 v15, s49, v15
    v_mfma_f32_16x16x32_bf16 v[116:119], v[140:143], v[148:151], v[116:119]
    s_sub_u32 s48, s48, 1
    s_cmp_lg_u32 s48, 0
    v_mfma_f32_16x16x32_bf16 v[120:123], v[140:143], v[152:155], v[120:123]
    v_mfma_f32_16x16x32_bf16 v[124:127], v[140:143], v[156:159], v[124:127]
    s_waitcnt lgkmcnt(0)
    s_cbranch_scc1 g4_kernel_cloop
    v_mfma_f32_16x16x32_bf16 v[64:67], v[160:163], v[176:179], v[64:67]
    v_mfma_f32_16x16x32_bf16 v[68:71], v[160:163], v[180:183], v[68:71]
    v_mfma_f32_16x16x32_bf16 v[72:75], v[160:163], v[184:187], v[72:75]
    v_mfma_f32_16x16x32_bf16 v[76:79], v[160:163], v[188:191], v[76:79]
    v_mfma_f32_16x16x32_bf16 v[80:83], v[164:167], v[176:179], v[80:83]
    v_mfma_f32_16x16x32_bf16 v[84:87], v[164:167], v[180:183], v[84:87]
    v_mfma_f32_16x16x32_bf16 v[88:91], v[164:167], v[184:187], v[88:91]
    v_mfma_f32_16x16x32_bf16 v[92:95], v[164:167], v[188:191], v[92:95]
    v_mfma_f32_16x16x32_bf16 v[96:99], v[168:171], v[176:179], v[96:99]
    v_mfma_f32_16x16x32_bf16 v[100:103], v[168:171], v[180:183], v[100:103]
    v_mfma_f32_16x16x32_bf16 v[104:107], v[168:171], v[184:187], v[104:107]
    v_mfma_f32_16x16x32_bf16 v[108:111], v[168:171], v[188:191], v[108:111]
    v_mfma_f32_16x16x32_bf16 v[112:115], v[172:175], v[176:179], v[112:115]
    v_mfma_f32_16x16x32_bf16 v[116:119], v[172:175], v[180:183], v[116:119]
    v_mfma_f32_16x16x32_bf16 v[120:123], v[172:175], v[184:187], v[120:123]
    v_mfma_f32_16x16x32_bf16 v[124:127], v[172:175], v[188:191], v[124:127]
    s_nop 7
    v_cvt_pk_bf16_f32 v128, v64, v65
    v_cvt_pk_bf16_f32 v129, v66, v67
    v_cvt_pk_bf16_f32 v130, v80, v81
    v_cvt_pk_bf16_f32 v131, v82, v83
    s_nop 1
    v_permlane16_swap_b32 v128, v130
    v_permlane16_swap_b32 v129, v131
    buffer_store_dwordx4 v[128:131], v9, s[16:19], s52 offen offset:0
    v_cvt_pk_bf16_f32 v132, v96, v97
    v_cvt_pk_bf16_f32 v133, v98, v99
    v_cvt_pk_bf16_f32 v134, v112, v113
    v_cvt_pk_bf16_f32 v135, v114, v115
    s_nop 1
    v_permlane16_swap_b32 v132, v134
    v_permlane16_swap_b32 v133, v135
    buffer_store_dwordx4 v[132:135], v9, s[16:19], s52 offen offset:64
    v_cvt_pk_bf16_f32 v136, v68, v69
    v_cvt_pk_bf16_f32 v137, v70, v71
    v_cvt_pk_bf16_f32 v138, v84, v85
    v_cvt_pk_bf16_f32 v139, v86, v87
    s_nop 1
    v_permlane16_swap_b32 v136, v138
    v_permlane16_swap_b32 v137, v139
    buffer_store_dwordx4 v[136:139], v9, s[16:19], s53 offen offset:0
    v_cvt_pk_bf16_f32 v140, v100, v101
    v_cvt_pk_bf16_f32 v141, v102, v103
    v_cvt_pk_bf16_f32 v142, v116, v117
    v_cvt_pk_bf16_f32 v143, v118, v119
    s_nop 1
    v_permlane16_swap_b32 v140, v142
    v_permlane16_swap_b32 v141, v143
    buffer_store_dwordx4 v[140:143], v9, s[16:19], s53 offen offset:64
    v_cvt_pk_bf16_f32 v128, v72, v73
    v_cvt_pk_bf16_f32 v129, v74, v75
    v_cvt_pk_bf16_f32 v130, v88, v89
    v_cvt_pk_bf16_f32 v131, v90, v91
    s_nop 1
    v_permlane16_swap_b32 v128, v130
    v_permlane16_swap_b32 v129, v131
    buffer_store_dwordx4 v[128:131], v9, s[16:19], s54 offen offset:0
    v_cvt_pk_bf16_f32 v132, v104, v105
    v_cvt_pk_bf16_f32 v133, v106, v107
    v_cvt_pk_bf16_f32 v134, v120, v121
    v_cvt_pk_bf16_f32 v135, v122, v123
    s_nop 1
    v_permlane16_swap_b32 v132, v134
    v_permlane16_swap_b32 v133, v135
    buffer_store_dwordx4 v[132:135], v9, s[16:19], s54 offen offset:64
    v_cvt_pk_bf16_f32 v136, v76, v77
    v_cvt_pk_bf16_f32 v137, v78, v79
    v_cvt_pk_bf16_f32 v138, v92, v93
    v_cvt_pk_bf16_f32 v139, v94, v95
    s_nop 1
    v_permlane16_swap_b32 v136, v138
    v_permlane16_swap_b32 v137, v139
    buffer_store_dwordx4 v[136:139], v9, s[16:19], s55 offen offset:0
    v_cvt_pk_bf16_f32 v140, v108, v109
    v_cvt_pk_bf16_f32 v141, v110, v111
    v_cvt_pk_bf16_f32 v142, v124, v125
    v_cvt_pk_bf16_f32 v143, v126, v127
    s_nop 1
    v_permlane16_swap_b32 v140, v142
    v_permlane16_swap_b32 v141, v143
    buffer_store_dwordx4 v[140:143], v9, s[16:19], s55 offen offset:64
    s_endpgm
g4_kernel_loader:
    s_sub_u32 s28, s28, 4
    s_mov_b32 s40, 7168
    v_lshrrev_b32 v3, 3, v2
    v_mul_lo_u32 v3, v3, s40
    v_lshrrev_b32 v4, 4, v2
    v_xor_b32 v4, v4, v2
    v_and_b32 v4, 7, v4
    v_lshl_add_u32 v3, v4, 4, v3
    s_mul_i32 s41, s24, 917504
    s_mul_i32 s42, s28, 229376
    s_add_u32 s41, s41, s42
    v_xor_b32 v4, 64, v3
    s_add_u32 s42, s41, 0
    v_add_u32 v10, s42, v3
    s_add_u32 s42, s41, 57344
    v_add_u32 v11, s42, v4
    s_add_u32 s42, s41, 114688
    v_add_u32 v12, s42, v3
    s_add_u32 s42, s41, 172032
    v_add_u32 v13, s42, v4
    s_mov_b32 s40, 4096
    v_lshrrev_b32 v4, 4, v2
    v_mul_lo_u32 v3, v4, s40
    v_lshlrev_b32 v4, 1, v4
    v_xor_b32 v4, v4, v2
    v_and_b32 v4, 15, v4
    v_lshl_add_u32 v3, v4, 4, v3
    s_mul_i32 s41, s25, 256
    s_mul_i32 s42, s28, 65536
    s_add_u32 s41, s41, s42
    v_xor_b32 v4, 128, v3
    s_add_u32 s42, s41, 0
    v_add_u32 v14, s42, v3
    s_add_u32 s42, s41, 16384
    v_add_u32 v15, s42, v3
    s_add_u32 s42, s41, 32768
    v_add_u32 v16, s42, v4
    s_add_u32 s42, s41, 49152
    v_add_u32 v17, s42, v4
    s_mul_i32 s36, s28, 4096
    s_mul_i32 s37, s28, 4096
    s_add_u32 s37, s37, 16384
    s_mov_b32 s32, 0
    s_mov_b32 s33, 0
g4_kernel_ld_loop:
    s_cmp_lt_u32 s32, 3
    s_cbranch_scc1 g4_kernel_ld_issue
    s_waitcnt vmcnt(16)
    s_barrier
g4_kernel_ld_issue:
    s_add_u32 s40, s32, s27
    s_and_b32 s40, s40, 3
    s_andn2_b32 s41, s32, 3
    s_or_b32 s40, s40, s41
    s_add_u32 s40, s40, s26
    s_mul_i32 s34, s40, 128
    s_mul_i32 s35, s40, 262144
    s_add_u32 s38, s33, s36
    s_add_u32 s39, s33, s37
    s_add_u32 m0, s38, 0
    s_nop 0
    buffer_load_dwordx4 v10, s[8:11], s34 offen lds
    s_add_u32 m0, s38, 1024
    s_nop 0
    buffer_load_dwordx4 v11, s[8:11], s34 offen lds
    s_add_u32 m0, s38, 2048
    s_nop 0
    buffer_load_dwordx4 v12, s[8:11], s34 offen lds
    s_add_u32 m0, s38, 3072
    s_nop 0
    buffer_load_dwordx4 v13, s[8:11], s34 offen lds
    s_add_u32 m0, s39, 0
    s_nop 0
    buffer_load_dwordx4 v14, s[12:15], s35 offen lds
    s_add_u32 m0, s39, 1024
    s_nop 0
    buffer_load_dwordx4 v15, s[12:15], s35 offen lds
    s_add_u32 m0, s39, 2048
    s_nop 0
    buffer_load_dwordx4 v16, s[12:15], s35 offen lds
    s_add_u32 m0, s39, 3072
    s_nop 0
    buffer_load_dwordx4 v17, s[12:15], s35 offen lds
    s_add_u32 s33, s33, 32768
    s_cmp_eq_u32 s33, 131072
    s_cselect_b32 s33, 0, s33
    s_add_u32 s32, s32, 1
    s_cmp_lt_u32 s32, 28
    s_cbranch_scc1 g4_kernel_ld_loop
    s_waitcnt vmcnt(16)
    s_barrier
    s_waitcnt vmcnt(8)
    s_barrier
    s_waitcnt vmcnt(0)
    s_barrier
g4_kernel_done:
    s_endpgm
.section .rodata,"a"
.p2align 6
.amdhsa_kernel g4_kernel
  .amdhsa_next_free_vgpr 192
  .amdhsa_next_free_sgpr 64
  .amdhsa_accum_offset 192
  .amdhsa_group_segment_fixed_size 0
  .amdhsa_kernarg_size 88
  .amdhsa_user_sgpr_count 2
  .amdhsa_user_sgpr_kernarg_segment_ptr 1
  .amdhsa_system_sgpr_workgroup_id_x 1
.end_amdhsa_kernel
.text
.globl ln6_kernel
.p2align 8
.type ln6_kernel,@function
ln6_kernel:
    s_cmp_ge_u32 s2, 512
    s_cbranch_scc1 ln6_kernel_done
    s_load_dwordx2 s[4:5], s[0:1], 80
    s_load_dwordx2 s[6:7], s[0:1], 56
    v_lshrrev_b32 v1, 6, v0
    v_and_b32 v2, 63, v0
    s_lshl_b32 s3, s2, 2
    v_add_u32 v1, s3, v1
    v_lshlrev_b32 v3, 11, v1
    v_lshl_add_u32 v3, v2, 4, v3
    v_lshlrev_b32 v4, 1, v1
    s_waitcnt lgkmcnt(0)
    s_add_u32 s8, s4, 0x800000
    s_addc_u32 s9, s5, 0
    s_mov_b32 s10, 0x400000
    s_mov_b32 s11, 0x20000
    s_add_u32 s16, s4, 0x1800000
    s_addc_u32 s17, s5, 0
    s_mov_b32 s18, 0x400000
    s_mov_b32 s19, 0x20000
    s_add_u32 s20, s4, 0x1c00000
    s_addc_u32 s21, s5, 0
    s_mov_b32 s22, 0x400000
    s_mov_b32 s23, 0x20000
    s_mov_b32 s24, s6
    s_mov_b32 s25, s7
    s_mov_b32 s26, 0x1000
    s_mov_b32 s27, 0x20000
    buffer_load_dwordx4 v[52:55], v3, s[16:19], 0 offen
    buffer_load_dwordx4 v[56:59], v3, s[16:19], 0 offen offset:1024
    buffer_load_dwordx4 v[60:63], v3, s[20:23], 0 offen
    buffer_load_dwordx4 v[64:67], v3, s[20:23], 0 offen offset:1024
    buffer_load_ushort v5, v4, s[24:27], 0 offen
    buffer_load_dwordx4 v[8:11], v3, s[8:11], 0 offen
    buffer_load_dwordx4 v[12:15], v3, s[8:11], 0 offen offset:1024
    s_mov_b32 s12, s4
    s_mov_b32 s13, s5
    s_mov_b32 s14, 0x400000
    s_mov_b32 s15, 0x20000
    s_add_u32 s28, s4, 0x2000000
    s_addc_u32 s29, s5, 0
    s_mov_b32 s30, 0x400000
    s_mov_b32 s31, 0x20000
    s_waitcnt vmcnt(3)
    v_lshlrev_b32 v16, 16, v52
    v_and_b32 v17, 0xffff0000, v52
    v_lshlrev_b32 v18, 16, v53
    v_and_b32 v19, 0xffff0000, v53
    v_lshlrev_b32 v20, 16, v54
    v_and_b32 v21, 0xffff0000, v54
    v_lshlrev_b32 v22, 16, v55
    v_and_b32 v23, 0xffff0000, v55
    v_lshlrev_b32 v24, 16, v56
    v_and_b32 v25, 0xffff0000, v56
    v_lshlrev_b32 v26, 16, v57
    v_and_b32 v27, 0xffff0000, v57
    v_lshlrev_b32 v28, 16, v58
    v_and_b32 v29, 0xffff0000, v58
    v_lshlrev_b32 v30, 16, v59
    v_and_b32 v31, 0xffff0000, v59
    v_lshlrev_b32 v32, 16, v60
    v_and_b32 v33, 0xffff0000, v60
    v_lshlrev_b32 v34, 16, v61
    v_and_b32 v35, 0xffff0000, v61
    v_lshlrev_b32 v36, 16, v62
    v_and_b32 v37, 0xffff0000, v62
    v_lshlrev_b32 v38, 16, v63
    v_and_b32 v39, 0xffff0000, v63
    v_lshlrev_b32 v40, 16, v64
    v_and_b32 v41, 0xffff0000, v64
    v_lshlrev_b32 v42, 16, v65
    v_and_b32 v43, 0xffff0000, v65
    v_lshlrev_b32 v44, 16, v66
    v_and_b32 v45, 0xffff0000, v66
    v_lshlrev_b32 v46, 16, v67
    v_and_b32 v47, 0xffff0000, v67
    v_pk_add_f32 v[16:17], v[16:17], v[32:33]
    v_pk_add_f32 v[18:19], v[18:19], v[34:35]
    v_pk_add_f32 v[20:21], v[20:21], v[36:37]
    v_pk_add_f32 v[22:23], v[22:23], v[38:39]
    v_pk_add_f32 v[24:25], v[24:25], v[40:41]
    v_pk_add_f32 v[26:27], v[26:27], v[42:43]
    v_pk_add_f32 v[28:29], v[28:29], v[44:45]
    v_pk_add_f32 v[30:31], v[30:31], v[46:47]
    v_cvt_pk_bf16_f32 v52, v16, v17
    v_cvt_pk_bf16_f32 v53, v18, v19
    v_cvt_pk_bf16_f32 v54, v20, v21
    v_cvt_pk_bf16_f32 v55, v22, v23
    v_cvt_pk_bf16_f32 v56, v24, v25
    v_cvt_pk_bf16_f32 v57, v26, v27
    v_cvt_pk_bf16_f32 v58, v28, v29
    v_cvt_pk_bf16_f32 v59, v30, v31
    s_waitcnt vmcnt(2)
    v_lshlrev_b32 v6, 16, v5
    v_lshlrev_b32 v7, 16, v5
    v_lshlrev_b32 v16, 16, v52
    v_and_b32 v17, 0xffff0000, v52
    v_lshlrev_b32 v18, 16, v53
    v_and_b32 v19, 0xffff0000, v53
    v_lshlrev_b32 v20, 16, v54
    v_and_b32 v21, 0xffff0000, v54
    v_lshlrev_b32 v22, 16, v55
    v_and_b32 v23, 0xffff0000, v55
    v_lshlrev_b32 v24, 16, v56
    v_and_b32 v25, 0xffff0000, v56
    v_lshlrev_b32 v26, 16, v57
    v_and_b32 v27, 0xffff0000, v57
    v_lshlrev_b32 v28, 16, v58
    v_and_b32 v29, 0xffff0000, v58
    v_lshlrev_b32 v30, 16, v59
    v_and_b32 v31, 0xffff0000, v59
    v_pk_add_f32 v[16:17], v[16:17], v[6:7]
    v_pk_add_f32 v[18:19], v[18:19], v[6:7]
    v_pk_add_f32 v[20:21], v[20:21], v[6:7]
    v_pk_add_f32 v[22:23], v[22:23], v[6:7]
    v_pk_add_f32 v[24:25], v[24:25], v[6:7]
    v_pk_add_f32 v[26:27], v[26:27], v[6:7]
    v_pk_add_f32 v[28:29], v[28:29], v[6:7]
    v_pk_add_f32 v[30:31], v[30:31], v[6:7]
    v_cvt_pk_bf16_f32 v52, v16, v17
    v_cvt_pk_bf16_f32 v53, v18, v19
    v_cvt_pk_bf16_f32 v54, v20, v21
    v_cvt_pk_bf16_f32 v55, v22, v23
    v_cvt_pk_bf16_f32 v56, v24, v25
    v_cvt_pk_bf16_f32 v57, v26, v27
    v_cvt_pk_bf16_f32 v58, v28, v29
    v_cvt_pk_bf16_f32 v59, v30, v31
    s_waitcnt vmcnt(0)
    v_lshlrev_b32 v16, 16, v52
    v_and_b32 v17, 0xffff0000, v52
    v_lshlrev_b32 v18, 16, v53
    v_and_b32 v19, 0xffff0000, v53
    v_lshlrev_b32 v20, 16, v54
    v_and_b32 v21, 0xffff0000, v54
    v_lshlrev_b32 v22, 16, v55
    v_and_b32 v23, 0xffff0000, v55
    v_lshlrev_b32 v24, 16, v56
    v_and_b32 v25, 0xffff0000, v56
    v_lshlrev_b32 v26, 16, v57
    v_and_b32 v27, 0xffff0000, v57
    v_lshlrev_b32 v28, 16, v58
    v_and_b32 v29, 0xffff0000, v58
    v_lshlrev_b32 v30, 16, v59
    v_and_b32 v31, 0xffff0000, v59
    v_lshlrev_b32 v32, 16, v8
    v_and_b32 v33, 0xffff0000, v8
    v_lshlrev_b32 v34, 16, v9
    v_and_b32 v35, 0xffff0000, v9
    v_lshlrev_b32 v36, 16, v10
    v_and_b32 v37, 0xffff0000, v10
    v_lshlrev_b32 v38, 16, v11
    v_and_b32 v39, 0xffff0000, v11
    v_lshlrev_b32 v40, 16, v12
    v_and_b32 v41, 0xffff0000, v12
    v_lshlrev_b32 v42, 16, v13
    v_and_b32 v43, 0xffff0000, v13
    v_lshlrev_b32 v44, 16, v14
    v_and_b32 v45, 0xffff0000, v14
    v_lshlrev_b32 v46, 16, v15
    v_and_b32 v47, 0xffff0000, v15
    v_pk_add_f32 v[16:17], v[16:17], v[32:33]
    v_pk_add_f32 v[18:19], v[18:19], v[34:35]
    v_pk_add_f32 v[20:21], v[20:21], v[36:37]
    v_pk_add_f32 v[22:23], v[22:23], v[38:39]
    v_pk_add_f32 v[24:25], v[24:25], v[40:41]
    v_pk_add_f32 v[26:27], v[26:27], v[42:43]
    v_pk_add_f32 v[28:29], v[28:29], v[44:45]
    v_pk_add_f32 v[30:31], v[30:31], v[46:47]
    v_cvt_pk_bf16_f32 v52, v16, v17
    v_cvt_pk_bf16_f32 v53, v18, v19
    v_cvt_pk_bf16_f32 v54, v20, v21
    v_cvt_pk_bf16_f32 v55, v22, v23
    v_cvt_pk_bf16_f32 v56, v24, v25
    v_cvt_pk_bf16_f32 v57, v26, v27
    v_cvt_pk_bf16_f32 v58, v28, v29
    v_cvt_pk_bf16_f32 v59, v30, v31
    buffer_store_dwordx4 v[52:55], v3, s[28:31], 0 offen
    buffer_store_dwordx4 v[56:59], v3, s[28:31], 0 offen offset:1024
    v_lshlrev_b32 v16, 16, v52
    v_and_b32 v17, 0xffff0000, v52
    v_lshlrev_b32 v18, 16, v53
    v_and_b32 v19, 0xffff0000, v53
    v_lshlrev_b32 v20, 16, v54
    v_and_b32 v21, 0xffff0000, v54
    v_lshlrev_b32 v22, 16, v55
    v_and_b32 v23, 0xffff0000, v55
    v_lshlrev_b32 v24, 16, v56
    v_and_b32 v25, 0xffff0000, v56
    v_lshlrev_b32 v26, 16, v57
    v_and_b32 v27, 0xffff0000, v57
    v_lshlrev_b32 v28, 16, v58
    v_and_b32 v29, 0xffff0000, v58
    v_lshlrev_b32 v30, 16, v59
    v_and_b32 v31, 0xffff0000, v59
    v_pk_add_f32 v[32:33], v[16:17], v[18:19]
    v_pk_add_f32 v[34:35], v[20:21], v[22:23]
    v_pk_add_f32 v[36:37], v[24:25], v[26:27]
    v_pk_add_f32 v[38:39], v[28:29], v[30:31]
    v_pk_add_f32 v[32:33], v[32:33], v[34:35]
    v_pk_add_f32 v[36:37], v[36:37], v[38:39]
    v_pk_add_f32 v[32:33], v[32:33], v[36:37]
    v_add_f32 v48, v32, v33
    s_nop 1
    v_add_f32_dpp v48, v48, v48 quad_perm:[1,0,3,2] row_mask:0xf bank_mask:0xf
    s_nop 1
    v_add_f32_dpp v48, v48, v48 quad_perm:[2,3,0,1] row_mask:0xf bank_mask:0xf
    s_nop 1
    v_add_f32_dpp v48, v48, v48 row_half_mirror row_mask:0xf bank_mask:0xf
    s_nop 1
    v_add_f32_dpp v48, v48, v48 row_mirror row_mask:0xf bank_mask:0xf
    s_nop 1
    v_add_f32_dpp v48, v48, v48 row_bcast:15 row_mask:0xa bank_mask:0xf
    s_nop 1
    v_add_f32_dpp v48, v48, v48 row_bcast:31 row_mask:0xc bank_mask:0xf
    s_nop 1
    v_readlane_b32 s40, v48, 63
    s_nop 1
    v_mov_b32 v49, 0xba800000
    v_mul_f32 v48, s40, v49
    v_mov_b32 v49, v48
    v_pk_add_f32 v[32:33], v[16:17], v[48:49]
    v_pk_add_f32 v[34:35], v[18:19], v[48:49]
    v_pk_add_f32 v[36:37], v[20:21], v[48:49]
    v_pk_add_f32 v[38:39], v[22:23], v[48:49]
    v_pk_add_f32 v[40:41], v[24:25], v[48:49]
    v_pk_add_f32 v[42:43], v[26:27], v[48:49]
    v_pk_add_f32 v[44:45], v[28:29], v[48:49]
    v_pk_add_f32 v[46:47], v[30:31], v[48:49]
    v_pk_mul_f32 v[50:51], v[32:33], v[32:33]
    v_pk_fma_f32 v[50:51], v[34:35], v[34:35], v[50:51]
    v_pk_fma_f32 v[50:51], v[36:37], v[36:37], v[50:51]
    v_pk_fma_f32 v[50:51], v[38:39], v[38:39], v[50:51]
    v_pk_fma_f32 v[50:51], v[40:41], v[40:41], v[50:51]
    v_pk_fma_f32 v[50:51], v[42:43], v[42:43], v[50:51]
    v_pk_fma_f32 v[50:51], v[44:45], v[44:45], v[50:51]
    v_pk_fma_f32 v[50:51], v[46:47], v[46:47], v[50:51]
    v_add_f32 v50, v50, v51
    v_cvt_pk_bf16_f32 v48, v48, v48
    v_lshlrev_b32 v48, 16, v48
    v_mov_b32 v49, v48
    s_nop 1
    v_add_f32_dpp v50, v50, v50 quad_perm:[1,0,3,2] row_mask:0xf bank_mask:0xf
    s_nop 1
    v_add_f32_dpp v50, v50, v50 quad_perm:[2,3,0,1] row_mask:0xf bank_mask:0xf
    s_nop 1
    v_add_f32_dpp v50, v50, v50 row_half_mirror row_mask:0xf bank_mask:0xf
    s_nop 1
    v_add_f32_dpp v50, v50, v50 row_mirror row_mask:0xf bank_mask:0xf
    s_nop 1
    v_add_f32_dpp v50, v50, v50 row_bcast:15 row_mask:0xa bank_mask:0xf
    s_nop 1
    v_add_f32_dpp v50, v50, v50 row_bcast:31 row_mask:0xc bank_mask:0xf
    s_nop 1
    v_readlane_b32 s41, v50, 63
    s_nop 1
    v_pk_add_f32 v[32:33], v[16:17], v[48:49]
    v_pk_add_f32 v[34:35], v[18:19], v[48:49]
    v_pk_add_f32 v[36:37], v[20:21], v[48:49]
    v_pk_add_f32 v[38:39], v[22:23], v[48:49]
    v_pk_add_f32 v[40:41], v[24:25], v[48:49]
    v_pk_add_f32 v[42:43], v[26:27], v[48:49]
    v_pk_add_f32 v[44:45], v[28:29], v[48:49]
    v_pk_add_f32 v[46:47], v[30:31], v[48:49]
    v_mov_b32 v50, 0x3a800000
    v_mul_f32 v50, s41, v50
    v_cvt_pk_bf16_f32 v50, v50, v50
    v_lshlrev_b32 v50, 16, v50
    v_add_f32 v50, 0x3727c5ac, v50
    v_cvt_pk_bf16_f32 v50, v50, v50
    v_lshlrev_b32 v50, 16, v50
    v_sqrt_f32 v50, v50
    v_cvt_pk_bf16_f32 v8, v32, v33
    v_cvt_pk_bf16_f32 v9, v34, v35
    v_cvt_pk_bf16_f32 v10, v36, v37
    v_cvt_pk_bf16_f32 v11, v38, v39
    v_cvt_pk_bf16_f32 v12, v40, v41
    v_cvt_pk_bf16_f32 v13, v42, v43
    v_cvt_pk_bf16_f32 v14, v44, v45
    v_cvt_pk_bf16_f32 v15, v46, v47
    v_cvt_pk_bf16_f32 v50, v50, v50
    v_lshlrev_b32 v50, 16, v50
    v_rcp_f32 v50, v50
    v_lshlrev_b32 v32, 16, v8
    v_and_b32 v33, 0xffff0000, v8
    v_lshlrev_b32 v34, 16, v9
    v_and_b32 v35, 0xffff0000, v9
    v_lshlrev_b32 v36, 16, v10
    v_and_b32 v37, 0xffff0000, v10
    v_lshlrev_b32 v38, 16, v11
    v_and_b32 v39, 0xffff0000, v11
    v_lshlrev_b32 v40, 16, v12
    v_and_b32 v41, 0xffff0000, v12
    v_lshlrev_b32 v42, 16, v13
    v_and_b32 v43, 0xffff0000, v13
    v_lshlrev_b32 v44, 16, v14
    v_and_b32 v45, 0xffff0000, v14
    v_lshlrev_b32 v46, 16, v15
    v_and_b32 v47, 0xffff0000, v15
    v_mov_b32 v51, v50
    v_pk_mul_f32 v[32:33], v[32:33], v[50:51]
    v_pk_mul_f32 v[34:35], v[34:35], v[50:51]
    v_pk_mul_f32 v[36:37], v[36:37], v[50:51]
    v_pk_mul_f32 v[38:39], v[38:39], v[50:51]
    v_pk_mul_f32 v[40:41], v[40:41], v[50:51]
    v_pk_mul_f32 v[42:43], v[42:43], v[50:51]
    v_pk_mul_f32 v[44:45], v[44:45], v[50:51]
    v_pk_mul_f32 v[46:47], v[46:47], v[50:51]
    v_cvt_pk_bf16_f32 v8, v32, v33
    v_cvt_pk_bf16_f32 v9, v34, v35
    v_cvt_pk_bf16_f32 v10, v36, v37
    v_cvt_pk_bf16_f32 v11, v38, v39
    v_cvt_pk_bf16_f32 v12, v40, v41
    v_cvt_pk_bf16_f32 v13, v42, v43
    v_cvt_pk_bf16_f32 v14, v44, v45
    v_cvt_pk_bf16_f32 v15, v46, v47
    buffer_store_dwordx4 v[8:11], v3, s[12:15], 0 offen
    buffer_store_dwordx4 v[12:15], v3, s[12:15], 0 offen offset:1024
ln6_kernel_done:
    s_endpgm
.section .rodata,"a"
.p2align 6
.amdhsa_kernel ln6_kernel
  .amdhsa_next_free_vgpr 68
  .amdhsa_next_free_sgpr 48
  .amdhsa_accum_offset 68
  .amdhsa_group_segment_fixed_size 0
  .amdhsa_kernarg_size 88
  .amdhsa_user_sgpr_count 2
  .amdhsa_user_sgpr_kernarg_segment_ptr 1
  .amdhsa_system_sgpr_workgroup_id_x 1
.end_amdhsa_kernel
.text
.globl fin_kernel
.p2align 8
.type fin_kernel,@function
fin_kernel:
    s_cmp_ge_u32 s2, 512
    s_cbranch_scc1 fin_kernel_done
    s_load_dwordx2 s[4:5], s[0:1], 80
    s_load_dwordx2 s[6:7], s[0:1], 56
    s_load_dwordx2 s[28:29], s[0:1], 64
    v_lshrrev_b32 v1, 6, v0
    v_and_b32 v2, 63, v0
    s_lshl_b32 s3, s2, 2
    v_add_u32 v1, s3, v1
    v_lshlrev_b32 v3, 11, v1
    v_lshl_add_u32 v3, v2, 4, v3
    v_lshlrev_b32 v4, 1, v1
    s_waitcnt lgkmcnt(0)
    s_add_u32 s8, s4, 0x800000
    s_addc_u32 s9, s5, 0
    s_mov_b32 s10, 0x400000
    s_mov_b32 s11, 0x20000
    s_add_u32 s16, s4, 0x1800000
    s_addc_u32 s17, s5, 0
    s_mov_b32 s18, 0x400000
    s_mov_b32 s19, 0x20000
    s_add_u32 s20, s4, 0x1c00000
    s_addc_u32 s21, s5, 0
    s_mov_b32 s22, 0x400000
    s_mov_b32 s23, 0x20000
    s_mov_b32 s24, s6
    s_mov_b32 s25, s7
    s_mov_b32 s26, 0x1000
    s_mov_b32 s27, 0x20000
    buffer_load_dwordx4 v[52:55], v3, s[16:19], 0 offen
    buffer_load_dwordx4 v[56:59], v3, s[16:19], 0 offen offset:1024
    buffer_load_dwordx4 v[60:63], v3, s[20:23], 0 offen
    buffer_load_dwordx4 v[64:67], v3, s[20:23], 0 offen offset:1024
    buffer_load_ushort v5, v4, s[24:27], 0 offen
    buffer_load_dwordx4 v[8:11], v3, s[8:11], 0 offen
    buffer_load_dwordx4 v[12:15], v3, s[8:11], 0 offen offset:1024
    s_mov_b32 s12, s28
    s_mov_b32 s13, s29
    s_mov_b32 s14, 0x400000
    s_mov_b32 s15, 0x20000
    s_waitcnt vmcnt(3)
    v_lshlrev_b32 v16, 16, v52
    v_and_b32 v17, 0xffff0000, v52
    v_lshlrev_b32 v18, 16, v53
    v_and_b32 v19, 0xffff0000, v53
    v_lshlrev_b32 v20, 16, v54
    v_and_b32 v21, 0xffff0000, v54
    v_lshlrev_b32 v22, 16, v55
    v_and_b32 v23, 0xffff0000, v55
    v_lshlrev_b32 v24, 16, v56
    v_and_b32 v25, 0xffff0000, v56
    v_lshlrev_b32 v26, 16, v57
    v_and_b32 v27, 0xffff0000, v57
    v_lshlrev_b32 v28, 16, v58
    v_and_b32 v29, 0xffff0000, v58
    v_lshlrev_b32 v30, 16, v59
    v_and_b32 v31, 0xffff0000, v59
    v_lshlrev_b32 v32, 16, v60
    v_and_b32 v33, 0xffff0000, v60
    v_lshlrev_b32 v34, 16, v61
    v_and_b32 v35, 0xffff0000, v61
    v_lshlrev_b32 v36, 16, v62
    v_and_b32 v37, 0xffff0000, v62
    v_lshlrev_b32 v38, 16, v63
    v_and_b32 v39, 0xffff0000, v63
    v_lshlrev_b32 v40, 16, v64
    v_and_b32 v41, 0xffff0000, v64
    v_lshlrev_b32 v42, 16, v65
    v_and_b32 v43, 0xffff0000, v65
    v_lshlrev_b32 v44, 16, v66
    v_and_b32 v45, 0xffff0000, v66
    v_lshlrev_b32 v46, 16, v67
    v_and_b32 v47, 0xffff0000, v67
    v_pk_add_f32 v[16:17], v[16:17], v[32:33]
    v_pk_add_f32 v[18:19], v[18:19], v[34:35]
    v_pk_add_f32 v[20:21], v[20:21], v[36:37]
    v_pk_add_f32 v[22:23], v[22:23], v[38:39]
    v_pk_add_f32 v[24:25], v[24:25], v[40:41]
    v_pk_add_f32 v[26:27], v[26:27], v[42:43]
    v_pk_add_f32 v[28:29], v[28:29], v[44:45]
    v_pk_add_f32 v[30:31], v[30:31], v[46:47]
    v_cvt_pk_bf16_f32 v52, v16, v17
    v_cvt_pk_bf16_f32 v53, v18, v19
    v_cvt_pk_bf16_f32 v54, v20, v21
    v_cvt_pk_bf16_f32 v55, v22, v23
    v_cvt_pk_bf16_f32 v56, v24, v25
    v_cvt_pk_bf16_f32 v57, v26, v27
    v_cvt_pk_bf16_f32 v58, v28, v29
    v_cvt_pk_bf16_f32 v59, v30, v31
    s_waitcnt vmcnt(2)
    v_lshlrev_b32 v6, 16, v5
    v_lshlrev_b32 v7, 16, v5
    v_lshlrev_b32 v16, 16, v52
    v_and_b32 v17, 0xffff0000, v52
    v_lshlrev_b32 v18, 16, v53
    v_and_b32 v19, 0xffff0000, v53
    v_lshlrev_b32 v20, 16, v54
    v_and_b32 v21, 0xffff0000, v54
    v_lshlrev_b32 v22, 16, v55
    v_and_b32 v23, 0xffff0000, v55
    v_lshlrev_b32 v24, 16, v56
    v_and_b32 v25, 0xffff0000, v56
    v_lshlrev_b32 v26, 16, v57
    v_and_b32 v27, 0xffff0000, v57
    v_lshlrev_b32 v28, 16, v58
    v_and_b32 v29, 0xffff0000, v58
    v_lshlrev_b32 v30, 16, v59
    v_and_b32 v31, 0xffff0000, v59
    v_pk_add_f32 v[16:17], v[16:17], v[6:7]
    v_pk_add_f32 v[18:19], v[18:19], v[6:7]
    v_pk_add_f32 v[20:21], v[20:21], v[6:7]
    v_pk_add_f32 v[22:23], v[22:23], v[6:7]
    v_pk_add_f32 v[24:25], v[24:25], v[6:7]
    v_pk_add_f32 v[26:27], v[26:27], v[6:7]
    v_pk_add_f32 v[28:29], v[28:29], v[6:7]
    v_pk_add_f32 v[30:31], v[30:31], v[6:7]
    v_cvt_pk_bf16_f32 v52, v16, v17
    v_cvt_pk_bf16_f32 v53, v18, v19
    v_cvt_pk_bf16_f32 v54, v20, v21
    v_cvt_pk_bf16_f32 v55, v22, v23
    v_cvt_pk_bf16_f32 v56, v24, v25
    v_cvt_pk_bf16_f32 v57, v26, v27
    v_cvt_pk_bf16_f32 v58, v28, v29
    v_cvt_pk_bf16_f32 v59, v30, v31
    s_waitcnt vmcnt(0)
    v_lshlrev_b32 v16, 16, v52
    v_and_b32 v17, 0xffff0000, v52
    v_lshlrev_b32 v18, 16, v53
    v_and_b32 v19, 0xffff0000, v53
    v_lshlrev_b32 v20, 16, v54
    v_and_b32 v21, 0xffff0000, v54
    v_lshlrev_b32 v22, 16, v55
    v_and_b32 v23, 0xffff0000, v55
    v_lshlrev_b32 v24, 16, v56
    v_and_b32 v25, 0xffff0000, v56
    v_lshlrev_b32 v26, 16, v57
    v_and_b32 v27, 0xffff0000, v57
    v_lshlrev_b32 v28, 16, v58
    v_and_b32 v29, 0xffff0000, v58
    v_lshlrev_b32 v30, 16, v59
    v_and_b32 v31, 0xffff0000, v59
    v_lshlrev_b32 v32, 16, v8
    v_and_b32 v33, 0xffff0000, v8
    v_lshlrev_b32 v34, 16, v9
    v_and_b32 v35, 0xffff0000, v9
    v_lshlrev_b32 v36, 16, v10
    v_and_b32 v37, 0xffff0000, v10
    v_lshlrev_b32 v38, 16, v11
    v_and_b32 v39, 0xffff0000, v11
    v_lshlrev_b32 v40, 16, v12
    v_and_b32 v41, 0xffff0000, v12
    v_lshlrev_b32 v42, 16, v13
    v_and_b32 v43, 0xffff0000, v13
    v_lshlrev_b32 v44, 16, v14
    v_and_b32 v45, 0xffff0000, v14
    v_lshlrev_b32 v46, 16, v15
    v_and_b32 v47, 0xffff0000, v15
    v_pk_add_f32 v[16:17], v[16:17], v[32:33]
    v_pk_add_f32 v[18:19], v[18:19], v[34:35]
    v_pk_add_f32 v[20:21], v[20:21], v[36:37]
    v_pk_add_f32 v[22:23], v[22:23], v[38:39]
    v_pk_add_f32 v[24:25], v[24:25], v[40:41]
    v_pk_add_f32 v[26:27], v[26:27], v[42:43]
    v_pk_add_f32 v[28:29], v[28:29], v[44:45]
    v_pk_add_f32 v[30:31], v[30:31], v[46:47]
    v_cvt_pk_bf16_f32 v8, v16, v17
    v_cvt_pk_bf16_f32 v9, v18, v19
    v_cvt_pk_bf16_f32 v10, v20, v21
    v_cvt_pk_bf16_f32 v11, v22, v23
    v_cvt_pk_bf16_f32 v12, v24, v25
    v_cvt_pk_bf16_f32 v13, v26, v27
    v_cvt_pk_bf16_f32 v14, v28, v29
    v_cvt_pk_bf16_f32 v15, v30, v31
    buffer_store_dwordx4 v[8:11], v3, s[12:15], 0 offen
    buffer_store_dwordx4 v[12:15], v3, s[12:15], 0 offen offset:1024
fin_kernel_done:
    s_endpgm
.section .rodata,"a"
.p2align 6
.amdhsa_kernel fin_kernel
  .amdhsa_next_free_vgpr 68
  .amdhsa_next_free_sgpr 48
  .amdhsa_accum_offset 68
  .amdhsa_group_segment_fixed_size 0
  .amdhsa_kernarg_size 88
  .amdhsa_user_sgpr_count 2
  .amdhsa_user_sgpr_kernarg_segment_ptr 1
  .amdhsa_system_sgpr_workgroup_id_x 1
.end_amdhsa_kernel
```

```asm
; @launch kernel=g1a_kernel grid=(256,1,1) block=(512,1,1) lds=131072
; @launch kernel=g2a_kernel grid=(256,1,1) block=(512,1,1) lds=98304
; @launch kernel=ln3_kernel grid=(512,1,1) block=(256,1,1) lds=0
; @launch kernel=g3a_kernel grid=(256,1,1) block=(512,1,1) lds=131072
; @launch kernel=g4a_kernel grid=(256,1,1) block=(512,1,1) lds=98304
; @launch kernel=g1b_kernel grid=(256,1,1) block=(512,1,1) lds=131072
; @launch kernel=g2b_kernel grid=(256,1,1) block=(512,1,1) lds=98304
; @launch kernel=ln3_kernel grid=(512,1,1) block=(256,1,1) lds=0
; @launch kernel=g3b_kernel grid=(224,1,1) block=(512,1,1) lds=131072
; @launch kernel=g4b_kernel grid=(256,1,1) block=(512,1,1) lds=98304
.amdgcn_target "amdgcn-amd-amdhsa--gfx950"
.text
.globl g1a_kernel
.p2align 8
.type g1a_kernel,@function
g1a_kernel:
    s_load_dwordx2 s[6:7], s[0:1], 0
    s_mov_b32 s47, 0
    s_mov_b32 s53, 1
    s_branch g1_body
.text
.globl g1b_kernel
.p2align 8
.type g1b_kernel,@function
g1b_kernel:
    s_load_dwordx2 s[6:7], s[0:1], 80
    s_mov_b32 s47, 0x1800000
    s_mov_b32 s53, 0
    s_branch g1_body
.p2align 6
g1_body:
    s_cmp_ge_u32 s2, 256
    s_cbranch_scc1 g1_done
    s_load_dwordx2 s[4:5], s[0:1], 80
    s_load_dwordx2 s[30:31], s[0:1], 8
    s_load_dwordx2 s[16:17], s[0:1], 72
    s_load_dwordx2 s[18:19], s[0:1], 16
    v_lshrrev_b32 v1, 6, v0
    v_and_b32 v2, 63, v0
    s_and_b32 s40, s2, 1
    s_lshl_b32 s40, s40, 3
    s_bfe_u32 s41, s2, 0x30003
    s_add_u32 s25, s40, s41
    s_bfe_u32 s40, s2, 0x20001
    s_lshl_b32 s40, s40, 2
    s_lshr_b32 s42, s2, 6
    s_add_u32 s24, s40, s42
    s_add_u32 s27, s41, s42
    s_add_u32 s52, s24, s25
    s_and_b32 s52, s52, 15
    s_and_b32 s26, s52, 12
    s_mul_i32 s26, s26, s53
    v_readfirstlane_b32 s28, v1
    v_lshrrev_b32 v5, 4, v2
    v_bfe_u32 v6, v2, 2, 2
    v_and_b32 v7, 3, v2
    v_and_b32 v8, 15, v2
    s_cmp_lt_u32 s28, 4
    s_cbranch_scc1 g1_compute
    s_sub_u32 s28, s28, 4
    s_mov_b32 s40, 2048
    v_lshrrev_b32 v3, 3, v2
    v_mul_lo_u32 v3, v3, s40
    v_lshrrev_b32 v4, 4, v2
    v_xor_b32 v4, v4, v2
    v_and_b32 v4, 7, v4
    v_lshl_add_u32 v3, v4, 4, v3
    s_mul_i32 s41, s25, 262144
    s_mul_i32 s42, s28, 65536
    s_add_u32 s41, s41, s42
    v_xor_b32 v4, 64, v3
    s_add_u32 s42, s41, 0
    v_add_u32 v16, s42, v3
    s_add_u32 s42, s41, 16384
    v_add_u32 v17, s42, v4
    s_add_u32 s42, s41, 32768
    v_add_u32 v18, s42, v3
    s_add_u32 s42, s41, 49152
    v_add_u32 v19, s42, v4
    s_mov_b32 s40, 6144
    v_lshrrev_b32 v3, 3, v2
    v_mul_lo_u32 v3, v3, s40
    v_bfe_u32 v4, v2, 4, 1
    v_lshlrev_b32 v4, 1, v4
    v_xor_b32 v4, v4, v2
    v_and_b32 v4, 7, v4
    v_lshl_add_u32 v3, v4, 4, v3
    s_mul_i32 s41, s24, 128
    s_mul_i32 s42, s28, 98304
    s_add_u32 s41, s41, s42
    v_xor_b32 v4, 64, v3
    s_add_u32 s42, s41, 0
    v_add_u32 v10, s42, v3
    s_add_u32 s42, s41, 49152
    v_add_u32 v11, s42, v4
    s_mov_b32 s40, 6144
    v_lshrrev_b32 v3, 3, v2
    v_mul_lo_u32 v3, v3, s40
    v_bfe_u32 v4, v2, 4, 1
    v_lshlrev_b32 v4, 1, v4
    v_xor_b32 v4, v4, v2
    v_and_b32 v4, 7, v4
    v_lshl_add_u32 v3, v4, 4, v3
    s_mul_i32 s41, s24, 128
    s_mul_i32 s42, s28, 98304
    s_add_u32 s41, s41, s42
    v_xor_b32 v4, 64, v3
    s_add_u32 s42, s41, 2048
    v_add_u32 v12, s42, v3
    s_add_u32 s42, s41, 51200
    v_add_u32 v13, s42, v4
    s_mov_b32 s40, 6144
    v_lshrrev_b32 v3, 3, v2
    v_mul_lo_u32 v3, v3, s40
    v_bfe_u32 v4, v2, 4, 1
    v_lshlrev_b32 v4, 1, v4
    v_xor_b32 v4, v4, v2
    v_and_b32 v4, 7, v4
    v_lshl_add_u32 v3, v4, 4, v3
    s_mul_i32 s41, s24, 128
    s_mul_i32 s42, s28, 98304
    s_add_u32 s41, s41, s42
    v_xor_b32 v4, 64, v3
    s_add_u32 s42, s41, 4096
    v_add_u32 v14, s42, v3
    s_add_u32 s42, s41, 53248
    v_add_u32 v15, s42, v4
    v_lshrrev_b32 v3, 3, v2
    s_lshl_b32 s40, s28, 2
    v_add_u32 v3, s40, v3
    v_lshrrev_b32 v4, 1, v3
    v_xor_b32 v4, v4, v2
    v_and_b32 v4, 7, v4
    s_lshl_b32 s40, s25, 7
    s_sub_u32 s40, s40, 16
    v_add_u32 v3, s40, v3
    v_max_i32 v3, 0, v3
    v_lshlrev_b32 v3, 11, v3
    v_lshl_add_u32 v20, v4, 4, v3
    s_mul_i32 s36, s28, 2048
    s_mul_i32 s37, s28, 4096
    s_add_u32 s37, s37, 26624
    s_mul_i32 s46, s28, 512
    s_add_u32 s46, s46, 24576
    s_waitcnt lgkmcnt(0)
    s_mov_b32 s8, s30
    s_mov_b32 s9, s31
    s_mov_b32 s10, 0x600000
    s_mov_b32 s11, 0x20000
    s_add_u32 s12, s6, s47
    s_addc_u32 s13, s7, 0
    s_mov_b32 s14, 0x400000
    s_mov_b32 s15, 0x20000
    s_mov_b32 s20, s4
    s_mov_b32 s21, s5
    s_mov_b32 s22, 0x40000
    s_mov_b32 s23, 0x20000
    s_add_u32 s56, s4, 0x100000
    s_addc_u32 s57, s5, 0
    s_mov_b32 s58, 0x30000
    s_mov_b32 s59, 0x20000
    s_mov_b32 s60, s16
    s_mov_b32 s61, s17
    s_mov_b32 s62, 0x100
    s_mov_b32 s63, 0x20000
    s_sub_u32 s40, s52, s27
    s_and_b32 s40, s40, 1
    s_and_b32 s41, s52, 2
    s_or_b32 s40, s40, s41
    s_add_u32 s54, s40, 2
    s_cmp_eq_u32 s53, 0
    s_cselect_b32 s54, 0x7fff, s54
    s_add_u32 s55, s54, 3
    s_cmp_lg_u32 s28, 0
    s_cselect_b32 s55, 0x7fff, s55
    s_cmp_lt_u32 s55, 0x7fff
    s_cselect_b32 s29, 13, 0x7fff
    s_mov_b32 s32, 0
    s_mov_b32 s33, 0
g1_ld_loop:
    s_cmp_lt_u32 s32, 2
    s_cbranch_scc1 g1_ld_issue
    s_sub_u32 s40, s32, s54
    s_sub_u32 s40, s40, 1
    s_cmp_lt_u32 s40, 2
    s_cbranch_scc1 g1_ld_w0
    s_sub_u32 s40, s32, s55
    s_sub_u32 s40, s40, 1
    s_cmp_lt_u32 s40, 2
    s_cbranch_scc1 g1_ld_w1
    s_sub_u32 s40, s32, s29
    s_sub_u32 s40, s40, 1
    s_cmp_lt_u32 s40, 2
    s_cbranch_scc1 g1_ld_w2
    s_waitcnt vmcnt(11)
g1_ld_bar:
    s_barrier
g1_ld_issue:
    s_add_u32 s40, s32, s27
    s_and_b32 s40, s40, 1
    s_andn2_b32 s41, s32, 1
    s_or_b32 s40, s40, s41
    s_add_u32 s40, s40, s26
    s_and_b32 s40, s40, 15
    s_mul_i32 s34, s40, 393216
    s_mul_i32 s35, s40, 128
    s_add_u32 s38, s33, s36
    s_add_u32 s39, s33, s37
    s_add_u32 m0, s39, 0
    s_nop 0
    buffer_load_dwordx4 v16, s[12:15], s35 offen lds
    s_add_u32 m0, s39, 1024
    s_nop 0
    buffer_load_dwordx4 v17, s[12:15], s35 offen lds
    s_add_u32 m0, s39, 2048
    s_nop 0
    buffer_load_dwordx4 v18, s[12:15], s35 offen lds
    s_add_u32 m0, s39, 3072
    s_nop 0
    buffer_load_dwordx4 v19, s[12:15], s35 offen lds
    s_add_u32 m0, s38, 0
    s_nop 0
    buffer_load_dwordx4 v10, s[8:11], s34 offen lds
    s_add_u32 m0, s38, 1024
    s_nop 0
    buffer_load_dwordx4 v11, s[8:11], s34 offen lds
    s_add_u32 m0, s38, 8192
    s_nop 0
    buffer_load_dwordx4 v12, s[8:11], s34 offen lds
    s_add_u32 m0, s38, 9216
    s_nop 0
    buffer_load_dwordx4 v13, s[8:11], s34 offen lds
    s_add_u32 m0, s38, 16384
    s_nop 0
    buffer_load_dwordx4 v14, s[8:11], s34 offen lds
    s_add_u32 m0, s38, 17408
    s_nop 0
    buffer_load_dwordx4 v15, s[8:11], s34 offen lds
    s_add_u32 m0, s33, s46
    s_mov_b32 exec_hi, 0
    buffer_load_dwordx4 v20, s[12:15], s35 offen lds
    s_mov_b32 exec_hi, -1
    s_cmp_eq_u32 s32, s54
    s_cbranch_scc1 g1_ld_h0
g1_ld_c0:
    s_cmp_eq_u32 s32, s55
    s_cbranch_scc1 g1_ld_h1
g1_ld_c1:
    s_cmp_eq_u32 s32, s29
    s_cbranch_scc1 g1_ld_h2
g1_ld_c2:
    s_add_u32 s33, s33, 43008
    s_cmp_eq_u32 s33, 129024
    s_cselect_b32 s33, 0, s33
    s_add_u32 s32, s32, 1
    s_cmp_lt_u32 s32, 16
    s_cbranch_scc1 g1_ld_loop
    s_cmp_eq_u32 s29, 0x7fff
    s_cbranch_scc1 g1_polled
    s_mov_b32 s41, 0x20000
    v_mov_b32 v21, 0
    s_waitcnt vmcnt(22)
g1_poll:
    v_readfirstlane_b32 s40, v23
    s_sub_u32 s41, s41, 1
    s_cmp_eq_u32 s41, 0
    s_cbranch_scc1 g1_polled
    s_cmp_ge_u32 s40, 256
    s_cbranch_scc1 g1_polled
    s_sleep 8
    buffer_load_dword v23, v21, s[60:63], 0 offen sc1
    s_waitcnt vmcnt(0)
    s_branch g1_poll
g1_polled:
    s_waitcnt vmcnt(11)
    s_barrier
    s_lshl_b32 s40, s28, 6
    v_add_u32 v21, s40, v2
    s_lshl_b32 s41, s25, 7
    s_sub_u32 s41, s41, 16
    v_add_u32 v3, s41, v21
    v_max_i32 v3, 0, v3
    v_min_u32 v3, 2047, v3
    v_lshlrev_b32 v3, 3, v3
    s_min_u32 s40, s28, 2
    s_lshl_b32 s40, s40, 12
    s_lshl_b32 s41, s24, 8
    s_add_u32 s40, s40, s41
    v_lshl_add_u32 v4, v2, 2, s40
    s_mov_b32 s40, 0
    buffer_load_dwordx2 v[24:25], v3, s[20:23], s40 offen sc1
    s_mov_b32 s41, 0
    buffer_load_dword v56, v4, s[56:59], s41 offen sc1
    s_mov_b32 s40, 16384
    buffer_load_dwordx2 v[26:27], v3, s[20:23], s40 offen sc1
    s_mov_b32 s41, 12288
    buffer_load_dword v57, v4, s[56:59], s41 offen sc1
    s_mov_b32 s40, 32768
    buffer_load_dwordx2 v[28:29], v3, s[20:23], s40 offen sc1
    s_mov_b32 s41, 24576
    buffer_load_dword v58, v4, s[56:59], s41 offen sc1
    s_mov_b32 s40, 49152
    buffer_load_dwordx2 v[30:31], v3, s[20:23], s40 offen sc1
    s_mov_b32 s41, 36864
    buffer_load_dword v59, v4, s[56:59], s41 offen sc1
    s_mov_b32 s40, 65536
    buffer_load_dwordx2 v[32:33], v3, s[20:23], s40 offen sc1
    s_mov_b32 s41, 49152
    buffer_load_dword v60, v4, s[56:59], s41 offen sc1
    s_mov_b32 s40, 81920
    buffer_load_dwordx2 v[34:35], v3, s[20:23], s40 offen sc1
    s_mov_b32 s41, 61440
    buffer_load_dword v61, v4, s[56:59], s41 offen sc1
    s_mov_b32 s40, 98304
    buffer_load_dwordx2 v[36:37], v3, s[20:23], s40 offen sc1
    s_mov_b32 s41, 73728
    buffer_load_dword v62, v4, s[56:59], s41 offen sc1
    s_mov_b32 s40, 114688
    buffer_load_dwordx2 v[38:39], v3, s[20:23], s40 offen sc1
    s_mov_b32 s41, 86016
    buffer_load_dword v63, v4, s[56:59], s41 offen sc1
    s_mov_b32 s40, 131072
    buffer_load_dwordx2 v[40:41], v3, s[20:23], s40 offen sc1
    s_mov_b32 s41, 98304
    buffer_load_dword v64, v4, s[56:59], s41 offen sc1
    s_mov_b32 s40, 147456
    buffer_load_dwordx2 v[42:43], v3, s[20:23], s40 offen sc1
    s_mov_b32 s41, 110592
    buffer_load_dword v65, v4, s[56:59], s41 offen sc1
    s_mov_b32 s40, 163840
    buffer_load_dwordx2 v[44:45], v3, s[20:23], s40 offen sc1
    s_mov_b32 s41, 122880
    buffer_load_dword v66, v4, s[56:59], s41 offen sc1
    s_mov_b32 s40, 180224
    buffer_load_dwordx2 v[46:47], v3, s[20:23], s40 offen sc1
    s_mov_b32 s41, 135168
    buffer_load_dword v67, v4, s[56:59], s41 offen sc1
    s_mov_b32 s40, 196608
    buffer_load_dwordx2 v[48:49], v3, s[20:23], s40 offen sc1
    s_mov_b32 s41, 147456
    buffer_load_dword v68, v4, s[56:59], s41 offen sc1
    s_mov_b32 s40, 212992
    buffer_load_dwordx2 v[50:51], v3, s[20:23], s40 offen sc1
    s_mov_b32 s41, 159744
    buffer_load_dword v69, v4, s[56:59], s41 offen sc1
    s_mov_b32 s40, 229376
    buffer_load_dwordx2 v[52:53], v3, s[20:23], s40 offen sc1
    s_mov_b32 s41, 172032
    buffer_load_dword v70, v4, s[56:59], s41 offen sc1
    s_mov_b32 s40, 245760
    buffer_load_dwordx2 v[54:55], v3, s[20:23], s40 offen sc1
    s_mov_b32 s41, 184320
    buffer_load_dword v71, v4, s[56:59], s41 offen sc1
    s_waitcnt vmcnt(32)
    s_barrier
    s_waitcnt vmcnt(0)
    v_pk_add_f32 v[24:25], v[24:25], v[40:41]
    v_add_f32 v56, v56, v64
    v_pk_add_f32 v[26:27], v[26:27], v[42:43]
    v_add_f32 v57, v57, v65
    v_pk_add_f32 v[28:29], v[28:29], v[44:45]
    v_add_f32 v58, v58, v66
    v_pk_add_f32 v[30:31], v[30:31], v[46:47]
    v_add_f32 v59, v59, v67
    v_pk_add_f32 v[32:33], v[32:33], v[48:49]
    v_add_f32 v60, v60, v68
    v_pk_add_f32 v[34:35], v[34:35], v[50:51]
    v_add_f32 v61, v61, v69
    v_pk_add_f32 v[36:37], v[36:37], v[52:53]
    v_add_f32 v62, v62, v70
    v_pk_add_f32 v[38:39], v[38:39], v[54:55]
    v_add_f32 v63, v63, v71
    v_pk_add_f32 v[24:25], v[24:25], v[32:33]
    v_add_f32 v56, v56, v60
    v_pk_add_f32 v[26:27], v[26:27], v[34:35]
    v_add_f32 v57, v57, v61
    v_pk_add_f32 v[28:29], v[28:29], v[36:37]
    v_add_f32 v58, v58, v62
    v_pk_add_f32 v[30:31], v[30:31], v[38:39]
    v_add_f32 v59, v59, v63
    v_pk_add_f32 v[24:25], v[24:25], v[28:29]
    v_add_f32 v56, v56, v58
    v_pk_add_f32 v[26:27], v[26:27], v[30:31]
    v_add_f32 v57, v57, v59
    v_pk_add_f32 v[24:25], v[24:25], v[26:27]
    v_add_f32 v56, v56, v57
    v_mul_f32 v24, 0x3a800000, v24
    v_mul_f32 v25, 0x3a800000, v25
    v_fma_f32 v25, -v24, v24, v25
    v_max_f32 v25, 0, v25
    v_cvt_pk_bf16_f32 v24, v24, v24
    v_lshlrev_b32 v24, 16, v24
    v_cvt_pk_bf16_f32 v25, v25, v25
    v_lshlrev_b32 v25, 16, v25
    v_add_f32 v25, 0x3727c5ac, v25
    v_cvt_pk_bf16_f32 v25, v25, v25
    v_lshlrev_b32 v25, 16, v25
    v_sqrt_f32 v25, v25
    s_nop 0
    v_cvt_pk_bf16_f32 v25, v25, v25
    v_lshlrev_b32 v25, 16, v25
    v_rcp_f32 v26, v25
    v_lshlrev_b32 v3, 3, v21
    v_lshlrev_b32 v4, 2, v21
    v_mul_f32 v27, -v24, v26
    v_cmp_gt_u32 vcc, 144, v21
    s_and_saveexec_b64 s[40:41], vcc
    v_add_u32 v3, 129024, v3
    ds_write_b64 v3, v[26:27]
    s_mov_b64 exec, s[40:41]
    v_cmp_gt_u32 vcc, 192, v21
    s_and_saveexec_b64 s[40:41], vcc
    v_add_u32 v4, 130304, v4
    ds_write_b32 v4, v56
    s_mov_b64 exec, s[40:41]
    s_waitcnt lgkmcnt(0)
    s_barrier
    s_cmp_eq_u32 s53, 0
    s_cbranch_scc1 g1_nopf
    s_mov_b32 s20, s18
    s_mov_b32 s21, s19
    s_mov_b32 s22, 0x200000
    s_mov_b32 s23, 0x20000
    s_lshl_b32 s40, s2, 13
    s_lshl_b32 s41, s28, 11
    s_add_u32 s40, s40, s41
    v_lshlrev_b32 v3, 4, v2
    buffer_load_dwordx4 v[120:123], v3, s[20:23], s40 offen
    buffer_load_dwordx4 v[120:123], v3, s[20:23], s40 offen offset:1024
g1_nopf:
    s_branch g1_ld_end
g1_ld_w0:
    s_waitcnt vmcnt(16)
    s_branch g1_ld_bar
g1_ld_h0:
    s_add_u32 s44, s33, 43008
    s_cmp_eq_u32 s44, 129024
    s_cselect_b32 s44, 0, s44
    s_mul_i32 s42, s28, 3
    s_add_u32 s42, s42, 0
    s_lshr_b32 s43, s42, 2
    s_lshl_b32 s43, s43, 13
    s_add_u32 s43, s43, s44
    s_and_b32 s42, s42, 3
    v_and_b32 v3, 1, v5
    v_lshlrev_b32 v3, 1, v3
    v_lshrrev_b32 v4, 1, v6
    v_or_b32 v3, v3, v4
    s_add_u32 s40, s42, 0
    v_xor_b32 v3, s40, v3
    v_lshlrev_b32 v3, 5, v3
    v_lshl_add_u32 v3, v7, 3, v3
    v_lshl_add_u32 v4, v5, 3, v6
    v_lshl_add_u32 v3, v4, 7, v3
    v_add_u32 v21, s43, v3
    ds_read_b64_tr_b16 v[24:25], v21 offset:0
    ds_read_b64_tr_b16 v[26:27], v21 offset:512
    ds_read_b64_tr_b16 v[28:29], v21 offset:4096
    ds_read_b64_tr_b16 v[30:31], v21 offset:4608
    s_mul_i32 s42, s28, 3
    s_add_u32 s42, s42, 1
    s_lshr_b32 s43, s42, 2
    s_lshl_b32 s43, s43, 13
    s_add_u32 s43, s43, s44
    s_and_b32 s42, s42, 3
    v_and_b32 v3, 1, v5
    v_lshlrev_b32 v3, 1, v3
    v_lshrrev_b32 v4, 1, v6
    v_or_b32 v3, v3, v4
    s_add_u32 s40, s42, 0
    v_xor_b32 v3, s40, v3
    v_lshlrev_b32 v3, 5, v3
    v_lshl_add_u32 v3, v7, 3, v3
    v_lshl_add_u32 v4, v5, 3, v6
    v_lshl_add_u32 v3, v4, 7, v3
    v_add_u32 v21, s43, v3
    ds_read_b64_tr_b16 v[32:33], v21 offset:0
    ds_read_b64_tr_b16 v[34:35], v21 offset:512
    ds_read_b64_tr_b16 v[36:37], v21 offset:4096
    ds_read_b64_tr_b16 v[38:39], v21 offset:4608
    s_mul_i32 s42, s28, 3
    s_add_u32 s42, s42, 2
    s_lshr_b32 s43, s42, 2
    s_lshl_b32 s43, s43, 13
    s_add_u32 s43, s43, s44
    s_and_b32 s42, s42, 3
    v_and_b32 v3, 1, v5
    v_lshlrev_b32 v3, 1, v3
    v_lshrrev_b32 v4, 1, v6
    v_or_b32 v3, v3, v4
    s_add_u32 s40, s42, 0
    v_xor_b32 v3, s40, v3
    v_lshlrev_b32 v3, 5, v3
    v_lshl_add_u32 v3, v7, 3, v3
    v_lshl_add_u32 v4, v5, 3, v6
    v_lshl_add_u32 v3, v4, 7, v3
    v_add_u32 v21, s43, v3
    ds_read_b64_tr_b16 v[40:41], v21 offset:0
    ds_read_b64_tr_b16 v[42:43], v21 offset:512
    ds_read_b64_tr_b16 v[44:45], v21 offset:4096
    ds_read_b64_tr_b16 v[46:47], v21 offset:4608
    s_lshr_b32 s42, s44, 7
    s_lshl_b32 s43, s28, 5
    s_add_u32 s42, s42, s43
    s_add_u32 s42, s42, 16
    v_lshrrev_b32 v3, 1, v8
    v_xor_b32 v3, v3, v5
    v_lshlrev_b32 v3, 4, v3
    v_lshl_add_u32 v3, v8, 7, v3
    s_lshl_b32 s40, s42, 7
    s_add_u32 s40, s40, 24576
    v_add_u32 v22, s40, v3
    v_xor_b32 v23, 64, v22
    ds_read_b128 v[48:51], v22 offset:0
    ds_read_b128 v[52:55], v23 offset:0
    ds_read_b128 v[56:59], v22 offset:2048
    ds_read_b128 v[60:63], v23 offset:2048
    v_mov_b32 v64, 0x3f803f80
    v_mov_b32 v65, 0x3f803f80
    v_mov_b32 v66, 0x3f803f80
    v_mov_b32 v67, 0x3f803f80
    s_mul_i32 s42, s52, 12288
    s_lshl_b32 s43, s24, 8
    s_add_u32 s42, s42, s43
    v_lshl_add_u32 v21, v5, 4, s42
    s_lshl_b32 s42, s52, 14
    s_lshl_b32 s43, s25, 10
    s_add_u32 s42, s42, s43
    s_lshl_b32 s43, s28, 8
    s_add_u32 s42, s42, s43
    v_lshl_add_u32 v22, v8, 3, s42
    s_waitcnt lgkmcnt(0)
    v_mfma_f32_16x16x32_bf16 v[68:71], v[24:27], v[64:67], 0
    v_mfma_f32_16x16x32_bf16 v[72:75], v[32:35], v[64:67], 0
    v_mfma_f32_16x16x32_bf16 v[76:79], v[40:43], v[64:67], 0
    v_mfma_f32_16x16x32_bf16 v[80:83], v[64:67], v[48:51], 0
    v_mfma_f32_16x16x32_bf16 v[84:87], v[48:51], v[48:51], 0
    v_mfma_f32_16x16x32_bf16 v[88:91], v[64:67], v[56:59], 0
    v_mfma_f32_16x16x32_bf16 v[92:95], v[56:59], v[56:59], 0
    v_mfma_f32_16x16x32_bf16 v[68:71], v[28:31], v[64:67], v[68:71]
    v_mfma_f32_16x16x32_bf16 v[72:75], v[36:39], v[64:67], v[72:75]
    v_mfma_f32_16x16x32_bf16 v[76:79], v[44:47], v[64:67], v[76:79]
    v_mfma_f32_16x16x32_bf16 v[80:83], v[64:67], v[52:55], v[80:83]
    v_mfma_f32_16x16x32_bf16 v[84:87], v[52:55], v[52:55], v[84:87]
    v_mfma_f32_16x16x32_bf16 v[88:91], v[64:67], v[60:63], v[88:91]
    v_mfma_f32_16x16x32_bf16 v[92:95], v[60:63], v[60:63], v[92:95]
    v_cmp_eq_u32 s[40:41], 1, v7
    v_cmp_eq_u32 s[42:43], 2, v7
    v_cmp_eq_u32 vcc, 3, v7
    s_nop 7
    v_cndmask_b32 v81, v84, v85, s[40:41]
    v_cndmask_b32 v81, v81, v86, s[42:43]
    v_cndmask_b32 v81, v81, v87, vcc
    v_cndmask_b32 v89, v92, v93, s[40:41]
    v_cndmask_b32 v89, v89, v94, s[42:43]
    v_cndmask_b32 v89, v89, v95, vcc
    s_mov_b32 exec_lo, 0x00f0000f
    s_mov_b32 exec_hi, 0xf0000f00
    buffer_store_dwordx2 v[80:81], v22, s[20:23], 0 offen offset:0 sc1
    buffer_store_dwordx2 v[88:89], v22, s[20:23], 0 offen offset:128 sc1
    s_mov_b32 exec_lo, 0x00010001
    s_mov_b32 exec_hi, 0x00010001
    s_mul_i32 s42, s28, 3
    s_add_u32 s42, s42, 0
    s_lshr_b32 s43, s42, 2
    s_lshl_b32 s43, s43, 12
    s_and_b32 s42, s42, 3
    s_lshl_b32 s42, s42, 6
    s_add_u32 s42, s42, s43
    buffer_store_dwordx4 v[68:71], v21, s[56:59], s42 offen sc1
    s_mul_i32 s42, s28, 3
    s_add_u32 s42, s42, 1
    s_lshr_b32 s43, s42, 2
    s_lshl_b32 s43, s43, 12
    s_and_b32 s42, s42, 3
    s_lshl_b32 s42, s42, 6
    s_add_u32 s42, s42, s43
    buffer_store_dwordx4 v[72:75], v21, s[56:59], s42 offen sc1
    s_mul_i32 s42, s28, 3
    s_add_u32 s42, s42, 2
    s_lshr_b32 s43, s42, 2
    s_lshl_b32 s43, s43, 12
    s_and_b32 s42, s42, 3
    s_lshl_b32 s42, s42, 6
    s_add_u32 s42, s42, s43
    buffer_store_dwordx4 v[76:79], v21, s[56:59], s42 offen sc1
    s_mov_b64 exec, -1
    s_branch g1_ld_c0
g1_ld_w1:
    s_waitcnt vmcnt(12)
    s_branch g1_ld_bar
g1_ld_h1:
    v_mov_b32 v21, 0
    v_mov_b32 v22, 1
    s_mov_b64 exec, 1
    buffer_atomic_add v22, v21, s[60:63], 0 offen sc1
    s_mov_b64 exec, -1
    s_branch g1_ld_c1
g1_ld_w2:
    s_waitcnt vmcnt(12)
    s_branch g1_ld_bar
g1_ld_h2:
    v_mov_b32 v21, 0
    buffer_load_dword v23, v21, s[60:63], 0 offen sc1
    s_branch g1_ld_c2
g1_ld_end:
    s_add_u32 s28, s28, 4
    s_branch g1_attn
g1_compute:
    s_and_b32 s44, s28, 1
    s_lshr_b32 s45, s28, 1
    s_lshl_b32 s42, s44, 1
    s_mov_b32 s43, 0
    v_and_b32 v3, 1, v5
    v_lshlrev_b32 v3, 1, v3
    v_lshrrev_b32 v4, 1, v6
    v_or_b32 v3, v3, v4
    s_add_u32 s40, s42, 0
    v_xor_b32 v3, s40, v3
    v_lshlrev_b32 v3, 5, v3
    v_lshl_add_u32 v3, v7, 3, v3
    v_lshl_add_u32 v4, v5, 3, v6
    v_lshl_add_u32 v3, v4, 7, v3
    v_add_u32 v10, s43, v3
    v_and_b32 v3, 1, v5
    v_lshlrev_b32 v3, 1, v3
    v_lshrrev_b32 v4, 1, v6
    v_or_b32 v3, v3, v4
    s_add_u32 s40, s42, 1
    v_xor_b32 v3, s40, v3
    v_lshlrev_b32 v3, 5, v3
    v_lshl_add_u32 v3, v7, 3, v3
    v_lshl_add_u32 v4, v5, 3, v6
    v_lshl_add_u32 v3, v4, 7, v3
    v_add_u32 v11, s43, v3
    s_xor_b32 s43, s45, 1
    s_add_u32 s43, s43, 1
    s_mul_i32 s43, s43, 8192
    v_and_b32 v3, 1, v5
    v_lshlrev_b32 v3, 1, v3
    v_lshrrev_b32 v4, 1, v6
    v_or_b32 v3, v3, v4
    s_add_u32 s40, s42, 0
    v_xor_b32 v3, s40, v3
    v_lshlrev_b32 v3, 5, v3
    v_lshl_add_u32 v3, v7, 3, v3
    v_lshl_add_u32 v4, v5, 3, v6
    v_lshl_add_u32 v3, v4, 7, v3
    v_add_u32 v12, s43, v3
    v_and_b32 v3, 1, v5
    v_lshlrev_b32 v3, 1, v3
    v_lshrrev_b32 v4, 1, v6
    v_or_b32 v3, v3, v4
    s_add_u32 s40, s42, 1
    v_xor_b32 v3, s40, v3
    v_lshlrev_b32 v3, 5, v3
    v_lshl_add_u32 v3, v7, 3, v3
    v_lshl_add_u32 v4, v5, 3, v6
    v_lshl_add_u32 v3, v4, 7, v3
    v_add_u32 v13, s43, v3
    s_xor_b32 s43, s45, 0
    s_add_u32 s43, s43, 1
    s_mul_i32 s43, s43, 8192
    v_and_b32 v3, 1, v5
    v_lshlrev_b32 v3, 1, v3
    v_lshrrev_b32 v4, 1, v6
    v_or_b32 v3, v3, v4
    s_add_u32 s40, s42, 0
    v_xor_b32 v3, s40, v3
    v_lshlrev_b32 v3, 5, v3
    v_lshl_add_u32 v3, v7, 3, v3
    v_lshl_add_u32 v4, v5, 3, v6
    v_lshl_add_u32 v3, v4, 7, v3
    v_add_u32 v14, s43, v3
    v_and_b32 v3, 1, v5
    v_lshlrev_b32 v3, 1, v3
    v_lshrrev_b32 v4, 1, v6
    v_or_b32 v3, v3, v4
    s_add_u32 s40, s42, 1
    v_xor_b32 v3, s40, v3
    v_lshlrev_b32 v3, 5, v3
    v_lshl_add_u32 v3, v7, 3, v3
    v_lshl_add_u32 v4, v5, 3, v6
    v_lshl_add_u32 v3, v4, 7, v3
    v_add_u32 v15, s43, v3
    s_mul_i32 s42, s45, 64
    s_add_u32 s42, s42, 16
    v_lshrrev_b32 v3, 1, v8
    v_xor_b32 v3, v3, v5
    v_lshlrev_b32 v3, 4, v3
    v_lshl_add_u32 v3, v8, 7, v3
    s_lshl_b32 s40, s42, 7
    s_add_u32 s40, s40, 24576
    v_add_u32 v16, s40, v3
    v_xor_b32 v17, 64, v16
    v_lshrrev_b32 v3, 1, v8
    v_xor_b32 v3, v3, v5
    v_lshlrev_b32 v3, 4, v3
    v_lshl_add_u32 v3, v8, 7, v3
    v_add_u32 v18, 24576, v3
    v_xor_b32 v19, 64, v18
    v_mov_b32 v24, 0
    v_mov_b32 v25, 0
    v_mov_b32 v26, 0
    v_mov_b32 v27, 0
    v_mov_b32 v28, 0
    v_mov_b32 v29, 0
    v_mov_b32 v30, 0
    v_mov_b32 v31, 0
    v_mov_b32 v32, 0
    v_mov_b32 v33, 0
    v_mov_b32 v34, 0
    v_mov_b32 v35, 0
    v_mov_b32 v36, 0
    v_mov_b32 v37, 0
    v_mov_b32 v38, 0
    v_mov_b32 v39, 0
    v_mov_b32 v40, 0
    v_mov_b32 v41, 0
    v_mov_b32 v42, 0
    v_mov_b32 v43, 0
    v_mov_b32 v44, 0
    v_mov_b32 v45, 0
    v_mov_b32 v46, 0
    v_mov_b32 v47, 0
    v_mov_b32 v48, 0
    v_mov_b32 v49, 0
    v_mov_b32 v50, 0
    v_mov_b32 v51, 0
    v_mov_b32 v52, 0
    v_mov_b32 v53, 0
    v_mov_b32 v54, 0
    v_mov_b32 v55, 0
    v_mov_b32 v56, 0
    v_mov_b32 v57, 0
    v_mov_b32 v58, 0
    v_mov_b32 v59, 0
    v_mov_b32 v60, 0
    v_mov_b32 v61, 0
    v_mov_b32 v62, 0
    v_mov_b32 v63, 0
    v_mov_b32 v64, 0
    v_mov_b32 v65, 0
    v_mov_b32 v66, 0
    v_mov_b32 v67, 0
    v_mov_b32 v68, 0
    v_mov_b32 v69, 0
    v_mov_b32 v70, 0
    v_mov_b32 v71, 0
    v_mov_b32 v72, 0
    v_mov_b32 v73, 0
    v_mov_b32 v74, 0
    v_mov_b32 v75, 0
    v_mov_b32 v76, 0
    v_mov_b32 v77, 0
    v_mov_b32 v78, 0
    v_mov_b32 v79, 0
    v_mov_b32 v80, 0
    v_mov_b32 v81, 0
    v_mov_b32 v82, 0
    v_mov_b32 v83, 0
    v_mov_b32 v84, 0
    v_mov_b32 v85, 0
    v_mov_b32 v86, 0
    v_mov_b32 v87, 0
    v_mov_b32 v88, 0
    v_mov_b32 v89, 0
    v_mov_b32 v90, 0
    v_mov_b32 v91, 0
    v_mov_b32 v92, 0
    v_mov_b32 v93, 0
    v_mov_b32 v94, 0
    v_mov_b32 v95, 0
    v_mov_b32 v96, 0
    v_mov_b32 v97, 0
    v_mov_b32 v98, 0
    v_mov_b32 v99, 0
    v_mov_b32 v100, 0
    v_mov_b32 v101, 0
    v_mov_b32 v102, 0
    v_mov_b32 v103, 0
    v_mov_b32 v104, 0
    v_mov_b32 v105, 0
    v_mov_b32 v106, 0
    v_mov_b32 v107, 0
    v_mov_b32 v108, 0
    v_mov_b32 v109, 0
    v_mov_b32 v110, 0
    v_mov_b32 v111, 0
    v_mov_b32 v112, 0
    v_mov_b32 v113, 0
    v_mov_b32 v114, 0
    v_mov_b32 v115, 0
    v_mov_b32 v116, 0
    v_mov_b32 v117, 0
    v_mov_b32 v118, 0
    v_mov_b32 v119, 0
    v_mov_b32 v120, 0
    v_mov_b32 v121, 0
    v_mov_b32 v122, 0
    v_mov_b32 v123, 0
    v_mov_b32 v124, 0
    v_mov_b32 v125, 0
    v_mov_b32 v126, 0
    v_mov_b32 v127, 0
    v_mov_b32 v172, 0
    v_mov_b32 v173, 0
    v_mov_b32 v174, 0
    v_mov_b32 v175, 0
    v_mov_b32 v176, 0
    v_mov_b32 v177, 0
    v_mov_b32 v178, 0
    v_mov_b32 v179, 0
    v_mov_b32 v180, 0
    v_mov_b32 v181, 0
    v_mov_b32 v182, 0
    v_mov_b32 v183, 0
    v_mov_b32 v184, 0
    v_mov_b32 v185, 0
    v_mov_b32 v186, 0
    v_mov_b32 v187, 0
    v_mov_b32 v188, 0
    v_mov_b32 v189, 0
    v_mov_b32 v190, 0
    v_mov_b32 v191, 0
    v_mov_b32 v192, 0
    v_mov_b32 v193, 0
    v_mov_b32 v194, 0
    v_mov_b32 v195, 0
    v_mov_b32 v196, 0
    v_mov_b32 v197, 0
    v_mov_b32 v198, 0
    v_mov_b32 v199, 0
    v_mov_b32 v200, 0
    v_mov_b32 v201, 0
    v_mov_b32 v202, 0
    v_mov_b32 v203, 0
    v_mov_b32 v204, 0
    v_mov_b32 v205, 0
    v_mov_b32 v206, 0
    v_mov_b32 v207, 0
    v_mov_b32 v208, 0
    v_mov_b32 v209, 0
    v_mov_b32 v210, 0
    v_mov_b32 v211, 0
    v_mov_b32 v212, 0
    v_mov_b32 v213, 0
    v_mov_b32 v214, 0
    v_mov_b32 v215, 0
    s_mov_b32 s48, 16
    s_mov_b32 s50, 0
    s_mov_b32 s51, 43008
    s_mov_b32 s29, 0xfffeb000
    s_waitcnt lgkmcnt(0)
.p2align 3
g1_cloop:
    s_barrier
g1_cloop2:
    v_mfma_f32_16x16x32_bf16 v[24:27], v[172:175], v[196:199], v[24:27]
    ds_read_b64_tr_b16 v[128:129], v10 offset:0
    ds_read_b64_tr_b16 v[130:131], v10 offset:512
    v_mfma_f32_16x16x32_bf16 v[28:31], v[172:175], v[200:203], v[28:31]
    ds_read_b128 v[152:155], v16 offset:0
    v_mfma_f32_16x16x32_bf16 v[32:35], v[172:175], v[204:207], v[32:35]
    ds_read_b128 v[156:159], v16 offset:2048
    v_mfma_f32_16x16x32_bf16 v[36:39], v[172:175], v[208:211], v[36:39]
    ds_read_b128 v[160:163], v16 offset:4096
    v_mfma_f32_16x16x32_bf16 v[40:43], v[176:179], v[196:199], v[40:43]
    ds_read_b128 v[164:167], v16 offset:6144
    v_mfma_f32_16x16x32_bf16 v[44:47], v[176:179], v[200:203], v[44:47]
    ds_read_b64_tr_b16 v[132:133], v11 offset:0
    ds_read_b64_tr_b16 v[134:135], v11 offset:512
    v_mfma_f32_16x16x32_bf16 v[48:51], v[176:179], v[204:207], v[48:51]
    ds_read_b64_tr_b16 v[136:137], v12 offset:0
    ds_read_b64_tr_b16 v[138:139], v12 offset:512
    v_mfma_f32_16x16x32_bf16 v[52:55], v[176:179], v[208:211], v[52:55]
    ds_read_b64_tr_b16 v[140:141], v13 offset:0
    ds_read_b64_tr_b16 v[142:143], v13 offset:512
    v_mfma_f32_16x16x32_bf16 v[56:59], v[180:183], v[196:199], v[56:59]
    ds_read_b64_tr_b16 v[144:145], v14 offset:0
    ds_read_b64_tr_b16 v[146:147], v14 offset:512
    v_mfma_f32_16x16x32_bf16 v[60:63], v[180:183], v[200:203], v[60:63]
    ds_read_b64_tr_b16 v[148:149], v15 offset:0
    ds_read_b64_tr_b16 v[150:151], v15 offset:512
    v_mfma_f32_16x16x32_bf16 v[64:67], v[180:183], v[204:207], v[64:67]
    ds_read_b128 v[168:171], v18 offset:0
    v_mfma_f32_16x16x32_bf16 v[68:71], v[180:183], v[208:211], v[68:71]
    v_mfma_f32_16x16x32_bf16 v[72:75], v[184:187], v[196:199], v[72:75]
    v_mfma_f32_16x16x32_bf16 v[76:79], v[184:187], v[200:203], v[76:79]
    v_mfma_f32_16x16x32_bf16 v[80:83], v[184:187], v[204:207], v[80:83]
    v_mfma_f32_16x16x32_bf16 v[84:87], v[184:187], v[208:211], v[84:87]
    v_mfma_f32_16x16x32_bf16 v[88:91], v[188:191], v[196:199], v[88:91]
    v_mfma_f32_16x16x32_bf16 v[92:95], v[188:191], v[200:203], v[92:95]
    v_mfma_f32_16x16x32_bf16 v[96:99], v[188:191], v[204:207], v[96:99]
    v_mfma_f32_16x16x32_bf16 v[100:103], v[188:191], v[208:211], v[100:103]
    v_mfma_f32_16x16x32_bf16 v[104:107], v[192:195], v[196:199], v[104:107]
    v_mfma_f32_16x16x32_bf16 v[108:111], v[192:195], v[200:203], v[108:111]
    v_mfma_f32_16x16x32_bf16 v[112:115], v[192:195], v[204:207], v[112:115]
    v_mfma_f32_16x16x32_bf16 v[116:119], v[192:195], v[208:211], v[116:119]
    v_mfma_f32_16x16x32_bf16 v[120:123], v[188:191], v[212:215], v[120:123]
    v_mfma_f32_16x16x32_bf16 v[124:127], v[192:195], v[212:215], v[124:127]
    s_waitcnt lgkmcnt(0)
    v_mfma_f32_16x16x32_bf16 v[24:27], v[128:131], v[152:155], v[24:27]
    ds_read_b64_tr_b16 v[172:173], v10 offset:4096
    ds_read_b64_tr_b16 v[174:175], v10 offset:4608
    v_mfma_f32_16x16x32_bf16 v[28:31], v[128:131], v[156:159], v[28:31]
    ds_read_b128 v[196:199], v17 offset:0
    v_mfma_f32_16x16x32_bf16 v[32:35], v[128:131], v[160:163], v[32:35]
    ds_read_b128 v[200:203], v17 offset:2048
    v_mfma_f32_16x16x32_bf16 v[36:39], v[128:131], v[164:167], v[36:39]
    ds_read_b128 v[204:207], v17 offset:4096
    v_mfma_f32_16x16x32_bf16 v[40:43], v[132:135], v[152:155], v[40:43]
    ds_read_b128 v[208:211], v17 offset:6144
    v_mfma_f32_16x16x32_bf16 v[44:47], v[132:135], v[156:159], v[44:47]
    ds_read_b64_tr_b16 v[176:177], v11 offset:4096
    ds_read_b64_tr_b16 v[178:179], v11 offset:4608
    v_mfma_f32_16x16x32_bf16 v[48:51], v[132:135], v[160:163], v[48:51]
    ds_read_b64_tr_b16 v[180:181], v12 offset:4096
    ds_read_b64_tr_b16 v[182:183], v12 offset:4608
    v_mfma_f32_16x16x32_bf16 v[52:55], v[132:135], v[164:167], v[52:55]
    ds_read_b64_tr_b16 v[184:185], v13 offset:4096
    ds_read_b64_tr_b16 v[186:187], v13 offset:4608
    v_mfma_f32_16x16x32_bf16 v[56:59], v[136:139], v[152:155], v[56:59]
    ds_read_b64_tr_b16 v[188:189], v14 offset:4096
    ds_read_b64_tr_b16 v[190:191], v14 offset:4608
    v_mfma_f32_16x16x32_bf16 v[60:63], v[136:139], v[156:159], v[60:63]
    ds_read_b64_tr_b16 v[192:193], v15 offset:4096
    ds_read_b64_tr_b16 v[194:195], v15 offset:4608
    v_mfma_f32_16x16x32_bf16 v[64:67], v[136:139], v[160:163], v[64:67]
    ds_read_b128 v[212:215], v19 offset:0
    v_mfma_f32_16x16x32_bf16 v[68:71], v[136:139], v[164:167], v[68:71]
    s_add_u32 s50, s50, 1
    s_cmp_eq_u32 s50, 3
    v_mfma_f32_16x16x32_bf16 v[72:75], v[140:143], v[152:155], v[72:75]
    s_cselect_b32 s49, s29, s51
    s_cselect_b32 s50, 0, s50
    v_mfma_f32_16x16x32_bf16 v[76:79], v[140:143], v[156:159], v[76:79]
    v_add_u32 v10, s49, v10
    v_add_u32 v11, s49, v11
    v_mfma_f32_16x16x32_bf16 v[80:83], v[140:143], v[160:163], v[80:83]
    v_add_u32 v12, s49, v12
    v_add_u32 v13, s49, v13
    v_mfma_f32_16x16x32_bf16 v[84:87], v[140:143], v[164:167], v[84:87]
    v_add_u32 v14, s49, v14
    v_add_u32 v15, s49, v15
    v_mfma_f32_16x16x32_bf16 v[88:91], v[144:147], v[152:155], v[88:91]
    v_add_u32 v16, s49, v16
    v_add_u32 v17, s49, v17
    v_mfma_f32_16x16x32_bf16 v[92:95], v[144:147], v[156:159], v[92:95]
    v_add_u32 v18, s49, v18
    v_add_u32 v19, s49, v19
    v_mfma_f32_16x16x32_bf16 v[96:99], v[144:147], v[160:163], v[96:99]
    s_sub_u32 s48, s48, 1
    s_cmp_lg_u32 s48, 0
    v_mfma_f32_16x16x32_bf16 v[100:103], v[144:147], v[164:167], v[100:103]
    v_mfma_f32_16x16x32_bf16 v[104:107], v[148:151], v[152:155], v[104:107]
    v_mfma_f32_16x16x32_bf16 v[108:111], v[148:151], v[156:159], v[108:111]
    v_mfma_f32_16x16x32_bf16 v[112:115], v[148:151], v[160:163], v[112:115]
    v_mfma_f32_16x16x32_bf16 v[116:119], v[148:151], v[164:167], v[116:119]
    v_mfma_f32_16x16x32_bf16 v[120:123], v[144:147], v[168:171], v[120:123]
    v_mfma_f32_16x16x32_bf16 v[124:127], v[148:151], v[168:171], v[124:127]
    s_waitcnt lgkmcnt(0)
    s_cbranch_scc1 g1_cloop
    v_mfma_f32_16x16x32_bf16 v[24:27], v[172:175], v[196:199], v[24:27]
    v_mfma_f32_16x16x32_bf16 v[28:31], v[172:175], v[200:203], v[28:31]
    v_mfma_f32_16x16x32_bf16 v[32:35], v[172:175], v[204:207], v[32:35]
    v_mfma_f32_16x16x32_bf16 v[36:39], v[172:175], v[208:211], v[36:39]
    v_mfma_f32_16x16x32_bf16 v[40:43], v[176:179], v[196:199], v[40:43]
    v_mfma_f32_16x16x32_bf16 v[44:47], v[176:179], v[200:203], v[44:47]
    v_mfma_f32_16x16x32_bf16 v[48:51], v[176:179], v[204:207], v[48:51]
    v_mfma_f32_16x16x32_bf16 v[52:55], v[176:179], v[208:211], v[52:55]
    v_mfma_f32_16x16x32_bf16 v[56:59], v[180:183], v[196:199], v[56:59]
    v_mfma_f32_16x16x32_bf16 v[60:63], v[180:183], v[200:203], v[60:63]
    v_mfma_f32_16x16x32_bf16 v[64:67], v[180:183], v[204:207], v[64:67]
    v_mfma_f32_16x16x32_bf16 v[68:71], v[180:183], v[208:211], v[68:71]
    v_mfma_f32_16x16x32_bf16 v[72:75], v[184:187], v[196:199], v[72:75]
    v_mfma_f32_16x16x32_bf16 v[76:79], v[184:187], v[200:203], v[76:79]
    v_mfma_f32_16x16x32_bf16 v[80:83], v[184:187], v[204:207], v[80:83]
    v_mfma_f32_16x16x32_bf16 v[84:87], v[184:187], v[208:211], v[84:87]
    v_mfma_f32_16x16x32_bf16 v[88:91], v[188:191], v[196:199], v[88:91]
    v_mfma_f32_16x16x32_bf16 v[92:95], v[188:191], v[200:203], v[92:95]
    v_mfma_f32_16x16x32_bf16 v[96:99], v[188:191], v[204:207], v[96:99]
    v_mfma_f32_16x16x32_bf16 v[100:103], v[188:191], v[208:211], v[100:103]
    v_mfma_f32_16x16x32_bf16 v[104:107], v[192:195], v[196:199], v[104:107]
    v_mfma_f32_16x16x32_bf16 v[108:111], v[192:195], v[200:203], v[108:111]
    v_mfma_f32_16x16x32_bf16 v[112:115], v[192:195], v[204:207], v[112:115]
    v_mfma_f32_16x16x32_bf16 v[116:119], v[192:195], v[208:211], v[116:119]
    v_mfma_f32_16x16x32_bf16 v[120:123], v[188:191], v[212:215], v[120:123]
    v_mfma_f32_16x16x32_bf16 v[124:127], v[192:195], v[212:215], v[124:127]
    s_barrier
    v_lshlrev_b32 v3, 3, v8
    v_add_u32 v4, 129024, v3
    s_mul_i32 s40, s45, 512
    s_add_u32 s40, s40, 129152
    v_add_u32 v3, s40, v3
    ds_read_b64 v[128:129], v3 offset:0
    ds_read_b64 v[130:131], v3 offset:128
    ds_read_b64 v[132:133], v3 offset:256
    ds_read_b64 v[134:135], v3 offset:384
    ds_read_b64 v[136:137], v4
    s_lshl_b32 s40, s44, 7
    s_add_u32 s40, s40, 130304
    v_lshl_add_u32 v3, v5, 4, s40
    s_mov_b32 s43, 0
    v_add_u32 v4, s43, v3
    ds_read_b128 v[140:143], v4 offset:0
    ds_read_b128 v[144:147], v4 offset:64
    s_xor_b32 s43, s45, 1
    s_add_u32 s43, s43, 1
    s_mul_i32 s43, s43, 256
    v_add_u32 v4, s43, v3
    ds_read_b128 v[148:151], v4 offset:0
    ds_read_b128 v[152:155], v4 offset:64
    s_xor_b32 s43, s45, 0
    s_add_u32 s43, s43, 1
    s_mul_i32 s43, s43, 256
    v_add_u32 v4, s43, v3
    ds_read_b128 v[156:159], v4 offset:0
    ds_read_b128 v[160:163], v4 offset:64
    v_and_b32 v3, 1, v5
    v_lshlrev_b32 v3, 1, v3
    v_lshrrev_b32 v4, 1, v5
    v_add_u32 v3, v3, v4
    s_lshl_b32 s40, s44, 2
    v_add_u32 v3, s40, v3
    v_lshrrev_b32 v4, 1, v8
    v_xor_b32 v3, v3, v4
    v_lshlrev_b32 v3, 4, v3
    v_lshl_add_u32 v3, v8, 7, v3
    s_mul_i32 s42, s45, 8192
    s_add_u32 s42, s42, 45056
    s_mov_b32 s43, 0
    s_add_u32 s40, s42, s43
    v_add_u32 v10, s40, v3
    s_xor_b32 s43, s45, 1
    s_add_u32 s43, s43, 1
    s_mul_i32 s43, s43, 18432
    s_add_u32 s40, s42, s43
    v_add_u32 v11, s40, v3
    s_xor_b32 s43, s45, 0
    s_add_u32 s43, s43, 1
    s_mul_i32 s43, s43, 18432
    s_add_u32 s40, s42, s43
    v_add_u32 v12, s40, v3
    s_add_u32 s40, s43, 43008
    v_add_u32 v13, s40, v3
    s_waitcnt lgkmcnt(0)
    v_pk_mul_f32 v[164:165], v[140:141], v[128:129] op_sel:[0,1] op_sel_hi:[1,1]
    v_pk_mul_f32 v[166:167], v[142:143], v[128:129] op_sel:[0,1] op_sel_hi:[1,1]
    v_pk_mul_f32 v[168:169], v[144:145], v[128:129] op_sel:[0,1] op_sel_hi:[1,1]
    v_pk_mul_f32 v[170:171], v[146:147], v[128:129] op_sel:[0,1] op_sel_hi:[1,1]
    v_pk_fma_f32 v[24:25], v[24:25], v[128:129], v[164:165] op_sel:[0,0,0] op_sel_hi:[1,0,1]
    v_pk_fma_f32 v[26:27], v[26:27], v[128:129], v[166:167] op_sel:[0,0,0] op_sel_hi:[1,0,1]
    v_pk_fma_f32 v[40:41], v[40:41], v[128:129], v[168:169] op_sel:[0,0,0] op_sel_hi:[1,0,1]
    v_pk_fma_f32 v[42:43], v[42:43], v[128:129], v[170:171] op_sel:[0,0,0] op_sel_hi:[1,0,1]
    v_cvt_pk_bf16_f32 v172, v24, v25
    v_cvt_pk_bf16_f32 v173, v26, v27
    v_cvt_pk_bf16_f32 v174, v40, v41
    v_cvt_pk_bf16_f32 v175, v42, v43
    s_nop 1
    v_permlane16_swap_b32 v172, v174
    v_permlane16_swap_b32 v173, v175
    ds_write_b128 v10, v[172:175] offset:0
    v_pk_mul_f32 v[164:165], v[140:141], v[130:131] op_sel:[0,1] op_sel_hi:[1,1]
    v_pk_mul_f32 v[166:167], v[142:143], v[130:131] op_sel:[0,1] op_sel_hi:[1,1]
    v_pk_mul_f32 v[168:169], v[144:145], v[130:131] op_sel:[0,1] op_sel_hi:[1,1]
    v_pk_mul_f32 v[170:171], v[146:147], v[130:131] op_sel:[0,1] op_sel_hi:[1,1]
    v_pk_fma_f32 v[28:29], v[28:29], v[130:131], v[164:165] op_sel:[0,0,0] op_sel_hi:[1,0,1]
    v_pk_fma_f32 v[30:31], v[30:31], v[130:131], v[166:167] op_sel:[0,0,0] op_sel_hi:[1,0,1]
    v_pk_fma_f32 v[44:45], v[44:45], v[130:131], v[168:169] op_sel:[0,0,0] op_sel_hi:[1,0,1]
    v_pk_fma_f32 v[46:47], v[46:47], v[130:131], v[170:171] op_sel:[0,0,0] op_sel_hi:[1,0,1]
    v_cvt_pk_bf16_f32 v176, v28, v29
    v_cvt_pk_bf16_f32 v177, v30, v31
    v_cvt_pk_bf16_f32 v178, v44, v45
    v_cvt_pk_bf16_f32 v179, v46, v47
    s_nop 1
    v_permlane16_swap_b32 v176, v178
    v_permlane16_swap_b32 v177, v179
    ds_write_b128 v10, v[176:179] offset:2048
    v_pk_mul_f32 v[164:165], v[140:141], v[132:133] op_sel:[0,1] op_sel_hi:[1,1]
    v_pk_mul_f32 v[166:167], v[142:143], v[132:133] op_sel:[0,1] op_sel_hi:[1,1]
    v_pk_mul_f32 v[168:169], v[144:145], v[132:133] op_sel:[0,1] op_sel_hi:[1,1]
    v_pk_mul_f32 v[170:171], v[146:147], v[132:133] op_sel:[0,1] op_sel_hi:[1,1]
    v_pk_fma_f32 v[32:33], v[32:33], v[132:133], v[164:165] op_sel:[0,0,0] op_sel_hi:[1,0,1]
    v_pk_fma_f32 v[34:35], v[34:35], v[132:133], v[166:167] op_sel:[0,0,0] op_sel_hi:[1,0,1]
    v_pk_fma_f32 v[48:49], v[48:49], v[132:133], v[168:169] op_sel:[0,0,0] op_sel_hi:[1,0,1]
    v_pk_fma_f32 v[50:51], v[50:51], v[132:133], v[170:171] op_sel:[0,0,0] op_sel_hi:[1,0,1]
    v_cvt_pk_bf16_f32 v180, v32, v33
    v_cvt_pk_bf16_f32 v181, v34, v35
    v_cvt_pk_bf16_f32 v182, v48, v49
    v_cvt_pk_bf16_f32 v183, v50, v51
    s_nop 1
    v_permlane16_swap_b32 v180, v182
    v_permlane16_swap_b32 v181, v183
    ds_write_b128 v10, v[180:183] offset:4096
    v_pk_mul_f32 v[164:165], v[140:141], v[134:135] op_sel:[0,1] op_sel_hi:[1,1]
    v_pk_mul_f32 v[166:167], v[142:143], v[134:135] op_sel:[0,1] op_sel_hi:[1,1]
    v_pk_mul_f32 v[168:169], v[144:145], v[134:135] op_sel:[0,1] op_sel_hi:[1,1]
    v_pk_mul_f32 v[170:171], v[146:147], v[134:135] op_sel:[0,1] op_sel_hi:[1,1]
    v_pk_fma_f32 v[36:37], v[36:37], v[134:135], v[164:165] op_sel:[0,0,0] op_sel_hi:[1,0,1]
    v_pk_fma_f32 v[38:39], v[38:39], v[134:135], v[166:167] op_sel:[0,0,0] op_sel_hi:[1,0,1]
    v_pk_fma_f32 v[52:53], v[52:53], v[134:135], v[168:169] op_sel:[0,0,0] op_sel_hi:[1,0,1]
    v_pk_fma_f32 v[54:55], v[54:55], v[134:135], v[170:171] op_sel:[0,0,0] op_sel_hi:[1,0,1]
    v_cvt_pk_bf16_f32 v184, v36, v37
    v_cvt_pk_bf16_f32 v185, v38, v39
    v_cvt_pk_bf16_f32 v186, v52, v53
    v_cvt_pk_bf16_f32 v187, v54, v55
    s_nop 1
    v_permlane16_swap_b32 v184, v186
    v_permlane16_swap_b32 v185, v187
    ds_write_b128 v10, v[184:187] offset:6144
    v_pk_mul_f32 v[164:165], v[148:149], v[128:129] op_sel:[0,1] op_sel_hi:[1,1]
    v_pk_mul_f32 v[166:167], v[150:151], v[128:129] op_sel:[0,1] op_sel_hi:[1,1]
    v_pk_mul_f32 v[168:169], v[152:153], v[128:129] op_sel:[0,1] op_sel_hi:[1,1]
    v_pk_mul_f32 v[170:171], v[154:155], v[128:129] op_sel:[0,1] op_sel_hi:[1,1]
    v_pk_fma_f32 v[56:57], v[56:57], v[128:129], v[164:165] op_sel:[0,0,0] op_sel_hi:[1,0,1]
    v_pk_fma_f32 v[58:59], v[58:59], v[128:129], v[166:167] op_sel:[0,0,0] op_sel_hi:[1,0,1]
    v_pk_fma_f32 v[72:73], v[72:73], v[128:129], v[168:169] op_sel:[0,0,0] op_sel_hi:[1,0,1]
    v_pk_fma_f32 v[74:75], v[74:75], v[128:129], v[170:171] op_sel:[0,0,0] op_sel_hi:[1,0,1]
    v_cvt_pk_bf16_f32 v172, v56, v57
    v_cvt_pk_bf16_f32 v173, v58, v59
    v_cvt_pk_bf16_f32 v174, v72, v73
    v_cvt_pk_bf16_f32 v175, v74, v75
    s_nop 1
    v_permlane16_swap_b32 v172, v174
    v_permlane16_swap_b32 v173, v175
    ds_write_b128 v11, v[172:175] offset:0
    v_pk_mul_f32 v[164:165], v[148:149], v[130:131] op_sel:[0,1] op_sel_hi:[1,1]
    v_pk_mul_f32 v[166:167], v[150:151], v[130:131] op_sel:[0,1] op_sel_hi:[1,1]
    v_pk_mul_f32 v[168:169], v[152:153], v[130:131] op_sel:[0,1] op_sel_hi:[1,1]
    v_pk_mul_f32 v[170:171], v[154:155], v[130:131] op_sel:[0,1] op_sel_hi:[1,1]
    v_pk_fma_f32 v[60:61], v[60:61], v[130:131], v[164:165] op_sel:[0,0,0] op_sel_hi:[1,0,1]
    v_pk_fma_f32 v[62:63], v[62:63], v[130:131], v[166:167] op_sel:[0,0,0] op_sel_hi:[1,0,1]
    v_pk_fma_f32 v[76:77], v[76:77], v[130:131], v[168:169] op_sel:[0,0,0] op_sel_hi:[1,0,1]
    v_pk_fma_f32 v[78:79], v[78:79], v[130:131], v[170:171] op_sel:[0,0,0] op_sel_hi:[1,0,1]
    v_cvt_pk_bf16_f32 v176, v60, v61
    v_cvt_pk_bf16_f32 v177, v62, v63
    v_cvt_pk_bf16_f32 v178, v76, v77
    v_cvt_pk_bf16_f32 v179, v78, v79
    s_nop 1
    v_permlane16_swap_b32 v176, v178
    v_permlane16_swap_b32 v177, v179
    ds_write_b128 v11, v[176:179] offset:2048
    v_pk_mul_f32 v[164:165], v[148:149], v[132:133] op_sel:[0,1] op_sel_hi:[1,1]
    v_pk_mul_f32 v[166:167], v[150:151], v[132:133] op_sel:[0,1] op_sel_hi:[1,1]
    v_pk_mul_f32 v[168:169], v[152:153], v[132:133] op_sel:[0,1] op_sel_hi:[1,1]
    v_pk_mul_f32 v[170:171], v[154:155], v[132:133] op_sel:[0,1] op_sel_hi:[1,1]
    v_pk_fma_f32 v[64:65], v[64:65], v[132:133], v[164:165] op_sel:[0,0,0] op_sel_hi:[1,0,1]
    v_pk_fma_f32 v[66:67], v[66:67], v[132:133], v[166:167] op_sel:[0,0,0] op_sel_hi:[1,0,1]
    v_pk_fma_f32 v[80:81], v[80:81], v[132:133], v[168:169] op_sel:[0,0,0] op_sel_hi:[1,0,1]
    v_pk_fma_f32 v[82:83], v[82:83], v[132:133], v[170:171] op_sel:[0,0,0] op_sel_hi:[1,0,1]
    v_cvt_pk_bf16_f32 v180, v64, v65
    v_cvt_pk_bf16_f32 v181, v66, v67
    v_cvt_pk_bf16_f32 v182, v80, v81
    v_cvt_pk_bf16_f32 v183, v82, v83
    s_nop 1
    v_permlane16_swap_b32 v180, v182
    v_permlane16_swap_b32 v181, v183
    ds_write_b128 v11, v[180:183] offset:4096
    v_pk_mul_f32 v[164:165], v[148:149], v[134:135] op_sel:[0,1] op_sel_hi:[1,1]
    v_pk_mul_f32 v[166:167], v[150:151], v[134:135] op_sel:[0,1] op_sel_hi:[1,1]
    v_pk_mul_f32 v[168:169], v[152:153], v[134:135] op_sel:[0,1] op_sel_hi:[1,1]
    v_pk_mul_f32 v[170:171], v[154:155], v[134:135] op_sel:[0,1] op_sel_hi:[1,1]
    v_pk_fma_f32 v[68:69], v[68:69], v[134:135], v[164:165] op_sel:[0,0,0] op_sel_hi:[1,0,1]
    v_pk_fma_f32 v[70:71], v[70:71], v[134:135], v[166:167] op_sel:[0,0,0] op_sel_hi:[1,0,1]
    v_pk_fma_f32 v[84:85], v[84:85], v[134:135], v[168:169] op_sel:[0,0,0] op_sel_hi:[1,0,1]
    v_pk_fma_f32 v[86:87], v[86:87], v[134:135], v[170:171] op_sel:[0,0,0] op_sel_hi:[1,0,1]
    v_cvt_pk_bf16_f32 v184, v68, v69
    v_cvt_pk_bf16_f32 v185, v70, v71
    v_cvt_pk_bf16_f32 v186, v84, v85
    v_cvt_pk_bf16_f32 v187, v86, v87
    s_nop 1
    v_permlane16_swap_b32 v184, v186
    v_permlane16_swap_b32 v185, v187
    ds_write_b128 v11, v[184:187] offset:6144
    v_pk_mul_f32 v[164:165], v[156:157], v[128:129] op_sel:[0,1] op_sel_hi:[1,1]
    v_pk_mul_f32 v[166:167], v[158:159], v[128:129] op_sel:[0,1] op_sel_hi:[1,1]
    v_pk_mul_f32 v[168:169], v[160:161], v[128:129] op_sel:[0,1] op_sel_hi:[1,1]
    v_pk_mul_f32 v[170:171], v[162:163], v[128:129] op_sel:[0,1] op_sel_hi:[1,1]
    v_pk_fma_f32 v[88:89], v[88:89], v[128:129], v[164:165] op_sel:[0,0,0] op_sel_hi:[1,0,1]
    v_pk_fma_f32 v[90:91], v[90:91], v[128:129], v[166:167] op_sel:[0,0,0] op_sel_hi:[1,0,1]
    v_pk_fma_f32 v[104:105], v[104:105], v[128:129], v[168:169] op_sel:[0,0,0] op_sel_hi:[1,0,1]
    v_pk_fma_f32 v[106:107], v[106:107], v[128:129], v[170:171] op_sel:[0,0,0] op_sel_hi:[1,0,1]
    v_cvt_pk_bf16_f32 v172, v88, v89
    v_cvt_pk_bf16_f32 v173, v90, v91
    v_cvt_pk_bf16_f32 v174, v104, v105
    v_cvt_pk_bf16_f32 v175, v106, v107
    s_nop 1
    v_permlane16_swap_b32 v172, v174
    v_permlane16_swap_b32 v173, v175
    ds_write_b128 v12, v[172:175] offset:0
    v_pk_mul_f32 v[164:165], v[156:157], v[130:131] op_sel:[0,1] op_sel_hi:[1,1]
    v_pk_mul_f32 v[166:167], v[158:159], v[130:131] op_sel:[0,1] op_sel_hi:[1,1]
    v_pk_mul_f32 v[168:169], v[160:161], v[130:131] op_sel:[0,1] op_sel_hi:[1,1]
    v_pk_mul_f32 v[170:171], v[162:163], v[130:131] op_sel:[0,1] op_sel_hi:[1,1]
    v_pk_fma_f32 v[92:93], v[92:93], v[130:131], v[164:165] op_sel:[0,0,0] op_sel_hi:[1,0,1]
    v_pk_fma_f32 v[94:95], v[94:95], v[130:131], v[166:167] op_sel:[0,0,0] op_sel_hi:[1,0,1]
    v_pk_fma_f32 v[108:109], v[108:109], v[130:131], v[168:169] op_sel:[0,0,0] op_sel_hi:[1,0,1]
    v_pk_fma_f32 v[110:111], v[110:111], v[130:131], v[170:171] op_sel:[0,0,0] op_sel_hi:[1,0,1]
    v_cvt_pk_bf16_f32 v176, v92, v93
    v_cvt_pk_bf16_f32 v177, v94, v95
    v_cvt_pk_bf16_f32 v178, v108, v109
    v_cvt_pk_bf16_f32 v179, v110, v111
    s_nop 1
    v_permlane16_swap_b32 v176, v178
    v_permlane16_swap_b32 v177, v179
    ds_write_b128 v12, v[176:179] offset:2048
    v_pk_mul_f32 v[164:165], v[156:157], v[132:133] op_sel:[0,1] op_sel_hi:[1,1]
    v_pk_mul_f32 v[166:167], v[158:159], v[132:133] op_sel:[0,1] op_sel_hi:[1,1]
    v_pk_mul_f32 v[168:169], v[160:161], v[132:133] op_sel:[0,1] op_sel_hi:[1,1]
    v_pk_mul_f32 v[170:171], v[162:163], v[132:133] op_sel:[0,1] op_sel_hi:[1,1]
    v_pk_fma_f32 v[96:97], v[96:97], v[132:133], v[164:165] op_sel:[0,0,0] op_sel_hi:[1,0,1]
    v_pk_fma_f32 v[98:99], v[98:99], v[132:133], v[166:167] op_sel:[0,0,0] op_sel_hi:[1,0,1]
    v_pk_fma_f32 v[112:113], v[112:113], v[132:133], v[168:169] op_sel:[0,0,0] op_sel_hi:[1,0,1]
    v_pk_fma_f32 v[114:115], v[114:115], v[132:133], v[170:171] op_sel:[0,0,0] op_sel_hi:[1,0,1]
    v_cvt_pk_bf16_f32 v180, v96, v97
    v_cvt_pk_bf16_f32 v181, v98, v99
    v_cvt_pk_bf16_f32 v182, v112, v113
    v_cvt_pk_bf16_f32 v183, v114, v115
    s_nop 1
    v_permlane16_swap_b32 v180, v182
    v_permlane16_swap_b32 v181, v183
    ds_write_b128 v12, v[180:183] offset:4096
    v_pk_mul_f32 v[164:165], v[156:157], v[134:135] op_sel:[0,1] op_sel_hi:[1,1]
    v_pk_mul_f32 v[166:167], v[158:159], v[134:135] op_sel:[0,1] op_sel_hi:[1,1]
    v_pk_mul_f32 v[168:169], v[160:161], v[134:135] op_sel:[0,1] op_sel_hi:[1,1]
    v_pk_mul_f32 v[170:171], v[162:163], v[134:135] op_sel:[0,1] op_sel_hi:[1,1]
    v_pk_fma_f32 v[100:101], v[100:101], v[134:135], v[164:165] op_sel:[0,0,0] op_sel_hi:[1,0,1]
    v_pk_fma_f32 v[102:103], v[102:103], v[134:135], v[166:167] op_sel:[0,0,0] op_sel_hi:[1,0,1]
    v_pk_fma_f32 v[116:117], v[116:117], v[134:135], v[168:169] op_sel:[0,0,0] op_sel_hi:[1,0,1]
    v_pk_fma_f32 v[118:119], v[118:119], v[134:135], v[170:171] op_sel:[0,0,0] op_sel_hi:[1,0,1]
    v_cvt_pk_bf16_f32 v184, v100, v101
    v_cvt_pk_bf16_f32 v185, v102, v103
    v_cvt_pk_bf16_f32 v186, v116, v117
    v_cvt_pk_bf16_f32 v187, v118, v119
    s_nop 1
    v_permlane16_swap_b32 v184, v186
    v_permlane16_swap_b32 v185, v187
    ds_write_b128 v12, v[184:187] offset:6144
    v_pk_mul_f32 v[164:165], v[156:157], v[136:137] op_sel:[0,1] op_sel_hi:[1,1]
    v_pk_mul_f32 v[166:167], v[158:159], v[136:137] op_sel:[0,1] op_sel_hi:[1,1]
    v_pk_mul_f32 v[168:169], v[160:161], v[136:137] op_sel:[0,1] op_sel_hi:[1,1]
    v_pk_mul_f32 v[170:171], v[162:163], v[136:137] op_sel:[0,1] op_sel_hi:[1,1]
    v_pk_fma_f32 v[120:121], v[120:121], v[136:137], v[164:165] op_sel:[0,0,0] op_sel_hi:[1,0,1]
    v_pk_fma_f32 v[122:123], v[122:123], v[136:137], v[166:167] op_sel:[0,0,0] op_sel_hi:[1,0,1]
    v_pk_fma_f32 v[124:125], v[124:125], v[136:137], v[168:169] op_sel:[0,0,0] op_sel_hi:[1,0,1]
    v_pk_fma_f32 v[126:127], v[126:127], v[136:137], v[170:171] op_sel:[0,0,0] op_sel_hi:[1,0,1]
    v_cvt_pk_bf16_f32 v172, v120, v121
    v_cvt_pk_bf16_f32 v173, v122, v123
    v_cvt_pk_bf16_f32 v174, v124, v125
    v_cvt_pk_bf16_f32 v175, v126, v127
    s_nop 1
    v_permlane16_swap_b32 v172, v174
    v_permlane16_swap_b32 v173, v175
    ds_write_b128 v13, v[172:175]
    s_waitcnt lgkmcnt(0)
g1_attn:
    s_add_u32 s16, s4, 0x400000
    s_addc_u32 s17, s5, 0
    s_mov_b32 s18, 0x400000
    s_mov_b32 s19, 0x20000
    s_and_b32 s44, s28, 1
    s_lshr_b32 s45, s28, 1
    s_lshl_b32 s40, s44, 2
    v_add_u32 v3, s40, v5
    v_and_b32 v4, 7, v8
    v_xor_b32 v3, v3, v4
    v_lshlrev_b32 v3, 4, v3
    v_lshl_add_u32 v3, v8, 8, v3
    s_mul_i32 s41, s45, 4096
    s_add_u32 s41, s41, 43008
    v_add_u32 v10, s41, v3
    v_lshl_add_u32 v3, v5, 2, v6
    v_and_b32 v4, 7, v3
    v_add_u32 v12, s40, v7
    v_xor_b32 v4, v4, v12
    v_lshlrev_b32 v4, 4, v4
    v_lshl_add_u32 v3, v3, 8, v4
    s_add_u32 s41, s41, 36864
    v_add_u32 v11, s41, v3
    v_and_b32 v3, 7, v8
    v_add_u32 v4, 1, v3
    s_or_b32 s40, s25, s45
    s_cmp_eq_u32 s40, 0
    s_cselect_b32 s40, 8, 0
    v_cmp_gt_u32 vcc, 8, v8
    v_mov_b32 v16, s40
    s_mov_b64 s[56:57], vcc
    v_cndmask_b32 v16, 0, v16, vcc
    v_max_u32 v4, v4, v16
    v_add_u32 v3, 8, v3
    v_sub_u32 v3, v3, v4
    v_lshlrev_b32 v16, 2, v5
    v_sub_u32 v16, v16, v4
    v_mov_b32 v17, 0xf149f2ca
    v_add_u32 v18, 0, v16
    v_cmp_ge_u32 vcc, v3, v18
    s_nop 1
    v_cndmask_b32 v12, v17, 0, vcc
    v_add_u32 v18, 1, v16
    v_cmp_ge_u32 vcc, v3, v18
    s_nop 1
    v_cndmask_b32 v13, v17, 0, vcc
    v_add_u32 v18, 2, v16
    v_cmp_ge_u32 vcc, v3, v18
    s_nop 1
    v_cndmask_b32 v14, v17, 0, vcc
    v_add_u32 v18, 3, v16
    v_cmp_ge_u32 vcc, v3, v18
    s_nop 1
    v_cndmask_b32 v15, v17, 0, vcc
    s_lshl_b32 s40, s25, 7
    s_lshl_b32 s41, s45, 5
    s_add_u32 s40, s40, s41
    s_lshl_b32 s40, s40, 11
    s_lshl_b32 s41, s24, 7
    s_add_u32 s40, s40, s41
    s_lshl_b32 s41, s44, 6
    s_add_u32 s40, s40, s41
    v_lshlrev_b32 v9, 12, v8
    v_lshl_add_u32 v9, v5, 4, v9
    v_add_u32 v9, s40, v9
    s_mov_b32 s58, 0x3e3504f3
    s_mov_b32 s59, 0x3fb8aa3b
    s_barrier
    ds_read_b128 v[24:27], v10 offset:2048
    ds_read_b128 v[28:31], v10 offset:18432
    ds_read_b128 v[32:35], v10 offset:20480
    ds_read_b128 v[72:75], v10 offset:2176
    ds_read_b128 v[76:79], v10 offset:18560
    ds_read_b128 v[80:83], v10 offset:20608
    ds_read_b64_tr_b16 v[36:37], v11 offset:0
    ds_read_b64_tr_b16 v[38:39], v11 offset:2048
    ds_read_b64_tr_b16 v[40:41], v11 offset:8
    ds_read_b64_tr_b16 v[42:43], v11 offset:2056
    ds_read_b64_tr_b16 v[84:85], v11 offset:128
    ds_read_b64_tr_b16 v[86:87], v11 offset:2176
    ds_read_b64_tr_b16 v[88:89], v11 offset:136
    ds_read_b64_tr_b16 v[90:91], v11 offset:2184
    s_waitcnt lgkmcnt(8)
    v_mfma_f32_16x16x32_bf16 v[44:47], v[28:31], v[24:27], 0
    v_mfma_f32_16x16x32_bf16 v[48:51], v[32:35], v[24:27], 0
    v_mfma_f32_16x16x32_bf16 v[92:95], v[76:79], v[72:75], 0
    v_mfma_f32_16x16x32_bf16 v[96:99], v[80:83], v[72:75], 0
    s_nop 7
    v_cndmask_b32 v44, v48, v44, s[56:57]
    v_cndmask_b32 v45, v49, v45, s[56:57]
    v_cndmask_b32 v46, v50, v46, s[56:57]
    v_cndmask_b32 v47, v51, v47, s[56:57]
    v_cndmask_b32 v92, v96, v92, s[56:57]
    v_cndmask_b32 v93, v97, v93, s[56:57]
    v_cndmask_b32 v94, v98, v94, s[56:57]
    v_cndmask_b32 v95, v99, v95, s[56:57]
    v_cvt_pk_bf16_f32 v48, v44, v45
    v_cvt_pk_bf16_f32 v49, v46, v47
    v_cvt_pk_bf16_f32 v96, v92, v93
    v_cvt_pk_bf16_f32 v97, v94, v95
    v_lshlrev_b32 v44, 16, v48
    v_and_b32 v45, 0xffff0000, v48
    v_lshlrev_b32 v46, 16, v49
    v_and_b32 v47, 0xffff0000, v49
    v_lshlrev_b32 v92, 16, v96
    v_and_b32 v93, 0xffff0000, v96
    v_lshlrev_b32 v94, 16, v97
    v_and_b32 v95, 0xffff0000, v97
    v_mul_f32 v44, s58, v44
    v_mul_f32 v45, s58, v45
    v_mul_f32 v46, s58, v46
    v_mul_f32 v47, s58, v47
    v_mul_f32 v92, s58, v92
    v_mul_f32 v93, s58, v93
    v_mul_f32 v94, s58, v94
    v_mul_f32 v95, s58, v95
    v_cvt_pk_bf16_f32 v48, v44, v45
    v_cvt_pk_bf16_f32 v49, v46, v47
    v_cvt_pk_bf16_f32 v96, v92, v93
    v_cvt_pk_bf16_f32 v97, v94, v95
    v_lshlrev_b32 v44, 16, v48
    v_and_b32 v45, 0xffff0000, v48
    v_lshlrev_b32 v46, 16, v49
    v_and_b32 v47, 0xffff0000, v49
    v_lshlrev_b32 v92, 16, v96
    v_and_b32 v93, 0xffff0000, v96
    v_lshlrev_b32 v94, 16, v97
    v_and_b32 v95, 0xffff0000, v97
    v_fma_f32 v44, v44, s59, v12
    v_fma_f32 v45, v45, s59, v13
    v_fma_f32 v46, v46, s59, v14
    v_fma_f32 v47, v47, s59, v15
    v_fma_f32 v92, v92, s59, v12
    v_fma_f32 v93, v93, s59, v13
    v_fma_f32 v94, v94, s59, v14
    v_fma_f32 v95, v95, s59, v15
    v_max3_f32 v48, v44, v45, v46
    v_max3_f32 v96, v92, v93, v94
    v_max_f32 v48, v48, v47
    v_max_f32 v96, v96, v95
    v_mov_b32 v49, v48
    v_mov_b32 v97, v96
    s_nop 1
    v_permlane16_swap_b32 v48, v49
    v_permlane16_swap_b32 v96, v97
    s_nop 0
    v_max_f32 v48, v48, v49
    v_max_f32 v96, v96, v97
    v_mov_b32 v49, v48
    v_mov_b32 v97, v96
    s_nop 1
    v_permlane32_swap_b32 v48, v49
    v_permlane32_swap_b32 v96, v97
    s_nop 0
    v_max_f32 v48, v48, v49
    v_max_f32 v96, v96, v97
    v_sub_f32 v44, v44, v48
    v_sub_f32 v45, v45, v48
    v_sub_f32 v46, v46, v48
    v_sub_f32 v47, v47, v48
    v_sub_f32 v92, v92, v96
    v_sub_f32 v93, v93, v96
    v_sub_f32 v94, v94, v96
    v_sub_f32 v95, v95, v96
    v_exp_f32 v44, v44
    v_exp_f32 v45, v45
    v_exp_f32 v46, v46
    v_exp_f32 v47, v47
    v_exp_f32 v92, v92
    v_exp_f32 v93, v93
    v_exp_f32 v94, v94
    v_exp_f32 v95, v95
    v_add_f32 v48, v44, v45
    v_add_f32 v49, v46, v47
    v_add_f32 v96, v92, v93
    v_add_f32 v97, v94, v95
    v_add_f32 v48, v48, v49
    v_add_f32 v96, v96, v97
    v_mov_b32 v49, v48
    v_mov_b32 v97, v96
    s_nop 1
    v_permlane16_swap_b32 v48, v49
    v_permlane16_swap_b32 v96, v97
    s_nop 0
    v_add_f32 v48, v48, v49
    v_add_f32 v96, v96, v97
    v_mov_b32 v49, v48
    v_mov_b32 v97, v96
    s_nop 1
    v_permlane32_swap_b32 v48, v49
    v_permlane32_swap_b32 v96, v97
    s_nop 0
    v_add_f32 v48, v48, v49
    v_add_f32 v96, v96, v97
    v_rcp_f32 v48, v48
    v_rcp_f32 v96, v96
    s_nop 0
    v_mul_f32 v44, v44, v48
    v_mul_f32 v45, v45, v48
    v_mul_f32 v46, v46, v48
    v_mul_f32 v47, v47, v48
    v_mul_f32 v92, v92, v96
    v_mul_f32 v93, v93, v96
    v_mul_f32 v94, v94, v96
    v_mul_f32 v95, v95, v96
    v_cvt_pk_bf16_f32 v48, v44, v45
    v_cvt_pk_bf16_f32 v49, v46, v47
    v_cvt_pk_bf16_f32 v96, v92, v93
    v_cvt_pk_bf16_f32 v97, v94, v95
    v_cndmask_b32 v52, 0, v48, s[56:57]
    v_cndmask_b32 v53, 0, v49, s[56:57]
    v_cndmask_b32 v54, v48, 0, s[56:57]
    v_cndmask_b32 v55, v49, 0, s[56:57]
    v_cndmask_b32 v100, 0, v96, s[56:57]
    v_cndmask_b32 v101, 0, v97, s[56:57]
    v_cndmask_b32 v102, v96, 0, s[56:57]
    v_cndmask_b32 v103, v97, 0, s[56:57]
    s_waitcnt lgkmcnt(0)
    s_nop 0
    v_mfma_f32_16x16x32_bf16 v[56:59], v[36:39], v[52:55], 0
    v_mfma_f32_16x16x32_bf16 v[60:63], v[40:43], v[52:55], 0
    v_mfma_f32_16x16x32_bf16 v[104:107], v[84:87], v[100:103], 0
    v_mfma_f32_16x16x32_bf16 v[108:111], v[88:91], v[100:103], 0
    s_nop 7
    v_cvt_pk_bf16_f32 v64, v56, v57
    v_cvt_pk_bf16_f32 v65, v58, v59
    v_cvt_pk_bf16_f32 v66, v60, v61
    v_cvt_pk_bf16_f32 v67, v62, v63
    buffer_store_dwordx4 v[64:67], v9, s[16:19], 0 offen offset:0 sc1
    v_cvt_pk_bf16_f32 v112, v104, v105
    v_cvt_pk_bf16_f32 v113, v106, v107
    v_cvt_pk_bf16_f32 v114, v108, v109
    v_cvt_pk_bf16_f32 v115, v110, v111
    buffer_store_dwordx4 v[112:115], v9, s[16:19], 0 offen offset:2048 sc1
g1_done:
    s_endpgm
.section .rodata,"a"
.p2align 6
.amdhsa_kernel g1a_kernel
  .amdhsa_next_free_vgpr 216
  .amdhsa_next_free_sgpr 72
  .amdhsa_accum_offset 216
  .amdhsa_group_segment_fixed_size 0
  .amdhsa_kernarg_size 88
  .amdhsa_user_sgpr_count 2
  .amdhsa_user_sgpr_kernarg_segment_ptr 1
  .amdhsa_system_sgpr_workgroup_id_x 1
.end_amdhsa_kernel
.section .rodata,"a"
.p2align 6
.amdhsa_kernel g1b_kernel
  .amdhsa_next_free_vgpr 216
  .amdhsa_next_free_sgpr 72
  .amdhsa_accum_offset 216
  .amdhsa_group_segment_fixed_size 0
  .amdhsa_kernarg_size 88
  .amdhsa_user_sgpr_count 2
  .amdhsa_user_sgpr_kernarg_segment_ptr 1
  .amdhsa_system_sgpr_workgroup_id_x 1
.end_amdhsa_kernel
.text
.globl g2a_kernel
.p2align 8
.type g2a_kernel,@function
g2a_kernel:
    s_load_dwordx2 s[6:7], s[0:1], 0
    s_mov_b32 s47, 0
    s_branch g2_body
.text
.globl g2b_kernel
.p2align 8
.type g2b_kernel,@function
g2b_kernel:
    s_load_dwordx2 s[6:7], s[0:1], 80
    s_mov_b32 s47, 0x1800000
    s_branch g2_body
.p2align 6
g2_body:
    s_cmp_ge_u32 s2, 256
    s_cbranch_scc1 g2_done
    s_load_dwordx2 s[4:5], s[0:1], 80
    s_load_dwordx2 s[30:31], s[0:1], 16
    v_lshrrev_b32 v1, 6, v0
    v_and_b32 v2, 63, v0
    s_and_b32 s40, s2, 3
    s_lshl_b32 s40, s40, 2
    s_bfe_u32 s41, s2, 0x20003
    s_add_u32 s25, s40, s41
    s_bfe_u32 s40, s2, 0x10002
    s_lshl_b32 s40, s40, 3
    s_lshr_b32 s42, s2, 5
    s_add_u32 s24, s40, s42
    s_add_u32 s27, s41, s42
    s_mov_b32 s26, 0
    v_readfirstlane_b32 s28, v1
    s_nop 0
    s_cmp_lt_u32 s28, 4
    s_cbranch_scc1 g2_compute
    s_sub_u32 s28, s28, 4
    s_mov_b32 s40, 2048
    v_lshrrev_b32 v3, 3, v2
    v_mul_lo_u32 v3, v3, s40
    v_bfe_u32 v4, v2, 4, 1
    v_lshlrev_b32 v4, 1, v4
    v_xor_b32 v4, v4, v2
    v_and_b32 v4, 7, v4
    v_lshl_add_u32 v3, v4, 4, v3
    s_mul_i32 s41, s24, 128
    s_mul_i32 s42, s28, 32768
    s_add_u32 s41, s41, s42
    v_xor_b32 v4, 64, v3
    s_add_u32 s42, s41, 0
    v_add_u32 v10, s42, v3
    s_add_u32 s42, s41, 16384
    v_add_u32 v11, s42, v4
    s_mov_b32 s40, 2048
    v_lshrrev_b32 v3, 3, v2
    v_mul_lo_u32 v3, v3, s40
    v_lshrrev_b32 v4, 4, v2
    v_xor_b32 v4, v4, v2
    v_and_b32 v4, 7, v4
    v_lshl_add_u32 v3, v4, 4, v3
    s_mul_i32 s41, s25, 262144
    s_mul_i32 s42, s28, 65536
    s_add_u32 s41, s41, s42
    v_xor_b32 v4, 64, v3
    s_add_u32 s42, s41, 0
    v_add_u32 v12, s42, v3
    s_add_u32 s42, s41, 16384
    v_add_u32 v13, s42, v4
    s_add_u32 s42, s41, 32768
    v_add_u32 v14, s42, v3
    s_add_u32 s42, s41, 49152
    v_add_u32 v15, s42, v4
    s_mul_i32 s36, s28, 2048
    s_mul_i32 s37, s28, 4096
    s_add_u32 s37, s37, 8192
    s_waitcnt lgkmcnt(0)
    s_mov_b32 s8, s30
    s_mov_b32 s9, s31
    s_mov_b32 s10, 0x200000
    s_mov_b32 s11, 0x20000
    s_add_u32 s12, s4, 0x400000
    s_addc_u32 s13, s5, 0
    s_mov_b32 s14, 0x400000
    s_mov_b32 s15, 0x20000
    s_mov_b32 s32, 0
    s_mov_b32 s33, 0
g2_ld_loop:
    s_cmp_lt_u32 s32, 3
    s_cbranch_scc1 g2_ld_issue
    s_waitcnt vmcnt(12)
g2_ld_bar:
    s_barrier
g2_ld_issue:
    s_add_u32 s40, s32, s27
    s_and_b32 s40, s40, 1
    s_andn2_b32 s41, s32, 1
    s_or_b32 s40, s40, s41
    s_add_u32 s40, s40, s26
    s_mul_i32 s34, s40, 131072
    s_mul_i32 s35, s40, 128
    s_add_u32 s38, s33, s36
    s_add_u32 s39, s33, s37
    s_add_u32 m0, s38, 0
    s_nop 0
    buffer_load_dwordx4 v10, s[8:11], s34 offen lds
    s_add_u32 m0, s38, 1024
    s_nop 0
    buffer_load_dwordx4 v11, s[8:11], s34 offen lds
    s_add_u32 m0, s39, 0
    s_nop 0
    buffer_load_dwordx4 v12, s[12:15], s35 offen lds
    s_add_u32 m0, s39, 1024
    s_nop 0
    buffer_load_dwordx4 v13, s[12:15], s35 offen lds
    s_add_u32 m0, s39, 2048
    s_nop 0
    buffer_load_dwordx4 v14, s[12:15], s35 offen lds
    s_add_u32 m0, s39, 3072
    s_nop 0
    buffer_load_dwordx4 v15, s[12:15], s35 offen lds
    s_add_u32 s33, s33, 24576
    s_cmp_eq_u32 s33, 98304
    s_cselect_b32 s33, 0, s33
    s_add_u32 s32, s32, 1
    s_cmp_lt_u32 s32, 16
    s_cbranch_scc1 g2_ld_loop
    s_waitcnt vmcnt(12)
    s_barrier
    s_waitcnt vmcnt(6)
    s_barrier
    s_waitcnt vmcnt(0)
    s_barrier
g2_done:
    s_endpgm
g2_compute:
    v_lshrrev_b32 v5, 4, v2
    v_bfe_u32 v6, v2, 2, 2
    v_and_b32 v7, 3, v2
    v_and_b32 v8, 15, v2
    s_and_b32 s44, s28, 0
    s_lshr_b32 s45, s28, 0
    s_mul_i32 s40, s25, 128
    s_mul_i32 s41, s45, 32
    s_add_u32 s40, s40, s41
    v_add_u32 v20, s40, v8
    s_mov_b32 s41, 2048
    v_mul_lo_u32 v9, v20, s41
    s_mul_i32 s40, s24, 128
    s_mul_i32 s41, s44, 128
    s_add_u32 s46, s40, s41
    v_and_b32 v3, 1, v5
    v_lshlrev_b32 v3, 5, v3
    v_lshrrev_b32 v4, 1, v5
    v_lshl_add_u32 v3, v4, 4, v3
    v_add3_u32 v9, v9, v3, s46
    s_mov_b32 s52, 0
    s_mov_b32 s53, 32768
    s_waitcnt lgkmcnt(0)
    s_add_u32 s20, s6, s47
    s_addc_u32 s21, s7, 0
    s_mov_b32 s22, 0x400000
    s_mov_b32 s23, 0x20000
    s_add_u32 s16, s4, 0x800000
    s_addc_u32 s17, s5, 0
    s_mov_b32 s18, 0x400000
    s_mov_b32 s19, 0x20000
    buffer_load_dwordx4 v[56:59], v9, s[20:23], s52 offen offset:0
    buffer_load_dwordx4 v[60:63], v9, s[20:23], s52 offen offset:64
    buffer_load_dwordx4 v[64:67], v9, s[20:23], s53 offen offset:0
    buffer_load_dwordx4 v[68:71], v9, s[20:23], s53 offen offset:64
    s_mul_i32 s42, s44, 4
    s_mov_b32 s43, 0
    v_and_b32 v3, 1, v5
    v_lshlrev_b32 v3, 1, v3
    v_lshrrev_b32 v4, 1, v6
    v_or_b32 v3, v3, v4
    s_add_u32 s40, s42, 0
    v_xor_b32 v3, s40, v3
    v_lshlrev_b32 v3, 5, v3
    v_lshl_add_u32 v3, v7, 3, v3
    v_lshl_add_u32 v4, v5, 3, v6
    v_lshl_add_u32 v3, v4, 7, v3
    v_add_u32 v10, s43, v3
    v_and_b32 v3, 1, v5
    v_lshlrev_b32 v3, 1, v3
    v_lshrrev_b32 v4, 1, v6
    v_or_b32 v3, v3, v4
    s_add_u32 s40, s42, 1
    v_xor_b32 v3, s40, v3
    v_lshlrev_b32 v3, 5, v3
    v_lshl_add_u32 v3, v7, 3, v3
    v_lshl_add_u32 v4, v5, 3, v6
    v_lshl_add_u32 v3, v4, 7, v3
    v_add_u32 v11, s43, v3
    v_and_b32 v3, 1, v5
    v_lshlrev_b32 v3, 1, v3
    v_lshrrev_b32 v4, 1, v6
    v_or_b32 v3, v3, v4
    s_add_u32 s40, s42, 2
    v_xor_b32 v3, s40, v3
    v_lshlrev_b32 v3, 5, v3
    v_lshl_add_u32 v3, v7, 3, v3
    v_lshl_add_u32 v4, v5, 3, v6
    v_lshl_add_u32 v3, v4, 7, v3
    v_add_u32 v12, s43, v3
    v_and_b32 v3, 1, v5
    v_lshlrev_b32 v3, 1, v3
    v_lshrrev_b32 v4, 1, v6
    v_or_b32 v3, v3, v4
    s_add_u32 s40, s42, 3
    v_xor_b32 v3, s40, v3
    v_lshlrev_b32 v3, 5, v3
    v_lshl_add_u32 v3, v7, 3, v3
    v_lshl_add_u32 v4, v5, 3, v6
    v_lshl_add_u32 v3, v4, 7, v3
    v_add_u32 v13, s43, v3
    s_mul_i32 s42, s45, 32
    v_lshrrev_b32 v3, 1, v8
    v_xor_b32 v3, v3, v5
    v_lshlrev_b32 v3, 4, v3
    v_lshl_add_u32 v3, v8, 7, v3
    s_lshl_b32 s40, s42, 7
    s_add_u32 s40, s40, 8192
    v_add_u32 v14, s40, v3
    v_xor_b32 v15, 64, v14
    v_mov_b32 v80, 0
    v_mov_b32 v81, 0
    v_mov_b32 v82, 0
    v_mov_b32 v83, 0
    v_mov_b32 v84, 0
    v_mov_b32 v85, 0
    v_mov_b32 v86, 0
    v_mov_b32 v87, 0
    v_mov_b32 v88, 0
    v_mov_b32 v89, 0
    v_mov_b32 v90, 0
    v_mov_b32 v91, 0
    v_mov_b32 v92, 0
    v_mov_b32 v93, 0
    v_mov_b32 v94, 0
    v_mov_b32 v95, 0
    v_mov_b32 v96, 0
    v_mov_b32 v97, 0
    v_mov_b32 v98, 0
    v_mov_b32 v99, 0
    v_mov_b32 v100, 0
    v_mov_b32 v101, 0
    v_mov_b32 v102, 0
    v_mov_b32 v103, 0
    s_mov_b32 s48, 16
    s_mov_b32 s50, 0
    s_mov_b32 s51, 24576
    s_mov_b32 s29, 0xfffee000
    s_waitcnt vmcnt(0)
    v_permlane16_swap_b32 v56, v58
    v_permlane16_swap_b32 v57, v59
    v_permlane16_swap_b32 v60, v62
    v_permlane16_swap_b32 v61, v63
    v_permlane16_swap_b32 v64, v66
    v_permlane16_swap_b32 v65, v67
    v_permlane16_swap_b32 v68, v70
    v_permlane16_swap_b32 v69, v71
    v_lshlrev_b32 v24, 16, v56
    v_and_b32 v25, 0xffff0000, v56
    v_lshlrev_b32 v26, 16, v57
    v_and_b32 v27, 0xffff0000, v57
    v_lshlrev_b32 v32, 16, v58
    v_and_b32 v33, 0xffff0000, v58
    v_lshlrev_b32 v34, 16, v59
    v_and_b32 v35, 0xffff0000, v59
    v_lshlrev_b32 v40, 16, v60
    v_and_b32 v41, 0xffff0000, v60
    v_lshlrev_b32 v42, 16, v61
    v_and_b32 v43, 0xffff0000, v61
    v_lshlrev_b32 v48, 16, v62
    v_and_b32 v49, 0xffff0000, v62
    v_lshlrev_b32 v50, 16, v63
    v_and_b32 v51, 0xffff0000, v63
    v_lshlrev_b32 v28, 16, v64
    v_and_b32 v29, 0xffff0000, v64
    v_lshlrev_b32 v30, 16, v65
    v_and_b32 v31, 0xffff0000, v65
    v_lshlrev_b32 v36, 16, v66
    v_and_b32 v37, 0xffff0000, v66
    v_lshlrev_b32 v38, 16, v67
    v_and_b32 v39, 0xffff0000, v67
    v_lshlrev_b32 v44, 16, v68
    v_and_b32 v45, 0xffff0000, v68
    v_lshlrev_b32 v46, 16, v69
    v_and_b32 v47, 0xffff0000, v69
    v_lshlrev_b32 v52, 16, v70
    v_and_b32 v53, 0xffff0000, v70
    v_lshlrev_b32 v54, 16, v71
    v_and_b32 v55, 0xffff0000, v71
.p2align 3
g2_cloop:
    s_barrier
g2_cloop2:
    v_mfma_f32_16x16x32_bf16 v[24:27], v[80:83], v[96:99], v[24:27]
    ds_read_b64_tr_b16 v[56:57], v10 offset:0
    ds_read_b64_tr_b16 v[58:59], v10 offset:512
    v_mfma_f32_16x16x32_bf16 v[28:31], v[80:83], v[100:103], v[28:31]
    ds_read_b128 v[72:75], v14 offset:0
    v_mfma_f32_16x16x32_bf16 v[32:35], v[84:87], v[96:99], v[32:35]
    ds_read_b128 v[76:79], v14 offset:2048
    v_mfma_f32_16x16x32_bf16 v[36:39], v[84:87], v[100:103], v[36:39]
    ds_read_b64_tr_b16 v[60:61], v11 offset:0
    ds_read_b64_tr_b16 v[62:63], v11 offset:512
    v_mfma_f32_16x16x32_bf16 v[40:43], v[88:91], v[96:99], v[40:43]
    ds_read_b64_tr_b16 v[64:65], v12 offset:0
    ds_read_b64_tr_b16 v[66:67], v12 offset:512
    v_mfma_f32_16x16x32_bf16 v[44:47], v[88:91], v[100:103], v[44:47]
    ds_read_b64_tr_b16 v[68:69], v13 offset:0
    ds_read_b64_tr_b16 v[70:71], v13 offset:512
    v_mfma_f32_16x16x32_bf16 v[48:51], v[92:95], v[96:99], v[48:51]
    v_mfma_f32_16x16x32_bf16 v[52:55], v[92:95], v[100:103], v[52:55]
    s_waitcnt lgkmcnt(0)
    v_mfma_f32_16x16x32_bf16 v[24:27], v[56:59], v[72:75], v[24:27]
    ds_read_b64_tr_b16 v[80:81], v10 offset:4096
    ds_read_b64_tr_b16 v[82:83], v10 offset:4608
    v_mfma_f32_16x16x32_bf16 v[28:31], v[56:59], v[76:79], v[28:31]
    ds_read_b128 v[96:99], v15 offset:0
    v_mfma_f32_16x16x32_bf16 v[32:35], v[60:63], v[72:75], v[32:35]
    ds_read_b128 v[100:103], v15 offset:2048
    v_mfma_f32_16x16x32_bf16 v[36:39], v[60:63], v[76:79], v[36:39]
    ds_read_b64_tr_b16 v[84:85], v11 offset:4096
    ds_read_b64_tr_b16 v[86:87], v11 offset:4608
    v_mfma_f32_16x16x32_bf16 v[40:43], v[64:67], v[72:75], v[40:43]
    ds_read_b64_tr_b16 v[88:89], v12 offset:4096
    ds_read_b64_tr_b16 v[90:91], v12 offset:4608
    v_mfma_f32_16x16x32_bf16 v[44:47], v[64:67], v[76:79], v[44:47]
    ds_read_b64_tr_b16 v[92:93], v13 offset:4096
    ds_read_b64_tr_b16 v[94:95], v13 offset:4608
    v_mfma_f32_16x16x32_bf16 v[48:51], v[68:71], v[72:75], v[48:51]
    s_add_u32 s50, s50, 1
    s_cmp_eq_u32 s50, 4
    v_mfma_f32_16x16x32_bf16 v[52:55], v[68:71], v[76:79], v[52:55]
    s_cselect_b32 s49, s29, s51
    s_cselect_b32 s50, 0, s50
    v_add_u32 v10, s49, v10
    v_add_u32 v11, s49, v11
    v_add_u32 v12, s49, v12
    v_add_u32 v13, s49, v13
    v_add_u32 v14, s49, v14
    v_add_u32 v15, s49, v15
    s_sub_u32 s48, s48, 1
    s_cmp_lg_u32 s48, 0
    s_waitcnt lgkmcnt(0)
    s_cbranch_scc1 g2_cloop
    v_mfma_f32_16x16x32_bf16 v[24:27], v[80:83], v[96:99], v[24:27]
    v_mfma_f32_16x16x32_bf16 v[28:31], v[80:83], v[100:103], v[28:31]
    v_mfma_f32_16x16x32_bf16 v[32:35], v[84:87], v[96:99], v[32:35]
    v_mfma_f32_16x16x32_bf16 v[36:39], v[84:87], v[100:103], v[36:39]
    v_mfma_f32_16x16x32_bf16 v[40:43], v[88:91], v[96:99], v[40:43]
    v_mfma_f32_16x16x32_bf16 v[44:47], v[88:91], v[100:103], v[44:47]
    v_mfma_f32_16x16x32_bf16 v[48:51], v[92:95], v[96:99], v[48:51]
    v_mfma_f32_16x16x32_bf16 v[52:55], v[92:95], v[100:103], v[52:55]
    s_nop 7
    v_cvt_pk_bf16_f32 v56, v24, v25
    v_cvt_pk_bf16_f32 v57, v26, v27
    v_cvt_pk_bf16_f32 v58, v32, v33
    v_cvt_pk_bf16_f32 v59, v34, v35
    s_nop 1
    v_permlane16_swap_b32 v56, v58
    v_permlane16_swap_b32 v57, v59
    buffer_store_dwordx4 v[56:59], v9, s[16:19], s52 offen offset:0 sc1
    v_cvt_pk_bf16_f32 v60, v40, v41
    v_cvt_pk_bf16_f32 v61, v42, v43
    v_cvt_pk_bf16_f32 v62, v48, v49
    v_cvt_pk_bf16_f32 v63, v50, v51
    s_nop 1
    v_permlane16_swap_b32 v60, v62
    v_permlane16_swap_b32 v61, v63
    buffer_store_dwordx4 v[60:63], v9, s[16:19], s52 offen offset:64 sc1
    v_cvt_pk_bf16_f32 v64, v28, v29
    v_cvt_pk_bf16_f32 v65, v30, v31
    v_cvt_pk_bf16_f32 v66, v36, v37
    v_cvt_pk_bf16_f32 v67, v38, v39
    s_nop 1
    v_permlane16_swap_b32 v64, v66
    v_permlane16_swap_b32 v65, v67
    buffer_store_dwordx4 v[64:67], v9, s[16:19], s53 offen offset:0 sc1
    v_cvt_pk_bf16_f32 v68, v44, v45
    v_cvt_pk_bf16_f32 v69, v46, v47
    v_cvt_pk_bf16_f32 v70, v52, v53
    v_cvt_pk_bf16_f32 v71, v54, v55
    s_nop 1
    v_permlane16_swap_b32 v68, v70
    v_permlane16_swap_b32 v69, v71
    buffer_store_dwordx4 v[68:71], v9, s[16:19], s53 offen offset:64 sc1
    s_endpgm
.section .rodata,"a"
.p2align 6
.amdhsa_kernel g2a_kernel
  .amdhsa_next_free_vgpr 104
  .amdhsa_next_free_sgpr 72
  .amdhsa_accum_offset 104
  .amdhsa_group_segment_fixed_size 0
  .amdhsa_kernarg_size 88
  .amdhsa_user_sgpr_count 2
  .amdhsa_user_sgpr_kernarg_segment_ptr 1
  .amdhsa_system_sgpr_workgroup_id_x 1
.end_amdhsa_kernel
.section .rodata,"a"
.p2align 6
.amdhsa_kernel g2b_kernel
  .amdhsa_next_free_vgpr 104
  .amdhsa_next_free_sgpr 72
  .amdhsa_accum_offset 104
  .amdhsa_group_segment_fixed_size 0
  .amdhsa_kernarg_size 88
  .amdhsa_user_sgpr_count 2
  .amdhsa_user_sgpr_kernarg_segment_ptr 1
  .amdhsa_system_sgpr_workgroup_id_x 1
.end_amdhsa_kernel
.text
.globl ln3_kernel
.p2align 8
.type ln3_kernel,@function
ln3_kernel:
    s_cmp_ge_u32 s2, 512
    s_cbranch_scc1 ln3_kernel_done
    s_load_dwordx2 s[4:5], s[0:1], 80
    v_lshrrev_b32 v1, 6, v0
    v_and_b32 v2, 63, v0
    s_lshl_b32 s3, s2, 2
    v_add_u32 v1, s3, v1
    v_lshlrev_b32 v3, 11, v1
    v_lshl_add_u32 v3, v2, 4, v3
    s_waitcnt lgkmcnt(0)
    s_add_u32 s8, s4, 0x800000
    s_addc_u32 s9, s5, 0
    s_mov_b32 s10, 0x400000
    s_mov_b32 s11, 0x20000
    buffer_load_dwordx4 v[8:11], v3, s[8:11], 0 offen
    buffer_load_dwordx4 v[12:15], v3, s[8:11], 0 offen offset:1024
    s_add_u32 s12, s4, 0xc00000
    s_addc_u32 s13, s5, 0
    s_mov_b32 s14, 0x400000
    s_mov_b32 s15, 0x20000
    s_waitcnt vmcnt(0)
    v_lshlrev_b32 v16, 16, v8
    v_and_b32 v17, 0xffff0000, v8
    v_lshlrev_b32 v18, 16, v9
    v_and_b32 v19, 0xffff0000, v9
    v_lshlrev_b32 v20, 16, v10
    v_and_b32 v21, 0xffff0000, v10
    v_lshlrev_b32 v22, 16, v11
    v_and_b32 v23, 0xffff0000, v11
    v_lshlrev_b32 v24, 16, v12
    v_and_b32 v25, 0xffff0000, v12
    v_lshlrev_b32 v26, 16, v13
    v_and_b32 v27, 0xffff0000, v13
    v_lshlrev_b32 v28, 16, v14
    v_and_b32 v29, 0xffff0000, v14
    v_lshlrev_b32 v30, 16, v15
    v_and_b32 v31, 0xffff0000, v15
    v_pk_add_f32 v[32:33], v[16:17], v[18:19]
    v_pk_add_f32 v[34:35], v[20:21], v[22:23]
    v_pk_add_f32 v[36:37], v[24:25], v[26:27]
    v_pk_add_f32 v[38:39], v[28:29], v[30:31]
    v_pk_add_f32 v[32:33], v[32:33], v[34:35]
    v_pk_add_f32 v[36:37], v[36:37], v[38:39]
    v_pk_add_f32 v[32:33], v[32:33], v[36:37]
    v_add_f32 v48, v32, v33
    s_nop 1
    v_add_f32_dpp v48, v48, v48 quad_perm:[1,0,3,2] row_mask:0xf bank_mask:0xf
    s_nop 1
    v_add_f32_dpp v48, v48, v48 quad_perm:[2,3,0,1] row_mask:0xf bank_mask:0xf
    s_nop 1
    v_add_f32_dpp v48, v48, v48 row_half_mirror row_mask:0xf bank_mask:0xf
    s_nop 1
    v_add_f32_dpp v48, v48, v48 row_mirror row_mask:0xf bank_mask:0xf
    s_nop 1
    v_add_f32_dpp v48, v48, v48 row_bcast:15 row_mask:0xa bank_mask:0xf
    s_nop 1
    v_add_f32_dpp v48, v48, v48 row_bcast:31 row_mask:0xc bank_mask:0xf
    s_nop 1
    v_readlane_b32 s40, v48, 63
    s_nop 1
    v_mov_b32 v49, 0xba800000
    v_mul_f32 v48, s40, v49
    v_mov_b32 v49, v48
    v_pk_add_f32 v[32:33], v[16:17], v[48:49]
    v_pk_add_f32 v[34:35], v[18:19], v[48:49]
    v_pk_add_f32 v[36:37], v[20:21], v[48:49]
    v_pk_add_f32 v[38:39], v[22:23], v[48:49]
    v_pk_add_f32 v[40:41], v[24:25], v[48:49]
    v_pk_add_f32 v[42:43], v[26:27], v[48:49]
    v_pk_add_f32 v[44:45], v[28:29], v[48:49]
    v_pk_add_f32 v[46:47], v[30:31], v[48:49]
    v_pk_mul_f32 v[50:51], v[32:33], v[32:33]
    v_pk_fma_f32 v[50:51], v[34:35], v[34:35], v[50:51]
    v_pk_fma_f32 v[50:51], v[36:37], v[36:37], v[50:51]
    v_pk_fma_f32 v[50:51], v[38:39], v[38:39], v[50:51]
    v_pk_fma_f32 v[50:51], v[40:41], v[40:41], v[50:51]
    v_pk_fma_f32 v[50:51], v[42:43], v[42:43], v[50:51]
    v_pk_fma_f32 v[50:51], v[44:45], v[44:45], v[50:51]
    v_pk_fma_f32 v[50:51], v[46:47], v[46:47], v[50:51]
    v_add_f32 v50, v50, v51
    v_cvt_pk_bf16_f32 v48, v48, v48
    v_lshlrev_b32 v48, 16, v48
    v_mov_b32 v49, v48
    s_nop 1
    v_add_f32_dpp v50, v50, v50 quad_perm:[1,0,3,2] row_mask:0xf bank_mask:0xf
    s_nop 1
    v_add_f32_dpp v50, v50, v50 quad_perm:[2,3,0,1] row_mask:0xf bank_mask:0xf
    s_nop 1
    v_add_f32_dpp v50, v50, v50 row_half_mirror row_mask:0xf bank_mask:0xf
    s_nop 1
    v_add_f32_dpp v50, v50, v50 row_mirror row_mask:0xf bank_mask:0xf
    s_nop 1
    v_add_f32_dpp v50, v50, v50 row_bcast:15 row_mask:0xa bank_mask:0xf
    s_nop 1
    v_add_f32_dpp v50, v50, v50 row_bcast:31 row_mask:0xc bank_mask:0xf
    s_nop 1
    v_readlane_b32 s41, v50, 63
    s_nop 1
    v_pk_add_f32 v[32:33], v[16:17], v[48:49]
    v_pk_add_f32 v[34:35], v[18:19], v[48:49]
    v_pk_add_f32 v[36:37], v[20:21], v[48:49]
    v_pk_add_f32 v[38:39], v[22:23], v[48:49]
    v_pk_add_f32 v[40:41], v[24:25], v[48:49]
    v_pk_add_f32 v[42:43], v[26:27], v[48:49]
    v_pk_add_f32 v[44:45], v[28:29], v[48:49]
    v_pk_add_f32 v[46:47], v[30:31], v[48:49]
    v_mov_b32 v50, 0x3a800000
    v_mul_f32 v50, s41, v50
    v_cvt_pk_bf16_f32 v50, v50, v50
    v_lshlrev_b32 v50, 16, v50
    v_add_f32 v50, 0x3727c5ac, v50
    v_cvt_pk_bf16_f32 v50, v50, v50
    v_lshlrev_b32 v50, 16, v50
    v_sqrt_f32 v50, v50
    v_cvt_pk_bf16_f32 v8, v32, v33
    v_cvt_pk_bf16_f32 v9, v34, v35
    v_cvt_pk_bf16_f32 v10, v36, v37
    v_cvt_pk_bf16_f32 v11, v38, v39
    v_cvt_pk_bf16_f32 v12, v40, v41
    v_cvt_pk_bf16_f32 v13, v42, v43
    v_cvt_pk_bf16_f32 v14, v44, v45
    v_cvt_pk_bf16_f32 v15, v46, v47
    v_cvt_pk_bf16_f32 v50, v50, v50
    v_lshlrev_b32 v50, 16, v50
    v_rcp_f32 v50, v50
    v_lshlrev_b32 v32, 16, v8
    v_and_b32 v33, 0xffff0000, v8
    v_lshlrev_b32 v34, 16, v9
    v_and_b32 v35, 0xffff0000, v9
    v_lshlrev_b32 v36, 16, v10
    v_and_b32 v37, 0xffff0000, v10
    v_lshlrev_b32 v38, 16, v11
    v_and_b32 v39, 0xffff0000, v11
    v_lshlrev_b32 v40, 16, v12
    v_and_b32 v41, 0xffff0000, v12
    v_lshlrev_b32 v42, 16, v13
    v_and_b32 v43, 0xffff0000, v13
    v_lshlrev_b32 v44, 16, v14
    v_and_b32 v45, 0xffff0000, v14
    v_lshlrev_b32 v46, 16, v15
    v_and_b32 v47, 0xffff0000, v15
    v_mov_b32 v51, v50
    v_pk_mul_f32 v[32:33], v[32:33], v[50:51]
    v_pk_mul_f32 v[34:35], v[34:35], v[50:51]
    v_pk_mul_f32 v[36:37], v[36:37], v[50:51]
    v_pk_mul_f32 v[38:39], v[38:39], v[50:51]
    v_pk_mul_f32 v[40:41], v[40:41], v[50:51]
    v_pk_mul_f32 v[42:43], v[42:43], v[50:51]
    v_pk_mul_f32 v[44:45], v[44:45], v[50:51]
    v_pk_mul_f32 v[46:47], v[46:47], v[50:51]
    v_cvt_pk_bf16_f32 v8, v32, v33
    v_cvt_pk_bf16_f32 v9, v34, v35
    v_cvt_pk_bf16_f32 v10, v36, v37
    v_cvt_pk_bf16_f32 v11, v38, v39
    v_cvt_pk_bf16_f32 v12, v40, v41
    v_cvt_pk_bf16_f32 v13, v42, v43
    v_cvt_pk_bf16_f32 v14, v44, v45
    v_cvt_pk_bf16_f32 v15, v46, v47
    v_lshlrev_b32 v16, 16, v8
    v_and_b32 v17, 0xffff0000, v8
    v_lshlrev_b32 v18, 16, v9
    v_and_b32 v19, 0xffff0000, v9
    v_lshlrev_b32 v20, 16, v10
    v_and_b32 v21, 0xffff0000, v10
    v_lshlrev_b32 v22, 16, v11
    v_and_b32 v23, 0xffff0000, v11
    v_lshlrev_b32 v24, 16, v12
    v_and_b32 v25, 0xffff0000, v12
    v_lshlrev_b32 v26, 16, v13
    v_and_b32 v27, 0xffff0000, v13
    v_lshlrev_b32 v28, 16, v14
    v_and_b32 v29, 0xffff0000, v14
    v_lshlrev_b32 v30, 16, v15
    v_and_b32 v31, 0xffff0000, v15
    v_pk_add_f32 v[32:33], v[16:17], v[18:19]
    v_pk_add_f32 v[34:35], v[20:21], v[22:23]
    v_pk_add_f32 v[36:37], v[24:25], v[26:27]
    v_pk_add_f32 v[38:39], v[28:29], v[30:31]
    v_pk_add_f32 v[32:33], v[32:33], v[34:35]
    v_pk_add_f32 v[36:37], v[36:37], v[38:39]
    v_pk_add_f32 v[32:33], v[32:33], v[36:37]
    v_add_f32 v48, v32, v33
    s_nop 1
    v_add_f32_dpp v48, v48, v48 quad_perm:[1,0,3,2] row_mask:0xf bank_mask:0xf
    s_nop 1
    v_add_f32_dpp v48, v48, v48 quad_perm:[2,3,0,1] row_mask:0xf bank_mask:0xf
    s_nop 1
    v_add_f32_dpp v48, v48, v48 row_half_mirror row_mask:0xf bank_mask:0xf
    s_nop 1
    v_add_f32_dpp v48, v48, v48 row_mirror row_mask:0xf bank_mask:0xf
    s_nop 1
    v_add_f32_dpp v48, v48, v48 row_bcast:15 row_mask:0xa bank_mask:0xf
    s_nop 1
    v_add_f32_dpp v48, v48, v48 row_bcast:31 row_mask:0xc bank_mask:0xf
    s_nop 1
    v_readlane_b32 s40, v48, 63
    s_nop 1
    v_mov_b32 v49, 0xba800000
    v_mul_f32 v48, s40, v49
    v_mov_b32 v49, v48
    v_pk_add_f32 v[32:33], v[16:17], v[48:49]
    v_pk_add_f32 v[34:35], v[18:19], v[48:49]
    v_pk_add_f32 v[36:37], v[20:21], v[48:49]
    v_pk_add_f32 v[38:39], v[22:23], v[48:49]
    v_pk_add_f32 v[40:41], v[24:25], v[48:49]
    v_pk_add_f32 v[42:43], v[26:27], v[48:49]
    v_pk_add_f32 v[44:45], v[28:29], v[48:49]
    v_pk_add_f32 v[46:47], v[30:31], v[48:49]
    v_pk_mul_f32 v[50:51], v[32:33], v[32:33]
    v_pk_fma_f32 v[50:51], v[34:35], v[34:35], v[50:51]
    v_pk_fma_f32 v[50:51], v[36:37], v[36:37], v[50:51]
    v_pk_fma_f32 v[50:51], v[38:39], v[38:39], v[50:51]
    v_pk_fma_f32 v[50:51], v[40:41], v[40:41], v[50:51]
    v_pk_fma_f32 v[50:51], v[42:43], v[42:43], v[50:51]
    v_pk_fma_f32 v[50:51], v[44:45], v[44:45], v[50:51]
    v_pk_fma_f32 v[50:51], v[46:47], v[46:47], v[50:51]
    v_add_f32 v50, v50, v51
    v_cvt_pk_bf16_f32 v48, v48, v48
    v_lshlrev_b32 v48, 16, v48
    v_mov_b32 v49, v48
    s_nop 1
    v_add_f32_dpp v50, v50, v50 quad_perm:[1,0,3,2] row_mask:0xf bank_mask:0xf
    s_nop 1
    v_add_f32_dpp v50, v50, v50 quad_perm:[2,3,0,1] row_mask:0xf bank_mask:0xf
    s_nop 1
    v_add_f32_dpp v50, v50, v50 row_half_mirror row_mask:0xf bank_mask:0xf
    s_nop 1
    v_add_f32_dpp v50, v50, v50 row_mirror row_mask:0xf bank_mask:0xf
    s_nop 1
    v_add_f32_dpp v50, v50, v50 row_bcast:15 row_mask:0xa bank_mask:0xf
    s_nop 1
    v_add_f32_dpp v50, v50, v50 row_bcast:31 row_mask:0xc bank_mask:0xf
    s_nop 1
    v_readlane_b32 s41, v50, 63
    s_nop 1
    v_pk_add_f32 v[32:33], v[16:17], v[48:49]
    v_pk_add_f32 v[34:35], v[18:19], v[48:49]
    v_pk_add_f32 v[36:37], v[20:21], v[48:49]
    v_pk_add_f32 v[38:39], v[22:23], v[48:49]
    v_pk_add_f32 v[40:41], v[24:25], v[48:49]
    v_pk_add_f32 v[42:43], v[26:27], v[48:49]
    v_pk_add_f32 v[44:45], v[28:29], v[48:49]
    v_pk_add_f32 v[46:47], v[30:31], v[48:49]
    v_mov_b32 v50, 0x3a800000
    v_mul_f32 v50, s41, v50
    v_cvt_pk_bf16_f32 v50, v50, v50
    v_lshlrev_b32 v50, 16, v50
    v_add_f32 v50, 0x3727c5ac, v50
    v_cvt_pk_bf16_f32 v50, v50, v50
    v_lshlrev_b32 v50, 16, v50
    v_sqrt_f32 v50, v50
    v_cvt_pk_bf16_f32 v8, v32, v33
    v_cvt_pk_bf16_f32 v9, v34, v35
    v_cvt_pk_bf16_f32 v10, v36, v37
    v_cvt_pk_bf16_f32 v11, v38, v39
    v_cvt_pk_bf16_f32 v12, v40, v41
    v_cvt_pk_bf16_f32 v13, v42, v43
    v_cvt_pk_bf16_f32 v14, v44, v45
    v_cvt_pk_bf16_f32 v15, v46, v47
    v_cvt_pk_bf16_f32 v50, v50, v50
    v_lshlrev_b32 v50, 16, v50
    v_rcp_f32 v50, v50
    v_lshlrev_b32 v32, 16, v8
    v_and_b32 v33, 0xffff0000, v8
    v_lshlrev_b32 v34, 16, v9
    v_and_b32 v35, 0xffff0000, v9
    v_lshlrev_b32 v36, 16, v10
    v_and_b32 v37, 0xffff0000, v10
    v_lshlrev_b32 v38, 16, v11
    v_and_b32 v39, 0xffff0000, v11
    v_lshlrev_b32 v40, 16, v12
    v_and_b32 v41, 0xffff0000, v12
    v_lshlrev_b32 v42, 16, v13
    v_and_b32 v43, 0xffff0000, v13
    v_lshlrev_b32 v44, 16, v14
    v_and_b32 v45, 0xffff0000, v14
    v_lshlrev_b32 v46, 16, v15
    v_and_b32 v47, 0xffff0000, v15
    v_mov_b32 v51, v50
    v_pk_mul_f32 v[32:33], v[32:33], v[50:51]
    v_pk_mul_f32 v[34:35], v[34:35], v[50:51]
    v_pk_mul_f32 v[36:37], v[36:37], v[50:51]
    v_pk_mul_f32 v[38:39], v[38:39], v[50:51]
    v_pk_mul_f32 v[40:41], v[40:41], v[50:51]
    v_pk_mul_f32 v[42:43], v[42:43], v[50:51]
    v_pk_mul_f32 v[44:45], v[44:45], v[50:51]
    v_pk_mul_f32 v[46:47], v[46:47], v[50:51]
    v_cvt_pk_bf16_f32 v8, v32, v33
    v_cvt_pk_bf16_f32 v9, v34, v35
    v_cvt_pk_bf16_f32 v10, v36, v37
    v_cvt_pk_bf16_f32 v11, v38, v39
    v_cvt_pk_bf16_f32 v12, v40, v41
    v_cvt_pk_bf16_f32 v13, v42, v43
    v_cvt_pk_bf16_f32 v14, v44, v45
    v_cvt_pk_bf16_f32 v15, v46, v47
    buffer_store_dwordx4 v[8:11], v3, s[12:15], 0 offen sc1
    buffer_store_dwordx4 v[12:15], v3, s[12:15], 0 offen offset:1024 sc1
ln3_kernel_done:
    s_endpgm
.section .rodata,"a"
.p2align 6
.amdhsa_kernel ln3_kernel
  .amdhsa_next_free_vgpr 52
  .amdhsa_next_free_sgpr 48
  .amdhsa_accum_offset 52
  .amdhsa_group_segment_fixed_size 0
  .amdhsa_kernarg_size 88
  .amdhsa_user_sgpr_count 2
  .amdhsa_user_sgpr_kernarg_segment_ptr 1
  .amdhsa_system_sgpr_workgroup_id_x 1
.end_amdhsa_kernel
.text
.globl g3a_kernel
.p2align 8
.type g3a_kernel,@function
g3a_kernel:
    s_mov_b32 s47, 256
    s_branch g3_body
.text
.globl g3b_kernel
.p2align 8
.type g3b_kernel,@function
g3b_kernel:
    s_mov_b32 s47, 224
    s_branch g3_body
.p2align 6
g3_body:
    s_cmp_ge_u32 s2, 224
    s_cbranch_scc1 g3_spare
    s_load_dwordx2 s[4:5], s[0:1], 80
    s_load_dwordx2 s[30:31], s[0:1], 32
    s_load_dwordx2 s[6:7], s[0:1], 40
    v_lshrrev_b32 v1, 6, v0
    v_and_b32 v2, 63, v0
    s_and_b32 s40, s2, 1
    s_lshl_b32 s40, s40, 2
    s_bfe_u32 s41, s2, 0x20003
    s_add_u32 s25, s40, s41
    s_bfe_u32 s40, s2, 0x20001
    s_mul_i32 s40, s40, 7
    s_lshr_b32 s42, s2, 5
    s_add_u32 s24, s40, s42
    s_add_u32 s27, s41, s42
    s_mov_b32 s26, 0
    v_readfirstlane_b32 s28, v1
    s_nop 0
    s_cmp_lt_u32 s28, 4
    s_cbranch_scc1 g3_compute
    s_sub_u32 s28, s28, 4
    s_mov_b32 s40, 7168
    v_lshrrev_b32 v4, 4, v2
    v_mul_lo_u32 v3, v4, s40
    v_lshlrev_b32 v4, 1, v4
    v_xor_b32 v4, v4, v2
    v_and_b32 v4, 15, v4
    v_lshl_add_u32 v3, v4, 4, v3
    s_mul_i32 s41, s24, 256
    s_mul_i32 s42, s28, 114688
    s_add_u32 s41, s41, s42
    v_xor_b32 v4, 128, v3
    s_add_u32 s42, s41, 0
    v_add_u32 v10, s42, v3
    s_add_u32 s42, s41, 28672
    v_add_u32 v11, s42, v3
    s_add_u32 s42, s41, 57344
    v_add_u32 v12, s42, v4
    s_add_u32 s42, s41, 86016
    v_add_u32 v13, s42, v4
    s_mov_b32 s40, 2048
    v_lshrrev_b32 v4, 4, v2
    v_mul_lo_u32 v3, v4, s40
    v_lshlrev_b32 v4, 1, v4
    v_xor_b32 v4, v4, v2
    v_and_b32 v4, 15, v4
    v_lshl_add_u32 v3, v4, 4, v3
    s_mul_i32 s41, s25, 256
    s_mul_i32 s42, s28, 32768
    s_add_u32 s41, s41, s42
    v_xor_b32 v4, 128, v3
    s_add_u32 s42, s41, 0
    v_add_u32 v14, s42, v3
    s_add_u32 s42, s41, 8192
    v_add_u32 v15, s42, v3
    s_add_u32 s42, s41, 16384
    v_add_u32 v16, s42, v4
    s_add_u32 s42, s41, 24576
    v_add_u32 v17, s42, v4
    s_mul_i32 s36, s28, 4096
    s_mul_i32 s37, s28, 4096
    s_add_u32 s37, s37, 16384
    s_waitcnt lgkmcnt(0)
    s_mov_b32 s8, s30
    s_mov_b32 s9, s31
    s_mov_b32 s10, 0xe00000
    s_mov_b32 s11, 0x20000
    s_add_u32 s12, s4, 0xc00000
    s_addc_u32 s13, s5, 0
    s_mov_b32 s14, 0x400000
    s_mov_b32 s15, 0x20000
    s_mov_b32 s32, 0
    s_mov_b32 s33, 0
g3_ld_loop:
    s_cmp_lt_u32 s32, 3
    s_cbranch_scc1 g3_ld_issue
    s_waitcnt vmcnt(16)
g3_ld_bar:
    s_barrier
g3_ld_issue:
    s_add_u32 s40, s32, s27
    s_and_b32 s40, s40, 3
    s_andn2_b32 s41, s32, 3
    s_or_b32 s40, s40, s41
    s_add_u32 s40, s40, s26
    s_mul_i32 s34, s40, 458752
    s_mul_i32 s35, s40, 131072
    s_add_u32 s38, s33, s36
    s_add_u32 s39, s33, s37
    s_add_u32 m0, s38, 0
    s_nop 0
    buffer_load_dwordx4 v10, s[8:11], s34 offen lds
    s_add_u32 m0, s38, 1024
    s_nop 0
    buffer_load_dwordx4 v11, s[8:11], s34 offen lds
    s_add_u32 m0, s38, 2048
    s_nop 0
    buffer_load_dwordx4 v12, s[8:11], s34 offen lds
    s_add_u32 m0, s38, 3072
    s_nop 0
    buffer_load_dwordx4 v13, s[8:11], s34 offen lds
    s_add_u32 m0, s39, 0
    s_nop 0
    buffer_load_dwordx4 v14, s[12:15], s35 offen lds
    s_add_u32 m0, s39, 1024
    s_nop 0
    buffer_load_dwordx4 v15, s[12:15], s35 offen lds
    s_add_u32 m0, s39, 2048
    s_nop 0
    buffer_load_dwordx4 v16, s[12:15], s35 offen lds
    s_add_u32 m0, s39, 3072
    s_nop 0
    buffer_load_dwordx4 v17, s[12:15], s35 offen lds
    s_add_u32 s33, s33, 32768
    s_cmp_eq_u32 s33, 131072
    s_cselect_b32 s33, 0, s33
    s_add_u32 s32, s32, 1
    s_cmp_lt_u32 s32, 32
    s_cbranch_scc1 g3_ld_loop
    s_waitcnt vmcnt(16)
    s_barrier
    s_waitcnt vmcnt(8)
    s_barrier
    s_waitcnt vmcnt(0)
    s_barrier
g3_done:
    s_endpgm
g3_compute:
    v_lshrrev_b32 v5, 4, v2
    v_bfe_u32 v6, v2, 2, 2
    v_and_b32 v7, 3, v2
    v_and_b32 v8, 15, v2
    s_and_b32 s44, s28, 1
    s_lshr_b32 s45, s28, 1
    s_mul_i32 s40, s25, 128
    s_mul_i32 s41, s45, 64
    s_add_u32 s40, s40, s41
    v_add_u32 v20, s40, v8
    s_mov_b32 s41, 7168
    v_mul_lo_u32 v9, v20, s41
    s_mul_i32 s40, s24, 256
    s_mul_i32 s41, s44, 128
    s_add_u32 s46, s40, s41
    v_and_b32 v3, 1, v5
    v_lshlrev_b32 v3, 5, v3
    v_lshrrev_b32 v4, 1, v5
    v_lshl_add_u32 v3, v4, 4, v3
    v_add3_u32 v9, v9, v3, s46
    s_mov_b32 s52, 0
    s_mov_b32 s53, 114688
    s_mov_b32 s54, 229376
    s_mov_b32 s55, 344064
    s_waitcnt lgkmcnt(0)
    s_mov_b32 s20, s6
    s_mov_b32 s21, s7
    s_mov_b32 s22, 0x1c00
    s_mov_b32 s23, 0x20000
    s_add_u32 s16, s4, 0x1000000
    s_addc_u32 s17, s5, 0
    s_mov_b32 s18, 0x700000
    s_mov_b32 s19, 0x20000
    v_lshl_add_u32 v3, v5, 3, s46
    buffer_load_dwordx2 v[88:89], v3, s[20:23], 0 offen offset:0
    buffer_load_dwordx2 v[90:91], v3, s[20:23], 0 offen offset:32
    buffer_load_dwordx2 v[92:93], v3, s[20:23], 0 offen offset:64
    buffer_load_dwordx2 v[94:95], v3, s[20:23], 0 offen offset:96
    s_mul_i32 s42, s44, 4
    s_mov_b32 s43, 0
    v_and_b32 v3, 1, v5
    v_lshl_or_b32 v3, v3, 2, v6
    s_add_u32 s40, s42, 0
    v_xor_b32 v3, s40, v3
    v_lshlrev_b32 v3, 5, v3
    v_lshl_add_u32 v3, v7, 3, v3
    v_lshl_add_u32 v4, v5, 3, v6
    v_lshl_add_u32 v3, v4, 8, v3
    v_add_u32 v10, s43, v3
    v_and_b32 v3, 1, v5
    v_lshl_or_b32 v3, v3, 2, v6
    s_add_u32 s40, s42, 1
    v_xor_b32 v3, s40, v3
    v_lshlrev_b32 v3, 5, v3
    v_lshl_add_u32 v3, v7, 3, v3
    v_lshl_add_u32 v4, v5, 3, v6
    v_lshl_add_u32 v3, v4, 8, v3
    v_add_u32 v11, s43, v3
    v_and_b32 v3, 1, v5
    v_lshl_or_b32 v3, v3, 2, v6
    s_add_u32 s40, s42, 2
    v_xor_b32 v3, s40, v3
    v_lshlrev_b32 v3, 5, v3
    v_lshl_add_u32 v3, v7, 3, v3
    v_lshl_add_u32 v4, v5, 3, v6
    v_lshl_add_u32 v3, v4, 8, v3
    v_add_u32 v12, s43, v3
    v_and_b32 v3, 1, v5
    v_lshl_or_b32 v3, v3, 2, v6
    s_add_u32 s40, s42, 3
    v_xor_b32 v3, s40, v3
    v_lshlrev_b32 v3, 5, v3
    v_lshl_add_u32 v3, v7, 3, v3
    v_lshl_add_u32 v4, v5, 3, v6
    v_lshl_add_u32 v3, v4, 8, v3
    v_add_u32 v13, s43, v3
    s_mul_i32 s42, s45, 4
    s_mov_b32 s43, 16384
    v_and_b32 v3, 1, v5
    v_lshl_or_b32 v3, v3, 2, v6
    s_add_u32 s40, s42, 0
    v_xor_b32 v3, s40, v3
    v_lshlrev_b32 v3, 5, v3
    v_lshl_add_u32 v3, v7, 3, v3
    v_lshl_add_u32 v4, v5, 3, v6
    v_lshl_add_u32 v3, v4, 8, v3
    v_add_u32 v14, s43, v3
    v_and_b32 v3, 1, v5
    v_lshl_or_b32 v3, v3, 2, v6
    s_add_u32 s40, s42, 1
    v_xor_b32 v3, s40, v3
    v_lshlrev_b32 v3, 5, v3
    v_lshl_add_u32 v3, v7, 3, v3
    v_lshl_add_u32 v4, v5, 3, v6
    v_lshl_add_u32 v3, v4, 8, v3
    v_add_u32 v15, s43, v3
    v_and_b32 v3, 1, v5
    v_lshl_or_b32 v3, v3, 2, v6
    s_add_u32 s40, s42, 2
    v_xor_b32 v3, s40, v3
    v_lshlrev_b32 v3, 5, v3
    v_lshl_add_u32 v3, v7, 3, v3
    v_lshl_add_u32 v4, v5, 3, v6
    v_lshl_add_u32 v3, v4, 8, v3
    v_add_u32 v16, s43, v3
    v_and_b32 v3, 1, v5
    v_lshl_or_b32 v3, v3, 2, v6
    s_add_u32 s40, s42, 3
    v_xor_b32 v3, s40, v3
    v_lshlrev_b32 v3, 5, v3
    v_lshl_add_u32 v3, v7, 3, v3
    v_lshl_add_u32 v4, v5, 3, v6
    v_lshl_add_u32 v3, v4, 8, v3
    v_add_u32 v17, s43, v3
    v_mov_b32 v120, 0
    v_mov_b32 v121, 0
    v_mov_b32 v122, 0
    v_mov_b32 v123, 0
    v_mov_b32 v124, 0
    v_mov_b32 v125, 0
    v_mov_b32 v126, 0
    v_mov_b32 v127, 0
    v_mov_b32 v128, 0
    v_mov_b32 v129, 0
    v_mov_b32 v130, 0
    v_mov_b32 v131, 0
    v_mov_b32 v132, 0
    v_mov_b32 v133, 0
    v_mov_b32 v134, 0
    v_mov_b32 v135, 0
    v_mov_b32 v136, 0
    v_mov_b32 v137, 0
    v_mov_b32 v138, 0
    v_mov_b32 v139, 0
    v_mov_b32 v140, 0
    v_mov_b32 v141, 0
    v_mov_b32 v142, 0
    v_mov_b32 v143, 0
    v_mov_b32 v144, 0
    v_mov_b32 v145, 0
    v_mov_b32 v146, 0
    v_mov_b32 v147, 0
    v_mov_b32 v148, 0
    v_mov_b32 v149, 0
    v_mov_b32 v150, 0
    v_mov_b32 v151, 0
    s_mov_b32 s48, 32
    s_mov_b32 s50, 0
    s_mov_b32 s51, 32768
    s_mov_b32 s29, 0xfffe8000
    s_waitcnt vmcnt(0)
    v_lshlrev_b32 v24, 16, v88
    v_and_b32 v25, 0xffff0000, v88
    v_lshlrev_b32 v26, 16, v89
    v_and_b32 v27, 0xffff0000, v89
    v_lshlrev_b32 v28, 16, v88
    v_and_b32 v29, 0xffff0000, v88
    v_lshlrev_b32 v30, 16, v89
    v_and_b32 v31, 0xffff0000, v89
    v_lshlrev_b32 v32, 16, v88
    v_and_b32 v33, 0xffff0000, v88
    v_lshlrev_b32 v34, 16, v89
    v_and_b32 v35, 0xffff0000, v89
    v_lshlrev_b32 v36, 16, v88
    v_and_b32 v37, 0xffff0000, v88
    v_lshlrev_b32 v38, 16, v89
    v_and_b32 v39, 0xffff0000, v89
    v_lshlrev_b32 v40, 16, v90
    v_and_b32 v41, 0xffff0000, v90
    v_lshlrev_b32 v42, 16, v91
    v_and_b32 v43, 0xffff0000, v91
    v_lshlrev_b32 v44, 16, v90
    v_and_b32 v45, 0xffff0000, v90
    v_lshlrev_b32 v46, 16, v91
    v_and_b32 v47, 0xffff0000, v91
    v_lshlrev_b32 v48, 16, v90
    v_and_b32 v49, 0xffff0000, v90
    v_lshlrev_b32 v50, 16, v91
    v_and_b32 v51, 0xffff0000, v91
    v_lshlrev_b32 v52, 16, v90
    v_and_b32 v53, 0xffff0000, v90
    v_lshlrev_b32 v54, 16, v91
    v_and_b32 v55, 0xffff0000, v91
    v_lshlrev_b32 v56, 16, v92
    v_and_b32 v57, 0xffff0000, v92
    v_lshlrev_b32 v58, 16, v93
    v_and_b32 v59, 0xffff0000, v93
    v_lshlrev_b32 v60, 16, v92
    v_and_b32 v61, 0xffff0000, v92
    v_lshlrev_b32 v62, 16, v93
    v_and_b32 v63, 0xffff0000, v93
    v_lshlrev_b32 v64, 16, v92
    v_and_b32 v65, 0xffff0000, v92
    v_lshlrev_b32 v66, 16, v93
    v_and_b32 v67, 0xffff0000, v93
    v_lshlrev_b32 v68, 16, v92
    v_and_b32 v69, 0xffff0000, v92
    v_lshlrev_b32 v70, 16, v93
    v_and_b32 v71, 0xffff0000, v93
    v_lshlrev_b32 v72, 16, v94
    v_and_b32 v73, 0xffff0000, v94
    v_lshlrev_b32 v74, 16, v95
    v_and_b32 v75, 0xffff0000, v95
    v_lshlrev_b32 v76, 16, v94
    v_and_b32 v77, 0xffff0000, v94
    v_lshlrev_b32 v78, 16, v95
    v_and_b32 v79, 0xffff0000, v95
    v_lshlrev_b32 v80, 16, v94
    v_and_b32 v81, 0xffff0000, v94
    v_lshlrev_b32 v82, 16, v95
    v_and_b32 v83, 0xffff0000, v95
    v_lshlrev_b32 v84, 16, v94
    v_and_b32 v85, 0xffff0000, v94
    v_lshlrev_b32 v86, 16, v95
    v_and_b32 v87, 0xffff0000, v95
.p2align 3
g3_cloop:
    s_barrier
g3_cloop2:
    v_mfma_f32_16x16x32_bf16 v[24:27], v[120:123], v[136:139], v[24:27]
    ds_read_b64_tr_b16 v[88:89], v10 offset:0
    ds_read_b64_tr_b16 v[90:91], v10 offset:1024
    v_mfma_f32_16x16x32_bf16 v[28:31], v[120:123], v[140:143], v[28:31]
    ds_read_b64_tr_b16 v[104:105], v14 offset:0
    ds_read_b64_tr_b16 v[106:107], v14 offset:1024
    v_mfma_f32_16x16x32_bf16 v[32:35], v[120:123], v[144:147], v[32:35]
    ds_read_b64_tr_b16 v[108:109], v15 offset:0
    ds_read_b64_tr_b16 v[110:111], v15 offset:1024
    v_mfma_f32_16x16x32_bf16 v[36:39], v[120:123], v[148:151], v[36:39]
    ds_read_b64_tr_b16 v[112:113], v16 offset:0
    ds_read_b64_tr_b16 v[114:115], v16 offset:1024
    v_mfma_f32_16x16x32_bf16 v[40:43], v[124:127], v[136:139], v[40:43]
    ds_read_b64_tr_b16 v[116:117], v17 offset:0
    ds_read_b64_tr_b16 v[118:119], v17 offset:1024
    v_mfma_f32_16x16x32_bf16 v[44:47], v[124:127], v[140:143], v[44:47]
    ds_read_b64_tr_b16 v[92:93], v11 offset:0
    ds_read_b64_tr_b16 v[94:95], v11 offset:1024
    v_mfma_f32_16x16x32_bf16 v[48:51], v[124:127], v[144:147], v[48:51]
    ds_read_b64_tr_b16 v[96:97], v12 offset:0
    ds_read_b64_tr_b16 v[98:99], v12 offset:1024
    v_mfma_f32_16x16x32_bf16 v[52:55], v[124:127], v[148:151], v[52:55]
    ds_read_b64_tr_b16 v[100:101], v13 offset:0
    ds_read_b64_tr_b16 v[102:103], v13 offset:1024
    v_mfma_f32_16x16x32_bf16 v[56:59], v[128:131], v[136:139], v[56:59]
    v_mfma_f32_16x16x32_bf16 v[60:63], v[128:131], v[140:143], v[60:63]
    v_mfma_f32_16x16x32_bf16 v[64:67], v[128:131], v[144:147], v[64:67]
    v_mfma_f32_16x16x32_bf16 v[68:71], v[128:131], v[148:151], v[68:71]
    v_mfma_f32_16x16x32_bf16 v[72:75], v[132:135], v[136:139], v[72:75]
    v_mfma_f32_16x16x32_bf16 v[76:79], v[132:135], v[140:143], v[76:79]
    v_mfma_f32_16x16x32_bf16 v[80:83], v[132:135], v[144:147], v[80:83]
    v_mfma_f32_16x16x32_bf16 v[84:87], v[132:135], v[148:151], v[84:87]
    s_waitcnt lgkmcnt(0)
    v_mfma_f32_16x16x32_bf16 v[24:27], v[88:91], v[104:107], v[24:27]
    ds_read_b64_tr_b16 v[120:121], v10 offset:8192
    ds_read_b64_tr_b16 v[122:123], v10 offset:9216
    v_mfma_f32_16x16x32_bf16 v[28:31], v[88:91], v[108:111], v[28:31]
    ds_read_b64_tr_b16 v[136:137], v14 offset:8192
    ds_read_b64_tr_b16 v[138:139], v14 offset:9216
    v_mfma_f32_16x16x32_bf16 v[32:35], v[88:91], v[112:115], v[32:35]
    ds_read_b64_tr_b16 v[140:141], v15 offset:8192
    ds_read_b64_tr_b16 v[142:143], v15 offset:9216
    v_mfma_f32_16x16x32_bf16 v[36:39], v[88:91], v[116:119], v[36:39]
    ds_read_b64_tr_b16 v[144:145], v16 offset:8192
    ds_read_b64_tr_b16 v[146:147], v16 offset:9216
    v_mfma_f32_16x16x32_bf16 v[40:43], v[92:95], v[104:107], v[40:43]
    ds_read_b64_tr_b16 v[148:149], v17 offset:8192
    ds_read_b64_tr_b16 v[150:151], v17 offset:9216
    v_mfma_f32_16x16x32_bf16 v[44:47], v[92:95], v[108:111], v[44:47]
    ds_read_b64_tr_b16 v[124:125], v11 offset:8192
    ds_read_b64_tr_b16 v[126:127], v11 offset:9216
    v_mfma_f32_16x16x32_bf16 v[48:51], v[92:95], v[112:115], v[48:51]
    ds_read_b64_tr_b16 v[128:129], v12 offset:8192
    ds_read_b64_tr_b16 v[130:131], v12 offset:9216
    v_mfma_f32_16x16x32_bf16 v[52:55], v[92:95], v[116:119], v[52:55]
    ds_read_b64_tr_b16 v[132:133], v13 offset:8192
    ds_read_b64_tr_b16 v[134:135], v13 offset:9216
    v_mfma_f32_16x16x32_bf16 v[56:59], v[96:99], v[104:107], v[56:59]
    s_add_u32 s50, s50, 1
    s_cmp_eq_u32 s50, 4
    v_mfma_f32_16x16x32_bf16 v[60:63], v[96:99], v[108:111], v[60:63]
    s_cselect_b32 s49, s29, s51
    s_cselect_b32 s50, 0, s50
    v_mfma_f32_16x16x32_bf16 v[64:67], v[96:99], v[112:115], v[64:67]
    v_add_u32 v10, s49, v10
    v_add_u32 v11, s49, v11
    v_mfma_f32_16x16x32_bf16 v[68:71], v[96:99], v[116:119], v[68:71]
    v_add_u32 v12, s49, v12
    v_add_u32 v13, s49, v13
    v_mfma_f32_16x16x32_bf16 v[72:75], v[100:103], v[104:107], v[72:75]
    v_add_u32 v14, s49, v14
    v_add_u32 v15, s49, v15
    v_mfma_f32_16x16x32_bf16 v[76:79], v[100:103], v[108:111], v[76:79]
    v_add_u32 v16, s49, v16
    v_add_u32 v17, s49, v17
    v_mfma_f32_16x16x32_bf16 v[80:83], v[100:103], v[112:115], v[80:83]
    s_sub_u32 s48, s48, 1
    s_cmp_lg_u32 s48, 0
    v_mfma_f32_16x16x32_bf16 v[84:87], v[100:103], v[116:119], v[84:87]
    s_waitcnt lgkmcnt(0)
    s_cbranch_scc1 g3_cloop
    v_mfma_f32_16x16x32_bf16 v[24:27], v[120:123], v[136:139], v[24:27]
    v_mfma_f32_16x16x32_bf16 v[28:31], v[120:123], v[140:143], v[28:31]
    v_mfma_f32_16x16x32_bf16 v[32:35], v[120:123], v[144:147], v[32:35]
    v_mfma_f32_16x16x32_bf16 v[36:39], v[120:123], v[148:151], v[36:39]
    v_mfma_f32_16x16x32_bf16 v[40:43], v[124:127], v[136:139], v[40:43]
    v_mfma_f32_16x16x32_bf16 v[44:47], v[124:127], v[140:143], v[44:47]
    v_mfma_f32_16x16x32_bf16 v[48:51], v[124:127], v[144:147], v[48:51]
    v_mfma_f32_16x16x32_bf16 v[52:55], v[124:127], v[148:151], v[52:55]
    v_mfma_f32_16x16x32_bf16 v[56:59], v[128:131], v[136:139], v[56:59]
    v_mfma_f32_16x16x32_bf16 v[60:63], v[128:131], v[140:143], v[60:63]
    v_mfma_f32_16x16x32_bf16 v[64:67], v[128:131], v[144:147], v[64:67]
    v_mfma_f32_16x16x32_bf16 v[68:71], v[128:131], v[148:151], v[68:71]
    v_mfma_f32_16x16x32_bf16 v[72:75], v[132:135], v[136:139], v[72:75]
    v_mfma_f32_16x16x32_bf16 v[76:79], v[132:135], v[140:143], v[76:79]
    v_mfma_f32_16x16x32_bf16 v[80:83], v[132:135], v[144:147], v[80:83]
    v_mfma_f32_16x16x32_bf16 v[84:87], v[132:135], v[148:151], v[84:87]
    v_mov_b32 v10, 0xbdd2d3e8
    v_mov_b32 v11, 0xbdd2d3e8
    v_mov_b32 v12, 0xc0135761
    v_mov_b32 v13, 0xc0135761
    v_mov_b32 v14, 0x3f800000
    v_mov_b32 v15, 0x3f800000
    s_nop 7
    v_pk_mul_f32 v[104:105], v[24:25], v[24:25]
    v_pk_mul_f32 v[106:107], v[26:27], v[26:27]
    v_pk_mul_f32 v[108:109], v[40:41], v[40:41]
    v_pk_mul_f32 v[110:111], v[42:43], v[42:43]
    v_pk_fma_f32 v[104:105], v[104:105], v[10:11], v[12:13]
    v_pk_fma_f32 v[106:107], v[106:107], v[10:11], v[12:13]
    v_pk_fma_f32 v[108:109], v[108:109], v[10:11], v[12:13]
    v_pk_fma_f32 v[110:111], v[110:111], v[10:11], v[12:13]
    v_pk_mul_f32 v[104:105], v[104:105], v[24:25]
    v_pk_mul_f32 v[106:107], v[106:107], v[26:27]
    v_pk_mul_f32 v[108:109], v[108:109], v[40:41]
    v_pk_mul_f32 v[110:111], v[110:111], v[42:43]
    v_exp_f32 v104, v104
    v_exp_f32 v105, v105
    v_exp_f32 v106, v106
    v_exp_f32 v107, v107
    v_exp_f32 v108, v108
    v_exp_f32 v109, v109
    v_exp_f32 v110, v110
    v_exp_f32 v111, v111
    v_pk_add_f32 v[104:105], v[104:105], v[14:15]
    v_pk_add_f32 v[106:107], v[106:107], v[14:15]
    v_pk_add_f32 v[108:109], v[108:109], v[14:15]
    v_pk_add_f32 v[110:111], v[110:111], v[14:15]
    v_rcp_f32 v104, v104
    v_rcp_f32 v105, v105
    v_rcp_f32 v106, v106
    v_rcp_f32 v107, v107
    v_rcp_f32 v108, v108
    v_rcp_f32 v109, v109
    v_rcp_f32 v110, v110
    v_rcp_f32 v111, v111
    v_pk_mul_f32 v[24:25], v[24:25], v[104:105]
    v_pk_mul_f32 v[26:27], v[26:27], v[106:107]
    v_pk_mul_f32 v[40:41], v[40:41], v[108:109]
    v_pk_mul_f32 v[42:43], v[42:43], v[110:111]
    v_cvt_pk_bf16_f32 v88, v24, v25
    v_cvt_pk_bf16_f32 v89, v26, v27
    v_cvt_pk_bf16_f32 v90, v40, v41
    v_cvt_pk_bf16_f32 v91, v42, v43
    s_nop 1
    v_permlane16_swap_b32 v88, v90
    v_permlane16_swap_b32 v89, v91
    buffer_store_dwordx4 v[88:91], v9, s[16:19], s52 offen offset:0 sc1
    v_pk_mul_f32 v[104:105], v[56:57], v[56:57]
    v_pk_mul_f32 v[106:107], v[58:59], v[58:59]
    v_pk_mul_f32 v[108:109], v[72:73], v[72:73]
    v_pk_mul_f32 v[110:111], v[74:75], v[74:75]
    v_pk_fma_f32 v[104:105], v[104:105], v[10:11], v[12:13]
    v_pk_fma_f32 v[106:107], v[106:107], v[10:11], v[12:13]
    v_pk_fma_f32 v[108:109], v[108:109], v[10:11], v[12:13]
    v_pk_fma_f32 v[110:111], v[110:111], v[10:11], v[12:13]
    v_pk_mul_f32 v[104:105], v[104:105], v[56:57]
    v_pk_mul_f32 v[106:107], v[106:107], v[58:59]
    v_pk_mul_f32 v[108:109], v[108:109], v[72:73]
    v_pk_mul_f32 v[110:111], v[110:111], v[74:75]
    v_exp_f32 v104, v104
    v_exp_f32 v105, v105
    v_exp_f32 v106, v106
    v_exp_f32 v107, v107
    v_exp_f32 v108, v108
    v_exp_f32 v109, v109
    v_exp_f32 v110, v110
    v_exp_f32 v111, v111
    v_pk_add_f32 v[104:105], v[104:105], v[14:15]
    v_pk_add_f32 v[106:107], v[106:107], v[14:15]
    v_pk_add_f32 v[108:109], v[108:109], v[14:15]
    v_pk_add_f32 v[110:111], v[110:111], v[14:15]
    v_rcp_f32 v104, v104
    v_rcp_f32 v105, v105
    v_rcp_f32 v106, v106
    v_rcp_f32 v107, v107
    v_rcp_f32 v108, v108
    v_rcp_f32 v109, v109
    v_rcp_f32 v110, v110
    v_rcp_f32 v111, v111
    v_pk_mul_f32 v[56:57], v[56:57], v[104:105]
    v_pk_mul_f32 v[58:59], v[58:59], v[106:107]
    v_pk_mul_f32 v[72:73], v[72:73], v[108:109]
    v_pk_mul_f32 v[74:75], v[74:75], v[110:111]
    v_cvt_pk_bf16_f32 v92, v56, v57
    v_cvt_pk_bf16_f32 v93, v58, v59
    v_cvt_pk_bf16_f32 v94, v72, v73
    v_cvt_pk_bf16_f32 v95, v74, v75
    s_nop 1
    v_permlane16_swap_b32 v92, v94
    v_permlane16_swap_b32 v93, v95
    buffer_store_dwordx4 v[92:95], v9, s[16:19], s52 offen offset:64 sc1
    v_pk_mul_f32 v[104:105], v[28:29], v[28:29]
    v_pk_mul_f32 v[106:107], v[30:31], v[30:31]
    v_pk_mul_f32 v[108:109], v[44:45], v[44:45]
    v_pk_mul_f32 v[110:111], v[46:47], v[46:47]
    v_pk_fma_f32 v[104:105], v[104:105], v[10:11], v[12:13]
    v_pk_fma_f32 v[106:107], v[106:107], v[10:11], v[12:13]
    v_pk_fma_f32 v[108:109], v[108:109], v[10:11], v[12:13]
    v_pk_fma_f32 v[110:111], v[110:111], v[10:11], v[12:13]
    v_pk_mul_f32 v[104:105], v[104:105], v[28:29]
    v_pk_mul_f32 v[106:107], v[106:107], v[30:31]
    v_pk_mul_f32 v[108:109], v[108:109], v[44:45]
    v_pk_mul_f32 v[110:111], v[110:111], v[46:47]
    v_exp_f32 v104, v104
    v_exp_f32 v105, v105
    v_exp_f32 v106, v106
    v_exp_f32 v107, v107
    v_exp_f32 v108, v108
    v_exp_f32 v109, v109
    v_exp_f32 v110, v110
    v_exp_f32 v111, v111
    v_pk_add_f32 v[104:105], v[104:105], v[14:15]
    v_pk_add_f32 v[106:107], v[106:107], v[14:15]
    v_pk_add_f32 v[108:109], v[108:109], v[14:15]
    v_pk_add_f32 v[110:111], v[110:111], v[14:15]
    v_rcp_f32 v104, v104
    v_rcp_f32 v105, v105
    v_rcp_f32 v106, v106
    v_rcp_f32 v107, v107
    v_rcp_f32 v108, v108
    v_rcp_f32 v109, v109
    v_rcp_f32 v110, v110
    v_rcp_f32 v111, v111
    v_pk_mul_f32 v[28:29], v[28:29], v[104:105]
    v_pk_mul_f32 v[30:31], v[30:31], v[106:107]
    v_pk_mul_f32 v[44:45], v[44:45], v[108:109]
    v_pk_mul_f32 v[46:47], v[46:47], v[110:111]
    v_cvt_pk_bf16_f32 v96, v28, v29
    v_cvt_pk_bf16_f32 v97, v30, v31
    v_cvt_pk_bf16_f32 v98, v44, v45
    v_cvt_pk_bf16_f32 v99, v46, v47
    s_nop 1
    v_permlane16_swap_b32 v96, v98
    v_permlane16_swap_b32 v97, v99
    buffer_store_dwordx4 v[96:99], v9, s[16:19], s53 offen offset:0 sc1
    v_pk_mul_f32 v[104:105], v[60:61], v[60:61]
    v_pk_mul_f32 v[106:107], v[62:63], v[62:63]
    v_pk_mul_f32 v[108:109], v[76:77], v[76:77]
    v_pk_mul_f32 v[110:111], v[78:79], v[78:79]
    v_pk_fma_f32 v[104:105], v[104:105], v[10:11], v[12:13]
    v_pk_fma_f32 v[106:107], v[106:107], v[10:11], v[12:13]
    v_pk_fma_f32 v[108:109], v[108:109], v[10:11], v[12:13]
    v_pk_fma_f32 v[110:111], v[110:111], v[10:11], v[12:13]
    v_pk_mul_f32 v[104:105], v[104:105], v[60:61]
    v_pk_mul_f32 v[106:107], v[106:107], v[62:63]
    v_pk_mul_f32 v[108:109], v[108:109], v[76:77]
    v_pk_mul_f32 v[110:111], v[110:111], v[78:79]
    v_exp_f32 v104, v104
    v_exp_f32 v105, v105
    v_exp_f32 v106, v106
    v_exp_f32 v107, v107
    v_exp_f32 v108, v108
    v_exp_f32 v109, v109
    v_exp_f32 v110, v110
    v_exp_f32 v111, v111
    v_pk_add_f32 v[104:105], v[104:105], v[14:15]
    v_pk_add_f32 v[106:107], v[106:107], v[14:15]
    v_pk_add_f32 v[108:109], v[108:109], v[14:15]
    v_pk_add_f32 v[110:111], v[110:111], v[14:15]
    v_rcp_f32 v104, v104
    v_rcp_f32 v105, v105
    v_rcp_f32 v106, v106
    v_rcp_f32 v107, v107
    v_rcp_f32 v108, v108
    v_rcp_f32 v109, v109
    v_rcp_f32 v110, v110
    v_rcp_f32 v111, v111
    v_pk_mul_f32 v[60:61], v[60:61], v[104:105]
    v_pk_mul_f32 v[62:63], v[62:63], v[106:107]
    v_pk_mul_f32 v[76:77], v[76:77], v[108:109]
    v_pk_mul_f32 v[78:79], v[78:79], v[110:111]
    v_cvt_pk_bf16_f32 v100, v60, v61
    v_cvt_pk_bf16_f32 v101, v62, v63
    v_cvt_pk_bf16_f32 v102, v76, v77
    v_cvt_pk_bf16_f32 v103, v78, v79
    s_nop 1
    v_permlane16_swap_b32 v100, v102
    v_permlane16_swap_b32 v101, v103
    buffer_store_dwordx4 v[100:103], v9, s[16:19], s53 offen offset:64 sc1
    v_pk_mul_f32 v[104:105], v[32:33], v[32:33]
    v_pk_mul_f32 v[106:107], v[34:35], v[34:35]
    v_pk_mul_f32 v[108:109], v[48:49], v[48:49]
    v_pk_mul_f32 v[110:111], v[50:51], v[50:51]
    v_pk_fma_f32 v[104:105], v[104:105], v[10:11], v[12:13]
    v_pk_fma_f32 v[106:107], v[106:107], v[10:11], v[12:13]
    v_pk_fma_f32 v[108:109], v[108:109], v[10:11], v[12:13]
    v_pk_fma_f32 v[110:111], v[110:111], v[10:11], v[12:13]
    v_pk_mul_f32 v[104:105], v[104:105], v[32:33]
    v_pk_mul_f32 v[106:107], v[106:107], v[34:35]
    v_pk_mul_f32 v[108:109], v[108:109], v[48:49]
    v_pk_mul_f32 v[110:111], v[110:111], v[50:51]
    v_exp_f32 v104, v104
    v_exp_f32 v105, v105
    v_exp_f32 v106, v106
    v_exp_f32 v107, v107
    v_exp_f32 v108, v108
    v_exp_f32 v109, v109
    v_exp_f32 v110, v110
    v_exp_f32 v111, v111
    v_pk_add_f32 v[104:105], v[104:105], v[14:15]
    v_pk_add_f32 v[106:107], v[106:107], v[14:15]
    v_pk_add_f32 v[108:109], v[108:109], v[14:15]
    v_pk_add_f32 v[110:111], v[110:111], v[14:15]
    v_rcp_f32 v104, v104
    v_rcp_f32 v105, v105
    v_rcp_f32 v106, v106
    v_rcp_f32 v107, v107
    v_rcp_f32 v108, v108
    v_rcp_f32 v109, v109
    v_rcp_f32 v110, v110
    v_rcp_f32 v111, v111
    v_pk_mul_f32 v[32:33], v[32:33], v[104:105]
    v_pk_mul_f32 v[34:35], v[34:35], v[106:107]
    v_pk_mul_f32 v[48:49], v[48:49], v[108:109]
    v_pk_mul_f32 v[50:51], v[50:51], v[110:111]
    v_cvt_pk_bf16_f32 v88, v32, v33
    v_cvt_pk_bf16_f32 v89, v34, v35
    v_cvt_pk_bf16_f32 v90, v48, v49
    v_cvt_pk_bf16_f32 v91, v50, v51
    s_nop 1
    v_permlane16_swap_b32 v88, v90
    v_permlane16_swap_b32 v89, v91
    buffer_store_dwordx4 v[88:91], v9, s[16:19], s54 offen offset:0 sc1
    v_pk_mul_f32 v[104:105], v[64:65], v[64:65]
    v_pk_mul_f32 v[106:107], v[66:67], v[66:67]
    v_pk_mul_f32 v[108:109], v[80:81], v[80:81]
    v_pk_mul_f32 v[110:111], v[82:83], v[82:83]
    v_pk_fma_f32 v[104:105], v[104:105], v[10:11], v[12:13]
    v_pk_fma_f32 v[106:107], v[106:107], v[10:11], v[12:13]
    v_pk_fma_f32 v[108:109], v[108:109], v[10:11], v[12:13]
    v_pk_fma_f32 v[110:111], v[110:111], v[10:11], v[12:13]
    v_pk_mul_f32 v[104:105], v[104:105], v[64:65]
    v_pk_mul_f32 v[106:107], v[106:107], v[66:67]
    v_pk_mul_f32 v[108:109], v[108:109], v[80:81]
    v_pk_mul_f32 v[110:111], v[110:111], v[82:83]
    v_exp_f32 v104, v104
    v_exp_f32 v105, v105
    v_exp_f32 v106, v106
    v_exp_f32 v107, v107
    v_exp_f32 v108, v108
    v_exp_f32 v109, v109
    v_exp_f32 v110, v110
    v_exp_f32 v111, v111
    v_pk_add_f32 v[104:105], v[104:105], v[14:15]
    v_pk_add_f32 v[106:107], v[106:107], v[14:15]
    v_pk_add_f32 v[108:109], v[108:109], v[14:15]
    v_pk_add_f32 v[110:111], v[110:111], v[14:15]
    v_rcp_f32 v104, v104
    v_rcp_f32 v105, v105
    v_rcp_f32 v106, v106
    v_rcp_f32 v107, v107
    v_rcp_f32 v108, v108
    v_rcp_f32 v109, v109
    v_rcp_f32 v110, v110
    v_rcp_f32 v111, v111
    v_pk_mul_f32 v[64:65], v[64:65], v[104:105]
    v_pk_mul_f32 v[66:67], v[66:67], v[106:107]
    v_pk_mul_f32 v[80:81], v[80:81], v[108:109]
    v_pk_mul_f32 v[82:83], v[82:83], v[110:111]
    v_cvt_pk_bf16_f32 v92, v64, v65
    v_cvt_pk_bf16_f32 v93, v66, v67
    v_cvt_pk_bf16_f32 v94, v80, v81
    v_cvt_pk_bf16_f32 v95, v82, v83
    s_nop 1
    v_permlane16_swap_b32 v92, v94
    v_permlane16_swap_b32 v93, v95
    buffer_store_dwordx4 v[92:95], v9, s[16:19], s54 offen offset:64 sc1
    v_pk_mul_f32 v[104:105], v[36:37], v[36:37]
    v_pk_mul_f32 v[106:107], v[38:39], v[38:39]
    v_pk_mul_f32 v[108:109], v[52:53], v[52:53]
    v_pk_mul_f32 v[110:111], v[54:55], v[54:55]
    v_pk_fma_f32 v[104:105], v[104:105], v[10:11], v[12:13]
    v_pk_fma_f32 v[106:107], v[106:107], v[10:11], v[12:13]
    v_pk_fma_f32 v[108:109], v[108:109], v[10:11], v[12:13]
    v_pk_fma_f32 v[110:111], v[110:111], v[10:11], v[12:13]
    v_pk_mul_f32 v[104:105], v[104:105], v[36:37]
    v_pk_mul_f32 v[106:107], v[106:107], v[38:39]
    v_pk_mul_f32 v[108:109], v[108:109], v[52:53]
    v_pk_mul_f32 v[110:111], v[110:111], v[54:55]
    v_exp_f32 v104, v104
    v_exp_f32 v105, v105
    v_exp_f32 v106, v106
    v_exp_f32 v107, v107
    v_exp_f32 v108, v108
    v_exp_f32 v109, v109
    v_exp_f32 v110, v110
    v_exp_f32 v111, v111
    v_pk_add_f32 v[104:105], v[104:105], v[14:15]
    v_pk_add_f32 v[106:107], v[106:107], v[14:15]
    v_pk_add_f32 v[108:109], v[108:109], v[14:15]
    v_pk_add_f32 v[110:111], v[110:111], v[14:15]
    v_rcp_f32 v104, v104
    v_rcp_f32 v105, v105
    v_rcp_f32 v106, v106
    v_rcp_f32 v107, v107
    v_rcp_f32 v108, v108
    v_rcp_f32 v109, v109
    v_rcp_f32 v110, v110
    v_rcp_f32 v111, v111
    v_pk_mul_f32 v[36:37], v[36:37], v[104:105]
    v_pk_mul_f32 v[38:39], v[38:39], v[106:107]
    v_pk_mul_f32 v[52:53], v[52:53], v[108:109]
    v_pk_mul_f32 v[54:55], v[54:55], v[110:111]
    v_cvt_pk_bf16_f32 v96, v36, v37
    v_cvt_pk_bf16_f32 v97, v38, v39
    v_cvt_pk_bf16_f32 v98, v52, v53
    v_cvt_pk_bf16_f32 v99, v54, v55
    s_nop 1
    v_permlane16_swap_b32 v96, v98
    v_permlane16_swap_b32 v97, v99
    buffer_store_dwordx4 v[96:99], v9, s[16:19], s55 offen offset:0 sc1
    v_pk_mul_f32 v[104:105], v[68:69], v[68:69]
    v_pk_mul_f32 v[106:107], v[70:71], v[70:71]
    v_pk_mul_f32 v[108:109], v[84:85], v[84:85]
    v_pk_mul_f32 v[110:111], v[86:87], v[86:87]
    v_pk_fma_f32 v[104:105], v[104:105], v[10:11], v[12:13]
    v_pk_fma_f32 v[106:107], v[106:107], v[10:11], v[12:13]
    v_pk_fma_f32 v[108:109], v[108:109], v[10:11], v[12:13]
    v_pk_fma_f32 v[110:111], v[110:111], v[10:11], v[12:13]
    v_pk_mul_f32 v[104:105], v[104:105], v[68:69]
    v_pk_mul_f32 v[106:107], v[106:107], v[70:71]
    v_pk_mul_f32 v[108:109], v[108:109], v[84:85]
    v_pk_mul_f32 v[110:111], v[110:111], v[86:87]
    v_exp_f32 v104, v104
    v_exp_f32 v105, v105
    v_exp_f32 v106, v106
    v_exp_f32 v107, v107
    v_exp_f32 v108, v108
    v_exp_f32 v109, v109
    v_exp_f32 v110, v110
    v_exp_f32 v111, v111
    v_pk_add_f32 v[104:105], v[104:105], v[14:15]
    v_pk_add_f32 v[106:107], v[106:107], v[14:15]
    v_pk_add_f32 v[108:109], v[108:109], v[14:15]
    v_pk_add_f32 v[110:111], v[110:111], v[14:15]
    v_rcp_f32 v104, v104
    v_rcp_f32 v105, v105
    v_rcp_f32 v106, v106
    v_rcp_f32 v107, v107
    v_rcp_f32 v108, v108
    v_rcp_f32 v109, v109
    v_rcp_f32 v110, v110
    v_rcp_f32 v111, v111
    v_pk_mul_f32 v[68:69], v[68:69], v[104:105]
    v_pk_mul_f32 v[70:71], v[70:71], v[106:107]
    v_pk_mul_f32 v[84:85], v[84:85], v[108:109]
    v_pk_mul_f32 v[86:87], v[86:87], v[110:111]
    v_cvt_pk_bf16_f32 v100, v68, v69
    v_cvt_pk_bf16_f32 v101, v70, v71
    v_cvt_pk_bf16_f32 v102, v84, v85
    v_cvt_pk_bf16_f32 v103, v86, v87
    s_nop 1
    v_permlane16_swap_b32 v100, v102
    v_permlane16_swap_b32 v101, v103
    buffer_store_dwordx4 v[100:103], v9, s[16:19], s55 offen offset:64 sc1
    s_endpgm
g3_spare:
    s_cmp_ge_u32 s2, s47
    s_cbranch_scc1 g3_done
    s_load_dwordx2 s[4:5], s[0:1], 48
    s_sub_u32 s3, s2, 224
    s_mul_i32 s3, s3, 458752
    v_lshlrev_b32 v1, 4, v0
    s_mov_b32 s12, 7
    s_waitcnt lgkmcnt(0)
    s_mov_b32 s8, s4
    s_mov_b32 s9, s5
    s_mov_b32 s10, 0xe00000
    s_mov_b32 s11, 0x20000
g3_spare_loop:
    buffer_load_dwordx4 v[4:7], v1, s[8:11], s3 offen
    s_add_u32 s3, s3, 8192
    buffer_load_dwordx4 v[4:7], v1, s[8:11], s3 offen
    s_add_u32 s3, s3, 8192
    buffer_load_dwordx4 v[4:7], v1, s[8:11], s3 offen
    s_add_u32 s3, s3, 8192
    buffer_load_dwordx4 v[4:7], v1, s[8:11], s3 offen
    s_add_u32 s3, s3, 8192
    buffer_load_dwordx4 v[4:7], v1, s[8:11], s3 offen
    s_add_u32 s3, s3, 8192
    buffer_load_dwordx4 v[4:7], v1, s[8:11], s3 offen
    s_add_u32 s3, s3, 8192
    buffer_load_dwordx4 v[4:7], v1, s[8:11], s3 offen
    s_add_u32 s3, s3, 8192
    buffer_load_dwordx4 v[4:7], v1, s[8:11], s3 offen
    s_add_u32 s3, s3, 8192
    s_waitcnt vmcnt(8)
    s_sub_u32 s12, s12, 1
    s_cmp_lg_u32 s12, 0
    s_cbranch_scc1 g3_spare_loop
    s_endpgm
.section .rodata,"a"
.p2align 6
.amdhsa_kernel g3a_kernel
  .amdhsa_next_free_vgpr 152
  .amdhsa_next_free_sgpr 72
  .amdhsa_accum_offset 152
  .amdhsa_group_segment_fixed_size 0
  .amdhsa_kernarg_size 88
  .amdhsa_user_sgpr_count 2
  .amdhsa_user_sgpr_kernarg_segment_ptr 1
  .amdhsa_system_sgpr_workgroup_id_x 1
.end_amdhsa_kernel
.section .rodata,"a"
.p2align 6
.amdhsa_kernel g3b_kernel
  .amdhsa_next_free_vgpr 152
  .amdhsa_next_free_sgpr 72
  .amdhsa_accum_offset 152
  .amdhsa_group_segment_fixed_size 0
  .amdhsa_kernarg_size 88
  .amdhsa_user_sgpr_count 2
  .amdhsa_user_sgpr_kernarg_segment_ptr 1
  .amdhsa_system_sgpr_workgroup_id_x 1
.end_amdhsa_kernel
.text
.globl g4a_kernel
.p2align 8
.type g4a_kernel,@function
g4a_kernel:
    s_load_dwordx2 s[6:7], s[0:1], 80
    s_mov_b32 s47, 0x1800000
    s_branch g4_body
.text
.globl g4b_kernel
.p2align 8
.type g4b_kernel,@function
g4b_kernel:
    s_load_dwordx2 s[6:7], s[0:1], 64
    s_mov_b32 s47, 0
    s_branch g4_body
.p2align 6
g4_body:
    s_cmp_ge_u32 s2, 256
    s_cbranch_scc1 g4_done
    s_load_dwordx2 s[4:5], s[0:1], 80
    s_load_dwordx2 s[30:31], s[0:1], 48
    s_load_dwordx2 s[34:35], s[0:1], 56
    v_lshrrev_b32 v1, 6, v0
    v_and_b32 v2, 63, v0
    s_and_b32 s40, s2, 3
    s_lshl_b32 s40, s40, 2
    s_bfe_u32 s41, s2, 0x20003
    s_add_u32 s25, s40, s41
    s_bfe_u32 s40, s2, 0x10002
    s_lshl_b32 s40, s40, 3
    s_lshr_b32 s42, s2, 5
    s_add_u32 s24, s40, s42
    s_add_u32 s27, s41, s42
    s_mov_b32 s26, 0
    v_readfirstlane_b32 s28, v1
    s_nop 0
    s_cmp_lt_u32 s28, 4
    s_cbranch_scc1 g4_compute
    s_sub_u32 s28, s28, 4
    s_mov_b32 s40, 7168
    v_lshrrev_b32 v3, 3, v2
    v_mul_lo_u32 v3, v3, s40
    v_lshrrev_b32 v4, 4, v2
    v_xor_b32 v4, v4, v2
    v_and_b32 v4, 7, v4
    v_lshl_add_u32 v3, v4, 4, v3
    s_mul_i32 s41, s24, 458752
    s_mul_i32 s42, s28, 114688
    s_add_u32 s41, s41, s42
    v_xor_b32 v4, 64, v3
    s_add_u32 s42, s41, 0
    v_add_u32 v10, s42, v3
    s_add_u32 s42, s41, 57344
    v_add_u32 v11, s42, v4
    s_mov_b32 s40, 4096
    v_lshrrev_b32 v4, 4, v2
    v_mul_lo_u32 v3, v4, s40
    v_lshlrev_b32 v4, 1, v4
    v_xor_b32 v4, v4, v2
    v_and_b32 v4, 15, v4
    v_lshl_add_u32 v3, v4, 4, v3
    s_mul_i32 s41, s25, 256
    s_mul_i32 s42, s28, 65536
    s_add_u32 s41, s41, s42
    v_xor_b32 v4, 128, v3
    s_add_u32 s42, s41, 0
    v_add_u32 v12, s42, v3
    s_add_u32 s42, s41, 16384
    v_add_u32 v13, s42, v3
    s_add_u32 s42, s41, 32768
    v_add_u32 v14, s42, v4
    s_add_u32 s42, s41, 49152
    v_add_u32 v15, s42, v4
    s_mul_i32 s36, s28, 2048
    s_mul_i32 s37, s28, 4096
    s_add_u32 s37, s37, 8192
    s_waitcnt lgkmcnt(0)
    s_add_u32 s8, s4, 0x1000000
    s_addc_u32 s9, s5, 0
    s_mov_b32 s10, 0x700000
    s_mov_b32 s11, 0x20000
    s_mov_b32 s12, s30
    s_mov_b32 s13, s31
    s_mov_b32 s14, 0xe00000
    s_mov_b32 s15, 0x20000
    s_mov_b32 s32, 0
    s_mov_b32 s33, 0
g4_ld_loop:
    s_cmp_lt_u32 s32, 3
    s_cbranch_scc1 g4_ld_issue
    s_waitcnt vmcnt(12)
g4_ld_bar:
    s_barrier
g4_ld_issue:
    s_add_u32 s40, s32, s27
    s_and_b32 s40, s40, 3
    s_andn2_b32 s41, s32, 3
    s_or_b32 s40, s40, s41
    s_add_u32 s40, s40, s26
    s_mul_i32 s34, s40, 128
    s_mul_i32 s35, s40, 262144
    s_add_u32 s38, s33, s36
    s_add_u32 s39, s33, s37
    s_add_u32 m0, s38, 0
    s_nop 0
    buffer_load_dwordx4 v10, s[8:11], s34 offen lds
    s_add_u32 m0, s38, 1024
    s_nop 0
    buffer_load_dwordx4 v11, s[8:11], s34 offen lds
    s_add_u32 m0, s39, 0
    s_nop 0
    buffer_load_dwordx4 v12, s[12:15], s35 offen lds
    s_add_u32 m0, s39, 1024
    s_nop 0
    buffer_load_dwordx4 v13, s[12:15], s35 offen lds
    s_add_u32 m0, s39, 2048
    s_nop 0
    buffer_load_dwordx4 v14, s[12:15], s35 offen lds
    s_add_u32 m0, s39, 3072
    s_nop 0
    buffer_load_dwordx4 v15, s[12:15], s35 offen lds
    s_add_u32 s33, s33, 24576
    s_cmp_eq_u32 s33, 98304
    s_cselect_b32 s33, 0, s33
    s_add_u32 s32, s32, 1
    s_cmp_lt_u32 s32, 56
    s_cbranch_scc1 g4_ld_loop
    s_waitcnt vmcnt(12)
    s_barrier
    s_waitcnt vmcnt(6)
    s_barrier
    s_waitcnt vmcnt(0)
    s_barrier
g4_done:
    s_endpgm
g4_compute:
    v_lshrrev_b32 v5, 4, v2
    v_bfe_u32 v6, v2, 2, 2
    v_and_b32 v7, 3, v2
    v_and_b32 v8, 15, v2
    s_and_b32 s44, s28, 0
    s_lshr_b32 s45, s28, 0
    s_mul_i32 s40, s25, 128
    s_mul_i32 s41, s45, 32
    s_add_u32 s40, s40, s41
    v_add_u32 v20, s40, v8
    s_mov_b32 s41, 2048
    v_mul_lo_u32 v9, v20, s41
    s_mul_i32 s40, s24, 128
    s_mul_i32 s41, s44, 128
    s_add_u32 s46, s40, s41
    v_and_b32 v3, 1, v5
    v_lshlrev_b32 v3, 5, v3
    v_lshrrev_b32 v4, 1, v5
    v_lshl_add_u32 v3, v4, 4, v3
    v_add3_u32 v9, v9, v3, s46
    s_mov_b32 s52, 0
    s_mov_b32 s53, 32768
    s_waitcnt lgkmcnt(0)
    s_add_u32 s20, s4, 0x800000
    s_addc_u32 s21, s5, 0
    s_mov_b32 s22, 0x400000
    s_mov_b32 s23, 0x20000
    s_mov_b32 s56, s34
    s_mov_b32 s57, s35
    s_mov_b32 s58, 0x1000
    s_mov_b32 s59, 0x20000
    s_add_u32 s16, s6, s47
    s_addc_u32 s17, s7, 0
    s_mov_b32 s18, 0x400000
    s_mov_b32 s19, 0x20000
    s_mov_b32 s60, s4
    s_mov_b32 s61, s5
    s_mov_b32 s62, 0x40000
    s_mov_b32 s63, 0x20000
    buffer_load_dwordx4 v[56:59], v9, s[20:23], s52 offen offset:0
    buffer_load_dwordx4 v[60:63], v9, s[20:23], s52 offen offset:64
    buffer_load_dwordx4 v[64:67], v9, s[20:23], s53 offen offset:0
    buffer_load_dwordx4 v[68:71], v9, s[20:23], s53 offen offset:64
    v_lshlrev_b32 v3, 1, v20
    buffer_load_ushort v22, v3, s[56:59], 0 offen offset:0
    buffer_load_ushort v23, v3, s[56:59], 0 offen offset:32
    s_mul_i32 s42, s44, 64
    v_lshrrev_b32 v3, 1, v8
    v_xor_b32 v3, v3, v5
    v_lshlrev_b32 v3, 4, v3
    v_lshl_add_u32 v3, v8, 7, v3
    s_lshl_b32 s40, s42, 7
    s_add_u32 s40, s40, 0
    v_add_u32 v10, s40, v3
    v_xor_b32 v11, 64, v10
    s_mul_i32 s42, s45, 2
    s_mov_b32 s43, 8192
    v_and_b32 v3, 1, v5
    v_lshl_or_b32 v3, v3, 2, v6
    s_add_u32 s40, s42, 0
    v_xor_b32 v3, s40, v3
    v_lshlrev_b32 v3, 5, v3
    v_lshl_add_u32 v3, v7, 3, v3
    v_lshl_add_u32 v4, v5, 3, v6
    v_lshl_add_u32 v3, v4, 8, v3
    v_add_u32 v12, s43, v3
    v_and_b32 v3, 1, v5
    v_lshl_or_b32 v3, v3, 2, v6
    s_add_u32 s40, s42, 1
    v_xor_b32 v3, s40, v3
    v_lshlrev_b32 v3, 5, v3
    v_lshl_add_u32 v3, v7, 3, v3
    v_lshl_add_u32 v4, v5, 3, v6
    v_lshl_add_u32 v3, v4, 8, v3
    v_add_u32 v13, s43, v3
    v_mov_b32 v80, 0
    v_mov_b32 v81, 0
    v_mov_b32 v82, 0
    v_mov_b32 v83, 0
    v_mov_b32 v84, 0
    v_mov_b32 v85, 0
    v_mov_b32 v86, 0
    v_mov_b32 v87, 0
    v_mov_b32 v88, 0
    v_mov_b32 v89, 0
    v_mov_b32 v90, 0
    v_mov_b32 v91, 0
    v_mov_b32 v92, 0
    v_mov_b32 v93, 0
    v_mov_b32 v94, 0
    v_mov_b32 v95, 0
    v_mov_b32 v96, 0
    v_mov_b32 v97, 0
    v_mov_b32 v98, 0
    v_mov_b32 v99, 0
    v_mov_b32 v100, 0
    v_mov_b32 v101, 0
    v_mov_b32 v102, 0
    v_mov_b32 v103, 0
    s_mov_b32 s48, 56
    s_mov_b32 s50, 0
    s_mov_b32 s51, 24576
    s_mov_b32 s29, 0xfffee000
    s_waitcnt vmcnt(0)
    v_permlane16_swap_b32 v56, v58
    v_permlane16_swap_b32 v57, v59
    v_permlane16_swap_b32 v60, v62
    v_permlane16_swap_b32 v61, v63
    v_permlane16_swap_b32 v64, v66
    v_permlane16_swap_b32 v65, v67
    v_permlane16_swap_b32 v68, v70
    v_permlane16_swap_b32 v69, v71
    v_lshlrev_b32 v22, 16, v22
    v_lshlrev_b32 v23, 16, v23
    v_lshlrev_b32 v24, 16, v56
    v_and_b32 v25, 0xffff0000, v56
    v_lshlrev_b32 v26, 16, v57
    v_and_b32 v27, 0xffff0000, v57
    v_add_f32 v24, v24, v22
    v_add_f32 v25, v25, v22
    v_add_f32 v26, v26, v22
    v_add_f32 v27, v27, v22
    v_lshlrev_b32 v32, 16, v58
    v_and_b32 v33, 0xffff0000, v58
    v_lshlrev_b32 v34, 16, v59
    v_and_b32 v35, 0xffff0000, v59
    v_add_f32 v32, v32, v22
    v_add_f32 v33, v33, v22
    v_add_f32 v34, v34, v22
    v_add_f32 v35, v35, v22
    v_lshlrev_b32 v40, 16, v60
    v_and_b32 v41, 0xffff0000, v60
    v_lshlrev_b32 v42, 16, v61
    v_and_b32 v43, 0xffff0000, v61
    v_add_f32 v40, v40, v22
    v_add_f32 v41, v41, v22
    v_add_f32 v42, v42, v22
    v_add_f32 v43, v43, v22
    v_lshlrev_b32 v48, 16, v62
    v_and_b32 v49, 0xffff0000, v62
    v_lshlrev_b32 v50, 16, v63
    v_and_b32 v51, 0xffff0000, v63
    v_add_f32 v48, v48, v22
    v_add_f32 v49, v49, v22
    v_add_f32 v50, v50, v22
    v_add_f32 v51, v51, v22
    v_lshlrev_b32 v28, 16, v64
    v_and_b32 v29, 0xffff0000, v64
    v_lshlrev_b32 v30, 16, v65
    v_and_b32 v31, 0xffff0000, v65
    v_add_f32 v28, v28, v23
    v_add_f32 v29, v29, v23
    v_add_f32 v30, v30, v23
    v_add_f32 v31, v31, v23
    v_lshlrev_b32 v36, 16, v66
    v_and_b32 v37, 0xffff0000, v66
    v_lshlrev_b32 v38, 16, v67
    v_and_b32 v39, 0xffff0000, v67
    v_add_f32 v36, v36, v23
    v_add_f32 v37, v37, v23
    v_add_f32 v38, v38, v23
    v_add_f32 v39, v39, v23
    v_lshlrev_b32 v44, 16, v68
    v_and_b32 v45, 0xffff0000, v68
    v_lshlrev_b32 v46, 16, v69
    v_and_b32 v47, 0xffff0000, v69
    v_add_f32 v44, v44, v23
    v_add_f32 v45, v45, v23
    v_add_f32 v46, v46, v23
    v_add_f32 v47, v47, v23
    v_lshlrev_b32 v52, 16, v70
    v_and_b32 v53, 0xffff0000, v70
    v_lshlrev_b32 v54, 16, v71
    v_and_b32 v55, 0xffff0000, v71
    v_add_f32 v52, v52, v23
    v_add_f32 v53, v53, v23
    v_add_f32 v54, v54, v23
    v_add_f32 v55, v55, v23
.p2align 3
g4_cloop:
    s_barrier
g4_cloop2:
    v_mfma_f32_16x16x32_bf16 v[24:27], v[80:83], v[96:99], v[24:27]
    ds_read_b128 v[56:59], v10 offset:0
    v_mfma_f32_16x16x32_bf16 v[28:31], v[80:83], v[100:103], v[28:31]
    ds_read_b64_tr_b16 v[72:73], v12 offset:0
    ds_read_b64_tr_b16 v[74:75], v12 offset:1024
    v_mfma_f32_16x16x32_bf16 v[32:35], v[84:87], v[96:99], v[32:35]
    ds_read_b64_tr_b16 v[76:77], v13 offset:0
    ds_read_b64_tr_b16 v[78:79], v13 offset:1024
    v_mfma_f32_16x16x32_bf16 v[36:39], v[84:87], v[100:103], v[36:39]
    ds_read_b128 v[60:63], v10 offset:2048
    v_mfma_f32_16x16x32_bf16 v[40:43], v[88:91], v[96:99], v[40:43]
    ds_read_b128 v[64:67], v10 offset:4096
    v_mfma_f32_16x16x32_bf16 v[44:47], v[88:91], v[100:103], v[44:47]
    ds_read_b128 v[68:71], v10 offset:6144
    v_mfma_f32_16x16x32_bf16 v[48:51], v[92:95], v[96:99], v[48:51]
    v_mfma_f32_16x16x32_bf16 v[52:55], v[92:95], v[100:103], v[52:55]
    s_waitcnt lgkmcnt(0)
    v_mfma_f32_16x16x32_bf16 v[24:27], v[56:59], v[72:75], v[24:27]
    ds_read_b128 v[80:83], v11 offset:0
    v_mfma_f32_16x16x32_bf16 v[28:31], v[56:59], v[76:79], v[28:31]
    ds_read_b64_tr_b16 v[96:97], v12 offset:8192
    ds_read_b64_tr_b16 v[98:99], v12 offset:9216
    v_mfma_f32_16x16x32_bf16 v[32:35], v[60:63], v[72:75], v[32:35]
    ds_read_b64_tr_b16 v[100:101], v13 offset:8192
    ds_read_b64_tr_b16 v[102:103], v13 offset:9216
    v_mfma_f32_16x16x32_bf16 v[36:39], v[60:63], v[76:79], v[36:39]
    ds_read_b128 v[84:87], v11 offset:2048
    v_mfma_f32_16x16x32_bf16 v[40:43], v[64:67], v[72:75], v[40:43]
    ds_read_b128 v[88:91], v11 offset:4096
    v_mfma_f32_16x16x32_bf16 v[44:47], v[64:67], v[76:79], v[44:47]
    ds_read_b128 v[92:95], v11 offset:6144
    v_mfma_f32_16x16x32_bf16 v[48:51], v[68:71], v[72:75], v[48:51]
    s_add_u32 s50, s50, 1
    s_cmp_eq_u32 s50, 4
    v_mfma_f32_16x16x32_bf16 v[52:55], v[68:71], v[76:79], v[52:55]
    s_cselect_b32 s49, s29, s51
    s_cselect_b32 s50, 0, s50
    v_add_u32 v10, s49, v10
    v_add_u32 v11, s49, v11
    v_add_u32 v12, s49, v12
    v_add_u32 v13, s49, v13
    s_sub_u32 s48, s48, 1
    s_cmp_lg_u32 s48, 0
    s_waitcnt lgkmcnt(0)
    s_cbranch_scc1 g4_cloop
    v_mfma_f32_16x16x32_bf16 v[24:27], v[80:83], v[96:99], v[24:27]
    v_mfma_f32_16x16x32_bf16 v[28:31], v[80:83], v[100:103], v[28:31]
    v_mfma_f32_16x16x32_bf16 v[32:35], v[84:87], v[96:99], v[32:35]
    v_mfma_f32_16x16x32_bf16 v[36:39], v[84:87], v[100:103], v[36:39]
    v_mfma_f32_16x16x32_bf16 v[40:43], v[88:91], v[96:99], v[40:43]
    v_mfma_f32_16x16x32_bf16 v[44:47], v[88:91], v[100:103], v[44:47]
    v_mfma_f32_16x16x32_bf16 v[48:51], v[92:95], v[96:99], v[48:51]
    v_mfma_f32_16x16x32_bf16 v[52:55], v[92:95], v[100:103], v[52:55]
    s_nop 7
    v_cvt_pk_bf16_f32 v56, v24, v25
    v_cvt_pk_bf16_f32 v57, v26, v27
    v_cvt_pk_bf16_f32 v58, v32, v33
    v_cvt_pk_bf16_f32 v59, v34, v35
    s_nop 1
    v_permlane16_swap_b32 v56, v58
    v_permlane16_swap_b32 v57, v59
    buffer_store_dwordx4 v[56:59], v9, s[16:19], s52 offen offset:0 sc1
    v_cvt_pk_bf16_f32 v60, v40, v41
    v_cvt_pk_bf16_f32 v61, v42, v43
    v_cvt_pk_bf16_f32 v62, v48, v49
    v_cvt_pk_bf16_f32 v63, v50, v51
    s_nop 1
    v_permlane16_swap_b32 v60, v62
    v_permlane16_swap_b32 v61, v63
    buffer_store_dwordx4 v[60:63], v9, s[16:19], s52 offen offset:64 sc1
    v_cvt_pk_bf16_f32 v64, v28, v29
    v_cvt_pk_bf16_f32 v65, v30, v31
    v_cvt_pk_bf16_f32 v66, v36, v37
    v_cvt_pk_bf16_f32 v67, v38, v39
    s_nop 1
    v_permlane16_swap_b32 v64, v66
    v_permlane16_swap_b32 v65, v67
    buffer_store_dwordx4 v[64:67], v9, s[16:19], s53 offen offset:0 sc1
    v_cvt_pk_bf16_f32 v68, v44, v45
    v_cvt_pk_bf16_f32 v69, v46, v47
    v_cvt_pk_bf16_f32 v70, v52, v53
    v_cvt_pk_bf16_f32 v71, v54, v55
    s_nop 1
    v_permlane16_swap_b32 v68, v70
    v_permlane16_swap_b32 v69, v71
    buffer_store_dwordx4 v[68:71], v9, s[16:19], s53 offen offset:64 sc1
    v_pk_add_f32 v[10:11], v[24:25], v[26:27]
    v_pk_mul_f32 v[12:13], v[24:25], v[24:25]
    v_pk_fma_f32 v[12:13], v[26:27], v[26:27], v[12:13]
    v_pk_add_f32 v[10:11], v[10:11], v[32:33]
    v_pk_fma_f32 v[12:13], v[32:33], v[32:33], v[12:13]
    v_pk_add_f32 v[10:11], v[10:11], v[34:35]
    v_pk_fma_f32 v[12:13], v[34:35], v[34:35], v[12:13]
    v_pk_add_f32 v[10:11], v[10:11], v[40:41]
    v_pk_fma_f32 v[12:13], v[40:41], v[40:41], v[12:13]
    v_pk_add_f32 v[10:11], v[10:11], v[42:43]
    v_pk_fma_f32 v[12:13], v[42:43], v[42:43], v[12:13]
    v_pk_add_f32 v[10:11], v[10:11], v[48:49]
    v_pk_fma_f32 v[12:13], v[48:49], v[48:49], v[12:13]
    v_pk_add_f32 v[10:11], v[10:11], v[50:51]
    v_pk_fma_f32 v[12:13], v[50:51], v[50:51], v[12:13]
    v_pk_add_f32 v[14:15], v[28:29], v[30:31]
    v_pk_mul_f32 v[16:17], v[28:29], v[28:29]
    v_pk_fma_f32 v[16:17], v[30:31], v[30:31], v[16:17]
    v_pk_add_f32 v[14:15], v[14:15], v[36:37]
    v_pk_fma_f32 v[16:17], v[36:37], v[36:37], v[16:17]
    v_pk_add_f32 v[14:15], v[14:15], v[38:39]
    v_pk_fma_f32 v[16:17], v[38:39], v[38:39], v[16:17]
    v_pk_add_f32 v[14:15], v[14:15], v[44:45]
    v_pk_fma_f32 v[16:17], v[44:45], v[44:45], v[16:17]
    v_pk_add_f32 v[14:15], v[14:15], v[46:47]
    v_pk_fma_f32 v[16:17], v[46:47], v[46:47], v[16:17]
    v_pk_add_f32 v[14:15], v[14:15], v[52:53]
    v_pk_fma_f32 v[16:17], v[52:53], v[52:53], v[16:17]
    v_pk_add_f32 v[14:15], v[14:15], v[54:55]
    v_pk_fma_f32 v[16:17], v[54:55], v[54:55], v[16:17]
    v_add_f32 v10, v10, v11
    v_add_f32 v11, v12, v13
    v_add_f32 v14, v14, v15
    v_add_f32 v15, v16, v17
    s_nop 1
    v_permlane16_swap_b32 v10, v14
    v_permlane16_swap_b32 v11, v15
    v_pk_add_f32 v[10:11], v[10:11], v[14:15]
    v_mov_b32 v12, v10
    v_mov_b32 v13, v11
    s_nop 1
    v_permlane32_swap_b32 v10, v12
    v_permlane32_swap_b32 v11, v13
    v_pk_add_f32 v[10:11], v[10:11], v[12:13]
    v_and_b32 v3, 16, v2
    v_add_u32 v3, v3, v20
    v_lshlrev_b32 v3, 3, v3
    s_lshl_b32 s40, s24, 14
    s_mov_b32 exec_hi, 0
    buffer_store_dwordx2 v[10:11], v3, s[60:63], s40 offen sc1
    s_mov_b32 exec_hi, -1
    s_endpgm
.section .rodata,"a"
.p2align 6
.amdhsa_kernel g4a_kernel
  .amdhsa_next_free_vgpr 104
  .amdhsa_next_free_sgpr 72
  .amdhsa_accum_offset 104
  .amdhsa_group_segment_fixed_size 0
  .amdhsa_kernarg_size 88
  .amdhsa_user_sgpr_count 2
  .amdhsa_user_sgpr_kernarg_segment_ptr 1
  .amdhsa_system_sgpr_workgroup_id_x 1
.end_amdhsa_kernel
.section .rodata,"a"
.p2align 6
.amdhsa_kernel g4b_kernel
  .amdhsa_next_free_vgpr 104
  .amdhsa_next_free_sgpr 72
  .amdhsa_accum_offset 104
  .amdhsa_group_segment_fixed_size 0
  .amdhsa_kernarg_size 88
  .amdhsa_user_sgpr_count 2
  .amdhsa_user_sgpr_kernarg_segment_ptr 1
  .amdhsa_system_sgpr_workgroup_id_x 1
.end_amdhsa_kernel
```

```asm
; @launch kernel=g1a_kernel grid=(256,1,1) block=(512,1,1) lds=131072
; @launch kernel=g2a_kernel grid=(256,1,1) block=(512,1,1) lds=98304
; @launch kernel=g3a_kernel grid=(256,1,1) block=(512,1,1) lds=131072
; @launch kernel=g4a_kernel grid=(256,1,1) block=(512,1,1) lds=131072
; @launch kernel=g1b_kernel grid=(256,1,1) block=(512,1,1) lds=131072
; @launch kernel=g2b_kernel grid=(256,1,1) block=(512,1,1) lds=98304
; @launch kernel=g3b_kernel grid=(256,1,1) block=(512,1,1) lds=131072
; @launch kernel=g4b_kernel grid=(256,1,1) block=(512,1,1) lds=131072
.amdgcn_target "amdgcn-amd-amdhsa--gfx950"
.text
.globl g1a_kernel
.p2align 8
.type g1a_kernel,@function
g1a_kernel:
    s_load_dwordx2 s[6:7], s[0:1], 0
    s_mov_b32 s47, 0
    s_mov_b32 s53, 1
    s_branch g1_body
.text
.globl g1b_kernel
.p2align 8
.type g1b_kernel,@function
g1b_kernel:
    s_load_dwordx2 s[6:7], s[0:1], 80
    s_mov_b32 s47, 0x1800000
    s_mov_b32 s53, 0
    s_branch g1_body
.p2align 6
g1_body:
    s_cmp_ge_u32 s2, 256
    s_cbranch_scc1 g1_done
    s_load_dwordx2 s[4:5], s[0:1], 80
    s_load_dwordx2 s[30:31], s[0:1], 8
    s_load_dwordx2 s[16:17], s[0:1], 72
    s_load_dwordx2 s[18:19], s[0:1], 16
    v_lshrrev_b32 v1, 6, v0
    v_and_b32 v2, 63, v0
    s_and_b32 s40, s2, 1
    s_lshl_b32 s40, s40, 3
    s_bfe_u32 s41, s2, 0x30003
    s_add_u32 s25, s40, s41
    s_bfe_u32 s40, s2, 0x20001
    s_lshl_b32 s40, s40, 2
    s_lshr_b32 s42, s2, 6
    s_add_u32 s24, s40, s42
    s_add_u32 s27, s41, s42
    s_add_u32 s52, s24, s25
    s_and_b32 s52, s52, 15
    s_and_b32 s26, s52, 12
    s_mul_i32 s26, s26, s53
    v_readfirstlane_b32 s28, v1
    v_lshrrev_b32 v5, 4, v2
    v_bfe_u32 v6, v2, 2, 2
    v_and_b32 v7, 3, v2
    v_and_b32 v8, 15, v2
    s_cmp_lt_u32 s28, 4
    s_cbranch_scc1 g1_compute
    s_sub_u32 s28, s28, 4
    s_mov_b32 s40, 2048
    v_lshrrev_b32 v3, 3, v2
    v_mul_lo_u32 v3, v3, s40
    v_lshrrev_b32 v4, 4, v2
    v_xor_b32 v4, v4, v2
    v_and_b32 v4, 7, v4
    v_lshl_add_u32 v3, v4, 4, v3
    s_mul_i32 s41, s25, 262144
    s_mul_i32 s42, s28, 65536
    s_add_u32 s41, s41, s42
    v_xor_b32 v4, 64, v3
    s_add_u32 s42, s41, 0
    v_add_u32 v16, s42, v3
    s_add_u32 s42, s41, 16384
    v_add_u32 v17, s42, v4
    s_add_u32 s42, s41, 32768
    v_add_u32 v18, s42, v3
    s_add_u32 s42, s41, 49152
    v_add_u32 v19, s42, v4
    s_mov_b32 s40, 6144
    v_lshrrev_b32 v3, 3, v2
    v_mul_lo_u32 v3, v3, s40
    v_bfe_u32 v4, v2, 4, 1
    v_lshlrev_b32 v4, 1, v4
    v_xor_b32 v4, v4, v2
    v_and_b32 v4, 7, v4
    v_lshl_add_u32 v3, v4, 4, v3
    s_mul_i32 s41, s24, 128
    s_mul_i32 s42, s28, 98304
    s_add_u32 s41, s41, s42
    v_xor_b32 v4, 64, v3
    s_add_u32 s42, s41, 0
    v_add_u32 v10, s42, v3
    s_add_u32 s42, s41, 49152
    v_add_u32 v11, s42, v4
    s_mov_b32 s40, 6144
    v_lshrrev_b32 v3, 3, v2
    v_mul_lo_u32 v3, v3, s40
    v_bfe_u32 v4, v2, 4, 1
    v_lshlrev_b32 v4, 1, v4
    v_xor_b32 v4, v4, v2
    v_and_b32 v4, 7, v4
    v_lshl_add_u32 v3, v4, 4, v3
    s_mul_i32 s41, s24, 128
    s_mul_i32 s42, s28, 98304
    s_add_u32 s41, s41, s42
    v_xor_b32 v4, 64, v3
    s_add_u32 s42, s41, 2048
    v_add_u32 v12, s42, v3
    s_add_u32 s42, s41, 51200
    v_add_u32 v13, s42, v4
    s_mov_b32 s40, 6144
    v_lshrrev_b32 v3, 3, v2
    v_mul_lo_u32 v3, v3, s40
    v_bfe_u32 v4, v2, 4, 1
    v_lshlrev_b32 v4, 1, v4
    v_xor_b32 v4, v4, v2
    v_and_b32 v4, 7, v4
    v_lshl_add_u32 v3, v4, 4, v3
    s_mul_i32 s41, s24, 128
    s_mul_i32 s42, s28, 98304
    s_add_u32 s41, s41, s42
    v_xor_b32 v4, 64, v3
    s_add_u32 s42, s41, 4096
    v_add_u32 v14, s42, v3
    s_add_u32 s42, s41, 53248
    v_add_u32 v15, s42, v4
    v_lshrrev_b32 v3, 3, v2
    s_lshl_b32 s40, s28, 2
    v_add_u32 v3, s40, v3
    v_lshrrev_b32 v4, 1, v3
    v_xor_b32 v4, v4, v2
    v_and_b32 v4, 7, v4
    s_lshl_b32 s40, s25, 7
    s_sub_u32 s40, s40, 16
    v_add_u32 v3, s40, v3
    v_max_i32 v3, 0, v3
    v_lshlrev_b32 v3, 11, v3
    v_lshl_add_u32 v20, v4, 4, v3
    s_mul_i32 s36, s28, 2048
    s_mul_i32 s37, s28, 4096
    s_add_u32 s37, s37, 26624
    s_mul_i32 s46, s28, 512
    s_add_u32 s46, s46, 24576
    s_waitcnt lgkmcnt(0)
    s_mov_b32 s8, s30
    s_mov_b32 s9, s31
    s_mov_b32 s10, 0x600000
    s_mov_b32 s11, 0x20000
    s_add_u32 s12, s6, s47
    s_addc_u32 s13, s7, 0
    s_mov_b32 s14, 0x400000
    s_mov_b32 s15, 0x20000
    s_mov_b32 s20, s4
    s_mov_b32 s21, s5
    s_mov_b32 s22, 0x40000
    s_mov_b32 s23, 0x20000
    s_add_u32 s56, s4, 0x100000
    s_addc_u32 s57, s5, 0
    s_mov_b32 s58, 0x30000
    s_mov_b32 s59, 0x20000
    s_mov_b32 s60, s16
    s_mov_b32 s61, s17
    s_mov_b32 s62, 0x100
    s_mov_b32 s63, 0x20000
    s_sub_u32 s40, s52, s27
    s_and_b32 s40, s40, 1
    s_and_b32 s41, s52, 2
    s_or_b32 s40, s40, s41
    s_add_u32 s54, s40, 2
    s_cmp_eq_u32 s53, 0
    s_cselect_b32 s54, 0x7fff, s54
    s_add_u32 s55, s54, 3
    s_cmp_lg_u32 s28, 0
    s_cselect_b32 s55, 0x7fff, s55
    s_cmp_lt_u32 s55, 0x7fff
    s_cselect_b32 s29, 13, 0x7fff
    s_mov_b32 s32, 0
    s_mov_b32 s33, 0
g1_ld_loop:
    s_cmp_lt_u32 s32, 2
    s_cbranch_scc1 g1_ld_issue
    s_sub_u32 s40, s32, s54
    s_sub_u32 s40, s40, 1
    s_cmp_lt_u32 s40, 2
    s_cbranch_scc1 g1_ld_w0
    s_sub_u32 s40, s32, s55
    s_sub_u32 s40, s40, 1
    s_cmp_lt_u32 s40, 2
    s_cbranch_scc1 g1_ld_w1
    s_sub_u32 s40, s32, s29
    s_sub_u32 s40, s40, 1
    s_cmp_lt_u32 s40, 2
    s_cbranch_scc1 g1_ld_w2
    s_waitcnt vmcnt(11)
g1_ld_bar:
    s_barrier
g1_ld_issue:
    s_add_u32 s40, s32, s27
    s_and_b32 s40, s40, 1
    s_andn2_b32 s41, s32, 1
    s_or_b32 s40, s40, s41
    s_add_u32 s40, s40, s26
    s_and_b32 s40, s40, 15
    s_mul_i32 s34, s40, 393216
    s_mul_i32 s35, s40, 128
    s_add_u32 s38, s33, s36
    s_add_u32 s39, s33, s37
    s_add_u32 m0, s39, 0
    s_nop 0
    buffer_load_dwordx4 v16, s[12:15], s35 offen lds
    s_add_u32 m0, s39, 1024
    s_nop 0
    buffer_load_dwordx4 v17, s[12:15], s35 offen lds
    s_add_u32 m0, s39, 2048
    s_nop 0
    buffer_load_dwordx4 v18, s[12:15], s35 offen lds
    s_add_u32 m0, s39, 3072
    s_nop 0
    buffer_load_dwordx4 v19, s[12:15], s35 offen lds
    s_add_u32 m0, s38, 0
    s_nop 0
    buffer_load_dwordx4 v10, s[8:11], s34 offen lds
    s_add_u32 m0, s38, 1024
    s_nop 0
    buffer_load_dwordx4 v11, s[8:11], s34 offen lds
    s_add_u32 m0, s38, 8192
    s_nop 0
    buffer_load_dwordx4 v12, s[8:11], s34 offen lds
    s_add_u32 m0, s38, 9216
    s_nop 0
    buffer_load_dwordx4 v13, s[8:11], s34 offen lds
    s_add_u32 m0, s38, 16384
    s_nop 0
    buffer_load_dwordx4 v14, s[8:11], s34 offen lds
    s_add_u32 m0, s38, 17408
    s_nop 0
    buffer_load_dwordx4 v15, s[8:11], s34 offen lds
    s_add_u32 m0, s33, s46
    s_mov_b32 exec_hi, 0
    buffer_load_dwordx4 v20, s[12:15], s35 offen lds
    s_mov_b32 exec_hi, -1
    s_cmp_eq_u32 s32, s54
    s_cbranch_scc1 g1_ld_h0
g1_ld_c0:
    s_cmp_eq_u32 s32, s55
    s_cbranch_scc1 g1_ld_h1
g1_ld_c1:
    s_cmp_eq_u32 s32, s29
    s_cbranch_scc1 g1_ld_h2
g1_ld_c2:
    s_add_u32 s33, s33, 43008
    s_cmp_eq_u32 s33, 129024
    s_cselect_b32 s33, 0, s33
    s_add_u32 s32, s32, 1
    s_cmp_lt_u32 s32, 16
    s_cbranch_scc1 g1_ld_loop
    s_cmp_eq_u32 s29, 0x7fff
    s_cbranch_scc1 g1_polled
    s_mov_b32 s41, 0x20000
    v_mov_b32 v21, 0
    s_waitcnt vmcnt(22)
g1_poll:
    v_readfirstlane_b32 s40, v23
    s_sub_u32 s41, s41, 1
    s_cmp_eq_u32 s41, 0
    s_cbranch_scc1 g1_polled
    s_cmp_ge_u32 s40, 256
    s_cbranch_scc1 g1_polled
    s_sleep 8
    buffer_load_dword v23, v21, s[60:63], 0 offen sc1
    s_waitcnt vmcnt(0)
    s_branch g1_poll
g1_polled:
    s_waitcnt vmcnt(11)
    s_barrier
    s_lshl_b32 s40, s28, 6
    v_add_u32 v21, s40, v2
    s_lshl_b32 s41, s25, 7
    s_sub_u32 s41, s41, 16
    v_add_u32 v3, s41, v21
    v_max_i32 v3, 0, v3
    v_min_u32 v3, 2047, v3
    v_lshlrev_b32 v3, 3, v3
    s_min_u32 s40, s28, 2
    s_lshl_b32 s40, s40, 12
    s_lshl_b32 s41, s24, 8
    s_add_u32 s40, s40, s41
    v_lshl_add_u32 v4, v2, 2, s40
    s_mov_b32 s40, 0
    buffer_load_dwordx2 v[24:25], v3, s[20:23], s40 offen sc1
    s_mov_b32 s41, 0
    buffer_load_dword v56, v4, s[56:59], s41 offen sc1
    s_mov_b32 s40, 16384
    buffer_load_dwordx2 v[26:27], v3, s[20:23], s40 offen sc1
    s_mov_b32 s41, 12288
    buffer_load_dword v57, v4, s[56:59], s41 offen sc1
    s_mov_b32 s40, 32768
    buffer_load_dwordx2 v[28:29], v3, s[20:23], s40 offen sc1
    s_mov_b32 s41, 24576
    buffer_load_dword v58, v4, s[56:59], s41 offen sc1
    s_mov_b32 s40, 49152
    buffer_load_dwordx2 v[30:31], v3, s[20:23], s40 offen sc1
    s_mov_b32 s41, 36864
    buffer_load_dword v59, v4, s[56:59], s41 offen sc1
    s_mov_b32 s40, 65536
    buffer_load_dwordx2 v[32:33], v3, s[20:23], s40 offen sc1
    s_mov_b32 s41, 49152
    buffer_load_dword v60, v4, s[56:59], s41 offen sc1
    s_mov_b32 s40, 81920
    buffer_load_dwordx2 v[34:35], v3, s[20:23], s40 offen sc1
    s_mov_b32 s41, 61440
    buffer_load_dword v61, v4, s[56:59], s41 offen sc1
    s_mov_b32 s40, 98304
    buffer_load_dwordx2 v[36:37], v3, s[20:23], s40 offen sc1
    s_mov_b32 s41, 73728
    buffer_load_dword v62, v4, s[56:59], s41 offen sc1
    s_mov_b32 s40, 114688
    buffer_load_dwordx2 v[38:39], v3, s[20:23], s40 offen sc1
    s_mov_b32 s41, 86016
    buffer_load_dword v63, v4, s[56:59], s41 offen sc1
    s_mov_b32 s40, 131072
    buffer_load_dwordx2 v[40:41], v3, s[20:23], s40 offen sc1
    s_mov_b32 s41, 98304
    buffer_load_dword v64, v4, s[56:59], s41 offen sc1
    s_mov_b32 s40, 147456
    buffer_load_dwordx2 v[42:43], v3, s[20:23], s40 offen sc1
    s_mov_b32 s41, 110592
    buffer_load_dword v65, v4, s[56:59], s41 offen sc1
    s_mov_b32 s40, 163840
    buffer_load_dwordx2 v[44:45], v3, s[20:23], s40 offen sc1
    s_mov_b32 s41, 122880
    buffer_load_dword v66, v4, s[56:59], s41 offen sc1
    s_mov_b32 s40, 180224
    buffer_load_dwordx2 v[46:47], v3, s[20:23], s40 offen sc1
    s_mov_b32 s41, 135168
    buffer_load_dword v67, v4, s[56:59], s41 offen sc1
    s_mov_b32 s40, 196608
    buffer_load_dwordx2 v[48:49], v3, s[20:23], s40 offen sc1
    s_mov_b32 s41, 147456
    buffer_load_dword v68, v4, s[56:59], s41 offen sc1
    s_mov_b32 s40, 212992
    buffer_load_dwordx2 v[50:51], v3, s[20:23], s40 offen sc1
    s_mov_b32 s41, 159744
    buffer_load_dword v69, v4, s[56:59], s41 offen sc1
    s_mov_b32 s40, 229376
    buffer_load_dwordx2 v[52:53], v3, s[20:23], s40 offen sc1
    s_mov_b32 s41, 172032
    buffer_load_dword v70, v4, s[56:59], s41 offen sc1
    s_mov_b32 s40, 245760
    buffer_load_dwordx2 v[54:55], v3, s[20:23], s40 offen sc1
    s_mov_b32 s41, 184320
    buffer_load_dword v71, v4, s[56:59], s41 offen sc1
    s_waitcnt vmcnt(32)
    s_barrier
    s_waitcnt vmcnt(0)
    v_pk_add_f32 v[24:25], v[24:25], v[40:41]
    v_add_f32 v56, v56, v64
    v_pk_add_f32 v[26:27], v[26:27], v[42:43]
    v_add_f32 v57, v57, v65
    v_pk_add_f32 v[28:29], v[28:29], v[44:45]
    v_add_f32 v58, v58, v66
    v_pk_add_f32 v[30:31], v[30:31], v[46:47]
    v_add_f32 v59, v59, v67
    v_pk_add_f32 v[32:33], v[32:33], v[48:49]
    v_add_f32 v60, v60, v68
    v_pk_add_f32 v[34:35], v[34:35], v[50:51]
    v_add_f32 v61, v61, v69
    v_pk_add_f32 v[36:37], v[36:37], v[52:53]
    v_add_f32 v62, v62, v70
    v_pk_add_f32 v[38:39], v[38:39], v[54:55]
    v_add_f32 v63, v63, v71
    v_pk_add_f32 v[24:25], v[24:25], v[32:33]
    v_add_f32 v56, v56, v60
    v_pk_add_f32 v[26:27], v[26:27], v[34:35]
    v_add_f32 v57, v57, v61
    v_pk_add_f32 v[28:29], v[28:29], v[36:37]
    v_add_f32 v58, v58, v62
    v_pk_add_f32 v[30:31], v[30:31], v[38:39]
    v_add_f32 v59, v59, v63
    v_pk_add_f32 v[24:25], v[24:25], v[28:29]
    v_add_f32 v56, v56, v58
    v_pk_add_f32 v[26:27], v[26:27], v[30:31]
    v_add_f32 v57, v57, v59
    v_pk_add_f32 v[24:25], v[24:25], v[26:27]
    v_add_f32 v56, v56, v57
    v_mul_f32 v24, 0x3a800000, v24
    v_mul_f32 v25, 0x3a800000, v25
    v_fma_f32 v25, -v24, v24, v25
    v_max_f32 v25, 0, v25
    v_cvt_pk_bf16_f32 v24, v24, v24
    v_lshlrev_b32 v24, 16, v24
    v_cvt_pk_bf16_f32 v25, v25, v25
    v_lshlrev_b32 v25, 16, v25
    v_add_f32 v25, 0x3727c5ac, v25
    v_cvt_pk_bf16_f32 v25, v25, v25
    v_lshlrev_b32 v25, 16, v25
    v_sqrt_f32 v25, v25
    s_nop 0
    v_cvt_pk_bf16_f32 v25, v25, v25
    v_lshlrev_b32 v25, 16, v25
    v_rcp_f32 v26, v25
    v_lshlrev_b32 v3, 3, v21
    v_lshlrev_b32 v4, 2, v21
    v_mul_f32 v27, -v24, v26
    v_cmp_gt_u32 vcc, 144, v21
    s_and_saveexec_b64 s[40:41], vcc
    v_add_u32 v3, 129024, v3
    ds_write_b64 v3, v[26:27]
    s_mov_b64 exec, s[40:41]
    v_cmp_gt_u32 vcc, 192, v21
    s_and_saveexec_b64 s[40:41], vcc
    v_add_u32 v4, 130304, v4
    ds_write_b32 v4, v56
    s_mov_b64 exec, s[40:41]
    s_waitcnt lgkmcnt(0)
    s_barrier
    s_add_u32 s20, s4, 0x200000
    s_addc_u32 s21, s5, 0
    s_mov_b32 s22, 0x40000
    s_mov_b32 s23, 0x20000
    s_lshl_b32 s40, s2, 10
    s_lshl_b32 s41, s28, 8
    s_add_u32 s40, s40, s41
    v_lshlrev_b32 v3, 2, v2
    v_mov_b32 v4, -1
    buffer_store_dword v4, v3, s[20:23], s40 offen sc1
    s_cmp_eq_u32 s53, 0
    s_cbranch_scc1 g1_nopf
    s_mov_b32 s20, s18
    s_mov_b32 s21, s19
    s_mov_b32 s22, 0x200000
    s_mov_b32 s23, 0x20000
    s_lshl_b32 s40, s2, 13
    s_lshl_b32 s41, s28, 11
    s_add_u32 s40, s40, s41
    v_lshlrev_b32 v3, 4, v2
    buffer_load_dwordx4 v[120:123], v3, s[20:23], s40 offen
    buffer_load_dwordx4 v[120:123], v3, s[20:23], s40 offen offset:1024
g1_nopf:
    s_branch g1_ld_end
g1_ld_w0:
    s_waitcnt vmcnt(16)
    s_branch g1_ld_bar
g1_ld_h0:
    s_add_u32 s44, s33, 43008
    s_cmp_eq_u32 s44, 129024
    s_cselect_b32 s44, 0, s44
    s_mul_i32 s42, s28, 3
    s_add_u32 s42, s42, 0
    s_lshr_b32 s43, s42, 2
    s_lshl_b32 s43, s43, 13
    s_add_u32 s43, s43, s44
    s_and_b32 s42, s42, 3
    v_and_b32 v3, 1, v5
    v_lshlrev_b32 v3, 1, v3
    v_lshrrev_b32 v4, 1, v6
    v_or_b32 v3, v3, v4
    s_add_u32 s40, s42, 0
    v_xor_b32 v3, s40, v3
    v_lshlrev_b32 v3, 5, v3
    v_lshl_add_u32 v3, v7, 3, v3
    v_lshl_add_u32 v4, v5, 3, v6
    v_lshl_add_u32 v3, v4, 7, v3
    v_add_u32 v21, s43, v3
    ds_read_b64_tr_b16 v[24:25], v21 offset:0
    ds_read_b64_tr_b16 v[26:27], v21 offset:512
    ds_read_b64_tr_b16 v[28:29], v21 offset:4096
    ds_read_b64_tr_b16 v[30:31], v21 offset:4608
    s_mul_i32 s42, s28, 3
    s_add_u32 s42, s42, 1
    s_lshr_b32 s43, s42, 2
    s_lshl_b32 s43, s43, 13
    s_add_u32 s43, s43, s44
    s_and_b32 s42, s42, 3
    v_and_b32 v3, 1, v5
    v_lshlrev_b32 v3, 1, v3
    v_lshrrev_b32 v4, 1, v6
    v_or_b32 v3, v3, v4
    s_add_u32 s40, s42, 0
    v_xor_b32 v3, s40, v3
    v_lshlrev_b32 v3, 5, v3
    v_lshl_add_u32 v3, v7, 3, v3
    v_lshl_add_u32 v4, v5, 3, v6
    v_lshl_add_u32 v3, v4, 7, v3
    v_add_u32 v21, s43, v3
    ds_read_b64_tr_b16 v[32:33], v21 offset:0
    ds_read_b64_tr_b16 v[34:35], v21 offset:512
    ds_read_b64_tr_b16 v[36:37], v21 offset:4096
    ds_read_b64_tr_b16 v[38:39], v21 offset:4608
    s_mul_i32 s42, s28, 3
    s_add_u32 s42, s42, 2
    s_lshr_b32 s43, s42, 2
    s_lshl_b32 s43, s43, 13
    s_add_u32 s43, s43, s44
    s_and_b32 s42, s42, 3
    v_and_b32 v3, 1, v5
    v_lshlrev_b32 v3, 1, v3
    v_lshrrev_b32 v4, 1, v6
    v_or_b32 v3, v3, v4
    s_add_u32 s40, s42, 0
    v_xor_b32 v3, s40, v3
    v_lshlrev_b32 v3, 5, v3
    v_lshl_add_u32 v3, v7, 3, v3
    v_lshl_add_u32 v4, v5, 3, v6
    v_lshl_add_u32 v3, v4, 7, v3
    v_add_u32 v21, s43, v3
    ds_read_b64_tr_b16 v[40:41], v21 offset:0
    ds_read_b64_tr_b16 v[42:43], v21 offset:512
    ds_read_b64_tr_b16 v[44:45], v21 offset:4096
    ds_read_b64_tr_b16 v[46:47], v21 offset:4608
    s_lshr_b32 s42, s44, 7
    s_lshl_b32 s43, s28, 5
    s_add_u32 s42, s42, s43
    s_add_u32 s42, s42, 16
    v_lshrrev_b32 v3, 1, v8
    v_xor_b32 v3, v3, v5
    v_lshlrev_b32 v3, 4, v3
    v_lshl_add_u32 v3, v8, 7, v3
    s_lshl_b32 s40, s42, 7
    s_add_u32 s40, s40, 24576
    v_add_u32 v22, s40, v3
    v_xor_b32 v23, 64, v22
    ds_read_b128 v[48:51], v22 offset:0
    ds_read_b128 v[52:55], v23 offset:0
    ds_read_b128 v[56:59], v22 offset:2048
    ds_read_b128 v[60:63], v23 offset:2048
    v_mov_b32 v64, 0x3f803f80
    v_mov_b32 v65, 0x3f803f80
    v_mov_b32 v66, 0x3f803f80
    v_mov_b32 v67, 0x3f803f80
    s_mul_i32 s42, s52, 12288
    s_lshl_b32 s43, s24, 8
    s_add_u32 s42, s42, s43
    v_lshl_add_u32 v21, v5, 4, s42
    s_lshl_b32 s42, s52, 14
    s_lshl_b32 s43, s25, 10
    s_add_u32 s42, s42, s43
    s_lshl_b32 s43, s28, 8
    s_add_u32 s42, s42, s43
    v_lshl_add_u32 v22, v8, 3, s42
    s_waitcnt lgkmcnt(0)
    v_mfma_f32_16x16x32_bf16 v[68:71], v[24:27], v[64:67], 0
    v_mfma_f32_16x16x32_bf16 v[72:75], v[32:35], v[64:67], 0
    v_mfma_f32_16x16x32_bf16 v[76:79], v[40:43], v[64:67], 0
    v_mfma_f32_16x16x32_bf16 v[80:83], v[64:67], v[48:51], 0
    v_mfma_f32_16x16x32_bf16 v[84:87], v[48:51], v[48:51], 0
    v_mfma_f32_16x16x32_bf16 v[88:91], v[64:67], v[56:59], 0
    v_mfma_f32_16x16x32_bf16 v[92:95], v[56:59], v[56:59], 0
    v_mfma_f32_16x16x32_bf16 v[68:71], v[28:31], v[64:67], v[68:71]
    v_mfma_f32_16x16x32_bf16 v[72:75], v[36:39], v[64:67], v[72:75]
    v_mfma_f32_16x16x32_bf16 v[76:79], v[44:47], v[64:67], v[76:79]
    v_mfma_f32_16x16x32_bf16 v[80:83], v[64:67], v[52:55], v[80:83]
    v_mfma_f32_16x16x32_bf16 v[84:87], v[52:55], v[52:55], v[84:87]
    v_mfma_f32_16x16x32_bf16 v[88:91], v[64:67], v[60:63], v[88:91]
    v_mfma_f32_16x16x32_bf16 v[92:95], v[60:63], v[60:63], v[92:95]
    v_cmp_eq_u32 s[40:41], 1, v7
    v_cmp_eq_u32 s[42:43], 2, v7
    v_cmp_eq_u32 vcc, 3, v7
    s_nop 7
    v_cndmask_b32 v81, v84, v85, s[40:41]
    v_cndmask_b32 v81, v81, v86, s[42:43]
    v_cndmask_b32 v81, v81, v87, vcc
    v_cndmask_b32 v89, v92, v93, s[40:41]
    v_cndmask_b32 v89, v89, v94, s[42:43]
    v_cndmask_b32 v89, v89, v95, vcc
    s_mov_b32 exec_lo, 0x00f0000f
    s_mov_b32 exec_hi, 0xf0000f00
    buffer_store_dwordx2 v[80:81], v22, s[20:23], 0 offen offset:0 sc1
    buffer_store_dwordx2 v[88:89], v22, s[20:23], 0 offen offset:128 sc1
    s_mov_b32 exec_lo, 0x00010001
    s_mov_b32 exec_hi, 0x00010001
    s_mul_i32 s42, s28, 3
    s_add_u32 s42, s42, 0
    s_lshr_b32 s43, s42, 2
    s_lshl_b32 s43, s43, 12
    s_and_b32 s42, s42, 3
    s_lshl_b32 s42, s42, 6
    s_add_u32 s42, s42, s43
    buffer_store_dwordx4 v[68:71], v21, s[56:59], s42 offen sc1
    s_mul_i32 s42, s28, 3
    s_add_u32 s42, s42, 1
    s_lshr_b32 s43, s42, 2
    s_lshl_b32 s43, s43, 12
    s_and_b32 s42, s42, 3
    s_lshl_b32 s42, s42, 6
    s_add_u32 s42, s42, s43
    buffer_store_dwordx4 v[72:75], v21, s[56:59], s42 offen sc1
    s_mul_i32 s42, s28, 3
    s_add_u32 s42, s42, 2
    s_lshr_b32 s43, s42, 2
    s_lshl_b32 s43, s43, 12
    s_and_b32 s42, s42, 3
    s_lshl_b32 s42, s42, 6
    s_add_u32 s42, s42, s43
    buffer_store_dwordx4 v[76:79], v21, s[56:59], s42 offen sc1
    s_mov_b64 exec, -1
    s_branch g1_ld_c0
g1_ld_w1:
    s_waitcnt vmcnt(12)
    s_branch g1_ld_bar
g1_ld_h1:
    v_mov_b32 v21, 0
    v_mov_b32 v22, 1
    s_mov_b64 exec, 1
    buffer_atomic_add v22, v21, s[60:63], 0 offen sc1
    s_mov_b64 exec, -1
    s_branch g1_ld_c1
g1_ld_w2:
    s_waitcnt vmcnt(12)
    s_branch g1_ld_bar
g1_ld_h2:
    v_mov_b32 v21, 0
    buffer_load_dword v23, v21, s[60:63], 0 offen sc1
    s_branch g1_ld_c2
g1_ld_end:
    s_add_u32 s28, s28, 4
    s_branch g1_attn
g1_compute:
    s_and_b32 s44, s28, 1
    s_lshr_b32 s45, s28, 1
    s_lshl_b32 s42, s44, 1
    s_mov_b32 s43, 0
    v_and_b32 v3, 1, v5
    v_lshlrev_b32 v3, 1, v3
    v_lshrrev_b32 v4, 1, v6
    v_or_b32 v3, v3, v4
    s_add_u32 s40, s42, 0
    v_xor_b32 v3, s40, v3
    v_lshlrev_b32 v3, 5, v3
    v_lshl_add_u32 v3, v7, 3, v3
    v_lshl_add_u32 v4, v5, 3, v6
    v_lshl_add_u32 v3, v4, 7, v3
    v_add_u32 v10, s43, v3
    v_and_b32 v3, 1, v5
    v_lshlrev_b32 v3, 1, v3
    v_lshrrev_b32 v4, 1, v6
    v_or_b32 v3, v3, v4
    s_add_u32 s40, s42, 1
    v_xor_b32 v3, s40, v3
    v_lshlrev_b32 v3, 5, v3
    v_lshl_add_u32 v3, v7, 3, v3
    v_lshl_add_u32 v4, v5, 3, v6
    v_lshl_add_u32 v3, v4, 7, v3
    v_add_u32 v11, s43, v3
    s_xor_b32 s43, s45, 1
    s_add_u32 s43, s43, 1
    s_mul_i32 s43, s43, 8192
    v_and_b32 v3, 1, v5
    v_lshlrev_b32 v3, 1, v3
    v_lshrrev_b32 v4, 1, v6
    v_or_b32 v3, v3, v4
    s_add_u32 s40, s42, 0
    v_xor_b32 v3, s40, v3
    v_lshlrev_b32 v3, 5, v3
    v_lshl_add_u32 v3, v7, 3, v3
    v_lshl_add_u32 v4, v5, 3, v6
    v_lshl_add_u32 v3, v4, 7, v3
    v_add_u32 v12, s43, v3
    v_and_b32 v3, 1, v5
    v_lshlrev_b32 v3, 1, v3
    v_lshrrev_b32 v4, 1, v6
    v_or_b32 v3, v3, v4
    s_add_u32 s40, s42, 1
    v_xor_b32 v3, s40, v3
    v_lshlrev_b32 v3, 5, v3
    v_lshl_add_u32 v3, v7, 3, v3
    v_lshl_add_u32 v4, v5, 3, v6
    v_lshl_add_u32 v3, v4, 7, v3
    v_add_u32 v13, s43, v3
    s_xor_b32 s43, s45, 0
    s_add_u32 s43, s43, 1
    s_mul_i32 s43, s43, 8192
    v_and_b32 v3, 1, v5
    v_lshlrev_b32 v3, 1, v3
    v_lshrrev_b32 v4, 1, v6
    v_or_b32 v3, v3, v4
    s_add_u32 s40, s42, 0
    v_xor_b32 v3, s40, v3
    v_lshlrev_b32 v3, 5, v3
    v_lshl_add_u32 v3, v7, 3, v3
    v_lshl_add_u32 v4, v5, 3, v6
    v_lshl_add_u32 v3, v4, 7, v3
    v_add_u32 v14, s43, v3
    v_and_b32 v3, 1, v5
    v_lshlrev_b32 v3, 1, v3
    v_lshrrev_b32 v4, 1, v6
    v_or_b32 v3, v3, v4
    s_add_u32 s40, s42, 1
    v_xor_b32 v3, s40, v3
    v_lshlrev_b32 v3, 5, v3
    v_lshl_add_u32 v3, v7, 3, v3
    v_lshl_add_u32 v4, v5, 3, v6
    v_lshl_add_u32 v3, v4, 7, v3
    v_add_u32 v15, s43, v3
    s_mul_i32 s42, s45, 64
    s_add_u32 s42, s42, 16
    v_lshrrev_b32 v3, 1, v8
    v_xor_b32 v3, v3, v5
    v_lshlrev_b32 v3, 4, v3
    v_lshl_add_u32 v3, v8, 7, v3
    s_lshl_b32 s40, s42, 7
    s_add_u32 s40, s40, 24576
    v_add_u32 v16, s40, v3
    v_xor_b32 v17, 64, v16
    v_lshrrev_b32 v3, 1, v8
    v_xor_b32 v3, v3, v5
    v_lshlrev_b32 v3, 4, v3
    v_lshl_add_u32 v3, v8, 7, v3
    v_add_u32 v18, 24576, v3
    v_xor_b32 v19, 64, v18
    v_mov_b32 v24, 0
    v_mov_b32 v25, 0
    v_mov_b32 v26, 0
    v_mov_b32 v27, 0
    v_mov_b32 v28, 0
    v_mov_b32 v29, 0
    v_mov_b32 v30, 0
    v_mov_b32 v31, 0
    v_mov_b32 v32, 0
    v_mov_b32 v33, 0
    v_mov_b32 v34, 0
    v_mov_b32 v35, 0
    v_mov_b32 v36, 0
    v_mov_b32 v37, 0
    v_mov_b32 v38, 0
    v_mov_b32 v39, 0
    v_mov_b32 v40, 0
    v_mov_b32 v41, 0
    v_mov_b32 v42, 0
    v_mov_b32 v43, 0
    v_mov_b32 v44, 0
    v_mov_b32 v45, 0
    v_mov_b32 v46, 0
    v_mov_b32 v47, 0
    v_mov_b32 v48, 0
    v_mov_b32 v49, 0
    v_mov_b32 v50, 0
    v_mov_b32 v51, 0
    v_mov_b32 v52, 0
    v_mov_b32 v53, 0
    v_mov_b32 v54, 0
    v_mov_b32 v55, 0
    v_mov_b32 v56, 0
    v_mov_b32 v57, 0
    v_mov_b32 v58, 0
    v_mov_b32 v59, 0
    v_mov_b32 v60, 0
    v_mov_b32 v61, 0
    v_mov_b32 v62, 0
    v_mov_b32 v63, 0
    v_mov_b32 v64, 0
    v_mov_b32 v65, 0
    v_mov_b32 v66, 0
    v_mov_b32 v67, 0
    v_mov_b32 v68, 0
    v_mov_b32 v69, 0
    v_mov_b32 v70, 0
    v_mov_b32 v71, 0
    v_mov_b32 v72, 0
    v_mov_b32 v73, 0
    v_mov_b32 v74, 0
    v_mov_b32 v75, 0
    v_mov_b32 v76, 0
    v_mov_b32 v77, 0
    v_mov_b32 v78, 0
    v_mov_b32 v79, 0
    v_mov_b32 v80, 0
    v_mov_b32 v81, 0
    v_mov_b32 v82, 0
    v_mov_b32 v83, 0
    v_mov_b32 v84, 0
    v_mov_b32 v85, 0
    v_mov_b32 v86, 0
    v_mov_b32 v87, 0
    v_mov_b32 v88, 0
    v_mov_b32 v89, 0
    v_mov_b32 v90, 0
    v_mov_b32 v91, 0
    v_mov_b32 v92, 0
    v_mov_b32 v93, 0
    v_mov_b32 v94, 0
    v_mov_b32 v95, 0
    v_mov_b32 v96, 0
    v_mov_b32 v97, 0
    v_mov_b32 v98, 0
    v_mov_b32 v99, 0
    v_mov_b32 v100, 0
    v_mov_b32 v101, 0
    v_mov_b32 v102, 0
    v_mov_b32 v103, 0
    v_mov_b32 v104, 0
    v_mov_b32 v105, 0
    v_mov_b32 v106, 0
    v_mov_b32 v107, 0
    v_mov_b32 v108, 0
    v_mov_b32 v109, 0
    v_mov_b32 v110, 0
    v_mov_b32 v111, 0
    v_mov_b32 v112, 0
    v_mov_b32 v113, 0
    v_mov_b32 v114, 0
    v_mov_b32 v115, 0
    v_mov_b32 v116, 0
    v_mov_b32 v117, 0
    v_mov_b32 v118, 0
    v_mov_b32 v119, 0
    v_mov_b32 v120, 0
    v_mov_b32 v121, 0
    v_mov_b32 v122, 0
    v_mov_b32 v123, 0
    v_mov_b32 v124, 0
    v_mov_b32 v125, 0
    v_mov_b32 v126, 0
    v_mov_b32 v127, 0
    v_mov_b32 v172, 0
    v_mov_b32 v173, 0
    v_mov_b32 v174, 0
    v_mov_b32 v175, 0
    v_mov_b32 v176, 0
    v_mov_b32 v177, 0
    v_mov_b32 v178, 0
    v_mov_b32 v179, 0
    v_mov_b32 v180, 0
    v_mov_b32 v181, 0
    v_mov_b32 v182, 0
    v_mov_b32 v183, 0
    v_mov_b32 v184, 0
    v_mov_b32 v185, 0
    v_mov_b32 v186, 0
    v_mov_b32 v187, 0
    v_mov_b32 v188, 0
    v_mov_b32 v189, 0
    v_mov_b32 v190, 0
    v_mov_b32 v191, 0
    v_mov_b32 v192, 0
    v_mov_b32 v193, 0
    v_mov_b32 v194, 0
    v_mov_b32 v195, 0
    v_mov_b32 v196, 0
    v_mov_b32 v197, 0
    v_mov_b32 v198, 0
    v_mov_b32 v199, 0
    v_mov_b32 v200, 0
    v_mov_b32 v201, 0
    v_mov_b32 v202, 0
    v_mov_b32 v203, 0
    v_mov_b32 v204, 0
    v_mov_b32 v205, 0
    v_mov_b32 v206, 0
    v_mov_b32 v207, 0
    v_mov_b32 v208, 0
    v_mov_b32 v209, 0
    v_mov_b32 v210, 0
    v_mov_b32 v211, 0
    v_mov_b32 v212, 0
    v_mov_b32 v213, 0
    v_mov_b32 v214, 0
    v_mov_b32 v215, 0
    s_mov_b32 s48, 16
    s_mov_b32 s50, 0
    s_mov_b32 s51, 43008
    s_mov_b32 s29, 0xfffeb000
    s_waitcnt lgkmcnt(0)
.p2align 3
g1_cloop:
    s_barrier
g1_cloop2:
    v_mfma_f32_16x16x32_bf16 v[24:27], v[172:175], v[196:199], v[24:27]
    ds_read_b64_tr_b16 v[128:129], v10 offset:0
    ds_read_b64_tr_b16 v[130:131], v10 offset:512
    v_mfma_f32_16x16x32_bf16 v[28:31], v[172:175], v[200:203], v[28:31]
    ds_read_b128 v[152:155], v16 offset:0
    v_mfma_f32_16x16x32_bf16 v[32:35], v[172:175], v[204:207], v[32:35]
    ds_read_b128 v[156:159], v16 offset:2048
    v_mfma_f32_16x16x32_bf16 v[36:39], v[172:175], v[208:211], v[36:39]
    ds_read_b128 v[160:163], v16 offset:4096
    v_mfma_f32_16x16x32_bf16 v[40:43], v[176:179], v[196:199], v[40:43]
    ds_read_b128 v[164:167], v16 offset:6144
    v_mfma_f32_16x16x32_bf16 v[44:47], v[176:179], v[200:203], v[44:47]
    ds_read_b64_tr_b16 v[132:133], v11 offset:0
    ds_read_b64_tr_b16 v[134:135], v11 offset:512
    v_mfma_f32_16x16x32_bf16 v[48:51], v[176:179], v[204:207], v[48:51]
    ds_read_b64_tr_b16 v[136:137], v12 offset:0
    ds_read_b64_tr_b16 v[138:139], v12 offset:512
    v_mfma_f32_16x16x32_bf16 v[52:55], v[176:179], v[208:211], v[52:55]
    ds_read_b64_tr_b16 v[140:141], v13 offset:0
    ds_read_b64_tr_b16 v[142:143], v13 offset:512
    v_mfma_f32_16x16x32_bf16 v[56:59], v[180:183], v[196:199], v[56:59]
    ds_read_b64_tr_b16 v[144:145], v14 offset:0
    ds_read_b64_tr_b16 v[146:147], v14 offset:512
    v_mfma_f32_16x16x32_bf16 v[60:63], v[180:183], v[200:203], v[60:63]
    ds_read_b64_tr_b16 v[148:149], v15 offset:0
    ds_read_b64_tr_b16 v[150:151], v15 offset:512
    v_mfma_f32_16x16x32_bf16 v[64:67], v[180:183], v[204:207], v[64:67]
    ds_read_b128 v[168:171], v18 offset:0
    v_mfma_f32_16x16x32_bf16 v[68:71], v[180:183], v[208:211], v[68:71]
    v_mfma_f32_16x16x32_bf16 v[72:75], v[184:187], v[196:199], v[72:75]
    v_mfma_f32_16x16x32_bf16 v[76:79], v[184:187], v[200:203], v[76:79]
    v_mfma_f32_16x16x32_bf16 v[80:83], v[184:187], v[204:207], v[80:83]
    v_mfma_f32_16x16x32_bf16 v[84:87], v[184:187], v[208:211], v[84:87]
    v_mfma_f32_16x16x32_bf16 v[88:91], v[188:191], v[196:199], v[88:91]
    v_mfma_f32_16x16x32_bf16 v[92:95], v[188:191], v[200:203], v[92:95]
    v_mfma_f32_16x16x32_bf16 v[96:99], v[188:191], v[204:207], v[96:99]
    v_mfma_f32_16x16x32_bf16 v[100:103], v[188:191], v[208:211], v[100:103]
    v_mfma_f32_16x16x32_bf16 v[104:107], v[192:195], v[196:199], v[104:107]
    v_mfma_f32_16x16x32_bf16 v[108:111], v[192:195], v[200:203], v[108:111]
    v_mfma_f32_16x16x32_bf16 v[112:115], v[192:195], v[204:207], v[112:115]
    v_mfma_f32_16x16x32_bf16 v[116:119], v[192:195], v[208:211], v[116:119]
    v_mfma_f32_16x16x32_bf16 v[120:123], v[188:191], v[212:215], v[120:123]
    v_mfma_f32_16x16x32_bf16 v[124:127], v[192:195], v[212:215], v[124:127]
    s_waitcnt lgkmcnt(0)
    v_mfma_f32_16x16x32_bf16 v[24:27], v[128:131], v[152:155], v[24:27]
    ds_read_b64_tr_b16 v[172:173], v10 offset:4096
    ds_read_b64_tr_b16 v[174:175], v10 offset:4608
    v_mfma_f32_16x16x32_bf16 v[28:31], v[128:131], v[156:159], v[28:31]
    ds_read_b128 v[196:199], v17 offset:0
    v_mfma_f32_16x16x32_bf16 v[32:35], v[128:131], v[160:163], v[32:35]
    ds_read_b128 v[200:203], v17 offset:2048
    v_mfma_f32_16x16x32_bf16 v[36:39], v[128:131], v[164:167], v[36:39]
    ds_read_b128 v[204:207], v17 offset:4096
    v_mfma_f32_16x16x32_bf16 v[40:43], v[132:135], v[152:155], v[40:43]
    ds_read_b128 v[208:211], v17 offset:6144
    v_mfma_f32_16x16x32_bf16 v[44:47], v[132:135], v[156:159], v[44:47]
    ds_read_b64_tr_b16 v[176:177], v11 offset:4096
    ds_read_b64_tr_b16 v[178:179], v11 offset:4608
    v_mfma_f32_16x16x32_bf16 v[48:51], v[132:135], v[160:163], v[48:51]
    ds_read_b64_tr_b16 v[180:181], v12 offset:4096
    ds_read_b64_tr_b16 v[182:183], v12 offset:4608
    v_mfma_f32_16x16x32_bf16 v[52:55], v[132:135], v[164:167], v[52:55]
    ds_read_b64_tr_b16 v[184:185], v13 offset:4096
    ds_read_b64_tr_b16 v[186:187], v13 offset:4608
    v_mfma_f32_16x16x32_bf16 v[56:59], v[136:139], v[152:155], v[56:59]
    ds_read_b64_tr_b16 v[188:189], v14 offset:4096
    ds_read_b64_tr_b16 v[190:191], v14 offset:4608
    v_mfma_f32_16x16x32_bf16 v[60:63], v[136:139], v[156:159], v[60:63]
    ds_read_b64_tr_b16 v[192:193], v15 offset:4096
    ds_read_b64_tr_b16 v[194:195], v15 offset:4608
    v_mfma_f32_16x16x32_bf16 v[64:67], v[136:139], v[160:163], v[64:67]
    ds_read_b128 v[212:215], v19 offset:0
    v_mfma_f32_16x16x32_bf16 v[68:71], v[136:139], v[164:167], v[68:71]
    s_add_u32 s50, s50, 1
    s_cmp_eq_u32 s50, 3
    v_mfma_f32_16x16x32_bf16 v[72:75], v[140:143], v[152:155], v[72:75]
    s_cselect_b32 s49, s29, s51
    s_cselect_b32 s50, 0, s50
    v_mfma_f32_16x16x32_bf16 v[76:79], v[140:143], v[156:159], v[76:79]
    v_add_u32 v10, s49, v10
    v_add_u32 v11, s49, v11
    v_mfma_f32_16x16x32_bf16 v[80:83], v[140:143], v[160:163], v[80:83]
    v_add_u32 v12, s49, v12
    v_add_u32 v13, s49, v13
    v_mfma_f32_16x16x32_bf16 v[84:87], v[140:143], v[164:167], v[84:87]
    v_add_u32 v14, s49, v14
    v_add_u32 v15, s49, v15
    v_mfma_f32_16x16x32_bf16 v[88:91], v[144:147], v[152:155], v[88:91]
    v_add_u32 v16, s49, v16
    v_add_u32 v17, s49, v17
    v_mfma_f32_16x16x32_bf16 v[92:95], v[144:147], v[156:159], v[92:95]
    v_add_u32 v18, s49, v18
    v_add_u32 v19, s49, v19
    v_mfma_f32_16x16x32_bf16 v[96:99], v[144:147], v[160:163], v[96:99]
    s_sub_u32 s48, s48, 1
    s_cmp_lg_u32 s48, 0
    v_mfma_f32_16x16x32_bf16 v[100:103], v[144:147], v[164:167], v[100:103]
    v_mfma_f32_16x16x32_bf16 v[104:107], v[148:151], v[152:155], v[104:107]
    v_mfma_f32_16x16x32_bf16 v[108:111], v[148:151], v[156:159], v[108:111]
    v_mfma_f32_16x16x32_bf16 v[112:115], v[148:151], v[160:163], v[112:115]
    v_mfma_f32_16x16x32_bf16 v[116:119], v[148:151], v[164:167], v[116:119]
    v_mfma_f32_16x16x32_bf16 v[120:123], v[144:147], v[168:171], v[120:123]
    v_mfma_f32_16x16x32_bf16 v[124:127], v[148:151], v[168:171], v[124:127]
    s_waitcnt lgkmcnt(0)
    s_cbranch_scc1 g1_cloop
    v_mfma_f32_16x16x32_bf16 v[24:27], v[172:175], v[196:199], v[24:27]
    v_mfma_f32_16x16x32_bf16 v[28:31], v[172:175], v[200:203], v[28:31]
    v_mfma_f32_16x16x32_bf16 v[32:35], v[172:175], v[204:207], v[32:35]
    v_mfma_f32_16x16x32_bf16 v[36:39], v[172:175], v[208:211], v[36:39]
    v_mfma_f32_16x16x32_bf16 v[40:43], v[176:179], v[196:199], v[40:43]
    v_mfma_f32_16x16x32_bf16 v[44:47], v[176:179], v[200:203], v[44:47]
    v_mfma_f32_16x16x32_bf16 v[48:51], v[176:179], v[204:207], v[48:51]
    v_mfma_f32_16x16x32_bf16 v[52:55], v[176:179], v[208:211], v[52:55]
    v_mfma_f32_16x16x32_bf16 v[56:59], v[180:183], v[196:199], v[56:59]
    v_mfma_f32_16x16x32_bf16 v[60:63], v[180:183], v[200:203], v[60:63]
    v_mfma_f32_16x16x32_bf16 v[64:67], v[180:183], v[204:207], v[64:67]
    v_mfma_f32_16x16x32_bf16 v[68:71], v[180:183], v[208:211], v[68:71]
    v_mfma_f32_16x16x32_bf16 v[72:75], v[184:187], v[196:199], v[72:75]
    v_mfma_f32_16x16x32_bf16 v[76:79], v[184:187], v[200:203], v[76:79]
    v_mfma_f32_16x16x32_bf16 v[80:83], v[184:187], v[204:207], v[80:83]
    v_mfma_f32_16x16x32_bf16 v[84:87], v[184:187], v[208:211], v[84:87]
    v_mfma_f32_16x16x32_bf16 v[88:91], v[188:191], v[196:199], v[88:91]
    v_mfma_f32_16x16x32_bf16 v[92:95], v[188:191], v[200:203], v[92:95]
    v_mfma_f32_16x16x32_bf16 v[96:99], v[188:191], v[204:207], v[96:99]
    v_mfma_f32_16x16x32_bf16 v[100:103], v[188:191], v[208:211], v[100:103]
    v_mfma_f32_16x16x32_bf16 v[104:107], v[192:195], v[196:199], v[104:107]
    v_mfma_f32_16x16x32_bf16 v[108:111], v[192:195], v[200:203], v[108:111]
    v_mfma_f32_16x16x32_bf16 v[112:115], v[192:195], v[204:207], v[112:115]
    v_mfma_f32_16x16x32_bf16 v[116:119], v[192:195], v[208:211], v[116:119]
    v_mfma_f32_16x16x32_bf16 v[120:123], v[188:191], v[212:215], v[120:123]
    v_mfma_f32_16x16x32_bf16 v[124:127], v[192:195], v[212:215], v[124:127]
    s_barrier
    v_lshlrev_b32 v3, 3, v8
    v_add_u32 v4, 129024, v3
    s_mul_i32 s40, s45, 512
    s_add_u32 s40, s40, 129152
    v_add_u32 v3, s40, v3
    ds_read_b64 v[128:129], v3 offset:0
    ds_read_b64 v[130:131], v3 offset:128
    ds_read_b64 v[132:133], v3 offset:256
    ds_read_b64 v[134:135], v3 offset:384
    ds_read_b64 v[136:137], v4
    s_lshl_b32 s40, s44, 7
    s_add_u32 s40, s40, 130304
    v_lshl_add_u32 v3, v5, 4, s40
    s_mov_b32 s43, 0
    v_add_u32 v4, s43, v3
    ds_read_b128 v[140:143], v4 offset:0
    ds_read_b128 v[144:147], v4 offset:64
    s_xor_b32 s43, s45, 1
    s_add_u32 s43, s43, 1
    s_mul_i32 s43, s43, 256
    v_add_u32 v4, s43, v3
    ds_read_b128 v[148:151], v4 offset:0
    ds_read_b128 v[152:155], v4 offset:64
    s_xor_b32 s43, s45, 0
    s_add_u32 s43, s43, 1
    s_mul_i32 s43, s43, 256
    v_add_u32 v4, s43, v3
    ds_read_b128 v[156:159], v4 offset:0
    ds_read_b128 v[160:163], v4 offset:64
    v_and_b32 v3, 1, v5
    v_lshlrev_b32 v3, 1, v3
    v_lshrrev_b32 v4, 1, v5
    v_add_u32 v3, v3, v4
    s_lshl_b32 s40, s44, 2
    v_add_u32 v3, s40, v3
    v_lshrrev_b32 v4, 1, v8
    v_xor_b32 v3, v3, v4
    v_lshlrev_b32 v3, 4, v3
    v_lshl_add_u32 v3, v8, 7, v3
    s_mul_i32 s42, s45, 8192
    s_add_u32 s42, s42, 45056
    s_mov_b32 s43, 0
    s_add_u32 s40, s42, s43
    v_add_u32 v10, s40, v3
    s_xor_b32 s43, s45, 1
    s_add_u32 s43, s43, 1
    s_mul_i32 s43, s43, 18432
    s_add_u32 s40, s42, s43
    v_add_u32 v11, s40, v3
    s_xor_b32 s43, s45, 0
    s_add_u32 s43, s43, 1
    s_mul_i32 s43, s43, 18432
    s_add_u32 s40, s42, s43
    v_add_u32 v12, s40, v3
    s_add_u32 s40, s43, 43008
    v_add_u32 v13, s40, v3
    s_waitcnt lgkmcnt(0)
    v_pk_mul_f32 v[164:165], v[140:141], v[128:129] op_sel:[0,1] op_sel_hi:[1,1]
    v_pk_mul_f32 v[166:167], v[142:143], v[128:129] op_sel:[0,1] op_sel_hi:[1,1]
    v_pk_mul_f32 v[168:169], v[144:145], v[128:129] op_sel:[0,1] op_sel_hi:[1,1]
    v_pk_mul_f32 v[170:171], v[146:147], v[128:129] op_sel:[0,1] op_sel_hi:[1,1]
    v_pk_fma_f32 v[24:25], v[24:25], v[128:129], v[164:165] op_sel:[0,0,0] op_sel_hi:[1,0,1]
    v_pk_fma_f32 v[26:27], v[26:27], v[128:129], v[166:167] op_sel:[0,0,0] op_sel_hi:[1,0,1]
    v_pk_fma_f32 v[40:41], v[40:41], v[128:129], v[168:169] op_sel:[0,0,0] op_sel_hi:[1,0,1]
    v_pk_fma_f32 v[42:43], v[42:43], v[128:129], v[170:171] op_sel:[0,0,0] op_sel_hi:[1,0,1]
    v_cvt_pk_bf16_f32 v172, v24, v25
    v_cvt_pk_bf16_f32 v173, v26, v27
    v_cvt_pk_bf16_f32 v174, v40, v41
    v_cvt_pk_bf16_f32 v175, v42, v43
    s_nop 1
    v_permlane16_swap_b32 v172, v174
    v_permlane16_swap_b32 v173, v175
    ds_write_b128 v10, v[172:175] offset:0
    v_pk_mul_f32 v[164:165], v[140:141], v[130:131] op_sel:[0,1] op_sel_hi:[1,1]
    v_pk_mul_f32 v[166:167], v[142:143], v[130:131] op_sel:[0,1] op_sel_hi:[1,1]
    v_pk_mul_f32 v[168:169], v[144:145], v[130:131] op_sel:[0,1] op_sel_hi:[1,1]
    v_pk_mul_f32 v[170:171], v[146:147], v[130:131] op_sel:[0,1] op_sel_hi:[1,1]
    v_pk_fma_f32 v[28:29], v[28:29], v[130:131], v[164:165] op_sel:[0,0,0] op_sel_hi:[1,0,1]
    v_pk_fma_f32 v[30:31], v[30:31], v[130:131], v[166:167] op_sel:[0,0,0] op_sel_hi:[1,0,1]
    v_pk_fma_f32 v[44:45], v[44:45], v[130:131], v[168:169] op_sel:[0,0,0] op_sel_hi:[1,0,1]
    v_pk_fma_f32 v[46:47], v[46:47], v[130:131], v[170:171] op_sel:[0,0,0] op_sel_hi:[1,0,1]
    v_cvt_pk_bf16_f32 v176, v28, v29
    v_cvt_pk_bf16_f32 v177, v30, v31
    v_cvt_pk_bf16_f32 v178, v44, v45
    v_cvt_pk_bf16_f32 v179, v46, v47
    s_nop 1
    v_permlane16_swap_b32 v176, v178
    v_permlane16_swap_b32 v177, v179
    ds_write_b128 v10, v[176:179] offset:2048
    v_pk_mul_f32 v[164:165], v[140:141], v[132:133] op_sel:[0,1] op_sel_hi:[1,1]
    v_pk_mul_f32 v[166:167], v[142:143], v[132:133] op_sel:[0,1] op_sel_hi:[1,1]
    v_pk_mul_f32 v[168:169], v[144:145], v[132:133] op_sel:[0,1] op_sel_hi:[1,1]
    v_pk_mul_f32 v[170:171], v[146:147], v[132:133] op_sel:[0,1] op_sel_hi:[1,1]
    v_pk_fma_f32 v[32:33], v[32:33], v[132:133], v[164:165] op_sel:[0,0,0] op_sel_hi:[1,0,1]
    v_pk_fma_f32 v[34:35], v[34:35], v[132:133], v[166:167] op_sel:[0,0,0] op_sel_hi:[1,0,1]
    v_pk_fma_f32 v[48:49], v[48:49], v[132:133], v[168:169] op_sel:[0,0,0] op_sel_hi:[1,0,1]
    v_pk_fma_f32 v[50:51], v[50:51], v[132:133], v[170:171] op_sel:[0,0,0] op_sel_hi:[1,0,1]
    v_cvt_pk_bf16_f32 v180, v32, v33
    v_cvt_pk_bf16_f32 v181, v34, v35
    v_cvt_pk_bf16_f32 v182, v48, v49
    v_cvt_pk_bf16_f32 v183, v50, v51
    s_nop 1
    v_permlane16_swap_b32 v180, v182
    v_permlane16_swap_b32 v181, v183
    ds_write_b128 v10, v[180:183] offset:4096
    v_pk_mul_f32 v[164:165], v[140:141], v[134:135] op_sel:[0,1] op_sel_hi:[1,1]
    v_pk_mul_f32 v[166:167], v[142:143], v[134:135] op_sel:[0,1] op_sel_hi:[1,1]
    v_pk_mul_f32 v[168:169], v[144:145], v[134:135] op_sel:[0,1] op_sel_hi:[1,1]
    v_pk_mul_f32 v[170:171], v[146:147], v[134:135] op_sel:[0,1] op_sel_hi:[1,1]
    v_pk_fma_f32 v[36:37], v[36:37], v[134:135], v[164:165] op_sel:[0,0,0] op_sel_hi:[1,0,1]
    v_pk_fma_f32 v[38:39], v[38:39], v[134:135], v[166:167] op_sel:[0,0,0] op_sel_hi:[1,0,1]
    v_pk_fma_f32 v[52:53], v[52:53], v[134:135], v[168:169] op_sel:[0,0,0] op_sel_hi:[1,0,1]
    v_pk_fma_f32 v[54:55], v[54:55], v[134:135], v[170:171] op_sel:[0,0,0] op_sel_hi:[1,0,1]
    v_cvt_pk_bf16_f32 v184, v36, v37
    v_cvt_pk_bf16_f32 v185, v38, v39
    v_cvt_pk_bf16_f32 v186, v52, v53
    v_cvt_pk_bf16_f32 v187, v54, v55
    s_nop 1
    v_permlane16_swap_b32 v184, v186
    v_permlane16_swap_b32 v185, v187
    ds_write_b128 v10, v[184:187] offset:6144
    v_pk_mul_f32 v[164:165], v[148:149], v[128:129] op_sel:[0,1] op_sel_hi:[1,1]
    v_pk_mul_f32 v[166:167], v[150:151], v[128:129] op_sel:[0,1] op_sel_hi:[1,1]
    v_pk_mul_f32 v[168:169], v[152:153], v[128:129] op_sel:[0,1] op_sel_hi:[1,1]
    v_pk_mul_f32 v[170:171], v[154:155], v[128:129] op_sel:[0,1] op_sel_hi:[1,1]
    v_pk_fma_f32 v[56:57], v[56:57], v[128:129], v[164:165] op_sel:[0,0,0] op_sel_hi:[1,0,1]
    v_pk_fma_f32 v[58:59], v[58:59], v[128:129], v[166:167] op_sel:[0,0,0] op_sel_hi:[1,0,1]
    v_pk_fma_f32 v[72:73], v[72:73], v[128:129], v[168:169] op_sel:[0,0,0] op_sel_hi:[1,0,1]
    v_pk_fma_f32 v[74:75], v[74:75], v[128:129], v[170:171] op_sel:[0,0,0] op_sel_hi:[1,0,1]
    v_cvt_pk_bf16_f32 v172, v56, v57
    v_cvt_pk_bf16_f32 v173, v58, v59
    v_cvt_pk_bf16_f32 v174, v72, v73
    v_cvt_pk_bf16_f32 v175, v74, v75
    s_nop 1
    v_permlane16_swap_b32 v172, v174
    v_permlane16_swap_b32 v173, v175
    ds_write_b128 v11, v[172:175] offset:0
    v_pk_mul_f32 v[164:165], v[148:149], v[130:131] op_sel:[0,1] op_sel_hi:[1,1]
    v_pk_mul_f32 v[166:167], v[150:151], v[130:131] op_sel:[0,1] op_sel_hi:[1,1]
    v_pk_mul_f32 v[168:169], v[152:153], v[130:131] op_sel:[0,1] op_sel_hi:[1,1]
    v_pk_mul_f32 v[170:171], v[154:155], v[130:131] op_sel:[0,1] op_sel_hi:[1,1]
    v_pk_fma_f32 v[60:61], v[60:61], v[130:131], v[164:165] op_sel:[0,0,0] op_sel_hi:[1,0,1]
    v_pk_fma_f32 v[62:63], v[62:63], v[130:131], v[166:167] op_sel:[0,0,0] op_sel_hi:[1,0,1]
    v_pk_fma_f32 v[76:77], v[76:77], v[130:131], v[168:169] op_sel:[0,0,0] op_sel_hi:[1,0,1]
    v_pk_fma_f32 v[78:79], v[78:79], v[130:131], v[170:171] op_sel:[0,0,0] op_sel_hi:[1,0,1]
    v_cvt_pk_bf16_f32 v176, v60, v61
    v_cvt_pk_bf16_f32 v177, v62, v63
    v_cvt_pk_bf16_f32 v178, v76, v77
    v_cvt_pk_bf16_f32 v179, v78, v79
    s_nop 1
    v_permlane16_swap_b32 v176, v178
    v_permlane16_swap_b32 v177, v179
    ds_write_b128 v11, v[176:179] offset:2048
    v_pk_mul_f32 v[164:165], v[148:149], v[132:133] op_sel:[0,1] op_sel_hi:[1,1]
    v_pk_mul_f32 v[166:167], v[150:151], v[132:133] op_sel:[0,1] op_sel_hi:[1,1]
    v_pk_mul_f32 v[168:169], v[152:153], v[132:133] op_sel:[0,1] op_sel_hi:[1,1]
    v_pk_mul_f32 v[170:171], v[154:155], v[132:133] op_sel:[0,1] op_sel_hi:[1,1]
    v_pk_fma_f32 v[64:65], v[64:65], v[132:133], v[164:165] op_sel:[0,0,0] op_sel_hi:[1,0,1]
    v_pk_fma_f32 v[66:67], v[66:67], v[132:133], v[166:167] op_sel:[0,0,0] op_sel_hi:[1,0,1]
    v_pk_fma_f32 v[80:81], v[80:81], v[132:133], v[168:169] op_sel:[0,0,0] op_sel_hi:[1,0,1]
    v_pk_fma_f32 v[82:83], v[82:83], v[132:133], v[170:171] op_sel:[0,0,0] op_sel_hi:[1,0,1]
    v_cvt_pk_bf16_f32 v180, v64, v65
    v_cvt_pk_bf16_f32 v181, v66, v67
    v_cvt_pk_bf16_f32 v182, v80, v81
    v_cvt_pk_bf16_f32 v183, v82, v83
    s_nop 1
    v_permlane16_swap_b32 v180, v182
    v_permlane16_swap_b32 v181, v183
    ds_write_b128 v11, v[180:183] offset:4096
    v_pk_mul_f32 v[164:165], v[148:149], v[134:135] op_sel:[0,1] op_sel_hi:[1,1]
    v_pk_mul_f32 v[166:167], v[150:151], v[134:135] op_sel:[0,1] op_sel_hi:[1,1]
    v_pk_mul_f32 v[168:169], v[152:153], v[134:135] op_sel:[0,1] op_sel_hi:[1,1]
    v_pk_mul_f32 v[170:171], v[154:155], v[134:135] op_sel:[0,1] op_sel_hi:[1,1]
    v_pk_fma_f32 v[68:69], v[68:69], v[134:135], v[164:165] op_sel:[0,0,0] op_sel_hi:[1,0,1]
    v_pk_fma_f32 v[70:71], v[70:71], v[134:135], v[166:167] op_sel:[0,0,0] op_sel_hi:[1,0,1]
    v_pk_fma_f32 v[84:85], v[84:85], v[134:135], v[168:169] op_sel:[0,0,0] op_sel_hi:[1,0,1]
    v_pk_fma_f32 v[86:87], v[86:87], v[134:135], v[170:171] op_sel:[0,0,0] op_sel_hi:[1,0,1]
    v_cvt_pk_bf16_f32 v184, v68, v69
    v_cvt_pk_bf16_f32 v185, v70, v71
    v_cvt_pk_bf16_f32 v186, v84, v85
    v_cvt_pk_bf16_f32 v187, v86, v87
    s_nop 1
    v_permlane16_swap_b32 v184, v186
    v_permlane16_swap_b32 v185, v187
    ds_write_b128 v11, v[184:187] offset:6144
    v_pk_mul_f32 v[164:165], v[156:157], v[128:129] op_sel:[0,1] op_sel_hi:[1,1]
    v_pk_mul_f32 v[166:167], v[158:159], v[128:129] op_sel:[0,1] op_sel_hi:[1,1]
    v_pk_mul_f32 v[168:169], v[160:161], v[128:129] op_sel:[0,1] op_sel_hi:[1,1]
    v_pk_mul_f32 v[170:171], v[162:163], v[128:129] op_sel:[0,1] op_sel_hi:[1,1]
    v_pk_fma_f32 v[88:89], v[88:89], v[128:129], v[164:165] op_sel:[0,0,0] op_sel_hi:[1,0,1]
    v_pk_fma_f32 v[90:91], v[90:91], v[128:129], v[166:167] op_sel:[0,0,0] op_sel_hi:[1,0,1]
    v_pk_fma_f32 v[104:105], v[104:105], v[128:129], v[168:169] op_sel:[0,0,0] op_sel_hi:[1,0,1]
    v_pk_fma_f32 v[106:107], v[106:107], v[128:129], v[170:171] op_sel:[0,0,0] op_sel_hi:[1,0,1]
    v_cvt_pk_bf16_f32 v172, v88, v89
    v_cvt_pk_bf16_f32 v173, v90, v91
    v_cvt_pk_bf16_f32 v174, v104, v105
    v_cvt_pk_bf16_f32 v175, v106, v107
    s_nop 1
    v_permlane16_swap_b32 v172, v174
    v_permlane16_swap_b32 v173, v175
    ds_write_b128 v12, v[172:175] offset:0
    v_pk_mul_f32 v[164:165], v[156:157], v[130:131] op_sel:[0,1] op_sel_hi:[1,1]
    v_pk_mul_f32 v[166:167], v[158:159], v[130:131] op_sel:[0,1] op_sel_hi:[1,1]
    v_pk_mul_f32 v[168:169], v[160:161], v[130:131] op_sel:[0,1] op_sel_hi:[1,1]
    v_pk_mul_f32 v[170:171], v[162:163], v[130:131] op_sel:[0,1] op_sel_hi:[1,1]
    v_pk_fma_f32 v[92:93], v[92:93], v[130:131], v[164:165] op_sel:[0,0,0] op_sel_hi:[1,0,1]
    v_pk_fma_f32 v[94:95], v[94:95], v[130:131], v[166:167] op_sel:[0,0,0] op_sel_hi:[1,0,1]
    v_pk_fma_f32 v[108:109], v[108:109], v[130:131], v[168:169] op_sel:[0,0,0] op_sel_hi:[1,0,1]
    v_pk_fma_f32 v[110:111], v[110:111], v[130:131], v[170:171] op_sel:[0,0,0] op_sel_hi:[1,0,1]
    v_cvt_pk_bf16_f32 v176, v92, v93
    v_cvt_pk_bf16_f32 v177, v94, v95
    v_cvt_pk_bf16_f32 v178, v108, v109
    v_cvt_pk_bf16_f32 v179, v110, v111
    s_nop 1
    v_permlane16_swap_b32 v176, v178
    v_permlane16_swap_b32 v177, v179
    ds_write_b128 v12, v[176:179] offset:2048
    v_pk_mul_f32 v[164:165], v[156:157], v[132:133] op_sel:[0,1] op_sel_hi:[1,1]
    v_pk_mul_f32 v[166:167], v[158:159], v[132:133] op_sel:[0,1] op_sel_hi:[1,1]
    v_pk_mul_f32 v[168:169], v[160:161], v[132:133] op_sel:[0,1] op_sel_hi:[1,1]
    v_pk_mul_f32 v[170:171], v[162:163], v[132:133] op_sel:[0,1] op_sel_hi:[1,1]
    v_pk_fma_f32 v[96:97], v[96:97], v[132:133], v[164:165] op_sel:[0,0,0] op_sel_hi:[1,0,1]
    v_pk_fma_f32 v[98:99], v[98:99], v[132:133], v[166:167] op_sel:[0,0,0] op_sel_hi:[1,0,1]
    v_pk_fma_f32 v[112:113], v[112:113], v[132:133], v[168:169] op_sel:[0,0,0] op_sel_hi:[1,0,1]
    v_pk_fma_f32 v[114:115], v[114:115], v[132:133], v[170:171] op_sel:[0,0,0] op_sel_hi:[1,0,1]
    v_cvt_pk_bf16_f32 v180, v96, v97
    v_cvt_pk_bf16_f32 v181, v98, v99
    v_cvt_pk_bf16_f32 v182, v112, v113
    v_cvt_pk_bf16_f32 v183, v114, v115
    s_nop 1
    v_permlane16_swap_b32 v180, v182
    v_permlane16_swap_b32 v181, v183
    ds_write_b128 v12, v[180:183] offset:4096
    v_pk_mul_f32 v[164:165], v[156:157], v[134:135] op_sel:[0,1] op_sel_hi:[1,1]
    v_pk_mul_f32 v[166:167], v[158:159], v[134:135] op_sel:[0,1] op_sel_hi:[1,1]
    v_pk_mul_f32 v[168:169], v[160:161], v[134:135] op_sel:[0,1] op_sel_hi:[1,1]
    v_pk_mul_f32 v[170:171], v[162:163], v[134:135] op_sel:[0,1] op_sel_hi:[1,1]
    v_pk_fma_f32 v[100:101], v[100:101], v[134:135], v[164:165] op_sel:[0,0,0] op_sel_hi:[1,0,1]
    v_pk_fma_f32 v[102:103], v[102:103], v[134:135], v[166:167] op_sel:[0,0,0] op_sel_hi:[1,0,1]
    v_pk_fma_f32 v[116:117], v[116:117], v[134:135], v[168:169] op_sel:[0,0,0] op_sel_hi:[1,0,1]
    v_pk_fma_f32 v[118:119], v[118:119], v[134:135], v[170:171] op_sel:[0,0,0] op_sel_hi:[1,0,1]
    v_cvt_pk_bf16_f32 v184, v100, v101
    v_cvt_pk_bf16_f32 v185, v102, v103
    v_cvt_pk_bf16_f32 v186, v116, v117
    v_cvt_pk_bf16_f32 v187, v118, v119
    s_nop 1
    v_permlane16_swap_b32 v184, v186
    v_permlane16_swap_b32 v185, v187
    ds_write_b128 v12, v[184:187] offset:6144
    v_pk_mul_f32 v[164:165], v[156:157], v[136:137] op_sel:[0,1] op_sel_hi:[1,1]
    v_pk_mul_f32 v[166:167], v[158:159], v[136:137] op_sel:[0,1] op_sel_hi:[1,1]
    v_pk_mul_f32 v[168:169], v[160:161], v[136:137] op_sel:[0,1] op_sel_hi:[1,1]
    v_pk_mul_f32 v[170:171], v[162:163], v[136:137] op_sel:[0,1] op_sel_hi:[1,1]
    v_pk_fma_f32 v[120:121], v[120:121], v[136:137], v[164:165] op_sel:[0,0,0] op_sel_hi:[1,0,1]
    v_pk_fma_f32 v[122:123], v[122:123], v[136:137], v[166:167] op_sel:[0,0,0] op_sel_hi:[1,0,1]
    v_pk_fma_f32 v[124:125], v[124:125], v[136:137], v[168:169] op_sel:[0,0,0] op_sel_hi:[1,0,1]
    v_pk_fma_f32 v[126:127], v[126:127], v[136:137], v[170:171] op_sel:[0,0,0] op_sel_hi:[1,0,1]
    v_cvt_pk_bf16_f32 v172, v120, v121
    v_cvt_pk_bf16_f32 v173, v122, v123
    v_cvt_pk_bf16_f32 v174, v124, v125
    v_cvt_pk_bf16_f32 v175, v126, v127
    s_nop 1
    v_permlane16_swap_b32 v172, v174
    v_permlane16_swap_b32 v173, v175
    ds_write_b128 v13, v[172:175]
    s_waitcnt lgkmcnt(0)
g1_attn:
    s_add_u32 s16, s4, 0x400000
    s_addc_u32 s17, s5, 0
    s_mov_b32 s18, 0x400000
    s_mov_b32 s19, 0x20000
    s_and_b32 s44, s28, 1
    s_lshr_b32 s45, s28, 1
    s_lshl_b32 s40, s44, 2
    v_add_u32 v3, s40, v5
    v_and_b32 v4, 7, v8
    v_xor_b32 v3, v3, v4
    v_lshlrev_b32 v3, 4, v3
    v_lshl_add_u32 v3, v8, 8, v3
    s_mul_i32 s41, s45, 4096
    s_add_u32 s41, s41, 43008
    v_add_u32 v10, s41, v3
    v_lshl_add_u32 v3, v5, 2, v6
    v_and_b32 v4, 7, v3
    v_add_u32 v12, s40, v7
    v_xor_b32 v4, v4, v12
    v_lshlrev_b32 v4, 4, v4
    v_lshl_add_u32 v3, v3, 8, v4
    s_add_u32 s41, s41, 36864
    v_add_u32 v11, s41, v3
    v_and_b32 v3, 7, v8
    v_add_u32 v4, 1, v3
    s_or_b32 s40, s25, s45
    s_cmp_eq_u32 s40, 0
    s_cselect_b32 s40, 8, 0
    v_cmp_gt_u32 vcc, 8, v8
    v_mov_b32 v16, s40
    s_mov_b64 s[56:57], vcc
    v_cndmask_b32 v16, 0, v16, vcc
    v_max_u32 v4, v4, v16
    v_add_u32 v3, 8, v3
    v_sub_u32 v3, v3, v4
    v_lshlrev_b32 v16, 2, v5
    v_sub_u32 v16, v16, v4
    v_mov_b32 v17, 0xf149f2ca
    v_add_u32 v18, 0, v16
    v_cmp_ge_u32 vcc, v3, v18
    s_nop 1
    v_cndmask_b32 v12, v17, 0, vcc
    v_add_u32 v18, 1, v16
    v_cmp_ge_u32 vcc, v3, v18
    s_nop 1
    v_cndmask_b32 v13, v17, 0, vcc
    v_add_u32 v18, 2, v16
    v_cmp_ge_u32 vcc, v3, v18
    s_nop 1
    v_cndmask_b32 v14, v17, 0, vcc
    v_add_u32 v18, 3, v16
    v_cmp_ge_u32 vcc, v3, v18
    s_nop 1
    v_cndmask_b32 v15, v17, 0, vcc
    s_lshl_b32 s40, s25, 7
    s_lshl_b32 s41, s45, 5
    s_add_u32 s40, s40, s41
    s_lshl_b32 s40, s40, 11
    s_lshl_b32 s41, s24, 7
    s_add_u32 s40, s40, s41
    s_lshl_b32 s41, s44, 6
    s_add_u32 s40, s40, s41
    v_lshlrev_b32 v9, 12, v8
    v_lshl_add_u32 v9, v5, 4, v9
    v_add_u32 v9, s40, v9
    s_mov_b32 s58, 0x3e3504f3
    s_mov_b32 s59, 0x3fb8aa3b
    s_barrier
    ds_read_b128 v[24:27], v10 offset:2048
    ds_read_b128 v[28:31], v10 offset:18432
    ds_read_b128 v[32:35], v10 offset:20480
    ds_read_b128 v[72:75], v10 offset:2176
    ds_read_b128 v[76:79], v10 offset:18560
    ds_read_b128 v[80:83], v10 offset:20608
    ds_read_b64_tr_b16 v[36:37], v11 offset:0
    ds_read_b64_tr_b16 v[38:39], v11 offset:2048
    ds_read_b64_tr_b16 v[40:41], v11 offset:8
    ds_read_b64_tr_b16 v[42:43], v11 offset:2056
    ds_read_b64_tr_b16 v[84:85], v11 offset:128
    ds_read_b64_tr_b16 v[86:87], v11 offset:2176
    ds_read_b64_tr_b16 v[88:89], v11 offset:136
    ds_read_b64_tr_b16 v[90:91], v11 offset:2184
    s_waitcnt lgkmcnt(8)
    v_mfma_f32_16x16x32_bf16 v[44:47], v[28:31], v[24:27], 0
    v_mfma_f32_16x16x32_bf16 v[48:51], v[32:35], v[24:27], 0
    v_mfma_f32_16x16x32_bf16 v[92:95], v[76:79], v[72:75], 0
    v_mfma_f32_16x16x32_bf16 v[96:99], v[80:83], v[72:75], 0
    s_nop 7
    v_cndmask_b32 v44, v48, v44, s[56:57]
    v_cndmask_b32 v45, v49, v45, s[56:57]
    v_cndmask_b32 v46, v50, v46, s[56:57]
    v_cndmask_b32 v47, v51, v47, s[56:57]
    v_cndmask_b32 v92, v96, v92, s[56:57]
    v_cndmask_b32 v93, v97, v93, s[56:57]
    v_cndmask_b32 v94, v98, v94, s[56:57]
    v_cndmask_b32 v95, v99, v95, s[56:57]
    v_cvt_pk_bf16_f32 v48, v44, v45
    v_cvt_pk_bf16_f32 v49, v46, v47
    v_cvt_pk_bf16_f32 v96, v92, v93
    v_cvt_pk_bf16_f32 v97, v94, v95
    v_lshlrev_b32 v44, 16, v48
    v_and_b32 v45, 0xffff0000, v48
    v_lshlrev_b32 v46, 16, v49
    v_and_b32 v47, 0xffff0000, v49
    v_lshlrev_b32 v92, 16, v96
    v_and_b32 v93, 0xffff0000, v96
    v_lshlrev_b32 v94, 16, v97
    v_and_b32 v95, 0xffff0000, v97
    v_mul_f32 v44, s58, v44
    v_mul_f32 v45, s58, v45
    v_mul_f32 v46, s58, v46
    v_mul_f32 v47, s58, v47
    v_mul_f32 v92, s58, v92
    v_mul_f32 v93, s58, v93
    v_mul_f32 v94, s58, v94
    v_mul_f32 v95, s58, v95
    v_cvt_pk_bf16_f32 v48, v44, v45
    v_cvt_pk_bf16_f32 v49, v46, v47
    v_cvt_pk_bf16_f32 v96, v92, v93
    v_cvt_pk_bf16_f32 v97, v94, v95
    v_lshlrev_b32 v44, 16, v48
    v_and_b32 v45, 0xffff0000, v48
    v_lshlrev_b32 v46, 16, v49
    v_and_b32 v47, 0xffff0000, v49
    v_lshlrev_b32 v92, 16, v96
    v_and_b32 v93, 0xffff0000, v96
    v_lshlrev_b32 v94, 16, v97
    v_and_b32 v95, 0xffff0000, v97
    v_fma_f32 v44, v44, s59, v12
    v_fma_f32 v45, v45, s59, v13
    v_fma_f32 v46, v46, s59, v14
    v_fma_f32 v47, v47, s59, v15
    v_fma_f32 v92, v92, s59, v12
    v_fma_f32 v93, v93, s59, v13
    v_fma_f32 v94, v94, s59, v14
    v_fma_f32 v95, v95, s59, v15
    v_max3_f32 v48, v44, v45, v46
    v_max3_f32 v96, v92, v93, v94
    v_max_f32 v48, v48, v47
    v_max_f32 v96, v96, v95
    v_mov_b32 v49, v48
    v_mov_b32 v97, v96
    s_nop 1
    v_permlane16_swap_b32 v48, v49
    v_permlane16_swap_b32 v96, v97
    s_nop 0
    v_max_f32 v48, v48, v49
    v_max_f32 v96, v96, v97
    v_mov_b32 v49, v48
    v_mov_b32 v97, v96
    s_nop 1
    v_permlane32_swap_b32 v48, v49
    v_permlane32_swap_b32 v96, v97
    s_nop 0
    v_max_f32 v48, v48, v49
    v_max_f32 v96, v96, v97
    v_sub_f32 v44, v44, v48
    v_sub_f32 v45, v45, v48
    v_sub_f32 v46, v46, v48
    v_sub_f32 v47, v47, v48
    v_sub_f32 v92, v92, v96
    v_sub_f32 v93, v93, v96
    v_sub_f32 v94, v94, v96
    v_sub_f32 v95, v95, v96
    v_exp_f32 v44, v44
    v_exp_f32 v45, v45
    v_exp_f32 v46, v46
    v_exp_f32 v47, v47
    v_exp_f32 v92, v92
    v_exp_f32 v93, v93
    v_exp_f32 v94, v94
    v_exp_f32 v95, v95
    v_add_f32 v48, v44, v45
    v_add_f32 v49, v46, v47
    v_add_f32 v96, v92, v93
    v_add_f32 v97, v94, v95
    v_add_f32 v48, v48, v49
    v_add_f32 v96, v96, v97
    v_mov_b32 v49, v48
    v_mov_b32 v97, v96
    s_nop 1
    v_permlane16_swap_b32 v48, v49
    v_permlane16_swap_b32 v96, v97
    s_nop 0
    v_add_f32 v48, v48, v49
    v_add_f32 v96, v96, v97
    v_mov_b32 v49, v48
    v_mov_b32 v97, v96
    s_nop 1
    v_permlane32_swap_b32 v48, v49
    v_permlane32_swap_b32 v96, v97
    s_nop 0
    v_add_f32 v48, v48, v49
    v_add_f32 v96, v96, v97
    v_rcp_f32 v48, v48
    v_rcp_f32 v96, v96
    s_nop 0
    v_mul_f32 v44, v44, v48
    v_mul_f32 v45, v45, v48
    v_mul_f32 v46, v46, v48
    v_mul_f32 v47, v47, v48
    v_mul_f32 v92, v92, v96
    v_mul_f32 v93, v93, v96
    v_mul_f32 v94, v94, v96
    v_mul_f32 v95, v95, v96
    v_cvt_pk_bf16_f32 v48, v44, v45
    v_cvt_pk_bf16_f32 v49, v46, v47
    v_cvt_pk_bf16_f32 v96, v92, v93
    v_cvt_pk_bf16_f32 v97, v94, v95
    v_cndmask_b32 v52, 0, v48, s[56:57]
    v_cndmask_b32 v53, 0, v49, s[56:57]
    v_cndmask_b32 v54, v48, 0, s[56:57]
    v_cndmask_b32 v55, v49, 0, s[56:57]
    v_cndmask_b32 v100, 0, v96, s[56:57]
    v_cndmask_b32 v101, 0, v97, s[56:57]
    v_cndmask_b32 v102, v96, 0, s[56:57]
    v_cndmask_b32 v103, v97, 0, s[56:57]
    s_waitcnt lgkmcnt(0)
    s_nop 0
    v_mfma_f32_16x16x32_bf16 v[56:59], v[36:39], v[52:55], 0
    v_mfma_f32_16x16x32_bf16 v[60:63], v[40:43], v[52:55], 0
    v_mfma_f32_16x16x32_bf16 v[104:107], v[84:87], v[100:103], 0
    v_mfma_f32_16x16x32_bf16 v[108:111], v[88:91], v[100:103], 0
    s_nop 7
    v_cvt_pk_bf16_f32 v64, v56, v57
    v_cvt_pk_bf16_f32 v65, v58, v59
    v_cvt_pk_bf16_f32 v66, v60, v61
    v_cvt_pk_bf16_f32 v67, v62, v63
    buffer_store_dwordx4 v[64:67], v9, s[16:19], 0 offen offset:0 sc1
    v_cvt_pk_bf16_f32 v112, v104, v105
    v_cvt_pk_bf16_f32 v113, v106, v107
    v_cvt_pk_bf16_f32 v114, v108, v109
    v_cvt_pk_bf16_f32 v115, v110, v111
    buffer_store_dwordx4 v[112:115], v9, s[16:19], 0 offen offset:2048 sc1
g1_done:
    s_endpgm
.section .rodata,"a"
.p2align 6
.amdhsa_kernel g1a_kernel
  .amdhsa_next_free_vgpr 216
  .amdhsa_next_free_sgpr 72
  .amdhsa_accum_offset 216
  .amdhsa_group_segment_fixed_size 0
  .amdhsa_kernarg_size 88
  .amdhsa_user_sgpr_count 2
  .amdhsa_user_sgpr_kernarg_segment_ptr 1
  .amdhsa_system_sgpr_workgroup_id_x 1
.end_amdhsa_kernel
.section .rodata,"a"
.p2align 6
.amdhsa_kernel g1b_kernel
  .amdhsa_next_free_vgpr 216
  .amdhsa_next_free_sgpr 72
  .amdhsa_accum_offset 216
  .amdhsa_group_segment_fixed_size 0
  .amdhsa_kernarg_size 88
  .amdhsa_user_sgpr_count 2
  .amdhsa_user_sgpr_kernarg_segment_ptr 1
  .amdhsa_system_sgpr_workgroup_id_x 1
.end_amdhsa_kernel
.text
.globl g2a_kernel
.p2align 8
.type g2a_kernel,@function
g2a_kernel:
    s_load_dwordx2 s[6:7], s[0:1], 0
    s_mov_b32 s47, 0
    s_branch g2_body
.text
.globl g2b_kernel
.p2align 8
.type g2b_kernel,@function
g2b_kernel:
    s_load_dwordx2 s[6:7], s[0:1], 80
    s_mov_b32 s47, 0x1800000
    s_branch g2_body
.p2align 6
g2_body:
    s_cmp_ge_u32 s2, 256
    s_cbranch_scc1 g2_done
    s_load_dwordx2 s[4:5], s[0:1], 80
    s_load_dwordx2 s[30:31], s[0:1], 16
    v_lshrrev_b32 v1, 6, v0
    v_and_b32 v2, 63, v0
    s_and_b32 s40, s2, 3
    s_lshl_b32 s40, s40, 2
    s_bfe_u32 s41, s2, 0x20003
    s_add_u32 s25, s40, s41
    s_bfe_u32 s40, s2, 0x10002
    s_lshl_b32 s40, s40, 3
    s_lshr_b32 s42, s2, 5
    s_add_u32 s24, s40, s42
    s_add_u32 s27, s41, s42
    s_mov_b32 s26, 0
    v_readfirstlane_b32 s28, v1
    s_nop 0
    s_cmp_lt_u32 s28, 4
    s_cbranch_scc1 g2_compute
    s_sub_u32 s28, s28, 4
    s_mov_b32 s40, 2048
    v_lshrrev_b32 v3, 3, v2
    v_mul_lo_u32 v3, v3, s40
    v_bfe_u32 v4, v2, 4, 1
    v_lshlrev_b32 v4, 1, v4
    v_xor_b32 v4, v4, v2
    v_and_b32 v4, 7, v4
    v_lshl_add_u32 v3, v4, 4, v3
    s_mul_i32 s41, s24, 128
    s_mul_i32 s42, s28, 32768
    s_add_u32 s41, s41, s42
    v_xor_b32 v4, 64, v3
    s_add_u32 s42, s41, 0
    v_add_u32 v10, s42, v3
    s_add_u32 s42, s41, 16384
    v_add_u32 v11, s42, v4
    s_mov_b32 s40, 2048
    v_lshrrev_b32 v3, 3, v2
    v_mul_lo_u32 v3, v3, s40
    v_lshrrev_b32 v4, 4, v2
    v_xor_b32 v4, v4, v2
    v_and_b32 v4, 7, v4
    v_lshl_add_u32 v3, v4, 4, v3
    s_mul_i32 s41, s25, 262144
    s_mul_i32 s42, s28, 65536
    s_add_u32 s41, s41, s42
    v_xor_b32 v4, 64, v3
    s_add_u32 s42, s41, 0
    v_add_u32 v12, s42, v3
    s_add_u32 s42, s41, 16384
    v_add_u32 v13, s42, v4
    s_add_u32 s42, s41, 32768
    v_add_u32 v14, s42, v3
    s_add_u32 s42, s41, 49152
    v_add_u32 v15, s42, v4
    s_mul_i32 s36, s28, 2048
    s_mul_i32 s37, s28, 4096
    s_add_u32 s37, s37, 8192
    s_waitcnt lgkmcnt(0)
    s_mov_b32 s8, s30
    s_mov_b32 s9, s31
    s_mov_b32 s10, 0x200000
    s_mov_b32 s11, 0x20000
    s_add_u32 s12, s4, 0x400000
    s_addc_u32 s13, s5, 0
    s_mov_b32 s14, 0x400000
    s_mov_b32 s15, 0x20000
    s_mov_b32 s32, 0
    s_mov_b32 s33, 0
g2_ld_loop:
    s_cmp_lt_u32 s32, 3
    s_cbranch_scc1 g2_ld_issue
    s_waitcnt vmcnt(12)
g2_ld_bar:
    s_barrier
g2_ld_issue:
    s_add_u32 s40, s32, s27
    s_and_b32 s40, s40, 1
    s_andn2_b32 s41, s32, 1
    s_or_b32 s40, s40, s41
    s_add_u32 s40, s40, s26
    s_mul_i32 s34, s40, 131072
    s_mul_i32 s35, s40, 128
    s_add_u32 s38, s33, s36
    s_add_u32 s39, s33, s37
    s_add_u32 m0, s38, 0
    s_nop 0
    buffer_load_dwordx4 v10, s[8:11], s34 offen lds
    s_add_u32 m0, s38, 1024
    s_nop 0
    buffer_load_dwordx4 v11, s[8:11], s34 offen lds
    s_add_u32 m0, s39, 0
    s_nop 0
    buffer_load_dwordx4 v12, s[12:15], s35 offen lds
    s_add_u32 m0, s39, 1024
    s_nop 0
    buffer_load_dwordx4 v13, s[12:15], s35 offen lds
    s_add_u32 m0, s39, 2048
    s_nop 0
    buffer_load_dwordx4 v14, s[12:15], s35 offen lds
    s_add_u32 m0, s39, 3072
    s_nop 0
    buffer_load_dwordx4 v15, s[12:15], s35 offen lds
    s_add_u32 s33, s33, 24576
    s_cmp_eq_u32 s33, 98304
    s_cselect_b32 s33, 0, s33
    s_add_u32 s32, s32, 1
    s_cmp_lt_u32 s32, 16
    s_cbranch_scc1 g2_ld_loop
    s_waitcnt vmcnt(12)
    s_barrier
    s_waitcnt vmcnt(6)
    s_barrier
    s_waitcnt vmcnt(0)
    s_barrier
g2_done:
    s_endpgm
g2_compute:
    v_lshrrev_b32 v5, 4, v2
    v_bfe_u32 v6, v2, 2, 2
    v_and_b32 v7, 3, v2
    v_and_b32 v8, 15, v2
    s_and_b32 s44, s28, 0
    s_lshr_b32 s45, s28, 0
    s_mul_i32 s40, s25, 128
    s_mul_i32 s41, s45, 32
    s_add_u32 s40, s40, s41
    v_add_u32 v20, s40, v8
    s_mov_b32 s41, 2048
    v_mul_lo_u32 v9, v20, s41
    s_mul_i32 s40, s24, 128
    s_mul_i32 s41, s44, 128
    s_add_u32 s46, s40, s41
    v_and_b32 v3, 1, v5
    v_lshlrev_b32 v3, 5, v3
    v_lshrrev_b32 v4, 1, v5
    v_lshl_add_u32 v3, v4, 4, v3
    v_add3_u32 v9, v9, v3, s46
    s_mov_b32 s52, 0
    s_mov_b32 s53, 32768
    s_waitcnt lgkmcnt(0)
    s_add_u32 s20, s6, s47
    s_addc_u32 s21, s7, 0
    s_mov_b32 s22, 0x400000
    s_mov_b32 s23, 0x20000
    s_add_u32 s16, s4, 0x800000
    s_addc_u32 s17, s5, 0
    s_mov_b32 s18, 0x400000
    s_mov_b32 s19, 0x20000
    s_add_u32 s56, s4, 0xc00000
    s_addc_u32 s57, s5, 0
    s_mov_b32 s58, 0x400000
    s_mov_b32 s59, 0x20000
    s_add_u32 s60, s4, 0x200000
    s_addc_u32 s61, s5, 0
    s_mov_b32 s62, 0x40000
    s_mov_b32 s63, 0x20000
    buffer_load_dwordx4 v[60:63], v9, s[20:23], s52 offen offset:0
    buffer_load_dwordx4 v[64:67], v9, s[20:23], s52 offen offset:64
    buffer_load_dwordx4 v[68:71], v9, s[20:23], s53 offen offset:0
    buffer_load_dwordx4 v[72:75], v9, s[20:23], s53 offen offset:64
    s_mul_i32 s42, s44, 4
    s_mov_b32 s43, 0
    v_and_b32 v3, 1, v5
    v_lshlrev_b32 v3, 1, v3
    v_lshrrev_b32 v4, 1, v6
    v_or_b32 v3, v3, v4
    s_add_u32 s40, s42, 0
    v_xor_b32 v3, s40, v3
    v_lshlrev_b32 v3, 5, v3
    v_lshl_add_u32 v3, v7, 3, v3
    v_lshl_add_u32 v4, v5, 3, v6
    v_lshl_add_u32 v3, v4, 7, v3
    v_add_u32 v10, s43, v3
    v_and_b32 v3, 1, v5
    v_lshlrev_b32 v3, 1, v3
    v_lshrrev_b32 v4, 1, v6
    v_or_b32 v3, v3, v4
    s_add_u32 s40, s42, 1
    v_xor_b32 v3, s40, v3
    v_lshlrev_b32 v3, 5, v3
    v_lshl_add_u32 v3, v7, 3, v3
    v_lshl_add_u32 v4, v5, 3, v6
    v_lshl_add_u32 v3, v4, 7, v3
    v_add_u32 v11, s43, v3
    v_and_b32 v3, 1, v5
    v_lshlrev_b32 v3, 1, v3
    v_lshrrev_b32 v4, 1, v6
    v_or_b32 v3, v3, v4
    s_add_u32 s40, s42, 2
    v_xor_b32 v3, s40, v3
    v_lshlrev_b32 v3, 5, v3
    v_lshl_add_u32 v3, v7, 3, v3
    v_lshl_add_u32 v4, v5, 3, v6
    v_lshl_add_u32 v3, v4, 7, v3
    v_add_u32 v12, s43, v3
    v_and_b32 v3, 1, v5
    v_lshlrev_b32 v3, 1, v3
    v_lshrrev_b32 v4, 1, v6
    v_or_b32 v3, v3, v4
    s_add_u32 s40, s42, 3
    v_xor_b32 v3, s40, v3
    v_lshlrev_b32 v3, 5, v3
    v_lshl_add_u32 v3, v7, 3, v3
    v_lshl_add_u32 v4, v5, 3, v6
    v_lshl_add_u32 v3, v4, 7, v3
    v_add_u32 v13, s43, v3
    s_mul_i32 s42, s45, 32
    v_lshrrev_b32 v3, 1, v8
    v_xor_b32 v3, v3, v5
    v_lshlrev_b32 v3, 4, v3
    v_lshl_add_u32 v3, v8, 7, v3
    s_lshl_b32 s40, s42, 7
    s_add_u32 s40, s40, 8192
    v_add_u32 v14, s40, v3
    v_xor_b32 v15, 64, v14
    v_mov_b32 v84, 0
    v_mov_b32 v85, 0
    v_mov_b32 v86, 0
    v_mov_b32 v87, 0
    v_mov_b32 v88, 0
    v_mov_b32 v89, 0
    v_mov_b32 v90, 0
    v_mov_b32 v91, 0
    v_mov_b32 v92, 0
    v_mov_b32 v93, 0
    v_mov_b32 v94, 0
    v_mov_b32 v95, 0
    v_mov_b32 v96, 0
    v_mov_b32 v97, 0
    v_mov_b32 v98, 0
    v_mov_b32 v99, 0
    v_mov_b32 v100, 0
    v_mov_b32 v101, 0
    v_mov_b32 v102, 0
    v_mov_b32 v103, 0
    v_mov_b32 v104, 0
    v_mov_b32 v105, 0
    v_mov_b32 v106, 0
    v_mov_b32 v107, 0
    s_mov_b32 s48, 16
    s_mov_b32 s50, 0
    s_mov_b32 s51, 24576
    s_mov_b32 s29, 0xfffee000
    s_waitcnt vmcnt(0)
    v_permlane16_swap_b32 v60, v62
    v_permlane16_swap_b32 v61, v63
    v_permlane16_swap_b32 v64, v66
    v_permlane16_swap_b32 v65, v67
    v_permlane16_swap_b32 v68, v70
    v_permlane16_swap_b32 v69, v71
    v_permlane16_swap_b32 v72, v74
    v_permlane16_swap_b32 v73, v75
    v_lshlrev_b32 v28, 16, v60
    v_and_b32 v29, 0xffff0000, v60
    v_lshlrev_b32 v30, 16, v61
    v_and_b32 v31, 0xffff0000, v61
    v_lshlrev_b32 v36, 16, v62
    v_and_b32 v37, 0xffff0000, v62
    v_lshlrev_b32 v38, 16, v63
    v_and_b32 v39, 0xffff0000, v63
    v_lshlrev_b32 v44, 16, v64
    v_and_b32 v45, 0xffff0000, v64
    v_lshlrev_b32 v46, 16, v65
    v_and_b32 v47, 0xffff0000, v65
    v_lshlrev_b32 v52, 16, v66
    v_and_b32 v53, 0xffff0000, v66
    v_lshlrev_b32 v54, 16, v67
    v_and_b32 v55, 0xffff0000, v67
    v_lshlrev_b32 v32, 16, v68
    v_and_b32 v33, 0xffff0000, v68
    v_lshlrev_b32 v34, 16, v69
    v_and_b32 v35, 0xffff0000, v69
    v_lshlrev_b32 v40, 16, v70
    v_and_b32 v41, 0xffff0000, v70
    v_lshlrev_b32 v42, 16, v71
    v_and_b32 v43, 0xffff0000, v71
    v_lshlrev_b32 v48, 16, v72
    v_and_b32 v49, 0xffff0000, v72
    v_lshlrev_b32 v50, 16, v73
    v_and_b32 v51, 0xffff0000, v73
    v_lshlrev_b32 v56, 16, v74
    v_and_b32 v57, 0xffff0000, v74
    v_lshlrev_b32 v58, 16, v75
    v_and_b32 v59, 0xffff0000, v75
.p2align 3
g2_cloop:
    s_barrier
g2_cloop2:
    v_mfma_f32_16x16x32_bf16 v[28:31], v[84:87], v[100:103], v[28:31]
    ds_read_b64_tr_b16 v[60:61], v10 offset:0
    ds_read_b64_tr_b16 v[62:63], v10 offset:512
    v_mfma_f32_16x16x32_bf16 v[32:35], v[84:87], v[104:107], v[32:35]
    ds_read_b128 v[76:79], v14 offset:0
    v_mfma_f32_16x16x32_bf16 v[36:39], v[88:91], v[100:103], v[36:39]
    ds_read_b128 v[80:83], v14 offset:2048
    v_mfma_f32_16x16x32_bf16 v[40:43], v[88:91], v[104:107], v[40:43]
    ds_read_b64_tr_b16 v[64:65], v11 offset:0
    ds_read_b64_tr_b16 v[66:67], v11 offset:512
    v_mfma_f32_16x16x32_bf16 v[44:47], v[92:95], v[100:103], v[44:47]
    ds_read_b64_tr_b16 v[68:69], v12 offset:0
    ds_read_b64_tr_b16 v[70:71], v12 offset:512
    v_mfma_f32_16x16x32_bf16 v[48:51], v[92:95], v[104:107], v[48:51]
    ds_read_b64_tr_b16 v[72:73], v13 offset:0
    ds_read_b64_tr_b16 v[74:75], v13 offset:512
    v_mfma_f32_16x16x32_bf16 v[52:55], v[96:99], v[100:103], v[52:55]
    v_mfma_f32_16x16x32_bf16 v[56:59], v[96:99], v[104:107], v[56:59]
    s_waitcnt lgkmcnt(0)
    v_mfma_f32_16x16x32_bf16 v[28:31], v[60:63], v[76:79], v[28:31]
    ds_read_b64_tr_b16 v[84:85], v10 offset:4096
    ds_read_b64_tr_b16 v[86:87], v10 offset:4608
    v_mfma_f32_16x16x32_bf16 v[32:35], v[60:63], v[80:83], v[32:35]
    ds_read_b128 v[100:103], v15 offset:0
    v_mfma_f32_16x16x32_bf16 v[36:39], v[64:67], v[76:79], v[36:39]
    ds_read_b128 v[104:107], v15 offset:2048
    v_mfma_f32_16x16x32_bf16 v[40:43], v[64:67], v[80:83], v[40:43]
    ds_read_b64_tr_b16 v[88:89], v11 offset:4096
    ds_read_b64_tr_b16 v[90:91], v11 offset:4608
    v_mfma_f32_16x16x32_bf16 v[44:47], v[68:71], v[76:79], v[44:47]
    ds_read_b64_tr_b16 v[92:93], v12 offset:4096
    ds_read_b64_tr_b16 v[94:95], v12 offset:4608
    v_mfma_f32_16x16x32_bf16 v[48:51], v[68:71], v[80:83], v[48:51]
    ds_read_b64_tr_b16 v[96:97], v13 offset:4096
    ds_read_b64_tr_b16 v[98:99], v13 offset:4608
    v_mfma_f32_16x16x32_bf16 v[52:55], v[72:75], v[76:79], v[52:55]
    s_add_u32 s50, s50, 1
    s_cmp_eq_u32 s50, 4
    v_mfma_f32_16x16x32_bf16 v[56:59], v[72:75], v[80:83], v[56:59]
    s_cselect_b32 s49, s29, s51
    s_cselect_b32 s50, 0, s50
    v_add_u32 v10, s49, v10
    v_add_u32 v11, s49, v11
    v_add_u32 v12, s49, v12
    v_add_u32 v13, s49, v13
    v_add_u32 v14, s49, v14
    v_add_u32 v15, s49, v15
    s_sub_u32 s48, s48, 1
    s_cmp_lg_u32 s48, 0
    s_waitcnt lgkmcnt(0)
    s_cbranch_scc1 g2_cloop
    v_mfma_f32_16x16x32_bf16 v[28:31], v[84:87], v[100:103], v[28:31]
    v_mfma_f32_16x16x32_bf16 v[32:35], v[84:87], v[104:107], v[32:35]
    v_mfma_f32_16x16x32_bf16 v[36:39], v[88:91], v[100:103], v[36:39]
    v_mfma_f32_16x16x32_bf16 v[40:43], v[88:91], v[104:107], v[40:43]
    v_mfma_f32_16x16x32_bf16 v[44:47], v[92:95], v[100:103], v[44:47]
    v_mfma_f32_16x16x32_bf16 v[48:51], v[92:95], v[104:107], v[48:51]
    v_mfma_f32_16x16x32_bf16 v[52:55], v[96:99], v[100:103], v[52:55]
    v_mfma_f32_16x16x32_bf16 v[56:59], v[96:99], v[104:107], v[56:59]
    s_nop 7
    v_pk_add_f32 v[76:77], v[28:29], v[30:31]
    v_pk_mul_f32 v[78:79], v[28:29], v[28:29]
    v_pk_fma_f32 v[78:79], v[30:31], v[30:31], v[78:79]
    v_pk_add_f32 v[76:77], v[76:77], v[36:37]
    v_pk_fma_f32 v[78:79], v[36:37], v[36:37], v[78:79]
    v_pk_add_f32 v[76:77], v[76:77], v[38:39]
    v_pk_fma_f32 v[78:79], v[38:39], v[38:39], v[78:79]
    v_pk_add_f32 v[76:77], v[76:77], v[44:45]
    v_pk_fma_f32 v[78:79], v[44:45], v[44:45], v[78:79]
    v_pk_add_f32 v[76:77], v[76:77], v[46:47]
    v_pk_fma_f32 v[78:79], v[46:47], v[46:47], v[78:79]
    v_pk_add_f32 v[76:77], v[76:77], v[52:53]
    v_pk_fma_f32 v[78:79], v[52:53], v[52:53], v[78:79]
    v_pk_add_f32 v[76:77], v[76:77], v[54:55]
    v_pk_fma_f32 v[78:79], v[54:55], v[54:55], v[78:79]
    v_pk_add_f32 v[80:81], v[32:33], v[34:35]
    v_pk_mul_f32 v[82:83], v[32:33], v[32:33]
    v_pk_fma_f32 v[82:83], v[34:35], v[34:35], v[82:83]
    v_pk_add_f32 v[80:81], v[80:81], v[40:41]
    v_pk_fma_f32 v[82:83], v[40:41], v[40:41], v[82:83]
    v_pk_add_f32 v[80:81], v[80:81], v[42:43]
    v_pk_fma_f32 v[82:83], v[42:43], v[42:43], v[82:83]
    v_pk_add_f32 v[80:81], v[80:81], v[48:49]
    v_pk_fma_f32 v[82:83], v[48:49], v[48:49], v[82:83]
    v_pk_add_f32 v[80:81], v[80:81], v[50:51]
    v_pk_fma_f32 v[82:83], v[50:51], v[50:51], v[82:83]
    v_pk_add_f32 v[80:81], v[80:81], v[56:57]
    v_pk_fma_f32 v[82:83], v[56:57], v[56:57], v[82:83]
    v_pk_add_f32 v[80:81], v[80:81], v[58:59]
    v_pk_fma_f32 v[82:83], v[58:59], v[58:59], v[82:83]
    v_add_f32 v76, v76, v77
    v_add_f32 v77, v78, v79
    v_add_f32 v80, v80, v81
    v_add_f32 v81, v82, v83
    s_nop 1
    v_permlane16_swap_b32 v76, v80
    v_permlane16_swap_b32 v77, v81
    v_pk_add_f32 v[76:77], v[76:77], v[80:81]
    v_mov_b32 v84, v76
    v_mov_b32 v85, v77
    v_and_b32 v3, 16, v2
    v_add_u32 v3, v3, v20
    v_permlane32_swap_b32 v76, v84
    v_permlane32_swap_b32 v77, v85
    v_pk_add_f32 v[76:77], v[76:77], v[84:85]
    v_lshlrev_b32 v3, 3, v3
    s_mul_i32 s40, s24, 1
    s_add_u32 s40, s40, s44
    s_lshl_b32 s40, s40, 14
    s_mov_b32 exec_hi, 0
    buffer_store_dwordx2 v[76:77], v3, s[60:63], s40 offen sc1
    s_mov_b32 exec_hi, -1
    v_lshrrev_b32 v4, 5, v2
    v_lshl_add_u32 v21, v4, 17, v3
    v_cvt_pk_bf16_f32 v60, v28, v29
    v_cvt_pk_bf16_f32 v61, v30, v31
    v_cvt_pk_bf16_f32 v62, v36, v37
    v_cvt_pk_bf16_f32 v63, v38, v39
    v_lshlrev_b32 v28, 16, v60
    v_and_b32 v29, 0xffff0000, v60
    v_lshlrev_b32 v30, 16, v61
    v_and_b32 v31, 0xffff0000, v61
    v_lshlrev_b32 v36, 16, v62
    v_and_b32 v37, 0xffff0000, v62
    v_lshlrev_b32 v38, 16, v63
    v_and_b32 v39, 0xffff0000, v63
    v_permlane16_swap_b32 v60, v62
    v_permlane16_swap_b32 v61, v63
    buffer_store_dwordx4 v[60:63], v9, s[16:19], s52 offen offset:0 sc1
    v_cvt_pk_bf16_f32 v64, v44, v45
    v_cvt_pk_bf16_f32 v65, v46, v47
    v_cvt_pk_bf16_f32 v66, v52, v53
    v_cvt_pk_bf16_f32 v67, v54, v55
    v_lshlrev_b32 v44, 16, v64
    v_and_b32 v45, 0xffff0000, v64
    v_lshlrev_b32 v46, 16, v65
    v_and_b32 v47, 0xffff0000, v65
    v_lshlrev_b32 v52, 16, v66
    v_and_b32 v53, 0xffff0000, v66
    v_lshlrev_b32 v54, 16, v67
    v_and_b32 v55, 0xffff0000, v67
    v_permlane16_swap_b32 v64, v66
    v_permlane16_swap_b32 v65, v67
    buffer_store_dwordx4 v[64:67], v9, s[16:19], s52 offen offset:64 sc1
    v_cvt_pk_bf16_f32 v68, v32, v33
    v_cvt_pk_bf16_f32 v69, v34, v35
    v_cvt_pk_bf16_f32 v70, v40, v41
    v_cvt_pk_bf16_f32 v71, v42, v43
    v_lshlrev_b32 v32, 16, v68
    v_and_b32 v33, 0xffff0000, v68
    v_lshlrev_b32 v34, 16, v69
    v_and_b32 v35, 0xffff0000, v69
    v_lshlrev_b32 v40, 16, v70
    v_and_b32 v41, 0xffff0000, v70
    v_lshlrev_b32 v42, 16, v71
    v_and_b32 v43, 0xffff0000, v71
    v_permlane16_swap_b32 v68, v70
    v_permlane16_swap_b32 v69, v71
    buffer_store_dwordx4 v[68:71], v9, s[16:19], s53 offen offset:0 sc1
    v_cvt_pk_bf16_f32 v72, v48, v49
    v_cvt_pk_bf16_f32 v73, v50, v51
    v_cvt_pk_bf16_f32 v74, v56, v57
    v_cvt_pk_bf16_f32 v75, v58, v59
    v_lshlrev_b32 v48, 16, v72
    v_and_b32 v49, 0xffff0000, v72
    v_lshlrev_b32 v50, 16, v73
    v_and_b32 v51, 0xffff0000, v73
    v_lshlrev_b32 v56, 16, v74
    v_and_b32 v57, 0xffff0000, v74
    v_lshlrev_b32 v58, 16, v75
    v_and_b32 v59, 0xffff0000, v75
    v_permlane16_swap_b32 v72, v74
    v_permlane16_swap_b32 v73, v75
    buffer_store_dwordx4 v[72:75], v9, s[16:19], s53 offen offset:64 sc1
    s_mov_b32 s48, 0x2000
    s_mov_b32 s40, 0
    buffer_load_dwordx2 v[108:109], v21, s[60:63], s40 offen sc1
    s_mov_b32 s41, 16384
    buffer_load_dwordx2 v[110:111], v21, s[60:63], s41 offen sc1
    s_mov_b32 s40, 32768
    buffer_load_dwordx2 v[112:113], v21, s[60:63], s40 offen sc1
    s_mov_b32 s41, 49152
    buffer_load_dwordx2 v[114:115], v21, s[60:63], s41 offen sc1
    s_mov_b32 s40, 65536
    buffer_load_dwordx2 v[116:117], v21, s[60:63], s40 offen sc1
    s_mov_b32 s41, 81920
    buffer_load_dwordx2 v[118:119], v21, s[60:63], s41 offen sc1
    s_mov_b32 s40, 98304
    buffer_load_dwordx2 v[120:121], v21, s[60:63], s40 offen sc1
    s_mov_b32 s41, 114688
    buffer_load_dwordx2 v[122:123], v21, s[60:63], s41 offen sc1
    s_waitcnt vmcnt(0)
g2_ex:
    v_max3_u32 v4, v108, v109, v110
    v_max3_u32 v4, v4, v111, v112
    v_max3_u32 v4, v4, v113, v114
    v_max3_u32 v4, v4, v115, v116
    v_max3_u32 v4, v4, v117, v118
    v_max3_u32 v4, v4, v119, v120
    v_max3_u32 v4, v4, v121, v122
    v_max_u32 v4, v4, v123
    v_cmp_eq_u32 vcc, -1, v4
    s_sub_u32 s48, s48, 1
    s_cmp_eq_u32 s48, 0
    s_cbranch_scc1 g2_exd
    s_cbranch_vccz g2_exd
    s_sleep 2
    s_mov_b32 s40, 0
    buffer_load_dwordx2 v[108:109], v21, s[60:63], s40 offen sc1
    s_mov_b32 s41, 16384
    buffer_load_dwordx2 v[110:111], v21, s[60:63], s41 offen sc1
    s_mov_b32 s40, 32768
    buffer_load_dwordx2 v[112:113], v21, s[60:63], s40 offen sc1
    s_mov_b32 s41, 49152
    buffer_load_dwordx2 v[114:115], v21, s[60:63], s41 offen sc1
    s_mov_b32 s40, 65536
    buffer_load_dwordx2 v[116:117], v21, s[60:63], s40 offen sc1
    s_mov_b32 s41, 81920
    buffer_load_dwordx2 v[118:119], v21, s[60:63], s41 offen sc1
    s_mov_b32 s40, 98304
    buffer_load_dwordx2 v[120:121], v21, s[60:63], s40 offen sc1
    s_mov_b32 s41, 114688
    buffer_load_dwordx2 v[122:123], v21, s[60:63], s41 offen sc1
    s_waitcnt vmcnt(0)
    s_branch g2_ex
g2_exd:
    v_pk_add_f32 v[108:109], v[108:109], v[116:117]
    v_pk_add_f32 v[110:111], v[110:111], v[118:119]
    v_pk_add_f32 v[112:113], v[112:113], v[120:121]
    v_pk_add_f32 v[114:115], v[114:115], v[122:123]
    v_pk_add_f32 v[108:109], v[108:109], v[112:113]
    v_pk_add_f32 v[110:111], v[110:111], v[114:115]
    v_pk_add_f32 v[108:109], v[108:109], v[110:111]
    v_mov_b32 v110, v108
    v_mov_b32 v111, v109
    s_nop 1
    v_permlane32_swap_b32 v108, v110
    v_permlane32_swap_b32 v109, v111
    v_pk_add_f32 v[108:109], v[108:109], v[110:111]
    v_mul_f32 v108, 0x3a800000, v108
    v_mul_f32 v109, 0x3a800000, v109
    v_fma_f32 v109, -v108, v108, v109
    v_max_f32 v109, 0, v109
    v_mov_b32 v110, v108
    v_mov_b32 v111, v109
    v_cvt_pk_bf16_f32 v110, v110, v110
    v_lshlrev_b32 v110, 16, v110
    v_cvt_pk_bf16_f32 v111, v111, v111
    v_lshlrev_b32 v111, 16, v111
    v_add_f32 v111, 0x3727c5ac, v111
    v_cvt_pk_bf16_f32 v111, v111, v111
    v_lshlrev_b32 v111, 16, v111
    v_sqrt_f32 v111, v111
    s_nop 0
    v_cvt_pk_bf16_f32 v111, v111, v111
    v_lshlrev_b32 v111, 16, v111
    v_rcp_f32 v111, v111
    v_sub_f32 v112, v108, v110
    v_mul_f32 v113, v109, v111
    v_mul_f32 v112, v112, v111
    v_mul_f32 v113, v113, v111
    v_cvt_pk_bf16_f32 v112, v112, v112
    v_lshlrev_b32 v112, 16, v112
    v_cvt_pk_bf16_f32 v113, v113, v113
    v_lshlrev_b32 v113, 16, v113
    v_add_f32 v113, 0x3727c5ac, v113
    v_cvt_pk_bf16_f32 v113, v113, v113
    v_lshlrev_b32 v113, 16, v113
    v_sqrt_f32 v113, v113
    s_nop 0
    v_cvt_pk_bf16_f32 v113, v113, v113
    v_lshlrev_b32 v113, 16, v113
    v_rcp_f32 v113, v113
    v_fma_f32 v112, v110, v111, v112
    v_mul_f32 v114, v111, v113
    v_mul_f32 v115, -v112, v113
    v_mov_b32 v116, v114
    v_mov_b32 v117, v115
    s_nop 1
    v_permlane16_swap_b32 v114, v116
    v_permlane16_swap_b32 v115, v117
    v_pk_fma_f32 v[28:29], v[28:29], v[114:115], v[114:115] op_sel:[0,0,1] op_sel_hi:[1,0,1]
    v_pk_fma_f32 v[30:31], v[30:31], v[114:115], v[114:115] op_sel:[0,0,1] op_sel_hi:[1,0,1]
    v_pk_fma_f32 v[36:37], v[36:37], v[114:115], v[114:115] op_sel:[0,0,1] op_sel_hi:[1,0,1]
    v_pk_fma_f32 v[38:39], v[38:39], v[114:115], v[114:115] op_sel:[0,0,1] op_sel_hi:[1,0,1]
    v_cvt_pk_bf16_f32 v60, v28, v29
    v_cvt_pk_bf16_f32 v61, v30, v31
    v_cvt_pk_bf16_f32 v62, v36, v37
    v_cvt_pk_bf16_f32 v63, v38, v39
    s_nop 1
    v_permlane16_swap_b32 v60, v62
    v_permlane16_swap_b32 v61, v63
    buffer_store_dwordx4 v[60:63], v9, s[56:59], s52 offen offset:0 sc1
    v_pk_fma_f32 v[44:45], v[44:45], v[114:115], v[114:115] op_sel:[0,0,1] op_sel_hi:[1,0,1]
    v_pk_fma_f32 v[46:47], v[46:47], v[114:115], v[114:115] op_sel:[0,0,1] op_sel_hi:[1,0,1]
    v_pk_fma_f32 v[52:53], v[52:53], v[114:115], v[114:115] op_sel:[0,0,1] op_sel_hi:[1,0,1]
    v_pk_fma_f32 v[54:55], v[54:55], v[114:115], v[114:115] op_sel:[0,0,1] op_sel_hi:[1,0,1]
    v_cvt_pk_bf16_f32 v64, v44, v45
    v_cvt_pk_bf16_f32 v65, v46, v47
    v_cvt_pk_bf16_f32 v66, v52, v53
    v_cvt_pk_bf16_f32 v67, v54, v55
    s_nop 1
    v_permlane16_swap_b32 v64, v66
    v_permlane16_swap_b32 v65, v67
    buffer_store_dwordx4 v[64:67], v9, s[56:59], s52 offen offset:64 sc1
    v_pk_fma_f32 v[32:33], v[32:33], v[116:117], v[116:117] op_sel:[0,0,1] op_sel_hi:[1,0,1]
    v_pk_fma_f32 v[34:35], v[34:35], v[116:117], v[116:117] op_sel:[0,0,1] op_sel_hi:[1,0,1]
    v_pk_fma_f32 v[40:41], v[40:41], v[116:117], v[116:117] op_sel:[0,0,1] op_sel_hi:[1,0,1]
    v_pk_fma_f32 v[42:43], v[42:43], v[116:117], v[116:117] op_sel:[0,0,1] op_sel_hi:[1,0,1]
    v_cvt_pk_bf16_f32 v68, v32, v33
    v_cvt_pk_bf16_f32 v69, v34, v35
    v_cvt_pk_bf16_f32 v70, v40, v41
    v_cvt_pk_bf16_f32 v71, v42, v43
    s_nop 1
    v_permlane16_swap_b32 v68, v70
    v_permlane16_swap_b32 v69, v71
    buffer_store_dwordx4 v[68:71], v9, s[56:59], s53 offen offset:0 sc1
    v_pk_fma_f32 v[48:49], v[48:49], v[116:117], v[116:117] op_sel:[0,0,1] op_sel_hi:[1,0,1]
    v_pk_fma_f32 v[50:51], v[50:51], v[116:117], v[116:117] op_sel:[0,0,1] op_sel_hi:[1,0,1]
    v_pk_fma_f32 v[56:57], v[56:57], v[116:117], v[116:117] op_sel:[0,0,1] op_sel_hi:[1,0,1]
    v_pk_fma_f32 v[58:59], v[58:59], v[116:117], v[116:117] op_sel:[0,0,1] op_sel_hi:[1,0,1]
    v_cvt_pk_bf16_f32 v72, v48, v49
    v_cvt_pk_bf16_f32 v73, v50, v51
    v_cvt_pk_bf16_f32 v74, v56, v57
    v_cvt_pk_bf16_f32 v75, v58, v59
    s_nop 1
    v_permlane16_swap_b32 v72, v74
    v_permlane16_swap_b32 v73, v75
    buffer_store_dwordx4 v[72:75], v9, s[56:59], s53 offen offset:64 sc1
    s_endpgm
.section .rodata,"a"
.p2align 6
.amdhsa_kernel g2a_kernel
  .amdhsa_next_free_vgpr 124
  .amdhsa_next_free_sgpr 96
  .amdhsa_accum_offset 124
  .amdhsa_group_segment_fixed_size 0
  .amdhsa_kernarg_size 88
  .amdhsa_user_sgpr_count 2
  .amdhsa_user_sgpr_kernarg_segment_ptr 1
  .amdhsa_system_sgpr_workgroup_id_x 1
.end_amdhsa_kernel
.section .rodata,"a"
.p2align 6
.amdhsa_kernel g2b_kernel
  .amdhsa_next_free_vgpr 124
  .amdhsa_next_free_sgpr 96
  .amdhsa_accum_offset 124
  .amdhsa_group_segment_fixed_size 0
  .amdhsa_kernarg_size 88
  .amdhsa_user_sgpr_count 2
  .amdhsa_user_sgpr_kernarg_segment_ptr 1
  .amdhsa_system_sgpr_workgroup_id_x 1
.end_amdhsa_kernel
.text
.globl g3a_kernel
.p2align 8
.type g3a_kernel,@function
g3a_kernel:
    s_mov_b32 s47, 256
    s_mov_b32 s95, 3
    s_branch g3_body
.text
.globl g3b_kernel
.p2align 8
.type g3b_kernel,@function
g3b_kernel:
    s_mov_b32 s47, 224
    s_mov_b32 s95, 1
    s_branch g3_body
.p2align 6
g3_body:
    s_cmp_ge_u32 s2, 224
    s_cbranch_scc1 g3_spare
    s_load_dwordx2 s[4:5], s[0:1], 80
    s_load_dwordx2 s[30:31], s[0:1], 32
    s_load_dwordx2 s[6:7], s[0:1], 40
    v_lshrrev_b32 v1, 6, v0
    v_and_b32 v2, 63, v0
    s_and_b32 s40, s2, 1
    s_lshl_b32 s40, s40, 2
    s_bfe_u32 s41, s2, 0x20003
    s_add_u32 s25, s40, s41
    s_bfe_u32 s40, s2, 0x20001
    s_mul_i32 s40, s40, 7
    s_lshr_b32 s42, s2, 5
    s_add_u32 s24, s40, s42
    s_add_u32 s27, s41, s42
    s_mov_b32 s26, 0
    v_readfirstlane_b32 s28, v1
    s_nop 0
    s_cmp_lt_u32 s28, 4
    s_cbranch_scc1 g3_compute
    s_sub_u32 s28, s28, 4
    s_mov_b32 s40, 7168
    v_lshrrev_b32 v4, 4, v2
    v_mul_lo_u32 v3, v4, s40
    v_lshlrev_b32 v4, 1, v4
    v_xor_b32 v4, v4, v2
    v_and_b32 v4, 15, v4
    v_lshl_add_u32 v3, v4, 4, v3
    s_mul_i32 s41, s24, 256
    s_mul_i32 s42, s28, 114688
    s_add_u32 s41, s41, s42
    v_xor_b32 v4, 128, v3
    s_add_u32 s42, s41, 0
    v_add_u32 v10, s42, v3
    s_add_u32 s42, s41, 28672
    v_add_u32 v11, s42, v3
    s_add_u32 s42, s41, 57344
    v_add_u32 v12, s42, v4
    s_add_u32 s42, s41, 86016
    v_add_u32 v13, s42, v4
    s_mov_b32 s40, 2048
    v_lshrrev_b32 v4, 4, v2
    v_mul_lo_u32 v3, v4, s40
    v_lshlrev_b32 v4, 1, v4
    v_xor_b32 v4, v4, v2
    v_and_b32 v4, 15, v4
    v_lshl_add_u32 v3, v4, 4, v3
    s_mul_i32 s41, s25, 256
    s_mul_i32 s42, s28, 32768
    s_add_u32 s41, s41, s42
    v_xor_b32 v4, 128, v3
    s_add_u32 s42, s41, 0
    v_add_u32 v14, s42, v3
    s_add_u32 s42, s41, 8192
    v_add_u32 v15, s42, v3
    s_add_u32 s42, s41, 16384
    v_add_u32 v16, s42, v4
    s_add_u32 s42, s41, 24576
    v_add_u32 v17, s42, v4
    s_mul_i32 s36, s28, 4096
    s_mul_i32 s37, s28, 4096
    s_add_u32 s37, s37, 16384
    s_waitcnt lgkmcnt(0)
    s_mov_b32 s8, s30
    s_mov_b32 s9, s31
    s_mov_b32 s10, 0xe00000
    s_mov_b32 s11, 0x20000
    s_add_u32 s12, s4, 0xc00000
    s_addc_u32 s13, s5, 0
    s_mov_b32 s14, 0x400000
    s_mov_b32 s15, 0x20000
    s_mov_b32 s32, 0
    s_mov_b32 s33, 0
g3_ld_loop:
    s_cmp_lt_u32 s32, 3
    s_cbranch_scc1 g3_ld_issue
    s_waitcnt vmcnt(16)
g3_ld_bar:
    s_barrier
g3_ld_issue:
    s_add_u32 s40, s32, s27
    s_and_b32 s40, s40, s95
    s_andn2_b32 s41, s32, s95
    s_or_b32 s40, s40, s41
    s_add_u32 s40, s40, s26
    s_mul_i32 s34, s40, 458752
    s_mul_i32 s35, s40, 131072
    s_add_u32 s38, s33, s36
    s_add_u32 s39, s33, s37
    s_add_u32 m0, s38, 0
    s_nop 0
    buffer_load_dwordx4 v10, s[8:11], s34 offen lds
    s_add_u32 m0, s38, 1024
    s_nop 0
    buffer_load_dwordx4 v11, s[8:11], s34 offen lds
    s_add_u32 m0, s38, 2048
    s_nop 0
    buffer_load_dwordx4 v12, s[8:11], s34 offen lds
    s_add_u32 m0, s38, 3072
    s_nop 0
    buffer_load_dwordx4 v13, s[8:11], s34 offen lds
    s_add_u32 m0, s39, 0
    s_nop 0
    buffer_load_dwordx4 v14, s[12:15], s35 offen lds
    s_add_u32 m0, s39, 1024
    s_nop 0
    buffer_load_dwordx4 v15, s[12:15], s35 offen lds
    s_add_u32 m0, s39, 2048
    s_nop 0
    buffer_load_dwordx4 v16, s[12:15], s35 offen lds
    s_add_u32 m0, s39, 3072
    s_nop 0
    buffer_load_dwordx4 v17, s[12:15], s35 offen lds
    s_add_u32 s33, s33, 32768
    s_cmp_eq_u32 s33, 131072
    s_cselect_b32 s33, 0, s33
    s_add_u32 s32, s32, 1
    s_cmp_lt_u32 s32, 32
    s_cbranch_scc1 g3_ld_loop
    s_waitcnt vmcnt(16)
    s_barrier
    s_waitcnt vmcnt(8)
    s_barrier
    s_waitcnt vmcnt(0)
    s_barrier
g3_done:
    s_endpgm
g3_compute:
    v_lshrrev_b32 v5, 4, v2
    v_bfe_u32 v6, v2, 2, 2
    v_and_b32 v7, 3, v2
    v_and_b32 v8, 15, v2
    s_and_b32 s44, s28, 1
    s_lshr_b32 s45, s28, 1
    s_mul_i32 s40, s25, 128
    s_mul_i32 s41, s45, 64
    s_add_u32 s40, s40, s41
    v_add_u32 v20, s40, v8
    s_mov_b32 s41, 7168
    v_mul_lo_u32 v9, v20, s41
    s_mul_i32 s40, s24, 256
    s_mul_i32 s41, s44, 128
    s_add_u32 s46, s40, s41
    v_and_b32 v3, 1, v5
    v_lshlrev_b32 v3, 5, v3
    v_lshrrev_b32 v4, 1, v5
    v_lshl_add_u32 v3, v4, 4, v3
    v_add3_u32 v9, v9, v3, s46
    s_mov_b32 s52, 0
    s_mov_b32 s53, 114688
    s_mov_b32 s54, 229376
    s_mov_b32 s55, 344064
    s_waitcnt lgkmcnt(0)
    s_mov_b32 s20, s6
    s_mov_b32 s21, s7
    s_mov_b32 s22, 0x1c00
    s_mov_b32 s23, 0x20000
    s_add_u32 s16, s4, 0x1000000
    s_addc_u32 s17, s5, 0
    s_mov_b32 s18, 0x700000
    s_mov_b32 s19, 0x20000
    v_lshl_add_u32 v3, v5, 3, s46
    buffer_load_dwordx2 v[92:93], v3, s[20:23], 0 offen offset:0
    buffer_load_dwordx2 v[94:95], v3, s[20:23], 0 offen offset:32
    buffer_load_dwordx2 v[96:97], v3, s[20:23], 0 offen offset:64
    buffer_load_dwordx2 v[98:99], v3, s[20:23], 0 offen offset:96
    s_mul_i32 s42, s44, 4
    s_mov_b32 s43, 0
    v_and_b32 v3, 1, v5
    v_lshl_or_b32 v3, v3, 2, v6
    s_add_u32 s40, s42, 0
    v_xor_b32 v3, s40, v3
    v_lshlrev_b32 v3, 5, v3
    v_lshl_add_u32 v3, v7, 3, v3
    v_lshl_add_u32 v4, v5, 3, v6
    v_lshl_add_u32 v3, v4, 8, v3
    v_add_u32 v10, s43, v3
    v_and_b32 v3, 1, v5
    v_lshl_or_b32 v3, v3, 2, v6
    s_add_u32 s40, s42, 1
    v_xor_b32 v3, s40, v3
    v_lshlrev_b32 v3, 5, v3
    v_lshl_add_u32 v3, v7, 3, v3
    v_lshl_add_u32 v4, v5, 3, v6
    v_lshl_add_u32 v3, v4, 8, v3
    v_add_u32 v11, s43, v3
    v_and_b32 v3, 1, v5
    v_lshl_or_b32 v3, v3, 2, v6
    s_add_u32 s40, s42, 2
    v_xor_b32 v3, s40, v3
    v_lshlrev_b32 v3, 5, v3
    v_lshl_add_u32 v3, v7, 3, v3
    v_lshl_add_u32 v4, v5, 3, v6
    v_lshl_add_u32 v3, v4, 8, v3
    v_add_u32 v12, s43, v3
    v_and_b32 v3, 1, v5
    v_lshl_or_b32 v3, v3, 2, v6
    s_add_u32 s40, s42, 3
    v_xor_b32 v3, s40, v3
    v_lshlrev_b32 v3, 5, v3
    v_lshl_add_u32 v3, v7, 3, v3
    v_lshl_add_u32 v4, v5, 3, v6
    v_lshl_add_u32 v3, v4, 8, v3
    v_add_u32 v13, s43, v3
    s_mul_i32 s42, s45, 4
    s_mov_b32 s43, 16384
    v_and_b32 v3, 1, v5
    v_lshl_or_b32 v3, v3, 2, v6
    s_add_u32 s40, s42, 0
    v_xor_b32 v3, s40, v3
    v_lshlrev_b32 v3, 5, v3
    v_lshl_add_u32 v3, v7, 3, v3
    v_lshl_add_u32 v4, v5, 3, v6
    v_lshl_add_u32 v3, v4, 8, v3
    v_add_u32 v14, s43, v3
    v_and_b32 v3, 1, v5
    v_lshl_or_b32 v3, v3, 2, v6
    s_add_u32 s40, s42, 1
    v_xor_b32 v3, s40, v3
    v_lshlrev_b32 v3, 5, v3
    v_lshl_add_u32 v3, v7, 3, v3
    v_lshl_add_u32 v4, v5, 3, v6
    v_lshl_add_u32 v3, v4, 8, v3
    v_add_u32 v15, s43, v3
    v_and_b32 v3, 1, v5
    v_lshl_or_b32 v3, v3, 2, v6
    s_add_u32 s40, s42, 2
    v_xor_b32 v3, s40, v3
    v_lshlrev_b32 v3, 5, v3
    v_lshl_add_u32 v3, v7, 3, v3
    v_lshl_add_u32 v4, v5, 3, v6
    v_lshl_add_u32 v3, v4, 8, v3
    v_add_u32 v16, s43, v3
    v_and_b32 v3, 1, v5
    v_lshl_or_b32 v3, v3, 2, v6
    s_add_u32 s40, s42, 3
    v_xor_b32 v3, s40, v3
    v_lshlrev_b32 v3, 5, v3
    v_lshl_add_u32 v3, v7, 3, v3
    v_lshl_add_u32 v4, v5, 3, v6
    v_lshl_add_u32 v3, v4, 8, v3
    v_add_u32 v17, s43, v3
    v_mov_b32 v124, 0
    v_mov_b32 v125, 0
    v_mov_b32 v126, 0
    v_mov_b32 v127, 0
    v_mov_b32 v128, 0
    v_mov_b32 v129, 0
    v_mov_b32 v130, 0
    v_mov_b32 v131, 0
    v_mov_b32 v132, 0
    v_mov_b32 v133, 0
    v_mov_b32 v134, 0
    v_mov_b32 v135, 0
    v_mov_b32 v136, 0
    v_mov_b32 v137, 0
    v_mov_b32 v138, 0
    v_mov_b32 v139, 0
    v_mov_b32 v140, 0
    v_mov_b32 v141, 0
    v_mov_b32 v142, 0
    v_mov_b32 v143, 0
    v_mov_b32 v144, 0
    v_mov_b32 v145, 0
    v_mov_b32 v146, 0
    v_mov_b32 v147, 0
    v_mov_b32 v148, 0
    v_mov_b32 v149, 0
    v_mov_b32 v150, 0
    v_mov_b32 v151, 0
    v_mov_b32 v152, 0
    v_mov_b32 v153, 0
    v_mov_b32 v154, 0
    v_mov_b32 v155, 0
    s_mov_b32 s48, 32
    s_mov_b32 s50, 0
    s_mov_b32 s51, 32768
    s_mov_b32 s29, 0xfffe8000
    s_waitcnt vmcnt(0)
    v_lshlrev_b32 v28, 16, v92
    v_and_b32 v29, 0xffff0000, v92
    v_lshlrev_b32 v30, 16, v93
    v_and_b32 v31, 0xffff0000, v93
    v_lshlrev_b32 v32, 16, v92
    v_and_b32 v33, 0xffff0000, v92
    v_lshlrev_b32 v34, 16, v93
    v_and_b32 v35, 0xffff0000, v93
    v_lshlrev_b32 v36, 16, v92
    v_and_b32 v37, 0xffff0000, v92
    v_lshlrev_b32 v38, 16, v93
    v_and_b32 v39, 0xffff0000, v93
    v_lshlrev_b32 v40, 16, v92
    v_and_b32 v41, 0xffff0000, v92
    v_lshlrev_b32 v42, 16, v93
    v_and_b32 v43, 0xffff0000, v93
    v_lshlrev_b32 v44, 16, v94
    v_and_b32 v45, 0xffff0000, v94
    v_lshlrev_b32 v46, 16, v95
    v_and_b32 v47, 0xffff0000, v95
    v_lshlrev_b32 v48, 16, v94
    v_and_b32 v49, 0xffff0000, v94
    v_lshlrev_b32 v50, 16, v95
    v_and_b32 v51, 0xffff0000, v95
    v_lshlrev_b32 v52, 16, v94
    v_and_b32 v53, 0xffff0000, v94
    v_lshlrev_b32 v54, 16, v95
    v_and_b32 v55, 0xffff0000, v95
    v_lshlrev_b32 v56, 16, v94
    v_and_b32 v57, 0xffff0000, v94
    v_lshlrev_b32 v58, 16, v95
    v_and_b32 v59, 0xffff0000, v95
    v_lshlrev_b32 v60, 16, v96
    v_and_b32 v61, 0xffff0000, v96
    v_lshlrev_b32 v62, 16, v97
    v_and_b32 v63, 0xffff0000, v97
    v_lshlrev_b32 v64, 16, v96
    v_and_b32 v65, 0xffff0000, v96
    v_lshlrev_b32 v66, 16, v97
    v_and_b32 v67, 0xffff0000, v97
    v_lshlrev_b32 v68, 16, v96
    v_and_b32 v69, 0xffff0000, v96
    v_lshlrev_b32 v70, 16, v97
    v_and_b32 v71, 0xffff0000, v97
    v_lshlrev_b32 v72, 16, v96
    v_and_b32 v73, 0xffff0000, v96
    v_lshlrev_b32 v74, 16, v97
    v_and_b32 v75, 0xffff0000, v97
    v_lshlrev_b32 v76, 16, v98
    v_and_b32 v77, 0xffff0000, v98
    v_lshlrev_b32 v78, 16, v99
    v_and_b32 v79, 0xffff0000, v99
    v_lshlrev_b32 v80, 16, v98
    v_and_b32 v81, 0xffff0000, v98
    v_lshlrev_b32 v82, 16, v99
    v_and_b32 v83, 0xffff0000, v99
    v_lshlrev_b32 v84, 16, v98
    v_and_b32 v85, 0xffff0000, v98
    v_lshlrev_b32 v86, 16, v99
    v_and_b32 v87, 0xffff0000, v99
    v_lshlrev_b32 v88, 16, v98
    v_and_b32 v89, 0xffff0000, v98
    v_lshlrev_b32 v90, 16, v99
    v_and_b32 v91, 0xffff0000, v99
.p2align 3
g3_cloop:
    s_barrier
g3_cloop2:
    v_mfma_f32_16x16x32_bf16 v[28:31], v[124:127], v[140:143], v[28:31]
    ds_read_b64_tr_b16 v[92:93], v10 offset:0
    ds_read_b64_tr_b16 v[94:95], v10 offset:1024
    v_mfma_f32_16x16x32_bf16 v[32:35], v[124:127], v[144:147], v[32:35]
    ds_read_b64_tr_b16 v[108:109], v14 offset:0
    ds_read_b64_tr_b16 v[110:111], v14 offset:1024
    v_mfma_f32_16x16x32_bf16 v[36:39], v[124:127], v[148:151], v[36:39]
    ds_read_b64_tr_b16 v[112:113], v15 offset:0
    ds_read_b64_tr_b16 v[114:115], v15 offset:1024
    v_mfma_f32_16x16x32_bf16 v[40:43], v[124:127], v[152:155], v[40:43]
    ds_read_b64_tr_b16 v[116:117], v16 offset:0
    ds_read_b64_tr_b16 v[118:119], v16 offset:1024
    v_mfma_f32_16x16x32_bf16 v[44:47], v[128:131], v[140:143], v[44:47]
    ds_read_b64_tr_b16 v[120:121], v17 offset:0
    ds_read_b64_tr_b16 v[122:123], v17 offset:1024
    v_mfma_f32_16x16x32_bf16 v[48:51], v[128:131], v[144:147], v[48:51]
    ds_read_b64_tr_b16 v[96:97], v11 offset:0
    ds_read_b64_tr_b16 v[98:99], v11 offset:1024
    v_mfma_f32_16x16x32_bf16 v[52:55], v[128:131], v[148:151], v[52:55]
    ds_read_b64_tr_b16 v[100:101], v12 offset:0
    ds_read_b64_tr_b16 v[102:103], v12 offset:1024
    v_mfma_f32_16x16x32_bf16 v[56:59], v[128:131], v[152:155], v[56:59]
    ds_read_b64_tr_b16 v[104:105], v13 offset:0
    ds_read_b64_tr_b16 v[106:107], v13 offset:1024
    v_mfma_f32_16x16x32_bf16 v[60:63], v[132:135], v[140:143], v[60:63]
    v_mfma_f32_16x16x32_bf16 v[64:67], v[132:135], v[144:147], v[64:67]
    v_mfma_f32_16x16x32_bf16 v[68:71], v[132:135], v[148:151], v[68:71]
    v_mfma_f32_16x16x32_bf16 v[72:75], v[132:135], v[152:155], v[72:75]
    v_mfma_f32_16x16x32_bf16 v[76:79], v[136:139], v[140:143], v[76:79]
    v_mfma_f32_16x16x32_bf16 v[80:83], v[136:139], v[144:147], v[80:83]
    v_mfma_f32_16x16x32_bf16 v[84:87], v[136:139], v[148:151], v[84:87]
    v_mfma_f32_16x16x32_bf16 v[88:91], v[136:139], v[152:155], v[88:91]
    s_waitcnt lgkmcnt(0)
    v_mfma_f32_16x16x32_bf16 v[28:31], v[92:95], v[108:111], v[28:31]
    ds_read_b64_tr_b16 v[124:125], v10 offset:8192
    ds_read_b64_tr_b16 v[126:127], v10 offset:9216
    v_mfma_f32_16x16x32_bf16 v[32:35], v[92:95], v[112:115], v[32:35]
    ds_read_b64_tr_b16 v[140:141], v14 offset:8192
    ds_read_b64_tr_b16 v[142:143], v14 offset:9216
    v_mfma_f32_16x16x32_bf16 v[36:39], v[92:95], v[116:119], v[36:39]
    ds_read_b64_tr_b16 v[144:145], v15 offset:8192
    ds_read_b64_tr_b16 v[146:147], v15 offset:9216
    v_mfma_f32_16x16x32_bf16 v[40:43], v[92:95], v[120:123], v[40:43]
    ds_read_b64_tr_b16 v[148:149], v16 offset:8192
    ds_read_b64_tr_b16 v[150:151], v16 offset:9216
    v_mfma_f32_16x16x32_bf16 v[44:47], v[96:99], v[108:111], v[44:47]
    ds_read_b64_tr_b16 v[152:153], v17 offset:8192
    ds_read_b64_tr_b16 v[154:155], v17 offset:9216
    v_mfma_f32_16x16x32_bf16 v[48:51], v[96:99], v[112:115], v[48:51]
    ds_read_b64_tr_b16 v[128:129], v11 offset:8192
    ds_read_b64_tr_b16 v[130:131], v11 offset:9216
    v_mfma_f32_16x16x32_bf16 v[52:55], v[96:99], v[116:119], v[52:55]
    ds_read_b64_tr_b16 v[132:133], v12 offset:8192
    ds_read_b64_tr_b16 v[134:135], v12 offset:9216
    v_mfma_f32_16x16x32_bf16 v[56:59], v[96:99], v[120:123], v[56:59]
    ds_read_b64_tr_b16 v[136:137], v13 offset:8192
    ds_read_b64_tr_b16 v[138:139], v13 offset:9216
    v_mfma_f32_16x16x32_bf16 v[60:63], v[100:103], v[108:111], v[60:63]
    s_add_u32 s50, s50, 1
    s_cmp_eq_u32 s50, 4
    v_mfma_f32_16x16x32_bf16 v[64:67], v[100:103], v[112:115], v[64:67]
    s_cselect_b32 s49, s29, s51
    s_cselect_b32 s50, 0, s50
    v_mfma_f32_16x16x32_bf16 v[68:71], v[100:103], v[116:119], v[68:71]
    v_add_u32 v10, s49, v10
    v_add_u32 v11, s49, v11
    v_mfma_f32_16x16x32_bf16 v[72:75], v[100:103], v[120:123], v[72:75]
    v_add_u32 v12, s49, v12
    v_add_u32 v13, s49, v13
    v_mfma_f32_16x16x32_bf16 v[76:79], v[104:107], v[108:111], v[76:79]
    v_add_u32 v14, s49, v14
    v_add_u32 v15, s49, v15
    v_mfma_f32_16x16x32_bf16 v[80:83], v[104:107], v[112:115], v[80:83]
    v_add_u32 v16, s49, v16
    v_add_u32 v17, s49, v17
    v_mfma_f32_16x16x32_bf16 v[84:87], v[104:107], v[116:119], v[84:87]
    s_sub_u32 s48, s48, 1
    s_cmp_lg_u32 s48, 0
    v_mfma_f32_16x16x32_bf16 v[88:91], v[104:107], v[120:123], v[88:91]
    s_waitcnt lgkmcnt(0)
    s_cbranch_scc1 g3_cloop
    v_mfma_f32_16x16x32_bf16 v[28:31], v[124:127], v[140:143], v[28:31]
    v_mfma_f32_16x16x32_bf16 v[32:35], v[124:127], v[144:147], v[32:35]
    v_mfma_f32_16x16x32_bf16 v[36:39], v[124:127], v[148:151], v[36:39]
    v_mfma_f32_16x16x32_bf16 v[40:43], v[124:127], v[152:155], v[40:43]
    v_mfma_f32_16x16x32_bf16 v[44:47], v[128:131], v[140:143], v[44:47]
    v_mfma_f32_16x16x32_bf16 v[48:51], v[128:131], v[144:147], v[48:51]
    v_mfma_f32_16x16x32_bf16 v[52:55], v[128:131], v[148:151], v[52:55]
    v_mfma_f32_16x16x32_bf16 v[56:59], v[128:131], v[152:155], v[56:59]
    v_mfma_f32_16x16x32_bf16 v[60:63], v[132:135], v[140:143], v[60:63]
    v_mfma_f32_16x16x32_bf16 v[64:67], v[132:135], v[144:147], v[64:67]
    v_mfma_f32_16x16x32_bf16 v[68:71], v[132:135], v[148:151], v[68:71]
    v_mfma_f32_16x16x32_bf16 v[72:75], v[132:135], v[152:155], v[72:75]
    v_mfma_f32_16x16x32_bf16 v[76:79], v[136:139], v[140:143], v[76:79]
    v_mfma_f32_16x16x32_bf16 v[80:83], v[136:139], v[144:147], v[80:83]
    v_mfma_f32_16x16x32_bf16 v[84:87], v[136:139], v[148:151], v[84:87]
    v_mfma_f32_16x16x32_bf16 v[88:91], v[136:139], v[152:155], v[88:91]
    v_mov_b32 v10, 0xbdd2d3e8
    v_mov_b32 v11, 0xbdd2d3e8
    v_mov_b32 v12, 0xc0135761
    v_mov_b32 v13, 0xc0135761
    v_mov_b32 v14, 0x3f800000
    v_mov_b32 v15, 0x3f800000
    s_nop 7
    v_pk_mul_f32 v[108:109], v[28:29], v[28:29]
    v_pk_mul_f32 v[110:111], v[30:31], v[30:31]
    v_pk_mul_f32 v[112:113], v[44:45], v[44:45]
    v_pk_mul_f32 v[114:115], v[46:47], v[46:47]
    v_pk_fma_f32 v[108:109], v[108:109], v[10:11], v[12:13]
    v_pk_fma_f32 v[110:111], v[110:111], v[10:11], v[12:13]
    v_pk_fma_f32 v[112:113], v[112:113], v[10:11], v[12:13]
    v_pk_fma_f32 v[114:115], v[114:115], v[10:11], v[12:13]
    v_pk_mul_f32 v[108:109], v[108:109], v[28:29]
    v_pk_mul_f32 v[110:111], v[110:111], v[30:31]
    v_pk_mul_f32 v[112:113], v[112:113], v[44:45]
    v_pk_mul_f32 v[114:115], v[114:115], v[46:47]
    v_exp_f32 v108, v108
    v_exp_f32 v109, v109
    v_exp_f32 v110, v110
    v_exp_f32 v111, v111
    v_exp_f32 v112, v112
    v_exp_f32 v113, v113
    v_exp_f32 v114, v114
    v_exp_f32 v115, v115
    v_pk_add_f32 v[108:109], v[108:109], v[14:15]
    v_pk_add_f32 v[110:111], v[110:111], v[14:15]
    v_pk_add_f32 v[112:113], v[112:113], v[14:15]
    v_pk_add_f32 v[114:115], v[114:115], v[14:15]
    v_rcp_f32 v108, v108
    v_rcp_f32 v109, v109
    v_rcp_f32 v110, v110
    v_rcp_f32 v111, v111
    v_rcp_f32 v112, v112
    v_rcp_f32 v113, v113
    v_rcp_f32 v114, v114
    v_rcp_f32 v115, v115
    v_pk_mul_f32 v[28:29], v[28:29], v[108:109]
    v_pk_mul_f32 v[30:31], v[30:31], v[110:111]
    v_pk_mul_f32 v[44:45], v[44:45], v[112:113]
    v_pk_mul_f32 v[46:47], v[46:47], v[114:115]
    v_cvt_pk_bf16_f32 v92, v28, v29
    v_cvt_pk_bf16_f32 v93, v30, v31
    v_cvt_pk_bf16_f32 v94, v44, v45
    v_cvt_pk_bf16_f32 v95, v46, v47
    s_nop 1
    v_permlane16_swap_b32 v92, v94
    v_permlane16_swap_b32 v93, v95
    buffer_store_dwordx4 v[92:95], v9, s[16:19], s52 offen offset:0 sc1
    v_pk_mul_f32 v[108:109], v[60:61], v[60:61]
    v_pk_mul_f32 v[110:111], v[62:63], v[62:63]
    v_pk_mul_f32 v[112:113], v[76:77], v[76:77]
    v_pk_mul_f32 v[114:115], v[78:79], v[78:79]
    v_pk_fma_f32 v[108:109], v[108:109], v[10:11], v[12:13]
    v_pk_fma_f32 v[110:111], v[110:111], v[10:11], v[12:13]
    v_pk_fma_f32 v[112:113], v[112:113], v[10:11], v[12:13]
    v_pk_fma_f32 v[114:115], v[114:115], v[10:11], v[12:13]
    v_pk_mul_f32 v[108:109], v[108:109], v[60:61]
    v_pk_mul_f32 v[110:111], v[110:111], v[62:63]
    v_pk_mul_f32 v[112:113], v[112:113], v[76:77]
    v_pk_mul_f32 v[114:115], v[114:115], v[78:79]
    v_exp_f32 v108, v108
    v_exp_f32 v109, v109
    v_exp_f32 v110, v110
    v_exp_f32 v111, v111
    v_exp_f32 v112, v112
    v_exp_f32 v113, v113
    v_exp_f32 v114, v114
    v_exp_f32 v115, v115
    v_pk_add_f32 v[108:109], v[108:109], v[14:15]
    v_pk_add_f32 v[110:111], v[110:111], v[14:15]
    v_pk_add_f32 v[112:113], v[112:113], v[14:15]
    v_pk_add_f32 v[114:115], v[114:115], v[14:15]
    v_rcp_f32 v108, v108
    v_rcp_f32 v109, v109
    v_rcp_f32 v110, v110
    v_rcp_f32 v111, v111
    v_rcp_f32 v112, v112
    v_rcp_f32 v113, v113
    v_rcp_f32 v114, v114
    v_rcp_f32 v115, v115
    v_pk_mul_f32 v[60:61], v[60:61], v[108:109]
    v_pk_mul_f32 v[62:63], v[62:63], v[110:111]
    v_pk_mul_f32 v[76:77], v[76:77], v[112:113]
    v_pk_mul_f32 v[78:79], v[78:79], v[114:115]
    v_cvt_pk_bf16_f32 v96, v60, v61
    v_cvt_pk_bf16_f32 v97, v62, v63
    v_cvt_pk_bf16_f32 v98, v76, v77
    v_cvt_pk_bf16_f32 v99, v78, v79
    s_nop 1
    v_permlane16_swap_b32 v96, v98
    v_permlane16_swap_b32 v97, v99
    buffer_store_dwordx4 v[96:99], v9, s[16:19], s52 offen offset:64 sc1
    v_pk_mul_f32 v[108:109], v[32:33], v[32:33]
    v_pk_mul_f32 v[110:111], v[34:35], v[34:35]
    v_pk_mul_f32 v[112:113], v[48:49], v[48:49]
    v_pk_mul_f32 v[114:115], v[50:51], v[50:51]
    v_pk_fma_f32 v[108:109], v[108:109], v[10:11], v[12:13]
    v_pk_fma_f32 v[110:111], v[110:111], v[10:11], v[12:13]
    v_pk_fma_f32 v[112:113], v[112:113], v[10:11], v[12:13]
    v_pk_fma_f32 v[114:115], v[114:115], v[10:11], v[12:13]
    v_pk_mul_f32 v[108:109], v[108:109], v[32:33]
    v_pk_mul_f32 v[110:111], v[110:111], v[34:35]
    v_pk_mul_f32 v[112:113], v[112:113], v[48:49]
    v_pk_mul_f32 v[114:115], v[114:115], v[50:51]
    v_exp_f32 v108, v108
    v_exp_f32 v109, v109
    v_exp_f32 v110, v110
    v_exp_f32 v111, v111
    v_exp_f32 v112, v112
    v_exp_f32 v113, v113
    v_exp_f32 v114, v114
    v_exp_f32 v115, v115
    v_pk_add_f32 v[108:109], v[108:109], v[14:15]
    v_pk_add_f32 v[110:111], v[110:111], v[14:15]
    v_pk_add_f32 v[112:113], v[112:113], v[14:15]
    v_pk_add_f32 v[114:115], v[114:115], v[14:15]
    v_rcp_f32 v108, v108
    v_rcp_f32 v109, v109
    v_rcp_f32 v110, v110
    v_rcp_f32 v111, v111
    v_rcp_f32 v112, v112
    v_rcp_f32 v113, v113
    v_rcp_f32 v114, v114
    v_rcp_f32 v115, v115
    v_pk_mul_f32 v[32:33], v[32:33], v[108:109]
    v_pk_mul_f32 v[34:35], v[34:35], v[110:111]
    v_pk_mul_f32 v[48:49], v[48:49], v[112:113]
    v_pk_mul_f32 v[50:51], v[50:51], v[114:115]
    v_cvt_pk_bf16_f32 v100, v32, v33
    v_cvt_pk_bf16_f32 v101, v34, v35
    v_cvt_pk_bf16_f32 v102, v48, v49
    v_cvt_pk_bf16_f32 v103, v50, v51
    s_nop 1
    v_permlane16_swap_b32 v100, v102
    v_permlane16_swap_b32 v101, v103
    buffer_store_dwordx4 v[100:103], v9, s[16:19], s53 offen offset:0 sc1
    v_pk_mul_f32 v[108:109], v[64:65], v[64:65]
    v_pk_mul_f32 v[110:111], v[66:67], v[66:67]
    v_pk_mul_f32 v[112:113], v[80:81], v[80:81]
    v_pk_mul_f32 v[114:115], v[82:83], v[82:83]
    v_pk_fma_f32 v[108:109], v[108:109], v[10:11], v[12:13]
    v_pk_fma_f32 v[110:111], v[110:111], v[10:11], v[12:13]
    v_pk_fma_f32 v[112:113], v[112:113], v[10:11], v[12:13]
    v_pk_fma_f32 v[114:115], v[114:115], v[10:11], v[12:13]
    v_pk_mul_f32 v[108:109], v[108:109], v[64:65]
    v_pk_mul_f32 v[110:111], v[110:111], v[66:67]
    v_pk_mul_f32 v[112:113], v[112:113], v[80:81]
    v_pk_mul_f32 v[114:115], v[114:115], v[82:83]
    v_exp_f32 v108, v108
    v_exp_f32 v109, v109
    v_exp_f32 v110, v110
    v_exp_f32 v111, v111
    v_exp_f32 v112, v112
    v_exp_f32 v113, v113
    v_exp_f32 v114, v114
    v_exp_f32 v115, v115
    v_pk_add_f32 v[108:109], v[108:109], v[14:15]
    v_pk_add_f32 v[110:111], v[110:111], v[14:15]
    v_pk_add_f32 v[112:113], v[112:113], v[14:15]
    v_pk_add_f32 v[114:115], v[114:115], v[14:15]
    v_rcp_f32 v108, v108
    v_rcp_f32 v109, v109
    v_rcp_f32 v110, v110
    v_rcp_f32 v111, v111
    v_rcp_f32 v112, v112
    v_rcp_f32 v113, v113
    v_rcp_f32 v114, v114
    v_rcp_f32 v115, v115
    v_pk_mul_f32 v[64:65], v[64:65], v[108:109]
    v_pk_mul_f32 v[66:67], v[66:67], v[110:111]
    v_pk_mul_f32 v[80:81], v[80:81], v[112:113]
    v_pk_mul_f32 v[82:83], v[82:83], v[114:115]
    v_cvt_pk_bf16_f32 v104, v64, v65
    v_cvt_pk_bf16_f32 v105, v66, v67
    v_cvt_pk_bf16_f32 v106, v80, v81
    v_cvt_pk_bf16_f32 v107, v82, v83
    s_nop 1
    v_permlane16_swap_b32 v104, v106
    v_permlane16_swap_b32 v105, v107
    buffer_store_dwordx4 v[104:107], v9, s[16:19], s53 offen offset:64 sc1
    v_pk_mul_f32 v[108:109], v[36:37], v[36:37]
    v_pk_mul_f32 v[110:111], v[38:39], v[38:39]
    v_pk_mul_f32 v[112:113], v[52:53], v[52:53]
    v_pk_mul_f32 v[114:115], v[54:55], v[54:55]
    v_pk_fma_f32 v[108:109], v[108:109], v[10:11], v[12:13]
    v_pk_fma_f32 v[110:111], v[110:111], v[10:11], v[12:13]
    v_pk_fma_f32 v[112:113], v[112:113], v[10:11], v[12:13]
    v_pk_fma_f32 v[114:115], v[114:115], v[10:11], v[12:13]
    v_pk_mul_f32 v[108:109], v[108:109], v[36:37]
    v_pk_mul_f32 v[110:111], v[110:111], v[38:39]
    v_pk_mul_f32 v[112:113], v[112:113], v[52:53]
    v_pk_mul_f32 v[114:115], v[114:115], v[54:55]
    v_exp_f32 v108, v108
    v_exp_f32 v109, v109
    v_exp_f32 v110, v110
    v_exp_f32 v111, v111
    v_exp_f32 v112, v112
    v_exp_f32 v113, v113
    v_exp_f32 v114, v114
    v_exp_f32 v115, v115
    v_pk_add_f32 v[108:109], v[108:109], v[14:15]
    v_pk_add_f32 v[110:111], v[110:111], v[14:15]
    v_pk_add_f32 v[112:113], v[112:113], v[14:15]
    v_pk_add_f32 v[114:115], v[114:115], v[14:15]
    v_rcp_f32 v108, v108
    v_rcp_f32 v109, v109
    v_rcp_f32 v110, v110
    v_rcp_f32 v111, v111
    v_rcp_f32 v112, v112
    v_rcp_f32 v113, v113
    v_rcp_f32 v114, v114
    v_rcp_f32 v115, v115
    v_pk_mul_f32 v[36:37], v[36:37], v[108:109]
    v_pk_mul_f32 v[38:39], v[38:39], v[110:111]
    v_pk_mul_f32 v[52:53], v[52:53], v[112:113]
    v_pk_mul_f32 v[54:55], v[54:55], v[114:115]
    v_cvt_pk_bf16_f32 v92, v36, v37
    v_cvt_pk_bf16_f32 v93, v38, v39
    v_cvt_pk_bf16_f32 v94, v52, v53
    v_cvt_pk_bf16_f32 v95, v54, v55
    s_nop 1
    v_permlane16_swap_b32 v92, v94
    v_permlane16_swap_b32 v93, v95
    buffer_store_dwordx4 v[92:95], v9, s[16:19], s54 offen offset:0 sc1
    v_pk_mul_f32 v[108:109], v[68:69], v[68:69]
    v_pk_mul_f32 v[110:111], v[70:71], v[70:71]
    v_pk_mul_f32 v[112:113], v[84:85], v[84:85]
    v_pk_mul_f32 v[114:115], v[86:87], v[86:87]
    v_pk_fma_f32 v[108:109], v[108:109], v[10:11], v[12:13]
    v_pk_fma_f32 v[110:111], v[110:111], v[10:11], v[12:13]
    v_pk_fma_f32 v[112:113], v[112:113], v[10:11], v[12:13]
    v_pk_fma_f32 v[114:115], v[114:115], v[10:11], v[12:13]
    v_pk_mul_f32 v[108:109], v[108:109], v[68:69]
    v_pk_mul_f32 v[110:111], v[110:111], v[70:71]
    v_pk_mul_f32 v[112:113], v[112:113], v[84:85]
    v_pk_mul_f32 v[114:115], v[114:115], v[86:87]
    v_exp_f32 v108, v108
    v_exp_f32 v109, v109
    v_exp_f32 v110, v110
    v_exp_f32 v111, v111
    v_exp_f32 v112, v112
    v_exp_f32 v113, v113
    v_exp_f32 v114, v114
    v_exp_f32 v115, v115
    v_pk_add_f32 v[108:109], v[108:109], v[14:15]
    v_pk_add_f32 v[110:111], v[110:111], v[14:15]
    v_pk_add_f32 v[112:113], v[112:113], v[14:15]
    v_pk_add_f32 v[114:115], v[114:115], v[14:15]
    v_rcp_f32 v108, v108
    v_rcp_f32 v109, v109
    v_rcp_f32 v110, v110
    v_rcp_f32 v111, v111
    v_rcp_f32 v112, v112
    v_rcp_f32 v113, v113
    v_rcp_f32 v114, v114
    v_rcp_f32 v115, v115
    v_pk_mul_f32 v[68:69], v[68:69], v[108:109]
    v_pk_mul_f32 v[70:71], v[70:71], v[110:111]
    v_pk_mul_f32 v[84:85], v[84:85], v[112:113]
    v_pk_mul_f32 v[86:87], v[86:87], v[114:115]
    v_cvt_pk_bf16_f32 v96, v68, v69
    v_cvt_pk_bf16_f32 v97, v70, v71
    v_cvt_pk_bf16_f32 v98, v84, v85
    v_cvt_pk_bf16_f32 v99, v86, v87
    s_nop 1
    v_permlane16_swap_b32 v96, v98
    v_permlane16_swap_b32 v97, v99
    buffer_store_dwordx4 v[96:99], v9, s[16:19], s54 offen offset:64 sc1
    v_pk_mul_f32 v[108:109], v[40:41], v[40:41]
    v_pk_mul_f32 v[110:111], v[42:43], v[42:43]
    v_pk_mul_f32 v[112:113], v[56:57], v[56:57]
    v_pk_mul_f32 v[114:115], v[58:59], v[58:59]
    v_pk_fma_f32 v[108:109], v[108:109], v[10:11], v[12:13]
    v_pk_fma_f32 v[110:111], v[110:111], v[10:11], v[12:13]
    v_pk_fma_f32 v[112:113], v[112:113], v[10:11], v[12:13]
    v_pk_fma_f32 v[114:115], v[114:115], v[10:11], v[12:13]
    v_pk_mul_f32 v[108:109], v[108:109], v[40:41]
    v_pk_mul_f32 v[110:111], v[110:111], v[42:43]
    v_pk_mul_f32 v[112:113], v[112:113], v[56:57]
    v_pk_mul_f32 v[114:115], v[114:115], v[58:59]
    v_exp_f32 v108, v108
    v_exp_f32 v109, v109
    v_exp_f32 v110, v110
    v_exp_f32 v111, v111
    v_exp_f32 v112, v112
    v_exp_f32 v113, v113
    v_exp_f32 v114, v114
    v_exp_f32 v115, v115
    v_pk_add_f32 v[108:109], v[108:109], v[14:15]
    v_pk_add_f32 v[110:111], v[110:111], v[14:15]
    v_pk_add_f32 v[112:113], v[112:113], v[14:15]
    v_pk_add_f32 v[114:115], v[114:115], v[14:15]
    v_rcp_f32 v108, v108
    v_rcp_f32 v109, v109
    v_rcp_f32 v110, v110
    v_rcp_f32 v111, v111
    v_rcp_f32 v112, v112
    v_rcp_f32 v113, v113
    v_rcp_f32 v114, v114
    v_rcp_f32 v115, v115
    v_pk_mul_f32 v[40:41], v[40:41], v[108:109]
    v_pk_mul_f32 v[42:43], v[42:43], v[110:111]
    v_pk_mul_f32 v[56:57], v[56:57], v[112:113]
    v_pk_mul_f32 v[58:59], v[58:59], v[114:115]
    v_cvt_pk_bf16_f32 v100, v40, v41
    v_cvt_pk_bf16_f32 v101, v42, v43
    v_cvt_pk_bf16_f32 v102, v56, v57
    v_cvt_pk_bf16_f32 v103, v58, v59
    s_nop 1
    v_permlane16_swap_b32 v100, v102
    v_permlane16_swap_b32 v101, v103
    buffer_store_dwordx4 v[100:103], v9, s[16:19], s55 offen offset:0 sc1
    v_pk_mul_f32 v[108:109], v[72:73], v[72:73]
    v_pk_mul_f32 v[110:111], v[74:75], v[74:75]
    v_pk_mul_f32 v[112:113], v[88:89], v[88:89]
    v_pk_mul_f32 v[114:115], v[90:91], v[90:91]
    v_pk_fma_f32 v[108:109], v[108:109], v[10:11], v[12:13]
    v_pk_fma_f32 v[110:111], v[110:111], v[10:11], v[12:13]
    v_pk_fma_f32 v[112:113], v[112:113], v[10:11], v[12:13]
    v_pk_fma_f32 v[114:115], v[114:115], v[10:11], v[12:13]
    v_pk_mul_f32 v[108:109], v[108:109], v[72:73]
    v_pk_mul_f32 v[110:111], v[110:111], v[74:75]
    v_pk_mul_f32 v[112:113], v[112:113], v[88:89]
    v_pk_mul_f32 v[114:115], v[114:115], v[90:91]
    v_exp_f32 v108, v108
    v_exp_f32 v109, v109
    v_exp_f32 v110, v110
    v_exp_f32 v111, v111
    v_exp_f32 v112, v112
    v_exp_f32 v113, v113
    v_exp_f32 v114, v114
    v_exp_f32 v115, v115
    v_pk_add_f32 v[108:109], v[108:109], v[14:15]
    v_pk_add_f32 v[110:111], v[110:111], v[14:15]
    v_pk_add_f32 v[112:113], v[112:113], v[14:15]
    v_pk_add_f32 v[114:115], v[114:115], v[14:15]
    v_rcp_f32 v108, v108
    v_rcp_f32 v109, v109
    v_rcp_f32 v110, v110
    v_rcp_f32 v111, v111
    v_rcp_f32 v112, v112
    v_rcp_f32 v113, v113
    v_rcp_f32 v114, v114
    v_rcp_f32 v115, v115
    v_pk_mul_f32 v[72:73], v[72:73], v[108:109]
    v_pk_mul_f32 v[74:75], v[74:75], v[110:111]
    v_pk_mul_f32 v[88:89], v[88:89], v[112:113]
    v_pk_mul_f32 v[90:91], v[90:91], v[114:115]
    v_cvt_pk_bf16_f32 v104, v72, v73
    v_cvt_pk_bf16_f32 v105, v74, v75
    v_cvt_pk_bf16_f32 v106, v88, v89
    v_cvt_pk_bf16_f32 v107, v90, v91
    s_nop 1
    v_permlane16_swap_b32 v104, v106
    v_permlane16_swap_b32 v105, v107
    buffer_store_dwordx4 v[104:107], v9, s[16:19], s55 offen offset:64 sc1
    s_endpgm
g3_spare:
    s_cmp_ge_u32 s2, 256
    s_cbranch_scc1 g3_done
    s_load_dwordx2 s[4:5], s[0:1], 48
    s_load_dwordx2 s[6:7], s[0:1], 80
    s_sub_u32 s3, s2, 224
    v_lshlrev_b32 v1, 4, v0
    v_mov_b32 v8, -1
    v_mov_b32 v9, -1
    v_mov_b32 v10, -1
    v_mov_b32 v11, -1
    s_lshl_b32 s13, s3, 17
    s_mov_b32 s12, 2
    s_waitcnt lgkmcnt(0)
    s_add_u32 s8, s6, 0x1c00000
    s_addc_u32 s9, s7, 0
    s_mov_b32 s10, 0x400000
    s_mov_b32 s11, 0x20000
g3_clear_loop:
    buffer_store_dwordx4 v[8:11], v1, s[8:11], s13 offen sc1
    s_add_u32 s13, s13, 8192
    buffer_store_dwordx4 v[8:11], v1, s[8:11], s13 offen sc1
    s_add_u32 s13, s13, 8192
    buffer_store_dwordx4 v[8:11], v1, s[8:11], s13 offen sc1
    s_add_u32 s13, s13, 8192
    buffer_store_dwordx4 v[8:11], v1, s[8:11], s13 offen sc1
    s_add_u32 s13, s13, 8192
    buffer_store_dwordx4 v[8:11], v1, s[8:11], s13 offen sc1
    s_add_u32 s13, s13, 8192
    buffer_store_dwordx4 v[8:11], v1, s[8:11], s13 offen sc1
    s_add_u32 s13, s13, 8192
    buffer_store_dwordx4 v[8:11], v1, s[8:11], s13 offen sc1
    s_add_u32 s13, s13, 8192
    buffer_store_dwordx4 v[8:11], v1, s[8:11], s13 offen sc1
    s_add_u32 s13, s13, 8192
    s_waitcnt vmcnt(8)
    s_sub_u32 s12, s12, 1
    s_cmp_lg_u32 s12, 0
    s_cbranch_scc1 g3_clear_loop
    s_cmp_ge_u32 s2, s47
    s_cbranch_scc1 g3_done
    s_cmp_ge_u32 s3, 16
    s_cselect_b32 s12, 3145728, 0
    s_lshl_b32 s3, s3, 18
    s_add_u32 s3, s3, s12
    s_mov_b32 s12, 4
    s_mov_b32 s8, s4
    s_mov_b32 s9, s5
    s_mov_b32 s10, 0xe00000
    s_mov_b32 s11, 0x20000
g3_spare_loop:
    buffer_load_dwordx4 v[4:7], v1, s[8:11], s3 offen
    s_add_u32 s3, s3, 8192
    buffer_load_dwordx4 v[4:7], v1, s[8:11], s3 offen
    s_add_u32 s3, s3, 8192
    buffer_load_dwordx4 v[4:7], v1, s[8:11], s3 offen
    s_add_u32 s3, s3, 8192
    buffer_load_dwordx4 v[4:7], v1, s[8:11], s3 offen
    s_add_u32 s3, s3, 8192
    buffer_load_dwordx4 v[4:7], v1, s[8:11], s3 offen
    s_add_u32 s3, s3, 8192
    buffer_load_dwordx4 v[4:7], v1, s[8:11], s3 offen
    s_add_u32 s3, s3, 8192
    buffer_load_dwordx4 v[4:7], v1, s[8:11], s3 offen
    s_add_u32 s3, s3, 8192
    buffer_load_dwordx4 v[4:7], v1, s[8:11], s3 offen
    s_add_u32 s3, s3, 8192
    s_waitcnt vmcnt(8)
    s_sub_u32 s12, s12, 1
    s_cmp_lg_u32 s12, 0
    s_cbranch_scc1 g3_spare_loop
    s_endpgm
.section .rodata,"a"
.p2align 6
.amdhsa_kernel g3a_kernel
  .amdhsa_next_free_vgpr 156
  .amdhsa_next_free_sgpr 96
  .amdhsa_accum_offset 156
  .amdhsa_group_segment_fixed_size 0
  .amdhsa_kernarg_size 88
  .amdhsa_user_sgpr_count 2
  .amdhsa_user_sgpr_kernarg_segment_ptr 1
  .amdhsa_system_sgpr_workgroup_id_x 1
.end_amdhsa_kernel
.section .rodata,"a"
.p2align 6
.amdhsa_kernel g3b_kernel
  .amdhsa_next_free_vgpr 156
  .amdhsa_next_free_sgpr 96
  .amdhsa_accum_offset 156
  .amdhsa_group_segment_fixed_size 0
  .amdhsa_kernarg_size 88
  .amdhsa_user_sgpr_count 2
  .amdhsa_user_sgpr_kernarg_segment_ptr 1
  .amdhsa_system_sgpr_workgroup_id_x 1
.end_amdhsa_kernel
.text
.globl g4a_kernel
.p2align 8
.type g4a_kernel,@function
g4a_kernel:
    s_load_dwordx2 s[6:7], s[0:1], 80
    s_mov_b32 s47, 0x1800000
    s_mov_b32 s95, 3
    s_branch g4_body
.text
.globl g4b_kernel
.p2align 8
.type g4b_kernel,@function
g4b_kernel:
    s_load_dwordx2 s[6:7], s[0:1], 64
    s_mov_b32 s47, 0
    s_mov_b32 s95, 1
    s_branch g4_body
.p2align 6
g4_body:
    s_cmp_ge_u32 s2, 256
    s_cbranch_scc1 g4_done
    s_load_dwordx2 s[4:5], s[0:1], 80
    s_load_dwordx2 s[30:31], s[0:1], 48
    s_load_dwordx2 s[34:35], s[0:1], 56
    v_lshrrev_b32 v1, 6, v0
    v_and_b32 v2, 63, v0
    s_bfe_u32 s40, s2, 0x10001
    s_lshl_b32 s40, s40, 2
    s_bfe_u32 s41, s2, 0x20003
    s_add_u32 s24, s40, s41
    s_bfe_u32 s40, s2, 0x10002
    s_lshl_b32 s40, s40, 3
    s_lshr_b32 s42, s2, 5
    s_add_u32 s25, s40, s42
    s_and_b32 s91, s2, 1
    s_add_u32 s27, s41, s42
    s_lshl_b32 s92, s24, 4
    s_add_u32 s92, s92, s25
    s_mul_i32 s26, s91, 28
    v_readfirstlane_b32 s28, v1
    s_nop 0
    s_cmp_lt_u32 s28, 4
    s_cbranch_scc1 g4_compute
    s_sub_u32 s28, s28, 4
    s_mov_b32 s40, 7168
    v_lshrrev_b32 v3, 3, v2
    v_mul_lo_u32 v3, v3, s40
    v_lshrrev_b32 v4, 4, v2
    v_xor_b32 v4, v4, v2
    v_and_b32 v4, 7, v4
    v_lshl_add_u32 v3, v4, 4, v3
    s_mul_i32 s41, s24, 917504
    s_mul_i32 s42, s28, 229376
    s_add_u32 s41, s41, s42
    v_xor_b32 v4, 64, v3
    s_add_u32 s42, s41, 0
    v_add_u32 v10, s42, v3
    s_add_u32 s42, s41, 57344
    v_add_u32 v11, s42, v4
    s_add_u32 s42, s41, 114688
    v_add_u32 v12, s42, v3
    s_add_u32 s42, s41, 172032
    v_add_u32 v13, s42, v4
    s_mov_b32 s40, 4096
    v_lshrrev_b32 v4, 4, v2
    v_mul_lo_u32 v3, v4, s40
    v_lshlrev_b32 v4, 1, v4
    v_xor_b32 v4, v4, v2
    v_and_b32 v4, 15, v4
    v_lshl_add_u32 v3, v4, 4, v3
    s_mul_i32 s41, s25, 256
    s_mul_i32 s42, s28, 65536
    s_add_u32 s41, s41, s42
    v_xor_b32 v4, 128, v3
    s_add_u32 s42, s41, 0
    v_add_u32 v14, s42, v3
    s_add_u32 s42, s41, 16384
    v_add_u32 v15, s42, v3
    s_add_u32 s42, s41, 32768
    v_add_u32 v16, s42, v4
    s_add_u32 s42, s41, 49152
    v_add_u32 v17, s42, v4
    s_mul_i32 s36, s28, 4096
    s_mul_i32 s37, s28, 4096
    s_add_u32 s37, s37, 16384
    s_waitcnt lgkmcnt(0)
    s_add_u32 s8, s4, 0x1000000
    s_addc_u32 s9, s5, 0
    s_mov_b32 s10, 0x700000
    s_mov_b32 s11, 0x20000
    s_mov_b32 s12, s30
    s_mov_b32 s13, s31
    s_mov_b32 s14, 0xe00000
    s_mov_b32 s15, 0x20000
    s_mov_b32 s32, 0
    s_mov_b32 s33, 0
g4_ld_loop:
    s_cmp_lt_u32 s32, 3
    s_cbranch_scc1 g4_ld_issue
    s_waitcnt vmcnt(16)
g4_ld_bar:
    s_barrier
g4_ld_issue:
    s_add_u32 s40, s32, s27
    s_and_b32 s40, s40, s95
    s_andn2_b32 s41, s32, s95
    s_or_b32 s40, s40, s41
    s_add_u32 s40, s40, s26
    s_mul_i32 s34, s40, 128
    s_mul_i32 s35, s40, 262144
    s_add_u32 s38, s33, s36
    s_add_u32 s39, s33, s37
    s_add_u32 m0, s38, 0
    s_nop 0
    buffer_load_dwordx4 v10, s[8:11], s34 offen lds
    s_add_u32 m0, s38, 1024
    s_nop 0
    buffer_load_dwordx4 v11, s[8:11], s34 offen lds
    s_add_u32 m0, s38, 2048
    s_nop 0
    buffer_load_dwordx4 v12, s[8:11], s34 offen lds
    s_add_u32 m0, s38, 3072
    s_nop 0
    buffer_load_dwordx4 v13, s[8:11], s34 offen lds
    s_add_u32 m0, s39, 0
    s_nop 0
    buffer_load_dwordx4 v14, s[12:15], s35 offen lds
    s_add_u32 m0, s39, 1024
    s_nop 0
    buffer_load_dwordx4 v15, s[12:15], s35 offen lds
    s_add_u32 m0, s39, 2048
    s_nop 0
    buffer_load_dwordx4 v16, s[12:15], s35 offen lds
    s_add_u32 m0, s39, 3072
    s_nop 0
    buffer_load_dwordx4 v17, s[12:15], s35 offen lds
    s_add_u32 s33, s33, 32768
    s_cmp_eq_u32 s33, 131072
    s_cselect_b32 s33, 0, s33
    s_add_u32 s32, s32, 1
    s_cmp_lt_u32 s32, 28
    s_cbranch_scc1 g4_ld_loop
    s_waitcnt vmcnt(16)
    s_barrier
    s_waitcnt vmcnt(8)
    s_barrier
    s_waitcnt vmcnt(0)
    s_barrier
g4_done:
    s_endpgm
g4_compute:
    v_lshrrev_b32 v5, 4, v2
    v_bfe_u32 v6, v2, 2, 2
    v_and_b32 v7, 3, v2
    v_and_b32 v8, 15, v2
    s_and_b32 s44, s28, 1
    s_lshr_b32 s45, s28, 1
    s_mul_i32 s40, s25, 128
    s_mul_i32 s41, s45, 64
    s_add_u32 s40, s40, s41
    s_lshl_b32 s41, s91, 5
    s_add_u32 s40, s40, s41
    v_add_u32 v20, s40, v8
    s_mov_b32 s41, 2048
    v_mul_lo_u32 v9, v20, s41
    s_mul_i32 s40, s24, 256
    s_mul_i32 s41, s44, 128
    s_add_u32 s46, s40, s41
    v_and_b32 v3, 1, v5
    v_lshlrev_b32 v3, 5, v3
    v_lshrrev_b32 v4, 1, v5
    v_lshl_add_u32 v3, v4, 4, v3
    v_add3_u32 v9, v9, v3, s46
    s_mov_b32 s52, 0
    s_mov_b32 s53, 32768
    s_mov_b32 s54, 65536
    s_mov_b32 s55, 98304
    s_waitcnt lgkmcnt(0)
    s_add_u32 s20, s4, 0x800000
    s_addc_u32 s21, s5, 0
    s_mov_b32 s22, 0x400000
    s_mov_b32 s23, 0x20000
    s_mov_b32 s56, s34
    s_mov_b32 s57, s35
    s_mov_b32 s58, 0x1000
    s_mov_b32 s59, 0x20000
    s_add_u32 s16, s6, s47
    s_addc_u32 s17, s7, 0
    s_mov_b32 s18, 0x400000
    s_mov_b32 s19, 0x20000
    s_mov_b32 s60, s4
    s_mov_b32 s61, s5
    s_mov_b32 s62, 0x40000
    s_mov_b32 s63, 0x20000
    s_add_u32 s84, s4, 0x1c00000
    s_addc_u32 s85, s5, 0
    s_mov_b32 s86, 0x400000
    s_mov_b32 s87, 0x20000
    buffer_load_dwordx4 v[92:95], v9, s[20:23], s52 offen offset:0
    buffer_load_dwordx4 v[96:99], v9, s[20:23], s52 offen offset:64
    buffer_load_dwordx4 v[100:103], v9, s[20:23], s53 offen offset:0
    buffer_load_dwordx4 v[104:107], v9, s[20:23], s53 offen offset:64
    v_lshlrev_b32 v3, 1, v20
    buffer_load_ushort v22, v3, s[56:59], 0 offen offset:0
    buffer_load_ushort v23, v3, s[56:59], 0 offen offset:32
    s_mul_i32 s42, s44, 64
    v_lshrrev_b32 v3, 1, v8
    v_xor_b32 v3, v3, v5
    v_lshlrev_b32 v3, 4, v3
    v_lshl_add_u32 v3, v8, 7, v3
    s_lshl_b32 s40, s42, 7
    s_add_u32 s40, s40, 0
    v_add_u32 v10, s40, v3
    v_xor_b32 v11, 64, v10
    s_lshl_b32 s90, s91, 1
    s_mul_i32 s42, s45, 4
    s_mov_b32 s43, 16384
    v_and_b32 v3, 1, v5
    v_lshl_or_b32 v3, v3, 2, v6
    s_add_u32 s40, s42, 0
    s_xor_b32 s40, s40, s90
    v_xor_b32 v3, s40, v3
    v_lshlrev_b32 v3, 5, v3
    v_lshl_add_u32 v3, v7, 3, v3
    v_lshl_add_u32 v4, v5, 3, v6
    v_lshl_add_u32 v3, v4, 8, v3
    v_add_u32 v12, s43, v3
    v_and_b32 v3, 1, v5
    v_lshl_or_b32 v3, v3, 2, v6
    s_add_u32 s40, s42, 1
    s_xor_b32 s40, s40, s90
    v_xor_b32 v3, s40, v3
    v_lshlrev_b32 v3, 5, v3
    v_lshl_add_u32 v3, v7, 3, v3
    v_lshl_add_u32 v4, v5, 3, v6
    v_lshl_add_u32 v3, v4, 8, v3
    v_add_u32 v13, s43, v3
    v_and_b32 v3, 1, v5
    v_lshl_or_b32 v3, v3, 2, v6
    s_add_u32 s40, s42, 2
    s_xor_b32 s40, s40, s90
    v_xor_b32 v3, s40, v3
    v_lshlrev_b32 v3, 5, v3
    v_lshl_add_u32 v3, v7, 3, v3
    v_lshl_add_u32 v4, v5, 3, v6
    v_lshl_add_u32 v3, v4, 8, v3
    v_add_u32 v14, s43, v3
    v_and_b32 v3, 1, v5
    v_lshl_or_b32 v3, v3, 2, v6
    s_add_u32 s40, s42, 3
    s_xor_b32 s40, s40, s90
    v_xor_b32 v3, s40, v3
    v_lshlrev_b32 v3, 5, v3
    v_lshl_add_u32 v3, v7, 3, v3
    v_lshl_add_u32 v4, v5, 3, v6
    v_lshl_add_u32 v3, v4, 8, v3
    v_add_u32 v15, s43, v3
    v_mov_b32 v124, 0
    v_mov_b32 v125, 0
    v_mov_b32 v126, 0
    v_mov_b32 v127, 0
    v_mov_b32 v128, 0
    v_mov_b32 v129, 0
    v_mov_b32 v130, 0
    v_mov_b32 v131, 0
    v_mov_b32 v132, 0
    v_mov_b32 v133, 0
    v_mov_b32 v134, 0
    v_mov_b32 v135, 0
    v_mov_b32 v136, 0
    v_mov_b32 v137, 0
    v_mov_b32 v138, 0
    v_mov_b32 v139, 0
    v_mov_b32 v140, 0
    v_mov_b32 v141, 0
    v_mov_b32 v142, 0
    v_mov_b32 v143, 0
    v_mov_b32 v144, 0
    v_mov_b32 v145, 0
    v_mov_b32 v146, 0
    v_mov_b32 v147, 0
    v_mov_b32 v148, 0
    v_mov_b32 v149, 0
    v_mov_b32 v150, 0
    v_mov_b32 v151, 0
    v_mov_b32 v152, 0
    v_mov_b32 v153, 0
    v_mov_b32 v154, 0
    v_mov_b32 v155, 0
    s_mov_b32 s48, 28
    s_mov_b32 s50, 0
    s_mov_b32 s51, 32768
    s_mov_b32 s29, 0xfffe8000
    v_mov_b32 v36, 0
    v_mov_b32 v37, 0
    v_mov_b32 v38, 0
    v_mov_b32 v39, 0
    v_mov_b32 v40, 0
    v_mov_b32 v41, 0
    v_mov_b32 v42, 0
    v_mov_b32 v43, 0
    v_mov_b32 v52, 0
    v_mov_b32 v53, 0
    v_mov_b32 v54, 0
    v_mov_b32 v55, 0
    v_mov_b32 v56, 0
    v_mov_b32 v57, 0
    v_mov_b32 v58, 0
    v_mov_b32 v59, 0
    v_mov_b32 v68, 0
    v_mov_b32 v69, 0
    v_mov_b32 v70, 0
    v_mov_b32 v71, 0
    v_mov_b32 v72, 0
    v_mov_b32 v73, 0
    v_mov_b32 v74, 0
    v_mov_b32 v75, 0
    v_mov_b32 v84, 0
    v_mov_b32 v85, 0
    v_mov_b32 v86, 0
    v_mov_b32 v87, 0
    v_mov_b32 v88, 0
    v_mov_b32 v89, 0
    v_mov_b32 v90, 0
    v_mov_b32 v91, 0
    s_lshl_b32 s40, s28, 12
    v_lshl_add_u32 v21, v2, 4, s40
    s_lshl_b32 s93, s92, 1
    s_add_u32 s93, s93, s91
    s_lshl_b32 s93, s93, 14
    s_xor_b32 s94, s93, 0x4000
    s_waitcnt vmcnt(0)
    v_permlane16_swap_b32 v92, v94
    v_permlane16_swap_b32 v93, v95
    v_permlane16_swap_b32 v96, v98
    v_permlane16_swap_b32 v97, v99
    v_permlane16_swap_b32 v100, v102
    v_permlane16_swap_b32 v101, v103
    v_permlane16_swap_b32 v104, v106
    v_permlane16_swap_b32 v105, v107
    v_lshlrev_b32 v22, 16, v22
    v_lshlrev_b32 v23, 16, v23
    v_lshlrev_b32 v28, 16, v92
    v_and_b32 v29, 0xffff0000, v92
    v_lshlrev_b32 v30, 16, v93
    v_and_b32 v31, 0xffff0000, v93
    v_add_f32 v28, v28, v22
    v_add_f32 v29, v29, v22
    v_add_f32 v30, v30, v22
    v_add_f32 v31, v31, v22
    v_lshlrev_b32 v44, 16, v94
    v_and_b32 v45, 0xffff0000, v94
    v_lshlrev_b32 v46, 16, v95
    v_and_b32 v47, 0xffff0000, v95
    v_add_f32 v44, v44, v22
    v_add_f32 v45, v45, v22
    v_add_f32 v46, v46, v22
    v_add_f32 v47, v47, v22
    v_lshlrev_b32 v60, 16, v96
    v_and_b32 v61, 0xffff0000, v96
    v_lshlrev_b32 v62, 16, v97
    v_and_b32 v63, 0xffff0000, v97
    v_add_f32 v60, v60, v22
    v_add_f32 v61, v61, v22
    v_add_f32 v62, v62, v22
    v_add_f32 v63, v63, v22
    v_lshlrev_b32 v76, 16, v98
    v_and_b32 v77, 0xffff0000, v98
    v_lshlrev_b32 v78, 16, v99
    v_and_b32 v79, 0xffff0000, v99
    v_add_f32 v76, v76, v22
    v_add_f32 v77, v77, v22
    v_add_f32 v78, v78, v22
    v_add_f32 v79, v79, v22
    v_lshlrev_b32 v32, 16, v100
    v_and_b32 v33, 0xffff0000, v100
    v_lshlrev_b32 v34, 16, v101
    v_and_b32 v35, 0xffff0000, v101
    v_add_f32 v32, v32, v23
    v_add_f32 v33, v33, v23
    v_add_f32 v34, v34, v23
    v_add_f32 v35, v35, v23
    v_lshlrev_b32 v48, 16, v102
    v_and_b32 v49, 0xffff0000, v102
    v_lshlrev_b32 v50, 16, v103
    v_and_b32 v51, 0xffff0000, v103
    v_add_f32 v48, v48, v23
    v_add_f32 v49, v49, v23
    v_add_f32 v50, v50, v23
    v_add_f32 v51, v51, v23
    v_lshlrev_b32 v64, 16, v104
    v_and_b32 v65, 0xffff0000, v104
    v_lshlrev_b32 v66, 16, v105
    v_and_b32 v67, 0xffff0000, v105
    v_add_f32 v64, v64, v23
    v_add_f32 v65, v65, v23
    v_add_f32 v66, v66, v23
    v_add_f32 v67, v67, v23
    v_lshlrev_b32 v80, 16, v106
    v_and_b32 v81, 0xffff0000, v106
    v_lshlrev_b32 v82, 16, v107
    v_and_b32 v83, 0xffff0000, v107
    v_add_f32 v80, v80, v23
    v_add_f32 v81, v81, v23
    v_add_f32 v82, v82, v23
    v_add_f32 v83, v83, v23
.p2align 3
g4_cloop:
    s_barrier
g4_cloop2:
    v_mfma_f32_16x16x32_bf16 v[28:31], v[124:127], v[140:143], v[28:31]
    ds_read_b128 v[92:95], v10 offset:0
    v_mfma_f32_16x16x32_bf16 v[32:35], v[124:127], v[144:147], v[32:35]
    ds_read_b64_tr_b16 v[108:109], v12 offset:0
    ds_read_b64_tr_b16 v[110:111], v12 offset:1024
    v_mfma_f32_16x16x32_bf16 v[36:39], v[124:127], v[148:151], v[36:39]
    ds_read_b64_tr_b16 v[112:113], v13 offset:0
    ds_read_b64_tr_b16 v[114:115], v13 offset:1024
    v_mfma_f32_16x16x32_bf16 v[40:43], v[124:127], v[152:155], v[40:43]
    ds_read_b64_tr_b16 v[116:117], v14 offset:0
    ds_read_b64_tr_b16 v[118:119], v14 offset:1024
    v_mfma_f32_16x16x32_bf16 v[44:47], v[128:131], v[140:143], v[44:47]
    ds_read_b64_tr_b16 v[120:121], v15 offset:0
    ds_read_b64_tr_b16 v[122:123], v15 offset:1024
    v_mfma_f32_16x16x32_bf16 v[48:51], v[128:131], v[144:147], v[48:51]
    ds_read_b128 v[96:99], v10 offset:2048
    v_mfma_f32_16x16x32_bf16 v[52:55], v[128:131], v[148:151], v[52:55]
    ds_read_b128 v[100:103], v10 offset:4096
    v_mfma_f32_16x16x32_bf16 v[56:59], v[128:131], v[152:155], v[56:59]
    ds_read_b128 v[104:107], v10 offset:6144
    v_mfma_f32_16x16x32_bf16 v[60:63], v[132:135], v[140:143], v[60:63]
    v_mfma_f32_16x16x32_bf16 v[64:67], v[132:135], v[144:147], v[64:67]
    v_mfma_f32_16x16x32_bf16 v[68:71], v[132:135], v[148:151], v[68:71]
    v_mfma_f32_16x16x32_bf16 v[72:75], v[132:135], v[152:155], v[72:75]
    v_mfma_f32_16x16x32_bf16 v[76:79], v[136:139], v[140:143], v[76:79]
    v_mfma_f32_16x16x32_bf16 v[80:83], v[136:139], v[144:147], v[80:83]
    v_mfma_f32_16x16x32_bf16 v[84:87], v[136:139], v[148:151], v[84:87]
    v_mfma_f32_16x16x32_bf16 v[88:91], v[136:139], v[152:155], v[88:91]
    s_waitcnt lgkmcnt(0)
    v_mfma_f32_16x16x32_bf16 v[28:31], v[92:95], v[108:111], v[28:31]
    ds_read_b128 v[124:127], v11 offset:0
    v_mfma_f32_16x16x32_bf16 v[32:35], v[92:95], v[112:115], v[32:35]
    ds_read_b64_tr_b16 v[140:141], v12 offset:8192
    ds_read_b64_tr_b16 v[142:143], v12 offset:9216
    v_mfma_f32_16x16x32_bf16 v[36:39], v[92:95], v[116:119], v[36:39]
    ds_read_b64_tr_b16 v[144:145], v13 offset:8192
    ds_read_b64_tr_b16 v[146:147], v13 offset:9216
    v_mfma_f32_16x16x32_bf16 v[40:43], v[92:95], v[120:123], v[40:43]
    ds_read_b64_tr_b16 v[148:149], v14 offset:8192
    ds_read_b64_tr_b16 v[150:151], v14 offset:9216
    v_mfma_f32_16x16x32_bf16 v[44:47], v[96:99], v[108:111], v[44:47]
    ds_read_b64_tr_b16 v[152:153], v15 offset:8192
    ds_read_b64_tr_b16 v[154:155], v15 offset:9216
    v_mfma_f32_16x16x32_bf16 v[48:51], v[96:99], v[112:115], v[48:51]
    ds_read_b128 v[128:131], v11 offset:2048
    v_mfma_f32_16x16x32_bf16 v[52:55], v[96:99], v[116:119], v[52:55]
    ds_read_b128 v[132:135], v11 offset:4096
    v_mfma_f32_16x16x32_bf16 v[56:59], v[96:99], v[120:123], v[56:59]
    ds_read_b128 v[136:139], v11 offset:6144
    v_mfma_f32_16x16x32_bf16 v[60:63], v[100:103], v[108:111], v[60:63]
    s_add_u32 s50, s50, 1
    s_cmp_eq_u32 s50, 4
    v_mfma_f32_16x16x32_bf16 v[64:67], v[100:103], v[112:115], v[64:67]
    s_cselect_b32 s49, s29, s51
    s_cselect_b32 s50, 0, s50
    v_mfma_f32_16x16x32_bf16 v[68:71], v[100:103], v[116:119], v[68:71]
    v_add_u32 v10, s49, v10
    v_add_u32 v11, s49, v11
    v_mfma_f32_16x16x32_bf16 v[72:75], v[100:103], v[120:123], v[72:75]
    v_add_u32 v12, s49, v12
    v_add_u32 v13, s49, v13
    v_mfma_f32_16x16x32_bf16 v[76:79], v[104:107], v[108:111], v[76:79]
    v_add_u32 v14, s49, v14
    v_add_u32 v15, s49, v15
    v_mfma_f32_16x16x32_bf16 v[80:83], v[104:107], v[112:115], v[80:83]
    s_sub_u32 s48, s48, 1
    s_cmp_lg_u32 s48, 0
    v_mfma_f32_16x16x32_bf16 v[84:87], v[104:107], v[116:119], v[84:87]
    v_mfma_f32_16x16x32_bf16 v[88:91], v[104:107], v[120:123], v[88:91]
    s_waitcnt lgkmcnt(0)
    s_cbranch_scc1 g4_cloop
    v_mfma_f32_16x16x32_bf16 v[28:31], v[124:127], v[140:143], v[28:31]
    v_mfma_f32_16x16x32_bf16 v[32:35], v[124:127], v[144:147], v[32:35]
    v_mfma_f32_16x16x32_bf16 v[36:39], v[124:127], v[148:151], v[36:39]
    v_mfma_f32_16x16x32_bf16 v[40:43], v[124:127], v[152:155], v[40:43]
    v_mfma_f32_16x16x32_bf16 v[44:47], v[128:131], v[140:143], v[44:47]
    v_mfma_f32_16x16x32_bf16 v[48:51], v[128:131], v[144:147], v[48:51]
    v_mfma_f32_16x16x32_bf16 v[52:55], v[128:131], v[148:151], v[52:55]
    v_mfma_f32_16x16x32_bf16 v[56:59], v[128:131], v[152:155], v[56:59]
    v_mfma_f32_16x16x32_bf16 v[60:63], v[132:135], v[140:143], v[60:63]
    v_mfma_f32_16x16x32_bf16 v[64:67], v[132:135], v[144:147], v[64:67]
    v_mfma_f32_16x16x32_bf16 v[68:71], v[132:135], v[148:151], v[68:71]
    v_mfma_f32_16x16x32_bf16 v[72:75], v[132:135], v[152:155], v[72:75]
    v_mfma_f32_16x16x32_bf16 v[76:79], v[136:139], v[140:143], v[76:79]
    v_mfma_f32_16x16x32_bf16 v[80:83], v[136:139], v[144:147], v[80:83]
    v_mfma_f32_16x16x32_bf16 v[84:87], v[136:139], v[148:151], v[84:87]
    v_mfma_f32_16x16x32_bf16 v[88:91], v[136:139], v[152:155], v[88:91]
    v_cvt_pk_bf16_f32 v156, v36, v37
    v_cvt_pk_bf16_f32 v157, v38, v39
    v_cvt_pk_bf16_f32 v158, v52, v53
    v_cvt_pk_bf16_f32 v159, v54, v55
    buffer_store_dwordx4 v[156:159], v21, s[84:87], s93 offen offset:0 sc1
    v_cvt_pk_bf16_f32 v160, v68, v69
    v_cvt_pk_bf16_f32 v161, v70, v71
    v_cvt_pk_bf16_f32 v162, v84, v85
    v_cvt_pk_bf16_f32 v163, v86, v87
    buffer_store_dwordx4 v[160:163], v21, s[84:87], s93 offen offset:1024 sc1
    v_cvt_pk_bf16_f32 v164, v40, v41
    v_cvt_pk_bf16_f32 v165, v42, v43
    v_cvt_pk_bf16_f32 v166, v56, v57
    v_cvt_pk_bf16_f32 v167, v58, v59
    buffer_store_dwordx4 v[164:167], v21, s[84:87], s93 offen offset:2048 sc1
    v_cvt_pk_bf16_f32 v168, v72, v73
    v_cvt_pk_bf16_f32 v169, v74, v75
    s_nop 3
    v_cvt_pk_bf16_f32 v170, v88, v89
    v_cvt_pk_bf16_f32 v171, v90, v91
    buffer_store_dwordx4 v[168:171], v21, s[84:87], s93 offen offset:3072 sc1
    s_mov_b32 s48, 0x2000
    buffer_load_dwordx4 v[172:175], v21, s[84:87], s94 offen offset:0 sc1
    buffer_load_dwordx4 v[176:179], v21, s[84:87], s94 offen offset:1024 sc1
    buffer_load_dwordx4 v[180:183], v21, s[84:87], s94 offen offset:2048 sc1
    buffer_load_dwordx4 v[184:187], v21, s[84:87], s94 offen offset:3072 sc1
    s_waitcnt vmcnt(0)
g4_rcv:
    v_max3_u32 v4, v172, v173, v174
    v_max3_u32 v4, v4, v175, v176
    v_max3_u32 v4, v4, v177, v178
    v_max3_u32 v4, v4, v179, v180
    v_max3_u32 v4, v4, v181, v182
    v_max3_u32 v4, v4, v183, v184
    v_max3_u32 v4, v4, v185, v186
    v_max_u32 v4, v4, v187
    v_cmp_eq_u32 vcc, -1, v4
    s_sub_u32 s48, s48, 1
    s_cmp_eq_u32 s48, 0
    s_cbranch_scc1 g4_rcvd
    s_cbranch_vccz g4_rcvd
    s_sleep 2
    buffer_load_dwordx4 v[172:175], v21, s[84:87], s94 offen offset:0 sc1
    buffer_load_dwordx4 v[176:179], v21, s[84:87], s94 offen offset:1024 sc1
    buffer_load_dwordx4 v[180:183], v21, s[84:87], s94 offen offset:2048 sc1
    buffer_load_dwordx4 v[184:187], v21, s[84:87], s94 offen offset:3072 sc1
    s_waitcnt vmcnt(0)
    s_branch g4_rcv
g4_rcvd:
    v_lshlrev_b32 v108, 16, v172
    v_and_b32 v109, 0xffff0000, v172
    v_lshlrev_b32 v110, 16, v173
    v_and_b32 v111, 0xffff0000, v173
    v_pk_add_f32 v[28:29], v[28:29], v[108:109]
    v_pk_add_f32 v[30:31], v[30:31], v[110:111]
    v_lshlrev_b32 v112, 16, v174
    v_and_b32 v113, 0xffff0000, v174
    v_lshlrev_b32 v114, 16, v175
    v_and_b32 v115, 0xffff0000, v175
    v_pk_add_f32 v[44:45], v[44:45], v[112:113]
    v_pk_add_f32 v[46:47], v[46:47], v[114:115]
    v_lshlrev_b32 v116, 16, v176
    v_and_b32 v117, 0xffff0000, v176
    v_lshlrev_b32 v118, 16, v177
    v_and_b32 v119, 0xffff0000, v177
    v_pk_add_f32 v[60:61], v[60:61], v[116:117]
    v_pk_add_f32 v[62:63], v[62:63], v[118:119]
    v_lshlrev_b32 v120, 16, v178
    v_and_b32 v121, 0xffff0000, v178
    v_lshlrev_b32 v122, 16, v179
    v_and_b32 v123, 0xffff0000, v179
    v_pk_add_f32 v[76:77], v[76:77], v[120:121]
    v_pk_add_f32 v[78:79], v[78:79], v[122:123]
    v_lshlrev_b32 v108, 16, v180
    v_and_b32 v109, 0xffff0000, v180
    v_lshlrev_b32 v110, 16, v181
    v_and_b32 v111, 0xffff0000, v181
    v_pk_add_f32 v[32:33], v[32:33], v[108:109]
    v_pk_add_f32 v[34:35], v[34:35], v[110:111]
    v_lshlrev_b32 v112, 16, v182
    v_and_b32 v113, 0xffff0000, v182
    v_lshlrev_b32 v114, 16, v183
    v_and_b32 v115, 0xffff0000, v183
    v_pk_add_f32 v[48:49], v[48:49], v[112:113]
    v_pk_add_f32 v[50:51], v[50:51], v[114:115]
    v_lshlrev_b32 v116, 16, v184
    v_and_b32 v117, 0xffff0000, v184
    v_lshlrev_b32 v118, 16, v185
    v_and_b32 v119, 0xffff0000, v185
    v_pk_add_f32 v[64:65], v[64:65], v[116:117]
    v_pk_add_f32 v[66:67], v[66:67], v[118:119]
    v_lshlrev_b32 v120, 16, v186
    v_and_b32 v121, 0xffff0000, v186
    v_lshlrev_b32 v122, 16, v187
    v_and_b32 v123, 0xffff0000, v187
    v_pk_add_f32 v[80:81], v[80:81], v[120:121]
    v_pk_add_f32 v[82:83], v[82:83], v[122:123]
    s_nop 7
    v_cvt_pk_bf16_f32 v92, v28, v29
    v_cvt_pk_bf16_f32 v93, v30, v31
    v_cvt_pk_bf16_f32 v94, v44, v45
    v_cvt_pk_bf16_f32 v95, v46, v47
    s_nop 1
    v_permlane16_swap_b32 v92, v94
    v_permlane16_swap_b32 v93, v95
    buffer_store_dwordx4 v[92:95], v9, s[16:19], s52 offen offset:0 sc1
    v_cvt_pk_bf16_f32 v96, v60, v61
    v_cvt_pk_bf16_f32 v97, v62, v63
    v_cvt_pk_bf16_f32 v98, v76, v77
    v_cvt_pk_bf16_f32 v99, v78, v79
    s_nop 1
    v_permlane16_swap_b32 v96, v98
    v_permlane16_swap_b32 v97, v99
    buffer_store_dwordx4 v[96:99], v9, s[16:19], s52 offen offset:64 sc1
    v_cvt_pk_bf16_f32 v100, v32, v33
    v_cvt_pk_bf16_f32 v101, v34, v35
    v_cvt_pk_bf16_f32 v102, v48, v49
    v_cvt_pk_bf16_f32 v103, v50, v51
    s_nop 1
    v_permlane16_swap_b32 v100, v102
    v_permlane16_swap_b32 v101, v103
    buffer_store_dwordx4 v[100:103], v9, s[16:19], s53 offen offset:0 sc1
    v_cvt_pk_bf16_f32 v104, v64, v65
    v_cvt_pk_bf16_f32 v105, v66, v67
    v_cvt_pk_bf16_f32 v106, v80, v81
    v_cvt_pk_bf16_f32 v107, v82, v83
    s_nop 1
    v_permlane16_swap_b32 v104, v106
    v_permlane16_swap_b32 v105, v107
    buffer_store_dwordx4 v[104:107], v9, s[16:19], s53 offen offset:64 sc1
    v_pk_add_f32 v[108:109], v[28:29], v[30:31]
    v_pk_mul_f32 v[110:111], v[28:29], v[28:29]
    v_pk_fma_f32 v[110:111], v[30:31], v[30:31], v[110:111]
    v_pk_add_f32 v[108:109], v[108:109], v[44:45]
    v_pk_fma_f32 v[110:111], v[44:45], v[44:45], v[110:111]
    v_pk_add_f32 v[108:109], v[108:109], v[46:47]
    v_pk_fma_f32 v[110:111], v[46:47], v[46:47], v[110:111]
    v_pk_add_f32 v[108:109], v[108:109], v[60:61]
    v_pk_fma_f32 v[110:111], v[60:61], v[60:61], v[110:111]
    v_pk_add_f32 v[108:109], v[108:109], v[62:63]
    v_pk_fma_f32 v[110:111], v[62:63], v[62:63], v[110:111]
    v_pk_add_f32 v[108:109], v[108:109], v[76:77]
    v_pk_fma_f32 v[110:111], v[76:77], v[76:77], v[110:111]
    v_pk_add_f32 v[108:109], v[108:109], v[78:79]
    v_pk_fma_f32 v[110:111], v[78:79], v[78:79], v[110:111]
    v_pk_add_f32 v[112:113], v[32:33], v[34:35]
    v_pk_mul_f32 v[114:115], v[32:33], v[32:33]
    v_pk_fma_f32 v[114:115], v[34:35], v[34:35], v[114:115]
    v_pk_add_f32 v[112:113], v[112:113], v[48:49]
    v_pk_fma_f32 v[114:115], v[48:49], v[48:49], v[114:115]
    v_pk_add_f32 v[112:113], v[112:113], v[50:51]
    v_pk_fma_f32 v[114:115], v[50:51], v[50:51], v[114:115]
    v_pk_add_f32 v[112:113], v[112:113], v[64:65]
    v_pk_fma_f32 v[114:115], v[64:65], v[64:65], v[114:115]
    v_pk_add_f32 v[112:113], v[112:113], v[66:67]
    v_pk_fma_f32 v[114:115], v[66:67], v[66:67], v[114:115]
    v_pk_add_f32 v[112:113], v[112:113], v[80:81]
    v_pk_fma_f32 v[114:115], v[80:81], v[80:81], v[114:115]
    v_pk_add_f32 v[112:113], v[112:113], v[82:83]
    v_pk_fma_f32 v[114:115], v[82:83], v[82:83], v[114:115]
    v_add_f32 v108, v108, v109
    v_add_f32 v109, v110, v111
    v_add_f32 v112, v112, v113
    v_add_f32 v113, v114, v115
    s_nop 1
    v_permlane16_swap_b32 v108, v112
    v_permlane16_swap_b32 v109, v113
    v_pk_add_f32 v[108:109], v[108:109], v[112:113]
    v_mov_b32 v116, v108
    v_mov_b32 v117, v109
    v_and_b32 v3, 16, v2
    v_add_u32 v3, v3, v20
    v_permlane32_swap_b32 v108, v116
    v_permlane32_swap_b32 v109, v117
    v_pk_add_f32 v[108:109], v[108:109], v[116:117]
    v_lshlrev_b32 v3, 3, v3
    s_mul_i32 s40, s24, 2
    s_add_u32 s40, s40, s44
    s_lshl_b32 s40, s40, 14
    s_mov_b32 exec_hi, 0
    buffer_store_dwordx2 v[108:109], v3, s[60:63], s40 offen sc1
    s_mov_b32 exec_hi, -1
    s_endpgm
.section .rodata,"a"
.p2align 6
.amdhsa_kernel g4a_kernel
  .amdhsa_next_free_vgpr 188
  .amdhsa_next_free_sgpr 96
  .amdhsa_accum_offset 188
  .amdhsa_group_segment_fixed_size 0
  .amdhsa_kernarg_size 88
  .amdhsa_user_sgpr_count 2
  .amdhsa_user_sgpr_kernarg_segment_ptr 1
  .amdhsa_system_sgpr_workgroup_id_x 1
.end_amdhsa_kernel
.section .rodata,"a"
.p2align 6
.amdhsa_kernel g4b_kernel
  .amdhsa_next_free_vgpr 188
  .amdhsa_next_free_sgpr 96
  .amdhsa_accum_offset 188
  .amdhsa_group_segment_fixed_size 0
  .amdhsa_kernarg_size 88
  .amdhsa_user_sgpr_count 2
  .amdhsa_user_sgpr_kernarg_segment_ptr 1
  .amdhsa_system_sgpr_workgroup_id_x 1
.end_amdhsa_kernel
```

```asm
; @launch kernel=g1a_kernel grid=(256,1,1) block=(512,1,1) lds=131072
; @launch kernel=g2a_kernel grid=(256,1,1) block=(512,1,1) lds=98304
; @launch kernel=g3a_kernel grid=(256,1,1) block=(512,1,1) lds=131072
; @launch kernel=g4a_kernel grid=(256,1,1) block=(512,1,1) lds=131072
; @launch kernel=g1b_kernel grid=(256,1,1) block=(512,1,1) lds=131072
; @launch kernel=g2b_kernel grid=(256,1,1) block=(512,1,1) lds=98304
; @launch kernel=g3b_kernel grid=(256,1,1) block=(512,1,1) lds=131072
; @launch kernel=g4b_kernel grid=(256,1,1) block=(512,1,1) lds=131072
.amdgcn_target "amdgcn-amd-amdhsa--gfx950"
.text
.globl g1a_kernel
.p2align 8
.type g1a_kernel,@function
g1a_kernel:
    s_load_dwordx2 s[6:7], s[0:1], 0
    s_mov_b32 s47, 0
    s_mov_b32 s53, 1
    s_branch g1_body
.text
.globl g1b_kernel
.p2align 8
.type g1b_kernel,@function
g1b_kernel:
    s_load_dwordx2 s[6:7], s[0:1], 80
    s_mov_b32 s47, 0x1900000
    s_mov_b32 s53, 0
    s_branch g1_body
.p2align 6
g1_body:
    s_cmp_ge_u32 s2, 256
    s_cbranch_scc1 g1_done
    s_load_dwordx2 s[4:5], s[0:1], 80
    s_load_dwordx2 s[30:31], s[0:1], 8
    s_load_dwordx2 s[16:17], s[0:1], 72
    s_load_dwordx2 s[18:19], s[0:1], 16
    v_lshrrev_b32 v1, 6, v0
    v_and_b32 v2, 63, v0
    s_and_b32 s40, s2, 1
    s_lshl_b32 s40, s40, 3
    s_bfe_u32 s41, s2, 0x30003
    s_add_u32 s25, s40, s41
    s_bfe_u32 s40, s2, 0x20001
    s_lshl_b32 s40, s40, 2
    s_lshr_b32 s42, s2, 6
    s_add_u32 s24, s40, s42
    s_add_u32 s27, s41, s42
    s_add_u32 s52, s24, s25
    s_and_b32 s52, s52, 15
    s_and_b32 s26, s52, 12
    s_mul_i32 s26, s26, s53
    v_readfirstlane_b32 s28, v1
    v_lshrrev_b32 v5, 4, v2
    v_bfe_u32 v6, v2, 2, 2
    v_and_b32 v7, 3, v2
    v_and_b32 v8, 15, v2
    s_cmp_lt_u32 s28, 4
    s_cbranch_scc1 g1_compute
    s_sub_u32 s28, s28, 4
    s_mov_b32 s40, 2048
    v_lshrrev_b32 v3, 3, v2
    v_mul_lo_u32 v3, v3, s40
    v_lshrrev_b32 v4, 4, v2
    v_xor_b32 v4, v4, v2
    v_and_b32 v4, 7, v4
    v_lshl_add_u32 v3, v4, 4, v3
    s_mul_i32 s41, s25, 262144
    s_mul_i32 s42, s28, 65536
    s_add_u32 s41, s41, s42
    v_xor_b32 v4, 64, v3
    s_add_u32 s42, s41, 0
    v_add_u32 v16, s42, v3
    s_add_u32 s42, s41, 16384
    v_add_u32 v17, s42, v4
    s_add_u32 s42, s41, 32768
    v_add_u32 v18, s42, v3
    s_add_u32 s42, s41, 49152
    v_add_u32 v19, s42, v4
    s_mov_b32 s40, 6144
    v_lshrrev_b32 v3, 3, v2
    v_mul_lo_u32 v3, v3, s40
    v_bfe_u32 v4, v2, 4, 1
    v_lshlrev_b32 v4, 1, v4
    v_xor_b32 v4, v4, v2
    v_and_b32 v4, 7, v4
    v_lshl_add_u32 v3, v4, 4, v3
    s_mul_i32 s41, s24, 128
    s_mul_i32 s42, s28, 98304
    s_add_u32 s41, s41, s42
    v_xor_b32 v4, 64, v3
    s_add_u32 s42, s41, 0
    v_add_u32 v10, s42, v3
    s_add_u32 s42, s41, 49152
    v_add_u32 v11, s42, v4
    s_mov_b32 s40, 6144
    v_lshrrev_b32 v3, 3, v2
    v_mul_lo_u32 v3, v3, s40
    v_bfe_u32 v4, v2, 4, 1
    v_lshlrev_b32 v4, 1, v4
    v_xor_b32 v4, v4, v2
    v_and_b32 v4, 7, v4
    v_lshl_add_u32 v3, v4, 4, v3
    s_mul_i32 s41, s24, 128
    s_mul_i32 s42, s28, 98304
    s_add_u32 s41, s41, s42
    v_xor_b32 v4, 64, v3
    s_add_u32 s42, s41, 2048
    v_add_u32 v12, s42, v3
    s_add_u32 s42, s41, 51200
    v_add_u32 v13, s42, v4
    s_mov_b32 s40, 6144
    v_lshrrev_b32 v3, 3, v2
    v_mul_lo_u32 v3, v3, s40
    v_bfe_u32 v4, v2, 4, 1
    v_lshlrev_b32 v4, 1, v4
    v_xor_b32 v4, v4, v2
    v_and_b32 v4, 7, v4
    v_lshl_add_u32 v3, v4, 4, v3
    s_mul_i32 s41, s24, 128
    s_mul_i32 s42, s28, 98304
    s_add_u32 s41, s41, s42
    v_xor_b32 v4, 64, v3
    s_add_u32 s42, s41, 4096
    v_add_u32 v14, s42, v3
    s_add_u32 s42, s41, 53248
    v_add_u32 v15, s42, v4
    v_lshrrev_b32 v3, 3, v2
    s_lshl_b32 s40, s28, 2
    v_add_u32 v3, s40, v3
    v_lshrrev_b32 v4, 1, v3
    v_xor_b32 v4, v4, v2
    v_and_b32 v4, 7, v4
    s_lshl_b32 s40, s25, 7
    s_sub_u32 s40, s40, 16
    v_add_u32 v3, s40, v3
    v_max_i32 v3, 0, v3
    v_lshlrev_b32 v3, 11, v3
    v_lshl_add_u32 v20, v4, 4, v3
    s_mul_i32 s36, s28, 2048
    s_mul_i32 s37, s28, 4096
    s_add_u32 s37, s37, 26624
    s_mul_i32 s46, s28, 512
    s_add_u32 s46, s46, 24576
    s_waitcnt lgkmcnt(0)
    s_mov_b32 s8, s30
    s_mov_b32 s9, s31
    s_mov_b32 s10, 0x600000
    s_mov_b32 s11, 0x20000
    s_add_u32 s12, s6, s47
    s_addc_u32 s13, s7, 0
    s_mov_b32 s14, 0x400000
    s_mov_b32 s15, 0x20000
    s_mov_b32 s20, s4
    s_mov_b32 s21, s5
    s_mov_b32 s22, 0x40000
    s_mov_b32 s23, 0x20000
    s_add_u32 s56, s4, 0x100000
    s_addc_u32 s57, s5, 0
    s_mov_b32 s58, 0x30000
    s_mov_b32 s59, 0x20000
    s_mov_b32 s60, s16
    s_mov_b32 s61, s17
    s_mov_b32 s62, 0x100
    s_mov_b32 s63, 0x20000
    s_sub_u32 s40, s52, s27
    s_and_b32 s40, s40, 1
    s_and_b32 s41, s52, 2
    s_or_b32 s40, s40, s41
    s_add_u32 s54, s40, 2
    s_cmp_eq_u32 s53, 0
    s_cselect_b32 s54, 0x7fff, s54
    s_add_u32 s55, s54, 3
    s_cmp_lg_u32 s28, 0
    s_cselect_b32 s55, 0x7fff, s55
    s_cmp_lt_u32 s55, 0x7fff
    s_cselect_b32 s29, 13, 0x7fff
    s_mov_b32 s32, 0
    s_mov_b32 s33, 0
g1_ld_loop:
    s_cmp_lt_u32 s32, 2
    s_cbranch_scc1 g1_ld_issue
    s_sub_u32 s40, s32, s54
    s_sub_u32 s40, s40, 1
    s_cmp_lt_u32 s40, 2
    s_cbranch_scc1 g1_ld_w0
    s_sub_u32 s40, s32, s55
    s_sub_u32 s40, s40, 1
    s_cmp_lt_u32 s40, 2
    s_cbranch_scc1 g1_ld_w1
    s_sub_u32 s40, s32, s29
    s_sub_u32 s40, s40, 1
    s_cmp_lt_u32 s40, 2
    s_cbranch_scc1 g1_ld_w2
    s_waitcnt vmcnt(11)
g1_ld_bar:
    s_barrier
g1_ld_issue:
    s_add_u32 s40, s32, s27
    s_and_b32 s40, s40, 1
    s_andn2_b32 s41, s32, 1
    s_or_b32 s40, s40, s41
    s_add_u32 s40, s40, s26
    s_and_b32 s40, s40, 15
    s_mul_i32 s34, s40, 393216
    s_mul_i32 s35, s40, 128
    s_add_u32 s38, s33, s36
    s_add_u32 s39, s33, s37
    s_add_u32 m0, s39, 0
    s_nop 0
    buffer_load_dwordx4 v16, s[12:15], s35 offen lds
    s_add_u32 m0, s39, 1024
    s_nop 0
    buffer_load_dwordx4 v17, s[12:15], s35 offen lds
    s_add_u32 m0, s39, 2048
    s_nop 0
    buffer_load_dwordx4 v18, s[12:15], s35 offen lds
    s_add_u32 m0, s39, 3072
    s_nop 0
    buffer_load_dwordx4 v19, s[12:15], s35 offen lds
    s_add_u32 m0, s38, 0
    s_nop 0
    buffer_load_dwordx4 v10, s[8:11], s34 offen lds
    s_add_u32 m0, s38, 1024
    s_nop 0
    buffer_load_dwordx4 v11, s[8:11], s34 offen lds
    s_add_u32 m0, s38, 8192
    s_nop 0
    buffer_load_dwordx4 v12, s[8:11], s34 offen lds
    s_add_u32 m0, s38, 9216
    s_nop 0
    buffer_load_dwordx4 v13, s[8:11], s34 offen lds
    s_add_u32 m0, s38, 16384
    s_nop 0
    buffer_load_dwordx4 v14, s[8:11], s34 offen lds
    s_add_u32 m0, s38, 17408
    s_nop 0
    buffer_load_dwordx4 v15, s[8:11], s34 offen lds
    s_add_u32 m0, s33, s46
    s_mov_b32 exec_hi, 0
    buffer_load_dwordx4 v20, s[12:15], s35 offen lds
    s_mov_b32 exec_hi, -1
    s_cmp_eq_u32 s32, s54
    s_cbranch_scc1 g1_ld_h0
g1_ld_c0:
    s_cmp_eq_u32 s32, s55
    s_cbranch_scc1 g1_ld_h1
g1_ld_c1:
    s_cmp_eq_u32 s32, s29
    s_cbranch_scc1 g1_ld_h2
g1_ld_c2:
    s_add_u32 s33, s33, 43008
    s_cmp_eq_u32 s33, 129024
    s_cselect_b32 s33, 0, s33
    s_add_u32 s32, s32, 1
    s_cmp_lt_u32 s32, 16
    s_cbranch_scc1 g1_ld_loop
    s_cmp_eq_u32 s29, 0x7fff
    s_cbranch_scc1 g1_polled
    s_mov_b32 s41, 0x20000
    v_mov_b32 v21, 0
    s_waitcnt vmcnt(22)
g1_poll:
    v_readfirstlane_b32 s40, v23
    s_sub_u32 s41, s41, 1
    s_cmp_eq_u32 s41, 0
    s_cbranch_scc1 g1_polled
    s_cmp_ge_u32 s40, 256
    s_cbranch_scc1 g1_polled
    s_sleep 8
    buffer_load_dword v23, v21, s[60:63], 0 offen sc1
    s_waitcnt vmcnt(0)
    s_branch g1_poll
g1_polled:
    s_waitcnt vmcnt(11)
    s_barrier
    s_lshl_b32 s40, s28, 6
    v_add_u32 v21, s40, v2
    s_lshl_b32 s41, s25, 7
    s_sub_u32 s41, s41, 16
    v_add_u32 v3, s41, v21
    v_max_i32 v3, 0, v3
    v_min_u32 v3, 2047, v3
    v_lshlrev_b32 v3, 3, v3
    s_min_u32 s40, s28, 2
    s_lshl_b32 s40, s40, 12
    s_lshl_b32 s41, s24, 8
    s_add_u32 s40, s40, s41
    v_lshl_add_u32 v4, v2, 2, s40
    s_mov_b32 s40, 0
    buffer_load_dwordx2 v[24:25], v3, s[20:23], s40 offen sc1
    s_mov_b32 s41, 0
    buffer_load_dword v56, v4, s[56:59], s41 offen sc1
    s_mov_b32 s40, 16384
    buffer_load_dwordx2 v[26:27], v3, s[20:23], s40 offen sc1
    s_mov_b32 s41, 12288
    buffer_load_dword v57, v4, s[56:59], s41 offen sc1
    s_mov_b32 s40, 32768
    buffer_load_dwordx2 v[28:29], v3, s[20:23], s40 offen sc1
    s_mov_b32 s41, 24576
    buffer_load_dword v58, v4, s[56:59], s41 offen sc1
    s_mov_b32 s40, 49152
    buffer_load_dwordx2 v[30:31], v3, s[20:23], s40 offen sc1
    s_mov_b32 s41, 36864
    buffer_load_dword v59, v4, s[56:59], s41 offen sc1
    s_mov_b32 s40, 65536
    buffer_load_dwordx2 v[32:33], v3, s[20:23], s40 offen sc1
    s_mov_b32 s41, 49152
    buffer_load_dword v60, v4, s[56:59], s41 offen sc1
    s_mov_b32 s40, 81920
    buffer_load_dwordx2 v[34:35], v3, s[20:23], s40 offen sc1
    s_mov_b32 s41, 61440
    buffer_load_dword v61, v4, s[56:59], s41 offen sc1
    s_mov_b32 s40, 98304
    buffer_load_dwordx2 v[36:37], v3, s[20:23], s40 offen sc1
    s_mov_b32 s41, 73728
    buffer_load_dword v62, v4, s[56:59], s41 offen sc1
    s_mov_b32 s40, 114688
    buffer_load_dwordx2 v[38:39], v3, s[20:23], s40 offen sc1
    s_mov_b32 s41, 86016
    buffer_load_dword v63, v4, s[56:59], s41 offen sc1
    s_mov_b32 s40, 131072
    buffer_load_dwordx2 v[40:41], v3, s[20:23], s40 offen sc1
    s_mov_b32 s41, 98304
    buffer_load_dword v64, v4, s[56:59], s41 offen sc1
    s_mov_b32 s40, 147456
    buffer_load_dwordx2 v[42:43], v3, s[20:23], s40 offen sc1
    s_mov_b32 s41, 110592
    buffer_load_dword v65, v4, s[56:59], s41 offen sc1
    s_mov_b32 s40, 163840
    buffer_load_dwordx2 v[44:45], v3, s[20:23], s40 offen sc1
    s_mov_b32 s41, 122880
    buffer_load_dword v66, v4, s[56:59], s41 offen sc1
    s_mov_b32 s40, 180224
    buffer_load_dwordx2 v[46:47], v3, s[20:23], s40 offen sc1
    s_mov_b32 s41, 135168
    buffer_load_dword v67, v4, s[56:59], s41 offen sc1
    s_mov_b32 s40, 196608
    buffer_load_dwordx2 v[48:49], v3, s[20:23], s40 offen sc1
    s_mov_b32 s41, 147456
    buffer_load_dword v68, v4, s[56:59], s41 offen sc1
    s_mov_b32 s40, 212992
    buffer_load_dwordx2 v[50:51], v3, s[20:23], s40 offen sc1
    s_mov_b32 s41, 159744
    buffer_load_dword v69, v4, s[56:59], s41 offen sc1
    s_mov_b32 s40, 229376
    buffer_load_dwordx2 v[52:53], v3, s[20:23], s40 offen sc1
    s_mov_b32 s41, 172032
    buffer_load_dword v70, v4, s[56:59], s41 offen sc1
    s_mov_b32 s40, 245760
    buffer_load_dwordx2 v[54:55], v3, s[20:23], s40 offen sc1
    s_mov_b32 s41, 184320
    buffer_load_dword v71, v4, s[56:59], s41 offen sc1
    s_waitcnt vmcnt(32)
    s_barrier
    s_waitcnt vmcnt(0)
    v_pk_add_f32 v[24:25], v[24:25], v[40:41]
    v_add_f32 v56, v56, v64
    v_pk_add_f32 v[26:27], v[26:27], v[42:43]
    v_add_f32 v57, v57, v65
    v_pk_add_f32 v[28:29], v[28:29], v[44:45]
    v_add_f32 v58, v58, v66
    v_pk_add_f32 v[30:31], v[30:31], v[46:47]
    v_add_f32 v59, v59, v67
    v_pk_add_f32 v[32:33], v[32:33], v[48:49]
    v_add_f32 v60, v60, v68
    v_pk_add_f32 v[34:35], v[34:35], v[50:51]
    v_add_f32 v61, v61, v69
    v_pk_add_f32 v[36:37], v[36:37], v[52:53]
    v_add_f32 v62, v62, v70
    v_pk_add_f32 v[38:39], v[38:39], v[54:55]
    v_add_f32 v63, v63, v71
    v_pk_add_f32 v[24:25], v[24:25], v[32:33]
    v_add_f32 v56, v56, v60
    v_pk_add_f32 v[26:27], v[26:27], v[34:35]
    v_add_f32 v57, v57, v61
    v_pk_add_f32 v[28:29], v[28:29], v[36:37]
    v_add_f32 v58, v58, v62
    v_pk_add_f32 v[30:31], v[30:31], v[38:39]
    v_add_f32 v59, v59, v63
    v_pk_add_f32 v[24:25], v[24:25], v[28:29]
    v_add_f32 v56, v56, v58
    v_pk_add_f32 v[26:27], v[26:27], v[30:31]
    v_add_f32 v57, v57, v59
    v_pk_add_f32 v[24:25], v[24:25], v[26:27]
    v_add_f32 v56, v56, v57
    v_mul_f32 v24, 0x3a800000, v24
    v_mul_f32 v25, 0x3a800000, v25
    v_fma_f32 v25, -v24, v24, v25
    v_max_f32 v25, 0, v25
    v_cvt_pk_bf16_f32 v24, v24, v24
    v_lshlrev_b32 v24, 16, v24
    v_cvt_pk_bf16_f32 v25, v25, v25
    v_lshlrev_b32 v25, 16, v25
    v_add_f32 v25, 0x3727c5ac, v25
    v_cvt_pk_bf16_f32 v25, v25, v25
    v_lshlrev_b32 v25, 16, v25
    v_sqrt_f32 v25, v25
    s_nop 0
    v_cvt_pk_bf16_f32 v25, v25, v25
    v_lshlrev_b32 v25, 16, v25
    v_rcp_f32 v26, v25
    v_lshlrev_b32 v3, 3, v21
    v_lshlrev_b32 v4, 2, v21
    v_mul_f32 v27, -v24, v26
    v_cmp_gt_u32 vcc, 144, v21
    s_and_saveexec_b64 s[40:41], vcc
    v_add_u32 v3, 129024, v3
    ds_write_b64 v3, v[26:27]
    s_mov_b64 exec, s[40:41]
    v_cmp_gt_u32 vcc, 192, v21
    s_and_saveexec_b64 s[40:41], vcc
    v_add_u32 v4, 130304, v4
    ds_write_b32 v4, v56
    s_mov_b64 exec, s[40:41]
    s_waitcnt lgkmcnt(0)
    s_barrier
    s_add_u32 s20, s4, 0x200000
    s_addc_u32 s21, s5, 0
    s_mov_b32 s22, 0x40000
    s_mov_b32 s23, 0x20000
    s_lshl_b32 s40, s2, 10
    s_lshl_b32 s41, s28, 8
    s_add_u32 s40, s40, s41
    v_lshlrev_b32 v3, 2, v2
    v_mov_b32 v4, -1
    buffer_store_dword v4, v3, s[20:23], s40 offen sc1
    s_cmp_eq_u32 s53, 0
    s_cbranch_scc1 g1_nopf
    s_mov_b32 s20, s18
    s_mov_b32 s21, s19
    s_mov_b32 s22, 0x200000
    s_mov_b32 s23, 0x20000
    s_lshl_b32 s40, s2, 13
    s_lshl_b32 s41, s28, 11
    s_add_u32 s40, s40, s41
    v_lshlrev_b32 v3, 4, v2
    buffer_load_dwordx4 v[120:123], v3, s[20:23], s40 offen
    buffer_load_dwordx4 v[120:123], v3, s[20:23], s40 offen offset:1024
g1_nopf:
    s_branch g1_ld_end
g1_ld_w0:
    s_waitcnt vmcnt(16)
    s_branch g1_ld_bar
g1_ld_h0:
    s_add_u32 s44, s33, 43008
    s_cmp_eq_u32 s44, 129024
    s_cselect_b32 s44, 0, s44
    s_mul_i32 s42, s28, 3
    s_add_u32 s42, s42, 0
    s_lshr_b32 s43, s42, 2
    s_lshl_b32 s43, s43, 13
    s_add_u32 s43, s43, s44
    s_and_b32 s42, s42, 3
    v_and_b32 v3, 1, v5
    v_lshlrev_b32 v3, 1, v3
    v_lshrrev_b32 v4, 1, v6
    v_or_b32 v3, v3, v4
    s_add_u32 s40, s42, 0
    v_xor_b32 v3, s40, v3
    v_lshlrev_b32 v3, 5, v3
    v_lshl_add_u32 v3, v7, 3, v3
    v_lshl_add_u32 v4, v5, 3, v6
    v_lshl_add_u32 v3, v4, 7, v3
    v_add_u32 v21, s43, v3
    ds_read_b64_tr_b16 v[24:25], v21 offset:0
    ds_read_b64_tr_b16 v[26:27], v21 offset:512
    ds_read_b64_tr_b16 v[28:29], v21 offset:4096
    ds_read_b64_tr_b16 v[30:31], v21 offset:4608
    s_mul_i32 s42, s28, 3
    s_add_u32 s42, s42, 1
    s_lshr_b32 s43, s42, 2
    s_lshl_b32 s43, s43, 13
    s_add_u32 s43, s43, s44
    s_and_b32 s42, s42, 3
    v_and_b32 v3, 1, v5
    v_lshlrev_b32 v3, 1, v3
    v_lshrrev_b32 v4, 1, v6
    v_or_b32 v3, v3, v4
    s_add_u32 s40, s42, 0
    v_xor_b32 v3, s40, v3
    v_lshlrev_b32 v3, 5, v3
    v_lshl_add_u32 v3, v7, 3, v3
    v_lshl_add_u32 v4, v5, 3, v6
    v_lshl_add_u32 v3, v4, 7, v3
    v_add_u32 v21, s43, v3
    ds_read_b64_tr_b16 v[32:33], v21 offset:0
    ds_read_b64_tr_b16 v[34:35], v21 offset:512
    ds_read_b64_tr_b16 v[36:37], v21 offset:4096
    ds_read_b64_tr_b16 v[38:39], v21 offset:4608
    s_mul_i32 s42, s28, 3
    s_add_u32 s42, s42, 2
    s_lshr_b32 s43, s42, 2
    s_lshl_b32 s43, s43, 13
    s_add_u32 s43, s43, s44
    s_and_b32 s42, s42, 3
    v_and_b32 v3, 1, v5
    v_lshlrev_b32 v3, 1, v3
    v_lshrrev_b32 v4, 1, v6
    v_or_b32 v3, v3, v4
    s_add_u32 s40, s42, 0
    v_xor_b32 v3, s40, v3
    v_lshlrev_b32 v3, 5, v3
    v_lshl_add_u32 v3, v7, 3, v3
    v_lshl_add_u32 v4, v5, 3, v6
    v_lshl_add_u32 v3, v4, 7, v3
    v_add_u32 v21, s43, v3
    ds_read_b64_tr_b16 v[40:41], v21 offset:0
    ds_read_b64_tr_b16 v[42:43], v21 offset:512
    ds_read_b64_tr_b16 v[44:45], v21 offset:4096
    ds_read_b64_tr_b16 v[46:47], v21 offset:4608
    s_lshr_b32 s42, s44, 7
    s_lshl_b32 s43, s28, 5
    s_add_u32 s42, s42, s43
    s_add_u32 s42, s42, 16
    v_lshrrev_b32 v3, 1, v8
    v_xor_b32 v3, v3, v5
    v_lshlrev_b32 v3, 4, v3
    v_lshl_add_u32 v3, v8, 7, v3
    s_lshl_b32 s40, s42, 7
    s_add_u32 s40, s40, 24576
    v_add_u32 v22, s40, v3
    v_xor_b32 v23, 64, v22
    ds_read_b128 v[48:51], v22 offset:0
    ds_read_b128 v[52:55], v23 offset:0
    ds_read_b128 v[56:59], v22 offset:2048
    ds_read_b128 v[60:63], v23 offset:2048
    v_mov_b32 v64, 0x3f803f80
    v_mov_b32 v65, 0x3f803f80
    v_mov_b32 v66, 0x3f803f80
    v_mov_b32 v67, 0x3f803f80
    s_mul_i32 s42, s52, 12288
    s_lshl_b32 s43, s24, 8
    s_add_u32 s42, s42, s43
    v_lshl_add_u32 v21, v5, 4, s42
    s_lshl_b32 s42, s52, 14
    s_lshl_b32 s43, s25, 10
    s_add_u32 s42, s42, s43
    s_lshl_b32 s43, s28, 8
    s_add_u32 s42, s42, s43
    v_lshl_add_u32 v22, v8, 3, s42
    s_waitcnt lgkmcnt(0)
    v_mfma_f32_16x16x32_bf16 v[68:71], v[24:27], v[64:67], 0
    v_mfma_f32_16x16x32_bf16 v[72:75], v[32:35], v[64:67], 0
    v_mfma_f32_16x16x32_bf16 v[76:79], v[40:43], v[64:67], 0
    v_mfma_f32_16x16x32_bf16 v[80:83], v[64:67], v[48:51], 0
    v_mfma_f32_16x16x32_bf16 v[84:87], v[48:51], v[48:51], 0
    v_mfma_f32_16x16x32_bf16 v[88:91], v[64:67], v[56:59], 0
    v_mfma_f32_16x16x32_bf16 v[92:95], v[56:59], v[56:59], 0
    v_mfma_f32_16x16x32_bf16 v[68:71], v[28:31], v[64:67], v[68:71]
    v_mfma_f32_16x16x32_bf16 v[72:75], v[36:39], v[64:67], v[72:75]
    v_mfma_f32_16x16x32_bf16 v[76:79], v[44:47], v[64:67], v[76:79]
    v_mfma_f32_16x16x32_bf16 v[80:83], v[64:67], v[52:55], v[80:83]
    v_mfma_f32_16x16x32_bf16 v[84:87], v[52:55], v[52:55], v[84:87]
    v_mfma_f32_16x16x32_bf16 v[88:91], v[64:67], v[60:63], v[88:91]
    v_mfma_f32_16x16x32_bf16 v[92:95], v[60:63], v[60:63], v[92:95]
    v_cmp_eq_u32 s[40:41], 1, v7
    v_cmp_eq_u32 s[42:43], 2, v7
    v_cmp_eq_u32 vcc, 3, v7
    s_nop 7
    v_cndmask_b32 v81, v84, v85, s[40:41]
    v_cndmask_b32 v81, v81, v86, s[42:43]
    v_cndmask_b32 v81, v81, v87, vcc
    v_cndmask_b32 v89, v92, v93, s[40:41]
    v_cndmask_b32 v89, v89, v94, s[42:43]
    v_cndmask_b32 v89, v89, v95, vcc
    s_mov_b32 exec_lo, 0x00f0000f
    s_mov_b32 exec_hi, 0xf0000f00
    buffer_store_dwordx2 v[80:81], v22, s[20:23], 0 offen offset:0 sc1
    buffer_store_dwordx2 v[88:89], v22, s[20:23], 0 offen offset:128 sc1
    s_mov_b32 exec_lo, 0x00010001
    s_mov_b32 exec_hi, 0x00010001
    s_mul_i32 s42, s28, 3
    s_add_u32 s42, s42, 0
    s_lshr_b32 s43, s42, 2
    s_lshl_b32 s43, s43, 12
    s_and_b32 s42, s42, 3
    s_lshl_b32 s42, s42, 6
    s_add_u32 s42, s42, s43
    buffer_store_dwordx4 v[68:71], v21, s[56:59], s42 offen sc1
    s_mul_i32 s42, s28, 3
    s_add_u32 s42, s42, 1
    s_lshr_b32 s43, s42, 2
    s_lshl_b32 s43, s43, 12
    s_and_b32 s42, s42, 3
    s_lshl_b32 s42, s42, 6
    s_add_u32 s42, s42, s43
    buffer_store_dwordx4 v[72:75], v21, s[56:59], s42 offen sc1
    s_mul_i32 s42, s28, 3
    s_add_u32 s42, s42, 2
    s_lshr_b32 s43, s42, 2
    s_lshl_b32 s43, s43, 12
    s_and_b32 s42, s42, 3
    s_lshl_b32 s42, s42, 6
    s_add_u32 s42, s42, s43
    buffer_store_dwordx4 v[76:79], v21, s[56:59], s42 offen sc1
    s_mov_b64 exec, -1
    s_branch g1_ld_c0
g1_ld_w1:
    s_waitcnt vmcnt(12)
    s_branch g1_ld_bar
g1_ld_h1:
    v_mov_b32 v21, 0
    v_mov_b32 v22, 1
    s_mov_b64 exec, 1
    buffer_atomic_add v22, v21, s[60:63], 0 offen sc1
    s_mov_b64 exec, -1
    s_branch g1_ld_c1
g1_ld_w2:
    s_waitcnt vmcnt(12)
    s_branch g1_ld_bar
g1_ld_h2:
    v_mov_b32 v21, 0
    buffer_load_dword v23, v21, s[60:63], 0 offen sc1
    s_branch g1_ld_c2
g1_ld_end:
    s_add_u32 s28, s28, 4
    s_branch g1_attn
g1_compute:
    s_and_b32 s44, s28, 1
    s_lshr_b32 s45, s28, 1
    s_lshl_b32 s42, s44, 1
    s_mov_b32 s43, 0
    v_and_b32 v3, 1, v5
    v_lshlrev_b32 v3, 1, v3
    v_lshrrev_b32 v4, 1, v6
    v_or_b32 v3, v3, v4
    s_add_u32 s40, s42, 0
    v_xor_b32 v3, s40, v3
    v_lshlrev_b32 v3, 5, v3
    v_lshl_add_u32 v3, v7, 3, v3
    v_lshl_add_u32 v4, v5, 3, v6
    v_lshl_add_u32 v3, v4, 7, v3
    v_add_u32 v10, s43, v3
    v_and_b32 v3, 1, v5
    v_lshlrev_b32 v3, 1, v3
    v_lshrrev_b32 v4, 1, v6
    v_or_b32 v3, v3, v4
    s_add_u32 s40, s42, 1
    v_xor_b32 v3, s40, v3
    v_lshlrev_b32 v3, 5, v3
    v_lshl_add_u32 v3, v7, 3, v3
    v_lshl_add_u32 v4, v5, 3, v6
    v_lshl_add_u32 v3, v4, 7, v3
    v_add_u32 v11, s43, v3
    s_xor_b32 s43, s45, 1
    s_add_u32 s43, s43, 1
    s_mul_i32 s43, s43, 8192
    v_and_b32 v3, 1, v5
    v_lshlrev_b32 v3, 1, v3
    v_lshrrev_b32 v4, 1, v6
    v_or_b32 v3, v3, v4
    s_add_u32 s40, s42, 0
    v_xor_b32 v3, s40, v3
    v_lshlrev_b32 v3, 5, v3
    v_lshl_add_u32 v3, v7, 3, v3
    v_lshl_add_u32 v4, v5, 3, v6
    v_lshl_add_u32 v3, v4, 7, v3
    v_add_u32 v12, s43, v3
    v_and_b32 v3, 1, v5
    v_lshlrev_b32 v3, 1, v3
    v_lshrrev_b32 v4, 1, v6
    v_or_b32 v3, v3, v4
    s_add_u32 s40, s42, 1
    v_xor_b32 v3, s40, v3
    v_lshlrev_b32 v3, 5, v3
    v_lshl_add_u32 v3, v7, 3, v3
    v_lshl_add_u32 v4, v5, 3, v6
    v_lshl_add_u32 v3, v4, 7, v3
    v_add_u32 v13, s43, v3
    s_xor_b32 s43, s45, 0
    s_add_u32 s43, s43, 1
    s_mul_i32 s43, s43, 8192
    v_and_b32 v3, 1, v5
    v_lshlrev_b32 v3, 1, v3
    v_lshrrev_b32 v4, 1, v6
    v_or_b32 v3, v3, v4
    s_add_u32 s40, s42, 0
    v_xor_b32 v3, s40, v3
    v_lshlrev_b32 v3, 5, v3
    v_lshl_add_u32 v3, v7, 3, v3
    v_lshl_add_u32 v4, v5, 3, v6
    v_lshl_add_u32 v3, v4, 7, v3
    v_add_u32 v14, s43, v3
    v_and_b32 v3, 1, v5
    v_lshlrev_b32 v3, 1, v3
    v_lshrrev_b32 v4, 1, v6
    v_or_b32 v3, v3, v4
    s_add_u32 s40, s42, 1
    v_xor_b32 v3, s40, v3
    v_lshlrev_b32 v3, 5, v3
    v_lshl_add_u32 v3, v7, 3, v3
    v_lshl_add_u32 v4, v5, 3, v6
    v_lshl_add_u32 v3, v4, 7, v3
    v_add_u32 v15, s43, v3
    s_mul_i32 s42, s45, 64
    s_add_u32 s42, s42, 16
    v_lshrrev_b32 v3, 1, v8
    v_xor_b32 v3, v3, v5
    v_lshlrev_b32 v3, 4, v3
    v_lshl_add_u32 v3, v8, 7, v3
    s_lshl_b32 s40, s42, 7
    s_add_u32 s40, s40, 24576
    v_add_u32 v16, s40, v3
    v_xor_b32 v17, 64, v16
    v_lshrrev_b32 v3, 1, v8
    v_xor_b32 v3, v3, v5
    v_lshlrev_b32 v3, 4, v3
    v_lshl_add_u32 v3, v8, 7, v3
    v_add_u32 v18, 24576, v3
    v_xor_b32 v19, 64, v18
    v_mov_b32 v24, 0
    v_mov_b32 v25, 0
    v_mov_b32 v26, 0
    v_mov_b32 v27, 0
    v_mov_b32 v28, 0
    v_mov_b32 v29, 0
    v_mov_b32 v30, 0
    v_mov_b32 v31, 0
    v_mov_b32 v32, 0
    v_mov_b32 v33, 0
    v_mov_b32 v34, 0
    v_mov_b32 v35, 0
    v_mov_b32 v36, 0
    v_mov_b32 v37, 0
    v_mov_b32 v38, 0
    v_mov_b32 v39, 0
    v_mov_b32 v40, 0
    v_mov_b32 v41, 0
    v_mov_b32 v42, 0
    v_mov_b32 v43, 0
    v_mov_b32 v44, 0
    v_mov_b32 v45, 0
    v_mov_b32 v46, 0
    v_mov_b32 v47, 0
    v_mov_b32 v48, 0
    v_mov_b32 v49, 0
    v_mov_b32 v50, 0
    v_mov_b32 v51, 0
    v_mov_b32 v52, 0
    v_mov_b32 v53, 0
    v_mov_b32 v54, 0
    v_mov_b32 v55, 0
    v_mov_b32 v56, 0
    v_mov_b32 v57, 0
    v_mov_b32 v58, 0
    v_mov_b32 v59, 0
    v_mov_b32 v60, 0
    v_mov_b32 v61, 0
    v_mov_b32 v62, 0
    v_mov_b32 v63, 0
    v_mov_b32 v64, 0
    v_mov_b32 v65, 0
    v_mov_b32 v66, 0
    v_mov_b32 v67, 0
    v_mov_b32 v68, 0
    v_mov_b32 v69, 0
    v_mov_b32 v70, 0
    v_mov_b32 v71, 0
    v_mov_b32 v72, 0
    v_mov_b32 v73, 0
    v_mov_b32 v74, 0
    v_mov_b32 v75, 0
    v_mov_b32 v76, 0
    v_mov_b32 v77, 0
    v_mov_b32 v78, 0
    v_mov_b32 v79, 0
    v_mov_b32 v80, 0
    v_mov_b32 v81, 0
    v_mov_b32 v82, 0
    v_mov_b32 v83, 0
    v_mov_b32 v84, 0
    v_mov_b32 v85, 0
    v_mov_b32 v86, 0
    v_mov_b32 v87, 0
    v_mov_b32 v88, 0
    v_mov_b32 v89, 0
    v_mov_b32 v90, 0
    v_mov_b32 v91, 0
    v_mov_b32 v92, 0
    v_mov_b32 v93, 0
    v_mov_b32 v94, 0
    v_mov_b32 v95, 0
    v_mov_b32 v96, 0
    v_mov_b32 v97, 0
    v_mov_b32 v98, 0
    v_mov_b32 v99, 0
    v_mov_b32 v100, 0
    v_mov_b32 v101, 0
    v_mov_b32 v102, 0
    v_mov_b32 v103, 0
    v_mov_b32 v104, 0
    v_mov_b32 v105, 0
    v_mov_b32 v106, 0
    v_mov_b32 v107, 0
    v_mov_b32 v108, 0
    v_mov_b32 v109, 0
    v_mov_b32 v110, 0
    v_mov_b32 v111, 0
    v_mov_b32 v112, 0
    v_mov_b32 v113, 0
    v_mov_b32 v114, 0
    v_mov_b32 v115, 0
    v_mov_b32 v116, 0
    v_mov_b32 v117, 0
    v_mov_b32 v118, 0
    v_mov_b32 v119, 0
    v_mov_b32 v120, 0
    v_mov_b32 v121, 0
    v_mov_b32 v122, 0
    v_mov_b32 v123, 0
    v_mov_b32 v124, 0
    v_mov_b32 v125, 0
    v_mov_b32 v126, 0
    v_mov_b32 v127, 0
    v_mov_b32 v172, 0
    v_mov_b32 v173, 0
    v_mov_b32 v174, 0
    v_mov_b32 v175, 0
    v_mov_b32 v176, 0
    v_mov_b32 v177, 0
    v_mov_b32 v178, 0
    v_mov_b32 v179, 0
    v_mov_b32 v180, 0
    v_mov_b32 v181, 0
    v_mov_b32 v182, 0
    v_mov_b32 v183, 0
    v_mov_b32 v184, 0
    v_mov_b32 v185, 0
    v_mov_b32 v186, 0
    v_mov_b32 v187, 0
    v_mov_b32 v188, 0
    v_mov_b32 v189, 0
    v_mov_b32 v190, 0
    v_mov_b32 v191, 0
    v_mov_b32 v192, 0
    v_mov_b32 v193, 0
    v_mov_b32 v194, 0
    v_mov_b32 v195, 0
    v_mov_b32 v196, 0
    v_mov_b32 v197, 0
    v_mov_b32 v198, 0
    v_mov_b32 v199, 0
    v_mov_b32 v200, 0
    v_mov_b32 v201, 0
    v_mov_b32 v202, 0
    v_mov_b32 v203, 0
    v_mov_b32 v204, 0
    v_mov_b32 v205, 0
    v_mov_b32 v206, 0
    v_mov_b32 v207, 0
    v_mov_b32 v208, 0
    v_mov_b32 v209, 0
    v_mov_b32 v210, 0
    v_mov_b32 v211, 0
    v_mov_b32 v212, 0
    v_mov_b32 v213, 0
    v_mov_b32 v214, 0
    v_mov_b32 v215, 0
    s_mov_b32 s48, 16
    s_mov_b32 s50, 0
    s_mov_b32 s51, 43008
    s_mov_b32 s29, 0xfffeb000
    s_waitcnt lgkmcnt(0)
.p2align 3
g1_cloop:
    s_barrier
g1_cloop2:
    v_mfma_f32_16x16x32_bf16 v[24:27], v[172:175], v[196:199], v[24:27]
    ds_read_b64_tr_b16 v[128:129], v10 offset:0
    ds_read_b64_tr_b16 v[130:131], v10 offset:512
    v_mfma_f32_16x16x32_bf16 v[28:31], v[172:175], v[200:203], v[28:31]
    ds_read_b128 v[152:155], v16 offset:0
    v_mfma_f32_16x16x32_bf16 v[32:35], v[172:175], v[204:207], v[32:35]
    ds_read_b128 v[156:159], v16 offset:2048
    v_mfma_f32_16x16x32_bf16 v[36:39], v[172:175], v[208:211], v[36:39]
    ds_read_b128 v[160:163], v16 offset:4096
    v_mfma_f32_16x16x32_bf16 v[40:43], v[176:179], v[196:199], v[40:43]
    ds_read_b128 v[164:167], v16 offset:6144
    v_mfma_f32_16x16x32_bf16 v[44:47], v[176:179], v[200:203], v[44:47]
    ds_read_b64_tr_b16 v[132:133], v11 offset:0
    ds_read_b64_tr_b16 v[134:135], v11 offset:512
    v_mfma_f32_16x16x32_bf16 v[48:51], v[176:179], v[204:207], v[48:51]
    ds_read_b64_tr_b16 v[136:137], v12 offset:0
    ds_read_b64_tr_b16 v[138:139], v12 offset:512
    v_mfma_f32_16x16x32_bf16 v[52:55], v[176:179], v[208:211], v[52:55]
    ds_read_b64_tr_b16 v[140:141], v13 offset:0
    ds_read_b64_tr_b16 v[142:143], v13 offset:512
    v_mfma_f32_16x16x32_bf16 v[56:59], v[180:183], v[196:199], v[56:59]
    ds_read_b64_tr_b16 v[144:145], v14 offset:0
    ds_read_b64_tr_b16 v[146:147], v14 offset:512
    v_mfma_f32_16x16x32_bf16 v[60:63], v[180:183], v[200:203], v[60:63]
    ds_read_b64_tr_b16 v[148:149], v15 offset:0
    ds_read_b64_tr_b16 v[150:151], v15 offset:512
    v_mfma_f32_16x16x32_bf16 v[64:67], v[180:183], v[204:207], v[64:67]
    ds_read_b128 v[168:171], v18 offset:0
    v_mfma_f32_16x16x32_bf16 v[68:71], v[180:183], v[208:211], v[68:71]
    v_mfma_f32_16x16x32_bf16 v[72:75], v[184:187], v[196:199], v[72:75]
    v_mfma_f32_16x16x32_bf16 v[76:79], v[184:187], v[200:203], v[76:79]
    v_mfma_f32_16x16x32_bf16 v[80:83], v[184:187], v[204:207], v[80:83]
    v_mfma_f32_16x16x32_bf16 v[84:87], v[184:187], v[208:211], v[84:87]
    v_mfma_f32_16x16x32_bf16 v[88:91], v[188:191], v[196:199], v[88:91]
    v_mfma_f32_16x16x32_bf16 v[92:95], v[188:191], v[200:203], v[92:95]
    v_mfma_f32_16x16x32_bf16 v[96:99], v[188:191], v[204:207], v[96:99]
    v_mfma_f32_16x16x32_bf16 v[100:103], v[188:191], v[208:211], v[100:103]
    v_mfma_f32_16x16x32_bf16 v[104:107], v[192:195], v[196:199], v[104:107]
    v_mfma_f32_16x16x32_bf16 v[108:111], v[192:195], v[200:203], v[108:111]
    v_mfma_f32_16x16x32_bf16 v[112:115], v[192:195], v[204:207], v[112:115]
    v_mfma_f32_16x16x32_bf16 v[116:119], v[192:195], v[208:211], v[116:119]
    v_mfma_f32_16x16x32_bf16 v[120:123], v[188:191], v[212:215], v[120:123]
    v_mfma_f32_16x16x32_bf16 v[124:127], v[192:195], v[212:215], v[124:127]
    s_waitcnt lgkmcnt(0)
    v_mfma_f32_16x16x32_bf16 v[24:27], v[128:131], v[152:155], v[24:27]
    ds_read_b64_tr_b16 v[172:173], v10 offset:4096
    ds_read_b64_tr_b16 v[174:175], v10 offset:4608
    v_mfma_f32_16x16x32_bf16 v[28:31], v[128:131], v[156:159], v[28:31]
    ds_read_b128 v[196:199], v17 offset:0
    v_mfma_f32_16x16x32_bf16 v[32:35], v[128:131], v[160:163], v[32:35]
    ds_read_b128 v[200:203], v17 offset:2048
    v_mfma_f32_16x16x32_bf16 v[36:39], v[128:131], v[164:167], v[36:39]
    ds_read_b128 v[204:207], v17 offset:4096
    v_mfma_f32_16x16x32_bf16 v[40:43], v[132:135], v[152:155], v[40:43]
    ds_read_b128 v[208:211], v17 offset:6144
    v_mfma_f32_16x16x32_bf16 v[44:47], v[132:135], v[156:159], v[44:47]
    ds_read_b64_tr_b16 v[176:177], v11 offset:4096
    ds_read_b64_tr_b16 v[178:179], v11 offset:4608
    v_mfma_f32_16x16x32_bf16 v[48:51], v[132:135], v[160:163], v[48:51]
    ds_read_b64_tr_b16 v[180:181], v12 offset:4096
    ds_read_b64_tr_b16 v[182:183], v12 offset:4608
    v_mfma_f32_16x16x32_bf16 v[52:55], v[132:135], v[164:167], v[52:55]
    ds_read_b64_tr_b16 v[184:185], v13 offset:4096
    ds_read_b64_tr_b16 v[186:187], v13 offset:4608
    v_mfma_f32_16x16x32_bf16 v[56:59], v[136:139], v[152:155], v[56:59]
    ds_read_b64_tr_b16 v[188:189], v14 offset:4096
    ds_read_b64_tr_b16 v[190:191], v14 offset:4608
    v_mfma_f32_16x16x32_bf16 v[60:63], v[136:139], v[156:159], v[60:63]
    ds_read_b64_tr_b16 v[192:193], v15 offset:4096
    ds_read_b64_tr_b16 v[194:195], v15 offset:4608
    v_mfma_f32_16x16x32_bf16 v[64:67], v[136:139], v[160:163], v[64:67]
    ds_read_b128 v[212:215], v19 offset:0
    v_mfma_f32_16x16x32_bf16 v[68:71], v[136:139], v[164:167], v[68:71]
    s_add_u32 s50, s50, 1
    s_cmp_eq_u32 s50, 3
    v_mfma_f32_16x16x32_bf16 v[72:75], v[140:143], v[152:155], v[72:75]
    s_cselect_b32 s49, s29, s51
    s_cselect_b32 s50, 0, s50
    v_mfma_f32_16x16x32_bf16 v[76:79], v[140:143], v[156:159], v[76:79]
    v_add_u32 v10, s49, v10
    v_add_u32 v11, s49, v11
    v_mfma_f32_16x16x32_bf16 v[80:83], v[140:143], v[160:163], v[80:83]
    v_add_u32 v12, s49, v12
    v_add_u32 v13, s49, v13
    v_mfma_f32_16x16x32_bf16 v[84:87], v[140:143], v[164:167], v[84:87]
    v_add_u32 v14, s49, v14
    v_add_u32 v15, s49, v15
    v_mfma_f32_16x16x32_bf16 v[88:91], v[144:147], v[152:155], v[88:91]
    v_add_u32 v16, s49, v16
    v_add_u32 v17, s49, v17
    v_mfma_f32_16x16x32_bf16 v[92:95], v[144:147], v[156:159], v[92:95]
    v_add_u32 v18, s49, v18
    v_add_u32 v19, s49, v19
    v_mfma_f32_16x16x32_bf16 v[96:99], v[144:147], v[160:163], v[96:99]
    s_sub_u32 s48, s48, 1
    s_cmp_lg_u32 s48, 0
    v_mfma_f32_16x16x32_bf16 v[100:103], v[144:147], v[164:167], v[100:103]
    v_mfma_f32_16x16x32_bf16 v[104:107], v[148:151], v[152:155], v[104:107]
    v_mfma_f32_16x16x32_bf16 v[108:111], v[148:151], v[156:159], v[108:111]
    v_mfma_f32_16x16x32_bf16 v[112:115], v[148:151], v[160:163], v[112:115]
    v_mfma_f32_16x16x32_bf16 v[116:119], v[148:151], v[164:167], v[116:119]
    v_mfma_f32_16x16x32_bf16 v[120:123], v[144:147], v[168:171], v[120:123]
    v_mfma_f32_16x16x32_bf16 v[124:127], v[148:151], v[168:171], v[124:127]
    s_waitcnt lgkmcnt(0)
    s_cbranch_scc1 g1_cloop
    v_mfma_f32_16x16x32_bf16 v[24:27], v[172:175], v[196:199], v[24:27]
    v_mfma_f32_16x16x32_bf16 v[28:31], v[172:175], v[200:203], v[28:31]
    v_mfma_f32_16x16x32_bf16 v[32:35], v[172:175], v[204:207], v[32:35]
    v_mfma_f32_16x16x32_bf16 v[36:39], v[172:175], v[208:211], v[36:39]
    v_mfma_f32_16x16x32_bf16 v[40:43], v[176:179], v[196:199], v[40:43]
    v_mfma_f32_16x16x32_bf16 v[44:47], v[176:179], v[200:203], v[44:47]
    v_mfma_f32_16x16x32_bf16 v[48:51], v[176:179], v[204:207], v[48:51]
    v_mfma_f32_16x16x32_bf16 v[52:55], v[176:179], v[208:211], v[52:55]
    v_mfma_f32_16x16x32_bf16 v[56:59], v[180:183], v[196:199], v[56:59]
    v_mfma_f32_16x16x32_bf16 v[60:63], v[180:183], v[200:203], v[60:63]
    v_mfma_f32_16x16x32_bf16 v[64:67], v[180:183], v[204:207], v[64:67]
    v_mfma_f32_16x16x32_bf16 v[68:71], v[180:183], v[208:211], v[68:71]
    v_mfma_f32_16x16x32_bf16 v[72:75], v[184:187], v[196:199], v[72:75]
    v_mfma_f32_16x16x32_bf16 v[76:79], v[184:187], v[200:203], v[76:79]
    v_mfma_f32_16x16x32_bf16 v[80:83], v[184:187], v[204:207], v[80:83]
    v_mfma_f32_16x16x32_bf16 v[84:87], v[184:187], v[208:211], v[84:87]
    v_mfma_f32_16x16x32_bf16 v[88:91], v[188:191], v[196:199], v[88:91]
    v_mfma_f32_16x16x32_bf16 v[92:95], v[188:191], v[200:203], v[92:95]
    v_mfma_f32_16x16x32_bf16 v[96:99], v[188:191], v[204:207], v[96:99]
    v_mfma_f32_16x16x32_bf16 v[100:103], v[188:191], v[208:211], v[100:103]
    v_mfma_f32_16x16x32_bf16 v[104:107], v[192:195], v[196:199], v[104:107]
    v_mfma_f32_16x16x32_bf16 v[108:111], v[192:195], v[200:203], v[108:111]
    v_mfma_f32_16x16x32_bf16 v[112:115], v[192:195], v[204:207], v[112:115]
    v_mfma_f32_16x16x32_bf16 v[116:119], v[192:195], v[208:211], v[116:119]
    v_mfma_f32_16x16x32_bf16 v[120:123], v[188:191], v[212:215], v[120:123]
    v_mfma_f32_16x16x32_bf16 v[124:127], v[192:195], v[212:215], v[124:127]
    s_barrier
    v_lshlrev_b32 v3, 3, v8
    v_add_u32 v4, 129024, v3
    s_mul_i32 s40, s45, 512
    s_add_u32 s40, s40, 129152
    v_add_u32 v3, s40, v3
    ds_read_b64 v[128:129], v3 offset:0
    ds_read_b64 v[130:131], v3 offset:128
    ds_read_b64 v[132:133], v3 offset:256
    ds_read_b64 v[134:135], v3 offset:384
    ds_read_b64 v[136:137], v4
    s_lshl_b32 s40, s44, 7
    s_add_u32 s40, s40, 130304
    v_lshl_add_u32 v3, v5, 4, s40
    s_mov_b32 s43, 0
    v_add_u32 v4, s43, v3
    ds_read_b128 v[140:143], v4 offset:0
    ds_read_b128 v[144:147], v4 offset:64
    s_xor_b32 s43, s45, 1
    s_add_u32 s43, s43, 1
    s_mul_i32 s43, s43, 256
    v_add_u32 v4, s43, v3
    ds_read_b128 v[148:151], v4 offset:0
    ds_read_b128 v[152:155], v4 offset:64
    s_xor_b32 s43, s45, 0
    s_add_u32 s43, s43, 1
    s_mul_i32 s43, s43, 256
    v_add_u32 v4, s43, v3
    ds_read_b128 v[156:159], v4 offset:0
    ds_read_b128 v[160:163], v4 offset:64
    v_and_b32 v3, 1, v5
    v_lshlrev_b32 v3, 1, v3
    v_lshrrev_b32 v4, 1, v5
    v_add_u32 v3, v3, v4
    s_lshl_b32 s40, s44, 2
    v_add_u32 v3, s40, v3
    v_lshrrev_b32 v4, 1, v8
    v_xor_b32 v3, v3, v4
    v_lshlrev_b32 v3, 4, v3
    v_lshl_add_u32 v3, v8, 7, v3
    s_mul_i32 s42, s45, 8192
    s_add_u32 s42, s42, 45056
    s_mov_b32 s43, 0
    s_add_u32 s40, s42, s43
    v_add_u32 v10, s40, v3
    s_xor_b32 s43, s45, 1
    s_add_u32 s43, s43, 1
    s_mul_i32 s43, s43, 18432
    s_add_u32 s40, s42, s43
    v_add_u32 v11, s40, v3
    s_xor_b32 s43, s45, 0
    s_add_u32 s43, s43, 1
    s_mul_i32 s43, s43, 18432
    s_add_u32 s40, s42, s43
    v_add_u32 v12, s40, v3
    s_add_u32 s40, s43, 43008
    v_add_u32 v13, s40, v3
    s_waitcnt lgkmcnt(0)
    v_pk_mul_f32 v[164:165], v[140:141], v[128:129] op_sel:[0,1] op_sel_hi:[1,1]
    v_pk_mul_f32 v[166:167], v[142:143], v[128:129] op_sel:[0,1] op_sel_hi:[1,1]
    v_pk_mul_f32 v[168:169], v[144:145], v[128:129] op_sel:[0,1] op_sel_hi:[1,1]
    v_pk_mul_f32 v[170:171], v[146:147], v[128:129] op_sel:[0,1] op_sel_hi:[1,1]
    v_pk_fma_f32 v[24:25], v[24:25], v[128:129], v[164:165] op_sel:[0,0,0] op_sel_hi:[1,0,1]
    v_pk_fma_f32 v[26:27], v[26:27], v[128:129], v[166:167] op_sel:[0,0,0] op_sel_hi:[1,0,1]
    v_pk_fma_f32 v[40:41], v[40:41], v[128:129], v[168:169] op_sel:[0,0,0] op_sel_hi:[1,0,1]
    v_pk_fma_f32 v[42:43], v[42:43], v[128:129], v[170:171] op_sel:[0,0,0] op_sel_hi:[1,0,1]
    v_cvt_pk_bf16_f32 v172, v24, v25
    v_cvt_pk_bf16_f32 v173, v26, v27
    v_cvt_pk_bf16_f32 v174, v40, v41
    v_cvt_pk_bf16_f32 v175, v42, v43
    s_nop 1
    v_permlane16_swap_b32 v172, v174
    v_permlane16_swap_b32 v173, v175
    ds_write_b128 v10, v[172:175] offset:0
    v_pk_mul_f32 v[164:165], v[140:141], v[130:131] op_sel:[0,1] op_sel_hi:[1,1]
    v_pk_mul_f32 v[166:167], v[142:143], v[130:131] op_sel:[0,1] op_sel_hi:[1,1]
    v_pk_mul_f32 v[168:169], v[144:145], v[130:131] op_sel:[0,1] op_sel_hi:[1,1]
    v_pk_mul_f32 v[170:171], v[146:147], v[130:131] op_sel:[0,1] op_sel_hi:[1,1]
    v_pk_fma_f32 v[28:29], v[28:29], v[130:131], v[164:165] op_sel:[0,0,0] op_sel_hi:[1,0,1]
    v_pk_fma_f32 v[30:31], v[30:31], v[130:131], v[166:167] op_sel:[0,0,0] op_sel_hi:[1,0,1]
    v_pk_fma_f32 v[44:45], v[44:45], v[130:131], v[168:169] op_sel:[0,0,0] op_sel_hi:[1,0,1]
    v_pk_fma_f32 v[46:47], v[46:47], v[130:131], v[170:171] op_sel:[0,0,0] op_sel_hi:[1,0,1]
    v_cvt_pk_bf16_f32 v176, v28, v29
    v_cvt_pk_bf16_f32 v177, v30, v31
    v_cvt_pk_bf16_f32 v178, v44, v45
    v_cvt_pk_bf16_f32 v179, v46, v47
    s_nop 1
    v_permlane16_swap_b32 v176, v178
    v_permlane16_swap_b32 v177, v179
    ds_write_b128 v10, v[176:179] offset:2048
    v_pk_mul_f32 v[164:165], v[140:141], v[132:133] op_sel:[0,1] op_sel_hi:[1,1]
    v_pk_mul_f32 v[166:167], v[142:143], v[132:133] op_sel:[0,1] op_sel_hi:[1,1]
    v_pk_mul_f32 v[168:169], v[144:145], v[132:133] op_sel:[0,1] op_sel_hi:[1,1]
    v_pk_mul_f32 v[170:171], v[146:147], v[132:133] op_sel:[0,1] op_sel_hi:[1,1]
    v_pk_fma_f32 v[32:33], v[32:33], v[132:133], v[164:165] op_sel:[0,0,0] op_sel_hi:[1,0,1]
    v_pk_fma_f32 v[34:35], v[34:35], v[132:133], v[166:167] op_sel:[0,0,0] op_sel_hi:[1,0,1]
    v_pk_fma_f32 v[48:49], v[48:49], v[132:133], v[168:169] op_sel:[0,0,0] op_sel_hi:[1,0,1]
    v_pk_fma_f32 v[50:51], v[50:51], v[132:133], v[170:171] op_sel:[0,0,0] op_sel_hi:[1,0,1]
    v_cvt_pk_bf16_f32 v180, v32, v33
    v_cvt_pk_bf16_f32 v181, v34, v35
    v_cvt_pk_bf16_f32 v182, v48, v49
    v_cvt_pk_bf16_f32 v183, v50, v51
    s_nop 1
    v_permlane16_swap_b32 v180, v182
    v_permlane16_swap_b32 v181, v183
    ds_write_b128 v10, v[180:183] offset:4096
    v_pk_mul_f32 v[164:165], v[140:141], v[134:135] op_sel:[0,1] op_sel_hi:[1,1]
    v_pk_mul_f32 v[166:167], v[142:143], v[134:135] op_sel:[0,1] op_sel_hi:[1,1]
    v_pk_mul_f32 v[168:169], v[144:145], v[134:135] op_sel:[0,1] op_sel_hi:[1,1]
    v_pk_mul_f32 v[170:171], v[146:147], v[134:135] op_sel:[0,1] op_sel_hi:[1,1]
    v_pk_fma_f32 v[36:37], v[36:37], v[134:135], v[164:165] op_sel:[0,0,0] op_sel_hi:[1,0,1]
    v_pk_fma_f32 v[38:39], v[38:39], v[134:135], v[166:167] op_sel:[0,0,0] op_sel_hi:[1,0,1]
    v_pk_fma_f32 v[52:53], v[52:53], v[134:135], v[168:169] op_sel:[0,0,0] op_sel_hi:[1,0,1]
    v_pk_fma_f32 v[54:55], v[54:55], v[134:135], v[170:171] op_sel:[0,0,0] op_sel_hi:[1,0,1]
    v_cvt_pk_bf16_f32 v184, v36, v37
    v_cvt_pk_bf16_f32 v185, v38, v39
    v_cvt_pk_bf16_f32 v186, v52, v53
    v_cvt_pk_bf16_f32 v187, v54, v55
    s_nop 1
    v_permlane16_swap_b32 v184, v186
    v_permlane16_swap_b32 v185, v187
    ds_write_b128 v10, v[184:187] offset:6144
    v_pk_mul_f32 v[164:165], v[148:149], v[128:129] op_sel:[0,1] op_sel_hi:[1,1]
    v_pk_mul_f32 v[166:167], v[150:151], v[128:129] op_sel:[0,1] op_sel_hi:[1,1]
    v_pk_mul_f32 v[168:169], v[152:153], v[128:129] op_sel:[0,1] op_sel_hi:[1,1]
    v_pk_mul_f32 v[170:171], v[154:155], v[128:129] op_sel:[0,1] op_sel_hi:[1,1]
    v_pk_fma_f32 v[56:57], v[56:57], v[128:129], v[164:165] op_sel:[0,0,0] op_sel_hi:[1,0,1]
    v_pk_fma_f32 v[58:59], v[58:59], v[128:129], v[166:167] op_sel:[0,0,0] op_sel_hi:[1,0,1]
    v_pk_fma_f32 v[72:73], v[72:73], v[128:129], v[168:169] op_sel:[0,0,0] op_sel_hi:[1,0,1]
    v_pk_fma_f32 v[74:75], v[74:75], v[128:129], v[170:171] op_sel:[0,0,0] op_sel_hi:[1,0,1]
    v_cvt_pk_bf16_f32 v172, v56, v57
    v_cvt_pk_bf16_f32 v173, v58, v59
    v_cvt_pk_bf16_f32 v174, v72, v73
    v_cvt_pk_bf16_f32 v175, v74, v75
    s_nop 1
    v_permlane16_swap_b32 v172, v174
    v_permlane16_swap_b32 v173, v175
    ds_write_b128 v11, v[172:175] offset:0
    v_pk_mul_f32 v[164:165], v[148:149], v[130:131] op_sel:[0,1] op_sel_hi:[1,1]
    v_pk_mul_f32 v[166:167], v[150:151], v[130:131] op_sel:[0,1] op_sel_hi:[1,1]
    v_pk_mul_f32 v[168:169], v[152:153], v[130:131] op_sel:[0,1] op_sel_hi:[1,1]
    v_pk_mul_f32 v[170:171], v[154:155], v[130:131] op_sel:[0,1] op_sel_hi:[1,1]
    v_pk_fma_f32 v[60:61], v[60:61], v[130:131], v[164:165] op_sel:[0,0,0] op_sel_hi:[1,0,1]
    v_pk_fma_f32 v[62:63], v[62:63], v[130:131], v[166:167] op_sel:[0,0,0] op_sel_hi:[1,0,1]
    v_pk_fma_f32 v[76:77], v[76:77], v[130:131], v[168:169] op_sel:[0,0,0] op_sel_hi:[1,0,1]
    v_pk_fma_f32 v[78:79], v[78:79], v[130:131], v[170:171] op_sel:[0,0,0] op_sel_hi:[1,0,1]
    v_cvt_pk_bf16_f32 v176, v60, v61
    v_cvt_pk_bf16_f32 v177, v62, v63
    v_cvt_pk_bf16_f32 v178, v76, v77
    v_cvt_pk_bf16_f32 v179, v78, v79
    s_nop 1
    v_permlane16_swap_b32 v176, v178
    v_permlane16_swap_b32 v177, v179
    ds_write_b128 v11, v[176:179] offset:2048
    v_pk_mul_f32 v[164:165], v[148:149], v[132:133] op_sel:[0,1] op_sel_hi:[1,1]
    v_pk_mul_f32 v[166:167], v[150:151], v[132:133] op_sel:[0,1] op_sel_hi:[1,1]
    v_pk_mul_f32 v[168:169], v[152:153], v[132:133] op_sel:[0,1] op_sel_hi:[1,1]
    v_pk_mul_f32 v[170:171], v[154:155], v[132:133] op_sel:[0,1] op_sel_hi:[1,1]
    v_pk_fma_f32 v[64:65], v[64:65], v[132:133], v[164:165] op_sel:[0,0,0] op_sel_hi:[1,0,1]
    v_pk_fma_f32 v[66:67], v[66:67], v[132:133], v[166:167] op_sel:[0,0,0] op_sel_hi:[1,0,1]
    v_pk_fma_f32 v[80:81], v[80:81], v[132:133], v[168:169] op_sel:[0,0,0] op_sel_hi:[1,0,1]
    v_pk_fma_f32 v[82:83], v[82:83], v[132:133], v[170:171] op_sel:[0,0,0] op_sel_hi:[1,0,1]
    v_cvt_pk_bf16_f32 v180, v64, v65
    v_cvt_pk_bf16_f32 v181, v66, v67
    v_cvt_pk_bf16_f32 v182, v80, v81
    v_cvt_pk_bf16_f32 v183, v82, v83
    s_nop 1
    v_permlane16_swap_b32 v180, v182
    v_permlane16_swap_b32 v181, v183
    ds_write_b128 v11, v[180:183] offset:4096
    v_pk_mul_f32 v[164:165], v[148:149], v[134:135] op_sel:[0,1] op_sel_hi:[1,1]
    v_pk_mul_f32 v[166:167], v[150:151], v[134:135] op_sel:[0,1] op_sel_hi:[1,1]
    v_pk_mul_f32 v[168:169], v[152:153], v[134:135] op_sel:[0,1] op_sel_hi:[1,1]
    v_pk_mul_f32 v[170:171], v[154:155], v[134:135] op_sel:[0,1] op_sel_hi:[1,1]
    v_pk_fma_f32 v[68:69], v[68:69], v[134:135], v[164:165] op_sel:[0,0,0] op_sel_hi:[1,0,1]
    v_pk_fma_f32 v[70:71], v[70:71], v[134:135], v[166:167] op_sel:[0,0,0] op_sel_hi:[1,0,1]
    v_pk_fma_f32 v[84:85], v[84:85], v[134:135], v[168:169] op_sel:[0,0,0] op_sel_hi:[1,0,1]
    v_pk_fma_f32 v[86:87], v[86:87], v[134:135], v[170:171] op_sel:[0,0,0] op_sel_hi:[1,0,1]
    v_cvt_pk_bf16_f32 v184, v68, v69
    v_cvt_pk_bf16_f32 v185, v70, v71
    v_cvt_pk_bf16_f32 v186, v84, v85
    v_cvt_pk_bf16_f32 v187, v86, v87
    s_nop 1
    v_permlane16_swap_b32 v184, v186
    v_permlane16_swap_b32 v185, v187
    ds_write_b128 v11, v[184:187] offset:6144
    v_pk_mul_f32 v[164:165], v[156:157], v[128:129] op_sel:[0,1] op_sel_hi:[1,1]
    v_pk_mul_f32 v[166:167], v[158:159], v[128:129] op_sel:[0,1] op_sel_hi:[1,1]
    v_pk_mul_f32 v[168:169], v[160:161], v[128:129] op_sel:[0,1] op_sel_hi:[1,1]
    v_pk_mul_f32 v[170:171], v[162:163], v[128:129] op_sel:[0,1] op_sel_hi:[1,1]
    v_pk_fma_f32 v[88:89], v[88:89], v[128:129], v[164:165] op_sel:[0,0,0] op_sel_hi:[1,0,1]
    v_pk_fma_f32 v[90:91], v[90:91], v[128:129], v[166:167] op_sel:[0,0,0] op_sel_hi:[1,0,1]
    v_pk_fma_f32 v[104:105], v[104:105], v[128:129], v[168:169] op_sel:[0,0,0] op_sel_hi:[1,0,1]
    v_pk_fma_f32 v[106:107], v[106:107], v[128:129], v[170:171] op_sel:[0,0,0] op_sel_hi:[1,0,1]
    v_cvt_pk_bf16_f32 v172, v88, v89
    v_cvt_pk_bf16_f32 v173, v90, v91
    v_cvt_pk_bf16_f32 v174, v104, v105
    v_cvt_pk_bf16_f32 v175, v106, v107
    s_nop 1
    v_permlane16_swap_b32 v172, v174
    v_permlane16_swap_b32 v173, v175
    ds_write_b128 v12, v[172:175] offset:0
    v_pk_mul_f32 v[164:165], v[156:157], v[130:131] op_sel:[0,1] op_sel_hi:[1,1]
    v_pk_mul_f32 v[166:167], v[158:159], v[130:131] op_sel:[0,1] op_sel_hi:[1,1]
    v_pk_mul_f32 v[168:169], v[160:161], v[130:131] op_sel:[0,1] op_sel_hi:[1,1]
    v_pk_mul_f32 v[170:171], v[162:163], v[130:131] op_sel:[0,1] op_sel_hi:[1,1]
    v_pk_fma_f32 v[92:93], v[92:93], v[130:131], v[164:165] op_sel:[0,0,0] op_sel_hi:[1,0,1]
    v_pk_fma_f32 v[94:95], v[94:95], v[130:131], v[166:167] op_sel:[0,0,0] op_sel_hi:[1,0,1]
    v_pk_fma_f32 v[108:109], v[108:109], v[130:131], v[168:169] op_sel:[0,0,0] op_sel_hi:[1,0,1]
    v_pk_fma_f32 v[110:111], v[110:111], v[130:131], v[170:171] op_sel:[0,0,0] op_sel_hi:[1,0,1]
    v_cvt_pk_bf16_f32 v176, v92, v93
    v_cvt_pk_bf16_f32 v177, v94, v95
    v_cvt_pk_bf16_f32 v178, v108, v109
    v_cvt_pk_bf16_f32 v179, v110, v111
    s_nop 1
    v_permlane16_swap_b32 v176, v178
    v_permlane16_swap_b32 v177, v179
    ds_write_b128 v12, v[176:179] offset:2048
    v_pk_mul_f32 v[164:165], v[156:157], v[132:133] op_sel:[0,1] op_sel_hi:[1,1]
    v_pk_mul_f32 v[166:167], v[158:159], v[132:133] op_sel:[0,1] op_sel_hi:[1,1]
    v_pk_mul_f32 v[168:169], v[160:161], v[132:133] op_sel:[0,1] op_sel_hi:[1,1]
    v_pk_mul_f32 v[170:171], v[162:163], v[132:133] op_sel:[0,1] op_sel_hi:[1,1]
    v_pk_fma_f32 v[96:97], v[96:97], v[132:133], v[164:165] op_sel:[0,0,0] op_sel_hi:[1,0,1]
    v_pk_fma_f32 v[98:99], v[98:99], v[132:133], v[166:167] op_sel:[0,0,0] op_sel_hi:[1,0,1]
    v_pk_fma_f32 v[112:113], v[112:113], v[132:133], v[168:169] op_sel:[0,0,0] op_sel_hi:[1,0,1]
    v_pk_fma_f32 v[114:115], v[114:115], v[132:133], v[170:171] op_sel:[0,0,0] op_sel_hi:[1,0,1]
    v_cvt_pk_bf16_f32 v180, v96, v97
    v_cvt_pk_bf16_f32 v181, v98, v99
    v_cvt_pk_bf16_f32 v182, v112, v113
    v_cvt_pk_bf16_f32 v183, v114, v115
    s_nop 1
    v_permlane16_swap_b32 v180, v182
    v_permlane16_swap_b32 v181, v183
    ds_write_b128 v12, v[180:183] offset:4096
    v_pk_mul_f32 v[164:165], v[156:157], v[134:135] op_sel:[0,1] op_sel_hi:[1,1]
    v_pk_mul_f32 v[166:167], v[158:159], v[134:135] op_sel:[0,1] op_sel_hi:[1,1]
    v_pk_mul_f32 v[168:169], v[160:161], v[134:135] op_sel:[0,1] op_sel_hi:[1,1]
    v_pk_mul_f32 v[170:171], v[162:163], v[134:135] op_sel:[0,1] op_sel_hi:[1,1]
    v_pk_fma_f32 v[100:101], v[100:101], v[134:135], v[164:165] op_sel:[0,0,0] op_sel_hi:[1,0,1]
    v_pk_fma_f32 v[102:103], v[102:103], v[134:135], v[166:167] op_sel:[0,0,0] op_sel_hi:[1,0,1]
    v_pk_fma_f32 v[116:117], v[116:117], v[134:135], v[168:169] op_sel:[0,0,0] op_sel_hi:[1,0,1]
    v_pk_fma_f32 v[118:119], v[118:119], v[134:135], v[170:171] op_sel:[0,0,0] op_sel_hi:[1,0,1]
    v_cvt_pk_bf16_f32 v184, v100, v101
    v_cvt_pk_bf16_f32 v185, v102, v103
    v_cvt_pk_bf16_f32 v186, v116, v117
    v_cvt_pk_bf16_f32 v187, v118, v119
    s_nop 1
    v_permlane16_swap_b32 v184, v186
    v_permlane16_swap_b32 v185, v187
    ds_write_b128 v12, v[184:187] offset:6144
    v_pk_mul_f32 v[164:165], v[156:157], v[136:137] op_sel:[0,1] op_sel_hi:[1,1]
    v_pk_mul_f32 v[166:167], v[158:159], v[136:137] op_sel:[0,1] op_sel_hi:[1,1]
    v_pk_mul_f32 v[168:169], v[160:161], v[136:137] op_sel:[0,1] op_sel_hi:[1,1]
    v_pk_mul_f32 v[170:171], v[162:163], v[136:137] op_sel:[0,1] op_sel_hi:[1,1]
    v_pk_fma_f32 v[120:121], v[120:121], v[136:137], v[164:165] op_sel:[0,0,0] op_sel_hi:[1,0,1]
    v_pk_fma_f32 v[122:123], v[122:123], v[136:137], v[166:167] op_sel:[0,0,0] op_sel_hi:[1,0,1]
    v_pk_fma_f32 v[124:125], v[124:125], v[136:137], v[168:169] op_sel:[0,0,0] op_sel_hi:[1,0,1]
    v_pk_fma_f32 v[126:127], v[126:127], v[136:137], v[170:171] op_sel:[0,0,0] op_sel_hi:[1,0,1]
    v_cvt_pk_bf16_f32 v172, v120, v121
    v_cvt_pk_bf16_f32 v173, v122, v123
    v_cvt_pk_bf16_f32 v174, v124, v125
    v_cvt_pk_bf16_f32 v175, v126, v127
    s_nop 1
    v_permlane16_swap_b32 v172, v174
    v_permlane16_swap_b32 v173, v175
    ds_write_b128 v13, v[172:175]
    s_waitcnt lgkmcnt(0)
g1_attn:
    s_add_u32 s16, s4, 0x400000
    s_addc_u32 s17, s5, 0
    s_mov_b32 s18, 0x400000
    s_mov_b32 s19, 0x20000
    s_and_b32 s44, s28, 1
    s_lshr_b32 s45, s28, 1
    s_lshl_b32 s40, s44, 2
    v_add_u32 v3, s40, v5
    v_and_b32 v4, 7, v8
    v_xor_b32 v3, v3, v4
    v_lshlrev_b32 v3, 4, v3
    v_lshl_add_u32 v3, v8, 8, v3
    s_mul_i32 s41, s45, 4096
    s_add_u32 s41, s41, 43008
    v_add_u32 v10, s41, v3
    v_lshl_add_u32 v3, v5, 2, v6
    v_and_b32 v4, 7, v3
    v_add_u32 v12, s40, v7
    v_xor_b32 v4, v4, v12
    v_lshlrev_b32 v4, 4, v4
    v_lshl_add_u32 v3, v3, 8, v4
    s_add_u32 s41, s41, 36864
    v_add_u32 v11, s41, v3
    v_and_b32 v3, 7, v8
    v_add_u32 v4, 1, v3
    s_or_b32 s40, s25, s45
    s_cmp_eq_u32 s40, 0
    s_cselect_b32 s40, 8, 0
    v_cmp_gt_u32 vcc, 8, v8
    v_mov_b32 v16, s40
    s_mov_b64 s[56:57], vcc
    v_cndmask_b32 v16, 0, v16, vcc
    v_max_u32 v4, v4, v16
    v_add_u32 v3, 8, v3
    v_sub_u32 v3, v3, v4
    v_lshlrev_b32 v16, 2, v5
    v_sub_u32 v16, v16, v4
    v_mov_b32 v17, 0xf149f2ca
    v_add_u32 v18, 0, v16
    v_cmp_ge_u32 vcc, v3, v18
    s_nop 1
    v_cndmask_b32 v12, v17, 0, vcc
    v_add_u32 v18, 1, v16
    v_cmp_ge_u32 vcc, v3, v18
    s_nop 1
    v_cndmask_b32 v13, v17, 0, vcc
    v_add_u32 v18, 2, v16
    v_cmp_ge_u32 vcc, v3, v18
    s_nop 1
    v_cndmask_b32 v14, v17, 0, vcc
    v_add_u32 v18, 3, v16
    v_cmp_ge_u32 vcc, v3, v18
    s_nop 1
    v_cndmask_b32 v15, v17, 0, vcc
    s_lshl_b32 s40, s25, 7
    s_lshl_b32 s41, s45, 5
    s_add_u32 s40, s40, s41
    s_lshl_b32 s40, s40, 11
    s_lshl_b32 s41, s24, 7
    s_add_u32 s40, s40, s41
    s_lshl_b32 s41, s44, 6
    s_add_u32 s40, s40, s41
    v_lshlrev_b32 v9, 12, v8
    v_lshl_add_u32 v9, v5, 4, v9
    v_add_u32 v9, s40, v9
    s_mov_b32 s58, 0x3e3504f3
    s_mov_b32 s59, 0x3fb8aa3b
    s_barrier
    ds_read_b128 v[24:27], v10 offset:2048
    ds_read_b128 v[28:31], v10 offset:18432
    ds_read_b128 v[32:35], v10 offset:20480
    ds_read_b128 v[72:75], v10 offset:2176
    ds_read_b128 v[76:79], v10 offset:18560
    ds_read_b128 v[80:83], v10 offset:20608
    ds_read_b64_tr_b16 v[36:37], v11 offset:0
    ds_read_b64_tr_b16 v[38:39], v11 offset:2048
    ds_read_b64_tr_b16 v[40:41], v11 offset:8
    ds_read_b64_tr_b16 v[42:43], v11 offset:2056
    ds_read_b64_tr_b16 v[84:85], v11 offset:128
    ds_read_b64_tr_b16 v[86:87], v11 offset:2176
    ds_read_b64_tr_b16 v[88:89], v11 offset:136
    ds_read_b64_tr_b16 v[90:91], v11 offset:2184
    s_waitcnt lgkmcnt(8)
    v_mfma_f32_16x16x32_bf16 v[44:47], v[28:31], v[24:27], 0
    v_mfma_f32_16x16x32_bf16 v[48:51], v[32:35], v[24:27], 0
    v_mfma_f32_16x16x32_bf16 v[92:95], v[76:79], v[72:75], 0
    v_mfma_f32_16x16x32_bf16 v[96:99], v[80:83], v[72:75], 0
    s_nop 7
    v_cndmask_b32 v44, v48, v44, s[56:57]
    v_cndmask_b32 v45, v49, v45, s[56:57]
    v_cndmask_b32 v46, v50, v46, s[56:57]
    v_cndmask_b32 v47, v51, v47, s[56:57]
    v_cndmask_b32 v92, v96, v92, s[56:57]
    v_cndmask_b32 v93, v97, v93, s[56:57]
    v_cndmask_b32 v94, v98, v94, s[56:57]
    v_cndmask_b32 v95, v99, v95, s[56:57]
    v_cvt_pk_bf16_f32 v48, v44, v45
    v_cvt_pk_bf16_f32 v49, v46, v47
    v_cvt_pk_bf16_f32 v96, v92, v93
    v_cvt_pk_bf16_f32 v97, v94, v95
    v_lshlrev_b32 v44, 16, v48
    v_and_b32 v45, 0xffff0000, v48
    v_lshlrev_b32 v46, 16, v49
    v_and_b32 v47, 0xffff0000, v49
    v_lshlrev_b32 v92, 16, v96
    v_and_b32 v93, 0xffff0000, v96
    v_lshlrev_b32 v94, 16, v97
    v_and_b32 v95, 0xffff0000, v97
    v_mul_f32 v44, s58, v44
    v_mul_f32 v45, s58, v45
    v_mul_f32 v46, s58, v46
    v_mul_f32 v47, s58, v47
    v_mul_f32 v92, s58, v92
    v_mul_f32 v93, s58, v93
    v_mul_f32 v94, s58, v94
    v_mul_f32 v95, s58, v95
    v_cvt_pk_bf16_f32 v48, v44, v45
    v_cvt_pk_bf16_f32 v49, v46, v47
    v_cvt_pk_bf16_f32 v96, v92, v93
    v_cvt_pk_bf16_f32 v97, v94, v95
    v_lshlrev_b32 v44, 16, v48
    v_and_b32 v45, 0xffff0000, v48
    v_lshlrev_b32 v46, 16, v49
    v_and_b32 v47, 0xffff0000, v49
    v_lshlrev_b32 v92, 16, v96
    v_and_b32 v93, 0xffff0000, v96
    v_lshlrev_b32 v94, 16, v97
    v_and_b32 v95, 0xffff0000, v97
    v_fma_f32 v44, v44, s59, v12
    v_fma_f32 v45, v45, s59, v13
    v_fma_f32 v46, v46, s59, v14
    v_fma_f32 v47, v47, s59, v15
    v_fma_f32 v92, v92, s59, v12
    v_fma_f32 v93, v93, s59, v13
    v_fma_f32 v94, v94, s59, v14
    v_fma_f32 v95, v95, s59, v15
    v_max3_f32 v48, v44, v45, v46
    v_max3_f32 v96, v92, v93, v94
    v_max_f32 v48, v48, v47
    v_max_f32 v96, v96, v95
    v_mov_b32 v49, v48
    v_mov_b32 v97, v96
    s_nop 1
    v_permlane16_swap_b32 v48, v49
    v_permlane16_swap_b32 v96, v97
    s_nop 0
    v_max_f32 v48, v48, v49
    v_max_f32 v96, v96, v97
    v_mov_b32 v49, v48
    v_mov_b32 v97, v96
    s_nop 1
    v_permlane32_swap_b32 v48, v49
    v_permlane32_swap_b32 v96, v97
    s_nop 0
    v_max_f32 v48, v48, v49
    v_max_f32 v96, v96, v97
    v_sub_f32 v44, v44, v48
    v_sub_f32 v45, v45, v48
    v_sub_f32 v46, v46, v48
    v_sub_f32 v47, v47, v48
    v_sub_f32 v92, v92, v96
    v_sub_f32 v93, v93, v96
    v_sub_f32 v94, v94, v96
    v_sub_f32 v95, v95, v96
    v_exp_f32 v44, v44
    v_exp_f32 v45, v45
    v_exp_f32 v46, v46
    v_exp_f32 v47, v47
    v_exp_f32 v92, v92
    v_exp_f32 v93, v93
    v_exp_f32 v94, v94
    v_exp_f32 v95, v95
    v_add_f32 v48, v44, v45
    v_add_f32 v49, v46, v47
    v_add_f32 v96, v92, v93
    v_add_f32 v97, v94, v95
    v_add_f32 v48, v48, v49
    v_add_f32 v96, v96, v97
    v_mov_b32 v49, v48
    v_mov_b32 v97, v96
    s_nop 1
    v_permlane16_swap_b32 v48, v49
    v_permlane16_swap_b32 v96, v97
    s_nop 0
    v_add_f32 v48, v48, v49
    v_add_f32 v96, v96, v97
    v_mov_b32 v49, v48
    v_mov_b32 v97, v96
    s_nop 1
    v_permlane32_swap_b32 v48, v49
    v_permlane32_swap_b32 v96, v97
    s_nop 0
    v_add_f32 v48, v48, v49
    v_add_f32 v96, v96, v97
    v_rcp_f32 v48, v48
    v_rcp_f32 v96, v96
    s_nop 0
    v_mul_f32 v44, v44, v48
    v_mul_f32 v45, v45, v48
    v_mul_f32 v46, v46, v48
    v_mul_f32 v47, v47, v48
    v_mul_f32 v92, v92, v96
    v_mul_f32 v93, v93, v96
    v_mul_f32 v94, v94, v96
    v_mul_f32 v95, v95, v96
    v_cvt_pk_bf16_f32 v48, v44, v45
    v_cvt_pk_bf16_f32 v49, v46, v47
    v_cvt_pk_bf16_f32 v96, v92, v93
    v_cvt_pk_bf16_f32 v97, v94, v95
    v_cndmask_b32 v52, 0, v48, s[56:57]
    v_cndmask_b32 v53, 0, v49, s[56:57]
    v_cndmask_b32 v54, v48, 0, s[56:57]
    v_cndmask_b32 v55, v49, 0, s[56:57]
    v_cndmask_b32 v100, 0, v96, s[56:57]
    v_cndmask_b32 v101, 0, v97, s[56:57]
    v_cndmask_b32 v102, v96, 0, s[56:57]
    v_cndmask_b32 v103, v97, 0, s[56:57]
    s_waitcnt lgkmcnt(0)
    s_nop 0
    v_mfma_f32_16x16x32_bf16 v[56:59], v[36:39], v[52:55], 0
    v_mfma_f32_16x16x32_bf16 v[60:63], v[40:43], v[52:55], 0
    v_mfma_f32_16x16x32_bf16 v[104:107], v[84:87], v[100:103], 0
    v_mfma_f32_16x16x32_bf16 v[108:111], v[88:91], v[100:103], 0
    s_nop 7
    v_cvt_pk_bf16_f32 v64, v56, v57
    v_cvt_pk_bf16_f32 v65, v58, v59
    v_cvt_pk_bf16_f32 v66, v60, v61
    v_cvt_pk_bf16_f32 v67, v62, v63
    buffer_store_dwordx4 v[64:67], v9, s[16:19], 0 offen offset:0 sc1
    v_cvt_pk_bf16_f32 v112, v104, v105
    v_cvt_pk_bf16_f32 v113, v106, v107
    v_cvt_pk_bf16_f32 v114, v108, v109
    v_cvt_pk_bf16_f32 v115, v110, v111
    buffer_store_dwordx4 v[112:115], v9, s[16:19], 0 offen offset:2048 sc1
g1_done:
    s_endpgm
.section .rodata,"a"
.p2align 6
.amdhsa_kernel g1a_kernel
  .amdhsa_next_free_vgpr 216
  .amdhsa_next_free_sgpr 96
  .amdhsa_accum_offset 216
  .amdhsa_group_segment_fixed_size 0
  .amdhsa_kernarg_size 88
  .amdhsa_user_sgpr_count 2
  .amdhsa_user_sgpr_kernarg_segment_ptr 1
  .amdhsa_system_sgpr_workgroup_id_x 1
.end_amdhsa_kernel
.section .rodata,"a"
.p2align 6
.amdhsa_kernel g1b_kernel
  .amdhsa_next_free_vgpr 216
  .amdhsa_next_free_sgpr 96
  .amdhsa_accum_offset 216
  .amdhsa_group_segment_fixed_size 0
  .amdhsa_kernarg_size 88
  .amdhsa_user_sgpr_count 2
  .amdhsa_user_sgpr_kernarg_segment_ptr 1
  .amdhsa_system_sgpr_workgroup_id_x 1
.end_amdhsa_kernel
.text
.globl g2a_kernel
.p2align 8
.type g2a_kernel,@function
g2a_kernel:
    s_load_dwordx2 s[6:7], s[0:1], 0
    s_mov_b32 s47, 0
    s_branch g2_body
.text
.globl g2b_kernel
.p2align 8
.type g2b_kernel,@function
g2b_kernel:
    s_load_dwordx2 s[6:7], s[0:1], 80
    s_mov_b32 s47, 0x1900000
    s_branch g2_body
.p2align 6
g2_body:
    s_cmp_ge_u32 s2, 256
    s_cbranch_scc1 g2_done
    s_load_dwordx2 s[4:5], s[0:1], 80
    s_load_dwordx2 s[30:31], s[0:1], 16
    v_lshrrev_b32 v1, 6, v0
    v_and_b32 v2, 63, v0
    s_and_b32 s40, s2, 3
    s_lshl_b32 s40, s40, 2
    s_bfe_u32 s41, s2, 0x20003
    s_add_u32 s25, s40, s41
    s_bfe_u32 s40, s2, 0x10002
    s_lshl_b32 s40, s40, 3
    s_lshr_b32 s42, s2, 5
    s_add_u32 s24, s40, s42
    s_add_u32 s27, s41, s42
    s_mov_b32 s26, 0
    v_readfirstlane_b32 s28, v1
    s_nop 0
    s_cmp_lt_u32 s28, 4
    s_cbranch_scc1 g2_compute
    s_sub_u32 s28, s28, 4
    s_mov_b32 s40, 2048
    v_lshrrev_b32 v3, 3, v2
    v_mul_lo_u32 v3, v3, s40
    v_bfe_u32 v4, v2, 4, 1
    v_lshlrev_b32 v4, 1, v4
    v_xor_b32 v4, v4, v2
    v_and_b32 v4, 7, v4
    v_lshl_add_u32 v3, v4, 4, v3
    s_mul_i32 s41, s24, 128
    s_mul_i32 s42, s28, 32768
    s_add_u32 s41, s41, s42
    v_xor_b32 v4, 64, v3
    s_add_u32 s42, s41, 0
    v_add_u32 v10, s42, v3
    s_add_u32 s42, s41, 16384
    v_add_u32 v11, s42, v4
    s_mov_b32 s40, 2048
    v_lshrrev_b32 v3, 3, v2
    v_mul_lo_u32 v3, v3, s40
    v_lshrrev_b32 v4, 4, v2
    v_xor_b32 v4, v4, v2
    v_and_b32 v4, 7, v4
    v_lshl_add_u32 v3, v4, 4, v3
    s_mul_i32 s41, s25, 262144
    s_mul_i32 s42, s28, 65536
    s_add_u32 s41, s41, s42
    v_xor_b32 v4, 64, v3
    s_add_u32 s42, s41, 0
    v_add_u32 v12, s42, v3
    s_add_u32 s42, s41, 16384
    v_add_u32 v13, s42, v4
    s_add_u32 s42, s41, 32768
    v_add_u32 v14, s42, v3
    s_add_u32 s42, s41, 49152
    v_add_u32 v15, s42, v4
    s_mul_i32 s36, s28, 2048
    s_mul_i32 s37, s28, 4096
    s_add_u32 s37, s37, 8192
    s_waitcnt lgkmcnt(0)
    s_mov_b32 s8, s30
    s_mov_b32 s9, s31
    s_mov_b32 s10, 0x200000
    s_mov_b32 s11, 0x20000
    s_add_u32 s12, s4, 0x400000
    s_addc_u32 s13, s5, 0
    s_mov_b32 s14, 0x400000
    s_mov_b32 s15, 0x20000
    s_mov_b32 s32, 0
    s_mov_b32 s33, 0
g2_ld_loop:
    s_cmp_lt_u32 s32, 3
    s_cbranch_scc1 g2_ld_issue
    s_waitcnt vmcnt(12)
g2_ld_bar:
    s_barrier
g2_ld_issue:
    s_add_u32 s40, s32, s27
    s_and_b32 s40, s40, 1
    s_andn2_b32 s41, s32, 1
    s_or_b32 s40, s40, s41
    s_add_u32 s40, s40, s26
    s_mul_i32 s34, s40, 131072
    s_mul_i32 s35, s40, 128
    s_add_u32 s38, s33, s36
    s_add_u32 s39, s33, s37
    s_add_u32 m0, s38, 0
    s_nop 0
    buffer_load_dwordx4 v10, s[8:11], s34 offen lds
    s_add_u32 m0, s38, 1024
    s_nop 0
    buffer_load_dwordx4 v11, s[8:11], s34 offen lds
    s_add_u32 m0, s39, 0
    s_nop 0
    buffer_load_dwordx4 v12, s[12:15], s35 offen lds
    s_add_u32 m0, s39, 1024
    s_nop 0
    buffer_load_dwordx4 v13, s[12:15], s35 offen lds
    s_add_u32 m0, s39, 2048
    s_nop 0
    buffer_load_dwordx4 v14, s[12:15], s35 offen lds
    s_add_u32 m0, s39, 3072
    s_nop 0
    buffer_load_dwordx4 v15, s[12:15], s35 offen lds
    s_add_u32 s33, s33, 24576
    s_cmp_eq_u32 s33, 98304
    s_cselect_b32 s33, 0, s33
    s_add_u32 s32, s32, 1
    s_cmp_lt_u32 s32, 16
    s_cbranch_scc1 g2_ld_loop
    s_waitcnt vmcnt(12)
    s_barrier
    s_waitcnt vmcnt(6)
    s_barrier
    s_waitcnt vmcnt(0)
    s_barrier
g2_done:
    s_endpgm
g2_compute:
    v_lshrrev_b32 v5, 4, v2
    v_bfe_u32 v6, v2, 2, 2
    v_and_b32 v7, 3, v2
    v_and_b32 v8, 15, v2
    s_and_b32 s44, s28, 0
    s_lshr_b32 s45, s28, 0
    s_mul_i32 s40, s25, 128
    s_mul_i32 s41, s45, 32
    s_add_u32 s40, s40, s41
    v_add_u32 v20, s40, v8
    s_mov_b32 s41, 2048
    v_mul_lo_u32 v9, v20, s41
    s_mul_i32 s40, s24, 128
    s_mul_i32 s41, s44, 128
    s_add_u32 s46, s40, s41
    v_and_b32 v3, 1, v5
    v_lshlrev_b32 v3, 5, v3
    v_lshrrev_b32 v4, 1, v5
    v_lshl_add_u32 v3, v4, 4, v3
    v_add3_u32 v9, v9, v3, s46
    s_mov_b32 s52, 0
    s_mov_b32 s53, 32768
    s_waitcnt lgkmcnt(0)
    s_add_u32 s20, s6, s47
    s_addc_u32 s21, s7, 0
    s_mov_b32 s22, 0x400000
    s_mov_b32 s23, 0x20000
    s_add_u32 s16, s4, 0x800000
    s_addc_u32 s17, s5, 0
    s_mov_b32 s18, 0x400000
    s_mov_b32 s19, 0x20000
    s_add_u32 s56, s4, 0xc00000
    s_addc_u32 s57, s5, 0
    s_mov_b32 s58, 0x480000
    s_mov_b32 s59, 0x20000
    s_add_u32 s60, s4, 0x200000
    s_addc_u32 s61, s5, 0
    s_mov_b32 s62, 0x40000
    s_mov_b32 s63, 0x20000
    buffer_load_dwordx4 v[60:63], v9, s[20:23], s52 offen offset:0
    buffer_load_dwordx4 v[64:67], v9, s[20:23], s52 offen offset:64
    buffer_load_dwordx4 v[68:71], v9, s[20:23], s53 offen offset:0
    buffer_load_dwordx4 v[72:75], v9, s[20:23], s53 offen offset:64
    s_mul_i32 s42, s44, 4
    s_mov_b32 s43, 0
    v_and_b32 v3, 1, v5
    v_lshlrev_b32 v3, 1, v3
    v_lshrrev_b32 v4, 1, v6
    v_or_b32 v3, v3, v4
    s_add_u32 s40, s42, 0
    v_xor_b32 v3, s40, v3
    v_lshlrev_b32 v3, 5, v3
    v_lshl_add_u32 v3, v7, 3, v3
    v_lshl_add_u32 v4, v5, 3, v6
    v_lshl_add_u32 v3, v4, 7, v3
    v_add_u32 v10, s43, v3
    v_and_b32 v3, 1, v5
    v_lshlrev_b32 v3, 1, v3
    v_lshrrev_b32 v4, 1, v6
    v_or_b32 v3, v3, v4
    s_add_u32 s40, s42, 1
    v_xor_b32 v3, s40, v3
    v_lshlrev_b32 v3, 5, v3
    v_lshl_add_u32 v3, v7, 3, v3
    v_lshl_add_u32 v4, v5, 3, v6
    v_lshl_add_u32 v3, v4, 7, v3
    v_add_u32 v11, s43, v3
    v_and_b32 v3, 1, v5
    v_lshlrev_b32 v3, 1, v3
    v_lshrrev_b32 v4, 1, v6
    v_or_b32 v3, v3, v4
    s_add_u32 s40, s42, 2
    v_xor_b32 v3, s40, v3
    v_lshlrev_b32 v3, 5, v3
    v_lshl_add_u32 v3, v7, 3, v3
    v_lshl_add_u32 v4, v5, 3, v6
    v_lshl_add_u32 v3, v4, 7, v3
    v_add_u32 v12, s43, v3
    v_and_b32 v3, 1, v5
    v_lshlrev_b32 v3, 1, v3
    v_lshrrev_b32 v4, 1, v6
    v_or_b32 v3, v3, v4
    s_add_u32 s40, s42, 3
    v_xor_b32 v3, s40, v3
    v_lshlrev_b32 v3, 5, v3
    v_lshl_add_u32 v3, v7, 3, v3
    v_lshl_add_u32 v4, v5, 3, v6
    v_lshl_add_u32 v3, v4, 7, v3
    v_add_u32 v13, s43, v3
    s_mul_i32 s42, s45, 32
    v_lshrrev_b32 v3, 1, v8
    v_xor_b32 v3, v3, v5
    v_lshlrev_b32 v3, 4, v3
    v_lshl_add_u32 v3, v8, 7, v3
    s_lshl_b32 s40, s42, 7
    s_add_u32 s40, s40, 8192
    v_add_u32 v14, s40, v3
    v_xor_b32 v15, 64, v14
    v_mov_b32 v84, 0
    v_mov_b32 v85, 0
    v_mov_b32 v86, 0
    v_mov_b32 v87, 0
    v_mov_b32 v88, 0
    v_mov_b32 v89, 0
    v_mov_b32 v90, 0
    v_mov_b32 v91, 0
    v_mov_b32 v92, 0
    v_mov_b32 v93, 0
    v_mov_b32 v94, 0
    v_mov_b32 v95, 0
    v_mov_b32 v96, 0
    v_mov_b32 v97, 0
    v_mov_b32 v98, 0
    v_mov_b32 v99, 0
    v_mov_b32 v100, 0
    v_mov_b32 v101, 0
    v_mov_b32 v102, 0
    v_mov_b32 v103, 0
    v_mov_b32 v104, 0
    v_mov_b32 v105, 0
    v_mov_b32 v106, 0
    v_mov_b32 v107, 0
    s_mov_b32 s48, 16
    s_mov_b32 s50, 0
    s_mov_b32 s51, 24576
    s_mov_b32 s29, 0xfffee000
    s_waitcnt vmcnt(0)
    v_permlane16_swap_b32 v60, v62
    v_permlane16_swap_b32 v61, v63
    v_permlane16_swap_b32 v64, v66
    v_permlane16_swap_b32 v65, v67
    v_permlane16_swap_b32 v68, v70
    v_permlane16_swap_b32 v69, v71
    v_permlane16_swap_b32 v72, v74
    v_permlane16_swap_b32 v73, v75
    v_lshlrev_b32 v28, 16, v60
    v_and_b32 v29, 0xffff0000, v60
    v_lshlrev_b32 v30, 16, v61
    v_and_b32 v31, 0xffff0000, v61
    v_lshlrev_b32 v36, 16, v62
    v_and_b32 v37, 0xffff0000, v62
    v_lshlrev_b32 v38, 16, v63
    v_and_b32 v39, 0xffff0000, v63
    v_lshlrev_b32 v44, 16, v64
    v_and_b32 v45, 0xffff0000, v64
    v_lshlrev_b32 v46, 16, v65
    v_and_b32 v47, 0xffff0000, v65
    v_lshlrev_b32 v52, 16, v66
    v_and_b32 v53, 0xffff0000, v66
    v_lshlrev_b32 v54, 16, v67
    v_and_b32 v55, 0xffff0000, v67
    v_lshlrev_b32 v32, 16, v68
    v_and_b32 v33, 0xffff0000, v68
    v_lshlrev_b32 v34, 16, v69
    v_and_b32 v35, 0xffff0000, v69
    v_lshlrev_b32 v40, 16, v70
    v_and_b32 v41, 0xffff0000, v70
    v_lshlrev_b32 v42, 16, v71
    v_and_b32 v43, 0xffff0000, v71
    v_lshlrev_b32 v48, 16, v72
    v_and_b32 v49, 0xffff0000, v72
    v_lshlrev_b32 v50, 16, v73
    v_and_b32 v51, 0xffff0000, v73
    v_lshlrev_b32 v56, 16, v74
    v_and_b32 v57, 0xffff0000, v74
    v_lshlrev_b32 v58, 16, v75
    v_and_b32 v59, 0xffff0000, v75
.p2align 3
g2_cloop:
    s_barrier
g2_cloop2:
    v_mfma_f32_16x16x32_bf16 v[28:31], v[84:87], v[100:103], v[28:31]
    ds_read_b64_tr_b16 v[60:61], v10 offset:0
    ds_read_b64_tr_b16 v[62:63], v10 offset:512
    v_mfma_f32_16x16x32_bf16 v[32:35], v[84:87], v[104:107], v[32:35]
    ds_read_b128 v[76:79], v14 offset:0
    v_mfma_f32_16x16x32_bf16 v[36:39], v[88:91], v[100:103], v[36:39]
    ds_read_b128 v[80:83], v14 offset:2048
    v_mfma_f32_16x16x32_bf16 v[40:43], v[88:91], v[104:107], v[40:43]
    ds_read_b64_tr_b16 v[64:65], v11 offset:0
    ds_read_b64_tr_b16 v[66:67], v11 offset:512
    v_mfma_f32_16x16x32_bf16 v[44:47], v[92:95], v[100:103], v[44:47]
    ds_read_b64_tr_b16 v[68:69], v12 offset:0
    ds_read_b64_tr_b16 v[70:71], v12 offset:512
    v_mfma_f32_16x16x32_bf16 v[48:51], v[92:95], v[104:107], v[48:51]
    ds_read_b64_tr_b16 v[72:73], v13 offset:0
    ds_read_b64_tr_b16 v[74:75], v13 offset:512
    v_mfma_f32_16x16x32_bf16 v[52:55], v[96:99], v[100:103], v[52:55]
    v_mfma_f32_16x16x32_bf16 v[56:59], v[96:99], v[104:107], v[56:59]
    s_waitcnt lgkmcnt(0)
    v_mfma_f32_16x16x32_bf16 v[28:31], v[60:63], v[76:79], v[28:31]
    ds_read_b64_tr_b16 v[84:85], v10 offset:4096
    ds_read_b64_tr_b16 v[86:87], v10 offset:4608
    v_mfma_f32_16x16x32_bf16 v[32:35], v[60:63], v[80:83], v[32:35]
    ds_read_b128 v[100:103], v15 offset:0
    v_mfma_f32_16x16x32_bf16 v[36:39], v[64:67], v[76:79], v[36:39]
    ds_read_b128 v[104:107], v15 offset:2048
    v_mfma_f32_16x16x32_bf16 v[40:43], v[64:67], v[80:83], v[40:43]
    ds_read_b64_tr_b16 v[88:89], v11 offset:4096
    ds_read_b64_tr_b16 v[90:91], v11 offset:4608
    v_mfma_f32_16x16x32_bf16 v[44:47], v[68:71], v[76:79], v[44:47]
    ds_read_b64_tr_b16 v[92:93], v12 offset:4096
    ds_read_b64_tr_b16 v[94:95], v12 offset:4608
    v_mfma_f32_16x16x32_bf16 v[48:51], v[68:71], v[80:83], v[48:51]
    ds_read_b64_tr_b16 v[96:97], v13 offset:4096
    ds_read_b64_tr_b16 v[98:99], v13 offset:4608
    v_mfma_f32_16x16x32_bf16 v[52:55], v[72:75], v[76:79], v[52:55]
    s_add_u32 s50, s50, 1
    s_cmp_eq_u32 s50, 4
    v_mfma_f32_16x16x32_bf16 v[56:59], v[72:75], v[80:83], v[56:59]
    s_cselect_b32 s49, s29, s51
    s_cselect_b32 s50, 0, s50
    v_add_u32 v10, s49, v10
    v_add_u32 v11, s49, v11
    v_add_u32 v12, s49, v12
    v_add_u32 v13, s49, v13
    v_add_u32 v14, s49, v14
    v_add_u32 v15, s49, v15
    s_sub_u32 s48, s48, 1
    s_cmp_lg_u32 s48, 0
    s_waitcnt lgkmcnt(0)
    s_cbranch_scc1 g2_cloop
    v_mfma_f32_16x16x32_bf16 v[28:31], v[84:87], v[100:103], v[28:31]
    v_mfma_f32_16x16x32_bf16 v[32:35], v[84:87], v[104:107], v[32:35]
    v_mfma_f32_16x16x32_bf16 v[36:39], v[88:91], v[100:103], v[36:39]
    v_mfma_f32_16x16x32_bf16 v[40:43], v[88:91], v[104:107], v[40:43]
    v_mfma_f32_16x16x32_bf16 v[44:47], v[92:95], v[100:103], v[44:47]
    v_mfma_f32_16x16x32_bf16 v[48:51], v[92:95], v[104:107], v[48:51]
    v_mfma_f32_16x16x32_bf16 v[52:55], v[96:99], v[100:103], v[52:55]
    v_mfma_f32_16x16x32_bf16 v[56:59], v[96:99], v[104:107], v[56:59]
    s_nop 7
    v_pk_add_f32 v[76:77], v[28:29], v[30:31]
    v_pk_mul_f32 v[78:79], v[28:29], v[28:29]
    v_pk_fma_f32 v[78:79], v[30:31], v[30:31], v[78:79]
    v_pk_add_f32 v[76:77], v[76:77], v[36:37]
    v_pk_fma_f32 v[78:79], v[36:37], v[36:37], v[78:79]
    v_pk_add_f32 v[76:77], v[76:77], v[38:39]
    v_pk_fma_f32 v[78:79], v[38:39], v[38:39], v[78:79]
    v_pk_add_f32 v[76:77], v[76:77], v[44:45]
    v_pk_fma_f32 v[78:79], v[44:45], v[44:45], v[78:79]
    v_pk_add_f32 v[76:77], v[76:77], v[46:47]
    v_pk_fma_f32 v[78:79], v[46:47], v[46:47], v[78:79]
    v_pk_add_f32 v[76:77], v[76:77], v[52:53]
    v_pk_fma_f32 v[78:79], v[52:53], v[52:53], v[78:79]
    v_pk_add_f32 v[76:77], v[76:77], v[54:55]
    v_pk_fma_f32 v[78:79], v[54:55], v[54:55], v[78:79]
    v_pk_add_f32 v[80:81], v[32:33], v[34:35]
    v_pk_mul_f32 v[82:83], v[32:33], v[32:33]
    v_pk_fma_f32 v[82:83], v[34:35], v[34:35], v[82:83]
    v_pk_add_f32 v[80:81], v[80:81], v[40:41]
    v_pk_fma_f32 v[82:83], v[40:41], v[40:41], v[82:83]
    v_pk_add_f32 v[80:81], v[80:81], v[42:43]
    v_pk_fma_f32 v[82:83], v[42:43], v[42:43], v[82:83]
    v_pk_add_f32 v[80:81], v[80:81], v[48:49]
    v_pk_fma_f32 v[82:83], v[48:49], v[48:49], v[82:83]
    v_pk_add_f32 v[80:81], v[80:81], v[50:51]
    v_pk_fma_f32 v[82:83], v[50:51], v[50:51], v[82:83]
    v_pk_add_f32 v[80:81], v[80:81], v[56:57]
    v_pk_fma_f32 v[82:83], v[56:57], v[56:57], v[82:83]
    v_pk_add_f32 v[80:81], v[80:81], v[58:59]
    v_pk_fma_f32 v[82:83], v[58:59], v[58:59], v[82:83]
    v_add_f32 v76, v76, v77
    v_add_f32 v77, v78, v79
    v_add_f32 v80, v80, v81
    v_add_f32 v81, v82, v83
    s_nop 1
    v_permlane16_swap_b32 v76, v80
    v_permlane16_swap_b32 v77, v81
    v_pk_add_f32 v[76:77], v[76:77], v[80:81]
    v_mov_b32 v84, v76
    v_mov_b32 v85, v77
    v_and_b32 v3, 16, v2
    v_add_u32 v3, v3, v20
    v_permlane32_swap_b32 v76, v84
    v_permlane32_swap_b32 v77, v85
    v_pk_add_f32 v[76:77], v[76:77], v[84:85]
    v_lshlrev_b32 v3, 3, v3
    s_mul_i32 s40, s24, 1
    s_add_u32 s40, s40, s44
    s_lshl_b32 s40, s40, 14
    s_mov_b32 exec_hi, 0
    buffer_store_dwordx2 v[76:77], v3, s[60:63], s40 offen sc1
    s_mov_b32 exec_hi, -1
    v_lshrrev_b32 v4, 5, v2
    v_lshl_add_u32 v21, v4, 17, v3
    v_cvt_pk_bf16_f32 v60, v28, v29
    v_cvt_pk_bf16_f32 v61, v30, v31
    v_cvt_pk_bf16_f32 v62, v36, v37
    v_cvt_pk_bf16_f32 v63, v38, v39
    v_lshlrev_b32 v28, 16, v60
    v_and_b32 v29, 0xffff0000, v60
    v_lshlrev_b32 v30, 16, v61
    v_and_b32 v31, 0xffff0000, v61
    v_lshlrev_b32 v36, 16, v62
    v_and_b32 v37, 0xffff0000, v62
    v_lshlrev_b32 v38, 16, v63
    v_and_b32 v39, 0xffff0000, v63
    v_permlane16_swap_b32 v60, v62
    v_permlane16_swap_b32 v61, v63
    buffer_store_dwordx4 v[60:63], v9, s[16:19], s52 offen offset:0 sc1
    v_cvt_pk_bf16_f32 v64, v44, v45
    v_cvt_pk_bf16_f32 v65, v46, v47
    v_cvt_pk_bf16_f32 v66, v52, v53
    v_cvt_pk_bf16_f32 v67, v54, v55
    v_lshlrev_b32 v44, 16, v64
    v_and_b32 v45, 0xffff0000, v64
    v_lshlrev_b32 v46, 16, v65
    v_and_b32 v47, 0xffff0000, v65
    v_lshlrev_b32 v52, 16, v66
    v_and_b32 v53, 0xffff0000, v66
    v_lshlrev_b32 v54, 16, v67
    v_and_b32 v55, 0xffff0000, v67
    v_permlane16_swap_b32 v64, v66
    v_permlane16_swap_b32 v65, v67
    buffer_store_dwordx4 v[64:67], v9, s[16:19], s52 offen offset:64 sc1
    v_cvt_pk_bf16_f32 v68, v32, v33
    v_cvt_pk_bf16_f32 v69, v34, v35
    v_cvt_pk_bf16_f32 v70, v40, v41
    v_cvt_pk_bf16_f32 v71, v42, v43
    v_lshlrev_b32 v32, 16, v68
    v_and_b32 v33, 0xffff0000, v68
    v_lshlrev_b32 v34, 16, v69
    v_and_b32 v35, 0xffff0000, v69
    v_lshlrev_b32 v40, 16, v70
    v_and_b32 v41, 0xffff0000, v70
    v_lshlrev_b32 v42, 16, v71
    v_and_b32 v43, 0xffff0000, v71
    v_permlane16_swap_b32 v68, v70
    v_permlane16_swap_b32 v69, v71
    buffer_store_dwordx4 v[68:71], v9, s[16:19], s53 offen offset:0 sc1
    v_cvt_pk_bf16_f32 v72, v48, v49
    v_cvt_pk_bf16_f32 v73, v50, v51
    v_cvt_pk_bf16_f32 v74, v56, v57
    v_cvt_pk_bf16_f32 v75, v58, v59
    v_lshlrev_b32 v48, 16, v72
    v_and_b32 v49, 0xffff0000, v72
    v_lshlrev_b32 v50, 16, v73
    v_and_b32 v51, 0xffff0000, v73
    v_lshlrev_b32 v56, 16, v74
    v_and_b32 v57, 0xffff0000, v74
    v_lshlrev_b32 v58, 16, v75
    v_and_b32 v59, 0xffff0000, v75
    v_permlane16_swap_b32 v72, v74
    v_permlane16_swap_b32 v73, v75
    buffer_store_dwordx4 v[72:75], v9, s[16:19], s53 offen offset:64 sc1
    s_mov_b32 s48, 0x2000
    v_mul_u32_u24 v19, 256, v20
    v_add_u32 v19, v19, v9
    s_mov_b32 s54, 0
    s_mov_b32 s55, 36864
    s_mov_b32 s40, 0
    buffer_load_dwordx2 v[108:109], v21, s[60:63], s40 offen sc1
    s_mov_b32 s41, 16384
    buffer_load_dwordx2 v[110:111], v21, s[60:63], s41 offen sc1
    s_mov_b32 s40, 32768
    buffer_load_dwordx2 v[112:113], v21, s[60:63], s40 offen sc1
    s_mov_b32 s41, 49152
    buffer_load_dwordx2 v[114:115], v21, s[60:63], s41 offen sc1
    s_mov_b32 s40, 65536
    buffer_load_dwordx2 v[116:117], v21, s[60:63], s40 offen sc1
    s_mov_b32 s41, 81920
    buffer_load_dwordx2 v[118:119], v21, s[60:63], s41 offen sc1
    s_mov_b32 s40, 98304
    buffer_load_dwordx2 v[120:121], v21, s[60:63], s40 offen sc1
    s_mov_b32 s41, 114688
    buffer_load_dwordx2 v[122:123], v21, s[60:63], s41 offen sc1
    s_waitcnt vmcnt(0)
g2_ex:
    v_max3_u32 v4, v108, v109, v110
    v_max3_u32 v4, v4, v111, v112
    v_max3_u32 v4, v4, v113, v114
    v_max3_u32 v4, v4, v115, v116
    v_max3_u32 v4, v4, v117, v118
    v_max3_u32 v4, v4, v119, v120
    v_max3_u32 v4, v4, v121, v122
    v_max_u32 v4, v4, v123
    v_cmp_eq_u32 vcc, -1, v4
    s_sub_u32 s48, s48, 1
    s_cmp_eq_u32 s48, 0
    s_cbranch_scc1 g2_exd
    s_cbranch_vccz g2_exd
    s_sleep 2
    s_mov_b32 s40, 0
    buffer_load_dwordx2 v[108:109], v21, s[60:63], s40 offen sc1
    s_mov_b32 s41, 16384
    buffer_load_dwordx2 v[110:111], v21, s[60:63], s41 offen sc1
    s_mov_b32 s40, 32768
    buffer_load_dwordx2 v[112:113], v21, s[60:63], s40 offen sc1
    s_mov_b32 s41, 49152
    buffer_load_dwordx2 v[114:115], v21, s[60:63], s41 offen sc1
    s_mov_b32 s40, 65536
    buffer_load_dwordx2 v[116:117], v21, s[60:63], s40 offen sc1
    s_mov_b32 s41, 81920
    buffer_load_dwordx2 v[118:119], v21, s[60:63], s41 offen sc1
    s_mov_b32 s40, 98304
    buffer_load_dwordx2 v[120:121], v21, s[60:63], s40 offen sc1
    s_mov_b32 s41, 114688
    buffer_load_dwordx2 v[122:123], v21, s[60:63], s41 offen sc1
    s_waitcnt vmcnt(0)
    s_branch g2_ex
g2_exd:
    v_pk_add_f32 v[108:109], v[108:109], v[116:117]
    v_pk_add_f32 v[110:111], v[110:111], v[118:119]
    v_pk_add_f32 v[112:113], v[112:113], v[120:121]
    v_pk_add_f32 v[114:115], v[114:115], v[122:123]
    v_pk_add_f32 v[108:109], v[108:109], v[112:113]
    v_pk_add_f32 v[110:111], v[110:111], v[114:115]
    v_pk_add_f32 v[108:109], v[108:109], v[110:111]
    v_mov_b32 v110, v108
    v_mov_b32 v111, v109
    s_nop 1
    v_permlane32_swap_b32 v108, v110
    v_permlane32_swap_b32 v109, v111
    v_pk_add_f32 v[108:109], v[108:109], v[110:111]
    v_mul_f32 v108, 0x3a800000, v108
    v_mul_f32 v109, 0x3a800000, v109
    v_fma_f32 v109, -v108, v108, v109
    v_max_f32 v109, 0, v109
    v_mov_b32 v110, v108
    v_mov_b32 v111, v109
    v_cvt_pk_bf16_f32 v110, v110, v110
    v_lshlrev_b32 v110, 16, v110
    v_cvt_pk_bf16_f32 v111, v111, v111
    v_lshlrev_b32 v111, 16, v111
    v_add_f32 v111, 0x3727c5ac, v111
    v_cvt_pk_bf16_f32 v111, v111, v111
    v_lshlrev_b32 v111, 16, v111
    v_sqrt_f32 v111, v111
    s_nop 0
    v_cvt_pk_bf16_f32 v111, v111, v111
    v_lshlrev_b32 v111, 16, v111
    v_rcp_f32 v111, v111
    v_sub_f32 v112, v108, v110
    v_mul_f32 v113, v109, v111
    v_mul_f32 v112, v112, v111
    v_mul_f32 v113, v113, v111
    v_cvt_pk_bf16_f32 v112, v112, v112
    v_lshlrev_b32 v112, 16, v112
    v_cvt_pk_bf16_f32 v113, v113, v113
    v_lshlrev_b32 v113, 16, v113
    v_add_f32 v113, 0x3727c5ac, v113
    v_cvt_pk_bf16_f32 v113, v113, v113
    v_lshlrev_b32 v113, 16, v113
    v_sqrt_f32 v113, v113
    s_nop 0
    v_cvt_pk_bf16_f32 v113, v113, v113
    v_lshlrev_b32 v113, 16, v113
    v_rcp_f32 v113, v113
    v_fma_f32 v112, v110, v111, v112
    v_mul_f32 v114, v111, v113
    v_mul_f32 v115, -v112, v113
    v_mov_b32 v116, v114
    v_mov_b32 v117, v115
    s_nop 1
    v_permlane16_swap_b32 v114, v116
    v_permlane16_swap_b32 v115, v117
    v_pk_fma_f32 v[28:29], v[28:29], v[114:115], v[114:115] op_sel:[0,0,1] op_sel_hi:[1,0,1]
    v_pk_fma_f32 v[30:31], v[30:31], v[114:115], v[114:115] op_sel:[0,0,1] op_sel_hi:[1,0,1]
    v_pk_fma_f32 v[36:37], v[36:37], v[114:115], v[114:115] op_sel:[0,0,1] op_sel_hi:[1,0,1]
    v_pk_fma_f32 v[38:39], v[38:39], v[114:115], v[114:115] op_sel:[0,0,1] op_sel_hi:[1,0,1]
    v_cvt_pk_bf16_f32 v60, v28, v29
    v_cvt_pk_bf16_f32 v61, v30, v31
    v_cvt_pk_bf16_f32 v62, v36, v37
    v_cvt_pk_bf16_f32 v63, v38, v39
    s_nop 1
    v_permlane16_swap_b32 v60, v62
    v_permlane16_swap_b32 v61, v63
    buffer_store_dwordx4 v[60:63], v19, s[56:59], s54 offen offset:0 sc1
    v_pk_fma_f32 v[44:45], v[44:45], v[114:115], v[114:115] op_sel:[0,0,1] op_sel_hi:[1,0,1]
    v_pk_fma_f32 v[46:47], v[46:47], v[114:115], v[114:115] op_sel:[0,0,1] op_sel_hi:[1,0,1]
    v_pk_fma_f32 v[52:53], v[52:53], v[114:115], v[114:115] op_sel:[0,0,1] op_sel_hi:[1,0,1]
    v_pk_fma_f32 v[54:55], v[54:55], v[114:115], v[114:115] op_sel:[0,0,1] op_sel_hi:[1,0,1]
    v_cvt_pk_bf16_f32 v64, v44, v45
    v_cvt_pk_bf16_f32 v65, v46, v47
    v_cvt_pk_bf16_f32 v66, v52, v53
    v_cvt_pk_bf16_f32 v67, v54, v55
    s_nop 1
    v_permlane16_swap_b32 v64, v66
    v_permlane16_swap_b32 v65, v67
    buffer_store_dwordx4 v[64:67], v19, s[56:59], s54 offen offset:64 sc1
    v_pk_fma_f32 v[32:33], v[32:33], v[116:117], v[116:117] op_sel:[0,0,1] op_sel_hi:[1,0,1]
    v_pk_fma_f32 v[34:35], v[34:35], v[116:117], v[116:117] op_sel:[0,0,1] op_sel_hi:[1,0,1]
    v_pk_fma_f32 v[40:41], v[40:41], v[116:117], v[116:117] op_sel:[0,0,1] op_sel_hi:[1,0,1]
    v_pk_fma_f32 v[42:43], v[42:43], v[116:117], v[116:117] op_sel:[0,0,1] op_sel_hi:[1,0,1]
    v_cvt_pk_bf16_f32 v68, v32, v33
    v_cvt_pk_bf16_f32 v69, v34, v35
    v_cvt_pk_bf16_f32 v70, v40, v41
    v_cvt_pk_bf16_f32 v71, v42, v43
    s_nop 1
    v_permlane16_swap_b32 v68, v70
    v_permlane16_swap_b32 v69, v71
    buffer_store_dwordx4 v[68:71], v19, s[56:59], s55 offen offset:0 sc1
    v_pk_fma_f32 v[48:49], v[48:49], v[116:117], v[116:117] op_sel:[0,0,1] op_sel_hi:[1,0,1]
    v_pk_fma_f32 v[50:51], v[50:51], v[116:117], v[116:117] op_sel:[0,0,1] op_sel_hi:[1,0,1]
    v_pk_fma_f32 v[56:57], v[56:57], v[116:117], v[116:117] op_sel:[0,0,1] op_sel_hi:[1,0,1]
    v_pk_fma_f32 v[58:59], v[58:59], v[116:117], v[116:117] op_sel:[0,0,1] op_sel_hi:[1,0,1]
    v_cvt_pk_bf16_f32 v72, v48, v49
    v_cvt_pk_bf16_f32 v73, v50, v51
    v_cvt_pk_bf16_f32 v74, v56, v57
    v_cvt_pk_bf16_f32 v75, v58, v59
    s_nop 1
    v_permlane16_swap_b32 v72, v74
    v_permlane16_swap_b32 v73, v75
    buffer_store_dwordx4 v[72:75], v19, s[56:59], s55 offen offset:64 sc1
    s_endpgm
.section .rodata,"a"
.p2align 6
.amdhsa_kernel g2a_kernel
  .amdhsa_next_free_vgpr 124
  .amdhsa_next_free_sgpr 96
  .amdhsa_accum_offset 124
  .amdhsa_group_segment_fixed_size 0
  .amdhsa_kernarg_size 88
  .amdhsa_user_sgpr_count 2
  .amdhsa_user_sgpr_kernarg_segment_ptr 1
  .amdhsa_system_sgpr_workgroup_id_x 1
.end_amdhsa_kernel
.section .rodata,"a"
.p2align 6
.amdhsa_kernel g2b_kernel
  .amdhsa_next_free_vgpr 124
  .amdhsa_next_free_sgpr 96
  .amdhsa_accum_offset 124
  .amdhsa_group_segment_fixed_size 0
  .amdhsa_kernarg_size 88
  .amdhsa_user_sgpr_count 2
  .amdhsa_user_sgpr_kernarg_segment_ptr 1
  .amdhsa_system_sgpr_workgroup_id_x 1
.end_amdhsa_kernel
.text
.globl g3a_kernel
.p2align 8
.type g3a_kernel,@function
g3a_kernel:
    s_mov_b32 s47, 256
    s_mov_b32 s95, 3
    s_mov_b32 s93, 0
    s_branch g3_body
.text
.globl g3b_kernel
.p2align 8
.type g3b_kernel,@function
g3b_kernel:
    s_mov_b32 s47, 224
    s_mov_b32 s95, 1
    s_mov_b32 s93, 0
    s_branch g3_body
.p2align 6
g3_body:
    s_cmp_ge_u32 s2, 224
    s_cbranch_scc1 g3_spare
    s_load_dwordx2 s[4:5], s[0:1], 80
    s_load_dwordx2 s[30:31], s[0:1], 32
    s_load_dwordx2 s[6:7], s[0:1], 40
    v_lshrrev_b32 v1, 6, v0
    v_and_b32 v2, 63, v0
    s_and_b32 s40, s2, 1
    s_lshl_b32 s40, s40, 2
    s_bfe_u32 s41, s2, 0x20003
    s_add_u32 s25, s40, s41
    s_bfe_u32 s40, s2, 0x20001
    s_mul_i32 s40, s40, 7
    s_lshr_b32 s42, s2, 5
    s_add_u32 s24, s40, s42
    s_add_u32 s27, s41, s42
    s_mov_b32 s26, 0
    v_readfirstlane_b32 s28, v1
    s_nop 0
    s_cmp_lt_u32 s28, 4
    s_cbranch_scc1 g3_compute
    s_sub_u32 s28, s28, 4
    s_mov_b32 s40, 7168
    v_lshrrev_b32 v4, 4, v2
    v_mul_lo_u32 v3, v4, s40
    v_lshlrev_b32 v4, 1, v4
    v_xor_b32 v4, v4, v2
    v_and_b32 v4, 15, v4
    v_lshl_add_u32 v3, v4, 4, v3
    s_mul_i32 s41, s24, 256
    s_mul_i32 s42, s28, 114688
    s_add_u32 s41, s41, s42
    v_xor_b32 v4, 128, v3
    s_add_u32 s42, s41, 0
    v_add_u32 v10, s42, v3
    s_add_u32 s42, s41, 28672
    v_add_u32 v11, s42, v3
    s_add_u32 s42, s41, 57344
    v_add_u32 v12, s42, v4
    s_add_u32 s42, s41, 86016
    v_add_u32 v13, s42, v4
    s_mov_b32 s40, 2304
    v_lshrrev_b32 v4, 4, v2
    v_mul_lo_u32 v3, v4, s40
    v_lshlrev_b32 v4, 1, v4
    v_xor_b32 v4, v4, v2
    v_and_b32 v4, 15, v4
    v_lshl_add_u32 v3, v4, 4, v3
    s_mul_i32 s41, s25, 256
    s_mul_i32 s42, s28, 36864
    s_add_u32 s41, s41, s42
    v_xor_b32 v4, 128, v3
    s_add_u32 s42, s41, 0
    v_add_u32 v14, s42, v3
    s_add_u32 s42, s41, 9216
    v_add_u32 v15, s42, v3
    s_add_u32 s42, s41, 18432
    v_add_u32 v16, s42, v4
    s_add_u32 s42, s41, 27648
    v_add_u32 v17, s42, v4
    s_mul_i32 s36, s28, 4096
    s_mul_i32 s37, s28, 4096
    s_add_u32 s37, s37, 16384
    s_waitcnt lgkmcnt(0)
    s_mov_b32 s8, s30
    s_mov_b32 s9, s31
    s_mov_b32 s10, 0xe00000
    s_mov_b32 s11, 0x20000
    s_add_u32 s12, s4, 0xc00000
    s_addc_u32 s13, s5, 0
    s_mov_b32 s14, 0x480000
    s_mov_b32 s15, 0x20000
    s_mov_b32 s32, 0
    s_mov_b32 s33, 0
g3_ld_loop:
    s_cmp_lt_u32 s32, 3
    s_cbranch_scc1 g3_ld_issue
    s_waitcnt vmcnt(16)
g3_ld_bar:
    s_barrier
g3_ld_issue:
    s_add_u32 s40, s32, s27
    s_and_b32 s40, s40, s95
    s_andn2_b32 s41, s32, s95
    s_or_b32 s40, s40, s41
    s_add_u32 s40, s40, s26
    s_mul_i32 s34, s40, 458752
    s_mul_i32 s35, s40, 147456
    s_add_u32 s38, s33, s36
    s_add_u32 s39, s33, s37
    s_add_u32 m0, s38, 0
    s_nop 0
    buffer_load_dwordx4 v10, s[8:11], s34 offen lds
    s_add_u32 m0, s38, 1024
    s_nop 0
    buffer_load_dwordx4 v11, s[8:11], s34 offen lds
    s_add_u32 m0, s38, 2048
    s_nop 0
    buffer_load_dwordx4 v12, s[8:11], s34 offen lds
    s_add_u32 m0, s38, 3072
    s_nop 0
    buffer_load_dwordx4 v13, s[8:11], s34 offen lds
    s_add_u32 m0, s39, 0
    s_nop 0
    buffer_load_dwordx4 v14, s[12:15], s35 offen lds
    s_add_u32 m0, s39, 1024
    s_nop 0
    buffer_load_dwordx4 v15, s[12:15], s35 offen lds
    s_add_u32 m0, s39, 2048
    s_nop 0
    buffer_load_dwordx4 v16, s[12:15], s35 offen lds
    s_add_u32 m0, s39, 3072
    s_nop 0
    buffer_load_dwordx4 v17, s[12:15], s35 offen lds
    s_add_u32 s33, s33, 32768
    s_cmp_eq_u32 s33, 131072
    s_cselect_b32 s33, 0, s33
    s_add_u32 s32, s32, 1
    s_cmp_lt_u32 s32, 32
    s_cbranch_scc1 g3_ld_loop
    s_waitcnt vmcnt(16)
    s_barrier
    s_waitcnt vmcnt(8)
    s_barrier
    s_waitcnt vmcnt(0)
    s_barrier
g3_done:
    s_endpgm
g3_compute:
    v_lshrrev_b32 v5, 4, v2
    v_bfe_u32 v6, v2, 2, 2
    v_and_b32 v7, 3, v2
    v_and_b32 v8, 15, v2
    s_and_b32 s44, s28, 1
    s_lshr_b32 s45, s28, 1
    s_mul_i32 s40, s25, 128
    s_mul_i32 s41, s45, 64
    s_add_u32 s40, s40, s41
    v_add_u32 v20, s40, v8
    s_mov_b32 s41, 8192
    v_mul_lo_u32 v9, v20, s41
    s_mul_i32 s40, s24, 256
    s_mul_i32 s41, s44, 128
    s_add_u32 s46, s40, s41
    v_and_b32 v3, 1, v5
    v_lshlrev_b32 v3, 5, v3
    v_lshrrev_b32 v4, 1, v5
    v_lshl_add_u32 v3, v4, 4, v3
    v_add3_u32 v9, v9, v3, s46
    s_mov_b32 s52, 0
    s_mov_b32 s53, 131072
    s_mov_b32 s54, 262144
    s_mov_b32 s55, 393216
    s_waitcnt lgkmcnt(0)
    s_mov_b32 s20, s6
    s_mov_b32 s21, s7
    s_mov_b32 s22, 0x1c00
    s_mov_b32 s23, 0x20000
    s_add_u32 s16, s4, 0x1100000
    s_addc_u32 s17, s5, 0
    s_mov_b32 s18, 0x800000
    s_mov_b32 s19, 0x20000
    v_lshl_add_u32 v3, v5, 3, s46
    buffer_load_dwordx2 v[92:93], v3, s[20:23], 0 offen offset:0
    buffer_load_dwordx2 v[94:95], v3, s[20:23], 0 offen offset:32
    buffer_load_dwordx2 v[96:97], v3, s[20:23], 0 offen offset:64
    buffer_load_dwordx2 v[98:99], v3, s[20:23], 0 offen offset:96
    s_mul_i32 s42, s44, 4
    s_mov_b32 s43, 0
    v_and_b32 v3, 1, v5
    v_lshl_or_b32 v3, v3, 2, v6
    s_add_u32 s40, s42, 0
    v_xor_b32 v3, s40, v3
    v_lshlrev_b32 v3, 5, v3
    v_lshl_add_u32 v3, v7, 3, v3
    v_lshl_add_u32 v4, v5, 3, v6
    v_lshl_add_u32 v3, v4, 8, v3
    v_add_u32 v10, s43, v3
    v_and_b32 v3, 1, v5
    v_lshl_or_b32 v3, v3, 2, v6
    s_add_u32 s40, s42, 1
    v_xor_b32 v3, s40, v3
    v_lshlrev_b32 v3, 5, v3
    v_lshl_add_u32 v3, v7, 3, v3
    v_lshl_add_u32 v4, v5, 3, v6
    v_lshl_add_u32 v3, v4, 8, v3
    v_add_u32 v11, s43, v3
    v_and_b32 v3, 1, v5
    v_lshl_or_b32 v3, v3, 2, v6
    s_add_u32 s40, s42, 2
    v_xor_b32 v3, s40, v3
    v_lshlrev_b32 v3, 5, v3
    v_lshl_add_u32 v3, v7, 3, v3
    v_lshl_add_u32 v4, v5, 3, v6
    v_lshl_add_u32 v3, v4, 8, v3
    v_add_u32 v12, s43, v3
    v_and_b32 v3, 1, v5
    v_lshl_or_b32 v3, v3, 2, v6
    s_add_u32 s40, s42, 3
    v_xor_b32 v3, s40, v3
    v_lshlrev_b32 v3, 5, v3
    v_lshl_add_u32 v3, v7, 3, v3
    v_lshl_add_u32 v4, v5, 3, v6
    v_lshl_add_u32 v3, v4, 8, v3
    v_add_u32 v13, s43, v3
    s_mul_i32 s42, s45, 4
    s_mov_b32 s43, 16384
    v_and_b32 v3, 1, v5
    v_lshl_or_b32 v3, v3, 2, v6
    s_add_u32 s40, s42, 0
    v_xor_b32 v3, s40, v3
    v_lshlrev_b32 v3, 5, v3
    v_lshl_add_u32 v3, v7, 3, v3
    v_lshl_add_u32 v4, v5, 3, v6
    v_lshl_add_u32 v3, v4, 8, v3
    v_add_u32 v14, s43, v3
    v_and_b32 v3, 1, v5
    v_lshl_or_b32 v3, v3, 2, v6
    s_add_u32 s40, s42, 1
    v_xor_b32 v3, s40, v3
    v_lshlrev_b32 v3, 5, v3
    v_lshl_add_u32 v3, v7, 3, v3
    v_lshl_add_u32 v4, v5, 3, v6
    v_lshl_add_u32 v3, v4, 8, v3
    v_add_u32 v15, s43, v3
    v_and_b32 v3, 1, v5
    v_lshl_or_b32 v3, v3, 2, v6
    s_add_u32 s40, s42, 2
    v_xor_b32 v3, s40, v3
    v_lshlrev_b32 v3, 5, v3
    v_lshl_add_u32 v3, v7, 3, v3
    v_lshl_add_u32 v4, v5, 3, v6
    v_lshl_add_u32 v3, v4, 8, v3
    v_add_u32 v16, s43, v3
    v_and_b32 v3, 1, v5
    v_lshl_or_b32 v3, v3, 2, v6
    s_add_u32 s40, s42, 3
    v_xor_b32 v3, s40, v3
    v_lshlrev_b32 v3, 5, v3
    v_lshl_add_u32 v3, v7, 3, v3
    v_lshl_add_u32 v4, v5, 3, v6
    v_lshl_add_u32 v3, v4, 8, v3
    v_add_u32 v17, s43, v3
    v_mov_b32 v124, 0
    v_mov_b32 v125, 0
    v_mov_b32 v126, 0
    v_mov_b32 v127, 0
    v_mov_b32 v128, 0
    v_mov_b32 v129, 0
    v_mov_b32 v130, 0
    v_mov_b32 v131, 0
    v_mov_b32 v132, 0
    v_mov_b32 v133, 0
    v_mov_b32 v134, 0
    v_mov_b32 v135, 0
    v_mov_b32 v136, 0
    v_mov_b32 v137, 0
    v_mov_b32 v138, 0
    v_mov_b32 v139, 0
    v_mov_b32 v140, 0
    v_mov_b32 v141, 0
    v_mov_b32 v142, 0
    v_mov_b32 v143, 0
    v_mov_b32 v144, 0
    v_mov_b32 v145, 0
    v_mov_b32 v146, 0
    v_mov_b32 v147, 0
    v_mov_b32 v148, 0
    v_mov_b32 v149, 0
    v_mov_b32 v150, 0
    v_mov_b32 v151, 0
    v_mov_b32 v152, 0
    v_mov_b32 v153, 0
    v_mov_b32 v154, 0
    v_mov_b32 v155, 0
    s_mov_b32 s48, 32
    s_mov_b32 s50, 0
    s_mov_b32 s51, 32768
    s_mov_b32 s29, 0xfffe8000
    s_waitcnt vmcnt(0)
    v_lshlrev_b32 v28, 16, v92
    v_and_b32 v29, 0xffff0000, v92
    v_lshlrev_b32 v30, 16, v93
    v_and_b32 v31, 0xffff0000, v93
    v_lshlrev_b32 v32, 16, v92
    v_and_b32 v33, 0xffff0000, v92
    v_lshlrev_b32 v34, 16, v93
    v_and_b32 v35, 0xffff0000, v93
    v_lshlrev_b32 v36, 16, v92
    v_and_b32 v37, 0xffff0000, v92
    v_lshlrev_b32 v38, 16, v93
    v_and_b32 v39, 0xffff0000, v93
    v_lshlrev_b32 v40, 16, v92
    v_and_b32 v41, 0xffff0000, v92
    v_lshlrev_b32 v42, 16, v93
    v_and_b32 v43, 0xffff0000, v93
    v_lshlrev_b32 v44, 16, v94
    v_and_b32 v45, 0xffff0000, v94
    v_lshlrev_b32 v46, 16, v95
    v_and_b32 v47, 0xffff0000, v95
    v_lshlrev_b32 v48, 16, v94
    v_and_b32 v49, 0xffff0000, v94
    v_lshlrev_b32 v50, 16, v95
    v_and_b32 v51, 0xffff0000, v95
    v_lshlrev_b32 v52, 16, v94
    v_and_b32 v53, 0xffff0000, v94
    v_lshlrev_b32 v54, 16, v95
    v_and_b32 v55, 0xffff0000, v95
    v_lshlrev_b32 v56, 16, v94
    v_and_b32 v57, 0xffff0000, v94
    v_lshlrev_b32 v58, 16, v95
    v_and_b32 v59, 0xffff0000, v95
    v_lshlrev_b32 v60, 16, v96
    v_and_b32 v61, 0xffff0000, v96
    v_lshlrev_b32 v62, 16, v97
    v_and_b32 v63, 0xffff0000, v97
    v_lshlrev_b32 v64, 16, v96
    v_and_b32 v65, 0xffff0000, v96
    v_lshlrev_b32 v66, 16, v97
    v_and_b32 v67, 0xffff0000, v97
    v_lshlrev_b32 v68, 16, v96
    v_and_b32 v69, 0xffff0000, v96
    v_lshlrev_b32 v70, 16, v97
    v_and_b32 v71, 0xffff0000, v97
    v_lshlrev_b32 v72, 16, v96
    v_and_b32 v73, 0xffff0000, v96
    v_lshlrev_b32 v74, 16, v97
    v_and_b32 v75, 0xffff0000, v97
    v_lshlrev_b32 v76, 16, v98
    v_and_b32 v77, 0xffff0000, v98
    v_lshlrev_b32 v78, 16, v99
    v_and_b32 v79, 0xffff0000, v99
    v_lshlrev_b32 v80, 16, v98
    v_and_b32 v81, 0xffff0000, v98
    v_lshlrev_b32 v82, 16, v99
    v_and_b32 v83, 0xffff0000, v99
    v_lshlrev_b32 v84, 16, v98
    v_and_b32 v85, 0xffff0000, v98
    v_lshlrev_b32 v86, 16, v99
    v_and_b32 v87, 0xffff0000, v99
    v_lshlrev_b32 v88, 16, v98
    v_and_b32 v89, 0xffff0000, v98
    v_lshlrev_b32 v90, 16, v99
    v_and_b32 v91, 0xffff0000, v99
.p2align 3
g3_cloop:
    s_barrier
g3_cloop2:
    v_mfma_f32_16x16x32_bf16 v[28:31], v[124:127], v[140:143], v[28:31]
    ds_read_b64_tr_b16 v[92:93], v10 offset:0
    ds_read_b64_tr_b16 v[94:95], v10 offset:1024
    v_mfma_f32_16x16x32_bf16 v[32:35], v[124:127], v[144:147], v[32:35]
    ds_read_b64_tr_b16 v[108:109], v14 offset:0
    ds_read_b64_tr_b16 v[110:111], v14 offset:1024
    v_mfma_f32_16x16x32_bf16 v[36:39], v[124:127], v[148:151], v[36:39]
    ds_read_b64_tr_b16 v[112:113], v15 offset:0
    ds_read_b64_tr_b16 v[114:115], v15 offset:1024
    v_mfma_f32_16x16x32_bf16 v[40:43], v[124:127], v[152:155], v[40:43]
    ds_read_b64_tr_b16 v[116:117], v16 offset:0
    ds_read_b64_tr_b16 v[118:119], v16 offset:1024
    v_mfma_f32_16x16x32_bf16 v[44:47], v[128:131], v[140:143], v[44:47]
    ds_read_b64_tr_b16 v[120:121], v17 offset:0
    ds_read_b64_tr_b16 v[122:123], v17 offset:1024
    v_mfma_f32_16x16x32_bf16 v[48:51], v[128:131], v[144:147], v[48:51]
    ds_read_b64_tr_b16 v[96:97], v11 offset:0
    ds_read_b64_tr_b16 v[98:99], v11 offset:1024
    v_mfma_f32_16x16x32_bf16 v[52:55], v[128:131], v[148:151], v[52:55]
    ds_read_b64_tr_b16 v[100:101], v12 offset:0
    ds_read_b64_tr_b16 v[102:103], v12 offset:1024
    v_mfma_f32_16x16x32_bf16 v[56:59], v[128:131], v[152:155], v[56:59]
    ds_read_b64_tr_b16 v[104:105], v13 offset:0
    ds_read_b64_tr_b16 v[106:107], v13 offset:1024
    v_mfma_f32_16x16x32_bf16 v[60:63], v[132:135], v[140:143], v[60:63]
    v_mfma_f32_16x16x32_bf16 v[64:67], v[132:135], v[144:147], v[64:67]
    v_mfma_f32_16x16x32_bf16 v[68:71], v[132:135], v[148:151], v[68:71]
    v_mfma_f32_16x16x32_bf16 v[72:75], v[132:135], v[152:155], v[72:75]
    v_mfma_f32_16x16x32_bf16 v[76:79], v[136:139], v[140:143], v[76:79]
    v_mfma_f32_16x16x32_bf16 v[80:83], v[136:139], v[144:147], v[80:83]
    v_mfma_f32_16x16x32_bf16 v[84:87], v[136:139], v[148:151], v[84:87]
    v_mfma_f32_16x16x32_bf16 v[88:91], v[136:139], v[152:155], v[88:91]
    s_waitcnt lgkmcnt(0)
    v_mfma_f32_16x16x32_bf16 v[28:31], v[92:95], v[108:111], v[28:31]
    ds_read_b64_tr_b16 v[124:125], v10 offset:8192
    ds_read_b64_tr_b16 v[126:127], v10 offset:9216
    v_mfma_f32_16x16x32_bf16 v[32:35], v[92:95], v[112:115], v[32:35]
    ds_read_b64_tr_b16 v[140:141], v14 offset:8192
    ds_read_b64_tr_b16 v[142:143], v14 offset:9216
    v_mfma_f32_16x16x32_bf16 v[36:39], v[92:95], v[116:119], v[36:39]
    ds_read_b64_tr_b16 v[144:145], v15 offset:8192
    ds_read_b64_tr_b16 v[146:147], v15 offset:9216
    v_mfma_f32_16x16x32_bf16 v[40:43], v[92:95], v[120:123], v[40:43]
    ds_read_b64_tr_b16 v[148:149], v16 offset:8192
    ds_read_b64_tr_b16 v[150:151], v16 offset:9216
    v_mfma_f32_16x16x32_bf16 v[44:47], v[96:99], v[108:111], v[44:47]
    ds_read_b64_tr_b16 v[152:153], v17 offset:8192
    ds_read_b64_tr_b16 v[154:155], v17 offset:9216
    v_mfma_f32_16x16x32_bf16 v[48:51], v[96:99], v[112:115], v[48:51]
    ds_read_b64_tr_b16 v[128:129], v11 offset:8192
    ds_read_b64_tr_b16 v[130:131], v11 offset:9216
    v_mfma_f32_16x16x32_bf16 v[52:55], v[96:99], v[116:119], v[52:55]
    ds_read_b64_tr_b16 v[132:133], v12 offset:8192
    ds_read_b64_tr_b16 v[134:135], v12 offset:9216
    v_mfma_f32_16x16x32_bf16 v[56:59], v[96:99], v[120:123], v[56:59]
    ds_read_b64_tr_b16 v[136:137], v13 offset:8192
    ds_read_b64_tr_b16 v[138:139], v13 offset:9216
    v_mfma_f32_16x16x32_bf16 v[60:63], v[100:103], v[108:111], v[60:63]
    s_add_u32 s50, s50, 1
    s_cmp_eq_u32 s50, 4
    v_mfma_f32_16x16x32_bf16 v[64:67], v[100:103], v[112:115], v[64:67]
    s_cselect_b32 s49, s29, s51
    s_cselect_b32 s50, 0, s50
    v_mfma_f32_16x16x32_bf16 v[68:71], v[100:103], v[116:119], v[68:71]
    v_add_u32 v10, s49, v10
    v_add_u32 v11, s49, v11
    v_mfma_f32_16x16x32_bf16 v[72:75], v[100:103], v[120:123], v[72:75]
    v_add_u32 v12, s49, v12
    v_add_u32 v13, s49, v13
    v_mfma_f32_16x16x32_bf16 v[76:79], v[104:107], v[108:111], v[76:79]
    v_add_u32 v14, s49, v14
    v_add_u32 v15, s49, v15
    v_mfma_f32_16x16x32_bf16 v[80:83], v[104:107], v[112:115], v[80:83]
    v_add_u32 v16, s49, v16
    v_add_u32 v17, s49, v17
    v_mfma_f32_16x16x32_bf16 v[84:87], v[104:107], v[116:119], v[84:87]
    s_sub_u32 s48, s48, 1
    s_cmp_lg_u32 s48, 0
    v_mfma_f32_16x16x32_bf16 v[88:91], v[104:107], v[120:123], v[88:91]
    s_waitcnt lgkmcnt(0)
    s_cbranch_scc1 g3_cloop
    v_mfma_f32_16x16x32_bf16 v[28:31], v[124:127], v[140:143], v[28:31]
    v_mfma_f32_16x16x32_bf16 v[32:35], v[124:127], v[144:147], v[32:35]
    v_mfma_f32_16x16x32_bf16 v[36:39], v[124:127], v[148:151], v[36:39]
    v_mfma_f32_16x16x32_bf16 v[40:43], v[124:127], v[152:155], v[40:43]
    v_mfma_f32_16x16x32_bf16 v[44:47], v[128:131], v[140:143], v[44:47]
    v_mfma_f32_16x16x32_bf16 v[48:51], v[128:131], v[144:147], v[48:51]
    v_mfma_f32_16x16x32_bf16 v[52:55], v[128:131], v[148:151], v[52:55]
    v_mfma_f32_16x16x32_bf16 v[56:59], v[128:131], v[152:155], v[56:59]
    v_mfma_f32_16x16x32_bf16 v[60:63], v[132:135], v[140:143], v[60:63]
    v_mfma_f32_16x16x32_bf16 v[64:67], v[132:135], v[144:147], v[64:67]
    v_mfma_f32_16x16x32_bf16 v[68:71], v[132:135], v[148:151], v[68:71]
    v_mfma_f32_16x16x32_bf16 v[72:75], v[132:135], v[152:155], v[72:75]
    v_mfma_f32_16x16x32_bf16 v[76:79], v[136:139], v[140:143], v[76:79]
    v_mfma_f32_16x16x32_bf16 v[80:83], v[136:139], v[144:147], v[80:83]
    v_mfma_f32_16x16x32_bf16 v[84:87], v[136:139], v[148:151], v[84:87]
    v_mfma_f32_16x16x32_bf16 v[88:91], v[136:139], v[152:155], v[88:91]
    v_mov_b32 v10, 0xbdd2d3e8
    v_mov_b32 v11, 0xbdd2d3e8
    v_mov_b32 v12, 0xc0135761
    v_mov_b32 v13, 0xc0135761
    v_mov_b32 v14, 0x3f800000
    v_mov_b32 v15, 0x3f800000
    s_nop 7
    v_pk_mul_f32 v[108:109], v[28:29], v[28:29]
    v_pk_mul_f32 v[110:111], v[30:31], v[30:31]
    v_pk_mul_f32 v[112:113], v[44:45], v[44:45]
    v_pk_mul_f32 v[114:115], v[46:47], v[46:47]
    v_pk_fma_f32 v[108:109], v[108:109], v[10:11], v[12:13]
    v_pk_fma_f32 v[110:111], v[110:111], v[10:11], v[12:13]
    v_pk_fma_f32 v[112:113], v[112:113], v[10:11], v[12:13]
    v_pk_fma_f32 v[114:115], v[114:115], v[10:11], v[12:13]
    v_pk_mul_f32 v[108:109], v[108:109], v[28:29]
    v_pk_mul_f32 v[110:111], v[110:111], v[30:31]
    v_pk_mul_f32 v[112:113], v[112:113], v[44:45]
    v_pk_mul_f32 v[114:115], v[114:115], v[46:47]
    v_exp_f32 v108, v108
    v_exp_f32 v109, v109
    v_exp_f32 v110, v110
    v_exp_f32 v111, v111
    v_exp_f32 v112, v112
    v_exp_f32 v113, v113
    v_exp_f32 v114, v114
    v_exp_f32 v115, v115
    v_pk_add_f32 v[108:109], v[108:109], v[14:15]
    v_pk_add_f32 v[110:111], v[110:111], v[14:15]
    v_pk_add_f32 v[112:113], v[112:113], v[14:15]
    v_pk_add_f32 v[114:115], v[114:115], v[14:15]
    v_rcp_f32 v108, v108
    v_rcp_f32 v109, v109
    v_rcp_f32 v110, v110
    v_rcp_f32 v111, v111
    v_rcp_f32 v112, v112
    v_rcp_f32 v113, v113
    v_rcp_f32 v114, v114
    v_rcp_f32 v115, v115
    v_pk_mul_f32 v[28:29], v[28:29], v[108:109]
    v_pk_mul_f32 v[30:31], v[30:31], v[110:111]
    v_pk_mul_f32 v[44:45], v[44:45], v[112:113]
    v_pk_mul_f32 v[46:47], v[46:47], v[114:115]
    v_cvt_pk_bf16_f32 v92, v28, v29
    v_cvt_pk_bf16_f32 v93, v30, v31
    v_cvt_pk_bf16_f32 v94, v44, v45
    v_cvt_pk_bf16_f32 v95, v46, v47
    s_nop 1
    v_permlane16_swap_b32 v92, v94
    v_permlane16_swap_b32 v93, v95
    buffer_store_dwordx4 v[92:95], v9, s[16:19], s52 offen offset:0 sc1
    v_pk_mul_f32 v[108:109], v[60:61], v[60:61]
    v_pk_mul_f32 v[110:111], v[62:63], v[62:63]
    v_pk_mul_f32 v[112:113], v[76:77], v[76:77]
    v_pk_mul_f32 v[114:115], v[78:79], v[78:79]
    v_pk_fma_f32 v[108:109], v[108:109], v[10:11], v[12:13]
    v_pk_fma_f32 v[110:111], v[110:111], v[10:11], v[12:13]
    v_pk_fma_f32 v[112:113], v[112:113], v[10:11], v[12:13]
    v_pk_fma_f32 v[114:115], v[114:115], v[10:11], v[12:13]
    v_pk_mul_f32 v[108:109], v[108:109], v[60:61]
    v_pk_mul_f32 v[110:111], v[110:111], v[62:63]
    v_pk_mul_f32 v[112:113], v[112:113], v[76:77]
    v_pk_mul_f32 v[114:115], v[114:115], v[78:79]
    v_exp_f32 v108, v108
    v_exp_f32 v109, v109
    v_exp_f32 v110, v110
    v_exp_f32 v111, v111
    v_exp_f32 v112, v112
    v_exp_f32 v113, v113
    v_exp_f32 v114, v114
    v_exp_f32 v115, v115
    v_pk_add_f32 v[108:109], v[108:109], v[14:15]
    v_pk_add_f32 v[110:111], v[110:111], v[14:15]
    v_pk_add_f32 v[112:113], v[112:113], v[14:15]
    v_pk_add_f32 v[114:115], v[114:115], v[14:15]
    v_rcp_f32 v108, v108
    v_rcp_f32 v109, v109
    v_rcp_f32 v110, v110
    v_rcp_f32 v111, v111
    v_rcp_f32 v112, v112
    v_rcp_f32 v113, v113
    v_rcp_f32 v114, v114
    v_rcp_f32 v115, v115
    v_pk_mul_f32 v[60:61], v[60:61], v[108:109]
    v_pk_mul_f32 v[62:63], v[62:63], v[110:111]
    v_pk_mul_f32 v[76:77], v[76:77], v[112:113]
    v_pk_mul_f32 v[78:79], v[78:79], v[114:115]
    v_cvt_pk_bf16_f32 v96, v60, v61
    v_cvt_pk_bf16_f32 v97, v62, v63
    v_cvt_pk_bf16_f32 v98, v76, v77
    v_cvt_pk_bf16_f32 v99, v78, v79
    s_nop 1
    v_permlane16_swap_b32 v96, v98
    v_permlane16_swap_b32 v97, v99
    buffer_store_dwordx4 v[96:99], v9, s[16:19], s52 offen offset:64 sc1
    v_pk_mul_f32 v[108:109], v[32:33], v[32:33]
    v_pk_mul_f32 v[110:111], v[34:35], v[34:35]
    v_pk_mul_f32 v[112:113], v[48:49], v[48:49]
    v_pk_mul_f32 v[114:115], v[50:51], v[50:51]
    v_pk_fma_f32 v[108:109], v[108:109], v[10:11], v[12:13]
    v_pk_fma_f32 v[110:111], v[110:111], v[10:11], v[12:13]
    v_pk_fma_f32 v[112:113], v[112:113], v[10:11], v[12:13]
    v_pk_fma_f32 v[114:115], v[114:115], v[10:11], v[12:13]
    v_pk_mul_f32 v[108:109], v[108:109], v[32:33]
    v_pk_mul_f32 v[110:111], v[110:111], v[34:35]
    v_pk_mul_f32 v[112:113], v[112:113], v[48:49]
    v_pk_mul_f32 v[114:115], v[114:115], v[50:51]
    v_exp_f32 v108, v108
    v_exp_f32 v109, v109
    v_exp_f32 v110, v110
    v_exp_f32 v111, v111
    v_exp_f32 v112, v112
    v_exp_f32 v113, v113
    v_exp_f32 v114, v114
    v_exp_f32 v115, v115
    v_pk_add_f32 v[108:109], v[108:109], v[14:15]
    v_pk_add_f32 v[110:111], v[110:111], v[14:15]
    v_pk_add_f32 v[112:113], v[112:113], v[14:15]
    v_pk_add_f32 v[114:115], v[114:115], v[14:15]
    v_rcp_f32 v108, v108
    v_rcp_f32 v109, v109
    v_rcp_f32 v110, v110
    v_rcp_f32 v111, v111
    v_rcp_f32 v112, v112
    v_rcp_f32 v113, v113
    v_rcp_f32 v114, v114
    v_rcp_f32 v115, v115
    v_pk_mul_f32 v[32:33], v[32:33], v[108:109]
    v_pk_mul_f32 v[34:35], v[34:35], v[110:111]
    v_pk_mul_f32 v[48:49], v[48:49], v[112:113]
    v_pk_mul_f32 v[50:51], v[50:51], v[114:115]
    v_cvt_pk_bf16_f32 v100, v32, v33
    v_cvt_pk_bf16_f32 v101, v34, v35
    v_cvt_pk_bf16_f32 v102, v48, v49
    v_cvt_pk_bf16_f32 v103, v50, v51
    s_nop 1
    v_permlane16_swap_b32 v100, v102
    v_permlane16_swap_b32 v101, v103
    buffer_store_dwordx4 v[100:103], v9, s[16:19], s53 offen offset:0 sc1
    v_pk_mul_f32 v[108:109], v[64:65], v[64:65]
    v_pk_mul_f32 v[110:111], v[66:67], v[66:67]
    v_pk_mul_f32 v[112:113], v[80:81], v[80:81]
    v_pk_mul_f32 v[114:115], v[82:83], v[82:83]
    v_pk_fma_f32 v[108:109], v[108:109], v[10:11], v[12:13]
    v_pk_fma_f32 v[110:111], v[110:111], v[10:11], v[12:13]
    v_pk_fma_f32 v[112:113], v[112:113], v[10:11], v[12:13]
    v_pk_fma_f32 v[114:115], v[114:115], v[10:11], v[12:13]
    v_pk_mul_f32 v[108:109], v[108:109], v[64:65]
    v_pk_mul_f32 v[110:111], v[110:111], v[66:67]
    v_pk_mul_f32 v[112:113], v[112:113], v[80:81]
    v_pk_mul_f32 v[114:115], v[114:115], v[82:83]
    v_exp_f32 v108, v108
    v_exp_f32 v109, v109
    v_exp_f32 v110, v110
    v_exp_f32 v111, v111
    v_exp_f32 v112, v112
    v_exp_f32 v113, v113
    v_exp_f32 v114, v114
    v_exp_f32 v115, v115
    v_pk_add_f32 v[108:109], v[108:109], v[14:15]
    v_pk_add_f32 v[110:111], v[110:111], v[14:15]
    v_pk_add_f32 v[112:113], v[112:113], v[14:15]
    v_pk_add_f32 v[114:115], v[114:115], v[14:15]
    v_rcp_f32 v108, v108
    v_rcp_f32 v109, v109
    v_rcp_f32 v110, v110
    v_rcp_f32 v111, v111
    v_rcp_f32 v112, v112
    v_rcp_f32 v113, v113
    v_rcp_f32 v114, v114
    v_rcp_f32 v115, v115
    v_pk_mul_f32 v[64:65], v[64:65], v[108:109]
    v_pk_mul_f32 v[66:67], v[66:67], v[110:111]
    v_pk_mul_f32 v[80:81], v[80:81], v[112:113]
    v_pk_mul_f32 v[82:83], v[82:83], v[114:115]
    v_cvt_pk_bf16_f32 v104, v64, v65
    v_cvt_pk_bf16_f32 v105, v66, v67
    v_cvt_pk_bf16_f32 v106, v80, v81
    v_cvt_pk_bf16_f32 v107, v82, v83
    s_nop 1
    v_permlane16_swap_b32 v104, v106
    v_permlane16_swap_b32 v105, v107
    buffer_store_dwordx4 v[104:107], v9, s[16:19], s53 offen offset:64 sc1
    v_pk_mul_f32 v[108:109], v[36:37], v[36:37]
    v_pk_mul_f32 v[110:111], v[38:39], v[38:39]
    v_pk_mul_f32 v[112:113], v[52:53], v[52:53]
    v_pk_mul_f32 v[114:115], v[54:55], v[54:55]
    v_pk_fma_f32 v[108:109], v[108:109], v[10:11], v[12:13]
    v_pk_fma_f32 v[110:111], v[110:111], v[10:11], v[12:13]
    v_pk_fma_f32 v[112:113], v[112:113], v[10:11], v[12:13]
    v_pk_fma_f32 v[114:115], v[114:115], v[10:11], v[12:13]
    v_pk_mul_f32 v[108:109], v[108:109], v[36:37]
    v_pk_mul_f32 v[110:111], v[110:111], v[38:39]
    v_pk_mul_f32 v[112:113], v[112:113], v[52:53]
    v_pk_mul_f32 v[114:115], v[114:115], v[54:55]
    v_exp_f32 v108, v108
    v_exp_f32 v109, v109
    v_exp_f32 v110, v110
    v_exp_f32 v111, v111
    v_exp_f32 v112, v112
    v_exp_f32 v113, v113
    v_exp_f32 v114, v114
    v_exp_f32 v115, v115
    v_pk_add_f32 v[108:109], v[108:109], v[14:15]
    v_pk_add_f32 v[110:111], v[110:111], v[14:15]
    v_pk_add_f32 v[112:113], v[112:113], v[14:15]
    v_pk_add_f32 v[114:115], v[114:115], v[14:15]
    v_rcp_f32 v108, v108
    v_rcp_f32 v109, v109
    v_rcp_f32 v110, v110
    v_rcp_f32 v111, v111
    v_rcp_f32 v112, v112
    v_rcp_f32 v113, v113
    v_rcp_f32 v114, v114
    v_rcp_f32 v115, v115
    v_pk_mul_f32 v[36:37], v[36:37], v[108:109]
    v_pk_mul_f32 v[38:39], v[38:39], v[110:111]
    v_pk_mul_f32 v[52:53], v[52:53], v[112:113]
    v_pk_mul_f32 v[54:55], v[54:55], v[114:115]
    v_cvt_pk_bf16_f32 v92, v36, v37
    v_cvt_pk_bf16_f32 v93, v38, v39
    v_cvt_pk_bf16_f32 v94, v52, v53
    v_cvt_pk_bf16_f32 v95, v54, v55
    s_nop 1
    v_permlane16_swap_b32 v92, v94
    v_permlane16_swap_b32 v93, v95
    buffer_store_dwordx4 v[92:95], v9, s[16:19], s54 offen offset:0 sc1
    v_pk_mul_f32 v[108:109], v[68:69], v[68:69]
    v_pk_mul_f32 v[110:111], v[70:71], v[70:71]
    v_pk_mul_f32 v[112:113], v[84:85], v[84:85]
    v_pk_mul_f32 v[114:115], v[86:87], v[86:87]
    v_pk_fma_f32 v[108:109], v[108:109], v[10:11], v[12:13]
    v_pk_fma_f32 v[110:111], v[110:111], v[10:11], v[12:13]
    v_pk_fma_f32 v[112:113], v[112:113], v[10:11], v[12:13]
    v_pk_fma_f32 v[114:115], v[114:115], v[10:11], v[12:13]
    v_pk_mul_f32 v[108:109], v[108:109], v[68:69]
    v_pk_mul_f32 v[110:111], v[110:111], v[70:71]
    v_pk_mul_f32 v[112:113], v[112:113], v[84:85]
    v_pk_mul_f32 v[114:115], v[114:115], v[86:87]
    v_exp_f32 v108, v108
    v_exp_f32 v109, v109
    v_exp_f32 v110, v110
    v_exp_f32 v111, v111
    v_exp_f32 v112, v112
    v_exp_f32 v113, v113
    v_exp_f32 v114, v114
    v_exp_f32 v115, v115
    v_pk_add_f32 v[108:109], v[108:109], v[14:15]
    v_pk_add_f32 v[110:111], v[110:111], v[14:15]
    v_pk_add_f32 v[112:113], v[112:113], v[14:15]
    v_pk_add_f32 v[114:115], v[114:115], v[14:15]
    v_rcp_f32 v108, v108
    v_rcp_f32 v109, v109
    v_rcp_f32 v110, v110
    v_rcp_f32 v111, v111
    v_rcp_f32 v112, v112
    v_rcp_f32 v113, v113
    v_rcp_f32 v114, v114
    v_rcp_f32 v115, v115
    v_pk_mul_f32 v[68:69], v[68:69], v[108:109]
    v_pk_mul_f32 v[70:71], v[70:71], v[110:111]
    v_pk_mul_f32 v[84:85], v[84:85], v[112:113]
    v_pk_mul_f32 v[86:87], v[86:87], v[114:115]
    v_cvt_pk_bf16_f32 v96, v68, v69
    v_cvt_pk_bf16_f32 v97, v70, v71
    v_cvt_pk_bf16_f32 v98, v84, v85
    v_cvt_pk_bf16_f32 v99, v86, v87
    s_nop 1
    v_permlane16_swap_b32 v96, v98
    v_permlane16_swap_b32 v97, v99
    buffer_store_dwordx4 v[96:99], v9, s[16:19], s54 offen offset:64 sc1
    v_pk_mul_f32 v[108:109], v[40:41], v[40:41]
    v_pk_mul_f32 v[110:111], v[42:43], v[42:43]
    v_pk_mul_f32 v[112:113], v[56:57], v[56:57]
    v_pk_mul_f32 v[114:115], v[58:59], v[58:59]
    v_pk_fma_f32 v[108:109], v[108:109], v[10:11], v[12:13]
    v_pk_fma_f32 v[110:111], v[110:111], v[10:11], v[12:13]
    v_pk_fma_f32 v[112:113], v[112:113], v[10:11], v[12:13]
    v_pk_fma_f32 v[114:115], v[114:115], v[10:11], v[12:13]
    v_pk_mul_f32 v[108:109], v[108:109], v[40:41]
    v_pk_mul_f32 v[110:111], v[110:111], v[42:43]
    v_pk_mul_f32 v[112:113], v[112:113], v[56:57]
    v_pk_mul_f32 v[114:115], v[114:115], v[58:59]
    v_exp_f32 v108, v108
    v_exp_f32 v109, v109
    v_exp_f32 v110, v110
    v_exp_f32 v111, v111
    v_exp_f32 v112, v112
    v_exp_f32 v113, v113
    v_exp_f32 v114, v114
    v_exp_f32 v115, v115
    v_pk_add_f32 v[108:109], v[108:109], v[14:15]
    v_pk_add_f32 v[110:111], v[110:111], v[14:15]
    v_pk_add_f32 v[112:113], v[112:113], v[14:15]
    v_pk_add_f32 v[114:115], v[114:115], v[14:15]
    v_rcp_f32 v108, v108
    v_rcp_f32 v109, v109
    v_rcp_f32 v110, v110
    v_rcp_f32 v111, v111
    v_rcp_f32 v112, v112
    v_rcp_f32 v113, v113
    v_rcp_f32 v114, v114
    v_rcp_f32 v115, v115
    v_pk_mul_f32 v[40:41], v[40:41], v[108:109]
    v_pk_mul_f32 v[42:43], v[42:43], v[110:111]
    v_pk_mul_f32 v[56:57], v[56:57], v[112:113]
    v_pk_mul_f32 v[58:59], v[58:59], v[114:115]
    v_cvt_pk_bf16_f32 v100, v40, v41
    v_cvt_pk_bf16_f32 v101, v42, v43
    v_cvt_pk_bf16_f32 v102, v56, v57
    v_cvt_pk_bf16_f32 v103, v58, v59
    s_nop 1
    v_permlane16_swap_b32 v100, v102
    v_permlane16_swap_b32 v101, v103
    buffer_store_dwordx4 v[100:103], v9, s[16:19], s55 offen offset:0 sc1
    v_pk_mul_f32 v[108:109], v[72:73], v[72:73]
    v_pk_mul_f32 v[110:111], v[74:75], v[74:75]
    v_pk_mul_f32 v[112:113], v[88:89], v[88:89]
    v_pk_mul_f32 v[114:115], v[90:91], v[90:91]
    v_pk_fma_f32 v[108:109], v[108:109], v[10:11], v[12:13]
    v_pk_fma_f32 v[110:111], v[110:111], v[10:11], v[12:13]
    v_pk_fma_f32 v[112:113], v[112:113], v[10:11], v[12:13]
    v_pk_fma_f32 v[114:115], v[114:115], v[10:11], v[12:13]
    v_pk_mul_f32 v[108:109], v[108:109], v[72:73]
    v_pk_mul_f32 v[110:111], v[110:111], v[74:75]
    v_pk_mul_f32 v[112:113], v[112:113], v[88:89]
    v_pk_mul_f32 v[114:115], v[114:115], v[90:91]
    v_exp_f32 v108, v108
    v_exp_f32 v109, v109
    v_exp_f32 v110, v110
    v_exp_f32 v111, v111
    v_exp_f32 v112, v112
    v_exp_f32 v113, v113
    v_exp_f32 v114, v114
    v_exp_f32 v115, v115
    v_pk_add_f32 v[108:109], v[108:109], v[14:15]
    v_pk_add_f32 v[110:111], v[110:111], v[14:15]
    v_pk_add_f32 v[112:113], v[112:113], v[14:15]
    v_pk_add_f32 v[114:115], v[114:115], v[14:15]
    v_rcp_f32 v108, v108
    v_rcp_f32 v109, v109
    v_rcp_f32 v110, v110
    v_rcp_f32 v111, v111
    v_rcp_f32 v112, v112
    v_rcp_f32 v113, v113
    v_rcp_f32 v114, v114
    v_rcp_f32 v115, v115
    v_pk_mul_f32 v[72:73], v[72:73], v[108:109]
    v_pk_mul_f32 v[74:75], v[74:75], v[110:111]
    v_pk_mul_f32 v[88:89], v[88:89], v[112:113]
    v_pk_mul_f32 v[90:91], v[90:91], v[114:115]
    v_cvt_pk_bf16_f32 v104, v72, v73
    v_cvt_pk_bf16_f32 v105, v74, v75
    v_cvt_pk_bf16_f32 v106, v88, v89
    v_cvt_pk_bf16_f32 v107, v90, v91
    s_nop 1
    v_permlane16_swap_b32 v104, v106
    v_permlane16_swap_b32 v105, v107
    buffer_store_dwordx4 v[104:107], v9, s[16:19], s55 offen offset:64 sc1
    s_endpgm
g3_spare:
    s_cmp_ge_u32 s2, 256
    s_cbranch_scc1 g3_done
    s_load_dwordx2 s[4:5], s[0:1], 48
    s_load_dwordx2 s[6:7], s[0:1], 80
    s_sub_u32 s3, s2, 224
    v_lshlrev_b32 v1, 4, v0
    v_mov_b32 v8, -1
    v_mov_b32 v9, -1
    v_mov_b32 v10, -1
    v_mov_b32 v11, -1
    s_lshl_b32 s13, s3, 17
    s_mov_b32 s12, 2
    s_waitcnt lgkmcnt(0)
    s_add_u32 s8, s6, 0x1d00000
    s_addc_u32 s9, s7, 0
    s_mov_b32 s10, 0x400000
    s_mov_b32 s11, 0x20000
g3_clear_loop:
    buffer_store_dwordx4 v[8:11], v1, s[8:11], s13 offen sc1
    s_add_u32 s13, s13, 8192
    buffer_store_dwordx4 v[8:11], v1, s[8:11], s13 offen sc1
    s_add_u32 s13, s13, 8192
    buffer_store_dwordx4 v[8:11], v1, s[8:11], s13 offen sc1
    s_add_u32 s13, s13, 8192
    buffer_store_dwordx4 v[8:11], v1, s[8:11], s13 offen sc1
    s_add_u32 s13, s13, 8192
    buffer_store_dwordx4 v[8:11], v1, s[8:11], s13 offen sc1
    s_add_u32 s13, s13, 8192
    buffer_store_dwordx4 v[8:11], v1, s[8:11], s13 offen sc1
    s_add_u32 s13, s13, 8192
    buffer_store_dwordx4 v[8:11], v1, s[8:11], s13 offen sc1
    s_add_u32 s13, s13, 8192
    buffer_store_dwordx4 v[8:11], v1, s[8:11], s13 offen sc1
    s_add_u32 s13, s13, 8192
    s_waitcnt vmcnt(8)
    s_sub_u32 s12, s12, 1
    s_cmp_lg_u32 s12, 0
    s_cbranch_scc1 g3_clear_loop
    s_cmp_ge_u32 s2, s47
    s_cbranch_scc1 g3_done
    s_cmp_ge_u32 s3, 16
    s_cselect_b32 s12, 3145728, 0
    s_lshl_b32 s3, s3, 18
    s_add_u32 s3, s3, s12
    s_mov_b32 s12, 4
    s_mov_b32 s8, s4
    s_mov_b32 s9, s5
    s_mov_b32 s10, 0xe00000
    s_mov_b32 s11, 0x20000
g3_spare_loop:
    buffer_load_dwordx4 v[4:7], v1, s[8:11], s3 offen
    s_add_u32 s3, s3, 8192
    buffer_load_dwordx4 v[4:7], v1, s[8:11], s3 offen
    s_add_u32 s3, s3, 8192
    buffer_load_dwordx4 v[4:7], v1, s[8:11], s3 offen
    s_add_u32 s3, s3, 8192
    buffer_load_dwordx4 v[4:7], v1, s[8:11], s3 offen
    s_add_u32 s3, s3, 8192
    buffer_load_dwordx4 v[4:7], v1, s[8:11], s3 offen
    s_add_u32 s3, s3, 8192
    buffer_load_dwordx4 v[4:7], v1, s[8:11], s3 offen
    s_add_u32 s3, s3, 8192
    buffer_load_dwordx4 v[4:7], v1, s[8:11], s3 offen
    s_add_u32 s3, s3, 8192
    buffer_load_dwordx4 v[4:7], v1, s[8:11], s3 offen
    s_add_u32 s3, s3, 8192
    s_waitcnt vmcnt(8)
    s_sub_u32 s12, s12, 1
    s_cmp_lg_u32 s12, 0
    s_cbranch_scc1 g3_spare_loop
    s_endpgm
.section .rodata,"a"
.p2align 6
.amdhsa_kernel g3a_kernel
  .amdhsa_next_free_vgpr 156
  .amdhsa_next_free_sgpr 96
  .amdhsa_accum_offset 156
  .amdhsa_group_segment_fixed_size 0
  .amdhsa_kernarg_size 88
  .amdhsa_user_sgpr_count 2
  .amdhsa_user_sgpr_kernarg_segment_ptr 1
  .amdhsa_system_sgpr_workgroup_id_x 1
.end_amdhsa_kernel
.section .rodata,"a"
.p2align 6
.amdhsa_kernel g3b_kernel
  .amdhsa_next_free_vgpr 156
  .amdhsa_next_free_sgpr 96
  .amdhsa_accum_offset 156
  .amdhsa_group_segment_fixed_size 0
  .amdhsa_kernarg_size 88
  .amdhsa_user_sgpr_count 2
  .amdhsa_user_sgpr_kernarg_segment_ptr 1
  .amdhsa_system_sgpr_workgroup_id_x 1
.end_amdhsa_kernel
.text
.globl g4a_kernel
.p2align 8
.type g4a_kernel,@function
g4a_kernel:
    s_load_dwordx2 s[6:7], s[0:1], 80
    s_mov_b32 s47, 0x1900000
    s_mov_b32 s95, 3
    s_branch g4_body
.text
.globl g4b_kernel
.p2align 8
.type g4b_kernel,@function
g4b_kernel:
    s_load_dwordx2 s[6:7], s[0:1], 64
    s_mov_b32 s47, 0
    s_mov_b32 s95, 1
    s_branch g4_body
.p2align 6
g4_body:
    s_cmp_ge_u32 s2, 256
    s_cbranch_scc1 g4_done
    s_load_dwordx2 s[4:5], s[0:1], 80
    s_load_dwordx2 s[30:31], s[0:1], 48
    s_load_dwordx2 s[34:35], s[0:1], 56
    v_lshrrev_b32 v1, 6, v0
    v_and_b32 v2, 63, v0
    s_bfe_u32 s40, s2, 0x10001
    s_lshl_b32 s40, s40, 2
    s_bfe_u32 s41, s2, 0x20003
    s_add_u32 s24, s40, s41
    s_bfe_u32 s40, s2, 0x10002
    s_lshl_b32 s40, s40, 3
    s_lshr_b32 s42, s2, 5
    s_add_u32 s25, s40, s42
    s_and_b32 s91, s2, 1
    s_add_u32 s27, s41, s42
    s_lshl_b32 s92, s24, 4
    s_add_u32 s92, s92, s25
    s_mul_i32 s26, s91, 28
    v_readfirstlane_b32 s28, v1
    s_nop 0
    s_cmp_lt_u32 s28, 4
    s_cbranch_scc1 g4_compute
    s_sub_u32 s28, s28, 4
    s_mov_b32 s40, 8192
    v_lshrrev_b32 v3, 3, v2
    v_mul_lo_u32 v3, v3, s40
    v_lshrrev_b32 v4, 4, v2
    v_xor_b32 v4, v4, v2
    v_and_b32 v4, 7, v4
    v_lshl_add_u32 v3, v4, 4, v3
    s_mul_i32 s41, s24, 1048576
    s_mul_i32 s42, s28, 262144
    s_add_u32 s41, s41, s42
    v_xor_b32 v4, 64, v3
    s_add_u32 s42, s41, 0
    v_add_u32 v10, s42, v3
    s_add_u32 s42, s41, 65536
    v_add_u32 v11, s42, v4
    s_add_u32 s42, s41, 131072
    v_add_u32 v12, s42, v3
    s_add_u32 s42, s41, 196608
    v_add_u32 v13, s42, v4
    s_mov_b32 s40, 4096
    v_lshrrev_b32 v4, 4, v2
    v_mul_lo_u32 v3, v4, s40
    v_lshlrev_b32 v4, 1, v4
    v_xor_b32 v4, v4, v2
    v_and_b32 v4, 15, v4
    v_lshl_add_u32 v3, v4, 4, v3
    s_mul_i32 s41, s25, 256
    s_mul_i32 s42, s28, 65536
    s_add_u32 s41, s41, s42
    v_xor_b32 v4, 128, v3
    s_add_u32 s42, s41, 0
    v_add_u32 v14, s42, v3
    s_add_u32 s42, s41, 16384
    v_add_u32 v15, s42, v3
    s_add_u32 s42, s41, 32768
    v_add_u32 v16, s42, v4
    s_add_u32 s42, s41, 49152
    v_add_u32 v17, s42, v4
    s_mul_i32 s36, s28, 4096
    s_mul_i32 s37, s28, 4096
    s_add_u32 s37, s37, 16384
    s_waitcnt lgkmcnt(0)
    s_add_u32 s8, s4, 0x1100000
    s_addc_u32 s9, s5, 0
    s_mov_b32 s10, 0x800000
    s_mov_b32 s11, 0x20000
    s_mov_b32 s12, s30
    s_mov_b32 s13, s31
    s_mov_b32 s14, 0xe00000
    s_mov_b32 s15, 0x20000
    s_mov_b32 s32, 0
    s_mov_b32 s33, 0
g4_ld_loop:
    s_cmp_lt_u32 s32, 3
    s_cbranch_scc1 g4_ld_issue
    s_waitcnt vmcnt(16)
g4_ld_bar:
    s_barrier
g4_ld_issue:
    s_add_u32 s40, s32, s27
    s_and_b32 s40, s40, s95
    s_andn2_b32 s41, s32, s95
    s_or_b32 s40, s40, s41
    s_add_u32 s40, s40, s26
    s_mul_i32 s34, s40, 128
    s_mul_i32 s35, s40, 262144
    s_add_u32 s38, s33, s36
    s_add_u32 s39, s33, s37
    s_add_u32 m0, s38, 0
    s_nop 0
    buffer_load_dwordx4 v10, s[8:11], s34 offen lds
    s_add_u32 m0, s38, 1024
    s_nop 0
    buffer_load_dwordx4 v11, s[8:11], s34 offen lds
    s_add_u32 m0, s38, 2048
    s_nop 0
    buffer_load_dwordx4 v12, s[8:11], s34 offen lds
    s_add_u32 m0, s38, 3072
    s_nop 0
    buffer_load_dwordx4 v13, s[8:11], s34 offen lds
    s_add_u32 m0, s39, 0
    s_nop 0
    buffer_load_dwordx4 v14, s[12:15], s35 offen lds
    s_add_u32 m0, s39, 1024
    s_nop 0
    buffer_load_dwordx4 v15, s[12:15], s35 offen lds
    s_add_u32 m0, s39, 2048
    s_nop 0
    buffer_load_dwordx4 v16, s[12:15], s35 offen lds
    s_add_u32 m0, s39, 3072
    s_nop 0
    buffer_load_dwordx4 v17, s[12:15], s35 offen lds
    s_add_u32 s33, s33, 32768
    s_cmp_eq_u32 s33, 131072
    s_cselect_b32 s33, 0, s33
    s_add_u32 s32, s32, 1
    s_cmp_lt_u32 s32, 28
    s_cbranch_scc1 g4_ld_loop
    s_waitcnt vmcnt(16)
    s_barrier
    s_waitcnt vmcnt(8)
    s_barrier
    s_waitcnt vmcnt(0)
    s_barrier
g4_done:
    s_endpgm
g4_compute:
    v_lshrrev_b32 v5, 4, v2
    v_bfe_u32 v6, v2, 2, 2
    v_and_b32 v7, 3, v2
    v_and_b32 v8, 15, v2
    s_and_b32 s44, s28, 1
    s_lshr_b32 s45, s28, 1
    s_mul_i32 s40, s25, 128
    s_mul_i32 s41, s45, 64
    s_add_u32 s40, s40, s41
    s_lshl_b32 s41, s91, 5
    s_add_u32 s40, s40, s41
    v_add_u32 v20, s40, v8
    s_mov_b32 s41, 2048
    v_mul_lo_u32 v9, v20, s41
    s_mul_i32 s40, s24, 256
    s_mul_i32 s41, s44, 128
    s_add_u32 s46, s40, s41
    v_and_b32 v3, 1, v5
    v_lshlrev_b32 v3, 5, v3
    v_lshrrev_b32 v4, 1, v5
    v_lshl_add_u32 v3, v4, 4, v3
    v_add3_u32 v9, v9, v3, s46
    s_mov_b32 s52, 0
    s_mov_b32 s53, 32768
    s_mov_b32 s54, 65536
    s_mov_b32 s55, 98304
    s_waitcnt lgkmcnt(0)
    s_add_u32 s20, s4, 0x800000
    s_addc_u32 s21, s5, 0
    s_mov_b32 s22, 0x400000
    s_mov_b32 s23, 0x20000
    s_mov_b32 s56, s34
    s_mov_b32 s57, s35
    s_mov_b32 s58, 0x1000
    s_mov_b32 s59, 0x20000
    s_add_u32 s16, s6, s47
    s_addc_u32 s17, s7, 0
    s_mov_b32 s18, 0x400000
    s_mov_b32 s19, 0x20000
    s_mov_b32 s60, s4
    s_mov_b32 s61, s5
    s_mov_b32 s62, 0x40000
    s_mov_b32 s63, 0x20000
    s_add_u32 s84, s4, 0x1d00000
    s_addc_u32 s85, s5, 0
    s_mov_b32 s86, 0x400000
    s_mov_b32 s87, 0x20000
    buffer_load_dwordx4 v[92:95], v9, s[20:23], s52 offen offset:0
    buffer_load_dwordx4 v[96:99], v9, s[20:23], s52 offen offset:64
    buffer_load_dwordx4 v[100:103], v9, s[20:23], s53 offen offset:0
    buffer_load_dwordx4 v[104:107], v9, s[20:23], s53 offen offset:64
    v_lshlrev_b32 v3, 1, v20
    buffer_load_ushort v22, v3, s[56:59], 0 offen offset:0
    buffer_load_ushort v23, v3, s[56:59], 0 offen offset:32
    s_mul_i32 s42, s44, 64
    v_lshrrev_b32 v3, 1, v8
    v_xor_b32 v3, v3, v5
    v_lshlrev_b32 v3, 4, v3
    v_lshl_add_u32 v3, v8, 7, v3
    s_lshl_b32 s40, s42, 7
    s_add_u32 s40, s40, 0
    v_add_u32 v10, s40, v3
    v_xor_b32 v11, 64, v10
    s_lshl_b32 s90, s91, 1
    s_mul_i32 s42, s45, 4
    s_mov_b32 s43, 16384
    v_and_b32 v3, 1, v5
    v_lshl_or_b32 v3, v3, 2, v6
    s_add_u32 s40, s42, 0
    s_xor_b32 s40, s40, s90
    v_xor_b32 v3, s40, v3
    v_lshlrev_b32 v3, 5, v3
    v_lshl_add_u32 v3, v7, 3, v3
    v_lshl_add_u32 v4, v5, 3, v6
    v_lshl_add_u32 v3, v4, 8, v3
    v_add_u32 v12, s43, v3
    v_and_b32 v3, 1, v5
    v_lshl_or_b32 v3, v3, 2, v6
    s_add_u32 s40, s42, 1
    s_xor_b32 s40, s40, s90
    v_xor_b32 v3, s40, v3
    v_lshlrev_b32 v3, 5, v3
    v_lshl_add_u32 v3, v7, 3, v3
    v_lshl_add_u32 v4, v5, 3, v6
    v_lshl_add_u32 v3, v4, 8, v3
    v_add_u32 v13, s43, v3
    v_and_b32 v3, 1, v5
    v_lshl_or_b32 v3, v3, 2, v6
    s_add_u32 s40, s42, 2
    s_xor_b32 s40, s40, s90
    v_xor_b32 v3, s40, v3
    v_lshlrev_b32 v3, 5, v3
    v_lshl_add_u32 v3, v7, 3, v3
    v_lshl_add_u32 v4, v5, 3, v6
    v_lshl_add_u32 v3, v4, 8, v3
    v_add_u32 v14, s43, v3
    v_and_b32 v3, 1, v5
    v_lshl_or_b32 v3, v3, 2, v6
    s_add_u32 s40, s42, 3
    s_xor_b32 s40, s40, s90
    v_xor_b32 v3, s40, v3
    v_lshlrev_b32 v3, 5, v3
    v_lshl_add_u32 v3, v7, 3, v3
    v_lshl_add_u32 v4, v5, 3, v6
    v_lshl_add_u32 v3, v4, 8, v3
    v_add_u32 v15, s43, v3
    v_mov_b32 v124, 0
    v_mov_b32 v125, 0
    v_mov_b32 v126, 0
    v_mov_b32 v127, 0
    v_mov_b32 v128, 0
    v_mov_b32 v129, 0
    v_mov_b32 v130, 0
    v_mov_b32 v131, 0
    v_mov_b32 v132, 0
    v_mov_b32 v133, 0
    v_mov_b32 v134, 0
    v_mov_b32 v135, 0
    v_mov_b32 v136, 0
    v_mov_b32 v137, 0
    v_mov_b32 v138, 0
    v_mov_b32 v139, 0
    v_mov_b32 v140, 0
    v_mov_b32 v141, 0
    v_mov_b32 v142, 0
    v_mov_b32 v143, 0
    v_mov_b32 v144, 0
    v_mov_b32 v145, 0
    v_mov_b32 v146, 0
    v_mov_b32 v147, 0
    v_mov_b32 v148, 0
    v_mov_b32 v149, 0
    v_mov_b32 v150, 0
    v_mov_b32 v151, 0
    v_mov_b32 v152, 0
    v_mov_b32 v153, 0
    v_mov_b32 v154, 0
    v_mov_b32 v155, 0
    s_mov_b32 s48, 28
    s_mov_b32 s50, 0
    s_mov_b32 s51, 32768
    s_mov_b32 s29, 0xfffe8000
    v_mov_b32 v36, 0
    v_mov_b32 v37, 0
    v_mov_b32 v38, 0
    v_mov_b32 v39, 0
    v_mov_b32 v40, 0
    v_mov_b32 v41, 0
    v_mov_b32 v42, 0
    v_mov_b32 v43, 0
    v_mov_b32 v52, 0
    v_mov_b32 v53, 0
    v_mov_b32 v54, 0
    v_mov_b32 v55, 0
    v_mov_b32 v56, 0
    v_mov_b32 v57, 0
    v_mov_b32 v58, 0
    v_mov_b32 v59, 0
    v_mov_b32 v68, 0
    v_mov_b32 v69, 0
    v_mov_b32 v70, 0
    v_mov_b32 v71, 0
    v_mov_b32 v72, 0
    v_mov_b32 v73, 0
    v_mov_b32 v74, 0
    v_mov_b32 v75, 0
    v_mov_b32 v84, 0
    v_mov_b32 v85, 0
    v_mov_b32 v86, 0
    v_mov_b32 v87, 0
    v_mov_b32 v88, 0
    v_mov_b32 v89, 0
    v_mov_b32 v90, 0
    v_mov_b32 v91, 0
    s_lshl_b32 s40, s28, 12
    v_lshl_add_u32 v21, v2, 4, s40
    s_lshl_b32 s93, s92, 1
    s_add_u32 s93, s93, s91
    s_lshl_b32 s93, s93, 14
    s_xor_b32 s94, s93, 0x4000
    s_waitcnt vmcnt(0)
    v_permlane16_swap_b32 v92, v94
    v_permlane16_swap_b32 v93, v95
    v_permlane16_swap_b32 v96, v98
    v_permlane16_swap_b32 v97, v99
    v_permlane16_swap_b32 v100, v102
    v_permlane16_swap_b32 v101, v103
    v_permlane16_swap_b32 v104, v106
    v_permlane16_swap_b32 v105, v107
    v_lshlrev_b32 v22, 16, v22
    v_lshlrev_b32 v23, 16, v23
    v_lshlrev_b32 v28, 16, v92
    v_and_b32 v29, 0xffff0000, v92
    v_lshlrev_b32 v30, 16, v93
    v_and_b32 v31, 0xffff0000, v93
    v_add_f32 v28, v28, v22
    v_add_f32 v29, v29, v22
    v_add_f32 v30, v30, v22
    v_add_f32 v31, v31, v22
    v_lshlrev_b32 v44, 16, v94
    v_and_b32 v45, 0xffff0000, v94
    v_lshlrev_b32 v46, 16, v95
    v_and_b32 v47, 0xffff0000, v95
    v_add_f32 v44, v44, v22
    v_add_f32 v45, v45, v22
    v_add_f32 v46, v46, v22
    v_add_f32 v47, v47, v22
    v_lshlrev_b32 v60, 16, v96
    v_and_b32 v61, 0xffff0000, v96
    v_lshlrev_b32 v62, 16, v97
    v_and_b32 v63, 0xffff0000, v97
    v_add_f32 v60, v60, v22
    v_add_f32 v61, v61, v22
    v_add_f32 v62, v62, v22
    v_add_f32 v63, v63, v22
    v_lshlrev_b32 v76, 16, v98
    v_and_b32 v77, 0xffff0000, v98
    v_lshlrev_b32 v78, 16, v99
    v_and_b32 v79, 0xffff0000, v99
    v_add_f32 v76, v76, v22
    v_add_f32 v77, v77, v22
    v_add_f32 v78, v78, v22
    v_add_f32 v79, v79, v22
    v_lshlrev_b32 v32, 16, v100
    v_and_b32 v33, 0xffff0000, v100
    v_lshlrev_b32 v34, 16, v101
    v_and_b32 v35, 0xffff0000, v101
    v_add_f32 v32, v32, v23
    v_add_f32 v33, v33, v23
    v_add_f32 v34, v34, v23
    v_add_f32 v35, v35, v23
    v_lshlrev_b32 v48, 16, v102
    v_and_b32 v49, 0xffff0000, v102
    v_lshlrev_b32 v50, 16, v103
    v_and_b32 v51, 0xffff0000, v103
    v_add_f32 v48, v48, v23
    v_add_f32 v49, v49, v23
    v_add_f32 v50, v50, v23
    v_add_f32 v51, v51, v23
    v_lshlrev_b32 v64, 16, v104
    v_and_b32 v65, 0xffff0000, v104
    v_lshlrev_b32 v66, 16, v105
    v_and_b32 v67, 0xffff0000, v105
    v_add_f32 v64, v64, v23
    v_add_f32 v65, v65, v23
    v_add_f32 v66, v66, v23
    v_add_f32 v67, v67, v23
    v_lshlrev_b32 v80, 16, v106
    v_and_b32 v81, 0xffff0000, v106
    v_lshlrev_b32 v82, 16, v107
    v_and_b32 v83, 0xffff0000, v107
    v_add_f32 v80, v80, v23
    v_add_f32 v81, v81, v23
    v_add_f32 v82, v82, v23
    v_add_f32 v83, v83, v23
.p2align 3
g4_cloop:
    s_barrier
g4_cloop2:
    v_mfma_f32_16x16x32_bf16 v[28:31], v[124:127], v[140:143], v[28:31]
    ds_read_b128 v[92:95], v10 offset:0
    v_mfma_f32_16x16x32_bf16 v[32:35], v[124:127], v[144:147], v[32:35]
    ds_read_b64_tr_b16 v[108:109], v12 offset:0
    ds_read_b64_tr_b16 v[110:111], v12 offset:1024
    v_mfma_f32_16x16x32_bf16 v[36:39], v[124:127], v[148:151], v[36:39]
    ds_read_b64_tr_b16 v[112:113], v13 offset:0
    ds_read_b64_tr_b16 v[114:115], v13 offset:1024
    v_mfma_f32_16x16x32_bf16 v[40:43], v[124:127], v[152:155], v[40:43]
    ds_read_b64_tr_b16 v[116:117], v14 offset:0
    ds_read_b64_tr_b16 v[118:119], v14 offset:1024
    v_mfma_f32_16x16x32_bf16 v[44:47], v[128:131], v[140:143], v[44:47]
    ds_read_b64_tr_b16 v[120:121], v15 offset:0
    ds_read_b64_tr_b16 v[122:123], v15 offset:1024
    v_mfma_f32_16x16x32_bf16 v[48:51], v[128:131], v[144:147], v[48:51]
    ds_read_b128 v[96:99], v10 offset:2048
    v_mfma_f32_16x16x32_bf16 v[52:55], v[128:131], v[148:151], v[52:55]
    ds_read_b128 v[100:103], v10 offset:4096
    v_mfma_f32_16x16x32_bf16 v[56:59], v[128:131], v[152:155], v[56:59]
    ds_read_b128 v[104:107], v10 offset:6144
    v_mfma_f32_16x16x32_bf16 v[60:63], v[132:135], v[140:143], v[60:63]
    v_mfma_f32_16x16x32_bf16 v[64:67], v[132:135], v[144:147], v[64:67]
    v_mfma_f32_16x16x32_bf16 v[68:71], v[132:135], v[148:151], v[68:71]
    v_mfma_f32_16x16x32_bf16 v[72:75], v[132:135], v[152:155], v[72:75]
    v_mfma_f32_16x16x32_bf16 v[76:79], v[136:139], v[140:143], v[76:79]
    v_mfma_f32_16x16x32_bf16 v[80:83], v[136:139], v[144:147], v[80:83]
    v_mfma_f32_16x16x32_bf16 v[84:87], v[136:139], v[148:151], v[84:87]
    v_mfma_f32_16x16x32_bf16 v[88:91], v[136:139], v[152:155], v[88:91]
    s_waitcnt lgkmcnt(0)
    v_mfma_f32_16x16x32_bf16 v[28:31], v[92:95], v[108:111], v[28:31]
    ds_read_b128 v[124:127], v11 offset:0
    v_mfma_f32_16x16x32_bf16 v[32:35], v[92:95], v[112:115], v[32:35]
    ds_read_b64_tr_b16 v[140:141], v12 offset:8192
    ds_read_b64_tr_b16 v[142:143], v12 offset:9216
    v_mfma_f32_16x16x32_bf16 v[36:39], v[92:95], v[116:119], v[36:39]
    ds_read_b64_tr_b16 v[144:145], v13 offset:8192
    ds_read_b64_tr_b16 v[146:147], v13 offset:9216
    v_mfma_f32_16x16x32_bf16 v[40:43], v[92:95], v[120:123], v[40:43]
    ds_read_b64_tr_b16 v[148:149], v14 offset:8192
    ds_read_b64_tr_b16 v[150:151], v14 offset:9216
    v_mfma_f32_16x16x32_bf16 v[44:47], v[96:99], v[108:111], v[44:47]
    ds_read_b64_tr_b16 v[152:153], v15 offset:8192
    ds_read_b64_tr_b16 v[154:155], v15 offset:9216
    v_mfma_f32_16x16x32_bf16 v[48:51], v[96:99], v[112:115], v[48:51]
    ds_read_b128 v[128:131], v11 offset:2048
    v_mfma_f32_16x16x32_bf16 v[52:55], v[96:99], v[116:119], v[52:55]
    ds_read_b128 v[132:135], v11 offset:4096
    v_mfma_f32_16x16x32_bf16 v[56:59], v[96:99], v[120:123], v[56:59]
    ds_read_b128 v[136:139], v11 offset:6144
    v_mfma_f32_16x16x32_bf16 v[60:63], v[100:103], v[108:111], v[60:63]
    s_add_u32 s50, s50, 1
    s_cmp_eq_u32 s50, 4
    v_mfma_f32_16x16x32_bf16 v[64:67], v[100:103], v[112:115], v[64:67]
    s_cselect_b32 s49, s29, s51
    s_cselect_b32 s50, 0, s50
    v_mfma_f32_16x16x32_bf16 v[68:71], v[100:103], v[116:119], v[68:71]
    v_add_u32 v10, s49, v10
    v_add_u32 v11, s49, v11
    v_mfma_f32_16x16x32_bf16 v[72:75], v[100:103], v[120:123], v[72:75]
    v_add_u32 v12, s49, v12
    v_add_u32 v13, s49, v13
    v_mfma_f32_16x16x32_bf16 v[76:79], v[104:107], v[108:111], v[76:79]
    v_add_u32 v14, s49, v14
    v_add_u32 v15, s49, v15
    v_mfma_f32_16x16x32_bf16 v[80:83], v[104:107], v[112:115], v[80:83]
    s_sub_u32 s48, s48, 1
    s_cmp_lg_u32 s48, 0
    v_mfma_f32_16x16x32_bf16 v[84:87], v[104:107], v[116:119], v[84:87]
    v_mfma_f32_16x16x32_bf16 v[88:91], v[104:107], v[120:123], v[88:91]
    s_waitcnt lgkmcnt(0)
    s_cbranch_scc1 g4_cloop
    v_mfma_f32_16x16x32_bf16 v[28:31], v[124:127], v[140:143], v[28:31]
    v_mfma_f32_16x16x32_bf16 v[32:35], v[124:127], v[144:147], v[32:35]
    v_mfma_f32_16x16x32_bf16 v[36:39], v[124:127], v[148:151], v[36:39]
    v_mfma_f32_16x16x32_bf16 v[40:43], v[124:127], v[152:155], v[40:43]
    v_mfma_f32_16x16x32_bf16 v[44:47], v[128:131], v[140:143], v[44:47]
    v_mfma_f32_16x16x32_bf16 v[48:51], v[128:131], v[144:147], v[48:51]
    v_mfma_f32_16x16x32_bf16 v[52:55], v[128:131], v[148:151], v[52:55]
    v_mfma_f32_16x16x32_bf16 v[56:59], v[128:131], v[152:155], v[56:59]
    v_mfma_f32_16x16x32_bf16 v[60:63], v[132:135], v[140:143], v[60:63]
    v_mfma_f32_16x16x32_bf16 v[64:67], v[132:135], v[144:147], v[64:67]
    v_mfma_f32_16x16x32_bf16 v[68:71], v[132:135], v[148:151], v[68:71]
    v_mfma_f32_16x16x32_bf16 v[72:75], v[132:135], v[152:155], v[72:75]
    v_mfma_f32_16x16x32_bf16 v[76:79], v[136:139], v[140:143], v[76:79]
    v_mfma_f32_16x16x32_bf16 v[80:83], v[136:139], v[144:147], v[80:83]
    v_mfma_f32_16x16x32_bf16 v[84:87], v[136:139], v[148:151], v[84:87]
    v_mfma_f32_16x16x32_bf16 v[88:91], v[136:139], v[152:155], v[88:91]
    v_cvt_pk_bf16_f32 v156, v36, v37
    v_cvt_pk_bf16_f32 v157, v38, v39
    v_cvt_pk_bf16_f32 v158, v52, v53
    v_cvt_pk_bf16_f32 v159, v54, v55
    buffer_store_dwordx4 v[156:159], v21, s[84:87], s93 offen offset:0 sc1
    v_cvt_pk_bf16_f32 v160, v68, v69
    v_cvt_pk_bf16_f32 v161, v70, v71
    v_cvt_pk_bf16_f32 v162, v84, v85
    v_cvt_pk_bf16_f32 v163, v86, v87
    buffer_store_dwordx4 v[160:163], v21, s[84:87], s93 offen offset:1024 sc1
    v_cvt_pk_bf16_f32 v164, v40, v41
    v_cvt_pk_bf16_f32 v165, v42, v43
    v_cvt_pk_bf16_f32 v166, v56, v57
    v_cvt_pk_bf16_f32 v167, v58, v59
    buffer_store_dwordx4 v[164:167], v21, s[84:87], s93 offen offset:2048 sc1
    v_cvt_pk_bf16_f32 v168, v72, v73
    v_cvt_pk_bf16_f32 v169, v74, v75
    s_nop 3
    v_cvt_pk_bf16_f32 v170, v88, v89
    v_cvt_pk_bf16_f32 v171, v90, v91
    buffer_store_dwordx4 v[168:171], v21, s[84:87], s93 offen offset:3072 sc1
    s_mov_b32 s48, 0x2000
    buffer_load_dwordx4 v[172:175], v21, s[84:87], s94 offen offset:0 sc1
    buffer_load_dwordx4 v[176:179], v21, s[84:87], s94 offen offset:1024 sc1
    buffer_load_dwordx4 v[180:183], v21, s[84:87], s94 offen offset:2048 sc1
    buffer_load_dwordx4 v[184:187], v21, s[84:87], s94 offen offset:3072 sc1
    s_waitcnt vmcnt(0)
g4_rcv:
    v_max3_u32 v4, v172, v173, v174
    v_max3_u32 v4, v4, v175, v176
    v_max3_u32 v4, v4, v177, v178
    v_max3_u32 v4, v4, v179, v180
    v_max3_u32 v4, v4, v181, v182
    v_max3_u32 v4, v4, v183, v184
    v_max3_u32 v4, v4, v185, v186
    v_max_u32 v4, v4, v187
    v_cmp_eq_u32 vcc, -1, v4
    s_sub_u32 s48, s48, 1
    s_cmp_eq_u32 s48, 0
    s_cbranch_scc1 g4_rcvd
    s_cbranch_vccz g4_rcvd
    s_sleep 2
    buffer_load_dwordx4 v[172:175], v21, s[84:87], s94 offen offset:0 sc1
    buffer_load_dwordx4 v[176:179], v21, s[84:87], s94 offen offset:1024 sc1
    buffer_load_dwordx4 v[180:183], v21, s[84:87], s94 offen offset:2048 sc1
    buffer_load_dwordx4 v[184:187], v21, s[84:87], s94 offen offset:3072 sc1
    s_waitcnt vmcnt(0)
    s_branch g4_rcv
g4_rcvd:
    v_lshlrev_b32 v108, 16, v172
    v_and_b32 v109, 0xffff0000, v172
    v_lshlrev_b32 v110, 16, v173
    v_and_b32 v111, 0xffff0000, v173
    v_pk_add_f32 v[28:29], v[28:29], v[108:109]
    v_pk_add_f32 v[30:31], v[30:31], v[110:111]
    v_lshlrev_b32 v112, 16, v174
    v_and_b32 v113, 0xffff0000, v174
    v_lshlrev_b32 v114, 16, v175
    v_and_b32 v115, 0xffff0000, v175
    v_pk_add_f32 v[44:45], v[44:45], v[112:113]
    v_pk_add_f32 v[46:47], v[46:47], v[114:115]
    v_lshlrev_b32 v116, 16, v176
    v_and_b32 v117, 0xffff0000, v176
    v_lshlrev_b32 v118, 16, v177
    v_and_b32 v119, 0xffff0000, v177
    v_pk_add_f32 v[60:61], v[60:61], v[116:117]
    v_pk_add_f32 v[62:63], v[62:63], v[118:119]
    v_lshlrev_b32 v120, 16, v178
    v_and_b32 v121, 0xffff0000, v178
    v_lshlrev_b32 v122, 16, v179
    v_and_b32 v123, 0xffff0000, v179
    v_pk_add_f32 v[76:77], v[76:77], v[120:121]
    v_pk_add_f32 v[78:79], v[78:79], v[122:123]
    v_lshlrev_b32 v108, 16, v180
    v_and_b32 v109, 0xffff0000, v180
    v_lshlrev_b32 v110, 16, v181
    v_and_b32 v111, 0xffff0000, v181
    v_pk_add_f32 v[32:33], v[32:33], v[108:109]
    v_pk_add_f32 v[34:35], v[34:35], v[110:111]
    v_lshlrev_b32 v112, 16, v182
    v_and_b32 v113, 0xffff0000, v182
    v_lshlrev_b32 v114, 16, v183
    v_and_b32 v115, 0xffff0000, v183
    v_pk_add_f32 v[48:49], v[48:49], v[112:113]
    v_pk_add_f32 v[50:51], v[50:51], v[114:115]
    v_lshlrev_b32 v116, 16, v184
    v_and_b32 v117, 0xffff0000, v184
    v_lshlrev_b32 v118, 16, v185
    v_and_b32 v119, 0xffff0000, v185
    v_pk_add_f32 v[64:65], v[64:65], v[116:117]
    v_pk_add_f32 v[66:67], v[66:67], v[118:119]
    v_lshlrev_b32 v120, 16, v186
    v_and_b32 v121, 0xffff0000, v186
    v_lshlrev_b32 v122, 16, v187
    v_and_b32 v123, 0xffff0000, v187
    v_pk_add_f32 v[80:81], v[80:81], v[120:121]
    v_pk_add_f32 v[82:83], v[82:83], v[122:123]
    s_nop 7
    v_cvt_pk_bf16_f32 v92, v28, v29
    v_cvt_pk_bf16_f32 v93, v30, v31
    v_cvt_pk_bf16_f32 v94, v44, v45
    v_cvt_pk_bf16_f32 v95, v46, v47
    s_nop 1
    v_permlane16_swap_b32 v92, v94
    v_permlane16_swap_b32 v93, v95
    buffer_store_dwordx4 v[92:95], v9, s[16:19], s52 offen offset:0 sc1
    v_cvt_pk_bf16_f32 v96, v60, v61
    v_cvt_pk_bf16_f32 v97, v62, v63
    v_cvt_pk_bf16_f32 v98, v76, v77
    v_cvt_pk_bf16_f32 v99, v78, v79
    s_nop 1
    v_permlane16_swap_b32 v96, v98
    v_permlane16_swap_b32 v97, v99
    buffer_store_dwordx4 v[96:99], v9, s[16:19], s52 offen offset:64 sc1
    v_cvt_pk_bf16_f32 v100, v32, v33
    v_cvt_pk_bf16_f32 v101, v34, v35
    v_cvt_pk_bf16_f32 v102, v48, v49
    v_cvt_pk_bf16_f32 v103, v50, v51
    s_nop 1
    v_permlane16_swap_b32 v100, v102
    v_permlane16_swap_b32 v101, v103
    buffer_store_dwordx4 v[100:103], v9, s[16:19], s53 offen offset:0 sc1
    v_cvt_pk_bf16_f32 v104, v64, v65
    v_cvt_pk_bf16_f32 v105, v66, v67
    v_cvt_pk_bf16_f32 v106, v80, v81
    v_cvt_pk_bf16_f32 v107, v82, v83
    s_nop 1
    v_permlane16_swap_b32 v104, v106
    v_permlane16_swap_b32 v105, v107
    buffer_store_dwordx4 v[104:107], v9, s[16:19], s53 offen offset:64 sc1
    v_pk_add_f32 v[108:109], v[28:29], v[30:31]
    v_pk_mul_f32 v[110:111], v[28:29], v[28:29]
    v_pk_fma_f32 v[110:111], v[30:31], v[30:31], v[110:111]
    v_pk_add_f32 v[108:109], v[108:109], v[44:45]
    v_pk_fma_f32 v[110:111], v[44:45], v[44:45], v[110:111]
    v_pk_add_f32 v[108:109], v[108:109], v[46:47]
    v_pk_fma_f32 v[110:111], v[46:47], v[46:47], v[110:111]
    v_pk_add_f32 v[108:109], v[108:109], v[60:61]
    v_pk_fma_f32 v[110:111], v[60:61], v[60:61], v[110:111]
    v_pk_add_f32 v[108:109], v[108:109], v[62:63]
    v_pk_fma_f32 v[110:111], v[62:63], v[62:63], v[110:111]
    v_pk_add_f32 v[108:109], v[108:109], v[76:77]
    v_pk_fma_f32 v[110:111], v[76:77], v[76:77], v[110:111]
    v_pk_add_f32 v[108:109], v[108:109], v[78:79]
    v_pk_fma_f32 v[110:111], v[78:79], v[78:79], v[110:111]
    v_pk_add_f32 v[112:113], v[32:33], v[34:35]
    v_pk_mul_f32 v[114:115], v[32:33], v[32:33]
    v_pk_fma_f32 v[114:115], v[34:35], v[34:35], v[114:115]
    v_pk_add_f32 v[112:113], v[112:113], v[48:49]
    v_pk_fma_f32 v[114:115], v[48:49], v[48:49], v[114:115]
    v_pk_add_f32 v[112:113], v[112:113], v[50:51]
    v_pk_fma_f32 v[114:115], v[50:51], v[50:51], v[114:115]
    v_pk_add_f32 v[112:113], v[112:113], v[64:65]
    v_pk_fma_f32 v[114:115], v[64:65], v[64:65], v[114:115]
    v_pk_add_f32 v[112:113], v[112:113], v[66:67]
    v_pk_fma_f32 v[114:115], v[66:67], v[66:67], v[114:115]
    v_pk_add_f32 v[112:113], v[112:113], v[80:81]
    v_pk_fma_f32 v[114:115], v[80:81], v[80:81], v[114:115]
    v_pk_add_f32 v[112:113], v[112:113], v[82:83]
    v_pk_fma_f32 v[114:115], v[82:83], v[82:83], v[114:115]
    v_add_f32 v108, v108, v109
    v_add_f32 v109, v110, v111
    v_add_f32 v112, v112, v113
    v_add_f32 v113, v114, v115
    s_nop 1
    v_permlane16_swap_b32 v108, v112
    v_permlane16_swap_b32 v109, v113
    v_pk_add_f32 v[108:109], v[108:109], v[112:113]
    v_mov_b32 v116, v108
    v_mov_b32 v117, v109
    v_and_b32 v3, 16, v2
    v_add_u32 v3, v3, v20
    v_permlane32_swap_b32 v108, v116
    v_permlane32_swap_b32 v109, v117
    v_pk_add_f32 v[108:109], v[108:109], v[116:117]
    v_lshlrev_b32 v3, 3, v3
    s_mul_i32 s40, s24, 2
    s_add_u32 s40, s40, s44
    s_lshl_b32 s40, s40, 14
    s_mov_b32 exec_hi, 0
    buffer_store_dwordx2 v[108:109], v3, s[60:63], s40 offen sc1
    s_mov_b32 exec_hi, -1
    s_endpgm
.section .rodata,"a"
.p2align 6
.amdhsa_kernel g4a_kernel
  .amdhsa_next_free_vgpr 188
  .amdhsa_next_free_sgpr 96
  .amdhsa_accum_offset 188
  .amdhsa_group_segment_fixed_size 0
  .amdhsa_kernarg_size 88
  .amdhsa_user_sgpr_count 2
  .amdhsa_user_sgpr_kernarg_segment_ptr 1
  .amdhsa_system_sgpr_workgroup_id_x 1
.end_amdhsa_kernel
.section .rodata,"a"
.p2align 6
.amdhsa_kernel g4b_kernel
  .amdhsa_next_free_vgpr 188
  .amdhsa_next_free_sgpr 96
  .amdhsa_accum_offset 188
  .amdhsa_group_segment_fixed_size 0
  .amdhsa_kernarg_size 88
  .amdhsa_user_sgpr_count 2
  .amdhsa_user_sgpr_kernarg_segment_ptr 1
  .amdhsa_system_sgpr_workgroup_id_x 1
.end_amdhsa_kernel
```

```asm
; @launch kernel=g1a_kernel grid=(256,1,1) block=(512,1,1) lds=131072
.amdgcn_target "amdgcn-amd-amdhsa--gfx950"
.text
.globl g1a_kernel
.p2align 8
.type g1a_kernel,@function
g1a_kernel:
    s_mov_b32 s96, 0
    s_mov_b32 s97, 0x0
    s_branch g1_in
.p2align 6
g1_in:
    s_cmp_ge_u32 s2, 256
    s_cbranch_scc1 g1_done
    s_load_dwordx2 s[4:5], s[0:1], 80
    s_load_dwordx2 s[6:7], s[0:1], 0
    s_xor_b32 s53, s96, 1
    s_load_dwordx2 s[30:31], s[0:1], 8
    s_load_dwordx2 s[16:17], s[0:1], 72
    s_load_dwordx2 s[18:19], s[0:1], 16
    v_lshrrev_b32 v1, 6, v0
    v_and_b32 v2, 63, v0
    s_and_b32 s40, s2, 1
    s_lshl_b32 s40, s40, 3
    s_bfe_u32 s41, s2, 0x30003
    s_add_u32 s25, s40, s41
    s_bfe_u32 s40, s2, 0x20001
    s_lshl_b32 s40, s40, 2
    s_lshr_b32 s42, s2, 6
    s_add_u32 s24, s40, s42
    s_add_u32 s27, s41, s42
    s_add_u32 s52, s24, s25
    s_and_b32 s52, s52, 15
    s_and_b32 s26, s52, 12
    s_mul_i32 s26, s26, s53
    v_readfirstlane_b32 s28, v1
    v_lshrrev_b32 v5, 4, v2
    v_bfe_u32 v6, v2, 2, 2
    v_and_b32 v7, 3, v2
    v_and_b32 v8, 15, v2
    s_cmp_lt_u32 s28, 4
    s_cbranch_scc1 g1_compute
    s_sub_u32 s28, s28, 4
    s_mov_b32 s40, 2048
    v_lshrrev_b32 v3, 3, v2
    v_mul_lo_u32 v3, v3, s40
    v_lshrrev_b32 v4, 4, v2
    v_xor_b32 v4, v4, v2
    v_and_b32 v4, 7, v4
    v_lshl_add_u32 v3, v4, 4, v3
    s_mul_i32 s41, s25, 262144
    s_mul_i32 s42, s28, 65536
    s_add_u32 s41, s41, s42
    v_xor_b32 v4, 64, v3
    s_add_u32 s42, s41, 0
    v_add_u32 v16, s42, v3
    s_add_u32 s42, s41, 16384
    v_add_u32 v17, s42, v4
    s_add_u32 s42, s41, 32768
    v_add_u32 v18, s42, v3
    s_add_u32 s42, s41, 49152
    v_add_u32 v19, s42, v4
    s_mov_b32 s40, 6144
    v_lshrrev_b32 v3, 3, v2
    v_mul_lo_u32 v3, v3, s40
    v_bfe_u32 v4, v2, 4, 1
    v_lshlrev_b32 v4, 1, v4
    v_xor_b32 v4, v4, v2
    v_and_b32 v4, 7, v4
    v_lshl_add_u32 v3, v4, 4, v3
    s_mul_i32 s41, s24, 128
    s_mul_i32 s42, s28, 98304
    s_add_u32 s41, s41, s42
    v_xor_b32 v4, 64, v3
    s_add_u32 s42, s41, 0
    v_add_u32 v10, s42, v3
    s_add_u32 s42, s41, 49152
    v_add_u32 v11, s42, v4
    s_mov_b32 s40, 6144
    v_lshrrev_b32 v3, 3, v2
    v_mul_lo_u32 v3, v3, s40
    v_bfe_u32 v4, v2, 4, 1
    v_lshlrev_b32 v4, 1, v4
    v_xor_b32 v4, v4, v2
    v_and_b32 v4, 7, v4
    v_lshl_add_u32 v3, v4, 4, v3
    s_mul_i32 s41, s24, 128
    s_mul_i32 s42, s28, 98304
    s_add_u32 s41, s41, s42
    v_xor_b32 v4, 64, v3
    s_add_u32 s42, s41, 2048
    v_add_u32 v12, s42, v3
    s_add_u32 s42, s41, 51200
    v_add_u32 v13, s42, v4
    s_mov_b32 s40, 6144
    v_lshrrev_b32 v3, 3, v2
    v_mul_lo_u32 v3, v3, s40
    v_bfe_u32 v4, v2, 4, 1
    v_lshlrev_b32 v4, 1, v4
    v_xor_b32 v4, v4, v2
    v_and_b32 v4, 7, v4
    v_lshl_add_u32 v3, v4, 4, v3
    s_mul_i32 s41, s24, 128
    s_mul_i32 s42, s28, 98304
    s_add_u32 s41, s41, s42
    v_xor_b32 v4, 64, v3
    s_add_u32 s42, s41, 4096
    v_add_u32 v14, s42, v3
    s_add_u32 s42, s41, 53248
    v_add_u32 v15, s42, v4
    v_lshrrev_b32 v3, 3, v2
    s_lshl_b32 s40, s28, 2
    v_add_u32 v3, s40, v3
    v_lshrrev_b32 v4, 1, v3
    v_xor_b32 v4, v4, v2
    v_and_b32 v4, 7, v4
    s_lshl_b32 s40, s25, 7
    s_sub_u32 s40, s40, 16
    v_add_u32 v3, s40, v3
    v_max_i32 v3, 0, v3
    v_lshlrev_b32 v3, 11, v3
    v_lshl_add_u32 v20, v4, 4, v3
    s_mul_i32 s36, s28, 2048
    s_mul_i32 s37, s28, 4096
    s_add_u32 s37, s37, 26624
    s_mul_i32 s46, s28, 512
    s_add_u32 s46, s46, 24576
    s_waitcnt lgkmcnt(0)
    s_mov_b32 s8, s30
    s_mov_b32 s9, s31
    s_mov_b32 s10, 0x600000
    s_mov_b32 s11, 0x20000
    s_add_u32 s56, s4, 0x100000
    s_addc_u32 s57, s5, 0
    s_mov_b32 s58, 0x30000
    s_mov_b32 s59, 0x20000
    s_add_u32 s4, s4, s97
    s_addc_u32 s5, s5, 0
    s_add_u32 s12, s4, 0x1900000
    s_addc_u32 s13, s5, 0
    s_cmp_eq_u32 s96, 1
    s_cselect_b32 s12, s12, s6
    s_cselect_b32 s13, s13, s7
    s_mov_b32 s14, 0x400000
    s_mov_b32 s15, 0x20000
    s_mov_b32 s20, s4
    s_mov_b32 s21, s5
    s_mov_b32 s22, 0x40000
    s_mov_b32 s23, 0x20000
    s_mov_b32 s60, s16
    s_mov_b32 s61, s17
    s_mov_b32 s62, 0x100
    s_mov_b32 s63, 0x20000
    s_sub_u32 s40, s52, s27
    s_and_b32 s40, s40, 1
    s_and_b32 s41, s52, 2
    s_or_b32 s40, s40, s41
    s_add_u32 s54, s40, 2
    s_cmp_eq_u32 s53, 0
    s_cselect_b32 s54, 0x7fff, s54
    s_add_u32 s55, s54, 3
    s_cmp_lg_u32 s28, 0
    s_cselect_b32 s55, 0x7fff, s55
    s_cmp_lt_u32 s55, 0x7fff
    s_cselect_b32 s29, 13, 0x7fff
    s_cmp_eq_u32 s96, 0
    s_cbranch_scc1 g1_dep_ok
    s_add_u32 s40, s25, 40
    s_lshl_b32 s40, s40, 8
    s_sub_u32 s42, s40, 256
    s_max_u32 s42, s42, 10240
    s_add_u32 s84, s4, 0x300000
    s_addc_u32 s85, s5, 0
    s_mov_b32 s86, 0x4000
    s_mov_b32 s87, 0x20000
    v_cmp_eq_u32 vcc, 1, v2
    v_mov_b32 v21, s40
    v_mov_b32 v23, s42
    v_cndmask_b32 v21, v21, v23, vcc
    v_mov_b32 v22, 16
    v_mov_b32 v23, 16
    v_cndmask_b32 v22, v22, v23, vcc
    s_mov_b32 s41, 0x8000
g1_dep:
    buffer_load_dword v23, v21, s[84:87], 0 offen sc1
    s_sub_u32 s41, s41, 1
    s_waitcnt vmcnt(0)
    v_cmp_lt_u32 vcc, v23, v22
    s_cmp_eq_u32 s41, 0
    s_cbranch_scc1 g1_dep_ok
    s_cbranch_vccz g1_dep_ok
    s_sleep 2
    s_branch g1_dep
g1_dep_ok:
    s_mov_b32 s32, 0
    s_mov_b32 s33, 0
g1_ld_loop:
    s_cmp_lt_u32 s32, 2
    s_cbranch_scc1 g1_ld_issue
    s_sub_u32 s40, s32, s54
    s_sub_u32 s40, s40, 1
    s_cmp_lt_u32 s40, 2
    s_cbranch_scc1 g1_ld_w0
    s_sub_u32 s40, s32, s55
    s_sub_u32 s40, s40, 1
    s_cmp_lt_u32 s40, 2
    s_cbranch_scc1 g1_ld_w1
    s_sub_u32 s40, s32, s29
    s_sub_u32 s40, s40, 1
    s_cmp_lt_u32 s40, 2
    s_cbranch_scc1 g1_ld_w2
    s_waitcnt vmcnt(11)
g1_ld_bar:
    s_barrier
g1_ld_issue:
    s_add_u32 s40, s32, s27
    s_and_b32 s40, s40, 1
    s_andn2_b32 s41, s32, 1
    s_or_b32 s40, s40, s41
    s_add_u32 s40, s40, s26
    s_and_b32 s40, s40, 15
    s_mul_i32 s34, s40, 393216
    s_mul_i32 s35, s40, 128
    s_add_u32 s38, s33, s36
    s_add_u32 s39, s33, s37
    s_add_u32 m0, s39, 0
    s_nop 0
    buffer_load_dwordx4 v16, s[12:15], s35 offen lds
    s_add_u32 m0, s39, 1024
    s_nop 0
    buffer_load_dwordx4 v17, s[12:15], s35 offen lds
    s_add_u32 m0, s39, 2048
    s_nop 0
    buffer_load_dwordx4 v18, s[12:15], s35 offen lds
    s_add_u32 m0, s39, 3072
    s_nop 0
    buffer_load_dwordx4 v19, s[12:15], s35 offen lds
    s_add_u32 m0, s38, 0
    s_nop 0
    buffer_load_dwordx4 v10, s[8:11], s34 offen lds
    s_add_u32 m0, s38, 1024
    s_nop 0
    buffer_load_dwordx4 v11, s[8:11], s34 offen lds
    s_add_u32 m0, s38, 8192
    s_nop 0
    buffer_load_dwordx4 v12, s[8:11], s34 offen lds
    s_add_u32 m0, s38, 9216
    s_nop 0
    buffer_load_dwordx4 v13, s[8:11], s34 offen lds
    s_add_u32 m0, s38, 16384
    s_nop 0
    buffer_load_dwordx4 v14, s[8:11], s34 offen lds
    s_add_u32 m0, s38, 17408
    s_nop 0
    buffer_load_dwordx4 v15, s[8:11], s34 offen lds
    s_add_u32 m0, s33, s46
    s_mov_b32 exec_hi, 0
    buffer_load_dwordx4 v20, s[12:15], s35 offen lds
    s_mov_b32 exec_hi, -1
    s_cmp_eq_u32 s32, s54
    s_cbranch_scc1 g1_ld_h0
g1_ld_c0:
    s_cmp_eq_u32 s32, s55
    s_cbranch_scc1 g1_ld_h1
g1_ld_c1:
    s_cmp_eq_u32 s32, s29
    s_cbranch_scc1 g1_ld_h2
g1_ld_c2:
    s_add_u32 s33, s33, 43008
    s_cmp_eq_u32 s33, 129024
    s_cselect_b32 s33, 0, s33
    s_add_u32 s32, s32, 1
    s_cmp_lt_u32 s32, 16
    s_cbranch_scc1 g1_ld_loop
    s_cmp_eq_u32 s29, 0x7fff
    s_cbranch_scc1 g1_polled
    s_mov_b32 s41, 0x20000
    v_mov_b32 v21, 0
    s_waitcnt vmcnt(22)
g1_poll:
    v_readfirstlane_b32 s40, v23
    s_sub_u32 s41, s41, 1
    s_cmp_eq_u32 s41, 0
    s_cbranch_scc1 g1_polled
    s_cmp_ge_u32 s40, 256
    s_cbranch_scc1 g1_polled
    s_sleep 8
    buffer_load_dword v23, v21, s[60:63], 0 offen sc1
    s_waitcnt vmcnt(0)
    s_branch g1_poll
g1_polled:
    s_waitcnt vmcnt(11)
    s_barrier
    s_lshl_b32 s40, s28, 6
    v_add_u32 v21, s40, v2
    s_lshl_b32 s41, s25, 7
    s_sub_u32 s41, s41, 16
    v_add_u32 v3, s41, v21
    v_max_i32 v3, 0, v3
    v_min_u32 v3, 2047, v3
    v_lshlrev_b32 v3, 3, v3
    s_min_u32 s40, s28, 2
    s_lshl_b32 s40, s40, 12
    s_lshl_b32 s41, s24, 8
    s_add_u32 s40, s40, s41
    v_lshl_add_u32 v4, v2, 2, s40
    s_mov_b32 s40, 0
    buffer_load_dwordx2 v[24:25], v3, s[20:23], s40 offen sc1
    s_mov_b32 s41, 0
    buffer_load_dword v56, v4, s[56:59], s41 offen sc1
    s_mov_b32 s40, 16384
    buffer_load_dwordx2 v[26:27], v3, s[20:23], s40 offen sc1
    s_mov_b32 s41, 12288
    buffer_load_dword v57, v4, s[56:59], s41 offen sc1
    s_mov_b32 s40, 32768
    buffer_load_dwordx2 v[28:29], v3, s[20:23], s40 offen sc1
    s_mov_b32 s41, 24576
    buffer_load_dword v58, v4, s[56:59], s41 offen sc1
    s_mov_b32 s40, 49152
    buffer_load_dwordx2 v[30:31], v3, s[20:23], s40 offen sc1
    s_mov_b32 s41, 36864
    buffer_load_dword v59, v4, s[56:59], s41 offen sc1
    s_mov_b32 s40, 65536
    buffer_load_dwordx2 v[32:33], v3, s[20:23], s40 offen sc1
    s_mov_b32 s41, 49152
    buffer_load_dword v60, v4, s[56:59], s41 offen sc1
    s_mov_b32 s40, 81920
    buffer_load_dwordx2 v[34:35], v3, s[20:23], s40 offen sc1
    s_mov_b32 s41, 61440
    buffer_load_dword v61, v4, s[56:59], s41 offen sc1
    s_mov_b32 s40, 98304
    buffer_load_dwordx2 v[36:37], v3, s[20:23], s40 offen sc1
    s_mov_b32 s41, 73728
    buffer_load_dword v62, v4, s[56:59], s41 offen sc1
    s_mov_b32 s40, 114688
    buffer_load_dwordx2 v[38:39], v3, s[20:23], s40 offen sc1
    s_mov_b32 s41, 86016
    buffer_load_dword v63, v4, s[56:59], s41 offen sc1
    s_mov_b32 s40, 131072
    buffer_load_dwordx2 v[40:41], v3, s[20:23], s40 offen sc1
    s_mov_b32 s41, 98304
    buffer_load_dword v64, v4, s[56:59], s41 offen sc1
    s_mov_b32 s40, 147456
    buffer_load_dwordx2 v[42:43], v3, s[20:23], s40 offen sc1
    s_mov_b32 s41, 110592
    buffer_load_dword v65, v4, s[56:59], s41 offen sc1
    s_mov_b32 s40, 163840
    buffer_load_dwordx2 v[44:45], v3, s[20:23], s40 offen sc1
    s_mov_b32 s41, 122880
    buffer_load_dword v66, v4, s[56:59], s41 offen sc1
    s_mov_b32 s40, 180224
    buffer_load_dwordx2 v[46:47], v3, s[20:23], s40 offen sc1
    s_mov_b32 s41, 135168
    buffer_load_dword v67, v4, s[56:59], s41 offen sc1
    s_mov_b32 s40, 196608
    buffer_load_dwordx2 v[48:49], v3, s[20:23], s40 offen sc1
    s_mov_b32 s41, 147456
    buffer_load_dword v68, v4, s[56:59], s41 offen sc1
    s_mov_b32 s40, 212992
    buffer_load_dwordx2 v[50:51], v3, s[20:23], s40 offen sc1
    s_mov_b32 s41, 159744
    buffer_load_dword v69, v4, s[56:59], s41 offen sc1
    s_mov_b32 s40, 229376
    buffer_load_dwordx2 v[52:53], v3, s[20:23], s40 offen sc1
    s_mov_b32 s41, 172032
    buffer_load_dword v70, v4, s[56:59], s41 offen sc1
    s_mov_b32 s40, 245760
    buffer_load_dwordx2 v[54:55], v3, s[20:23], s40 offen sc1
    s_mov_b32 s41, 184320
    buffer_load_dword v71, v4, s[56:59], s41 offen sc1
    s_waitcnt vmcnt(32)
    s_barrier
    s_waitcnt vmcnt(0)
    v_pk_add_f32 v[24:25], v[24:25], v[40:41]
    v_add_f32 v56, v56, v64
    v_pk_add_f32 v[26:27], v[26:27], v[42:43]
    v_add_f32 v57, v57, v65
    v_pk_add_f32 v[28:29], v[28:29], v[44:45]
    v_add_f32 v58, v58, v66
    v_pk_add_f32 v[30:31], v[30:31], v[46:47]
    v_add_f32 v59, v59, v67
    v_pk_add_f32 v[32:33], v[32:33], v[48:49]
    v_add_f32 v60, v60, v68
    v_pk_add_f32 v[34:35], v[34:35], v[50:51]
    v_add_f32 v61, v61, v69
    v_pk_add_f32 v[36:37], v[36:37], v[52:53]
    v_add_f32 v62, v62, v70
    v_pk_add_f32 v[38:39], v[38:39], v[54:55]
    v_add_f32 v63, v63, v71
    v_pk_add_f32 v[24:25], v[24:25], v[32:33]
    v_add_f32 v56, v56, v60
    v_pk_add_f32 v[26:27], v[26:27], v[34:35]
    v_add_f32 v57, v57, v61
    v_pk_add_f32 v[28:29], v[28:29], v[36:37]
    v_add_f32 v58, v58, v62
    v_pk_add_f32 v[30:31], v[30:31], v[38:39]
    v_add_f32 v59, v59, v63
    v_pk_add_f32 v[24:25], v[24:25], v[28:29]
    v_add_f32 v56, v56, v58
    v_pk_add_f32 v[26:27], v[26:27], v[30:31]
    v_add_f32 v57, v57, v59
    v_pk_add_f32 v[24:25], v[24:25], v[26:27]
    v_add_f32 v56, v56, v57
    v_mul_f32 v24, 0x3a800000, v24
    v_mul_f32 v25, 0x3a800000, v25
    v_fma_f32 v25, -v24, v24, v25
    v_max_f32 v25, 0, v25
    v_cvt_pk_bf16_f32 v24, v24, v24
    v_lshlrev_b32 v24, 16, v24
    v_cvt_pk_bf16_f32 v25, v25, v25
    v_lshlrev_b32 v25, 16, v25
    v_add_f32 v25, 0x3727c5ac, v25
    v_cvt_pk_bf16_f32 v25, v25, v25
    v_lshlrev_b32 v25, 16, v25
    v_sqrt_f32 v25, v25
    s_nop 0
    v_cvt_pk_bf16_f32 v25, v25, v25
    v_lshlrev_b32 v25, 16, v25
    v_rcp_f32 v26, v25
    v_lshlrev_b32 v3, 3, v21
    v_lshlrev_b32 v4, 2, v21
    v_mul_f32 v27, -v24, v26
    v_cmp_gt_u32 vcc, 144, v21
    s_and_saveexec_b64 s[40:41], vcc
    v_add_u32 v3, 129024, v3
    ds_write_b64 v3, v[26:27]
    s_mov_b64 exec, s[40:41]
    v_cmp_gt_u32 vcc, 192, v21
    s_and_saveexec_b64 s[40:41], vcc
    v_add_u32 v4, 130304, v4
    ds_write_b32 v4, v56
    s_mov_b64 exec, s[40:41]
    s_waitcnt lgkmcnt(0)
    s_barrier
    s_add_u32 s20, s4, 0x200000
    s_addc_u32 s21, s5, 0
    s_mov_b32 s22, 0x40000
    s_mov_b32 s23, 0x20000
    s_lshl_b32 s40, s24, 4
    s_add_u32 s40, s40, s25
    s_lshl_b32 s40, s40, 10
    s_lshl_b32 s41, s28, 8
    s_add_u32 s40, s40, s41
    v_lshlrev_b32 v3, 2, v2
    v_mov_b32 v4, -1
    buffer_store_dword v4, v3, s[20:23], s40 offen sc1
    s_cmp_eq_u32 s53, 0
    s_cbranch_scc1 g1_nopf
    s_mov_b32 s20, s18
    s_mov_b32 s21, s19
    s_mov_b32 s22, 0x200000
    s_mov_b32 s23, 0x20000
    s_lshl_b32 s40, s2, 13
    s_lshl_b32 s41, s28, 11
    s_add_u32 s40, s40, s41
    v_lshlrev_b32 v3, 4, v2
    buffer_load_dwordx4 v[120:123], v3, s[20:23], s40 offen
    buffer_load_dwordx4 v[120:123], v3, s[20:23], s40 offen offset:1024
g1_nopf:
    s_branch g1_ld_end
g1_ld_w0:
    s_waitcnt vmcnt(16)
    s_branch g1_ld_bar
g1_ld_h0:
    s_add_u32 s44, s33, 43008
    s_cmp_eq_u32 s44, 129024
    s_cselect_b32 s44, 0, s44
    s_mul_i32 s42, s28, 3
    s_add_u32 s42, s42, 0
    s_lshr_b32 s43, s42, 2
    s_lshl_b32 s43, s43, 13
    s_add_u32 s43, s43, s44
    s_and_b32 s42, s42, 3
    v_and_b32 v3, 1, v5
    v_lshlrev_b32 v3, 1, v3
    v_lshrrev_b32 v4, 1, v6
    v_or_b32 v3, v3, v4
    s_add_u32 s40, s42, 0
    v_xor_b32 v3, s40, v3
    v_lshlrev_b32 v3, 5, v3
    v_lshl_add_u32 v3, v7, 3, v3
    v_lshl_add_u32 v4, v5, 3, v6
    v_lshl_add_u32 v3, v4, 7, v3
    v_add_u32 v21, s43, v3
    ds_read_b64_tr_b16 v[24:25], v21 offset:0
    ds_read_b64_tr_b16 v[26:27], v21 offset:512
    ds_read_b64_tr_b16 v[28:29], v21 offset:4096
    ds_read_b64_tr_b16 v[30:31], v21 offset:4608
    s_mul_i32 s42, s28, 3
    s_add_u32 s42, s42, 1
    s_lshr_b32 s43, s42, 2
    s_lshl_b32 s43, s43, 13
    s_add_u32 s43, s43, s44
    s_and_b32 s42, s42, 3
    v_and_b32 v3, 1, v5
    v_lshlrev_b32 v3, 1, v3
    v_lshrrev_b32 v4, 1, v6
    v_or_b32 v3, v3, v4
    s_add_u32 s40, s42, 0
    v_xor_b32 v3, s40, v3
    v_lshlrev_b32 v3, 5, v3
    v_lshl_add_u32 v3, v7, 3, v3
    v_lshl_add_u32 v4, v5, 3, v6
    v_lshl_add_u32 v3, v4, 7, v3
    v_add_u32 v21, s43, v3
    ds_read_b64_tr_b16 v[32:33], v21 offset:0
    ds_read_b64_tr_b16 v[34:35], v21 offset:512
    ds_read_b64_tr_b16 v[36:37], v21 offset:4096
    ds_read_b64_tr_b16 v[38:39], v21 offset:4608
    s_mul_i32 s42, s28, 3
    s_add_u32 s42, s42, 2
    s_lshr_b32 s43, s42, 2
    s_lshl_b32 s43, s43, 13
    s_add_u32 s43, s43, s44
    s_and_b32 s42, s42, 3
    v_and_b32 v3, 1, v5
    v_lshlrev_b32 v3, 1, v3
    v_lshrrev_b32 v4, 1, v6
    v_or_b32 v3, v3, v4
    s_add_u32 s40, s42, 0
    v_xor_b32 v3, s40, v3
    v_lshlrev_b32 v3, 5, v3
    v_lshl_add_u32 v3, v7, 3, v3
    v_lshl_add_u32 v4, v5, 3, v6
    v_lshl_add_u32 v3, v4, 7, v3
    v_add_u32 v21, s43, v3
    ds_read_b64_tr_b16 v[40:41], v21 offset:0
    ds_read_b64_tr_b16 v[42:43], v21 offset:512
    ds_read_b64_tr_b16 v[44:45], v21 offset:4096
    ds_read_b64_tr_b16 v[46:47], v21 offset:4608
    s_lshr_b32 s42, s44, 7
    s_lshl_b32 s43, s28, 5
    s_add_u32 s42, s42, s43
    s_add_u32 s42, s42, 16
    v_lshrrev_b32 v3, 1, v8
    v_xor_b32 v3, v3, v5
    v_lshlrev_b32 v3, 4, v3
    v_lshl_add_u32 v3, v8, 7, v3
    s_lshl_b32 s40, s42, 7
    s_add_u32 s40, s40, 24576
    v_add_u32 v22, s40, v3
    v_xor_b32 v23, 64, v22
    ds_read_b128 v[48:51], v22 offset:0
    ds_read_b128 v[52:55], v23 offset:0
    ds_read_b128 v[56:59], v22 offset:2048
    ds_read_b128 v[60:63], v23 offset:2048
    v_mov_b32 v64, 0x3f803f80
    v_mov_b32 v65, 0x3f803f80
    v_mov_b32 v66, 0x3f803f80
    v_mov_b32 v67, 0x3f803f80
    s_mul_i32 s42, s52, 12288
    s_lshl_b32 s43, s24, 8
    s_add_u32 s42, s42, s43
    v_lshl_add_u32 v21, v5, 4, s42
    s_lshl_b32 s42, s52, 14
    s_lshl_b32 s43, s25, 10
    s_add_u32 s42, s42, s43
    s_lshl_b32 s43, s28, 8
    s_add_u32 s42, s42, s43
    v_lshl_add_u32 v22, v8, 3, s42
    s_waitcnt lgkmcnt(0)
    v_mfma_f32_16x16x32_bf16 v[68:71], v[24:27], v[64:67], 0
    v_mfma_f32_16x16x32_bf16 v[72:75], v[32:35], v[64:67], 0
    v_mfma_f32_16x16x32_bf16 v[76:79], v[40:43], v[64:67], 0
    v_mfma_f32_16x16x32_bf16 v[80:83], v[64:67], v[48:51], 0
    v_mfma_f32_16x16x32_bf16 v[84:87], v[48:51], v[48:51], 0
    v_mfma_f32_16x16x32_bf16 v[88:91], v[64:67], v[56:59], 0
    v_mfma_f32_16x16x32_bf16 v[92:95], v[56:59], v[56:59], 0
    v_mfma_f32_16x16x32_bf16 v[68:71], v[28:31], v[64:67], v[68:71]
    v_mfma_f32_16x16x32_bf16 v[72:75], v[36:39], v[64:67], v[72:75]
    v_mfma_f32_16x16x32_bf16 v[76:79], v[44:47], v[64:67], v[76:79]
    v_mfma_f32_16x16x32_bf16 v[80:83], v[64:67], v[52:55], v[80:83]
    v_mfma_f32_16x16x32_bf16 v[84:87], v[52:55], v[52:55], v[84:87]
    v_mfma_f32_16x16x32_bf16 v[88:91], v[64:67], v[60:63], v[88:91]
    v_mfma_f32_16x16x32_bf16 v[92:95], v[60:63], v[60:63], v[92:95]
    v_cmp_eq_u32 s[40:41], 1, v7
    v_cmp_eq_u32 s[42:43], 2, v7
    v_cmp_eq_u32 vcc, 3, v7
    s_nop 7
    v_cndmask_b32 v81, v84, v85, s[40:41]
    v_cndmask_b32 v81, v81, v86, s[42:43]
    v_cndmask_b32 v81, v81, v87, vcc
    v_cndmask_b32 v89, v92, v93, s[40:41]
    v_cndmask_b32 v89, v89, v94, s[42:43]
    v_cndmask_b32 v89, v89, v95, vcc
    s_mov_b32 exec_lo, 0x00f0000f
    s_mov_b32 exec_hi, 0xf0000f00
    buffer_store_dwordx2 v[80:81], v22, s[20:23], 0 offen offset:0 sc1
    buffer_store_dwordx2 v[88:89], v22, s[20:23], 0 offen offset:128 sc1
    s_mov_b32 exec_lo, 0x00010001
    s_mov_b32 exec_hi, 0x00010001
    s_mul_i32 s42, s28, 3
    s_add_u32 s42, s42, 0
    s_lshr_b32 s43, s42, 2
    s_lshl_b32 s43, s43, 12
    s_and_b32 s42, s42, 3
    s_lshl_b32 s42, s42, 6
    s_add_u32 s42, s42, s43
    buffer_store_dwordx4 v[68:71], v21, s[56:59], s42 offen sc1
    s_mul_i32 s42, s28, 3
    s_add_u32 s42, s42, 1
    s_lshr_b32 s43, s42, 2
    s_lshl_b32 s43, s43, 12
    s_and_b32 s42, s42, 3
    s_lshl_b32 s42, s42, 6
    s_add_u32 s42, s42, s43
    buffer_store_dwordx4 v[72:75], v21, s[56:59], s42 offen sc1
    s_mul_i32 s42, s28, 3
    s_add_u32 s42, s42, 2
    s_lshr_b32 s43, s42, 2
    s_lshl_b32 s43, s43, 12
    s_and_b32 s42, s42, 3
    s_lshl_b32 s42, s42, 6
    s_add_u32 s42, s42, s43
    buffer_store_dwordx4 v[76:79], v21, s[56:59], s42 offen sc1
    s_mov_b64 exec, -1
    s_or_b32 s40, s24, s25
    s_or_b32 s40, s40, s28
    s_cmp_lg_u32 s40, 0
    s_cbranch_scc1 g1_nocr
    v_lshlrev_b32 v21, 8, v2
    v_mov_b32 v22, 0
    s_add_u32 s84, s4, 0x300000
    s_addc_u32 s85, s5, 0
    s_mov_b32 s86, 0x4000
    s_mov_b32 s87, 0x20000
    buffer_store_dword v22, v21, s[84:87], 0 offen sc1
    s_add_u32 s84, s4, 0x2b00000
    s_addc_u32 s85, s5, 0
    s_mov_b32 s86, 0x4000
    s_mov_b32 s87, 0x20000
    buffer_store_dword v22, v21, s[84:87], 0 offen sc1
g1_nocr:
    s_branch g1_ld_c0
g1_ld_w1:
    s_waitcnt vmcnt(12)
    s_branch g1_ld_bar
g1_ld_h1:
    v_mov_b32 v21, 0
    v_mov_b32 v22, 1
    s_mov_b64 exec, 1
    buffer_atomic_add v22, v21, s[60:63], 0 offen sc1
    s_mov_b64 exec, -1
    s_branch g1_ld_c1
g1_ld_w2:
    s_waitcnt vmcnt(12)
    s_branch g1_ld_bar
g1_ld_h2:
    v_mov_b32 v21, 0
    buffer_load_dword v23, v21, s[60:63], 0 offen sc1
    s_branch g1_ld_c2
g1_ld_end:
    s_add_u32 s28, s28, 4
    s_branch g1_attn
g1_compute:
    s_and_b32 s44, s28, 1
    s_lshr_b32 s45, s28, 1
    s_lshl_b32 s42, s44, 1
    s_mov_b32 s43, 0
    v_and_b32 v3, 1, v5
    v_lshlrev_b32 v3, 1, v3
    v_lshrrev_b32 v4, 1, v6
    v_or_b32 v3, v3, v4
    s_add_u32 s40, s42, 0
    v_xor_b32 v3, s40, v3
    v_lshlrev_b32 v3, 5, v3
    v_lshl_add_u32 v3, v7, 3, v3
    v_lshl_add_u32 v4, v5, 3, v6
    v_lshl_add_u32 v3, v4, 7, v3
    v_add_u32 v10, s43, v3
    v_and_b32 v3, 1, v5
    v_lshlrev_b32 v3, 1, v3
    v_lshrrev_b32 v4, 1, v6
    v_or_b32 v3, v3, v4
    s_add_u32 s40, s42, 1
    v_xor_b32 v3, s40, v3
    v_lshlrev_b32 v3, 5, v3
    v_lshl_add_u32 v3, v7, 3, v3
    v_lshl_add_u32 v4, v5, 3, v6
    v_lshl_add_u32 v3, v4, 7, v3
    v_add_u32 v11, s43, v3
    s_xor_b32 s43, s45, 1
    s_add_u32 s43, s43, 1
    s_mul_i32 s43, s43, 8192
    v_and_b32 v3, 1, v5
    v_lshlrev_b32 v3, 1, v3
    v_lshrrev_b32 v4, 1, v6
    v_or_b32 v3, v3, v4
    s_add_u32 s40, s42, 0
    v_xor_b32 v3, s40, v3
    v_lshlrev_b32 v3, 5, v3
    v_lshl_add_u32 v3, v7, 3, v3
    v_lshl_add_u32 v4, v5, 3, v6
    v_lshl_add_u32 v3, v4, 7, v3
    v_add_u32 v12, s43, v3
    v_and_b32 v3, 1, v5
    v_lshlrev_b32 v3, 1, v3
    v_lshrrev_b32 v4, 1, v6
    v_or_b32 v3, v3, v4
    s_add_u32 s40, s42, 1
    v_xor_b32 v3, s40, v3
    v_lshlrev_b32 v3, 5, v3
    v_lshl_add_u32 v3, v7, 3, v3
    v_lshl_add_u32 v4, v5, 3, v6
    v_lshl_add_u32 v3, v4, 7, v3
    v_add_u32 v13, s43, v3
    s_xor_b32 s43, s45, 0
    s_add_u32 s43, s43, 1
    s_mul_i32 s43, s43, 8192
    v_and_b32 v3, 1, v5
    v_lshlrev_b32 v3, 1, v3
    v_lshrrev_b32 v4, 1, v6
    v_or_b32 v3, v3, v4
    s_add_u32 s40, s42, 0
    v_xor_b32 v3, s40, v3
    v_lshlrev_b32 v3, 5, v3
    v_lshl_add_u32 v3, v7, 3, v3
    v_lshl_add_u32 v4, v5, 3, v6
    v_lshl_add_u32 v3, v4, 7, v3
    v_add_u32 v14, s43, v3
    v_and_b32 v3, 1, v5
    v_lshlrev_b32 v3, 1, v3
    v_lshrrev_b32 v4, 1, v6
    v_or_b32 v3, v3, v4
    s_add_u32 s40, s42, 1
    v_xor_b32 v3, s40, v3
    v_lshlrev_b32 v3, 5, v3
    v_lshl_add_u32 v3, v7, 3, v3
    v_lshl_add_u32 v4, v5, 3, v6
    v_lshl_add_u32 v3, v4, 7, v3
    v_add_u32 v15, s43, v3
    s_mul_i32 s42, s45, 64
    s_add_u32 s42, s42, 16
    v_lshrrev_b32 v3, 1, v8
    v_xor_b32 v3, v3, v5
    v_lshlrev_b32 v3, 4, v3
    v_lshl_add_u32 v3, v8, 7, v3
    s_lshl_b32 s40, s42, 7
    s_add_u32 s40, s40, 24576
    v_add_u32 v16, s40, v3
    v_xor_b32 v17, 64, v16
    v_lshrrev_b32 v3, 1, v8
    v_xor_b32 v3, v3, v5
    v_lshlrev_b32 v3, 4, v3
    v_lshl_add_u32 v3, v8, 7, v3
    v_add_u32 v18, 24576, v3
    v_xor_b32 v19, 64, v18
    v_mov_b32 v24, 0
    v_mov_b32 v25, 0
    v_mov_b32 v26, 0
    v_mov_b32 v27, 0
    v_mov_b32 v28, 0
    v_mov_b32 v29, 0
    v_mov_b32 v30, 0
    v_mov_b32 v31, 0
    v_mov_b32 v32, 0
    v_mov_b32 v33, 0
    v_mov_b32 v34, 0
    v_mov_b32 v35, 0
    v_mov_b32 v36, 0
    v_mov_b32 v37, 0
    v_mov_b32 v38, 0
    v_mov_b32 v39, 0
    v_mov_b32 v40, 0
    v_mov_b32 v41, 0
    v_mov_b32 v42, 0
    v_mov_b32 v43, 0
    v_mov_b32 v44, 0
    v_mov_b32 v45, 0
    v_mov_b32 v46, 0
    v_mov_b32 v47, 0
    v_mov_b32 v48, 0
    v_mov_b32 v49, 0
    v_mov_b32 v50, 0
    v_mov_b32 v51, 0
    v_mov_b32 v52, 0
    v_mov_b32 v53, 0
    v_mov_b32 v54, 0
    v_mov_b32 v55, 0
    v_mov_b32 v56, 0
    v_mov_b32 v57, 0
    v_mov_b32 v58, 0
    v_mov_b32 v59, 0
    v_mov_b32 v60, 0
    v_mov_b32 v61, 0
    v_mov_b32 v62, 0
    v_mov_b32 v63, 0
    v_mov_b32 v64, 0
    v_mov_b32 v65, 0
    v_mov_b32 v66, 0
    v_mov_b32 v67, 0
    v_mov_b32 v68, 0
    v_mov_b32 v69, 0
    v_mov_b32 v70, 0
    v_mov_b32 v71, 0
    v_mov_b32 v72, 0
    v_mov_b32 v73, 0
    v_mov_b32 v74, 0
    v_mov_b32 v75, 0
    v_mov_b32 v76, 0
    v_mov_b32 v77, 0
    v_mov_b32 v78, 0
    v_mov_b32 v79, 0
    v_mov_b32 v80, 0
    v_mov_b32 v81, 0
    v_mov_b32 v82, 0
    v_mov_b32 v83, 0
    v_mov_b32 v84, 0
    v_mov_b32 v85, 0
    v_mov_b32 v86, 0
    v_mov_b32 v87, 0
    v_mov_b32 v88, 0
    v_mov_b32 v89, 0
    v_mov_b32 v90, 0
    v_mov_b32 v91, 0
    v_mov_b32 v92, 0
    v_mov_b32 v93, 0
    v_mov_b32 v94, 0
    v_mov_b32 v95, 0
    v_mov_b32 v96, 0
    v_mov_b32 v97, 0
    v_mov_b32 v98, 0
    v_mov_b32 v99, 0
    v_mov_b32 v100, 0
    v_mov_b32 v101, 0
    v_mov_b32 v102, 0
    v_mov_b32 v103, 0
    v_mov_b32 v104, 0
    v_mov_b32 v105, 0
    v_mov_b32 v106, 0
    v_mov_b32 v107, 0
    v_mov_b32 v108, 0
    v_mov_b32 v109, 0
    v_mov_b32 v110, 0
    v_mov_b32 v111, 0
    v_mov_b32 v112, 0
    v_mov_b32 v113, 0
    v_mov_b32 v114, 0
    v_mov_b32 v115, 0
    v_mov_b32 v116, 0
    v_mov_b32 v117, 0
    v_mov_b32 v118, 0
    v_mov_b32 v119, 0
    v_mov_b32 v120, 0
    v_mov_b32 v121, 0
    v_mov_b32 v122, 0
    v_mov_b32 v123, 0
    v_mov_b32 v124, 0
    v_mov_b32 v125, 0
    v_mov_b32 v126, 0
    v_mov_b32 v127, 0
    v_mov_b32 v172, 0
    v_mov_b32 v173, 0
    v_mov_b32 v174, 0
    v_mov_b32 v175, 0
    v_mov_b32 v176, 0
    v_mov_b32 v177, 0
    v_mov_b32 v178, 0
    v_mov_b32 v179, 0
    v_mov_b32 v180, 0
    v_mov_b32 v181, 0
    v_mov_b32 v182, 0
    v_mov_b32 v183, 0
    v_mov_b32 v184, 0
    v_mov_b32 v185, 0
    v_mov_b32 v186, 0
    v_mov_b32 v187, 0
    v_mov_b32 v188, 0
    v_mov_b32 v189, 0
    v_mov_b32 v190, 0
    v_mov_b32 v191, 0
    v_mov_b32 v192, 0
    v_mov_b32 v193, 0
    v_mov_b32 v194, 0
    v_mov_b32 v195, 0
    v_mov_b32 v196, 0
    v_mov_b32 v197, 0
    v_mov_b32 v198, 0
    v_mov_b32 v199, 0
    v_mov_b32 v200, 0
    v_mov_b32 v201, 0
    v_mov_b32 v202, 0
    v_mov_b32 v203, 0
    v_mov_b32 v204, 0
    v_mov_b32 v205, 0
    v_mov_b32 v206, 0
    v_mov_b32 v207, 0
    v_mov_b32 v208, 0
    v_mov_b32 v209, 0
    v_mov_b32 v210, 0
    v_mov_b32 v211, 0
    v_mov_b32 v212, 0
    v_mov_b32 v213, 0
    v_mov_b32 v214, 0
    v_mov_b32 v215, 0
    s_mov_b32 s48, 16
    s_mov_b32 s50, 0
    s_mov_b32 s51, 43008
    s_mov_b32 s29, 0xfffeb000
    s_waitcnt lgkmcnt(0)
    s_add_u32 s4, s4, s97
    s_addc_u32 s5, s5, 0
.p2align 3
g1_cloop:
    s_barrier
g1_cloop2:
    v_mfma_f32_16x16x32_bf16 v[24:27], v[172:175], v[196:199], v[24:27]
    ds_read_b64_tr_b16 v[128:129], v10 offset:0
    ds_read_b64_tr_b16 v[130:131], v10 offset:512
    v_mfma_f32_16x16x32_bf16 v[28:31], v[172:175], v[200:203], v[28:31]
    ds_read_b128 v[152:155], v16 offset:0
    v_mfma_f32_16x16x32_bf16 v[32:35], v[172:175], v[204:207], v[32:35]
    ds_read_b128 v[156:159], v16 offset:2048
    v_mfma_f32_16x16x32_bf16 v[36:39], v[172:175], v[208:211], v[36:39]
    ds_read_b128 v[160:163], v16 offset:4096
    v_mfma_f32_16x16x32_bf16 v[40:43], v[176:179], v[196:199], v[40:43]
    ds_read_b128 v[164:167], v16 offset:6144
    v_mfma_f32_16x16x32_bf16 v[44:47], v[176:179], v[200:203], v[44:47]
    ds_read_b64_tr_b16 v[132:133], v11 offset:0
    ds_read_b64_tr_b16 v[134:135], v11 offset:512
    v_mfma_f32_16x16x32_bf16 v[48:51], v[176:179], v[204:207], v[48:51]
    ds_read_b64_tr_b16 v[136:137], v12 offset:0
    ds_read_b64_tr_b16 v[138:139], v12 offset:512
    v_mfma_f32_16x16x32_bf16 v[52:55], v[176:179], v[208:211], v[52:55]
    ds_read_b64_tr_b16 v[140:141], v13 offset:0
    ds_read_b64_tr_b16 v[142:143], v13 offset:512
    v_mfma_f32_16x16x32_bf16 v[56:59], v[180:183], v[196:199], v[56:59]
    ds_read_b64_tr_b16 v[144:145], v14 offset:0
    ds_read_b64_tr_b16 v[146:147], v14 offset:512
    v_mfma_f32_16x16x32_bf16 v[60:63], v[180:183], v[200:203], v[60:63]
    ds_read_b64_tr_b16 v[148:149], v15 offset:0
    ds_read_b64_tr_b16 v[150:151], v15 offset:512
    v_mfma_f32_16x16x32_bf16 v[64:67], v[180:183], v[204:207], v[64:67]
    ds_read_b128 v[168:171], v18 offset:0
    v_mfma_f32_16x16x32_bf16 v[68:71], v[180:183], v[208:211], v[68:71]
    v_mfma_f32_16x16x32_bf16 v[72:75], v[184:187], v[196:199], v[72:75]
    v_mfma_f32_16x16x32_bf16 v[76:79], v[184:187], v[200:203], v[76:79]
    v_mfma_f32_16x16x32_bf16 v[80:83], v[184:187], v[204:207], v[80:83]
    v_mfma_f32_16x16x32_bf16 v[84:87], v[184:187], v[208:211], v[84:87]
    v_mfma_f32_16x16x32_bf16 v[88:91], v[188:191], v[196:199], v[88:91]
    v_mfma_f32_16x16x32_bf16 v[92:95], v[188:191], v[200:203], v[92:95]
    v_mfma_f32_16x16x32_bf16 v[96:99], v[188:191], v[204:207], v[96:99]
    v_mfma_f32_16x16x32_bf16 v[100:103], v[188:191], v[208:211], v[100:103]
    v_mfma_f32_16x16x32_bf16 v[104:107], v[192:195], v[196:199], v[104:107]
    v_mfma_f32_16x16x32_bf16 v[108:111], v[192:195], v[200:203], v[108:111]
    v_mfma_f32_16x16x32_bf16 v[112:115], v[192:195], v[204:207], v[112:115]
    v_mfma_f32_16x16x32_bf16 v[116:119], v[192:195], v[208:211], v[116:119]
    v_mfma_f32_16x16x32_bf16 v[120:123], v[188:191], v[212:215], v[120:123]
    v_mfma_f32_16x16x32_bf16 v[124:127], v[192:195], v[212:215], v[124:127]
    s_waitcnt lgkmcnt(0)
    v_mfma_f32_16x16x32_bf16 v[24:27], v[128:131], v[152:155], v[24:27]
    ds_read_b64_tr_b16 v[172:173], v10 offset:4096
    ds_read_b64_tr_b16 v[174:175], v10 offset:4608
    v_mfma_f32_16x16x32_bf16 v[28:31], v[128:131], v[156:159], v[28:31]
    ds_read_b128 v[196:199], v17 offset:0
    v_mfma_f32_16x16x32_bf16 v[32:35], v[128:131], v[160:163], v[32:35]
    ds_read_b128 v[200:203], v17 offset:2048
    v_mfma_f32_16x16x32_bf16 v[36:39], v[128:131], v[164:167], v[36:39]
    ds_read_b128 v[204:207], v17 offset:4096
    v_mfma_f32_16x16x32_bf16 v[40:43], v[132:135], v[152:155], v[40:43]
    ds_read_b128 v[208:211], v17 offset:6144
    v_mfma_f32_16x16x32_bf16 v[44:47], v[132:135], v[156:159], v[44:47]
    ds_read_b64_tr_b16 v[176:177], v11 offset:4096
    ds_read_b64_tr_b16 v[178:179], v11 offset:4608
    v_mfma_f32_16x16x32_bf16 v[48:51], v[132:135], v[160:163], v[48:51]
    ds_read_b64_tr_b16 v[180:181], v12 offset:4096
    ds_read_b64_tr_b16 v[182:183], v12 offset:4608
    v_mfma_f32_16x16x32_bf16 v[52:55], v[132:135], v[164:167], v[52:55]
    ds_read_b64_tr_b16 v[184:185], v13 offset:4096
    ds_read_b64_tr_b16 v[186:187], v13 offset:4608
    v_mfma_f32_16x16x32_bf16 v[56:59], v[136:139], v[152:155], v[56:59]
    ds_read_b64_tr_b16 v[188:189], v14 offset:4096
    ds_read_b64_tr_b16 v[190:191], v14 offset:4608
    v_mfma_f32_16x16x32_bf16 v[60:63], v[136:139], v[156:159], v[60:63]
    ds_read_b64_tr_b16 v[192:193], v15 offset:4096
    ds_read_b64_tr_b16 v[194:195], v15 offset:4608
    v_mfma_f32_16x16x32_bf16 v[64:67], v[136:139], v[160:163], v[64:67]
    ds_read_b128 v[212:215], v19 offset:0
    v_mfma_f32_16x16x32_bf16 v[68:71], v[136:139], v[164:167], v[68:71]
    s_add_u32 s50, s50, 1
    s_cmp_eq_u32 s50, 3
    v_mfma_f32_16x16x32_bf16 v[72:75], v[140:143], v[152:155], v[72:75]
    s_cselect_b32 s49, s29, s51
    s_cselect_b32 s50, 0, s50
    v_mfma_f32_16x16x32_bf16 v[76:79], v[140:143], v[156:159], v[76:79]
    v_add_u32 v10, s49, v10
    v_add_u32 v11, s49, v11
    v_mfma_f32_16x16x32_bf16 v[80:83], v[140:143], v[160:163], v[80:83]
    v_add_u32 v12, s49, v12
    v_add_u32 v13, s49, v13
    v_mfma_f32_16x16x32_bf16 v[84:87], v[140:143], v[164:167], v[84:87]
    v_add_u32 v14, s49, v14
    v_add_u32 v15, s49, v15
    v_mfma_f32_16x16x32_bf16 v[88:91], v[144:147], v[152:155], v[88:91]
    v_add_u32 v16, s49, v16
    v_add_u32 v17, s49, v17
    v_mfma_f32_16x16x32_bf16 v[92:95], v[144:147], v[156:159], v[92:95]
    v_add_u32 v18, s49, v18
    v_add_u32 v19, s49, v19
    v_mfma_f32_16x16x32_bf16 v[96:99], v[144:147], v[160:163], v[96:99]
    s_sub_u32 s48, s48, 1
    s_cmp_lg_u32 s48, 0
    v_mfma_f32_16x16x32_bf16 v[100:103], v[144:147], v[164:167], v[100:103]
    v_mfma_f32_16x16x32_bf16 v[104:107], v[148:151], v[152:155], v[104:107]
    v_mfma_f32_16x16x32_bf16 v[108:111], v[148:151], v[156:159], v[108:111]
    v_mfma_f32_16x16x32_bf16 v[112:115], v[148:151], v[160:163], v[112:115]
    v_mfma_f32_16x16x32_bf16 v[116:119], v[148:151], v[164:167], v[116:119]
    v_mfma_f32_16x16x32_bf16 v[120:123], v[144:147], v[168:171], v[120:123]
    v_mfma_f32_16x16x32_bf16 v[124:127], v[148:151], v[168:171], v[124:127]
    s_waitcnt lgkmcnt(0)
    s_cbranch_scc1 g1_cloop
    v_mfma_f32_16x16x32_bf16 v[24:27], v[172:175], v[196:199], v[24:27]
    v_mfma_f32_16x16x32_bf16 v[28:31], v[172:175], v[200:203], v[28:31]
    v_mfma_f32_16x16x32_bf16 v[32:35], v[172:175], v[204:207], v[32:35]
    v_mfma_f32_16x16x32_bf16 v[36:39], v[172:175], v[208:211], v[36:39]
    v_mfma_f32_16x16x32_bf16 v[40:43], v[176:179], v[196:199], v[40:43]
    v_mfma_f32_16x16x32_bf16 v[44:47], v[176:179], v[200:203], v[44:47]
    v_mfma_f32_16x16x32_bf16 v[48:51], v[176:179], v[204:207], v[48:51]
    v_mfma_f32_16x16x32_bf16 v[52:55], v[176:179], v[208:211], v[52:55]
    v_mfma_f32_16x16x32_bf16 v[56:59], v[180:183], v[196:199], v[56:59]
    v_mfma_f32_16x16x32_bf16 v[60:63], v[180:183], v[200:203], v[60:63]
    v_mfma_f32_16x16x32_bf16 v[64:67], v[180:183], v[204:207], v[64:67]
    v_mfma_f32_16x16x32_bf16 v[68:71], v[180:183], v[208:211], v[68:71]
    v_mfma_f32_16x16x32_bf16 v[72:75], v[184:187], v[196:199], v[72:75]
    v_mfma_f32_16x16x32_bf16 v[76:79], v[184:187], v[200:203], v[76:79]
    v_mfma_f32_16x16x32_bf16 v[80:83], v[184:187], v[204:207], v[80:83]
    v_mfma_f32_16x16x32_bf16 v[84:87], v[184:187], v[208:211], v[84:87]
    v_mfma_f32_16x16x32_bf16 v[88:91], v[188:191], v[196:199], v[88:91]
    v_mfma_f32_16x16x32_bf16 v[92:95], v[188:191], v[200:203], v[92:95]
    v_mfma_f32_16x16x32_bf16 v[96:99], v[188:191], v[204:207], v[96:99]
    v_mfma_f32_16x16x32_bf16 v[100:103], v[188:191], v[208:211], v[100:103]
    v_mfma_f32_16x16x32_bf16 v[104:107], v[192:195], v[196:199], v[104:107]
    v_mfma_f32_16x16x32_bf16 v[108:111], v[192:195], v[200:203], v[108:111]
    v_mfma_f32_16x16x32_bf16 v[112:115], v[192:195], v[204:207], v[112:115]
    v_mfma_f32_16x16x32_bf16 v[116:119], v[192:195], v[208:211], v[116:119]
    v_mfma_f32_16x16x32_bf16 v[120:123], v[188:191], v[212:215], v[120:123]
    v_mfma_f32_16x16x32_bf16 v[124:127], v[192:195], v[212:215], v[124:127]
    s_barrier
    v_lshlrev_b32 v3, 3, v8
    v_add_u32 v4, 129024, v3
    s_mul_i32 s40, s45, 512
    s_add_u32 s40, s40, 129152
    v_add_u32 v3, s40, v3
    ds_read_b64 v[128:129], v3 offset:0
    ds_read_b64 v[130:131], v3 offset:128
    ds_read_b64 v[132:133], v3 offset:256
    ds_read_b64 v[134:135], v3 offset:384
    ds_read_b64 v[136:137], v4
    s_lshl_b32 s40, s44, 7
    s_add_u32 s40, s40, 130304
    v_lshl_add_u32 v3, v5, 4, s40
    s_mov_b32 s43, 0
    v_add_u32 v4, s43, v3
    ds_read_b128 v[140:143], v4 offset:0
    ds_read_b128 v[144:147], v4 offset:64
    s_xor_b32 s43, s45, 1
    s_add_u32 s43, s43, 1
    s_mul_i32 s43, s43, 256
    v_add_u32 v4, s43, v3
    ds_read_b128 v[148:151], v4 offset:0
    ds_read_b128 v[152:155], v4 offset:64
    s_xor_b32 s43, s45, 0
    s_add_u32 s43, s43, 1
    s_mul_i32 s43, s43, 256
    v_add_u32 v4, s43, v3
    ds_read_b128 v[156:159], v4 offset:0
    ds_read_b128 v[160:163], v4 offset:64
    v_and_b32 v3, 1, v5
    v_lshlrev_b32 v3, 1, v3
    v_lshrrev_b32 v4, 1, v5
    v_add_u32 v3, v3, v4
    s_lshl_b32 s40, s44, 2
    v_add_u32 v3, s40, v3
    v_lshrrev_b32 v4, 1, v8
    v_xor_b32 v3, v3, v4
    v_lshlrev_b32 v3, 4, v3
    v_lshl_add_u32 v3, v8, 7, v3
    s_mul_i32 s42, s45, 8192
    s_add_u32 s42, s42, 45056
    s_mov_b32 s43, 0
    s_add_u32 s40, s42, s43
    v_add_u32 v10, s40, v3
    s_xor_b32 s43, s45, 1
    s_add_u32 s43, s43, 1
    s_mul_i32 s43, s43, 18432
    s_add_u32 s40, s42, s43
    v_add_u32 v11, s40, v3
    s_xor_b32 s43, s45, 0
    s_add_u32 s43, s43, 1
    s_mul_i32 s43, s43, 18432
    s_add_u32 s40, s42, s43
    v_add_u32 v12, s40, v3
    s_add_u32 s40, s43, 43008
    v_add_u32 v13, s40, v3
    s_waitcnt lgkmcnt(0)
    v_pk_mul_f32 v[164:165], v[140:141], v[128:129] op_sel:[0,1] op_sel_hi:[1,1]
    v_pk_mul_f32 v[166:167], v[142:143], v[128:129] op_sel:[0,1] op_sel_hi:[1,1]
    v_pk_mul_f32 v[168:169], v[144:145], v[128:129] op_sel:[0,1] op_sel_hi:[1,1]
    v_pk_mul_f32 v[170:171], v[146:147], v[128:129] op_sel:[0,1] op_sel_hi:[1,1]
    v_pk_fma_f32 v[24:25], v[24:25], v[128:129], v[164:165] op_sel:[0,0,0] op_sel_hi:[1,0,1]
    v_pk_fma_f32 v[26:27], v[26:27], v[128:129], v[166:167] op_sel:[0,0,0] op_sel_hi:[1,0,1]
    v_pk_fma_f32 v[40:41], v[40:41], v[128:129], v[168:169] op_sel:[0,0,0] op_sel_hi:[1,0,1]
    v_pk_fma_f32 v[42:43], v[42:43], v[128:129], v[170:171] op_sel:[0,0,0] op_sel_hi:[1,0,1]
    v_cvt_pk_bf16_f32 v172, v24, v25
    v_cvt_pk_bf16_f32 v173, v26, v27
    v_cvt_pk_bf16_f32 v174, v40, v41
    v_cvt_pk_bf16_f32 v175, v42, v43
    s_nop 1
    v_permlane16_swap_b32 v172, v174
    v_permlane16_swap_b32 v173, v175
    ds_write_b128 v10, v[172:175] offset:0
    v_pk_mul_f32 v[164:165], v[140:141], v[130:131] op_sel:[0,1] op_sel_hi:[1,1]
    v_pk_mul_f32 v[166:167], v[142:143], v[130:131] op_sel:[0,1] op_sel_hi:[1,1]
    v_pk_mul_f32 v[168:169], v[144:145], v[130:131] op_sel:[0,1] op_sel_hi:[1,1]
    v_pk_mul_f32 v[170:171], v[146:147], v[130:131] op_sel:[0,1] op_sel_hi:[1,1]
    v_pk_fma_f32 v[28:29], v[28:29], v[130:131], v[164:165] op_sel:[0,0,0] op_sel_hi:[1,0,1]
    v_pk_fma_f32 v[30:31], v[30:31], v[130:131], v[166:167] op_sel:[0,0,0] op_sel_hi:[1,0,1]
    v_pk_fma_f32 v[44:45], v[44:45], v[130:131], v[168:169] op_sel:[0,0,0] op_sel_hi:[1,0,1]
    v_pk_fma_f32 v[46:47], v[46:47], v[130:131], v[170:171] op_sel:[0,0,0] op_sel_hi:[1,0,1]
    v_cvt_pk_bf16_f32 v176, v28, v29
    v_cvt_pk_bf16_f32 v177, v30, v31
    v_cvt_pk_bf16_f32 v178, v44, v45
    v_cvt_pk_bf16_f32 v179, v46, v47
    s_nop 1
    v_permlane16_swap_b32 v176, v178
    v_permlane16_swap_b32 v177, v179
    ds_write_b128 v10, v[176:179] offset:2048
    v_pk_mul_f32 v[164:165], v[140:141], v[132:133] op_sel:[0,1] op_sel_hi:[1,1]
    v_pk_mul_f32 v[166:167], v[142:143], v[132:133] op_sel:[0,1] op_sel_hi:[1,1]
    v_pk_mul_f32 v[168:169], v[144:145], v[132:133] op_sel:[0,1] op_sel_hi:[1,1]
    v_pk_mul_f32 v[170:171], v[146:147], v[132:133] op_sel:[0,1] op_sel_hi:[1,1]
    v_pk_fma_f32 v[32:33], v[32:33], v[132:133], v[164:165] op_sel:[0,0,0] op_sel_hi:[1,0,1]
    v_pk_fma_f32 v[34:35], v[34:35], v[132:133], v[166:167] op_sel:[0,0,0] op_sel_hi:[1,0,1]
    v_pk_fma_f32 v[48:49], v[48:49], v[132:133], v[168:169] op_sel:[0,0,0] op_sel_hi:[1,0,1]
    v_pk_fma_f32 v[50:51], v[50:51], v[132:133], v[170:171] op_sel:[0,0,0] op_sel_hi:[1,0,1]
    v_cvt_pk_bf16_f32 v180, v32, v33
    v_cvt_pk_bf16_f32 v181, v34, v35
    v_cvt_pk_bf16_f32 v182, v48, v49
    v_cvt_pk_bf16_f32 v183, v50, v51
    s_nop 1
    v_permlane16_swap_b32 v180, v182
    v_permlane16_swap_b32 v181, v183
    ds_write_b128 v10, v[180:183] offset:4096
    v_pk_mul_f32 v[164:165], v[140:141], v[134:135] op_sel:[0,1] op_sel_hi:[1,1]
    v_pk_mul_f32 v[166:167], v[142:143], v[134:135] op_sel:[0,1] op_sel_hi:[1,1]
    v_pk_mul_f32 v[168:169], v[144:145], v[134:135] op_sel:[0,1] op_sel_hi:[1,1]
    v_pk_mul_f32 v[170:171], v[146:147], v[134:135] op_sel:[0,1] op_sel_hi:[1,1]
    v_pk_fma_f32 v[36:37], v[36:37], v[134:135], v[164:165] op_sel:[0,0,0] op_sel_hi:[1,0,1]
    v_pk_fma_f32 v[38:39], v[38:39], v[134:135], v[166:167] op_sel:[0,0,0] op_sel_hi:[1,0,1]
    v_pk_fma_f32 v[52:53], v[52:53], v[134:135], v[168:169] op_sel:[0,0,0] op_sel_hi:[1,0,1]
    v_pk_fma_f32 v[54:55], v[54:55], v[134:135], v[170:171] op_sel:[0,0,0] op_sel_hi:[1,0,1]
    v_cvt_pk_bf16_f32 v184, v36, v37
    v_cvt_pk_bf16_f32 v185, v38, v39
    v_cvt_pk_bf16_f32 v186, v52, v53
    v_cvt_pk_bf16_f32 v187, v54, v55
    s_nop 1
    v_permlane16_swap_b32 v184, v186
    v_permlane16_swap_b32 v185, v187
    ds_write_b128 v10, v[184:187] offset:6144
    v_pk_mul_f32 v[164:165], v[148:149], v[128:129] op_sel:[0,1] op_sel_hi:[1,1]
    v_pk_mul_f32 v[166:167], v[150:151], v[128:129] op_sel:[0,1] op_sel_hi:[1,1]
    v_pk_mul_f32 v[168:169], v[152:153], v[128:129] op_sel:[0,1] op_sel_hi:[1,1]
    v_pk_mul_f32 v[170:171], v[154:155], v[128:129] op_sel:[0,1] op_sel_hi:[1,1]
    v_pk_fma_f32 v[56:57], v[56:57], v[128:129], v[164:165] op_sel:[0,0,0] op_sel_hi:[1,0,1]
    v_pk_fma_f32 v[58:59], v[58:59], v[128:129], v[166:167] op_sel:[0,0,0] op_sel_hi:[1,0,1]
    v_pk_fma_f32 v[72:73], v[72:73], v[128:129], v[168:169] op_sel:[0,0,0] op_sel_hi:[1,0,1]
    v_pk_fma_f32 v[74:75], v[74:75], v[128:129], v[170:171] op_sel:[0,0,0] op_sel_hi:[1,0,1]
    v_cvt_pk_bf16_f32 v172, v56, v57
    v_cvt_pk_bf16_f32 v173, v58, v59
    v_cvt_pk_bf16_f32 v174, v72, v73
    v_cvt_pk_bf16_f32 v175, v74, v75
    s_nop 1
    v_permlane16_swap_b32 v172, v174
    v_permlane16_swap_b32 v173, v175
    ds_write_b128 v11, v[172:175] offset:0
    v_pk_mul_f32 v[164:165], v[148:149], v[130:131] op_sel:[0,1] op_sel_hi:[1,1]
    v_pk_mul_f32 v[166:167], v[150:151], v[130:131] op_sel:[0,1] op_sel_hi:[1,1]
    v_pk_mul_f32 v[168:169], v[152:153], v[130:131] op_sel:[0,1] op_sel_hi:[1,1]
    v_pk_mul_f32 v[170:171], v[154:155], v[130:131] op_sel:[0,1] op_sel_hi:[1,1]
    v_pk_fma_f32 v[60:61], v[60:61], v[130:131], v[164:165] op_sel:[0,0,0] op_sel_hi:[1,0,1]
    v_pk_fma_f32 v[62:63], v[62:63], v[130:131], v[166:167] op_sel:[0,0,0] op_sel_hi:[1,0,1]
    v_pk_fma_f32 v[76:77], v[76:77], v[130:131], v[168:169] op_sel:[0,0,0] op_sel_hi:[1,0,1]
    v_pk_fma_f32 v[78:79], v[78:79], v[130:131], v[170:171] op_sel:[0,0,0] op_sel_hi:[1,0,1]
    v_cvt_pk_bf16_f32 v176, v60, v61
    v_cvt_pk_bf16_f32 v177, v62, v63
    v_cvt_pk_bf16_f32 v178, v76, v77
    v_cvt_pk_bf16_f32 v179, v78, v79
    s_nop 1
    v_permlane16_swap_b32 v176, v178
    v_permlane16_swap_b32 v177, v179
    ds_write_b128 v11, v[176:179] offset:2048
    v_pk_mul_f32 v[164:165], v[148:149], v[132:133] op_sel:[0,1] op_sel_hi:[1,1]
    v_pk_mul_f32 v[166:167], v[150:151], v[132:133] op_sel:[0,1] op_sel_hi:[1,1]
    v_pk_mul_f32 v[168:169], v[152:153], v[132:133] op_sel:[0,1] op_sel_hi:[1,1]
    v_pk_mul_f32 v[170:171], v[154:155], v[132:133] op_sel:[0,1] op_sel_hi:[1,1]
    v_pk_fma_f32 v[64:65], v[64:65], v[132:133], v[164:165] op_sel:[0,0,0] op_sel_hi:[1,0,1]
    v_pk_fma_f32 v[66:67], v[66:67], v[132:133], v[166:167] op_sel:[0,0,0] op_sel_hi:[1,0,1]
    v_pk_fma_f32 v[80:81], v[80:81], v[132:133], v[168:169] op_sel:[0,0,0] op_sel_hi:[1,0,1]
    v_pk_fma_f32 v[82:83], v[82:83], v[132:133], v[170:171] op_sel:[0,0,0] op_sel_hi:[1,0,1]
    v_cvt_pk_bf16_f32 v180, v64, v65
    v_cvt_pk_bf16_f32 v181, v66, v67
    v_cvt_pk_bf16_f32 v182, v80, v81
    v_cvt_pk_bf16_f32 v183, v82, v83
    s_nop 1
    v_permlane16_swap_b32 v180, v182
    v_permlane16_swap_b32 v181, v183
    ds_write_b128 v11, v[180:183] offset:4096
    v_pk_mul_f32 v[164:165], v[148:149], v[134:135] op_sel:[0,1] op_sel_hi:[1,1]
    v_pk_mul_f32 v[166:167], v[150:151], v[134:135] op_sel:[0,1] op_sel_hi:[1,1]
    v_pk_mul_f32 v[168:169], v[152:153], v[134:135] op_sel:[0,1] op_sel_hi:[1,1]
    v_pk_mul_f32 v[170:171], v[154:155], v[134:135] op_sel:[0,1] op_sel_hi:[1,1]
    v_pk_fma_f32 v[68:69], v[68:69], v[134:135], v[164:165] op_sel:[0,0,0] op_sel_hi:[1,0,1]
    v_pk_fma_f32 v[70:71], v[70:71], v[134:135], v[166:167] op_sel:[0,0,0] op_sel_hi:[1,0,1]
    v_pk_fma_f32 v[84:85], v[84:85], v[134:135], v[168:169] op_sel:[0,0,0] op_sel_hi:[1,0,1]
    v_pk_fma_f32 v[86:87], v[86:87], v[134:135], v[170:171] op_sel:[0,0,0] op_sel_hi:[1,0,1]
    v_cvt_pk_bf16_f32 v184, v68, v69
    v_cvt_pk_bf16_f32 v185, v70, v71
    v_cvt_pk_bf16_f32 v186, v84, v85
    v_cvt_pk_bf16_f32 v187, v86, v87
    s_nop 1
    v_permlane16_swap_b32 v184, v186
    v_permlane16_swap_b32 v185, v187
    ds_write_b128 v11, v[184:187] offset:6144
    v_pk_mul_f32 v[164:165], v[156:157], v[128:129] op_sel:[0,1] op_sel_hi:[1,1]
    v_pk_mul_f32 v[166:167], v[158:159], v[128:129] op_sel:[0,1] op_sel_hi:[1,1]
    v_pk_mul_f32 v[168:169], v[160:161], v[128:129] op_sel:[0,1] op_sel_hi:[1,1]
    v_pk_mul_f32 v[170:171], v[162:163], v[128:129] op_sel:[0,1] op_sel_hi:[1,1]
    v_pk_fma_f32 v[88:89], v[88:89], v[128:129], v[164:165] op_sel:[0,0,0] op_sel_hi:[1,0,1]
    v_pk_fma_f32 v[90:91], v[90:91], v[128:129], v[166:167] op_sel:[0,0,0] op_sel_hi:[1,0,1]
    v_pk_fma_f32 v[104:105], v[104:105], v[128:129], v[168:169] op_sel:[0,0,0] op_sel_hi:[1,0,1]
    v_pk_fma_f32 v[106:107], v[106:107], v[128:129], v[170:171] op_sel:[0,0,0] op_sel_hi:[1,0,1]
    v_cvt_pk_bf16_f32 v172, v88, v89
    v_cvt_pk_bf16_f32 v173, v90, v91
    v_cvt_pk_bf16_f32 v174, v104, v105
    v_cvt_pk_bf16_f32 v175, v106, v107
    s_nop 1
    v_permlane16_swap_b32 v172, v174
    v_permlane16_swap_b32 v173, v175
    ds_write_b128 v12, v[172:175] offset:0
    v_pk_mul_f32 v[164:165], v[156:157], v[130:131] op_sel:[0,1] op_sel_hi:[1,1]
    v_pk_mul_f32 v[166:167], v[158:159], v[130:131] op_sel:[0,1] op_sel_hi:[1,1]
    v_pk_mul_f32 v[168:169], v[160:161], v[130:131] op_sel:[0,1] op_sel_hi:[1,1]
    v_pk_mul_f32 v[170:171], v[162:163], v[130:131] op_sel:[0,1] op_sel_hi:[1,1]
    v_pk_fma_f32 v[92:93], v[92:93], v[130:131], v[164:165] op_sel:[0,0,0] op_sel_hi:[1,0,1]
    v_pk_fma_f32 v[94:95], v[94:95], v[130:131], v[166:167] op_sel:[0,0,0] op_sel_hi:[1,0,1]
    v_pk_fma_f32 v[108:109], v[108:109], v[130:131], v[168:169] op_sel:[0,0,0] op_sel_hi:[1,0,1]
    v_pk_fma_f32 v[110:111], v[110:111], v[130:131], v[170:171] op_sel:[0,0,0] op_sel_hi:[1,0,1]
    v_cvt_pk_bf16_f32 v176, v92, v93
    v_cvt_pk_bf16_f32 v177, v94, v95
    v_cvt_pk_bf16_f32 v178, v108, v109
    v_cvt_pk_bf16_f32 v179, v110, v111
    s_nop 1
    v_permlane16_swap_b32 v176, v178
    v_permlane16_swap_b32 v177, v179
    ds_write_b128 v12, v[176:179] offset:2048
    v_pk_mul_f32 v[164:165], v[156:157], v[132:133] op_sel:[0,1] op_sel_hi:[1,1]
    v_pk_mul_f32 v[166:167], v[158:159], v[132:133] op_sel:[0,1] op_sel_hi:[1,1]
    v_pk_mul_f32 v[168:169], v[160:161], v[132:133] op_sel:[0,1] op_sel_hi:[1,1]
    v_pk_mul_f32 v[170:171], v[162:163], v[132:133] op_sel:[0,1] op_sel_hi:[1,1]
    v_pk_fma_f32 v[96:97], v[96:97], v[132:133], v[164:165] op_sel:[0,0,0] op_sel_hi:[1,0,1]
    v_pk_fma_f32 v[98:99], v[98:99], v[132:133], v[166:167] op_sel:[0,0,0] op_sel_hi:[1,0,1]
    v_pk_fma_f32 v[112:113], v[112:113], v[132:133], v[168:169] op_sel:[0,0,0] op_sel_hi:[1,0,1]
    v_pk_fma_f32 v[114:115], v[114:115], v[132:133], v[170:171] op_sel:[0,0,0] op_sel_hi:[1,0,1]
    v_cvt_pk_bf16_f32 v180, v96, v97
    v_cvt_pk_bf16_f32 v181, v98, v99
    v_cvt_pk_bf16_f32 v182, v112, v113
    v_cvt_pk_bf16_f32 v183, v114, v115
    s_nop 1
    v_permlane16_swap_b32 v180, v182
    v_permlane16_swap_b32 v181, v183
    ds_write_b128 v12, v[180:183] offset:4096
    v_pk_mul_f32 v[164:165], v[156:157], v[134:135] op_sel:[0,1] op_sel_hi:[1,1]
    v_pk_mul_f32 v[166:167], v[158:159], v[134:135] op_sel:[0,1] op_sel_hi:[1,1]
    v_pk_mul_f32 v[168:169], v[160:161], v[134:135] op_sel:[0,1] op_sel_hi:[1,1]
    v_pk_mul_f32 v[170:171], v[162:163], v[134:135] op_sel:[0,1] op_sel_hi:[1,1]
    v_pk_fma_f32 v[100:101], v[100:101], v[134:135], v[164:165] op_sel:[0,0,0] op_sel_hi:[1,0,1]
    v_pk_fma_f32 v[102:103], v[102:103], v[134:135], v[166:167] op_sel:[0,0,0] op_sel_hi:[1,0,1]
    v_pk_fma_f32 v[116:117], v[116:117], v[134:135], v[168:169] op_sel:[0,0,0] op_sel_hi:[1,0,1]
    v_pk_fma_f32 v[118:119], v[118:119], v[134:135], v[170:171] op_sel:[0,0,0] op_sel_hi:[1,0,1]
    v_cvt_pk_bf16_f32 v184, v100, v101
    v_cvt_pk_bf16_f32 v185, v102, v103
    v_cvt_pk_bf16_f32 v186, v116, v117
    v_cvt_pk_bf16_f32 v187, v118, v119
    s_nop 1
    v_permlane16_swap_b32 v184, v186
    v_permlane16_swap_b32 v185, v187
    ds_write_b128 v12, v[184:187] offset:6144
    v_pk_mul_f32 v[164:165], v[156:157], v[136:137] op_sel:[0,1] op_sel_hi:[1,1]
    v_pk_mul_f32 v[166:167], v[158:159], v[136:137] op_sel:[0,1] op_sel_hi:[1,1]
    v_pk_mul_f32 v[168:169], v[160:161], v[136:137] op_sel:[0,1] op_sel_hi:[1,1]
    v_pk_mul_f32 v[170:171], v[162:163], v[136:137] op_sel:[0,1] op_sel_hi:[1,1]
    v_pk_fma_f32 v[120:121], v[120:121], v[136:137], v[164:165] op_sel:[0,0,0] op_sel_hi:[1,0,1]
    v_pk_fma_f32 v[122:123], v[122:123], v[136:137], v[166:167] op_sel:[0,0,0] op_sel_hi:[1,0,1]
    v_pk_fma_f32 v[124:125], v[124:125], v[136:137], v[168:169] op_sel:[0,0,0] op_sel_hi:[1,0,1]
    v_pk_fma_f32 v[126:127], v[126:127], v[136:137], v[170:171] op_sel:[0,0,0] op_sel_hi:[1,0,1]
    v_cvt_pk_bf16_f32 v172, v120, v121
    v_cvt_pk_bf16_f32 v173, v122, v123
    v_cvt_pk_bf16_f32 v174, v124, v125
    v_cvt_pk_bf16_f32 v175, v126, v127
    s_nop 1
    v_permlane16_swap_b32 v172, v174
    v_permlane16_swap_b32 v173, v175
    ds_write_b128 v13, v[172:175]
    s_waitcnt lgkmcnt(0)
g1_attn:
    s_add_u32 s16, s4, 0x400000
    s_addc_u32 s17, s5, 0
    s_mov_b32 s18, 0x400000
    s_mov_b32 s19, 0x20000
    s_and_b32 s44, s28, 1
    s_lshr_b32 s45, s28, 1
    s_lshl_b32 s40, s44, 2
    v_add_u32 v3, s40, v5
    v_and_b32 v4, 7, v8
    v_xor_b32 v3, v3, v4
    v_lshlrev_b32 v3, 4, v3
    v_lshl_add_u32 v3, v8, 8, v3
    s_mul_i32 s41, s45, 4096
    s_add_u32 s41, s41, 43008
    v_add_u32 v10, s41, v3
    v_lshl_add_u32 v3, v5, 2, v6
    v_and_b32 v4, 7, v3
    v_add_u32 v12, s40, v7
    v_xor_b32 v4, v4, v12
    v_lshlrev_b32 v4, 4, v4
    v_lshl_add_u32 v3, v3, 8, v4
    s_add_u32 s41, s41, 36864
    v_add_u32 v11, s41, v3
    v_and_b32 v3, 7, v8
    v_add_u32 v4, 1, v3
    s_or_b32 s40, s25, s45
    s_cmp_eq_u32 s40, 0
    s_cselect_b32 s40, 8, 0
    v_cmp_gt_u32 vcc, 8, v8
    v_mov_b32 v16, s40
    s_mov_b64 s[56:57], vcc
    v_cndmask_b32 v16, 0, v16, vcc
    v_max_u32 v4, v4, v16
    v_add_u32 v3, 8, v3
    v_sub_u32 v3, v3, v4
    v_lshlrev_b32 v16, 2, v5
    v_sub_u32 v16, v16, v4
    v_mov_b32 v17, 0xf149f2ca
    v_add_u32 v18, 0, v16
    v_cmp_ge_u32 vcc, v3, v18
    s_nop 1
    v_cndmask_b32 v12, v17, 0, vcc
    v_add_u32 v18, 1, v16
    v_cmp_ge_u32 vcc, v3, v18
    s_nop 1
    v_cndmask_b32 v13, v17, 0, vcc
    v_add_u32 v18, 2, v16
    v_cmp_ge_u32 vcc, v3, v18
    s_nop 1
    v_cndmask_b32 v14, v17, 0, vcc
    v_add_u32 v18, 3, v16
    v_cmp_ge_u32 vcc, v3, v18
    s_nop 1
    v_cndmask_b32 v15, v17, 0, vcc
    s_lshl_b32 s40, s25, 7
    s_lshl_b32 s41, s45, 5
    s_add_u32 s40, s40, s41
    s_lshl_b32 s40, s40, 11
    s_lshl_b32 s41, s24, 7
    s_add_u32 s40, s40, s41
    s_lshl_b32 s41, s44, 6
    s_add_u32 s40, s40, s41
    v_lshlrev_b32 v9, 12, v8
    v_lshl_add_u32 v9, v5, 4, v9
    v_add_u32 v9, s40, v9
    s_mov_b32 s58, 0x3e3504f3
    s_mov_b32 s59, 0x3fb8aa3b
    s_barrier
    ds_read_b128 v[24:27], v10 offset:2048
    ds_read_b128 v[28:31], v10 offset:18432
    ds_read_b128 v[32:35], v10 offset:20480
    ds_read_b128 v[72:75], v10 offset:2176
    ds_read_b128 v[76:79], v10 offset:18560
    ds_read_b128 v[80:83], v10 offset:20608
    ds_read_b64_tr_b16 v[36:37], v11 offset:0
    ds_read_b64_tr_b16 v[38:39], v11 offset:2048
    ds_read_b64_tr_b16 v[40:41], v11 offset:8
    ds_read_b64_tr_b16 v[42:43], v11 offset:2056
    ds_read_b64_tr_b16 v[84:85], v11 offset:128
    ds_read_b64_tr_b16 v[86:87], v11 offset:2176
    ds_read_b64_tr_b16 v[88:89], v11 offset:136
    ds_read_b64_tr_b16 v[90:91], v11 offset:2184
    s_waitcnt lgkmcnt(8)
    v_mfma_f32_16x16x32_bf16 v[44:47], v[28:31], v[24:27], 0
    v_mfma_f32_16x16x32_bf16 v[48:51], v[32:35], v[24:27], 0
    v_mfma_f32_16x16x32_bf16 v[92:95], v[76:79], v[72:75], 0
    v_mfma_f32_16x16x32_bf16 v[96:99], v[80:83], v[72:75], 0
    s_nop 7
    v_cndmask_b32 v44, v48, v44, s[56:57]
    v_cndmask_b32 v45, v49, v45, s[56:57]
    v_cndmask_b32 v46, v50, v46, s[56:57]
    v_cndmask_b32 v47, v51, v47, s[56:57]
    v_cndmask_b32 v92, v96, v92, s[56:57]
    v_cndmask_b32 v93, v97, v93, s[56:57]
    v_cndmask_b32 v94, v98, v94, s[56:57]
    v_cndmask_b32 v95, v99, v95, s[56:57]
    v_cvt_pk_bf16_f32 v48, v44, v45
    v_cvt_pk_bf16_f32 v49, v46, v47
    v_cvt_pk_bf16_f32 v96, v92, v93
    v_cvt_pk_bf16_f32 v97, v94, v95
    v_lshlrev_b32 v44, 16, v48
    v_and_b32 v45, 0xffff0000, v48
    v_lshlrev_b32 v46, 16, v49
    v_and_b32 v47, 0xffff0000, v49
    v_lshlrev_b32 v92, 16, v96
    v_and_b32 v93, 0xffff0000, v96
    v_lshlrev_b32 v94, 16, v97
    v_and_b32 v95, 0xffff0000, v97
    v_mul_f32 v44, s58, v44
    v_mul_f32 v45, s58, v45
    v_mul_f32 v46, s58, v46
    v_mul_f32 v47, s58, v47
    v_mul_f32 v92, s58, v92
    v_mul_f32 v93, s58, v93
    v_mul_f32 v94, s58, v94
    v_mul_f32 v95, s58, v95
    v_cvt_pk_bf16_f32 v48, v44, v45
    v_cvt_pk_bf16_f32 v49, v46, v47
    v_cvt_pk_bf16_f32 v96, v92, v93
    v_cvt_pk_bf16_f32 v97, v94, v95
    v_lshlrev_b32 v44, 16, v48
    v_and_b32 v45, 0xffff0000, v48
    v_lshlrev_b32 v46, 16, v49
    v_and_b32 v47, 0xffff0000, v49
    v_lshlrev_b32 v92, 16, v96
    v_and_b32 v93, 0xffff0000, v96
    v_lshlrev_b32 v94, 16, v97
    v_and_b32 v95, 0xffff0000, v97
    v_fma_f32 v44, v44, s59, v12
    v_fma_f32 v45, v45, s59, v13
    v_fma_f32 v46, v46, s59, v14
    v_fma_f32 v47, v47, s59, v15
    v_fma_f32 v92, v92, s59, v12
    v_fma_f32 v93, v93, s59, v13
    v_fma_f32 v94, v94, s59, v14
    v_fma_f32 v95, v95, s59, v15
    v_max3_f32 v48, v44, v45, v46
    v_max3_f32 v96, v92, v93, v94
    v_max_f32 v48, v48, v47
    v_max_f32 v96, v96, v95
    v_mov_b32 v49, v48
    v_mov_b32 v97, v96
    s_nop 1
    v_permlane16_swap_b32 v48, v49
    v_permlane16_swap_b32 v96, v97
    s_nop 0
    v_max_f32 v48, v48, v49
    v_max_f32 v96, v96, v97
    v_mov_b32 v49, v48
    v_mov_b32 v97, v96
    s_nop 1
    v_permlane32_swap_b32 v48, v49
    v_permlane32_swap_b32 v96, v97
    s_nop 0
    v_max_f32 v48, v48, v49
    v_max_f32 v96, v96, v97
    v_sub_f32 v44, v44, v48
    v_sub_f32 v45, v45, v48
    v_sub_f32 v46, v46, v48
    v_sub_f32 v47, v47, v48
    v_sub_f32 v92, v92, v96
    v_sub_f32 v93, v93, v96
    v_sub_f32 v94, v94, v96
    v_sub_f32 v95, v95, v96
    v_exp_f32 v44, v44
    v_exp_f32 v45, v45
    v_exp_f32 v46, v46
    v_exp_f32 v47, v47
    v_exp_f32 v92, v92
    v_exp_f32 v93, v93
    v_exp_f32 v94, v94
    v_exp_f32 v95, v95
    v_add_f32 v48, v44, v45
    v_add_f32 v49, v46, v47
    v_add_f32 v96, v92, v93
    v_add_f32 v97, v94, v95
    v_add_f32 v48, v48, v49
    v_add_f32 v96, v96, v97
    v_mov_b32 v49, v48
    v_mov_b32 v97, v96
    s_nop 1
    v_permlane16_swap_b32 v48, v49
    v_permlane16_swap_b32 v96, v97
    s_nop 0
    v_add_f32 v48, v48, v49
    v_add_f32 v96, v96, v97
    v_mov_b32 v49, v48
    v_mov_b32 v97, v96
    s_nop 1
    v_permlane32_swap_b32 v48, v49
    v_permlane32_swap_b32 v96, v97
    s_nop 0
    v_add_f32 v48, v48, v49
    v_add_f32 v96, v96, v97
    v_rcp_f32 v48, v48
    v_rcp_f32 v96, v96
    s_nop 0
    v_mul_f32 v44, v44, v48
    v_mul_f32 v45, v45, v48
    v_mul_f32 v46, v46, v48
    v_mul_f32 v47, v47, v48
    v_mul_f32 v92, v92, v96
    v_mul_f32 v93, v93, v96
    v_mul_f32 v94, v94, v96
    v_mul_f32 v95, v95, v96
    v_cvt_pk_bf16_f32 v48, v44, v45
    v_cvt_pk_bf16_f32 v49, v46, v47
    v_cvt_pk_bf16_f32 v96, v92, v93
    v_cvt_pk_bf16_f32 v97, v94, v95
    v_cndmask_b32 v52, 0, v48, s[56:57]
    v_cndmask_b32 v53, 0, v49, s[56:57]
    v_cndmask_b32 v54, v48, 0, s[56:57]
    v_cndmask_b32 v55, v49, 0, s[56:57]
    v_cndmask_b32 v100, 0, v96, s[56:57]
    v_cndmask_b32 v101, 0, v97, s[56:57]
    v_cndmask_b32 v102, v96, 0, s[56:57]
    v_cndmask_b32 v103, v97, 0, s[56:57]
    s_waitcnt lgkmcnt(0)
    s_nop 0
    v_mfma_f32_16x16x32_bf16 v[56:59], v[36:39], v[52:55], 0
    v_mfma_f32_16x16x32_bf16 v[60:63], v[40:43], v[52:55], 0
    v_mfma_f32_16x16x32_bf16 v[104:107], v[84:87], v[100:103], 0
    v_mfma_f32_16x16x32_bf16 v[108:111], v[88:91], v[100:103], 0
    s_nop 7
    v_cvt_pk_bf16_f32 v64, v56, v57
    v_cvt_pk_bf16_f32 v65, v58, v59
    v_cvt_pk_bf16_f32 v66, v60, v61
    v_cvt_pk_bf16_f32 v67, v62, v63
    buffer_store_dwordx4 v[64:67], v9, s[16:19], 0 offen offset:0 sc1
    v_cvt_pk_bf16_f32 v112, v104, v105
    v_cvt_pk_bf16_f32 v113, v106, v107
    v_cvt_pk_bf16_f32 v114, v108, v109
    v_cvt_pk_bf16_f32 v115, v110, v111
    buffer_store_dwordx4 v[112:115], v9, s[16:19], 0 offen offset:2048 sc1
    s_add_u32 s40, s25, 0
    s_lshl_b32 s40, s40, 8
    s_add_u32 s84, s4, 0x300000
    s_addc_u32 s85, s5, 0
    s_mov_b32 s86, 0x4000
    s_mov_b32 s87, 0x20000
    v_mov_b32 v3, s40
    v_mov_b32 v4, 1
    s_waitcnt vmcnt(0)
    s_barrier
    s_cmp_lg_u32 s28, 0
    s_cbranch_scc1 g1_cin
    s_mov_b64 exec, 1
    buffer_atomic_add v4, v3, s[84:87], 0 offen sc1
    s_mov_b64 exec, -1
g1_cin:
    s_branch g2_in
g1_done:
    s_endpgm
.p2align 6
g2_in:
    s_cmp_ge_u32 s2, 256
    s_cbranch_scc1 g2_done
    s_load_dwordx2 s[4:5], s[0:1], 80
    s_load_dwordx2 s[6:7], s[0:1], 0
    s_load_dwordx2 s[30:31], s[0:1], 16
    v_lshrrev_b32 v1, 6, v0
    v_and_b32 v2, 63, v0
    s_and_b32 s40, s2, 3
    s_lshl_b32 s40, s40, 2
    s_bfe_u32 s41, s2, 0x20003
    s_add_u32 s25, s40, s41
    s_bfe_u32 s40, s2, 0x10002
    s_lshl_b32 s40, s40, 3
    s_lshr_b32 s42, s2, 5
    s_add_u32 s24, s40, s42
    s_add_u32 s27, s41, s42
    s_mov_b32 s26, 0
    v_readfirstlane_b32 s28, v1
    s_nop 0
    s_cmp_lt_u32 s28, 4
    s_cbranch_scc1 g2_compute
    s_sub_u32 s28, s28, 4
    s_mov_b32 s40, 2048
    v_lshrrev_b32 v3, 3, v2
    v_mul_lo_u32 v3, v3, s40
    v_bfe_u32 v4, v2, 4, 1
    v_lshlrev_b32 v4, 1, v4
    v_xor_b32 v4, v4, v2
    v_and_b32 v4, 7, v4
    v_lshl_add_u32 v3, v4, 4, v3
    s_mul_i32 s41, s24, 128
    s_mul_i32 s42, s28, 32768
    s_add_u32 s41, s41, s42
    v_xor_b32 v4, 64, v3
    s_add_u32 s42, s41, 0
    v_add_u32 v10, s42, v3
    s_add_u32 s42, s41, 16384
    v_add_u32 v11, s42, v4
    s_mov_b32 s40, 2048
    v_lshrrev_b32 v3, 3, v2
    v_mul_lo_u32 v3, v3, s40
    v_lshrrev_b32 v4, 4, v2
    v_xor_b32 v4, v4, v2
    v_and_b32 v4, 7, v4
    v_lshl_add_u32 v3, v4, 4, v3
    s_mul_i32 s41, s25, 262144
    s_mul_i32 s42, s28, 65536
    s_add_u32 s41, s41, s42
    v_xor_b32 v4, 64, v3
    s_add_u32 s42, s41, 0
    v_add_u32 v12, s42, v3
    s_add_u32 s42, s41, 16384
    v_add_u32 v13, s42, v4
    s_add_u32 s42, s41, 32768
    v_add_u32 v14, s42, v3
    s_add_u32 s42, s41, 49152
    v_add_u32 v15, s42, v4
    s_mul_i32 s36, s28, 2048
    s_mul_i32 s37, s28, 4096
    s_add_u32 s37, s37, 8192
    s_waitcnt lgkmcnt(0)
    s_add_u32 s4, s4, s97
    s_addc_u32 s5, s5, 0
    s_mov_b32 s8, s30
    s_mov_b32 s9, s31
    s_mov_b32 s10, 0x200000
    s_mov_b32 s11, 0x20000
    s_add_u32 s12, s4, 0x400000
    s_addc_u32 s13, s5, 0
    s_mov_b32 s14, 0x400000
    s_mov_b32 s15, 0x20000
    s_lshr_b32 s40, s25, 0
    s_add_u32 s40, s40, 0
    s_lshl_b32 s40, s40, 8
    s_mov_b32 s42, s40
    s_add_u32 s84, s4, 0x300000
    s_addc_u32 s85, s5, 0
    s_mov_b32 s86, 0x4000
    s_mov_b32 s87, 0x20000
    v_cmp_eq_u32 vcc, 1, v2
    v_mov_b32 v21, s40
    v_mov_b32 v23, s42
    v_cndmask_b32 v21, v21, v23, vcc
    v_mov_b32 v22, 16
    v_mov_b32 v23, 16
    v_cndmask_b32 v22, v22, v23, vcc
    s_mov_b32 s41, 0x8000
g2_dep:
    buffer_load_dword v23, v21, s[84:87], 0 offen sc1
    s_sub_u32 s41, s41, 1
    s_waitcnt vmcnt(0)
    v_cmp_lt_u32 vcc, v23, v22
    s_cmp_eq_u32 s41, 0
    s_cbranch_scc1 g2_dep_ok
    s_cbranch_vccz g2_dep_ok
    s_sleep 2
    s_branch g2_dep
g2_dep_ok:
    s_mov_b32 s32, 0
    s_mov_b32 s33, 0
g2_ld_loop:
    s_cmp_lt_u32 s32, 3
    s_cbranch_scc1 g2_ld_issue
    s_waitcnt vmcnt(12)
g2_ld_bar:
    s_barrier
g2_ld_issue:
    s_add_u32 s40, s32, s27
    s_and_b32 s40, s40, 1
    s_andn2_b32 s41, s32, 1
    s_or_b32 s40, s40, s41
    s_add_u32 s40, s40, s26
    s_mul_i32 s34, s40, 131072
    s_mul_i32 s35, s40, 128
    s_add_u32 s38, s33, s36
    s_add_u32 s39, s33, s37
    s_add_u32 m0, s38, 0
    s_nop 0
    buffer_load_dwordx4 v10, s[8:11], s34 offen lds
    s_add_u32 m0, s38, 1024
    s_nop 0
    buffer_load_dwordx4 v11, s[8:11], s34 offen lds
    s_add_u32 m0, s39, 0
    s_nop 0
    buffer_load_dwordx4 v12, s[12:15], s35 offen lds
    s_add_u32 m0, s39, 1024
    s_nop 0
    buffer_load_dwordx4 v13, s[12:15], s35 offen lds
    s_add_u32 m0, s39, 2048
    s_nop 0
    buffer_load_dwordx4 v14, s[12:15], s35 offen lds
    s_add_u32 m0, s39, 3072
    s_nop 0
    buffer_load_dwordx4 v15, s[12:15], s35 offen lds
    s_add_u32 s33, s33, 24576
    s_cmp_eq_u32 s33, 98304
    s_cselect_b32 s33, 0, s33
    s_add_u32 s32, s32, 1
    s_cmp_lt_u32 s32, 16
    s_cbranch_scc1 g2_ld_loop
    s_waitcnt vmcnt(12)
    s_barrier
    s_waitcnt vmcnt(6)
    s_barrier
    s_waitcnt vmcnt(0)
    s_barrier
    s_barrier
    s_branch g3_in
g2_done:
    s_endpgm
g2_compute:
    v_lshrrev_b32 v5, 4, v2
    v_bfe_u32 v6, v2, 2, 2
    v_and_b32 v7, 3, v2
    v_and_b32 v8, 15, v2
    s_and_b32 s44, s28, 0
    s_lshr_b32 s45, s28, 0
    s_mul_i32 s40, s25, 128
    s_mul_i32 s41, s45, 32
    s_add_u32 s40, s40, s41
    v_add_u32 v20, s40, v8
    s_mov_b32 s41, 2048
    v_mul_lo_u32 v9, v20, s41
    s_mul_i32 s40, s24, 128
    s_mul_i32 s41, s44, 128
    s_add_u32 s46, s40, s41
    v_and_b32 v3, 1, v5
    v_lshlrev_b32 v3, 5, v3
    v_lshrrev_b32 v4, 1, v5
    v_lshl_add_u32 v3, v4, 4, v3
    v_add3_u32 v9, v9, v3, s46
    s_mov_b32 s52, 0
    s_mov_b32 s53, 32768
    s_waitcnt lgkmcnt(0)
    s_add_u32 s4, s4, s97
    s_addc_u32 s5, s5, 0
    s_add_u32 s20, s4, 0x1900000
    s_addc_u32 s21, s5, 0
    s_cmp_eq_u32 s96, 1
    s_cselect_b32 s20, s20, s6
    s_cselect_b32 s21, s21, s7
    s_mov_b32 s22, 0x400000
    s_mov_b32 s23, 0x20000
    s_add_u32 s16, s4, 0x800000
    s_addc_u32 s17, s5, 0
    s_mov_b32 s18, 0x400000
    s_mov_b32 s19, 0x20000
    s_add_u32 s56, s4, 0xc00000
    s_addc_u32 s57, s5, 0
    s_mov_b32 s58, 0x480000
    s_mov_b32 s59, 0x20000
    s_add_u32 s60, s4, 0x200000
    s_addc_u32 s61, s5, 0
    s_mov_b32 s62, 0x40000
    s_mov_b32 s63, 0x20000
    s_mul_i32 s42, s44, 4
    s_mov_b32 s43, 0
    v_and_b32 v3, 1, v5
    v_lshlrev_b32 v3, 1, v3
    v_lshrrev_b32 v4, 1, v6
    v_or_b32 v3, v3, v4
    s_add_u32 s40, s42, 0
    v_xor_b32 v3, s40, v3
    v_lshlrev_b32 v3, 5, v3
    v_lshl_add_u32 v3, v7, 3, v3
    v_lshl_add_u32 v4, v5, 3, v6
    v_lshl_add_u32 v3, v4, 7, v3
    v_add_u32 v10, s43, v3
    v_and_b32 v3, 1, v5
    v_lshlrev_b32 v3, 1, v3
    v_lshrrev_b32 v4, 1, v6
    v_or_b32 v3, v3, v4
    s_add_u32 s40, s42, 1
    v_xor_b32 v3, s40, v3
    v_lshlrev_b32 v3, 5, v3
    v_lshl_add_u32 v3, v7, 3, v3
    v_lshl_add_u32 v4, v5, 3, v6
    v_lshl_add_u32 v3, v4, 7, v3
    v_add_u32 v11, s43, v3
    v_and_b32 v3, 1, v5
    v_lshlrev_b32 v3, 1, v3
    v_lshrrev_b32 v4, 1, v6
    v_or_b32 v3, v3, v4
    s_add_u32 s40, s42, 2
    v_xor_b32 v3, s40, v3
    v_lshlrev_b32 v3, 5, v3
    v_lshl_add_u32 v3, v7, 3, v3
    v_lshl_add_u32 v4, v5, 3, v6
    v_lshl_add_u32 v3, v4, 7, v3
    v_add_u32 v12, s43, v3
    v_and_b32 v3, 1, v5
    v_lshlrev_b32 v3, 1, v3
    v_lshrrev_b32 v4, 1, v6
    v_or_b32 v3, v3, v4
    s_add_u32 s40, s42, 3
    v_xor_b32 v3, s40, v3
    v_lshlrev_b32 v3, 5, v3
    v_lshl_add_u32 v3, v7, 3, v3
    v_lshl_add_u32 v4, v5, 3, v6
    v_lshl_add_u32 v3, v4, 7, v3
    v_add_u32 v13, s43, v3
    s_mul_i32 s42, s45, 32
    v_lshrrev_b32 v3, 1, v8
    v_xor_b32 v3, v3, v5
    v_lshlrev_b32 v3, 4, v3
    v_lshl_add_u32 v3, v8, 7, v3
    s_lshl_b32 s40, s42, 7
    s_add_u32 s40, s40, 8192
    v_add_u32 v14, s40, v3
    v_xor_b32 v15, 64, v14
    v_mov_b32 v84, 0
    v_mov_b32 v85, 0
    v_mov_b32 v86, 0
    v_mov_b32 v87, 0
    v_mov_b32 v88, 0
    v_mov_b32 v89, 0
    v_mov_b32 v90, 0
    v_mov_b32 v91, 0
    v_mov_b32 v92, 0
    v_mov_b32 v93, 0
    v_mov_b32 v94, 0
    v_mov_b32 v95, 0
    v_mov_b32 v96, 0
    v_mov_b32 v97, 0
    v_mov_b32 v98, 0
    v_mov_b32 v99, 0
    v_mov_b32 v100, 0
    v_mov_b32 v101, 0
    v_mov_b32 v102, 0
    v_mov_b32 v103, 0
    v_mov_b32 v104, 0
    v_mov_b32 v105, 0
    v_mov_b32 v106, 0
    v_mov_b32 v107, 0
    s_mov_b32 s48, 16
    s_mov_b32 s50, 0
    s_mov_b32 s51, 24576
    s_mov_b32 s29, 0xfffee000
    v_mov_b32 v28, 0
    v_mov_b32 v29, 0
    v_mov_b32 v30, 0
    v_mov_b32 v31, 0
    v_mov_b32 v32, 0
    v_mov_b32 v33, 0
    v_mov_b32 v34, 0
    v_mov_b32 v35, 0
    v_mov_b32 v36, 0
    v_mov_b32 v37, 0
    v_mov_b32 v38, 0
    v_mov_b32 v39, 0
    v_mov_b32 v40, 0
    v_mov_b32 v41, 0
    v_mov_b32 v42, 0
    v_mov_b32 v43, 0
    v_mov_b32 v44, 0
    v_mov_b32 v45, 0
    v_mov_b32 v46, 0
    v_mov_b32 v47, 0
    v_mov_b32 v48, 0
    v_mov_b32 v49, 0
    v_mov_b32 v50, 0
    v_mov_b32 v51, 0
    v_mov_b32 v52, 0
    v_mov_b32 v53, 0
    v_mov_b32 v54, 0
    v_mov_b32 v55, 0
    v_mov_b32 v56, 0
    v_mov_b32 v57, 0
    v_mov_b32 v58, 0
    v_mov_b32 v59, 0
    s_barrier
    buffer_load_dwordx4 v[124:127], v9, s[20:23], s52 offen offset:0
    buffer_load_dwordx4 v[128:131], v9, s[20:23], s52 offen offset:64
    buffer_load_dwordx4 v[132:135], v9, s[20:23], s53 offen offset:0
    buffer_load_dwordx4 v[136:139], v9, s[20:23], s53 offen offset:64
    s_branch g2_cloop2
g2_mid:
    s_waitcnt vmcnt(0)
    s_nop 7
    v_permlane16_swap_b32 v124, v126
    v_permlane16_swap_b32 v125, v127
    v_permlane16_swap_b32 v128, v130
    v_permlane16_swap_b32 v129, v131
    v_permlane16_swap_b32 v132, v134
    v_permlane16_swap_b32 v133, v135
    v_permlane16_swap_b32 v136, v138
    v_permlane16_swap_b32 v137, v139
    v_lshlrev_b32 v140, 16, v124
    v_and_b32 v141, 0xffff0000, v124
    v_lshlrev_b32 v142, 16, v125
    v_and_b32 v143, 0xffff0000, v125
    v_lshlrev_b32 v144, 16, v126
    v_and_b32 v145, 0xffff0000, v126
    v_lshlrev_b32 v146, 16, v127
    v_and_b32 v147, 0xffff0000, v127
    v_pk_add_f32 v[28:29], v[28:29], v[140:141]
    v_pk_add_f32 v[30:31], v[30:31], v[142:143]
    v_pk_add_f32 v[36:37], v[36:37], v[144:145]
    v_pk_add_f32 v[38:39], v[38:39], v[146:147]
    v_lshlrev_b32 v140, 16, v128
    v_and_b32 v141, 0xffff0000, v128
    v_lshlrev_b32 v142, 16, v129
    v_and_b32 v143, 0xffff0000, v129
    v_lshlrev_b32 v144, 16, v130
    v_and_b32 v145, 0xffff0000, v130
    v_lshlrev_b32 v146, 16, v131
    v_and_b32 v147, 0xffff0000, v131
    v_pk_add_f32 v[44:45], v[44:45], v[140:141]
    v_pk_add_f32 v[46:47], v[46:47], v[142:143]
    v_pk_add_f32 v[52:53], v[52:53], v[144:145]
    v_pk_add_f32 v[54:55], v[54:55], v[146:147]
    v_lshlrev_b32 v140, 16, v132
    v_and_b32 v141, 0xffff0000, v132
    v_lshlrev_b32 v142, 16, v133
    v_and_b32 v143, 0xffff0000, v133
    v_lshlrev_b32 v144, 16, v134
    v_and_b32 v145, 0xffff0000, v134
    v_lshlrev_b32 v146, 16, v135
    v_and_b32 v147, 0xffff0000, v135
    v_pk_add_f32 v[32:33], v[32:33], v[140:141]
    v_pk_add_f32 v[34:35], v[34:35], v[142:143]
    v_pk_add_f32 v[40:41], v[40:41], v[144:145]
    v_pk_add_f32 v[42:43], v[42:43], v[146:147]
    v_lshlrev_b32 v140, 16, v136
    v_and_b32 v141, 0xffff0000, v136
    v_lshlrev_b32 v142, 16, v137
    v_and_b32 v143, 0xffff0000, v137
    v_lshlrev_b32 v144, 16, v138
    v_and_b32 v145, 0xffff0000, v138
    v_lshlrev_b32 v146, 16, v139
    v_and_b32 v147, 0xffff0000, v139
    v_pk_add_f32 v[48:49], v[48:49], v[140:141]
    v_pk_add_f32 v[50:51], v[50:51], v[142:143]
    v_pk_add_f32 v[56:57], v[56:57], v[144:145]
    v_pk_add_f32 v[58:59], v[58:59], v[146:147]
    s_nop 1
    s_branch g2_cloop2
.p2align 3
g2_cloop:
    s_barrier
    s_cmp_eq_u32 s48, 8
    s_cbranch_scc1 g2_mid
g2_cloop2:
    v_mfma_f32_16x16x32_bf16 v[28:31], v[84:87], v[100:103], v[28:31]
    ds_read_b64_tr_b16 v[60:61], v10 offset:0
    ds_read_b64_tr_b16 v[62:63], v10 offset:512
    v_mfma_f32_16x16x32_bf16 v[32:35], v[84:87], v[104:107], v[32:35]
    ds_read_b128 v[76:79], v14 offset:0
    v_mfma_f32_16x16x32_bf16 v[36:39], v[88:91], v[100:103], v[36:39]
    ds_read_b128 v[80:83], v14 offset:2048
    v_mfma_f32_16x16x32_bf16 v[40:43], v[88:91], v[104:107], v[40:43]
    ds_read_b64_tr_b16 v[64:65], v11 offset:0
    ds_read_b64_tr_b16 v[66:67], v11 offset:512
    v_mfma_f32_16x16x32_bf16 v[44:47], v[92:95], v[100:103], v[44:47]
    ds_read_b64_tr_b16 v[68:69], v12 offset:0
    ds_read_b64_tr_b16 v[70:71], v12 offset:512
    v_mfma_f32_16x16x32_bf16 v[48:51], v[92:95], v[104:107], v[48:51]
    ds_read_b64_tr_b16 v[72:73], v13 offset:0
    ds_read_b64_tr_b16 v[74:75], v13 offset:512
    v_mfma_f32_16x16x32_bf16 v[52:55], v[96:99], v[100:103], v[52:55]
    v_mfma_f32_16x16x32_bf16 v[56:59], v[96:99], v[104:107], v[56:59]
    s_waitcnt lgkmcnt(0)
    v_mfma_f32_16x16x32_bf16 v[28:31], v[60:63], v[76:79], v[28:31]
    ds_read_b64_tr_b16 v[84:85], v10 offset:4096
    ds_read_b64_tr_b16 v[86:87], v10 offset:4608
    v_mfma_f32_16x16x32_bf16 v[32:35], v[60:63], v[80:83], v[32:35]
    ds_read_b128 v[100:103], v15 offset:0
    v_mfma_f32_16x16x32_bf16 v[36:39], v[64:67], v[76:79], v[36:39]
    ds_read_b128 v[104:107], v15 offset:2048
    v_mfma_f32_16x16x32_bf16 v[40:43], v[64:67], v[80:83], v[40:43]
    ds_read_b64_tr_b16 v[88:89], v11 offset:4096
    ds_read_b64_tr_b16 v[90:91], v11 offset:4608
    v_mfma_f32_16x16x32_bf16 v[44:47], v[68:71], v[76:79], v[44:47]
    ds_read_b64_tr_b16 v[92:93], v12 offset:4096
    ds_read_b64_tr_b16 v[94:95], v12 offset:4608
    v_mfma_f32_16x16x32_bf16 v[48:51], v[68:71], v[80:83], v[48:51]
    ds_read_b64_tr_b16 v[96:97], v13 offset:4096
    ds_read_b64_tr_b16 v[98:99], v13 offset:4608
    v_mfma_f32_16x16x32_bf16 v[52:55], v[72:75], v[76:79], v[52:55]
    s_add_u32 s50, s50, 1
    s_cmp_eq_u32 s50, 4
    v_mfma_f32_16x16x32_bf16 v[56:59], v[72:75], v[80:83], v[56:59]
    s_cselect_b32 s49, s29, s51
    s_cselect_b32 s50, 0, s50
    v_add_u32 v10, s49, v10
    v_add_u32 v11, s49, v11
    v_add_u32 v12, s49, v12
    v_add_u32 v13, s49, v13
    v_add_u32 v14, s49, v14
    v_add_u32 v15, s49, v15
    s_sub_u32 s48, s48, 1
    s_cmp_lg_u32 s48, 0
    s_waitcnt lgkmcnt(0)
    s_cbranch_scc1 g2_cloop
    v_mfma_f32_16x16x32_bf16 v[28:31], v[84:87], v[100:103], v[28:31]
    v_mfma_f32_16x16x32_bf16 v[32:35], v[84:87], v[104:107], v[32:35]
    v_mfma_f32_16x16x32_bf16 v[36:39], v[88:91], v[100:103], v[36:39]
    v_mfma_f32_16x16x32_bf16 v[40:43], v[88:91], v[104:107], v[40:43]
    v_mfma_f32_16x16x32_bf16 v[44:47], v[92:95], v[100:103], v[44:47]
    v_mfma_f32_16x16x32_bf16 v[48:51], v[92:95], v[104:107], v[48:51]
    v_mfma_f32_16x16x32_bf16 v[52:55], v[96:99], v[100:103], v[52:55]
    v_mfma_f32_16x16x32_bf16 v[56:59], v[96:99], v[104:107], v[56:59]
    s_nop 7
    v_pk_add_f32 v[76:77], v[28:29], v[30:31]
    v_pk_mul_f32 v[78:79], v[28:29], v[28:29]
    v_pk_fma_f32 v[78:79], v[30:31], v[30:31], v[78:79]
    v_pk_add_f32 v[76:77], v[76:77], v[36:37]
    v_pk_fma_f32 v[78:79], v[36:37], v[36:37], v[78:79]
    v_pk_add_f32 v[76:77], v[76:77], v[38:39]
    v_pk_fma_f32 v[78:79], v[38:39], v[38:39], v[78:79]
    v_pk_add_f32 v[76:77], v[76:77], v[44:45]
    v_pk_fma_f32 v[78:79], v[44:45], v[44:45], v[78:79]
    v_pk_add_f32 v[76:77], v[76:77], v[46:47]
    v_pk_fma_f32 v[78:79], v[46:47], v[46:47], v[78:79]
    v_pk_add_f32 v[76:77], v[76:77], v[52:53]
    v_pk_fma_f32 v[78:79], v[52:53], v[52:53], v[78:79]
    v_pk_add_f32 v[76:77], v[76:77], v[54:55]
    v_pk_fma_f32 v[78:79], v[54:55], v[54:55], v[78:79]
    v_pk_add_f32 v[80:81], v[32:33], v[34:35]
    v_pk_mul_f32 v[82:83], v[32:33], v[32:33]
    v_pk_fma_f32 v[82:83], v[34:35], v[34:35], v[82:83]
    v_pk_add_f32 v[80:81], v[80:81], v[40:41]
    v_pk_fma_f32 v[82:83], v[40:41], v[40:41], v[82:83]
    v_pk_add_f32 v[80:81], v[80:81], v[42:43]
    v_pk_fma_f32 v[82:83], v[42:43], v[42:43], v[82:83]
    v_pk_add_f32 v[80:81], v[80:81], v[48:49]
    v_pk_fma_f32 v[82:83], v[48:49], v[48:49], v[82:83]
    v_pk_add_f32 v[80:81], v[80:81], v[50:51]
    v_pk_fma_f32 v[82:83], v[50:51], v[50:51], v[82:83]
    v_pk_add_f32 v[80:81], v[80:81], v[56:57]
    v_pk_fma_f32 v[82:83], v[56:57], v[56:57], v[82:83]
    v_pk_add_f32 v[80:81], v[80:81], v[58:59]
    v_pk_fma_f32 v[82:83], v[58:59], v[58:59], v[82:83]
    v_add_f32 v76, v76, v77
    v_add_f32 v77, v78, v79
    v_add_f32 v80, v80, v81
    v_add_f32 v81, v82, v83
    s_nop 1
    v_permlane16_swap_b32 v76, v80
    v_permlane16_swap_b32 v77, v81
    v_pk_add_f32 v[76:77], v[76:77], v[80:81]
    v_mov_b32 v84, v76
    v_mov_b32 v85, v77
    v_and_b32 v3, 16, v2
    v_add_u32 v3, v3, v20
    v_permlane32_swap_b32 v76, v84
    v_permlane32_swap_b32 v77, v85
    v_pk_add_f32 v[76:77], v[76:77], v[84:85]
    v_lshlrev_b32 v3, 3, v3
    s_mul_i32 s40, s24, 1
    s_add_u32 s40, s40, s44
    s_lshl_b32 s40, s40, 14
    s_mov_b32 exec_hi, 0
    buffer_store_dwordx2 v[76:77], v3, s[60:63], s40 offen sc1
    s_mov_b32 exec_hi, -1
    v_lshrrev_b32 v4, 5, v2
    v_lshl_add_u32 v21, v4, 17, v3
    v_cvt_pk_bf16_f32 v60, v28, v29
    v_cvt_pk_bf16_f32 v61, v30, v31
    v_cvt_pk_bf16_f32 v62, v36, v37
    v_cvt_pk_bf16_f32 v63, v38, v39
    v_lshlrev_b32 v28, 16, v60
    v_and_b32 v29, 0xffff0000, v60
    v_lshlrev_b32 v30, 16, v61
    v_and_b32 v31, 0xffff0000, v61
    v_lshlrev_b32 v36, 16, v62
    v_and_b32 v37, 0xffff0000, v62
    v_lshlrev_b32 v38, 16, v63
    v_and_b32 v39, 0xffff0000, v63
    v_permlane16_swap_b32 v60, v62
    v_permlane16_swap_b32 v61, v63
    buffer_store_dwordx4 v[60:63], v9, s[16:19], s52 offen offset:0 sc1
    v_cvt_pk_bf16_f32 v64, v44, v45
    v_cvt_pk_bf16_f32 v65, v46, v47
    v_cvt_pk_bf16_f32 v66, v52, v53
    v_cvt_pk_bf16_f32 v67, v54, v55
    v_lshlrev_b32 v44, 16, v64
    v_and_b32 v45, 0xffff0000, v64
    v_lshlrev_b32 v46, 16, v65
    v_and_b32 v47, 0xffff0000, v65
    v_lshlrev_b32 v52, 16, v66
    v_and_b32 v53, 0xffff0000, v66
    v_lshlrev_b32 v54, 16, v67
    v_and_b32 v55, 0xffff0000, v67
    v_permlane16_swap_b32 v64, v66
    v_permlane16_swap_b32 v65, v67
    buffer_store_dwordx4 v[64:67], v9, s[16:19], s52 offen offset:64 sc1
    v_cvt_pk_bf16_f32 v68, v32, v33
    v_cvt_pk_bf16_f32 v69, v34, v35
    v_cvt_pk_bf16_f32 v70, v40, v41
    v_cvt_pk_bf16_f32 v71, v42, v43
    v_lshlrev_b32 v32, 16, v68
    v_and_b32 v33, 0xffff0000, v68
    v_lshlrev_b32 v34, 16, v69
    v_and_b32 v35, 0xffff0000, v69
    v_lshlrev_b32 v40, 16, v70
    v_and_b32 v41, 0xffff0000, v70
    v_lshlrev_b32 v42, 16, v71
    v_and_b32 v43, 0xffff0000, v71
    v_permlane16_swap_b32 v68, v70
    v_permlane16_swap_b32 v69, v71
    buffer_store_dwordx4 v[68:71], v9, s[16:19], s53 offen offset:0 sc1
    v_cvt_pk_bf16_f32 v72, v48, v49
    v_cvt_pk_bf16_f32 v73, v50, v51
    v_cvt_pk_bf16_f32 v74, v56, v57
    v_cvt_pk_bf16_f32 v75, v58, v59
    v_lshlrev_b32 v48, 16, v72
    v_and_b32 v49, 0xffff0000, v72
    v_lshlrev_b32 v50, 16, v73
    v_and_b32 v51, 0xffff0000, v73
    v_lshlrev_b32 v56, 16, v74
    v_and_b32 v57, 0xffff0000, v74
    v_lshlrev_b32 v58, 16, v75
    v_and_b32 v59, 0xffff0000, v75
    v_permlane16_swap_b32 v72, v74
    v_permlane16_swap_b32 v73, v75
    buffer_store_dwordx4 v[72:75], v9, s[16:19], s53 offen offset:64 sc1
    s_mov_b32 s48, 0x2000
    v_mul_u32_u24 v19, 256, v20
    v_add_u32 v19, v19, v9
    s_mov_b32 s54, 0
    s_mov_b32 s55, 36864
    s_mov_b32 s40, 0
    buffer_load_dwordx2 v[108:109], v21, s[60:63], s40 offen sc1
    s_mov_b32 s41, 16384
    buffer_load_dwordx2 v[110:111], v21, s[60:63], s41 offen sc1
    s_mov_b32 s40, 32768
    buffer_load_dwordx2 v[112:113], v21, s[60:63], s40 offen sc1
    s_mov_b32 s41, 49152
    buffer_load_dwordx2 v[114:115], v21, s[60:63], s41 offen sc1
    s_mov_b32 s40, 65536
    buffer_load_dwordx2 v[116:117], v21, s[60:63], s40 offen sc1
    s_mov_b32 s41, 81920
    buffer_load_dwordx2 v[118:119], v21, s[60:63], s41 offen sc1
    s_mov_b32 s40, 98304
    buffer_load_dwordx2 v[120:121], v21, s[60:63], s40 offen sc1
    s_mov_b32 s41, 114688
    buffer_load_dwordx2 v[122:123], v21, s[60:63], s41 offen sc1
    s_waitcnt vmcnt(0)
g2_ex:
    v_max3_u32 v4, v108, v109, v110
    v_max3_u32 v4, v4, v111, v112
    v_max3_u32 v4, v4, v113, v114
    v_max3_u32 v4, v4, v115, v116
    v_max3_u32 v4, v4, v117, v118
    v_max3_u32 v4, v4, v119, v120
    v_max3_u32 v4, v4, v121, v122
    v_max_u32 v4, v4, v123
    v_cmp_eq_u32 vcc, -1, v4
    s_sub_u32 s48, s48, 1
    s_cmp_eq_u32 s48, 0
    s_cbranch_scc1 g2_exd
    s_cbranch_vccz g2_exd
    s_sleep 2
    s_mov_b32 s40, 0
    buffer_load_dwordx2 v[108:109], v21, s[60:63], s40 offen sc1
    s_mov_b32 s41, 16384
    buffer_load_dwordx2 v[110:111], v21, s[60:63], s41 offen sc1
    s_mov_b32 s40, 32768
    buffer_load_dwordx2 v[112:113], v21, s[60:63], s40 offen sc1
    s_mov_b32 s41, 49152
    buffer_load_dwordx2 v[114:115], v21, s[60:63], s41 offen sc1
    s_mov_b32 s40, 65536
    buffer_load_dwordx2 v[116:117], v21, s[60:63], s40 offen sc1
    s_mov_b32 s41, 81920
    buffer_load_dwordx2 v[118:119], v21, s[60:63], s41 offen sc1
    s_mov_b32 s40, 98304
    buffer_load_dwordx2 v[120:121], v21, s[60:63], s40 offen sc1
    s_mov_b32 s41, 114688
    buffer_load_dwordx2 v[122:123], v21, s[60:63], s41 offen sc1
    s_waitcnt vmcnt(0)
    s_branch g2_ex
g2_exd:
    v_pk_add_f32 v[108:109], v[108:109], v[116:117]
    v_pk_add_f32 v[110:111], v[110:111], v[118:119]
    v_pk_add_f32 v[112:113], v[112:113], v[120:121]
    v_pk_add_f32 v[114:115], v[114:115], v[122:123]
    v_pk_add_f32 v[108:109], v[108:109], v[112:113]
    v_pk_add_f32 v[110:111], v[110:111], v[114:115]
    v_pk_add_f32 v[108:109], v[108:109], v[110:111]
    v_mov_b32 v110, v108
    v_mov_b32 v111, v109
    s_nop 1
    v_permlane32_swap_b32 v108, v110
    v_permlane32_swap_b32 v109, v111
    v_pk_add_f32 v[108:109], v[108:109], v[110:111]
    v_mul_f32 v108, 0x3a800000, v108
    v_mul_f32 v109, 0x3a800000, v109
    v_fma_f32 v109, -v108, v108, v109
    v_max_f32 v109, 0, v109
    v_mov_b32 v110, v108
    v_mov_b32 v111, v109
    v_cvt_pk_bf16_f32 v110, v110, v110
    v_lshlrev_b32 v110, 16, v110
    v_cvt_pk_bf16_f32 v111, v111, v111
    v_lshlrev_b32 v111, 16, v111
    v_add_f32 v111, 0x3727c5ac, v111
    v_cvt_pk_bf16_f32 v111, v111, v111
    v_lshlrev_b32 v111, 16, v111
    v_sqrt_f32 v111, v111
    s_nop 0
    v_cvt_pk_bf16_f32 v111, v111, v111
    v_lshlrev_b32 v111, 16, v111
    v_rcp_f32 v111, v111
    v_sub_f32 v112, v108, v110
    v_mul_f32 v113, v109, v111
    v_mul_f32 v112, v112, v111
    v_mul_f32 v113, v113, v111
    v_cvt_pk_bf16_f32 v112, v112, v112
    v_lshlrev_b32 v112, 16, v112
    v_cvt_pk_bf16_f32 v113, v113, v113
    v_lshlrev_b32 v113, 16, v113
    v_add_f32 v113, 0x3727c5ac, v113
    v_cvt_pk_bf16_f32 v113, v113, v113
    v_lshlrev_b32 v113, 16, v113
    v_sqrt_f32 v113, v113
    s_nop 0
    v_cvt_pk_bf16_f32 v113, v113, v113
    v_lshlrev_b32 v113, 16, v113
    v_rcp_f32 v113, v113
    v_fma_f32 v112, v110, v111, v112
    v_mul_f32 v114, v111, v113
    v_mul_f32 v115, -v112, v113
    v_mov_b32 v116, v114
    v_mov_b32 v117, v115
    s_nop 1
    v_permlane16_swap_b32 v114, v116
    v_permlane16_swap_b32 v115, v117
    v_pk_fma_f32 v[28:29], v[28:29], v[114:115], v[114:115] op_sel:[0,0,1] op_sel_hi:[1,0,1]
    v_pk_fma_f32 v[30:31], v[30:31], v[114:115], v[114:115] op_sel:[0,0,1] op_sel_hi:[1,0,1]
    v_pk_fma_f32 v[36:37], v[36:37], v[114:115], v[114:115] op_sel:[0,0,1] op_sel_hi:[1,0,1]
    v_pk_fma_f32 v[38:39], v[38:39], v[114:115], v[114:115] op_sel:[0,0,1] op_sel_hi:[1,0,1]
    v_cvt_pk_bf16_f32 v60, v28, v29
    v_cvt_pk_bf16_f32 v61, v30, v31
    v_cvt_pk_bf16_f32 v62, v36, v37
    v_cvt_pk_bf16_f32 v63, v38, v39
    s_nop 1
    v_permlane16_swap_b32 v60, v62
    v_permlane16_swap_b32 v61, v63
    buffer_store_dwordx4 v[60:63], v19, s[56:59], s54 offen offset:0 sc1
    v_pk_fma_f32 v[44:45], v[44:45], v[114:115], v[114:115] op_sel:[0,0,1] op_sel_hi:[1,0,1]
    v_pk_fma_f32 v[46:47], v[46:47], v[114:115], v[114:115] op_sel:[0,0,1] op_sel_hi:[1,0,1]
    v_pk_fma_f32 v[52:53], v[52:53], v[114:115], v[114:115] op_sel:[0,0,1] op_sel_hi:[1,0,1]
    v_pk_fma_f32 v[54:55], v[54:55], v[114:115], v[114:115] op_sel:[0,0,1] op_sel_hi:[1,0,1]
    v_cvt_pk_bf16_f32 v64, v44, v45
    v_cvt_pk_bf16_f32 v65, v46, v47
    v_cvt_pk_bf16_f32 v66, v52, v53
    v_cvt_pk_bf16_f32 v67, v54, v55
    s_nop 1
    v_permlane16_swap_b32 v64, v66
    v_permlane16_swap_b32 v65, v67
    buffer_store_dwordx4 v[64:67], v19, s[56:59], s54 offen offset:64 sc1
    v_pk_fma_f32 v[32:33], v[32:33], v[116:117], v[116:117] op_sel:[0,0,1] op_sel_hi:[1,0,1]
    v_pk_fma_f32 v[34:35], v[34:35], v[116:117], v[116:117] op_sel:[0,0,1] op_sel_hi:[1,0,1]
    v_pk_fma_f32 v[40:41], v[40:41], v[116:117], v[116:117] op_sel:[0,0,1] op_sel_hi:[1,0,1]
    v_pk_fma_f32 v[42:43], v[42:43], v[116:117], v[116:117] op_sel:[0,0,1] op_sel_hi:[1,0,1]
    v_cvt_pk_bf16_f32 v68, v32, v33
    v_cvt_pk_bf16_f32 v69, v34, v35
    v_cvt_pk_bf16_f32 v70, v40, v41
    v_cvt_pk_bf16_f32 v71, v42, v43
    s_nop 1
    v_permlane16_swap_b32 v68, v70
    v_permlane16_swap_b32 v69, v71
    buffer_store_dwordx4 v[68:71], v19, s[56:59], s55 offen offset:0 sc1
    v_pk_fma_f32 v[48:49], v[48:49], v[116:117], v[116:117] op_sel:[0,0,1] op_sel_hi:[1,0,1]
    v_pk_fma_f32 v[50:51], v[50:51], v[116:117], v[116:117] op_sel:[0,0,1] op_sel_hi:[1,0,1]
    v_pk_fma_f32 v[56:57], v[56:57], v[116:117], v[116:117] op_sel:[0,0,1] op_sel_hi:[1,0,1]
    v_pk_fma_f32 v[58:59], v[58:59], v[116:117], v[116:117] op_sel:[0,0,1] op_sel_hi:[1,0,1]
    v_cvt_pk_bf16_f32 v72, v48, v49
    v_cvt_pk_bf16_f32 v73, v50, v51
    v_cvt_pk_bf16_f32 v74, v56, v57
    v_cvt_pk_bf16_f32 v75, v58, v59
    s_nop 1
    v_permlane16_swap_b32 v72, v74
    v_permlane16_swap_b32 v73, v75
    buffer_store_dwordx4 v[72:75], v19, s[56:59], s55 offen offset:64 sc1
    s_lshr_b32 s40, s24, 1
    s_add_u32 s40, s40, 16
    s_lshl_b32 s40, s40, 8
    s_mov_b32 s42, s40
    s_add_u32 s84, s4, 0x300000
    s_addc_u32 s85, s5, 0
    s_mov_b32 s86, 0x4000
    s_mov_b32 s87, 0x20000
    v_mov_b32 v3, s40
    v_mov_b32 v4, 1
    s_waitcnt vmcnt(0)
    s_barrier
    s_cmp_lg_u32 s28, 0
    s_cbranch_scc1 g2_cin
    s_mov_b64 exec, 1
    buffer_atomic_add v4, v3, s[84:87], 0 offen sc1
    s_mov_b64 exec, -1
g2_cin:
    s_branch g3_in
.p2align 6
g3_in:
    s_cmp_ge_u32 s2, 224
    s_cbranch_scc1 g3_spare
    s_load_dwordx2 s[4:5], s[0:1], 80
    s_load_dwordx2 s[30:31], s[0:1], 32
    s_load_dwordx2 s[6:7], s[0:1], 40
    v_lshrrev_b32 v1, 6, v0
    v_and_b32 v2, 63, v0
    s_and_b32 s40, s2, 1
    s_lshl_b32 s40, s40, 2
    s_bfe_u32 s41, s2, 0x20003
    s_add_u32 s25, s40, s41
    s_bfe_u32 s40, s2, 0x20001
    s_mul_i32 s40, s40, 7
    s_lshr_b32 s42, s2, 5
    s_add_u32 s24, s40, s42
    s_add_u32 s27, s41, s42
    s_mov_b32 s26, 0
    s_cmp_eq_u32 s96, 0
    s_cselect_b32 s95, 3, 1
    v_readfirstlane_b32 s28, v1
    s_nop 0
    s_cmp_lt_u32 s28, 4
    s_cbranch_scc1 g3_compute
    s_sub_u32 s28, s28, 4
    s_mov_b32 s40, 7168
    v_lshrrev_b32 v4, 4, v2
    v_mul_lo_u32 v3, v4, s40
    v_lshlrev_b32 v4, 1, v4
    v_xor_b32 v4, v4, v2
    v_and_b32 v4, 15, v4
    v_lshl_add_u32 v3, v4, 4, v3
    s_mul_i32 s41, s24, 256
    s_mul_i32 s42, s28, 114688
    s_add_u32 s41, s41, s42
    v_xor_b32 v4, 128, v3
    s_add_u32 s42, s41, 0
    v_add_u32 v10, s42, v3
    s_add_u32 s42, s41, 28672
    v_add_u32 v11, s42, v3
    s_add_u32 s42, s41, 57344
    v_add_u32 v12, s42, v4
    s_add_u32 s42, s41, 86016
    v_add_u32 v13, s42, v4
    s_mov_b32 s40, 2304
    v_lshrrev_b32 v4, 4, v2
    v_mul_lo_u32 v3, v4, s40
    v_lshlrev_b32 v4, 1, v4
    v_xor_b32 v4, v4, v2
    v_and_b32 v4, 15, v4
    v_lshl_add_u32 v3, v4, 4, v3
    s_mul_i32 s41, s25, 256
    s_mul_i32 s42, s28, 36864
    s_add_u32 s41, s41, s42
    v_xor_b32 v4, 128, v3
    s_add_u32 s42, s41, 0
    v_add_u32 v14, s42, v3
    s_add_u32 s42, s41, 9216
    v_add_u32 v15, s42, v3
    s_add_u32 s42, s41, 18432
    v_add_u32 v16, s42, v4
    s_add_u32 s42, s41, 27648
    v_add_u32 v17, s42, v4
    s_mul_i32 s36, s28, 4096
    s_mul_i32 s37, s28, 4096
    s_add_u32 s37, s37, 16384
    s_waitcnt lgkmcnt(0)
    s_add_u32 s4, s4, s97
    s_addc_u32 s5, s5, 0
    s_mov_b32 s8, s30
    s_mov_b32 s9, s31
    s_mov_b32 s10, 0xe00000
    s_mov_b32 s11, 0x20000
    s_add_u32 s12, s4, 0xc00000
    s_addc_u32 s13, s5, 0
    s_mov_b32 s14, 0x480000
    s_mov_b32 s15, 0x20000
    s_lshr_b32 s40, s25, 0
    s_add_u32 s40, s40, 16
    s_lshl_b32 s40, s40, 8
    s_mov_b32 s42, s40
    s_add_u32 s84, s4, 0x300000
    s_addc_u32 s85, s5, 0
    s_mov_b32 s86, 0x4000
    s_mov_b32 s87, 0x20000
    v_cmp_eq_u32 vcc, 1, v2
    v_mov_b32 v21, s40
    v_mov_b32 v23, s42
    v_cndmask_b32 v21, v21, v23, vcc
    v_mov_b32 v22, 32
    v_mov_b32 v23, 32
    v_cndmask_b32 v22, v22, v23, vcc
    s_mov_b32 s41, 0x8000
g3_dep:
    buffer_load_dword v23, v21, s[84:87], 0 offen sc1
    s_sub_u32 s41, s41, 1
    s_waitcnt vmcnt(0)
    v_cmp_lt_u32 vcc, v23, v22
    s_cmp_eq_u32 s41, 0
    s_cbranch_scc1 g3_dep_ok
    s_cbranch_vccz g3_dep_ok
    s_sleep 2
    s_branch g3_dep
g3_dep_ok:
    s_mov_b32 s32, 0
    s_mov_b32 s33, 0
g3_ld_loop:
    s_cmp_lt_u32 s32, 3
    s_cbranch_scc1 g3_ld_issue
    s_waitcnt vmcnt(16)
g3_ld_bar:
    s_barrier
g3_ld_issue:
    s_add_u32 s40, s32, s27
    s_and_b32 s40, s40, s95
    s_andn2_b32 s41, s32, s95
    s_or_b32 s40, s40, s41
    s_add_u32 s40, s40, s26
    s_mul_i32 s34, s40, 458752
    s_mul_i32 s35, s40, 147456
    s_add_u32 s38, s33, s36
    s_add_u32 s39, s33, s37
    s_add_u32 m0, s38, 0
    s_nop 0
    buffer_load_dwordx4 v10, s[8:11], s34 offen lds
    s_add_u32 m0, s38, 1024
    s_nop 0
    buffer_load_dwordx4 v11, s[8:11], s34 offen lds
    s_add_u32 m0, s38, 2048
    s_nop 0
    buffer_load_dwordx4 v12, s[8:11], s34 offen lds
    s_add_u32 m0, s38, 3072
    s_nop 0
    buffer_load_dwordx4 v13, s[8:11], s34 offen lds
    s_add_u32 m0, s39, 0
    s_nop 0
    buffer_load_dwordx4 v14, s[12:15], s35 offen lds
    s_add_u32 m0, s39, 1024
    s_nop 0
    buffer_load_dwordx4 v15, s[12:15], s35 offen lds
    s_add_u32 m0, s39, 2048
    s_nop 0
    buffer_load_dwordx4 v16, s[12:15], s35 offen lds
    s_add_u32 m0, s39, 3072
    s_nop 0
    buffer_load_dwordx4 v17, s[12:15], s35 offen lds
    s_add_u32 s33, s33, 32768
    s_cmp_eq_u32 s33, 131072
    s_cselect_b32 s33, 0, s33
    s_add_u32 s32, s32, 1
    s_cmp_lt_u32 s32, 32
    s_cbranch_scc1 g3_ld_loop
    s_waitcnt vmcnt(16)
    s_barrier
    s_waitcnt vmcnt(8)
    s_barrier
    s_waitcnt vmcnt(0)
    s_barrier
    s_barrier
    s_branch g4_in
g3_done:
    s_endpgm
g3_compute:
    v_lshrrev_b32 v5, 4, v2
    v_bfe_u32 v6, v2, 2, 2
    v_and_b32 v7, 3, v2
    v_and_b32 v8, 15, v2
    s_and_b32 s44, s28, 1
    s_lshr_b32 s45, s28, 1
    s_mul_i32 s40, s25, 128
    s_mul_i32 s41, s45, 64
    s_add_u32 s40, s40, s41
    v_add_u32 v20, s40, v8
    s_mov_b32 s41, 8192
    v_mul_lo_u32 v9, v20, s41
    s_mul_i32 s40, s24, 256
    s_mul_i32 s41, s44, 128
    s_add_u32 s46, s40, s41
    v_and_b32 v3, 1, v5
    v_lshlrev_b32 v3, 5, v3
    v_lshrrev_b32 v4, 1, v5
    v_lshl_add_u32 v3, v4, 4, v3
    v_add3_u32 v9, v9, v3, s46
    s_mov_b32 s52, 0
    s_mov_b32 s53, 131072
    s_mov_b32 s54, 262144
    s_mov_b32 s55, 393216
    s_waitcnt lgkmcnt(0)
    s_add_u32 s4, s4, s97
    s_addc_u32 s5, s5, 0
    s_mov_b32 s20, s6
    s_mov_b32 s21, s7
    s_mov_b32 s22, 0x1c00
    s_mov_b32 s23, 0x20000
    s_add_u32 s16, s4, 0x1100000
    s_addc_u32 s17, s5, 0
    s_mov_b32 s18, 0x800000
    s_mov_b32 s19, 0x20000
    v_lshl_add_u32 v3, v5, 3, s46
    buffer_load_dwordx2 v[92:93], v3, s[20:23], 0 offen offset:0
    buffer_load_dwordx2 v[94:95], v3, s[20:23], 0 offen offset:32
    buffer_load_dwordx2 v[96:97], v3, s[20:23], 0 offen offset:64
    buffer_load_dwordx2 v[98:99], v3, s[20:23], 0 offen offset:96
    s_mul_i32 s42, s44, 4
    s_mov_b32 s43, 0
    v_and_b32 v3, 1, v5
    v_lshl_or_b32 v3, v3, 2, v6
    s_add_u32 s40, s42, 0
    v_xor_b32 v3, s40, v3
    v_lshlrev_b32 v3, 5, v3
    v_lshl_add_u32 v3, v7, 3, v3
    v_lshl_add_u32 v4, v5, 3, v6
    v_lshl_add_u32 v3, v4, 8, v3
    v_add_u32 v10, s43, v3
    v_and_b32 v3, 1, v5
    v_lshl_or_b32 v3, v3, 2, v6
    s_add_u32 s40, s42, 1
    v_xor_b32 v3, s40, v3
    v_lshlrev_b32 v3, 5, v3
    v_lshl_add_u32 v3, v7, 3, v3
    v_lshl_add_u32 v4, v5, 3, v6
    v_lshl_add_u32 v3, v4, 8, v3
    v_add_u32 v11, s43, v3
    v_and_b32 v3, 1, v5
    v_lshl_or_b32 v3, v3, 2, v6
    s_add_u32 s40, s42, 2
    v_xor_b32 v3, s40, v3
    v_lshlrev_b32 v3, 5, v3
    v_lshl_add_u32 v3, v7, 3, v3
    v_lshl_add_u32 v4, v5, 3, v6
    v_lshl_add_u32 v3, v4, 8, v3
    v_add_u32 v12, s43, v3
    v_and_b32 v3, 1, v5
    v_lshl_or_b32 v3, v3, 2, v6
    s_add_u32 s40, s42, 3
    v_xor_b32 v3, s40, v3
    v_lshlrev_b32 v3, 5, v3
    v_lshl_add_u32 v3, v7, 3, v3
    v_lshl_add_u32 v4, v5, 3, v6
    v_lshl_add_u32 v3, v4, 8, v3
    v_add_u32 v13, s43, v3
    s_mul_i32 s42, s45, 4
    s_mov_b32 s43, 16384
    v_and_b32 v3, 1, v5
    v_lshl_or_b32 v3, v3, 2, v6
    s_add_u32 s40, s42, 0
    v_xor_b32 v3, s40, v3
    v_lshlrev_b32 v3, 5, v3
    v_lshl_add_u32 v3, v7, 3, v3
    v_lshl_add_u32 v4, v5, 3, v6
    v_lshl_add_u32 v3, v4, 8, v3
    v_add_u32 v14, s43, v3
    v_and_b32 v3, 1, v5
    v_lshl_or_b32 v3, v3, 2, v6
    s_add_u32 s40, s42, 1
    v_xor_b32 v3, s40, v3
    v_lshlrev_b32 v3, 5, v3
    v_lshl_add_u32 v3, v7, 3, v3
    v_lshl_add_u32 v4, v5, 3, v6
    v_lshl_add_u32 v3, v4, 8, v3
    v_add_u32 v15, s43, v3
    v_and_b32 v3, 1, v5
    v_lshl_or_b32 v3, v3, 2, v6
    s_add_u32 s40, s42, 2
    v_xor_b32 v3, s40, v3
    v_lshlrev_b32 v3, 5, v3
    v_lshl_add_u32 v3, v7, 3, v3
    v_lshl_add_u32 v4, v5, 3, v6
    v_lshl_add_u32 v3, v4, 8, v3
    v_add_u32 v16, s43, v3
    v_and_b32 v3, 1, v5
    v_lshl_or_b32 v3, v3, 2, v6
    s_add_u32 s40, s42, 3
    v_xor_b32 v3, s40, v3
    v_lshlrev_b32 v3, 5, v3
    v_lshl_add_u32 v3, v7, 3, v3
    v_lshl_add_u32 v4, v5, 3, v6
    v_lshl_add_u32 v3, v4, 8, v3
    v_add_u32 v17, s43, v3
    v_mov_b32 v124, 0
    v_mov_b32 v125, 0
    v_mov_b32 v126, 0
    v_mov_b32 v127, 0
    v_mov_b32 v128, 0
    v_mov_b32 v129, 0
    v_mov_b32 v130, 0
    v_mov_b32 v131, 0
    v_mov_b32 v132, 0
    v_mov_b32 v133, 0
    v_mov_b32 v134, 0
    v_mov_b32 v135, 0
    v_mov_b32 v136, 0
    v_mov_b32 v137, 0
    v_mov_b32 v138, 0
    v_mov_b32 v139, 0
    v_mov_b32 v140, 0
    v_mov_b32 v141, 0
    v_mov_b32 v142, 0
    v_mov_b32 v143, 0
    v_mov_b32 v144, 0
    v_mov_b32 v145, 0
    v_mov_b32 v146, 0
    v_mov_b32 v147, 0
    v_mov_b32 v148, 0
    v_mov_b32 v149, 0
    v_mov_b32 v150, 0
    v_mov_b32 v151, 0
    v_mov_b32 v152, 0
    v_mov_b32 v153, 0
    v_mov_b32 v154, 0
    v_mov_b32 v155, 0
    s_mov_b32 s48, 32
    s_mov_b32 s50, 0
    s_mov_b32 s51, 32768
    s_mov_b32 s29, 0xfffe8000
    s_waitcnt vmcnt(0)
    v_lshlrev_b32 v28, 16, v92
    v_and_b32 v29, 0xffff0000, v92
    v_lshlrev_b32 v30, 16, v93
    v_and_b32 v31, 0xffff0000, v93
    v_lshlrev_b32 v32, 16, v92
    v_and_b32 v33, 0xffff0000, v92
    v_lshlrev_b32 v34, 16, v93
    v_and_b32 v35, 0xffff0000, v93
    v_lshlrev_b32 v36, 16, v92
    v_and_b32 v37, 0xffff0000, v92
    v_lshlrev_b32 v38, 16, v93
    v_and_b32 v39, 0xffff0000, v93
    v_lshlrev_b32 v40, 16, v92
    v_and_b32 v41, 0xffff0000, v92
    v_lshlrev_b32 v42, 16, v93
    v_and_b32 v43, 0xffff0000, v93
    v_lshlrev_b32 v44, 16, v94
    v_and_b32 v45, 0xffff0000, v94
    v_lshlrev_b32 v46, 16, v95
    v_and_b32 v47, 0xffff0000, v95
    v_lshlrev_b32 v48, 16, v94
    v_and_b32 v49, 0xffff0000, v94
    v_lshlrev_b32 v50, 16, v95
    v_and_b32 v51, 0xffff0000, v95
    v_lshlrev_b32 v52, 16, v94
    v_and_b32 v53, 0xffff0000, v94
    v_lshlrev_b32 v54, 16, v95
    v_and_b32 v55, 0xffff0000, v95
    v_lshlrev_b32 v56, 16, v94
    v_and_b32 v57, 0xffff0000, v94
    v_lshlrev_b32 v58, 16, v95
    v_and_b32 v59, 0xffff0000, v95
    v_lshlrev_b32 v60, 16, v96
    v_and_b32 v61, 0xffff0000, v96
    v_lshlrev_b32 v62, 16, v97
    v_and_b32 v63, 0xffff0000, v97
    v_lshlrev_b32 v64, 16, v96
    v_and_b32 v65, 0xffff0000, v96
    v_lshlrev_b32 v66, 16, v97
    v_and_b32 v67, 0xffff0000, v97
    v_lshlrev_b32 v68, 16, v96
    v_and_b32 v69, 0xffff0000, v96
    v_lshlrev_b32 v70, 16, v97
    v_and_b32 v71, 0xffff0000, v97
    v_lshlrev_b32 v72, 16, v96
    v_and_b32 v73, 0xffff0000, v96
    v_lshlrev_b32 v74, 16, v97
    v_and_b32 v75, 0xffff0000, v97
    v_lshlrev_b32 v76, 16, v98
    v_and_b32 v77, 0xffff0000, v98
    v_lshlrev_b32 v78, 16, v99
    v_and_b32 v79, 0xffff0000, v99
    v_lshlrev_b32 v80, 16, v98
    v_and_b32 v81, 0xffff0000, v98
    v_lshlrev_b32 v82, 16, v99
    v_and_b32 v83, 0xffff0000, v99
    v_lshlrev_b32 v84, 16, v98
    v_and_b32 v85, 0xffff0000, v98
    v_lshlrev_b32 v86, 16, v99
    v_and_b32 v87, 0xffff0000, v99
    v_lshlrev_b32 v88, 16, v98
    v_and_b32 v89, 0xffff0000, v98
    v_lshlrev_b32 v90, 16, v99
    v_and_b32 v91, 0xffff0000, v99
.p2align 3
g3_cloop:
    s_barrier
g3_cloop2:
    v_mfma_f32_16x16x32_bf16 v[28:31], v[124:127], v[140:143], v[28:31]
    ds_read_b64_tr_b16 v[92:93], v10 offset:0
    ds_read_b64_tr_b16 v[94:95], v10 offset:1024
    v_mfma_f32_16x16x32_bf16 v[32:35], v[124:127], v[144:147], v[32:35]
    ds_read_b64_tr_b16 v[108:109], v14 offset:0
    ds_read_b64_tr_b16 v[110:111], v14 offset:1024
    v_mfma_f32_16x16x32_bf16 v[36:39], v[124:127], v[148:151], v[36:39]
    ds_read_b64_tr_b16 v[112:113], v15 offset:0
    ds_read_b64_tr_b16 v[114:115], v15 offset:1024
    v_mfma_f32_16x16x32_bf16 v[40:43], v[124:127], v[152:155], v[40:43]
    ds_read_b64_tr_b16 v[116:117], v16 offset:0
    ds_read_b64_tr_b16 v[118:119], v16 offset:1024
    v_mfma_f32_16x16x32_bf16 v[44:47], v[128:131], v[140:143], v[44:47]
    ds_read_b64_tr_b16 v[120:121], v17 offset:0
    ds_read_b64_tr_b16 v[122:123], v17 offset:1024
    v_mfma_f32_16x16x32_bf16 v[48:51], v[128:131], v[144:147], v[48:51]
    ds_read_b64_tr_b16 v[96:97], v11 offset:0
    ds_read_b64_tr_b16 v[98:99], v11 offset:1024
    v_mfma_f32_16x16x32_bf16 v[52:55], v[128:131], v[148:151], v[52:55]
    ds_read_b64_tr_b16 v[100:101], v12 offset:0
    ds_read_b64_tr_b16 v[102:103], v12 offset:1024
    v_mfma_f32_16x16x32_bf16 v[56:59], v[128:131], v[152:155], v[56:59]
    ds_read_b64_tr_b16 v[104:105], v13 offset:0
    ds_read_b64_tr_b16 v[106:107], v13 offset:1024
    v_mfma_f32_16x16x32_bf16 v[60:63], v[132:135], v[140:143], v[60:63]
    v_mfma_f32_16x16x32_bf16 v[64:67], v[132:135], v[144:147], v[64:67]
    v_mfma_f32_16x16x32_bf16 v[68:71], v[132:135], v[148:151], v[68:71]
    v_mfma_f32_16x16x32_bf16 v[72:75], v[132:135], v[152:155], v[72:75]
    v_mfma_f32_16x16x32_bf16 v[76:79], v[136:139], v[140:143], v[76:79]
    v_mfma_f32_16x16x32_bf16 v[80:83], v[136:139], v[144:147], v[80:83]
    v_mfma_f32_16x16x32_bf16 v[84:87], v[136:139], v[148:151], v[84:87]
    v_mfma_f32_16x16x32_bf16 v[88:91], v[136:139], v[152:155], v[88:91]
    s_waitcnt lgkmcnt(0)
    v_mfma_f32_16x16x32_bf16 v[28:31], v[92:95], v[108:111], v[28:31]
    ds_read_b64_tr_b16 v[124:125], v10 offset:8192
    ds_read_b64_tr_b16 v[126:127], v10 offset:9216
    v_mfma_f32_16x16x32_bf16 v[32:35], v[92:95], v[112:115], v[32:35]
    ds_read_b64_tr_b16 v[140:141], v14 offset:8192
    ds_read_b64_tr_b16 v[142:143], v14 offset:9216
    v_mfma_f32_16x16x32_bf16 v[36:39], v[92:95], v[116:119], v[36:39]
    ds_read_b64_tr_b16 v[144:145], v15 offset:8192
    ds_read_b64_tr_b16 v[146:147], v15 offset:9216
    v_mfma_f32_16x16x32_bf16 v[40:43], v[92:95], v[120:123], v[40:43]
    ds_read_b64_tr_b16 v[148:149], v16 offset:8192
    ds_read_b64_tr_b16 v[150:151], v16 offset:9216
    v_mfma_f32_16x16x32_bf16 v[44:47], v[96:99], v[108:111], v[44:47]
    ds_read_b64_tr_b16 v[152:153], v17 offset:8192
    ds_read_b64_tr_b16 v[154:155], v17 offset:9216
    v_mfma_f32_16x16x32_bf16 v[48:51], v[96:99], v[112:115], v[48:51]
    ds_read_b64_tr_b16 v[128:129], v11 offset:8192
    ds_read_b64_tr_b16 v[130:131], v11 offset:9216
    v_mfma_f32_16x16x32_bf16 v[52:55], v[96:99], v[116:119], v[52:55]
    ds_read_b64_tr_b16 v[132:133], v12 offset:8192
    ds_read_b64_tr_b16 v[134:135], v12 offset:9216
    v_mfma_f32_16x16x32_bf16 v[56:59], v[96:99], v[120:123], v[56:59]
    ds_read_b64_tr_b16 v[136:137], v13 offset:8192
    ds_read_b64_tr_b16 v[138:139], v13 offset:9216
    v_mfma_f32_16x16x32_bf16 v[60:63], v[100:103], v[108:111], v[60:63]
    s_add_u32 s50, s50, 1
    s_cmp_eq_u32 s50, 4
    v_mfma_f32_16x16x32_bf16 v[64:67], v[100:103], v[112:115], v[64:67]
    s_cselect_b32 s49, s29, s51
    s_cselect_b32 s50, 0, s50
    v_mfma_f32_16x16x32_bf16 v[68:71], v[100:103], v[116:119], v[68:71]
    v_add_u32 v10, s49, v10
    v_add_u32 v11, s49, v11
    v_mfma_f32_16x16x32_bf16 v[72:75], v[100:103], v[120:123], v[72:75]
    v_add_u32 v12, s49, v12
    v_add_u32 v13, s49, v13
    v_mfma_f32_16x16x32_bf16 v[76:79], v[104:107], v[108:111], v[76:79]
    v_add_u32 v14, s49, v14
    v_add_u32 v15, s49, v15
    v_mfma_f32_16x16x32_bf16 v[80:83], v[104:107], v[112:115], v[80:83]
    v_add_u32 v16, s49, v16
    v_add_u32 v17, s49, v17
    v_mfma_f32_16x16x32_bf16 v[84:87], v[104:107], v[116:119], v[84:87]
    s_sub_u32 s48, s48, 1
    s_cmp_lg_u32 s48, 0
    v_mfma_f32_16x16x32_bf16 v[88:91], v[104:107], v[120:123], v[88:91]
    s_waitcnt lgkmcnt(0)
    s_cbranch_scc1 g3_cloop
    v_mfma_f32_16x16x32_bf16 v[28:31], v[124:127], v[140:143], v[28:31]
    v_mfma_f32_16x16x32_bf16 v[32:35], v[124:127], v[144:147], v[32:35]
    v_mfma_f32_16x16x32_bf16 v[36:39], v[124:127], v[148:151], v[36:39]
    v_mfma_f32_16x16x32_bf16 v[40:43], v[124:127], v[152:155], v[40:43]
    v_mfma_f32_16x16x32_bf16 v[44:47], v[128:131], v[140:143], v[44:47]
    v_mfma_f32_16x16x32_bf16 v[48:51], v[128:131], v[144:147], v[48:51]
    v_mfma_f32_16x16x32_bf16 v[52:55], v[128:131], v[148:151], v[52:55]
    v_mfma_f32_16x16x32_bf16 v[56:59], v[128:131], v[152:155], v[56:59]
    v_mfma_f32_16x16x32_bf16 v[60:63], v[132:135], v[140:143], v[60:63]
    v_mfma_f32_16x16x32_bf16 v[64:67], v[132:135], v[144:147], v[64:67]
    v_mfma_f32_16x16x32_bf16 v[68:71], v[132:135], v[148:151], v[68:71]
    v_mfma_f32_16x16x32_bf16 v[72:75], v[132:135], v[152:155], v[72:75]
    v_mfma_f32_16x16x32_bf16 v[76:79], v[136:139], v[140:143], v[76:79]
    v_mfma_f32_16x16x32_bf16 v[80:83], v[136:139], v[144:147], v[80:83]
    v_mfma_f32_16x16x32_bf16 v[84:87], v[136:139], v[148:151], v[84:87]
    v_mfma_f32_16x16x32_bf16 v[88:91], v[136:139], v[152:155], v[88:91]
    v_mov_b32 v10, 0xbdd2d3e8
    v_mov_b32 v11, 0xbdd2d3e8
    v_mov_b32 v12, 0xc0135761
    v_mov_b32 v13, 0xc0135761
    v_mov_b32 v14, 0x3f800000
    v_mov_b32 v15, 0x3f800000
    s_nop 7
    v_pk_mul_f32 v[108:109], v[28:29], v[28:29]
    v_pk_mul_f32 v[110:111], v[30:31], v[30:31]
    v_pk_mul_f32 v[112:113], v[44:45], v[44:45]
    v_pk_mul_f32 v[114:115], v[46:47], v[46:47]
    v_pk_fma_f32 v[108:109], v[108:109], v[10:11], v[12:13]
    v_pk_fma_f32 v[110:111], v[110:111], v[10:11], v[12:13]
    v_pk_fma_f32 v[112:113], v[112:113], v[10:11], v[12:13]
    v_pk_fma_f32 v[114:115], v[114:115], v[10:11], v[12:13]
    v_pk_mul_f32 v[108:109], v[108:109], v[28:29]
    v_pk_mul_f32 v[110:111], v[110:111], v[30:31]
    v_pk_mul_f32 v[112:113], v[112:113], v[44:45]
    v_pk_mul_f32 v[114:115], v[114:115], v[46:47]
    v_exp_f32 v108, v108
    v_exp_f32 v109, v109
    v_exp_f32 v110, v110
    v_exp_f32 v111, v111
    v_exp_f32 v112, v112
    v_exp_f32 v113, v113
    v_exp_f32 v114, v114
    v_exp_f32 v115, v115
    v_pk_add_f32 v[108:109], v[108:109], v[14:15]
    v_pk_add_f32 v[110:111], v[110:111], v[14:15]
    v_pk_add_f32 v[112:113], v[112:113], v[14:15]
    v_pk_add_f32 v[114:115], v[114:115], v[14:15]
    v_rcp_f32 v108, v108
    v_rcp_f32 v109, v109
    v_rcp_f32 v110, v110
    v_rcp_f32 v111, v111
    v_rcp_f32 v112, v112
    v_rcp_f32 v113, v113
    v_rcp_f32 v114, v114
    v_rcp_f32 v115, v115
    v_pk_mul_f32 v[28:29], v[28:29], v[108:109]
    v_pk_mul_f32 v[30:31], v[30:31], v[110:111]
    v_pk_mul_f32 v[44:45], v[44:45], v[112:113]
    v_pk_mul_f32 v[46:47], v[46:47], v[114:115]
    v_cvt_pk_bf16_f32 v92, v28, v29
    v_cvt_pk_bf16_f32 v93, v30, v31
    v_cvt_pk_bf16_f32 v94, v44, v45
    v_cvt_pk_bf16_f32 v95, v46, v47
    s_nop 1
    v_permlane16_swap_b32 v92, v94
    v_permlane16_swap_b32 v93, v95
    buffer_store_dwordx4 v[92:95], v9, s[16:19], s52 offen offset:0 sc1
    v_pk_mul_f32 v[108:109], v[60:61], v[60:61]
    v_pk_mul_f32 v[110:111], v[62:63], v[62:63]
    v_pk_mul_f32 v[112:113], v[76:77], v[76:77]
    v_pk_mul_f32 v[114:115], v[78:79], v[78:79]
    v_pk_fma_f32 v[108:109], v[108:109], v[10:11], v[12:13]
    v_pk_fma_f32 v[110:111], v[110:111], v[10:11], v[12:13]
    v_pk_fma_f32 v[112:113], v[112:113], v[10:11], v[12:13]
    v_pk_fma_f32 v[114:115], v[114:115], v[10:11], v[12:13]
    v_pk_mul_f32 v[108:109], v[108:109], v[60:61]
    v_pk_mul_f32 v[110:111], v[110:111], v[62:63]
    v_pk_mul_f32 v[112:113], v[112:113], v[76:77]
    v_pk_mul_f32 v[114:115], v[114:115], v[78:79]
    v_exp_f32 v108, v108
    v_exp_f32 v109, v109
    v_exp_f32 v110, v110
    v_exp_f32 v111, v111
    v_exp_f32 v112, v112
    v_exp_f32 v113, v113
    v_exp_f32 v114, v114
    v_exp_f32 v115, v115
    v_pk_add_f32 v[108:109], v[108:109], v[14:15]
    v_pk_add_f32 v[110:111], v[110:111], v[14:15]
    v_pk_add_f32 v[112:113], v[112:113], v[14:15]
    v_pk_add_f32 v[114:115], v[114:115], v[14:15]
    v_rcp_f32 v108, v108
    v_rcp_f32 v109, v109
    v_rcp_f32 v110, v110
    v_rcp_f32 v111, v111
    v_rcp_f32 v112, v112
    v_rcp_f32 v113, v113
    v_rcp_f32 v114, v114
    v_rcp_f32 v115, v115
    v_pk_mul_f32 v[60:61], v[60:61], v[108:109]
    v_pk_mul_f32 v[62:63], v[62:63], v[110:111]
    v_pk_mul_f32 v[76:77], v[76:77], v[112:113]
    v_pk_mul_f32 v[78:79], v[78:79], v[114:115]
    v_cvt_pk_bf16_f32 v96, v60, v61
    v_cvt_pk_bf16_f32 v97, v62, v63
    v_cvt_pk_bf16_f32 v98, v76, v77
    v_cvt_pk_bf16_f32 v99, v78, v79
    s_nop 1
    v_permlane16_swap_b32 v96, v98
    v_permlane16_swap_b32 v97, v99
    buffer_store_dwordx4 v[96:99], v9, s[16:19], s52 offen offset:64 sc1
    v_pk_mul_f32 v[108:109], v[32:33], v[32:33]
    v_pk_mul_f32 v[110:111], v[34:35], v[34:35]
    v_pk_mul_f32 v[112:113], v[48:49], v[48:49]
    v_pk_mul_f32 v[114:115], v[50:51], v[50:51]
    v_pk_fma_f32 v[108:109], v[108:109], v[10:11], v[12:13]
    v_pk_fma_f32 v[110:111], v[110:111], v[10:11], v[12:13]
    v_pk_fma_f32 v[112:113], v[112:113], v[10:11], v[12:13]
    v_pk_fma_f32 v[114:115], v[114:115], v[10:11], v[12:13]
    v_pk_mul_f32 v[108:109], v[108:109], v[32:33]
    v_pk_mul_f32 v[110:111], v[110:111], v[34:35]
    v_pk_mul_f32 v[112:113], v[112:113], v[48:49]
    v_pk_mul_f32 v[114:115], v[114:115], v[50:51]
    v_exp_f32 v108, v108
    v_exp_f32 v109, v109
    v_exp_f32 v110, v110
    v_exp_f32 v111, v111
    v_exp_f32 v112, v112
    v_exp_f32 v113, v113
    v_exp_f32 v114, v114
    v_exp_f32 v115, v115
    v_pk_add_f32 v[108:109], v[108:109], v[14:15]
    v_pk_add_f32 v[110:111], v[110:111], v[14:15]
    v_pk_add_f32 v[112:113], v[112:113], v[14:15]
    v_pk_add_f32 v[114:115], v[114:115], v[14:15]
    v_rcp_f32 v108, v108
    v_rcp_f32 v109, v109
    v_rcp_f32 v110, v110
    v_rcp_f32 v111, v111
    v_rcp_f32 v112, v112
    v_rcp_f32 v113, v113
    v_rcp_f32 v114, v114
    v_rcp_f32 v115, v115
    v_pk_mul_f32 v[32:33], v[32:33], v[108:109]
    v_pk_mul_f32 v[34:35], v[34:35], v[110:111]
    v_pk_mul_f32 v[48:49], v[48:49], v[112:113]
    v_pk_mul_f32 v[50:51], v[50:51], v[114:115]
    v_cvt_pk_bf16_f32 v100, v32, v33
    v_cvt_pk_bf16_f32 v101, v34, v35
    v_cvt_pk_bf16_f32 v102, v48, v49
    v_cvt_pk_bf16_f32 v103, v50, v51
    s_nop 1
    v_permlane16_swap_b32 v100, v102
    v_permlane16_swap_b32 v101, v103
    buffer_store_dwordx4 v[100:103], v9, s[16:19], s53 offen offset:0 sc1
    v_pk_mul_f32 v[108:109], v[64:65], v[64:65]
    v_pk_mul_f32 v[110:111], v[66:67], v[66:67]
    v_pk_mul_f32 v[112:113], v[80:81], v[80:81]
    v_pk_mul_f32 v[114:115], v[82:83], v[82:83]
    v_pk_fma_f32 v[108:109], v[108:109], v[10:11], v[12:13]
    v_pk_fma_f32 v[110:111], v[110:111], v[10:11], v[12:13]
    v_pk_fma_f32 v[112:113], v[112:113], v[10:11], v[12:13]
    v_pk_fma_f32 v[114:115], v[114:115], v[10:11], v[12:13]
    v_pk_mul_f32 v[108:109], v[108:109], v[64:65]
    v_pk_mul_f32 v[110:111], v[110:111], v[66:67]
    v_pk_mul_f32 v[112:113], v[112:113], v[80:81]
    v_pk_mul_f32 v[114:115], v[114:115], v[82:83]
    v_exp_f32 v108, v108
    v_exp_f32 v109, v109
    v_exp_f32 v110, v110
    v_exp_f32 v111, v111
    v_exp_f32 v112, v112
    v_exp_f32 v113, v113
    v_exp_f32 v114, v114
    v_exp_f32 v115, v115
    v_pk_add_f32 v[108:109], v[108:109], v[14:15]
    v_pk_add_f32 v[110:111], v[110:111], v[14:15]
    v_pk_add_f32 v[112:113], v[112:113], v[14:15]
    v_pk_add_f32 v[114:115], v[114:115], v[14:15]
    v_rcp_f32 v108, v108
    v_rcp_f32 v109, v109
    v_rcp_f32 v110, v110
    v_rcp_f32 v111, v111
    v_rcp_f32 v112, v112
    v_rcp_f32 v113, v113
    v_rcp_f32 v114, v114
    v_rcp_f32 v115, v115
    v_pk_mul_f32 v[64:65], v[64:65], v[108:109]
    v_pk_mul_f32 v[66:67], v[66:67], v[110:111]
    v_pk_mul_f32 v[80:81], v[80:81], v[112:113]
    v_pk_mul_f32 v[82:83], v[82:83], v[114:115]
    v_cvt_pk_bf16_f32 v104, v64, v65
    v_cvt_pk_bf16_f32 v105, v66, v67
    v_cvt_pk_bf16_f32 v106, v80, v81
    v_cvt_pk_bf16_f32 v107, v82, v83
    s_nop 1
    v_permlane16_swap_b32 v104, v106
    v_permlane16_swap_b32 v105, v107
    buffer_store_dwordx4 v[104:107], v9, s[16:19], s53 offen offset:64 sc1
    v_pk_mul_f32 v[108:109], v[36:37], v[36:37]
    v_pk_mul_f32 v[110:111], v[38:39], v[38:39]
    v_pk_mul_f32 v[112:113], v[52:53], v[52:53]
    v_pk_mul_f32 v[114:115], v[54:55], v[54:55]
    v_pk_fma_f32 v[108:109], v[108:109], v[10:11], v[12:13]
    v_pk_fma_f32 v[110:111], v[110:111], v[10:11], v[12:13]
    v_pk_fma_f32 v[112:113], v[112:113], v[10:11], v[12:13]
    v_pk_fma_f32 v[114:115], v[114:115], v[10:11], v[12:13]
    v_pk_mul_f32 v[108:109], v[108:109], v[36:37]
    v_pk_mul_f32 v[110:111], v[110:111], v[38:39]
    v_pk_mul_f32 v[112:113], v[112:113], v[52:53]
    v_pk_mul_f32 v[114:115], v[114:115], v[54:55]
    v_exp_f32 v108, v108
    v_exp_f32 v109, v109
    v_exp_f32 v110, v110
    v_exp_f32 v111, v111
    v_exp_f32 v112, v112
    v_exp_f32 v113, v113
    v_exp_f32 v114, v114
    v_exp_f32 v115, v115
    v_pk_add_f32 v[108:109], v[108:109], v[14:15]
    v_pk_add_f32 v[110:111], v[110:111], v[14:15]
    v_pk_add_f32 v[112:113], v[112:113], v[14:15]
    v_pk_add_f32 v[114:115], v[114:115], v[14:15]
    v_rcp_f32 v108, v108
    v_rcp_f32 v109, v109
    v_rcp_f32 v110, v110
    v_rcp_f32 v111, v111
    v_rcp_f32 v112, v112
    v_rcp_f32 v113, v113
    v_rcp_f32 v114, v114
    v_rcp_f32 v115, v115
    v_pk_mul_f32 v[36:37], v[36:37], v[108:109]
    v_pk_mul_f32 v[38:39], v[38:39], v[110:111]
    v_pk_mul_f32 v[52:53], v[52:53], v[112:113]
    v_pk_mul_f32 v[54:55], v[54:55], v[114:115]
    v_cvt_pk_bf16_f32 v92, v36, v37
    v_cvt_pk_bf16_f32 v93, v38, v39
    v_cvt_pk_bf16_f32 v94, v52, v53
    v_cvt_pk_bf16_f32 v95, v54, v55
    s_nop 1
    v_permlane16_swap_b32 v92, v94
    v_permlane16_swap_b32 v93, v95
    buffer_store_dwordx4 v[92:95], v9, s[16:19], s54 offen offset:0 sc1
    v_pk_mul_f32 v[108:109], v[68:69], v[68:69]
    v_pk_mul_f32 v[110:111], v[70:71], v[70:71]
    v_pk_mul_f32 v[112:113], v[84:85], v[84:85]
    v_pk_mul_f32 v[114:115], v[86:87], v[86:87]
    v_pk_fma_f32 v[108:109], v[108:109], v[10:11], v[12:13]
    v_pk_fma_f32 v[110:111], v[110:111], v[10:11], v[12:13]
    v_pk_fma_f32 v[112:113], v[112:113], v[10:11], v[12:13]
    v_pk_fma_f32 v[114:115], v[114:115], v[10:11], v[12:13]
    v_pk_mul_f32 v[108:109], v[108:109], v[68:69]
    v_pk_mul_f32 v[110:111], v[110:111], v[70:71]
    v_pk_mul_f32 v[112:113], v[112:113], v[84:85]
    v_pk_mul_f32 v[114:115], v[114:115], v[86:87]
    v_exp_f32 v108, v108
    v_exp_f32 v109, v109
    v_exp_f32 v110, v110
    v_exp_f32 v111, v111
    v_exp_f32 v112, v112
    v_exp_f32 v113, v113
    v_exp_f32 v114, v114
    v_exp_f32 v115, v115
    v_pk_add_f32 v[108:109], v[108:109], v[14:15]
    v_pk_add_f32 v[110:111], v[110:111], v[14:15]
    v_pk_add_f32 v[112:113], v[112:113], v[14:15]
    v_pk_add_f32 v[114:115], v[114:115], v[14:15]
    v_rcp_f32 v108, v108
    v_rcp_f32 v109, v109
    v_rcp_f32 v110, v110
    v_rcp_f32 v111, v111
    v_rcp_f32 v112, v112
    v_rcp_f32 v113, v113
    v_rcp_f32 v114, v114
    v_rcp_f32 v115, v115
    v_pk_mul_f32 v[68:69], v[68:69], v[108:109]
    v_pk_mul_f32 v[70:71], v[70:71], v[110:111]
    v_pk_mul_f32 v[84:85], v[84:85], v[112:113]
    v_pk_mul_f32 v[86:87], v[86:87], v[114:115]
    v_cvt_pk_bf16_f32 v96, v68, v69
    v_cvt_pk_bf16_f32 v97, v70, v71
    v_cvt_pk_bf16_f32 v98, v84, v85
    v_cvt_pk_bf16_f32 v99, v86, v87
    s_nop 1
    v_permlane16_swap_b32 v96, v98
    v_permlane16_swap_b32 v97, v99
    buffer_store_dwordx4 v[96:99], v9, s[16:19], s54 offen offset:64 sc1
    v_pk_mul_f32 v[108:109], v[40:41], v[40:41]
    v_pk_mul_f32 v[110:111], v[42:43], v[42:43]
    v_pk_mul_f32 v[112:113], v[56:57], v[56:57]
    v_pk_mul_f32 v[114:115], v[58:59], v[58:59]
    v_pk_fma_f32 v[108:109], v[108:109], v[10:11], v[12:13]
    v_pk_fma_f32 v[110:111], v[110:111], v[10:11], v[12:13]
    v_pk_fma_f32 v[112:113], v[112:113], v[10:11], v[12:13]
    v_pk_fma_f32 v[114:115], v[114:115], v[10:11], v[12:13]
    v_pk_mul_f32 v[108:109], v[108:109], v[40:41]
    v_pk_mul_f32 v[110:111], v[110:111], v[42:43]
    v_pk_mul_f32 v[112:113], v[112:113], v[56:57]
    v_pk_mul_f32 v[114:115], v[114:115], v[58:59]
    v_exp_f32 v108, v108
    v_exp_f32 v109, v109
    v_exp_f32 v110, v110
    v_exp_f32 v111, v111
    v_exp_f32 v112, v112
    v_exp_f32 v113, v113
    v_exp_f32 v114, v114
    v_exp_f32 v115, v115
    v_pk_add_f32 v[108:109], v[108:109], v[14:15]
    v_pk_add_f32 v[110:111], v[110:111], v[14:15]
    v_pk_add_f32 v[112:113], v[112:113], v[14:15]
    v_pk_add_f32 v[114:115], v[114:115], v[14:15]
    v_rcp_f32 v108, v108
    v_rcp_f32 v109, v109
    v_rcp_f32 v110, v110
    v_rcp_f32 v111, v111
    v_rcp_f32 v112, v112
    v_rcp_f32 v113, v113
    v_rcp_f32 v114, v114
    v_rcp_f32 v115, v115
    v_pk_mul_f32 v[40:41], v[40:41], v[108:109]
    v_pk_mul_f32 v[42:43], v[42:43], v[110:111]
    v_pk_mul_f32 v[56:57], v[56:57], v[112:113]
    v_pk_mul_f32 v[58:59], v[58:59], v[114:115]
    v_cvt_pk_bf16_f32 v100, v40, v41
    v_cvt_pk_bf16_f32 v101, v42, v43
    v_cvt_pk_bf16_f32 v102, v56, v57
    v_cvt_pk_bf16_f32 v103, v58, v59
    s_nop 1
    v_permlane16_swap_b32 v100, v102
    v_permlane16_swap_b32 v101, v103
    buffer_store_dwordx4 v[100:103], v9, s[16:19], s55 offen offset:0 sc1
    v_pk_mul_f32 v[108:109], v[72:73], v[72:73]
    v_pk_mul_f32 v[110:111], v[74:75], v[74:75]
    v_pk_mul_f32 v[112:113], v[88:89], v[88:89]
    v_pk_mul_f32 v[114:115], v[90:91], v[90:91]
    v_pk_fma_f32 v[108:109], v[108:109], v[10:11], v[12:13]
    v_pk_fma_f32 v[110:111], v[110:111], v[10:11], v[12:13]
    v_pk_fma_f32 v[112:113], v[112:113], v[10:11], v[12:13]
    v_pk_fma_f32 v[114:115], v[114:115], v[10:11], v[12:13]
    v_pk_mul_f32 v[108:109], v[108:109], v[72:73]
    v_pk_mul_f32 v[110:111], v[110:111], v[74:75]
    v_pk_mul_f32 v[112:113], v[112:113], v[88:89]
    v_pk_mul_f32 v[114:115], v[114:115], v[90:91]
    v_exp_f32 v108, v108
    v_exp_f32 v109, v109
    v_exp_f32 v110, v110
    v_exp_f32 v111, v111
    v_exp_f32 v112, v112
    v_exp_f32 v113, v113
    v_exp_f32 v114, v114
    v_exp_f32 v115, v115
    v_pk_add_f32 v[108:109], v[108:109], v[14:15]
    v_pk_add_f32 v[110:111], v[110:111], v[14:15]
    v_pk_add_f32 v[112:113], v[112:113], v[14:15]
    v_pk_add_f32 v[114:115], v[114:115], v[14:15]
    v_rcp_f32 v108, v108
    v_rcp_f32 v109, v109
    v_rcp_f32 v110, v110
    v_rcp_f32 v111, v111
    v_rcp_f32 v112, v112
    v_rcp_f32 v113, v113
    v_rcp_f32 v114, v114
    v_rcp_f32 v115, v115
    v_pk_mul_f32 v[72:73], v[72:73], v[108:109]
    v_pk_mul_f32 v[74:75], v[74:75], v[110:111]
    v_pk_mul_f32 v[88:89], v[88:89], v[112:113]
    v_pk_mul_f32 v[90:91], v[90:91], v[114:115]
    v_cvt_pk_bf16_f32 v104, v72, v73
    v_cvt_pk_bf16_f32 v105, v74, v75
    v_cvt_pk_bf16_f32 v106, v88, v89
    v_cvt_pk_bf16_f32 v107, v90, v91
    s_nop 1
    v_permlane16_swap_b32 v104, v106
    v_permlane16_swap_b32 v105, v107
    buffer_store_dwordx4 v[104:107], v9, s[16:19], s55 offen offset:64 sc1
    s_cmp_ge_u32 s24, 14
    s_cselect_b32 s40, 25, 24
    s_lshl_b32 s41, s25, 1
    s_add_u32 s40, s40, s41
    s_lshl_b32 s40, s40, 8
    s_add_u32 s84, s4, 0x300000
    s_addc_u32 s85, s5, 0
    s_mov_b32 s86, 0x4000
    s_mov_b32 s87, 0x20000
    v_mov_b32 v3, s40
    v_mov_b32 v4, 1
    s_waitcnt vmcnt(0)
    s_barrier
    s_cmp_lg_u32 s28, 0
    s_cbranch_scc1 g3_cin
    s_mov_b64 exec, 1
    buffer_atomic_add v4, v3, s[84:87], 0 offen sc1
    s_mov_b64 exec, -1
g3_cin:
    s_branch g4_in
g3_spare:
    s_cmp_ge_u32 s2, 256
    s_cbranch_scc1 g3_done
    s_load_dwordx2 s[4:5], s[0:1], 80
    s_load_dwordx2 s[6:7], s[0:1], 48
    s_sub_u32 s3, s2, 224
    v_lshrrev_b32 v2, 6, v0
    v_lshlrev_b32 v1, 4, v0
    v_mov_b32 v8, -1
    v_mov_b32 v9, -1
    v_mov_b32 v10, -1
    v_mov_b32 v11, -1
    v_readfirstlane_b32 s28, v2
    s_lshl_b32 s13, s3, 17
    s_waitcnt lgkmcnt(0)
    s_add_u32 s4, s4, s97
    s_addc_u32 s5, s5, 0
    s_add_u32 s8, s4, 0x1d00000
    s_addc_u32 s9, s5, 0
    s_mov_b32 s10, 0x400000
    s_mov_b32 s11, 0x20000
    buffer_store_dwordx4 v[8:11], v1, s[8:11], s13 offen sc1
    s_add_u32 s13, s13, 8192
    buffer_store_dwordx4 v[8:11], v1, s[8:11], s13 offen sc1
    s_add_u32 s13, s13, 8192
    buffer_store_dwordx4 v[8:11], v1, s[8:11], s13 offen sc1
    s_add_u32 s13, s13, 8192
    buffer_store_dwordx4 v[8:11], v1, s[8:11], s13 offen sc1
    s_add_u32 s13, s13, 8192
    buffer_store_dwordx4 v[8:11], v1, s[8:11], s13 offen sc1
    s_add_u32 s13, s13, 8192
    buffer_store_dwordx4 v[8:11], v1, s[8:11], s13 offen sc1
    s_add_u32 s13, s13, 8192
    buffer_store_dwordx4 v[8:11], v1, s[8:11], s13 offen sc1
    s_add_u32 s13, s13, 8192
    buffer_store_dwordx4 v[8:11], v1, s[8:11], s13 offen sc1
    s_add_u32 s13, s13, 8192
    buffer_store_dwordx4 v[8:11], v1, s[8:11], s13 offen sc1
    s_add_u32 s13, s13, 8192
    buffer_store_dwordx4 v[8:11], v1, s[8:11], s13 offen sc1
    s_add_u32 s13, s13, 8192
    buffer_store_dwordx4 v[8:11], v1, s[8:11], s13 offen sc1
    s_add_u32 s13, s13, 8192
    buffer_store_dwordx4 v[8:11], v1, s[8:11], s13 offen sc1
    s_add_u32 s13, s13, 8192
    buffer_store_dwordx4 v[8:11], v1, s[8:11], s13 offen sc1
    s_add_u32 s13, s13, 8192
    buffer_store_dwordx4 v[8:11], v1, s[8:11], s13 offen sc1
    s_add_u32 s13, s13, 8192
    buffer_store_dwordx4 v[8:11], v1, s[8:11], s13 offen sc1
    s_add_u32 s13, s13, 8192
    buffer_store_dwordx4 v[8:11], v1, s[8:11], s13 offen sc1
    s_add_u32 s13, s13, 8192
    s_mov_b32 s40, 14336
    s_add_u32 s84, s4, 0x300000
    s_addc_u32 s85, s5, 0
    s_mov_b32 s86, 0x4000
    s_mov_b32 s87, 0x20000
    v_mov_b32 v3, s40
    v_mov_b32 v4, 1
    s_waitcnt vmcnt(0)
    s_barrier
    s_cmp_lg_u32 s28, 0
    s_cbranch_scc1 g3_spare_cin
    s_mov_b64 exec, 1
    buffer_atomic_add v4, v3, s[84:87], 0 offen sc1
    s_mov_b64 exec, -1
g3_spare_cin:
    s_cmp_lg_u32 s96, 0
    s_cbranch_scc1 g3_spare_end
    s_mov_b32 s8, s6
    s_mov_b32 s9, s7
    s_mov_b32 s10, 0xe00000
    s_mov_b32 s11, 0x20000
    s_cmp_ge_u32 s3, 16
    s_cselect_b32 s12, 3145728, 0
    s_lshl_b32 s3, s3, 18
    s_add_u32 s3, s3, s12
    s_mov_b32 s12, 4
g3_spare_loop:
    buffer_load_dwordx4 v[4:7], v1, s[8:11], s3 offen
    s_add_u32 s3, s3, 8192
    buffer_load_dwordx4 v[4:7], v1, s[8:11], s3 offen
    s_add_u32 s3, s3, 8192
    buffer_load_dwordx4 v[4:7], v1, s[8:11], s3 offen
    s_add_u32 s3, s3, 8192
    buffer_load_dwordx4 v[4:7], v1, s[8:11], s3 offen
    s_add_u32 s3, s3, 8192
    buffer_load_dwordx4 v[4:7], v1, s[8:11], s3 offen
    s_add_u32 s3, s3, 8192
    buffer_load_dwordx4 v[4:7], v1, s[8:11], s3 offen
    s_add_u32 s3, s3, 8192
    buffer_load_dwordx4 v[4:7], v1, s[8:11], s3 offen
    s_add_u32 s3, s3, 8192
    buffer_load_dwordx4 v[4:7], v1, s[8:11], s3 offen
    s_add_u32 s3, s3, 8192
    s_waitcnt vmcnt(8)
    s_sub_u32 s12, s12, 1
    s_cmp_lg_u32 s12, 0
    s_cbranch_scc1 g3_spare_loop
    s_waitcnt vmcnt(0)
g3_spare_end:
    s_branch g4_in
.p2align 6
g4_in:
    s_cmp_ge_u32 s2, 256
    s_cbranch_scc1 g4_done
    s_load_dwordx2 s[4:5], s[0:1], 80
    s_load_dwordx2 s[6:7], s[0:1], 64
    s_load_dwordx2 s[30:31], s[0:1], 48
    s_load_dwordx2 s[34:35], s[0:1], 56
    v_lshrrev_b32 v1, 6, v0
    v_and_b32 v2, 63, v0
    s_bfe_u32 s40, s2, 0x10001
    s_lshl_b32 s40, s40, 2
    s_bfe_u32 s41, s2, 0x20003
    s_add_u32 s24, s40, s41
    s_bfe_u32 s40, s2, 0x10002
    s_lshl_b32 s40, s40, 3
    s_lshr_b32 s42, s2, 5
    s_add_u32 s25, s40, s42
    s_and_b32 s91, s2, 1
    s_add_u32 s27, s41, s42
    s_lshl_b32 s92, s24, 4
    s_add_u32 s92, s92, s25
    s_mul_i32 s26, s91, 28
    s_cmp_eq_u32 s96, 0
    s_cselect_b32 s95, 3, 1
    v_readfirstlane_b32 s28, v1
    s_nop 0
    s_cmp_lt_u32 s28, 4
    s_cbranch_scc1 g4_compute
    s_sub_u32 s28, s28, 4
    s_mov_b32 s40, 8192
    v_lshrrev_b32 v3, 3, v2
    v_mul_lo_u32 v3, v3, s40
    v_lshrrev_b32 v4, 4, v2
    v_xor_b32 v4, v4, v2
    v_and_b32 v4, 7, v4
    v_lshl_add_u32 v3, v4, 4, v3
    s_mul_i32 s41, s24, 1048576
    s_mul_i32 s42, s28, 262144
    s_add_u32 s41, s41, s42
    v_xor_b32 v4, 64, v3
    s_add_u32 s42, s41, 0
    v_add_u32 v10, s42, v3
    s_add_u32 s42, s41, 65536
    v_add_u32 v11, s42, v4
    s_add_u32 s42, s41, 131072
    v_add_u32 v12, s42, v3
    s_add_u32 s42, s41, 196608
    v_add_u32 v13, s42, v4
    s_mov_b32 s40, 4096
    v_lshrrev_b32 v4, 4, v2
    v_mul_lo_u32 v3, v4, s40
    v_lshlrev_b32 v4, 1, v4
    v_xor_b32 v4, v4, v2
    v_and_b32 v4, 15, v4
    v_lshl_add_u32 v3, v4, 4, v3
    s_mul_i32 s41, s25, 256
    s_mul_i32 s42, s28, 65536
    s_add_u32 s41, s41, s42
    v_xor_b32 v4, 128, v3
    s_add_u32 s42, s41, 0
    v_add_u32 v14, s42, v3
    s_add_u32 s42, s41, 16384
    v_add_u32 v15, s42, v3
    s_add_u32 s42, s41, 32768
    v_add_u32 v16, s42, v4
    s_add_u32 s42, s41, 49152
    v_add_u32 v17, s42, v4
    s_mul_i32 s36, s28, 4096
    s_mul_i32 s37, s28, 4096
    s_add_u32 s37, s37, 16384
    s_waitcnt lgkmcnt(0)
    s_add_u32 s4, s4, s97
    s_addc_u32 s5, s5, 0
    s_add_u32 s8, s4, 0x1100000
    s_addc_u32 s9, s5, 0
    s_mov_b32 s10, 0x800000
    s_mov_b32 s11, 0x20000
    s_mov_b32 s12, s30
    s_mov_b32 s13, s31
    s_mov_b32 s14, 0xe00000
    s_mov_b32 s15, 0x20000
    s_lshl_b32 s40, s24, 1
    s_add_u32 s40, s40, s91
    s_add_u32 s40, s40, 24
    s_lshl_b32 s40, s40, 8
    s_mov_b32 s42, 14336
    s_add_u32 s84, s4, 0x300000
    s_addc_u32 s85, s5, 0
    s_mov_b32 s86, 0x4000
    s_mov_b32 s87, 0x20000
    v_cmp_eq_u32 vcc, 1, v2
    v_mov_b32 v21, s40
    v_mov_b32 v23, s42
    v_cndmask_b32 v21, v21, v23, vcc
    v_mov_b32 v22, 14
    v_mov_b32 v23, 32
    v_cndmask_b32 v22, v22, v23, vcc
    s_mov_b32 s41, 0x8000
g4_dep:
    buffer_load_dword v23, v21, s[84:87], 0 offen sc1
    s_sub_u32 s41, s41, 1
    s_waitcnt vmcnt(0)
    v_cmp_lt_u32 vcc, v23, v22
    s_cmp_eq_u32 s41, 0
    s_cbranch_scc1 g4_dep_ok
    s_cbranch_vccz g4_dep_ok
    s_sleep 2
    s_branch g4_dep
g4_dep_ok:
    s_mov_b32 s32, 0
    s_mov_b32 s33, 0
g4_ld_loop:
    s_cmp_lt_u32 s32, 3
    s_cbranch_scc1 g4_ld_issue
    s_waitcnt vmcnt(16)
g4_ld_bar:
    s_barrier
g4_ld_issue:
    s_add_u32 s40, s32, s27
    s_and_b32 s40, s40, s95
    s_andn2_b32 s41, s32, s95
    s_or_b32 s40, s40, s41
    s_add_u32 s40, s40, s26
    s_mul_i32 s34, s40, 128
    s_mul_i32 s35, s40, 262144
    s_add_u32 s38, s33, s36
    s_add_u32 s39, s33, s37
    s_add_u32 m0, s38, 0
    s_nop 0
    buffer_load_dwordx4 v10, s[8:11], s34 offen lds
    s_add_u32 m0, s38, 1024
    s_nop 0
    buffer_load_dwordx4 v11, s[8:11], s34 offen lds
    s_add_u32 m0, s38, 2048
    s_nop 0
    buffer_load_dwordx4 v12, s[8:11], s34 offen lds
    s_add_u32 m0, s38, 3072
    s_nop 0
    buffer_load_dwordx4 v13, s[8:11], s34 offen lds
    s_add_u32 m0, s39, 0
    s_nop 0
    buffer_load_dwordx4 v14, s[12:15], s35 offen lds
    s_add_u32 m0, s39, 1024
    s_nop 0
    buffer_load_dwordx4 v15, s[12:15], s35 offen lds
    s_add_u32 m0, s39, 2048
    s_nop 0
    buffer_load_dwordx4 v16, s[12:15], s35 offen lds
    s_add_u32 m0, s39, 3072
    s_nop 0
    buffer_load_dwordx4 v17, s[12:15], s35 offen lds
    s_add_u32 s33, s33, 32768
    s_cmp_eq_u32 s33, 131072
    s_cselect_b32 s33, 0, s33
    s_add_u32 s32, s32, 1
    s_cmp_lt_u32 s32, 28
    s_cbranch_scc1 g4_ld_loop
    s_waitcnt vmcnt(16)
    s_barrier
    s_waitcnt vmcnt(8)
    s_barrier
    s_waitcnt vmcnt(0)
    s_barrier
    s_cmp_lg_u32 s96, 0
    s_cbranch_scc1 g4_done
    s_barrier
    s_mov_b32 s96, 1
    s_mov_b32 s97, 0x2800000
    s_branch g1_in
g4_done:
    s_endpgm
g4_compute:
    v_lshrrev_b32 v5, 4, v2
    v_bfe_u32 v6, v2, 2, 2
    v_and_b32 v7, 3, v2
    v_and_b32 v8, 15, v2
    s_and_b32 s44, s28, 1
    s_lshr_b32 s45, s28, 1
    s_mul_i32 s40, s25, 128
    s_mul_i32 s41, s45, 64
    s_add_u32 s40, s40, s41
    s_lshl_b32 s41, s91, 5
    s_add_u32 s40, s40, s41
    v_add_u32 v20, s40, v8
    s_mov_b32 s41, 2048
    v_mul_lo_u32 v9, v20, s41
    s_mul_i32 s40, s24, 256
    s_mul_i32 s41, s44, 128
    s_add_u32 s46, s40, s41
    v_and_b32 v3, 1, v5
    v_lshlrev_b32 v3, 5, v3
    v_lshrrev_b32 v4, 1, v5
    v_lshl_add_u32 v3, v4, 4, v3
    v_add3_u32 v9, v9, v3, s46
    s_mov_b32 s52, 0
    s_mov_b32 s53, 32768
    s_mov_b32 s54, 65536
    s_mov_b32 s55, 98304
    s_waitcnt lgkmcnt(0)
    s_add_u32 s4, s4, s97
    s_addc_u32 s5, s5, 0
    s_add_u32 s20, s4, 0x800000
    s_addc_u32 s21, s5, 0
    s_mov_b32 s22, 0x400000
    s_mov_b32 s23, 0x20000
    s_mov_b32 s56, s34
    s_mov_b32 s57, s35
    s_mov_b32 s58, 0x1000
    s_mov_b32 s59, 0x20000
    s_add_u32 s16, s4, 0x4100000
    s_addc_u32 s17, s5, 0
    s_cmp_eq_u32 s96, 0
    s_cselect_b32 s16, s16, s6
    s_cselect_b32 s17, s17, s7
    s_mov_b32 s18, 0x400000
    s_mov_b32 s19, 0x20000
    s_add_u32 s60, s4, 0x2800000
    s_addc_u32 s61, s5, 0
    s_mov_b32 s62, 0x40000
    s_mov_b32 s63, 0x20000
    s_add_u32 s84, s4, 0x1d00000
    s_addc_u32 s85, s5, 0
    s_mov_b32 s86, 0x400000
    s_mov_b32 s87, 0x20000
    s_mul_i32 s42, s44, 64
    v_lshrrev_b32 v3, 1, v8
    v_xor_b32 v3, v3, v5
    v_lshlrev_b32 v3, 4, v3
    v_lshl_add_u32 v3, v8, 7, v3
    s_lshl_b32 s40, s42, 7
    s_add_u32 s40, s40, 0
    v_add_u32 v10, s40, v3
    v_xor_b32 v11, 64, v10
    s_lshl_b32 s90, s91, 1
    s_mul_i32 s42, s45, 4
    s_mov_b32 s43, 16384
    v_and_b32 v3, 1, v5
    v_lshl_or_b32 v3, v3, 2, v6
    s_add_u32 s40, s42, 0
    s_xor_b32 s40, s40, s90
    v_xor_b32 v3, s40, v3
    v_lshlrev_b32 v3, 5, v3
    v_lshl_add_u32 v3, v7, 3, v3
    v_lshl_add_u32 v4, v5, 3, v6
    v_lshl_add_u32 v3, v4, 8, v3
    v_add_u32 v12, s43, v3
    v_and_b32 v3, 1, v5
    v_lshl_or_b32 v3, v3, 2, v6
    s_add_u32 s40, s42, 1
    s_xor_b32 s40, s40, s90
    v_xor_b32 v3, s40, v3
    v_lshlrev_b32 v3, 5, v3
    v_lshl_add_u32 v3, v7, 3, v3
    v_lshl_add_u32 v4, v5, 3, v6
    v_lshl_add_u32 v3, v4, 8, v3
    v_add_u32 v13, s43, v3
    v_and_b32 v3, 1, v5
    v_lshl_or_b32 v3, v3, 2, v6
    s_add_u32 s40, s42, 2
    s_xor_b32 s40, s40, s90
    v_xor_b32 v3, s40, v3
    v_lshlrev_b32 v3, 5, v3
    v_lshl_add_u32 v3, v7, 3, v3
    v_lshl_add_u32 v4, v5, 3, v6
    v_lshl_add_u32 v3, v4, 8, v3
    v_add_u32 v14, s43, v3
    v_and_b32 v3, 1, v5
    v_lshl_or_b32 v3, v3, 2, v6
    s_add_u32 s40, s42, 3
    s_xor_b32 s40, s40, s90
    v_xor_b32 v3, s40, v3
    v_lshlrev_b32 v3, 5, v3
    v_lshl_add_u32 v3, v7, 3, v3
    v_lshl_add_u32 v4, v5, 3, v6
    v_lshl_add_u32 v3, v4, 8, v3
    v_add_u32 v15, s43, v3
    v_mov_b32 v124, 0
    v_mov_b32 v125, 0
    v_mov_b32 v126, 0
    v_mov_b32 v127, 0
    v_mov_b32 v128, 0
    v_mov_b32 v129, 0
    v_mov_b32 v130, 0
    v_mov_b32 v131, 0
    v_mov_b32 v132, 0
    v_mov_b32 v133, 0
    v_mov_b32 v134, 0
    v_mov_b32 v135, 0
    v_mov_b32 v136, 0
    v_mov_b32 v137, 0
    v_mov_b32 v138, 0
    v_mov_b32 v139, 0
    v_mov_b32 v140, 0
    v_mov_b32 v141, 0
    v_mov_b32 v142, 0
    v_mov_b32 v143, 0
    v_mov_b32 v144, 0
    v_mov_b32 v145, 0
    v_mov_b32 v146, 0
    v_mov_b32 v147, 0
    v_mov_b32 v148, 0
    v_mov_b32 v149, 0
    v_mov_b32 v150, 0
    v_mov_b32 v151, 0
    v_mov_b32 v152, 0
    v_mov_b32 v153, 0
    v_mov_b32 v154, 0
    v_mov_b32 v155, 0
    s_mov_b32 s48, 28
    s_mov_b32 s50, 0
    s_mov_b32 s51, 32768
    s_mov_b32 s29, 0xfffe8000
    s_lshl_b32 s40, s28, 12
    v_lshl_add_u32 v21, v2, 4, s40
    s_lshl_b32 s93, s92, 1
    s_add_u32 s93, s93, s91
    s_lshl_b32 s93, s93, 14
    s_xor_b32 s94, s93, 0x4000
    v_mov_b32 v28, 0
    v_mov_b32 v29, 0
    v_mov_b32 v30, 0
    v_mov_b32 v31, 0
    v_mov_b32 v32, 0
    v_mov_b32 v33, 0
    v_mov_b32 v34, 0
    v_mov_b32 v35, 0
    v_mov_b32 v36, 0
    v_mov_b32 v37, 0
    v_mov_b32 v38, 0
    v_mov_b32 v39, 0
    v_mov_b32 v40, 0
    v_mov_b32 v41, 0
    v_mov_b32 v42, 0
    v_mov_b32 v43, 0
    v_mov_b32 v44, 0
    v_mov_b32 v45, 0
    v_mov_b32 v46, 0
    v_mov_b32 v47, 0
    v_mov_b32 v48, 0
    v_mov_b32 v49, 0
    v_mov_b32 v50, 0
    v_mov_b32 v51, 0
    v_mov_b32 v52, 0
    v_mov_b32 v53, 0
    v_mov_b32 v54, 0
    v_mov_b32 v55, 0
    v_mov_b32 v56, 0
    v_mov_b32 v57, 0
    v_mov_b32 v58, 0
    v_mov_b32 v59, 0
    v_mov_b32 v60, 0
    v_mov_b32 v61, 0
    v_mov_b32 v62, 0
    v_mov_b32 v63, 0
    v_mov_b32 v64, 0
    v_mov_b32 v65, 0
    v_mov_b32 v66, 0
    v_mov_b32 v67, 0
    v_mov_b32 v68, 0
    v_mov_b32 v69, 0
    v_mov_b32 v70, 0
    v_mov_b32 v71, 0
    v_mov_b32 v72, 0
    v_mov_b32 v73, 0
    v_mov_b32 v74, 0
    v_mov_b32 v75, 0
    v_mov_b32 v76, 0
    v_mov_b32 v77, 0
    v_mov_b32 v78, 0
    v_mov_b32 v79, 0
    v_mov_b32 v80, 0
    v_mov_b32 v81, 0
    v_mov_b32 v82, 0
    v_mov_b32 v83, 0
    v_mov_b32 v84, 0
    v_mov_b32 v85, 0
    v_mov_b32 v86, 0
    v_mov_b32 v87, 0
    v_mov_b32 v88, 0
    v_mov_b32 v89, 0
    v_mov_b32 v90, 0
    v_mov_b32 v91, 0
    s_barrier
    buffer_load_dwordx4 v[188:191], v9, s[20:23], s52 offen offset:0
    buffer_load_dwordx4 v[192:195], v9, s[20:23], s52 offen offset:64
    buffer_load_dwordx4 v[196:199], v9, s[20:23], s53 offen offset:0
    buffer_load_dwordx4 v[200:203], v9, s[20:23], s53 offen offset:64
    v_lshlrev_b32 v3, 1, v20
    buffer_load_ushort v22, v3, s[56:59], 0 offen offset:0
    buffer_load_ushort v23, v3, s[56:59], 0 offen offset:32
    s_branch g4_cloop2
.p2align 3
g4_cloop:
    s_barrier
g4_cloop2:
    v_mfma_f32_16x16x32_bf16 v[28:31], v[124:127], v[140:143], v[28:31]
    ds_read_b128 v[92:95], v10 offset:0
    v_mfma_f32_16x16x32_bf16 v[32:35], v[124:127], v[144:147], v[32:35]
    ds_read_b64_tr_b16 v[108:109], v12 offset:0
    ds_read_b64_tr_b16 v[110:111], v12 offset:1024
    v_mfma_f32_16x16x32_bf16 v[36:39], v[124:127], v[148:151], v[36:39]
    ds_read_b64_tr_b16 v[112:113], v13 offset:0
    ds_read_b64_tr_b16 v[114:115], v13 offset:1024
    v_mfma_f32_16x16x32_bf16 v[40:43], v[124:127], v[152:155], v[40:43]
    ds_read_b64_tr_b16 v[116:117], v14 offset:0
    ds_read_b64_tr_b16 v[118:119], v14 offset:1024
    v_mfma_f32_16x16x32_bf16 v[44:47], v[128:131], v[140:143], v[44:47]
    ds_read_b64_tr_b16 v[120:121], v15 offset:0
    ds_read_b64_tr_b16 v[122:123], v15 offset:1024
    v_mfma_f32_16x16x32_bf16 v[48:51], v[128:131], v[144:147], v[48:51]
    ds_read_b128 v[96:99], v10 offset:2048
    v_mfma_f32_16x16x32_bf16 v[52:55], v[128:131], v[148:151], v[52:55]
    ds_read_b128 v[100:103], v10 offset:4096
    v_mfma_f32_16x16x32_bf16 v[56:59], v[128:131], v[152:155], v[56:59]
    ds_read_b128 v[104:107], v10 offset:6144
    v_mfma_f32_16x16x32_bf16 v[60:63], v[132:135], v[140:143], v[60:63]
    v_mfma_f32_16x16x32_bf16 v[64:67], v[132:135], v[144:147], v[64:67]
    v_mfma_f32_16x16x32_bf16 v[68:71], v[132:135], v[148:151], v[68:71]
    v_mfma_f32_16x16x32_bf16 v[72:75], v[132:135], v[152:155], v[72:75]
    v_mfma_f32_16x16x32_bf16 v[76:79], v[136:139], v[140:143], v[76:79]
    v_mfma_f32_16x16x32_bf16 v[80:83], v[136:139], v[144:147], v[80:83]
    v_mfma_f32_16x16x32_bf16 v[84:87], v[136:139], v[148:151], v[84:87]
    v_mfma_f32_16x16x32_bf16 v[88:91], v[136:139], v[152:155], v[88:91]
    s_waitcnt lgkmcnt(0)
    v_mfma_f32_16x16x32_bf16 v[28:31], v[92:95], v[108:111], v[28:31]
    ds_read_b128 v[124:127], v11 offset:0
    v_mfma_f32_16x16x32_bf16 v[32:35], v[92:95], v[112:115], v[32:35]
    ds_read_b64_tr_b16 v[140:141], v12 offset:8192
    ds_read_b64_tr_b16 v[142:143], v12 offset:9216
    v_mfma_f32_16x16x32_bf16 v[36:39], v[92:95], v[116:119], v[36:39]
    ds_read_b64_tr_b16 v[144:145], v13 offset:8192
    ds_read_b64_tr_b16 v[146:147], v13 offset:9216
    v_mfma_f32_16x16x32_bf16 v[40:43], v[92:95], v[120:123], v[40:43]
    ds_read_b64_tr_b16 v[148:149], v14 offset:8192
    ds_read_b64_tr_b16 v[150:151], v14 offset:9216
    v_mfma_f32_16x16x32_bf16 v[44:47], v[96:99], v[108:111], v[44:47]
    ds_read_b64_tr_b16 v[152:153], v15 offset:8192
    ds_read_b64_tr_b16 v[154:155], v15 offset:9216
    v_mfma_f32_16x16x32_bf16 v[48:51], v[96:99], v[112:115], v[48:51]
    ds_read_b128 v[128:131], v11 offset:2048
    v_mfma_f32_16x16x32_bf16 v[52:55], v[96:99], v[116:119], v[52:55]
    ds_read_b128 v[132:135], v11 offset:4096
    v_mfma_f32_16x16x32_bf16 v[56:59], v[96:99], v[120:123], v[56:59]
    ds_read_b128 v[136:139], v11 offset:6144
    v_mfma_f32_16x16x32_bf16 v[60:63], v[100:103], v[108:111], v[60:63]
    s_add_u32 s50, s50, 1
    s_cmp_eq_u32 s50, 4
    v_mfma_f32_16x16x32_bf16 v[64:67], v[100:103], v[112:115], v[64:67]
    s_cselect_b32 s49, s29, s51
    s_cselect_b32 s50, 0, s50
    v_mfma_f32_16x16x32_bf16 v[68:71], v[100:103], v[116:119], v[68:71]
    v_add_u32 v10, s49, v10
    v_add_u32 v11, s49, v11
    v_mfma_f32_16x16x32_bf16 v[72:75], v[100:103], v[120:123], v[72:75]
    v_add_u32 v12, s49, v12
    v_add_u32 v13, s49, v13
    v_mfma_f32_16x16x32_bf16 v[76:79], v[104:107], v[108:111], v[76:79]
    v_add_u32 v14, s49, v14
    v_add_u32 v15, s49, v15
    v_mfma_f32_16x16x32_bf16 v[80:83], v[104:107], v[112:115], v[80:83]
    s_sub_u32 s48, s48, 1
    s_cmp_lg_u32 s48, 0
    v_mfma_f32_16x16x32_bf16 v[84:87], v[104:107], v[116:119], v[84:87]
    v_mfma_f32_16x16x32_bf16 v[88:91], v[104:107], v[120:123], v[88:91]
    s_waitcnt lgkmcnt(0)
    s_cbranch_scc1 g4_cloop
    v_mfma_f32_16x16x32_bf16 v[28:31], v[124:127], v[140:143], v[28:31]
    v_mfma_f32_16x16x32_bf16 v[32:35], v[124:127], v[144:147], v[32:35]
    v_mfma_f32_16x16x32_bf16 v[36:39], v[124:127], v[148:151], v[36:39]
    v_mfma_f32_16x16x32_bf16 v[40:43], v[124:127], v[152:155], v[40:43]
    v_mfma_f32_16x16x32_bf16 v[44:47], v[128:131], v[140:143], v[44:47]
    v_mfma_f32_16x16x32_bf16 v[48:51], v[128:131], v[144:147], v[48:51]
    v_mfma_f32_16x16x32_bf16 v[52:55], v[128:131], v[148:151], v[52:55]
    v_mfma_f32_16x16x32_bf16 v[56:59], v[128:131], v[152:155], v[56:59]
    v_mfma_f32_16x16x32_bf16 v[60:63], v[132:135], v[140:143], v[60:63]
    v_mfma_f32_16x16x32_bf16 v[64:67], v[132:135], v[144:147], v[64:67]
    v_mfma_f32_16x16x32_bf16 v[68:71], v[132:135], v[148:151], v[68:71]
    v_mfma_f32_16x16x32_bf16 v[72:75], v[132:135], v[152:155], v[72:75]
    v_mfma_f32_16x16x32_bf16 v[76:79], v[136:139], v[140:143], v[76:79]
    v_mfma_f32_16x16x32_bf16 v[80:83], v[136:139], v[144:147], v[80:83]
    v_mfma_f32_16x16x32_bf16 v[84:87], v[136:139], v[148:151], v[84:87]
    v_mfma_f32_16x16x32_bf16 v[88:91], v[136:139], v[152:155], v[88:91]
    v_cvt_pk_bf16_f32 v156, v36, v37
    v_cvt_pk_bf16_f32 v157, v38, v39
    v_cvt_pk_bf16_f32 v158, v52, v53
    v_cvt_pk_bf16_f32 v159, v54, v55
    buffer_store_dwordx4 v[156:159], v21, s[84:87], s93 offen offset:0 sc1
    v_cvt_pk_bf16_f32 v160, v68, v69
    v_cvt_pk_bf16_f32 v161, v70, v71
    v_cvt_pk_bf16_f32 v162, v84, v85
    v_cvt_pk_bf16_f32 v163, v86, v87
    buffer_store_dwordx4 v[160:163], v21, s[84:87], s93 offen offset:1024 sc1
    v_cvt_pk_bf16_f32 v164, v40, v41
    v_cvt_pk_bf16_f32 v165, v42, v43
    v_cvt_pk_bf16_f32 v166, v56, v57
    v_cvt_pk_bf16_f32 v167, v58, v59
    buffer_store_dwordx4 v[164:167], v21, s[84:87], s93 offen offset:2048 sc1
    v_cvt_pk_bf16_f32 v168, v72, v73
    v_cvt_pk_bf16_f32 v169, v74, v75
    s_nop 3
    v_cvt_pk_bf16_f32 v170, v88, v89
    v_cvt_pk_bf16_f32 v171, v90, v91
    buffer_store_dwordx4 v[168:171], v21, s[84:87], s93 offen offset:3072 sc1
    s_mov_b32 s48, 0x2000
    buffer_load_dwordx4 v[172:175], v21, s[84:87], s94 offen offset:0 sc1
    buffer_load_dwordx4 v[176:179], v21, s[84:87], s94 offen offset:1024 sc1
    buffer_load_dwordx4 v[180:183], v21, s[84:87], s94 offen offset:2048 sc1
    buffer_load_dwordx4 v[184:187], v21, s[84:87], s94 offen offset:3072 sc1
    s_waitcnt vmcnt(8)
    v_permlane16_swap_b32 v188, v190
    v_permlane16_swap_b32 v189, v191
    v_permlane16_swap_b32 v192, v194
    v_permlane16_swap_b32 v193, v195
    v_permlane16_swap_b32 v196, v198
    v_permlane16_swap_b32 v197, v199
    v_permlane16_swap_b32 v200, v202
    v_permlane16_swap_b32 v201, v203
    v_lshlrev_b32 v22, 16, v22
    v_lshlrev_b32 v23, 16, v23
    v_lshlrev_b32 v204, 16, v188
    v_and_b32 v205, 0xffff0000, v188
    v_lshlrev_b32 v206, 16, v189
    v_and_b32 v207, 0xffff0000, v189
    v_lshlrev_b32 v208, 16, v190
    v_and_b32 v209, 0xffff0000, v190
    v_lshlrev_b32 v210, 16, v191
    v_and_b32 v211, 0xffff0000, v191
    v_add_f32 v204, v204, v22
    v_add_f32 v205, v205, v22
    v_add_f32 v206, v206, v22
    v_add_f32 v207, v207, v22
    v_add_f32 v208, v208, v22
    v_add_f32 v209, v209, v22
    v_add_f32 v210, v210, v22
    v_add_f32 v211, v211, v22
    v_pk_add_f32 v[28:29], v[28:29], v[204:205]
    v_pk_add_f32 v[30:31], v[30:31], v[206:207]
    v_pk_add_f32 v[44:45], v[44:45], v[208:209]
    v_pk_add_f32 v[46:47], v[46:47], v[210:211]
    v_lshlrev_b32 v204, 16, v192
    v_and_b32 v205, 0xffff0000, v192
    v_lshlrev_b32 v206, 16, v193
    v_and_b32 v207, 0xffff0000, v193
    v_lshlrev_b32 v208, 16, v194
    v_and_b32 v209, 0xffff0000, v194
    v_lshlrev_b32 v210, 16, v195
    v_and_b32 v211, 0xffff0000, v195
    v_add_f32 v204, v204, v22
    v_add_f32 v205, v205, v22
    v_add_f32 v206, v206, v22
    v_add_f32 v207, v207, v22
    v_add_f32 v208, v208, v22
    v_add_f32 v209, v209, v22
    v_add_f32 v210, v210, v22
    v_add_f32 v211, v211, v22
    v_pk_add_f32 v[60:61], v[60:61], v[204:205]
    v_pk_add_f32 v[62:63], v[62:63], v[206:207]
    v_pk_add_f32 v[76:77], v[76:77], v[208:209]
    v_pk_add_f32 v[78:79], v[78:79], v[210:211]
    v_lshlrev_b32 v204, 16, v196
    v_and_b32 v205, 0xffff0000, v196
    v_lshlrev_b32 v206, 16, v197
    v_and_b32 v207, 0xffff0000, v197
    v_lshlrev_b32 v208, 16, v198
    v_and_b32 v209, 0xffff0000, v198
    v_lshlrev_b32 v210, 16, v199
    v_and_b32 v211, 0xffff0000, v199
    v_add_f32 v204, v204, v23
    v_add_f32 v205, v205, v23
    v_add_f32 v206, v206, v23
    v_add_f32 v207, v207, v23
    v_add_f32 v208, v208, v23
    v_add_f32 v209, v209, v23
    v_add_f32 v210, v210, v23
    v_add_f32 v211, v211, v23
    v_pk_add_f32 v[32:33], v[32:33], v[204:205]
    v_pk_add_f32 v[34:35], v[34:35], v[206:207]
    v_pk_add_f32 v[48:49], v[48:49], v[208:209]
    v_pk_add_f32 v[50:51], v[50:51], v[210:211]
    v_lshlrev_b32 v204, 16, v200
    v_and_b32 v205, 0xffff0000, v200
    v_lshlrev_b32 v206, 16, v201
    v_and_b32 v207, 0xffff0000, v201
    v_lshlrev_b32 v208, 16, v202
    v_and_b32 v209, 0xffff0000, v202
    v_lshlrev_b32 v210, 16, v203
    v_and_b32 v211, 0xffff0000, v203
    v_add_f32 v204, v204, v23
    v_add_f32 v205, v205, v23
    v_add_f32 v206, v206, v23
    v_add_f32 v207, v207, v23
    v_add_f32 v208, v208, v23
    v_add_f32 v209, v209, v23
    v_add_f32 v210, v210, v23
    v_add_f32 v211, v211, v23
    v_pk_add_f32 v[64:65], v[64:65], v[204:205]
    v_pk_add_f32 v[66:67], v[66:67], v[206:207]
    v_pk_add_f32 v[80:81], v[80:81], v[208:209]
    v_pk_add_f32 v[82:83], v[82:83], v[210:211]
    s_waitcnt vmcnt(0)
g4_rcv:
    v_max3_u32 v4, v172, v173, v174
    v_max3_u32 v4, v4, v175, v176
    v_max3_u32 v4, v4, v177, v178
    v_max3_u32 v4, v4, v179, v180
    v_max3_u32 v4, v4, v181, v182
    v_max3_u32 v4, v4, v183, v184
    v_max3_u32 v4, v4, v185, v186
    v_max_u32 v4, v4, v187
    v_cmp_eq_u32 vcc, -1, v4
    s_sub_u32 s48, s48, 1
    s_cmp_eq_u32 s48, 0
    s_cbranch_scc1 g4_rcvd
    s_cbranch_vccz g4_rcvd
    s_sleep 2
    buffer_load_dwordx4 v[172:175], v21, s[84:87], s94 offen offset:0 sc1
    buffer_load_dwordx4 v[176:179], v21, s[84:87], s94 offen offset:1024 sc1
    buffer_load_dwordx4 v[180:183], v21, s[84:87], s94 offen offset:2048 sc1
    buffer_load_dwordx4 v[184:187], v21, s[84:87], s94 offen offset:3072 sc1
    s_waitcnt vmcnt(0)
    s_branch g4_rcv
g4_rcvd:
    v_lshlrev_b32 v108, 16, v172
    v_and_b32 v109, 0xffff0000, v172
    v_lshlrev_b32 v110, 16, v173
    v_and_b32 v111, 0xffff0000, v173
    v_pk_add_f32 v[28:29], v[28:29], v[108:109]
    v_pk_add_f32 v[30:31], v[30:31], v[110:111]
    v_lshlrev_b32 v112, 16, v174
    v_and_b32 v113, 0xffff0000, v174
    v_lshlrev_b32 v114, 16, v175
    v_and_b32 v115, 0xffff0000, v175
    v_pk_add_f32 v[44:45], v[44:45], v[112:113]
    v_pk_add_f32 v[46:47], v[46:47], v[114:115]
    v_lshlrev_b32 v116, 16, v176
    v_and_b32 v117, 0xffff0000, v176
    v_lshlrev_b32 v118, 16, v177
    v_and_b32 v119, 0xffff0000, v177
    v_pk_add_f32 v[60:61], v[60:61], v[116:117]
    v_pk_add_f32 v[62:63], v[62:63], v[118:119]
    v_lshlrev_b32 v120, 16, v178
    v_and_b32 v121, 0xffff0000, v178
    v_lshlrev_b32 v122, 16, v179
    v_and_b32 v123, 0xffff0000, v179
    v_pk_add_f32 v[76:77], v[76:77], v[120:121]
    v_pk_add_f32 v[78:79], v[78:79], v[122:123]
    v_lshlrev_b32 v108, 16, v180
    v_and_b32 v109, 0xffff0000, v180
    v_lshlrev_b32 v110, 16, v181
    v_and_b32 v111, 0xffff0000, v181
    v_pk_add_f32 v[32:33], v[32:33], v[108:109]
    v_pk_add_f32 v[34:35], v[34:35], v[110:111]
    v_lshlrev_b32 v112, 16, v182
    v_and_b32 v113, 0xffff0000, v182
    v_lshlrev_b32 v114, 16, v183
    v_and_b32 v115, 0xffff0000, v183
    v_pk_add_f32 v[48:49], v[48:49], v[112:113]
    v_pk_add_f32 v[50:51], v[50:51], v[114:115]
    v_lshlrev_b32 v116, 16, v184
    v_and_b32 v117, 0xffff0000, v184
    v_lshlrev_b32 v118, 16, v185
    v_and_b32 v119, 0xffff0000, v185
    v_pk_add_f32 v[64:65], v[64:65], v[116:117]
    v_pk_add_f32 v[66:67], v[66:67], v[118:119]
    v_lshlrev_b32 v120, 16, v186
    v_and_b32 v121, 0xffff0000, v186
    v_lshlrev_b32 v122, 16, v187
    v_and_b32 v123, 0xffff0000, v187
    v_pk_add_f32 v[80:81], v[80:81], v[120:121]
    v_pk_add_f32 v[82:83], v[82:83], v[122:123]
    s_nop 7
    v_cvt_pk_bf16_f32 v92, v28, v29
    v_cvt_pk_bf16_f32 v93, v30, v31
    v_cvt_pk_bf16_f32 v94, v44, v45
    v_cvt_pk_bf16_f32 v95, v46, v47
    s_nop 1
    v_permlane16_swap_b32 v92, v94
    v_permlane16_swap_b32 v93, v95
    buffer_store_dwordx4 v[92:95], v9, s[16:19], s52 offen offset:0 sc1
    v_cvt_pk_bf16_f32 v96, v60, v61
    v_cvt_pk_bf16_f32 v97, v62, v63
    v_cvt_pk_bf16_f32 v98, v76, v77
    v_cvt_pk_bf16_f32 v99, v78, v79
    s_nop 1
    v_permlane16_swap_b32 v96, v98
    v_permlane16_swap_b32 v97, v99
    buffer_store_dwordx4 v[96:99], v9, s[16:19], s52 offen offset:64 sc1
    v_cvt_pk_bf16_f32 v100, v32, v33
    v_cvt_pk_bf16_f32 v101, v34, v35
    v_cvt_pk_bf16_f32 v102, v48, v49
    v_cvt_pk_bf16_f32 v103, v50, v51
    s_nop 1
    v_permlane16_swap_b32 v100, v102
    v_permlane16_swap_b32 v101, v103
    buffer_store_dwordx4 v[100:103], v9, s[16:19], s53 offen offset:0 sc1
    v_cvt_pk_bf16_f32 v104, v64, v65
    v_cvt_pk_bf16_f32 v105, v66, v67
    v_cvt_pk_bf16_f32 v106, v80, v81
    v_cvt_pk_bf16_f32 v107, v82, v83
    s_nop 1
    v_permlane16_swap_b32 v104, v106
    v_permlane16_swap_b32 v105, v107
    buffer_store_dwordx4 v[104:107], v9, s[16:19], s53 offen offset:64 sc1
    v_pk_add_f32 v[108:109], v[28:29], v[30:31]
    v_pk_mul_f32 v[110:111], v[28:29], v[28:29]
    v_pk_fma_f32 v[110:111], v[30:31], v[30:31], v[110:111]
    v_pk_add_f32 v[108:109], v[108:109], v[44:45]
    v_pk_fma_f32 v[110:111], v[44:45], v[44:45], v[110:111]
    v_pk_add_f32 v[108:109], v[108:109], v[46:47]
    v_pk_fma_f32 v[110:111], v[46:47], v[46:47], v[110:111]
    v_pk_add_f32 v[108:109], v[108:109], v[60:61]
    v_pk_fma_f32 v[110:111], v[60:61], v[60:61], v[110:111]
    v_pk_add_f32 v[108:109], v[108:109], v[62:63]
    v_pk_fma_f32 v[110:111], v[62:63], v[62:63], v[110:111]
    v_pk_add_f32 v[108:109], v[108:109], v[76:77]
    v_pk_fma_f32 v[110:111], v[76:77], v[76:77], v[110:111]
    v_pk_add_f32 v[108:109], v[108:109], v[78:79]
    v_pk_fma_f32 v[110:111], v[78:79], v[78:79], v[110:111]
    v_pk_add_f32 v[112:113], v[32:33], v[34:35]
    v_pk_mul_f32 v[114:115], v[32:33], v[32:33]
    v_pk_fma_f32 v[114:115], v[34:35], v[34:35], v[114:115]
    v_pk_add_f32 v[112:113], v[112:113], v[48:49]
    v_pk_fma_f32 v[114:115], v[48:49], v[48:49], v[114:115]
    v_pk_add_f32 v[112:113], v[112:113], v[50:51]
    v_pk_fma_f32 v[114:115], v[50:51], v[50:51], v[114:115]
    v_pk_add_f32 v[112:113], v[112:113], v[64:65]
    v_pk_fma_f32 v[114:115], v[64:65], v[64:65], v[114:115]
    v_pk_add_f32 v[112:113], v[112:113], v[66:67]
    v_pk_fma_f32 v[114:115], v[66:67], v[66:67], v[114:115]
    v_pk_add_f32 v[112:113], v[112:113], v[80:81]
    v_pk_fma_f32 v[114:115], v[80:81], v[80:81], v[114:115]
    v_pk_add_f32 v[112:113], v[112:113], v[82:83]
    v_pk_fma_f32 v[114:115], v[82:83], v[82:83], v[114:115]
    v_add_f32 v108, v108, v109
    v_add_f32 v109, v110, v111
    v_add_f32 v112, v112, v113
    v_add_f32 v113, v114, v115
    s_nop 1
    v_permlane16_swap_b32 v108, v112
    v_permlane16_swap_b32 v109, v113
    v_pk_add_f32 v[108:109], v[108:109], v[112:113]
    v_mov_b32 v116, v108
    v_mov_b32 v117, v109
    v_and_b32 v3, 16, v2
    v_add_u32 v3, v3, v20
    v_permlane32_swap_b32 v108, v116
    v_permlane32_swap_b32 v109, v117
    v_pk_add_f32 v[108:109], v[108:109], v[116:117]
    v_lshlrev_b32 v3, 3, v3
    s_mul_i32 s40, s24, 2
    s_add_u32 s40, s40, s44
    s_lshl_b32 s40, s40, 14
    s_mov_b32 exec_hi, 0
    buffer_store_dwordx2 v[108:109], v3, s[60:63], s40 offen sc1
    s_mov_b32 exec_hi, -1
    s_cmp_lg_u32 s96, 0
    s_cbranch_scc1 g4_done
    s_lshr_b32 s40, s25, 0
    s_add_u32 s40, s40, 40
    s_lshl_b32 s40, s40, 8
    s_mov_b32 s42, s40
    s_add_u32 s84, s4, 0x2b00000
    s_addc_u32 s85, s5, 0
    s_mov_b32 s86, 0x4000
    s_mov_b32 s87, 0x20000
    v_mov_b32 v3, s40
    v_mov_b32 v4, 1
    s_waitcnt vmcnt(0)
    s_barrier
    s_cmp_lg_u32 s28, 0
    s_cbranch_scc1 g4_cin
    s_mov_b64 exec, 1
    buffer_atomic_add v4, v3, s[84:87], 0 offen sc1
    s_mov_b64 exec, -1
g4_cin:
    s_mov_b32 s96, 1
    s_mov_b32 s97, 0x2800000
    s_branch g1_in
.section .rodata,"a"
.p2align 6
.amdhsa_kernel g1a_kernel
  .amdhsa_next_free_vgpr 216
  .amdhsa_next_free_sgpr 100
  .amdhsa_accum_offset 216
  .amdhsa_group_segment_fixed_size 0
  .amdhsa_kernarg_size 88
  .amdhsa_user_sgpr_count 2
  .amdhsa_user_sgpr_kernarg_segment_ptr 1
  .amdhsa_system_sgpr_workgroup_id_x 1
.end_amdhsa_kernel
```

```asm
; @launch kernel=g1a_kernel grid=(256,1,1) block=(512,1,1) lds=131072
.amdgcn_target "amdgcn-amd-amdhsa--gfx950"
.text
.globl g1a_kernel
.p2align 8
.type g1a_kernel,@function
g1a_kernel:
    s_mov_b32 s96, 0
    s_mov_b32 s97, 0x0
    s_branch g1_in
.p2align 6
g1_in:
    s_cmp_ge_u32 s2, 256
    s_cbranch_scc1 g1_done
    s_load_dwordx2 s[4:5], s[0:1], 80
    s_load_dwordx2 s[6:7], s[0:1], 0
    s_xor_b32 s53, s96, 1
    s_load_dwordx2 s[30:31], s[0:1], 8
    s_load_dwordx2 s[16:17], s[0:1], 72
    s_load_dwordx2 s[18:19], s[0:1], 16
    v_lshrrev_b32 v1, 6, v0
    v_and_b32 v2, 63, v0
    s_and_b32 s40, s2, 1
    s_lshl_b32 s40, s40, 3
    s_bfe_u32 s41, s2, 0x30003
    s_add_u32 s25, s40, s41
    s_bfe_u32 s40, s2, 0x20001
    s_lshl_b32 s40, s40, 2
    s_lshr_b32 s42, s2, 6
    s_add_u32 s24, s40, s42
    s_add_u32 s27, s41, s42
    s_add_u32 s52, s24, s25
    s_and_b32 s52, s52, 15
    s_and_b32 s26, s52, 12
    s_mul_i32 s26, s26, s53
    v_readfirstlane_b32 s28, v1
    v_lshrrev_b32 v5, 4, v2
    v_bfe_u32 v6, v2, 2, 2
    v_and_b32 v7, 3, v2
    v_and_b32 v8, 15, v2
    s_cmp_lt_u32 s28, 4
    s_cbranch_scc1 g1_compute
    s_sub_u32 s28, s28, 4
    s_mov_b32 s40, 2048
    v_lshrrev_b32 v3, 3, v2
    v_mul_lo_u32 v3, v3, s40
    v_lshrrev_b32 v4, 4, v2
    v_xor_b32 v4, v4, v2
    v_and_b32 v4, 7, v4
    v_lshl_add_u32 v3, v4, 4, v3
    s_mul_i32 s41, s25, 262144
    s_mul_i32 s42, s28, 65536
    s_add_u32 s41, s41, s42
    v_xor_b32 v4, 64, v3
    s_add_u32 s42, s41, 0
    v_add_u32 v16, s42, v3
    s_add_u32 s42, s41, 16384
    v_add_u32 v17, s42, v4
    s_add_u32 s42, s41, 32768
    v_add_u32 v18, s42, v3
    s_add_u32 s42, s41, 49152
    v_add_u32 v19, s42, v4
    s_mov_b32 s40, 6144
    v_lshrrev_b32 v3, 3, v2
    v_mul_lo_u32 v3, v3, s40
    v_bfe_u32 v4, v2, 4, 1
    v_lshlrev_b32 v4, 1, v4
    v_xor_b32 v4, v4, v2
    v_and_b32 v4, 7, v4
    v_lshl_add_u32 v3, v4, 4, v3
    s_mul_i32 s41, s24, 128
    s_mul_i32 s42, s28, 98304
    s_add_u32 s41, s41, s42
    v_xor_b32 v4, 64, v3
    s_add_u32 s42, s41, 0
    v_add_u32 v10, s42, v3
    s_add_u32 s42, s41, 49152
    v_add_u32 v11, s42, v4
    s_mov_b32 s40, 6144
    v_lshrrev_b32 v3, 3, v2
    v_mul_lo_u32 v3, v3, s40
    v_bfe_u32 v4, v2, 4, 1
    v_lshlrev_b32 v4, 1, v4
    v_xor_b32 v4, v4, v2
    v_and_b32 v4, 7, v4
    v_lshl_add_u32 v3, v4, 4, v3
    s_mul_i32 s41, s24, 128
    s_mul_i32 s42, s28, 98304
    s_add_u32 s41, s41, s42
    v_xor_b32 v4, 64, v3
    s_add_u32 s42, s41, 2048
    v_add_u32 v12, s42, v3
    s_add_u32 s42, s41, 51200
    v_add_u32 v13, s42, v4
    s_mov_b32 s40, 6144
    v_lshrrev_b32 v3, 3, v2
    v_mul_lo_u32 v3, v3, s40
    v_bfe_u32 v4, v2, 4, 1
    v_lshlrev_b32 v4, 1, v4
    v_xor_b32 v4, v4, v2
    v_and_b32 v4, 7, v4
    v_lshl_add_u32 v3, v4, 4, v3
    s_mul_i32 s41, s24, 128
    s_mul_i32 s42, s28, 98304
    s_add_u32 s41, s41, s42
    v_xor_b32 v4, 64, v3
    s_add_u32 s42, s41, 4096
    v_add_u32 v14, s42, v3
    s_add_u32 s42, s41, 53248
    v_add_u32 v15, s42, v4
    v_lshrrev_b32 v3, 3, v2
    s_lshl_b32 s40, s28, 2
    v_add_u32 v3, s40, v3
    v_lshrrev_b32 v4, 1, v3
    v_xor_b32 v4, v4, v2
    v_and_b32 v4, 7, v4
    s_lshl_b32 s40, s25, 7
    s_sub_u32 s40, s40, 16
    v_add_u32 v3, s40, v3
    v_max_i32 v3, 0, v3
    v_lshlrev_b32 v3, 11, v3
    v_lshl_add_u32 v20, v4, 4, v3
    s_mul_i32 s36, s28, 2048
    s_mul_i32 s37, s28, 4096
    s_add_u32 s37, s37, 26624
    s_mul_i32 s46, s28, 512
    s_add_u32 s46, s46, 24576
    s_waitcnt lgkmcnt(0)
    s_mov_b32 s8, s30
    s_mov_b32 s9, s31
    s_mov_b32 s10, 0x600000
    s_mov_b32 s11, 0x20000
    s_add_u32 s56, s4, 0x100000
    s_addc_u32 s57, s5, 0
    s_mov_b32 s58, 0x30000
    s_mov_b32 s59, 0x20000
    s_add_u32 s4, s4, s97
    s_addc_u32 s5, s5, 0
    s_add_u32 s12, s4, 0x1900000
    s_addc_u32 s13, s5, 0
    s_cmp_eq_u32 s96, 1
    s_cselect_b32 s12, s12, s6
    s_cselect_b32 s13, s13, s7
    s_mov_b32 s14, 0x400000
    s_mov_b32 s15, 0x20000
    s_mov_b32 s20, s4
    s_mov_b32 s21, s5
    s_mov_b32 s22, 0x40000
    s_mov_b32 s23, 0x20000
    s_mov_b32 s60, s16
    s_mov_b32 s61, s17
    s_mov_b32 s62, 0x100
    s_mov_b32 s63, 0x20000
    s_sub_u32 s40, s52, s27
    s_and_b32 s40, s40, 1
    s_and_b32 s41, s52, 2
    s_or_b32 s40, s40, s41
    s_add_u32 s54, s40, 2
    s_cmp_eq_u32 s53, 0
    s_cselect_b32 s54, 0x7fff, s54
    s_add_u32 s55, s54, 3
    s_cmp_lg_u32 s28, 0
    s_cselect_b32 s55, 0x7fff, s55
    s_cmp_lt_u32 s55, 0x7fff
    s_cselect_b32 s29, 13, 0x7fff
    s_mov_b32 s32, 0
    s_mov_b32 s33, 0
g1_ld_pW:
    s_add_u32 s40, s32, s27
    s_and_b32 s40, s40, 1
    s_andn2_b32 s41, s32, 1
    s_or_b32 s40, s40, s41
    s_add_u32 s40, s40, s26
    s_and_b32 s40, s40, 15
    s_mul_i32 s34, s40, 393216
    s_mul_i32 s35, s40, 128
    s_add_u32 s38, s33, s36
    s_add_u32 s39, s33, s37
    s_add_u32 m0, s38, 0
    s_nop 0
    buffer_load_dwordx4 v10, s[8:11], s34 offen lds
    s_add_u32 m0, s38, 1024
    s_nop 0
    buffer_load_dwordx4 v11, s[8:11], s34 offen lds
    s_add_u32 m0, s38, 8192
    s_nop 0
    buffer_load_dwordx4 v12, s[8:11], s34 offen lds
    s_add_u32 m0, s38, 9216
    s_nop 0
    buffer_load_dwordx4 v13, s[8:11], s34 offen lds
    s_add_u32 m0, s38, 16384
    s_nop 0
    buffer_load_dwordx4 v14, s[8:11], s34 offen lds
    s_add_u32 m0, s38, 17408
    s_nop 0
    buffer_load_dwordx4 v15, s[8:11], s34 offen lds
    s_add_u32 s33, s33, 43008
    s_add_u32 s32, s32, 1
    s_cmp_lt_u32 s32, 2
    s_cbranch_scc1 g1_ld_pW
    s_cmp_eq_u32 s96, 0
    s_cbranch_scc1 g1_dep_ok
    s_add_u32 s40, s25, 40
    s_lshl_b32 s40, s40, 8
    s_sub_u32 s42, s40, 256
    s_max_u32 s42, s42, 10240
    s_add_u32 s84, s4, 0x300000
    s_addc_u32 s85, s5, 0
    s_mov_b32 s86, 0x4000
    s_mov_b32 s87, 0x20000
    v_cmp_eq_u32 vcc, 1, v2
    v_mov_b32 v21, s40
    v_mov_b32 v23, s42
    v_cndmask_b32 v21, v21, v23, vcc
    v_mov_b32 v22, 16
    v_mov_b32 v23, 16
    v_cndmask_b32 v22, v22, v23, vcc
    s_mov_b32 s41, 0x8000
g1_dep:
    buffer_load_dword v23, v21, s[84:87], 0 offen sc1
    s_sub_u32 s41, s41, 1
    s_waitcnt vmcnt(0)
    v_cmp_lt_u32 vcc, v23, v22
    s_cmp_eq_u32 s41, 0
    s_cbranch_scc1 g1_dep_ok
    s_cbranch_vccz g1_dep_ok
    s_sleep 2
    s_branch g1_dep
g1_dep_ok:
    s_mov_b32 s32, 0
    s_mov_b32 s33, 0
g1_ld_pA:
    s_add_u32 s40, s32, s27
    s_and_b32 s40, s40, 1
    s_andn2_b32 s41, s32, 1
    s_or_b32 s40, s40, s41
    s_add_u32 s40, s40, s26
    s_and_b32 s40, s40, 15
    s_mul_i32 s34, s40, 393216
    s_mul_i32 s35, s40, 128
    s_add_u32 s38, s33, s36
    s_add_u32 s39, s33, s37
    s_add_u32 m0, s39, 0
    s_nop 0
    buffer_load_dwordx4 v16, s[12:15], s35 offen lds
    s_add_u32 m0, s39, 1024
    s_nop 0
    buffer_load_dwordx4 v17, s[12:15], s35 offen lds
    s_add_u32 m0, s39, 2048
    s_nop 0
    buffer_load_dwordx4 v18, s[12:15], s35 offen lds
    s_add_u32 m0, s39, 3072
    s_nop 0
    buffer_load_dwordx4 v19, s[12:15], s35 offen lds
    s_add_u32 m0, s33, s46
    s_mov_b32 exec_hi, 0
    buffer_load_dwordx4 v20, s[12:15], s35 offen lds
    s_mov_b32 exec_hi, -1
    s_add_u32 s33, s33, 43008
    s_add_u32 s32, s32, 1
    s_cmp_lt_u32 s32, 2
    s_cbranch_scc1 g1_ld_pA
    s_waitcnt vmcnt(5)
    s_branch g1_ld_bar
g1_ld_loop:
    s_sub_u32 s40, s32, s54
    s_sub_u32 s40, s40, 1
    s_cmp_lt_u32 s40, 2
    s_cbranch_scc1 g1_ld_w0
    s_sub_u32 s40, s32, s55
    s_sub_u32 s40, s40, 1
    s_cmp_lt_u32 s40, 2
    s_cbranch_scc1 g1_ld_w1
    s_sub_u32 s40, s32, s29
    s_sub_u32 s40, s40, 1
    s_cmp_lt_u32 s40, 2
    s_cbranch_scc1 g1_ld_w2
    s_waitcnt vmcnt(11)
g1_ld_bar:
    s_barrier
    s_add_u32 s40, s32, s27
    s_and_b32 s40, s40, 1
    s_andn2_b32 s41, s32, 1
    s_or_b32 s40, s40, s41
    s_add_u32 s40, s40, s26
    s_and_b32 s40, s40, 15
    s_mul_i32 s34, s40, 393216
    s_mul_i32 s35, s40, 128
    s_add_u32 s38, s33, s36
    s_add_u32 s39, s33, s37
    s_add_u32 m0, s39, 0
    s_nop 0
    buffer_load_dwordx4 v16, s[12:15], s35 offen lds
    s_add_u32 m0, s39, 1024
    s_nop 0
    buffer_load_dwordx4 v17, s[12:15], s35 offen lds
    s_add_u32 m0, s39, 2048
    s_nop 0
    buffer_load_dwordx4 v18, s[12:15], s35 offen lds
    s_add_u32 m0, s39, 3072
    s_nop 0
    buffer_load_dwordx4 v19, s[12:15], s35 offen lds
    s_add_u32 m0, s38, 0
    s_nop 0
    buffer_load_dwordx4 v10, s[8:11], s34 offen lds
    s_add_u32 m0, s38, 1024
    s_nop 0
    buffer_load_dwordx4 v11, s[8:11], s34 offen lds
    s_add_u32 m0, s38, 8192
    s_nop 0
    buffer_load_dwordx4 v12, s[8:11], s34 offen lds
    s_add_u32 m0, s38, 9216
    s_nop 0
    buffer_load_dwordx4 v13, s[8:11], s34 offen lds
    s_add_u32 m0, s38, 16384
    s_nop 0
    buffer_load_dwordx4 v14, s[8:11], s34 offen lds
    s_add_u32 m0, s38, 17408
    s_nop 0
    buffer_load_dwordx4 v15, s[8:11], s34 offen lds
    s_add_u32 m0, s33, s46
    s_mov_b32 exec_hi, 0
    buffer_load_dwordx4 v20, s[12:15], s35 offen lds
    s_mov_b32 exec_hi, -1
    s_cmp_eq_u32 s32, s54
    s_cbranch_scc1 g1_ld_h0
g1_ld_c0:
    s_cmp_eq_u32 s32, s55
    s_cbranch_scc1 g1_ld_h1
g1_ld_c1:
    s_cmp_eq_u32 s32, s29
    s_cbranch_scc1 g1_ld_h2
g1_ld_c2:
    s_add_u32 s33, s33, 43008
    s_add_u32 s32, s32, 1
    s_cmp_eq_u32 s33, 129024
    s_cselect_b32 s33, 0, s33
    s_cmp_lt_u32 s32, 16
    s_cbranch_scc1 g1_ld_loop
    s_cmp_eq_u32 s29, 0x7fff
    s_cbranch_scc1 g1_polled
    s_mov_b32 s41, 0x20000
    v_mov_b32 v21, 0
    s_waitcnt vmcnt(22)
g1_poll:
    v_readfirstlane_b32 s40, v23
    s_sub_u32 s41, s41, 1
    s_cmp_eq_u32 s41, 0
    s_cbranch_scc1 g1_polled
    s_cmp_ge_u32 s40, 256
    s_cbranch_scc1 g1_polled
    s_sleep 8
    buffer_load_dword v23, v21, s[60:63], 0 offen sc1
    s_waitcnt vmcnt(0)
    s_branch g1_poll
g1_polled:
    s_waitcnt vmcnt(11)
    s_barrier
    s_lshl_b32 s40, s28, 6
    v_add_u32 v21, s40, v2
    s_lshl_b32 s41, s25, 7
    s_sub_u32 s41, s41, 16
    v_add_u32 v3, s41, v21
    v_max_i32 v3, 0, v3
    v_min_u32 v3, 2047, v3
    v_lshlrev_b32 v3, 3, v3
    s_min_u32 s40, s28, 2
    s_lshl_b32 s40, s40, 12
    s_lshl_b32 s41, s24, 8
    s_add_u32 s40, s40, s41
    v_lshl_add_u32 v4, v2, 2, s40
    s_mov_b32 s40, 0
    buffer_load_dwordx2 v[24:25], v3, s[20:23], s40 offen sc1
    s_mov_b32 s41, 0
    buffer_load_dword v56, v4, s[56:59], s41 offen sc1
    s_mov_b32 s40, 16384
    buffer_load_dwordx2 v[26:27], v3, s[20:23], s40 offen sc1
    s_mov_b32 s41, 12288
    buffer_load_dword v57, v4, s[56:59], s41 offen sc1
    s_mov_b32 s40, 32768
    buffer_load_dwordx2 v[28:29], v3, s[20:23], s40 offen sc1
    s_mov_b32 s41, 24576
    buffer_load_dword v58, v4, s[56:59], s41 offen sc1
    s_mov_b32 s40, 49152
    buffer_load_dwordx2 v[30:31], v3, s[20:23], s40 offen sc1
    s_mov_b32 s41, 36864
    buffer_load_dword v59, v4, s[56:59], s41 offen sc1
    s_mov_b32 s40, 65536
    buffer_load_dwordx2 v[32:33], v3, s[20:23], s40 offen sc1
    s_mov_b32 s41, 49152
    buffer_load_dword v60, v4, s[56:59], s41 offen sc1
    s_mov_b32 s40, 81920
    buffer_load_dwordx2 v[34:35], v3, s[20:23], s40 offen sc1
    s_mov_b32 s41, 61440
    buffer_load_dword v61, v4, s[56:59], s41 offen sc1
    s_mov_b32 s40, 98304
    buffer_load_dwordx2 v[36:37], v3, s[20:23], s40 offen sc1
    s_mov_b32 s41, 73728
    buffer_load_dword v62, v4, s[56:59], s41 offen sc1
    s_mov_b32 s40, 114688
    buffer_load_dwordx2 v[38:39], v3, s[20:23], s40 offen sc1
    s_mov_b32 s41, 86016
    buffer_load_dword v63, v4, s[56:59], s41 offen sc1
    s_mov_b32 s40, 131072
    buffer_load_dwordx2 v[40:41], v3, s[20:23], s40 offen sc1
    s_mov_b32 s41, 98304
    buffer_load_dword v64, v4, s[56:59], s41 offen sc1
    s_mov_b32 s40, 147456
    buffer_load_dwordx2 v[42:43], v3, s[20:23], s40 offen sc1
    s_mov_b32 s41, 110592
    buffer_load_dword v65, v4, s[56:59], s41 offen sc1
    s_mov_b32 s40, 163840
    buffer_load_dwordx2 v[44:45], v3, s[20:23], s40 offen sc1
    s_mov_b32 s41, 122880
    buffer_load_dword v66, v4, s[56:59], s41 offen sc1
    s_mov_b32 s40, 180224
    buffer_load_dwordx2 v[46:47], v3, s[20:23], s40 offen sc1
    s_mov_b32 s41, 135168
    buffer_load_dword v67, v4, s[56:59], s41 offen sc1
    s_mov_b32 s40, 196608
    buffer_load_dwordx2 v[48:49], v3, s[20:23], s40 offen sc1
    s_mov_b32 s41, 147456
    buffer_load_dword v68, v4, s[56:59], s41 offen sc1
    s_mov_b32 s40, 212992
    buffer_load_dwordx2 v[50:51], v3, s[20:23], s40 offen sc1
    s_mov_b32 s41, 159744
    buffer_load_dword v69, v4, s[56:59], s41 offen sc1
    s_mov_b32 s40, 229376
    buffer_load_dwordx2 v[52:53], v3, s[20:23], s40 offen sc1
    s_mov_b32 s41, 172032
    buffer_load_dword v70, v4, s[56:59], s41 offen sc1
    s_mov_b32 s40, 245760
    buffer_load_dwordx2 v[54:55], v3, s[20:23], s40 offen sc1
    s_mov_b32 s41, 184320
    buffer_load_dword v71, v4, s[56:59], s41 offen sc1
    s_waitcnt vmcnt(32)
    s_barrier
    s_waitcnt vmcnt(0)
    v_pk_add_f32 v[24:25], v[24:25], v[40:41]
    v_add_f32 v56, v56, v64
    v_pk_add_f32 v[26:27], v[26:27], v[42:43]
    v_add_f32 v57, v57, v65
    v_pk_add_f32 v[28:29], v[28:29], v[44:45]
    v_add_f32 v58, v58, v66
    v_pk_add_f32 v[30:31], v[30:31], v[46:47]
    v_add_f32 v59, v59, v67
    v_pk_add_f32 v[32:33], v[32:33], v[48:49]
    v_add_f32 v60, v60, v68
    v_pk_add_f32 v[34:35], v[34:35], v[50:51]
    v_add_f32 v61, v61, v69
    v_pk_add_f32 v[36:37], v[36:37], v[52:53]
    v_add_f32 v62, v62, v70
    v_pk_add_f32 v[38:39], v[38:39], v[54:55]
    v_add_f32 v63, v63, v71
    v_pk_add_f32 v[24:25], v[24:25], v[32:33]
    v_add_f32 v56, v56, v60
    v_pk_add_f32 v[26:27], v[26:27], v[34:35]
    v_add_f32 v57, v57, v61
    v_pk_add_f32 v[28:29], v[28:29], v[36:37]
    v_add_f32 v58, v58, v62
    v_pk_add_f32 v[30:31], v[30:31], v[38:39]
    v_add_f32 v59, v59, v63
    v_pk_add_f32 v[24:25], v[24:25], v[28:29]
    v_add_f32 v56, v56, v58
    v_pk_add_f32 v[26:27], v[26:27], v[30:31]
    v_add_f32 v57, v57, v59
    v_pk_add_f32 v[24:25], v[24:25], v[26:27]
    v_add_f32 v56, v56, v57
    v_mul_f32 v24, 0x3a800000, v24
    v_mul_f32 v25, 0x3a800000, v25
    v_fma_f32 v25, -v24, v24, v25
    v_max_f32 v25, 0, v25
    v_cvt_pk_bf16_f32 v24, v24, v24
    v_lshlrev_b32 v24, 16, v24
    v_cvt_pk_bf16_f32 v25, v25, v25
    v_lshlrev_b32 v25, 16, v25
    v_add_f32 v25, 0x3727c5ac, v25
    v_cvt_pk_bf16_f32 v25, v25, v25
    v_lshlrev_b32 v25, 16, v25
    v_sqrt_f32 v25, v25
    s_nop 0
    v_cvt_pk_bf16_f32 v25, v25, v25
    v_lshlrev_b32 v25, 16, v25
    v_rcp_f32 v26, v25
    v_lshlrev_b32 v3, 3, v21
    v_lshlrev_b32 v4, 2, v21
    v_mul_f32 v27, -v24, v26
    v_cmp_gt_u32 vcc, 144, v21
    s_and_saveexec_b64 s[40:41], vcc
    v_add_u32 v3, 129024, v3
    ds_write_b64 v3, v[26:27]
    s_mov_b64 exec, s[40:41]
    v_cmp_gt_u32 vcc, 192, v21
    s_and_saveexec_b64 s[40:41], vcc
    v_add_u32 v4, 130304, v4
    ds_write_b32 v4, v56
    s_mov_b64 exec, s[40:41]
    s_waitcnt lgkmcnt(0)
    s_barrier
    s_add_u32 s20, s4, 0x200000
    s_addc_u32 s21, s5, 0
    s_mov_b32 s22, 0x40000
    s_mov_b32 s23, 0x20000
    s_lshl_b32 s40, s24, 4
    s_add_u32 s40, s40, s25
    s_lshl_b32 s40, s40, 10
    s_lshl_b32 s41, s28, 8
    s_add_u32 s40, s40, s41
    v_lshlrev_b32 v3, 2, v2
    v_mov_b32 v4, -1
    buffer_store_dword v4, v3, s[20:23], s40 offen sc1
    s_cmp_eq_u32 s53, 0
    s_cbranch_scc1 g1_nopf
    s_mov_b32 s20, s18
    s_mov_b32 s21, s19
    s_mov_b32 s22, 0x200000
    s_mov_b32 s23, 0x20000
    s_lshl_b32 s40, s2, 13
    s_lshl_b32 s41, s28, 11
    s_add_u32 s40, s40, s41
    v_lshlrev_b32 v3, 4, v2
    buffer_load_dwordx4 v[120:123], v3, s[20:23], s40 offen
    buffer_load_dwordx4 v[120:123], v3, s[20:23], s40 offen offset:1024
g1_nopf:
    s_branch g1_ld_end
g1_ld_w0:
    s_waitcnt vmcnt(16)
    s_branch g1_ld_bar
g1_ld_h0:
    s_add_u32 s44, s33, 43008
    s_cmp_eq_u32 s44, 129024
    s_cselect_b32 s44, 0, s44
    s_mul_i32 s42, s28, 3
    s_add_u32 s42, s42, 0
    s_lshr_b32 s43, s42, 2
    s_lshl_b32 s43, s43, 13
    s_add_u32 s43, s43, s44
    s_and_b32 s42, s42, 3
    v_and_b32 v3, 1, v5
    v_lshlrev_b32 v3, 1, v3
    v_lshrrev_b32 v4, 1, v6
    v_or_b32 v3, v3, v4
    s_add_u32 s40, s42, 0
    v_xor_b32 v3, s40, v3
    v_lshlrev_b32 v3, 5, v3
    v_lshl_add_u32 v3, v7, 3, v3
    v_lshl_add_u32 v4, v5, 3, v6
    v_lshl_add_u32 v3, v4, 7, v3
    v_add_u32 v21, s43, v3
    ds_read_b64_tr_b16 v[24:25], v21 offset:0
    ds_read_b64_tr_b16 v[26:27], v21 offset:512
    ds_read_b64_tr_b16 v[28:29], v21 offset:4096
    ds_read_b64_tr_b16 v[30:31], v21 offset:4608
    s_mul_i32 s42, s28, 3
    s_add_u32 s42, s42, 1
    s_lshr_b32 s43, s42, 2
    s_lshl_b32 s43, s43, 13
    s_add_u32 s43, s43, s44
    s_and_b32 s42, s42, 3
    v_and_b32 v3, 1, v5
    v_lshlrev_b32 v3, 1, v3
    v_lshrrev_b32 v4, 1, v6
    v_or_b32 v3, v3, v4
    s_add_u32 s40, s42, 0
    v_xor_b32 v3, s40, v3
    v_lshlrev_b32 v3, 5, v3
    v_lshl_add_u32 v3, v7, 3, v3
    v_lshl_add_u32 v4, v5, 3, v6
    v_lshl_add_u32 v3, v4, 7, v3
    v_add_u32 v21, s43, v3
    ds_read_b64_tr_b16 v[32:33], v21 offset:0
    ds_read_b64_tr_b16 v[34:35], v21 offset:512
    ds_read_b64_tr_b16 v[36:37], v21 offset:4096
    ds_read_b64_tr_b16 v[38:39], v21 offset:4608
    s_mul_i32 s42, s28, 3
    s_add_u32 s42, s42, 2
    s_lshr_b32 s43, s42, 2
    s_lshl_b32 s43, s43, 13
    s_add_u32 s43, s43, s44
    s_and_b32 s42, s42, 3
    v_and_b32 v3, 1, v5
    v_lshlrev_b32 v3, 1, v3
    v_lshrrev_b32 v4, 1, v6
    v_or_b32 v3, v3, v4
    s_add_u32 s40, s42, 0
    v_xor_b32 v3, s40, v3
    v_lshlrev_b32 v3, 5, v3
    v_lshl_add_u32 v3, v7, 3, v3
    v_lshl_add_u32 v4, v5, 3, v6
    v_lshl_add_u32 v3, v4, 7, v3
    v_add_u32 v21, s43, v3
    ds_read_b64_tr_b16 v[40:41], v21 offset:0
    ds_read_b64_tr_b16 v[42:43], v21 offset:512
    ds_read_b64_tr_b16 v[44:45], v21 offset:4096
    ds_read_b64_tr_b16 v[46:47], v21 offset:4608
    s_lshr_b32 s42, s44, 7
    s_lshl_b32 s43, s28, 5
    s_add_u32 s42, s42, s43
    s_add_u32 s42, s42, 16
    v_lshrrev_b32 v3, 1, v8
    v_xor_b32 v3, v3, v5
    v_lshlrev_b32 v3, 4, v3
    v_lshl_add_u32 v3, v8, 7, v3
    s_lshl_b32 s40, s42, 7
    s_add_u32 s40, s40, 24576
    v_add_u32 v22, s40, v3
    v_xor_b32 v23, 64, v22
    ds_read_b128 v[48:51], v22 offset:0
    ds_read_b128 v[52:55], v23 offset:0
    ds_read_b128 v[56:59], v22 offset:2048
    ds_read_b128 v[60:63], v23 offset:2048
    v_mov_b32 v64, 0x3f803f80
    v_mov_b32 v65, 0x3f803f80
    v_mov_b32 v66, 0x3f803f80
    v_mov_b32 v67, 0x3f803f80
    s_mul_i32 s42, s52, 12288
    s_lshl_b32 s43, s24, 8
    s_add_u32 s42, s42, s43
    v_lshl_add_u32 v21, v5, 4, s42
    s_lshl_b32 s42, s52, 14
    s_lshl_b32 s43, s25, 10
    s_add_u32 s42, s42, s43
    s_lshl_b32 s43, s28, 8
    s_add_u32 s42, s42, s43
    v_lshl_add_u32 v22, v8, 3, s42
    s_waitcnt lgkmcnt(0)
    v_mfma_f32_16x16x32_bf16 v[68:71], v[24:27], v[64:67], 0
    v_mfma_f32_16x16x32_bf16 v[72:75], v[32:35], v[64:67], 0
    v_mfma_f32_16x16x32_bf16 v[76:79], v[40:43], v[64:67], 0
    v_mfma_f32_16x16x32_bf16 v[80:83], v[64:67], v[48:51], 0
    v_mfma_f32_16x16x32_bf16 v[84:87], v[48:51], v[48:51], 0
    v_mfma_f32_16x16x32_bf16 v[88:91], v[64:67], v[56:59], 0
    v_mfma_f32_16x16x32_bf16 v[92:95], v[56:59], v[56:59], 0
    v_mfma_f32_16x16x32_bf16 v[68:71], v[28:31], v[64:67], v[68:71]
    v_mfma_f32_16x16x32_bf16 v[72:75], v[36:39], v[64:67], v[72:75]
    v_mfma_f32_16x16x32_bf16 v[76:79], v[44:47], v[64:67], v[76:79]
    v_mfma_f32_16x16x32_bf16 v[80:83], v[64:67], v[52:55], v[80:83]
    v_mfma_f32_16x16x32_bf16 v[84:87], v[52:55], v[52:55], v[84:87]
    v_mfma_f32_16x16x32_bf16 v[88:91], v[64:67], v[60:63], v[88:91]
    v_mfma_f32_16x16x32_bf16 v[92:95], v[60:63], v[60:63], v[92:95]
    v_cmp_eq_u32 s[40:41], 1, v7
    v_cmp_eq_u32 s[42:43], 2, v7
    v_cmp_eq_u32 vcc, 3, v7
    s_nop 7
    v_cndmask_b32 v81, v84, v85, s[40:41]
    v_cndmask_b32 v81, v81, v86, s[42:43]
    v_cndmask_b32 v81, v81, v87, vcc
    v_cndmask_b32 v89, v92, v93, s[40:41]
    v_cndmask_b32 v89, v89, v94, s[42:43]
    v_cndmask_b32 v89, v89, v95, vcc
    s_mov_b32 exec_lo, 0x00f0000f
    s_mov_b32 exec_hi, 0xf0000f00
    buffer_store_dwordx2 v[80:81], v22, s[20:23], 0 offen offset:0 sc1
    buffer_store_dwordx2 v[88:89], v22, s[20:23], 0 offen offset:128 sc1
    s_mov_b32 exec_lo, 0x00010001
    s_mov_b32 exec_hi, 0x00010001
    s_mul_i32 s42, s28, 3
    s_add_u32 s42, s42, 0
    s_lshr_b32 s43, s42, 2
    s_lshl_b32 s43, s43, 12
    s_and_b32 s42, s42, 3
    s_lshl_b32 s42, s42, 6
    s_add_u32 s42, s42, s43
    buffer_store_dwordx4 v[68:71], v21, s[56:59], s42 offen sc1
    s_mul_i32 s42, s28, 3
    s_add_u32 s42, s42, 1
    s_lshr_b32 s43, s42, 2
    s_lshl_b32 s43, s43, 12
    s_and_b32 s42, s42, 3
    s_lshl_b32 s42, s42, 6
    s_add_u32 s42, s42, s43
    buffer_store_dwordx4 v[72:75], v21, s[56:59], s42 offen sc1
    s_mul_i32 s42, s28, 3
    s_add_u32 s42, s42, 2
    s_lshr_b32 s43, s42, 2
    s_lshl_b32 s43, s43, 12
    s_and_b32 s42, s42, 3
    s_lshl_b32 s42, s42, 6
    s_add_u32 s42, s42, s43
    buffer_store_dwordx4 v[76:79], v21, s[56:59], s42 offen sc1
    s_mov_b64 exec, -1
    s_or_b32 s40, s24, s25
    s_or_b32 s40, s40, s28
    s_cmp_lg_u32 s40, 0
    s_cbranch_scc1 g1_nocr
    v_lshlrev_b32 v21, 8, v2
    v_mov_b32 v22, 0
    s_add_u32 s84, s4, 0x300000
    s_addc_u32 s85, s5, 0
    s_mov_b32 s86, 0x4000
    s_mov_b32 s87, 0x20000
    buffer_store_dword v22, v21, s[84:87], 0 offen sc1
    s_add_u32 s84, s4, 0x2b00000
    s_addc_u32 s85, s5, 0
    s_mov_b32 s86, 0x4000
    s_mov_b32 s87, 0x20000
    buffer_store_dword v22, v21, s[84:87], 0 offen sc1
g1_nocr:
    s_branch g1_ld_c0
g1_ld_w1:
    s_waitcnt vmcnt(12)
    s_branch g1_ld_bar
g1_ld_h1:
    v_mov_b32 v21, 0
    v_mov_b32 v22, 1
    s_mov_b64 exec, 1
    buffer_atomic_add v22, v21, s[60:63], 0 offen sc1
    s_mov_b64 exec, -1
    s_branch g1_ld_c1
g1_ld_w2:
    s_waitcnt vmcnt(12)
    s_branch g1_ld_bar
g1_ld_h2:
    v_mov_b32 v21, 0
    buffer_load_dword v23, v21, s[60:63], 0 offen sc1
    s_branch g1_ld_c2
g1_ld_end:
    s_add_u32 s28, s28, 4
    s_branch g1_attn
g1_compute:
    s_and_b32 s44, s28, 1
    s_lshr_b32 s45, s28, 1
    s_lshl_b32 s42, s44, 1
    s_mov_b32 s43, 0
    v_and_b32 v3, 1, v5
    v_lshlrev_b32 v3, 1, v3
    v_lshrrev_b32 v4, 1, v6
    v_or_b32 v3, v3, v4
    s_add_u32 s40, s42, 0
    v_xor_b32 v3, s40, v3
    v_lshlrev_b32 v3, 5, v3
    v_lshl_add_u32 v3, v7, 3, v3
    v_lshl_add_u32 v4, v5, 3, v6
    v_lshl_add_u32 v3, v4, 7, v3
    v_add_u32 v10, s43, v3
    v_and_b32 v3, 1, v5
    v_lshlrev_b32 v3, 1, v3
    v_lshrrev_b32 v4, 1, v6
    v_or_b32 v3, v3, v4
    s_add_u32 s40, s42, 1
    v_xor_b32 v3, s40, v3
    v_lshlrev_b32 v3, 5, v3
    v_lshl_add_u32 v3, v7, 3, v3
    v_lshl_add_u32 v4, v5, 3, v6
    v_lshl_add_u32 v3, v4, 7, v3
    v_add_u32 v11, s43, v3
    s_xor_b32 s43, s45, 1
    s_add_u32 s43, s43, 1
    s_mul_i32 s43, s43, 8192
    v_and_b32 v3, 1, v5
    v_lshlrev_b32 v3, 1, v3
    v_lshrrev_b32 v4, 1, v6
    v_or_b32 v3, v3, v4
    s_add_u32 s40, s42, 0
    v_xor_b32 v3, s40, v3
    v_lshlrev_b32 v3, 5, v3
    v_lshl_add_u32 v3, v7, 3, v3
    v_lshl_add_u32 v4, v5, 3, v6
    v_lshl_add_u32 v3, v4, 7, v3
    v_add_u32 v12, s43, v3
    v_and_b32 v3, 1, v5
    v_lshlrev_b32 v3, 1, v3
    v_lshrrev_b32 v4, 1, v6
    v_or_b32 v3, v3, v4
    s_add_u32 s40, s42, 1
    v_xor_b32 v3, s40, v3
    v_lshlrev_b32 v3, 5, v3
    v_lshl_add_u32 v3, v7, 3, v3
    v_lshl_add_u32 v4, v5, 3, v6
    v_lshl_add_u32 v3, v4, 7, v3
    v_add_u32 v13, s43, v3
    s_xor_b32 s43, s45, 0
    s_add_u32 s43, s43, 1
    s_mul_i32 s43, s43, 8192
    v_and_b32 v3, 1, v5
    v_lshlrev_b32 v3, 1, v3
    v_lshrrev_b32 v4, 1, v6
    v_or_b32 v3, v3, v4
    s_add_u32 s40, s42, 0
    v_xor_b32 v3, s40, v3
    v_lshlrev_b32 v3, 5, v3
    v_lshl_add_u32 v3, v7, 3, v3
    v_lshl_add_u32 v4, v5, 3, v6
    v_lshl_add_u32 v3, v4, 7, v3
    v_add_u32 v14, s43, v3
    v_and_b32 v3, 1, v5
    v_lshlrev_b32 v3, 1, v3
    v_lshrrev_b32 v4, 1, v6
    v_or_b32 v3, v3, v4
    s_add_u32 s40, s42, 1
    v_xor_b32 v3, s40, v3
    v_lshlrev_b32 v3, 5, v3
    v_lshl_add_u32 v3, v7, 3, v3
    v_lshl_add_u32 v4, v5, 3, v6
    v_lshl_add_u32 v3, v4, 7, v3
    v_add_u32 v15, s43, v3
    s_mul_i32 s42, s45, 64
    s_add_u32 s42, s42, 16
    v_lshrrev_b32 v3, 1, v8
    v_xor_b32 v3, v3, v5
    v_lshlrev_b32 v3, 4, v3
    v_lshl_add_u32 v3, v8, 7, v3
    s_lshl_b32 s40, s42, 7
    s_add_u32 s40, s40, 24576
    v_add_u32 v16, s40, v3
    v_xor_b32 v17, 64, v16
    v_lshrrev_b32 v3, 1, v8
    v_xor_b32 v3, v3, v5
    v_lshlrev_b32 v3, 4, v3
    v_lshl_add_u32 v3, v8, 7, v3
    v_add_u32 v18, 24576, v3
    v_xor_b32 v19, 64, v18
    v_mov_b32 v24, 0
    v_mov_b32 v25, 0
    v_mov_b32 v26, 0
    v_mov_b32 v27, 0
    v_mov_b32 v28, 0
    v_mov_b32 v29, 0
    v_mov_b32 v30, 0
    v_mov_b32 v31, 0
    v_mov_b32 v32, 0
    v_mov_b32 v33, 0
    v_mov_b32 v34, 0
    v_mov_b32 v35, 0
    v_mov_b32 v36, 0
    v_mov_b32 v37, 0
    v_mov_b32 v38, 0
    v_mov_b32 v39, 0
    v_mov_b32 v40, 0
    v_mov_b32 v41, 0
    v_mov_b32 v42, 0
    v_mov_b32 v43, 0
    v_mov_b32 v44, 0
    v_mov_b32 v45, 0
    v_mov_b32 v46, 0
    v_mov_b32 v47, 0
    v_mov_b32 v48, 0
    v_mov_b32 v49, 0
    v_mov_b32 v50, 0
    v_mov_b32 v51, 0
    v_mov_b32 v52, 0
    v_mov_b32 v53, 0
    v_mov_b32 v54, 0
    v_mov_b32 v55, 0
    v_mov_b32 v56, 0
    v_mov_b32 v57, 0
    v_mov_b32 v58, 0
    v_mov_b32 v59, 0
    v_mov_b32 v60, 0
    v_mov_b32 v61, 0
    v_mov_b32 v62, 0
    v_mov_b32 v63, 0
    v_mov_b32 v64, 0
    v_mov_b32 v65, 0
    v_mov_b32 v66, 0
    v_mov_b32 v67, 0
    v_mov_b32 v68, 0
    v_mov_b32 v69, 0
    v_mov_b32 v70, 0
    v_mov_b32 v71, 0
    v_mov_b32 v72, 0
    v_mov_b32 v73, 0
    v_mov_b32 v74, 0
    v_mov_b32 v75, 0
    v_mov_b32 v76, 0
    v_mov_b32 v77, 0
    v_mov_b32 v78, 0
    v_mov_b32 v79, 0
    v_mov_b32 v80, 0
    v_mov_b32 v81, 0
    v_mov_b32 v82, 0
    v_mov_b32 v83, 0
    v_mov_b32 v84, 0
    v_mov_b32 v85, 0
    v_mov_b32 v86, 0
    v_mov_b32 v87, 0
    v_mov_b32 v88, 0
    v_mov_b32 v89, 0
    v_mov_b32 v90, 0
    v_mov_b32 v91, 0
    v_mov_b32 v92, 0
    v_mov_b32 v93, 0
    v_mov_b32 v94, 0
    v_mov_b32 v95, 0
    v_mov_b32 v96, 0
    v_mov_b32 v97, 0
    v_mov_b32 v98, 0
    v_mov_b32 v99, 0
    v_mov_b32 v100, 0
    v_mov_b32 v101, 0
    v_mov_b32 v102, 0
    v_mov_b32 v103, 0
    v_mov_b32 v104, 0
    v_mov_b32 v105, 0
    v_mov_b32 v106, 0
    v_mov_b32 v107, 0
    v_mov_b32 v108, 0
    v_mov_b32 v109, 0
    v_mov_b32 v110, 0
    v_mov_b32 v111, 0
    v_mov_b32 v112, 0
    v_mov_b32 v113, 0
    v_mov_b32 v114, 0
    v_mov_b32 v115, 0
    v_mov_b32 v116, 0
    v_mov_b32 v117, 0
    v_mov_b32 v118, 0
    v_mov_b32 v119, 0
    v_mov_b32 v120, 0
    v_mov_b32 v121, 0
    v_mov_b32 v122, 0
    v_mov_b32 v123, 0
    v_mov_b32 v124, 0
    v_mov_b32 v125, 0
    v_mov_b32 v126, 0
    v_mov_b32 v127, 0
    v_mov_b32 v172, 0
    v_mov_b32 v173, 0
    v_mov_b32 v174, 0
    v_mov_b32 v175, 0
    v_mov_b32 v176, 0
    v_mov_b32 v177, 0
    v_mov_b32 v178, 0
    v_mov_b32 v179, 0
    v_mov_b32 v180, 0
    v_mov_b32 v181, 0
    v_mov_b32 v182, 0
    v_mov_b32 v183, 0
    v_mov_b32 v184, 0
    v_mov_b32 v185, 0
    v_mov_b32 v186, 0
    v_mov_b32 v187, 0
    v_mov_b32 v188, 0
    v_mov_b32 v189, 0
    v_mov_b32 v190, 0
    v_mov_b32 v191, 0
    v_mov_b32 v192, 0
    v_mov_b32 v193, 0
    v_mov_b32 v194, 0
    v_mov_b32 v195, 0
    v_mov_b32 v196, 0
    v_mov_b32 v197, 0
    v_mov_b32 v198, 0
    v_mov_b32 v199, 0
    v_mov_b32 v200, 0
    v_mov_b32 v201, 0
    v_mov_b32 v202, 0
    v_mov_b32 v203, 0
    v_mov_b32 v204, 0
    v_mov_b32 v205, 0
    v_mov_b32 v206, 0
    v_mov_b32 v207, 0
    v_mov_b32 v208, 0
    v_mov_b32 v209, 0
    v_mov_b32 v210, 0
    v_mov_b32 v211, 0
    v_mov_b32 v212, 0
    v_mov_b32 v213, 0
    v_mov_b32 v214, 0
    v_mov_b32 v215, 0
    s_mov_b32 s48, 16
    s_mov_b32 s50, 0
    s_mov_b32 s51, 43008
    s_mov_b32 s29, 0xfffeb000
    s_waitcnt lgkmcnt(0)
    s_add_u32 s4, s4, s97
    s_addc_u32 s5, s5, 0
.p2align 3
g1_cloop:
    s_barrier
g1_cloop2:
    v_mfma_f32_16x16x32_bf16 v[24:27], v[172:175], v[196:199], v[24:27]
    ds_read_b64_tr_b16 v[128:129], v10 offset:0
    ds_read_b64_tr_b16 v[130:131], v10 offset:512
    v_mfma_f32_16x16x32_bf16 v[28:31], v[172:175], v[200:203], v[28:31]
    ds_read_b128 v[152:155], v16 offset:0
    v_mfma_f32_16x16x32_bf16 v[32:35], v[172:175], v[204:207], v[32:35]
    ds_read_b128 v[156:159], v16 offset:2048
    v_mfma_f32_16x16x32_bf16 v[36:39], v[172:175], v[208:211], v[36:39]
    ds_read_b128 v[160:163], v16 offset:4096
    v_mfma_f32_16x16x32_bf16 v[40:43], v[176:179], v[196:199], v[40:43]
    ds_read_b128 v[164:167], v16 offset:6144
    v_mfma_f32_16x16x32_bf16 v[44:47], v[176:179], v[200:203], v[44:47]
    ds_read_b64_tr_b16 v[132:133], v11 offset:0
    ds_read_b64_tr_b16 v[134:135], v11 offset:512
    v_mfma_f32_16x16x32_bf16 v[48:51], v[176:179], v[204:207], v[48:51]
    ds_read_b64_tr_b16 v[136:137], v12 offset:0
    ds_read_b64_tr_b16 v[138:139], v12 offset:512
    v_mfma_f32_16x16x32_bf16 v[52:55], v[176:179], v[208:211], v[52:55]
    ds_read_b64_tr_b16 v[140:141], v13 offset:0
    ds_read_b64_tr_b16 v[142:143], v13 offset:512
    v_mfma_f32_16x16x32_bf16 v[56:59], v[180:183], v[196:199], v[56:59]
    ds_read_b64_tr_b16 v[144:145], v14 offset:0
    ds_read_b64_tr_b16 v[146:147], v14 offset:512
    v_mfma_f32_16x16x32_bf16 v[60:63], v[180:183], v[200:203], v[60:63]
    ds_read_b64_tr_b16 v[148:149], v15 offset:0
    ds_read_b64_tr_b16 v[150:151], v15 offset:512
    v_mfma_f32_16x16x32_bf16 v[64:67], v[180:183], v[204:207], v[64:67]
    ds_read_b128 v[168:171], v18 offset:0
    v_mfma_f32_16x16x32_bf16 v[68:71], v[180:183], v[208:211], v[68:71]
    v_mfma_f32_16x16x32_bf16 v[72:75], v[184:187], v[196:199], v[72:75]
    v_mfma_f32_16x16x32_bf16 v[76:79], v[184:187], v[200:203], v[76:79]
    v_mfma_f32_16x16x32_bf16 v[80:83], v[184:187], v[204:207], v[80:83]
    v_mfma_f32_16x16x32_bf16 v[84:87], v[184:187], v[208:211], v[84:87]
    v_mfma_f32_16x16x32_bf16 v[88:91], v[188:191], v[196:199], v[88:91]
    v_mfma_f32_16x16x32_bf16 v[92:95], v[188:191], v[200:203], v[92:95]
    v_mfma_f32_16x16x32_bf16 v[96:99], v[188:191], v[204:207], v[96:99]
    v_mfma_f32_16x16x32_bf16 v[100:103], v[188:191], v[208:211], v[100:103]
    v_mfma_f32_16x16x32_bf16 v[104:107], v[192:195], v[196:199], v[104:107]
    v_mfma_f32_16x16x32_bf16 v[108:111], v[192:195], v[200:203], v[108:111]
    v_mfma_f32_16x16x32_bf16 v[112:115], v[192:195], v[204:207], v[112:115]
    v_mfma_f32_16x16x32_bf16 v[116:119], v[192:195], v[208:211], v[116:119]
    v_mfma_f32_16x16x32_bf16 v[120:123], v[188:191], v[212:215], v[120:123]
    v_mfma_f32_16x16x32_bf16 v[124:127], v[192:195], v[212:215], v[124:127]
    s_waitcnt lgkmcnt(0)
    v_mfma_f32_16x16x32_bf16 v[24:27], v[128:131], v[152:155], v[24:27]
    ds_read_b64_tr_b16 v[172:173], v10 offset:4096
    ds_read_b64_tr_b16 v[174:175], v10 offset:4608
    v_mfma_f32_16x16x32_bf16 v[28:31], v[128:131], v[156:159], v[28:31]
    ds_read_b128 v[196:199], v17 offset:0
    v_mfma_f32_16x16x32_bf16 v[32:35], v[128:131], v[160:163], v[32:35]
    ds_read_b128 v[200:203], v17 offset:2048
    v_mfma_f32_16x16x32_bf16 v[36:39], v[128:131], v[164:167], v[36:39]
    ds_read_b128 v[204:207], v17 offset:4096
    v_mfma_f32_16x16x32_bf16 v[40:43], v[132:135], v[152:155], v[40:43]
    ds_read_b128 v[208:211], v17 offset:6144
    v_mfma_f32_16x16x32_bf16 v[44:47], v[132:135], v[156:159], v[44:47]
    ds_read_b64_tr_b16 v[176:177], v11 offset:4096
    ds_read_b64_tr_b16 v[178:179], v11 offset:4608
    v_mfma_f32_16x16x32_bf16 v[48:51], v[132:135], v[160:163], v[48:51]
    ds_read_b64_tr_b16 v[180:181], v12 offset:4096
    ds_read_b64_tr_b16 v[182:183], v12 offset:4608
    v_mfma_f32_16x16x32_bf16 v[52:55], v[132:135], v[164:167], v[52:55]
    ds_read_b64_tr_b16 v[184:185], v13 offset:4096
    ds_read_b64_tr_b16 v[186:187], v13 offset:4608
    v_mfma_f32_16x16x32_bf16 v[56:59], v[136:139], v[152:155], v[56:59]
    ds_read_b64_tr_b16 v[188:189], v14 offset:4096
    ds_read_b64_tr_b16 v[190:191], v14 offset:4608
    v_mfma_f32_16x16x32_bf16 v[60:63], v[136:139], v[156:159], v[60:63]
    ds_read_b64_tr_b16 v[192:193], v15 offset:4096
    ds_read_b64_tr_b16 v[194:195], v15 offset:4608
    v_mfma_f32_16x16x32_bf16 v[64:67], v[136:139], v[160:163], v[64:67]
    ds_read_b128 v[212:215], v19 offset:0
    v_mfma_f32_16x16x32_bf16 v[68:71], v[136:139], v[164:167], v[68:71]
    s_add_u32 s50, s50, 1
    s_cmp_eq_u32 s50, 3
    v_mfma_f32_16x16x32_bf16 v[72:75], v[140:143], v[152:155], v[72:75]
    s_cselect_b32 s49, s29, s51
    s_cselect_b32 s50, 0, s50
    v_mfma_f32_16x16x32_bf16 v[76:79], v[140:143], v[156:159], v[76:79]
    v_add_u32 v10, s49, v10
    v_add_u32 v11, s49, v11
    v_mfma_f32_16x16x32_bf16 v[80:83], v[140:143], v[160:163], v[80:83]
    v_add_u32 v12, s49, v12
    v_add_u32 v13, s49, v13
    v_mfma_f32_16x16x32_bf16 v[84:87], v[140:143], v[164:167], v[84:87]
    v_add_u32 v14, s49, v14
    v_add_u32 v15, s49, v15
    v_mfma_f32_16x16x32_bf16 v[88:91], v[144:147], v[152:155], v[88:91]
    v_add_u32 v16, s49, v16
    v_add_u32 v17, s49, v17
    v_mfma_f32_16x16x32_bf16 v[92:95], v[144:147], v[156:159], v[92:95]
    v_add_u32 v18, s49, v18
    v_add_u32 v19, s49, v19
    v_mfma_f32_16x16x32_bf16 v[96:99], v[144:147], v[160:163], v[96:99]
    s_sub_u32 s48, s48, 1
    s_cmp_lg_u32 s48, 0
    v_mfma_f32_16x16x32_bf16 v[100:103], v[144:147], v[164:167], v[100:103]
    v_mfma_f32_16x16x32_bf16 v[104:107], v[148:151], v[152:155], v[104:107]
    v_mfma_f32_16x16x32_bf16 v[108:111], v[148:151], v[156:159], v[108:111]
    v_mfma_f32_16x16x32_bf16 v[112:115], v[148:151], v[160:163], v[112:115]
    v_mfma_f32_16x16x32_bf16 v[116:119], v[148:151], v[164:167], v[116:119]
    v_mfma_f32_16x16x32_bf16 v[120:123], v[144:147], v[168:171], v[120:123]
    v_mfma_f32_16x16x32_bf16 v[124:127], v[148:151], v[168:171], v[124:127]
    s_waitcnt lgkmcnt(0)
    s_cbranch_scc1 g1_cloop
    v_mfma_f32_16x16x32_bf16 v[24:27], v[172:175], v[196:199], v[24:27]
    v_mfma_f32_16x16x32_bf16 v[28:31], v[172:175], v[200:203], v[28:31]
    v_mfma_f32_16x16x32_bf16 v[32:35], v[172:175], v[204:207], v[32:35]
    v_mfma_f32_16x16x32_bf16 v[36:39], v[172:175], v[208:211], v[36:39]
    v_mfma_f32_16x16x32_bf16 v[40:43], v[176:179], v[196:199], v[40:43]
    v_mfma_f32_16x16x32_bf16 v[44:47], v[176:179], v[200:203], v[44:47]
    v_mfma_f32_16x16x32_bf16 v[48:51], v[176:179], v[204:207], v[48:51]
    v_mfma_f32_16x16x32_bf16 v[52:55], v[176:179], v[208:211], v[52:55]
    v_mfma_f32_16x16x32_bf16 v[56:59], v[180:183], v[196:199], v[56:59]
    v_mfma_f32_16x16x32_bf16 v[60:63], v[180:183], v[200:203], v[60:63]
    v_mfma_f32_16x16x32_bf16 v[64:67], v[180:183], v[204:207], v[64:67]
    v_mfma_f32_16x16x32_bf16 v[68:71], v[180:183], v[208:211], v[68:71]
    v_mfma_f32_16x16x32_bf16 v[72:75], v[184:187], v[196:199], v[72:75]
    v_mfma_f32_16x16x32_bf16 v[76:79], v[184:187], v[200:203], v[76:79]
    v_mfma_f32_16x16x32_bf16 v[80:83], v[184:187], v[204:207], v[80:83]
    v_mfma_f32_16x16x32_bf16 v[84:87], v[184:187], v[208:211], v[84:87]
    v_mfma_f32_16x16x32_bf16 v[88:91], v[188:191], v[196:199], v[88:91]
    v_mfma_f32_16x16x32_bf16 v[92:95], v[188:191], v[200:203], v[92:95]
    v_mfma_f32_16x16x32_bf16 v[96:99], v[188:191], v[204:207], v[96:99]
    v_mfma_f32_16x16x32_bf16 v[100:103], v[188:191], v[208:211], v[100:103]
    v_mfma_f32_16x16x32_bf16 v[104:107], v[192:195], v[196:199], v[104:107]
    v_mfma_f32_16x16x32_bf16 v[108:111], v[192:195], v[200:203], v[108:111]
    v_mfma_f32_16x16x32_bf16 v[112:115], v[192:195], v[204:207], v[112:115]
    v_mfma_f32_16x16x32_bf16 v[116:119], v[192:195], v[208:211], v[116:119]
    v_mfma_f32_16x16x32_bf16 v[120:123], v[188:191], v[212:215], v[120:123]
    v_mfma_f32_16x16x32_bf16 v[124:127], v[192:195], v[212:215], v[124:127]
    s_barrier
    v_lshlrev_b32 v3, 3, v8
    v_add_u32 v4, 129024, v3
    s_mul_i32 s40, s45, 512
    s_add_u32 s40, s40, 129152
    v_add_u32 v3, s40, v3
    ds_read_b64 v[128:129], v3 offset:0
    ds_read_b64 v[130:131], v3 offset:128
    ds_read_b64 v[132:133], v3 offset:256
    ds_read_b64 v[134:135], v3 offset:384
    ds_read_b64 v[136:137], v4
    s_lshl_b32 s40, s44, 7
    s_add_u32 s40, s40, 130304
    v_lshl_add_u32 v3, v5, 4, s40
    s_mov_b32 s43, 0
    v_add_u32 v4, s43, v3
    ds_read_b128 v[140:143], v4 offset:0
    ds_read_b128 v[144:147], v4 offset:64
    s_xor_b32 s43, s45, 1
    s_add_u32 s43, s43, 1
    s_mul_i32 s43, s43, 256
    v_add_u32 v4, s43, v3
    ds_read_b128 v[148:151], v4 offset:0
    ds_read_b128 v[152:155], v4 offset:64
    s_xor_b32 s43, s45, 0
    s_add_u32 s43, s43, 1
    s_mul_i32 s43, s43, 256
    v_add_u32 v4, s43, v3
    ds_read_b128 v[156:159], v4 offset:0
    ds_read_b128 v[160:163], v4 offset:64
    v_and_b32 v3, 1, v5
    v_lshlrev_b32 v3, 1, v3
    v_lshrrev_b32 v4, 1, v5
    v_add_u32 v3, v3, v4
    s_lshl_b32 s40, s44, 2
    v_add_u32 v3, s40, v3
    v_lshrrev_b32 v4, 1, v8
    v_xor_b32 v3, v3, v4
    v_lshlrev_b32 v3, 4, v3
    v_lshl_add_u32 v3, v8, 7, v3
    s_mul_i32 s42, s45, 8192
    s_add_u32 s42, s42, 45056
    s_mov_b32 s43, 0
    s_add_u32 s40, s42, s43
    v_add_u32 v10, s40, v3
    s_xor_b32 s43, s45, 1
    s_add_u32 s43, s43, 1
    s_mul_i32 s43, s43, 18432
    s_add_u32 s40, s42, s43
    v_add_u32 v11, s40, v3
    s_xor_b32 s43, s45, 0
    s_add_u32 s43, s43, 1
    s_mul_i32 s43, s43, 18432
    s_add_u32 s40, s42, s43
    v_add_u32 v12, s40, v3
    s_add_u32 s40, s43, 43008
    v_add_u32 v13, s40, v3
    s_waitcnt lgkmcnt(0)
    v_pk_mul_f32 v[164:165], v[140:141], v[128:129] op_sel:[0,1] op_sel_hi:[1,1]
    v_pk_mul_f32 v[166:167], v[142:143], v[128:129] op_sel:[0,1] op_sel_hi:[1,1]
    v_pk_mul_f32 v[168:169], v[144:145], v[128:129] op_sel:[0,1] op_sel_hi:[1,1]
    v_pk_mul_f32 v[170:171], v[146:147], v[128:129] op_sel:[0,1] op_sel_hi:[1,1]
    v_pk_fma_f32 v[24:25], v[24:25], v[128:129], v[164:165] op_sel:[0,0,0] op_sel_hi:[1,0,1]
    v_pk_fma_f32 v[26:27], v[26:27], v[128:129], v[166:167] op_sel:[0,0,0] op_sel_hi:[1,0,1]
    v_pk_fma_f32 v[40:41], v[40:41], v[128:129], v[168:169] op_sel:[0,0,0] op_sel_hi:[1,0,1]
    v_pk_fma_f32 v[42:43], v[42:43], v[128:129], v[170:171] op_sel:[0,0,0] op_sel_hi:[1,0,1]
    v_cvt_pk_bf16_f32 v172, v24, v25
    v_cvt_pk_bf16_f32 v173, v26, v27
    v_cvt_pk_bf16_f32 v174, v40, v41
    v_cvt_pk_bf16_f32 v175, v42, v43
    s_nop 1
    v_permlane16_swap_b32 v172, v174
    v_permlane16_swap_b32 v173, v175
    ds_write_b128 v10, v[172:175] offset:0
    v_pk_mul_f32 v[164:165], v[140:141], v[130:131] op_sel:[0,1] op_sel_hi:[1,1]
    v_pk_mul_f32 v[166:167], v[142:143], v[130:131] op_sel:[0,1] op_sel_hi:[1,1]
    v_pk_mul_f32 v[168:169], v[144:145], v[130:131] op_sel:[0,1] op_sel_hi:[1,1]
    v_pk_mul_f32 v[170:171], v[146:147], v[130:131] op_sel:[0,1] op_sel_hi:[1,1]
    v_pk_fma_f32 v[28:29], v[28:29], v[130:131], v[164:165] op_sel:[0,0,0] op_sel_hi:[1,0,1]
    v_pk_fma_f32 v[30:31], v[30:31], v[130:131], v[166:167] op_sel:[0,0,0] op_sel_hi:[1,0,1]
    v_pk_fma_f32 v[44:45], v[44:45], v[130:131], v[168:169] op_sel:[0,0,0] op_sel_hi:[1,0,1]
    v_pk_fma_f32 v[46:47], v[46:47], v[130:131], v[170:171] op_sel:[0,0,0] op_sel_hi:[1,0,1]
    v_cvt_pk_bf16_f32 v176, v28, v29
    v_cvt_pk_bf16_f32 v177, v30, v31
    v_cvt_pk_bf16_f32 v178, v44, v45
    v_cvt_pk_bf16_f32 v179, v46, v47
    s_nop 1
    v_permlane16_swap_b32 v176, v178
    v_permlane16_swap_b32 v177, v179
    ds_write_b128 v10, v[176:179] offset:2048
    v_pk_mul_f32 v[164:165], v[140:141], v[132:133] op_sel:[0,1] op_sel_hi:[1,1]
    v_pk_mul_f32 v[166:167], v[142:143], v[132:133] op_sel:[0,1] op_sel_hi:[1,1]
    v_pk_mul_f32 v[168:169], v[144:145], v[132:133] op_sel:[0,1] op_sel_hi:[1,1]
    v_pk_mul_f32 v[170:171], v[146:147], v[132:133] op_sel:[0,1] op_sel_hi:[1,1]
    v_pk_fma_f32 v[32:33], v[32:33], v[132:133], v[164:165] op_sel:[0,0,0] op_sel_hi:[1,0,1]
    v_pk_fma_f32 v[34:35], v[34:35], v[132:133], v[166:167] op_sel:[0,0,0] op_sel_hi:[1,0,1]
    v_pk_fma_f32 v[48:49], v[48:49], v[132:133], v[168:169] op_sel:[0,0,0] op_sel_hi:[1,0,1]
    v_pk_fma_f32 v[50:51], v[50:51], v[132:133], v[170:171] op_sel:[0,0,0] op_sel_hi:[1,0,1]
    v_cvt_pk_bf16_f32 v180, v32, v33
    v_cvt_pk_bf16_f32 v181, v34, v35
    v_cvt_pk_bf16_f32 v182, v48, v49
    v_cvt_pk_bf16_f32 v183, v50, v51
    s_nop 1
    v_permlane16_swap_b32 v180, v182
    v_permlane16_swap_b32 v181, v183
    ds_write_b128 v10, v[180:183] offset:4096
    v_pk_mul_f32 v[164:165], v[140:141], v[134:135] op_sel:[0,1] op_sel_hi:[1,1]
    v_pk_mul_f32 v[166:167], v[142:143], v[134:135] op_sel:[0,1] op_sel_hi:[1,1]
    v_pk_mul_f32 v[168:169], v[144:145], v[134:135] op_sel:[0,1] op_sel_hi:[1,1]
    v_pk_mul_f32 v[170:171], v[146:147], v[134:135] op_sel:[0,1] op_sel_hi:[1,1]
    v_pk_fma_f32 v[36:37], v[36:37], v[134:135], v[164:165] op_sel:[0,0,0] op_sel_hi:[1,0,1]
    v_pk_fma_f32 v[38:39], v[38:39], v[134:135], v[166:167] op_sel:[0,0,0] op_sel_hi:[1,0,1]
    v_pk_fma_f32 v[52:53], v[52:53], v[134:135], v[168:169] op_sel:[0,0,0] op_sel_hi:[1,0,1]
    v_pk_fma_f32 v[54:55], v[54:55], v[134:135], v[170:171] op_sel:[0,0,0] op_sel_hi:[1,0,1]
    v_cvt_pk_bf16_f32 v184, v36, v37
    v_cvt_pk_bf16_f32 v185, v38, v39
    v_cvt_pk_bf16_f32 v186, v52, v53
    v_cvt_pk_bf16_f32 v187, v54, v55
    s_nop 1
    v_permlane16_swap_b32 v184, v186
    v_permlane16_swap_b32 v185, v187
    ds_write_b128 v10, v[184:187] offset:6144
    v_pk_mul_f32 v[164:165], v[148:149], v[128:129] op_sel:[0,1] op_sel_hi:[1,1]
    v_pk_mul_f32 v[166:167], v[150:151], v[128:129] op_sel:[0,1] op_sel_hi:[1,1]
    v_pk_mul_f32 v[168:169], v[152:153], v[128:129] op_sel:[0,1] op_sel_hi:[1,1]
    v_pk_mul_f32 v[170:171], v[154:155], v[128:129] op_sel:[0,1] op_sel_hi:[1,1]
    v_pk_fma_f32 v[56:57], v[56:57], v[128:129], v[164:165] op_sel:[0,0,0] op_sel_hi:[1,0,1]
    v_pk_fma_f32 v[58:59], v[58:59], v[128:129], v[166:167] op_sel:[0,0,0] op_sel_hi:[1,0,1]
    v_pk_fma_f32 v[72:73], v[72:73], v[128:129], v[168:169] op_sel:[0,0,0] op_sel_hi:[1,0,1]
    v_pk_fma_f32 v[74:75], v[74:75], v[128:129], v[170:171] op_sel:[0,0,0] op_sel_hi:[1,0,1]
    v_cvt_pk_bf16_f32 v172, v56, v57
    v_cvt_pk_bf16_f32 v173, v58, v59
    v_cvt_pk_bf16_f32 v174, v72, v73
    v_cvt_pk_bf16_f32 v175, v74, v75
    s_nop 1
    v_permlane16_swap_b32 v172, v174
    v_permlane16_swap_b32 v173, v175
    ds_write_b128 v11, v[172:175] offset:0
    v_pk_mul_f32 v[164:165], v[148:149], v[130:131] op_sel:[0,1] op_sel_hi:[1,1]
    v_pk_mul_f32 v[166:167], v[150:151], v[130:131] op_sel:[0,1] op_sel_hi:[1,1]
    v_pk_mul_f32 v[168:169], v[152:153], v[130:131] op_sel:[0,1] op_sel_hi:[1,1]
    v_pk_mul_f32 v[170:171], v[154:155], v[130:131] op_sel:[0,1] op_sel_hi:[1,1]
    v_pk_fma_f32 v[60:61], v[60:61], v[130:131], v[164:165] op_sel:[0,0,0] op_sel_hi:[1,0,1]
    v_pk_fma_f32 v[62:63], v[62:63], v[130:131], v[166:167] op_sel:[0,0,0] op_sel_hi:[1,0,1]
    v_pk_fma_f32 v[76:77], v[76:77], v[130:131], v[168:169] op_sel:[0,0,0] op_sel_hi:[1,0,1]
    v_pk_fma_f32 v[78:79], v[78:79], v[130:131], v[170:171] op_sel:[0,0,0] op_sel_hi:[1,0,1]
    v_cvt_pk_bf16_f32 v176, v60, v61
    v_cvt_pk_bf16_f32 v177, v62, v63
    v_cvt_pk_bf16_f32 v178, v76, v77
    v_cvt_pk_bf16_f32 v179, v78, v79
    s_nop 1
    v_permlane16_swap_b32 v176, v178
    v_permlane16_swap_b32 v177, v179
    ds_write_b128 v11, v[176:179] offset:2048
    v_pk_mul_f32 v[164:165], v[148:149], v[132:133] op_sel:[0,1] op_sel_hi:[1,1]
    v_pk_mul_f32 v[166:167], v[150:151], v[132:133] op_sel:[0,1] op_sel_hi:[1,1]
    v_pk_mul_f32 v[168:169], v[152:153], v[132:133] op_sel:[0,1] op_sel_hi:[1,1]
    v_pk_mul_f32 v[170:171], v[154:155], v[132:133] op_sel:[0,1] op_sel_hi:[1,1]
    v_pk_fma_f32 v[64:65], v[64:65], v[132:133], v[164:165] op_sel:[0,0,0] op_sel_hi:[1,0,1]
    v_pk_fma_f32 v[66:67], v[66:67], v[132:133], v[166:167] op_sel:[0,0,0] op_sel_hi:[1,0,1]
    v_pk_fma_f32 v[80:81], v[80:81], v[132:133], v[168:169] op_sel:[0,0,0] op_sel_hi:[1,0,1]
    v_pk_fma_f32 v[82:83], v[82:83], v[132:133], v[170:171] op_sel:[0,0,0] op_sel_hi:[1,0,1]
    v_cvt_pk_bf16_f32 v180, v64, v65
    v_cvt_pk_bf16_f32 v181, v66, v67
    v_cvt_pk_bf16_f32 v182, v80, v81
    v_cvt_pk_bf16_f32 v183, v82, v83
    s_nop 1
    v_permlane16_swap_b32 v180, v182
    v_permlane16_swap_b32 v181, v183
    ds_write_b128 v11, v[180:183] offset:4096
    v_pk_mul_f32 v[164:165], v[148:149], v[134:135] op_sel:[0,1] op_sel_hi:[1,1]
    v_pk_mul_f32 v[166:167], v[150:151], v[134:135] op_sel:[0,1] op_sel_hi:[1,1]
    v_pk_mul_f32 v[168:169], v[152:153], v[134:135] op_sel:[0,1] op_sel_hi:[1,1]
    v_pk_mul_f32 v[170:171], v[154:155], v[134:135] op_sel:[0,1] op_sel_hi:[1,1]
    v_pk_fma_f32 v[68:69], v[68:69], v[134:135], v[164:165] op_sel:[0,0,0] op_sel_hi:[1,0,1]
    v_pk_fma_f32 v[70:71], v[70:71], v[134:135], v[166:167] op_sel:[0,0,0] op_sel_hi:[1,0,1]
    v_pk_fma_f32 v[84:85], v[84:85], v[134:135], v[168:169] op_sel:[0,0,0] op_sel_hi:[1,0,1]
    v_pk_fma_f32 v[86:87], v[86:87], v[134:135], v[170:171] op_sel:[0,0,0] op_sel_hi:[1,0,1]
    v_cvt_pk_bf16_f32 v184, v68, v69
    v_cvt_pk_bf16_f32 v185, v70, v71
    v_cvt_pk_bf16_f32 v186, v84, v85
    v_cvt_pk_bf16_f32 v187, v86, v87
    s_nop 1
    v_permlane16_swap_b32 v184, v186
    v_permlane16_swap_b32 v185, v187
    ds_write_b128 v11, v[184:187] offset:6144
    v_pk_mul_f32 v[164:165], v[156:157], v[128:129] op_sel:[0,1] op_sel_hi:[1,1]
    v_pk_mul_f32 v[166:167], v[158:159], v[128:129] op_sel:[0,1] op_sel_hi:[1,1]
    v_pk_mul_f32 v[168:169], v[160:161], v[128:129] op_sel:[0,1] op_sel_hi:[1,1]
    v_pk_mul_f32 v[170:171], v[162:163], v[128:129] op_sel:[0,1] op_sel_hi:[1,1]
    v_pk_fma_f32 v[88:89], v[88:89], v[128:129], v[164:165] op_sel:[0,0,0] op_sel_hi:[1,0,1]
    v_pk_fma_f32 v[90:91], v[90:91], v[128:129], v[166:167] op_sel:[0,0,0] op_sel_hi:[1,0,1]
    v_pk_fma_f32 v[104:105], v[104:105], v[128:129], v[168:169] op_sel:[0,0,0] op_sel_hi:[1,0,1]
    v_pk_fma_f32 v[106:107], v[106:107], v[128:129], v[170:171] op_sel:[0,0,0] op_sel_hi:[1,0,1]
    v_cvt_pk_bf16_f32 v172, v88, v89
    v_cvt_pk_bf16_f32 v173, v90, v91
    v_cvt_pk_bf16_f32 v174, v104, v105
    v_cvt_pk_bf16_f32 v175, v106, v107
    s_nop 1
    v_permlane16_swap_b32 v172, v174
    v_permlane16_swap_b32 v173, v175
    ds_write_b128 v12, v[172:175] offset:0
    v_pk_mul_f32 v[164:165], v[156:157], v[130:131] op_sel:[0,1] op_sel_hi:[1,1]
    v_pk_mul_f32 v[166:167], v[158:159], v[130:131] op_sel:[0,1] op_sel_hi:[1,1]
    v_pk_mul_f32 v[168:169], v[160:161], v[130:131] op_sel:[0,1] op_sel_hi:[1,1]
    v_pk_mul_f32 v[170:171], v[162:163], v[130:131] op_sel:[0,1] op_sel_hi:[1,1]
    v_pk_fma_f32 v[92:93], v[92:93], v[130:131], v[164:165] op_sel:[0,0,0] op_sel_hi:[1,0,1]
    v_pk_fma_f32 v[94:95], v[94:95], v[130:131], v[166:167] op_sel:[0,0,0] op_sel_hi:[1,0,1]
    v_pk_fma_f32 v[108:109], v[108:109], v[130:131], v[168:169] op_sel:[0,0,0] op_sel_hi:[1,0,1]
    v_pk_fma_f32 v[110:111], v[110:111], v[130:131], v[170:171] op_sel:[0,0,0] op_sel_hi:[1,0,1]
    v_cvt_pk_bf16_f32 v176, v92, v93
    v_cvt_pk_bf16_f32 v177, v94, v95
    v_cvt_pk_bf16_f32 v178, v108, v109
    v_cvt_pk_bf16_f32 v179, v110, v111
    s_nop 1
    v_permlane16_swap_b32 v176, v178
    v_permlane16_swap_b32 v177, v179
    ds_write_b128 v12, v[176:179] offset:2048
    v_pk_mul_f32 v[164:165], v[156:157], v[132:133] op_sel:[0,1] op_sel_hi:[1,1]
    v_pk_mul_f32 v[166:167], v[158:159], v[132:133] op_sel:[0,1] op_sel_hi:[1,1]
    v_pk_mul_f32 v[168:169], v[160:161], v[132:133] op_sel:[0,1] op_sel_hi:[1,1]
    v_pk_mul_f32 v[170:171], v[162:163], v[132:133] op_sel:[0,1] op_sel_hi:[1,1]
    v_pk_fma_f32 v[96:97], v[96:97], v[132:133], v[164:165] op_sel:[0,0,0] op_sel_hi:[1,0,1]
    v_pk_fma_f32 v[98:99], v[98:99], v[132:133], v[166:167] op_sel:[0,0,0] op_sel_hi:[1,0,1]
    v_pk_fma_f32 v[112:113], v[112:113], v[132:133], v[168:169] op_sel:[0,0,0] op_sel_hi:[1,0,1]
    v_pk_fma_f32 v[114:115], v[114:115], v[132:133], v[170:171] op_sel:[0,0,0] op_sel_hi:[1,0,1]
    v_cvt_pk_bf16_f32 v180, v96, v97
    v_cvt_pk_bf16_f32 v181, v98, v99
    v_cvt_pk_bf16_f32 v182, v112, v113
    v_cvt_pk_bf16_f32 v183, v114, v115
    s_nop 1
    v_permlane16_swap_b32 v180, v182
    v_permlane16_swap_b32 v181, v183
    ds_write_b128 v12, v[180:183] offset:4096
    v_pk_mul_f32 v[164:165], v[156:157], v[134:135] op_sel:[0,1] op_sel_hi:[1,1]
    v_pk_mul_f32 v[166:167], v[158:159], v[134:135] op_sel:[0,1] op_sel_hi:[1,1]
    v_pk_mul_f32 v[168:169], v[160:161], v[134:135] op_sel:[0,1] op_sel_hi:[1,1]
    v_pk_mul_f32 v[170:171], v[162:163], v[134:135] op_sel:[0,1] op_sel_hi:[1,1]
    v_pk_fma_f32 v[100:101], v[100:101], v[134:135], v[164:165] op_sel:[0,0,0] op_sel_hi:[1,0,1]
    v_pk_fma_f32 v[102:103], v[102:103], v[134:135], v[166:167] op_sel:[0,0,0] op_sel_hi:[1,0,1]
    v_pk_fma_f32 v[116:117], v[116:117], v[134:135], v[168:169] op_sel:[0,0,0] op_sel_hi:[1,0,1]
    v_pk_fma_f32 v[118:119], v[118:119], v[134:135], v[170:171] op_sel:[0,0,0] op_sel_hi:[1,0,1]
    v_cvt_pk_bf16_f32 v184, v100, v101
    v_cvt_pk_bf16_f32 v185, v102, v103
    v_cvt_pk_bf16_f32 v186, v116, v117
    v_cvt_pk_bf16_f32 v187, v118, v119
    s_nop 1
    v_permlane16_swap_b32 v184, v186
    v_permlane16_swap_b32 v185, v187
    ds_write_b128 v12, v[184:187] offset:6144
    v_pk_mul_f32 v[164:165], v[156:157], v[136:137] op_sel:[0,1] op_sel_hi:[1,1]
    v_pk_mul_f32 v[166:167], v[158:159], v[136:137] op_sel:[0,1] op_sel_hi:[1,1]
    v_pk_mul_f32 v[168:169], v[160:161], v[136:137] op_sel:[0,1] op_sel_hi:[1,1]
    v_pk_mul_f32 v[170:171], v[162:163], v[136:137] op_sel:[0,1] op_sel_hi:[1,1]
    v_pk_fma_f32 v[120:121], v[120:121], v[136:137], v[164:165] op_sel:[0,0,0] op_sel_hi:[1,0,1]
    v_pk_fma_f32 v[122:123], v[122:123], v[136:137], v[166:167] op_sel:[0,0,0] op_sel_hi:[1,0,1]
    v_pk_fma_f32 v[124:125], v[124:125], v[136:137], v[168:169] op_sel:[0,0,0] op_sel_hi:[1,0,1]
    v_pk_fma_f32 v[126:127], v[126:127], v[136:137], v[170:171] op_sel:[0,0,0] op_sel_hi:[1,0,1]
    v_cvt_pk_bf16_f32 v172, v120, v121
    v_cvt_pk_bf16_f32 v173, v122, v123
    v_cvt_pk_bf16_f32 v174, v124, v125
    v_cvt_pk_bf16_f32 v175, v126, v127
    s_nop 1
    v_permlane16_swap_b32 v172, v174
    v_permlane16_swap_b32 v173, v175
    ds_write_b128 v13, v[172:175]
    s_waitcnt lgkmcnt(0)
g1_attn:
    s_add_u32 s16, s4, 0x400000
    s_addc_u32 s17, s5, 0
    s_mov_b32 s18, 0x400000
    s_mov_b32 s19, 0x20000
    s_and_b32 s44, s28, 1
    s_lshr_b32 s45, s28, 1
    s_lshl_b32 s40, s44, 2
    v_add_u32 v3, s40, v5
    v_and_b32 v4, 7, v8
    v_xor_b32 v3, v3, v4
    v_lshlrev_b32 v3, 4, v3
    v_lshl_add_u32 v3, v8, 8, v3
    s_mul_i32 s41, s45, 4096
    s_add_u32 s41, s41, 43008
    v_add_u32 v10, s41, v3
    v_lshl_add_u32 v3, v5, 2, v6
    v_and_b32 v4, 7, v3
    v_add_u32 v12, s40, v7
    v_xor_b32 v4, v4, v12
    v_lshlrev_b32 v4, 4, v4
    v_lshl_add_u32 v3, v3, 8, v4
    s_add_u32 s41, s41, 36864
    v_add_u32 v11, s41, v3
    v_and_b32 v3, 7, v8
    v_add_u32 v4, 1, v3
    s_or_b32 s40, s25, s45
    s_cmp_eq_u32 s40, 0
    s_cselect_b32 s40, 8, 0
    v_cmp_gt_u32 vcc, 8, v8
    v_mov_b32 v16, s40
    s_mov_b64 s[56:57], vcc
    v_cndmask_b32 v16, 0, v16, vcc
    v_max_u32 v4, v4, v16
    v_add_u32 v3, 8, v3
    v_sub_u32 v3, v3, v4
    v_lshlrev_b32 v16, 2, v5
    v_sub_u32 v16, v16, v4
    v_mov_b32 v17, 0xf149f2ca
    v_add_u32 v18, 0, v16
    v_cmp_ge_u32 vcc, v3, v18
    s_nop 1
    v_cndmask_b32 v12, v17, 0, vcc
    v_add_u32 v18, 1, v16
    v_cmp_ge_u32 vcc, v3, v18
    s_nop 1
    v_cndmask_b32 v13, v17, 0, vcc
    v_add_u32 v18, 2, v16
    v_cmp_ge_u32 vcc, v3, v18
    s_nop 1
    v_cndmask_b32 v14, v17, 0, vcc
    v_add_u32 v18, 3, v16
    v_cmp_ge_u32 vcc, v3, v18
    s_nop 1
    v_cndmask_b32 v15, v17, 0, vcc
    s_lshl_b32 s40, s25, 7
    s_lshl_b32 s41, s45, 5
    s_add_u32 s40, s40, s41
    s_lshl_b32 s40, s40, 11
    s_lshl_b32 s41, s24, 7
    s_add_u32 s40, s40, s41
    s_lshl_b32 s41, s44, 6
    s_add_u32 s40, s40, s41
    v_lshlrev_b32 v9, 12, v8
    v_lshl_add_u32 v9, v5, 4, v9
    v_add_u32 v9, s40, v9
    s_mov_b32 s58, 0x3e3504f3
    s_mov_b32 s59, 0x3fb8aa3b
    s_barrier
    ds_read_b128 v[24:27], v10 offset:2048
    ds_read_b128 v[28:31], v10 offset:18432
    ds_read_b128 v[32:35], v10 offset:20480
    ds_read_b128 v[72:75], v10 offset:2176
    ds_read_b128 v[76:79], v10 offset:18560
    ds_read_b128 v[80:83], v10 offset:20608
    ds_read_b64_tr_b16 v[36:37], v11 offset:0
    ds_read_b64_tr_b16 v[38:39], v11 offset:2048
    ds_read_b64_tr_b16 v[40:41], v11 offset:8
    ds_read_b64_tr_b16 v[42:43], v11 offset:2056
    ds_read_b64_tr_b16 v[84:85], v11 offset:128
    ds_read_b64_tr_b16 v[86:87], v11 offset:2176
    ds_read_b64_tr_b16 v[88:89], v11 offset:136
    ds_read_b64_tr_b16 v[90:91], v11 offset:2184
    s_waitcnt lgkmcnt(8)
    v_mfma_f32_16x16x32_bf16 v[44:47], v[28:31], v[24:27], 0
    v_mfma_f32_16x16x32_bf16 v[48:51], v[32:35], v[24:27], 0
    v_mfma_f32_16x16x32_bf16 v[92:95], v[76:79], v[72:75], 0
    v_mfma_f32_16x16x32_bf16 v[96:99], v[80:83], v[72:75], 0
    s_nop 7
    v_cndmask_b32 v44, v48, v44, s[56:57]
    v_cndmask_b32 v45, v49, v45, s[56:57]
    v_cndmask_b32 v46, v50, v46, s[56:57]
    v_cndmask_b32 v47, v51, v47, s[56:57]
    v_cndmask_b32 v92, v96, v92, s[56:57]
    v_cndmask_b32 v93, v97, v93, s[56:57]
    v_cndmask_b32 v94, v98, v94, s[56:57]
    v_cndmask_b32 v95, v99, v95, s[56:57]
    v_cvt_pk_bf16_f32 v48, v44, v45
    v_cvt_pk_bf16_f32 v49, v46, v47
    v_cvt_pk_bf16_f32 v96, v92, v93
    v_cvt_pk_bf16_f32 v97, v94, v95
    v_lshlrev_b32 v44, 16, v48
    v_and_b32 v45, 0xffff0000, v48
    v_lshlrev_b32 v46, 16, v49
    v_and_b32 v47, 0xffff0000, v49
    v_lshlrev_b32 v92, 16, v96
    v_and_b32 v93, 0xffff0000, v96
    v_lshlrev_b32 v94, 16, v97
    v_and_b32 v95, 0xffff0000, v97
    v_mul_f32 v44, s58, v44
    v_mul_f32 v45, s58, v45
    v_mul_f32 v46, s58, v46
    v_mul_f32 v47, s58, v47
    v_mul_f32 v92, s58, v92
    v_mul_f32 v93, s58, v93
    v_mul_f32 v94, s58, v94
    v_mul_f32 v95, s58, v95
    v_cvt_pk_bf16_f32 v48, v44, v45
    v_cvt_pk_bf16_f32 v49, v46, v47
    v_cvt_pk_bf16_f32 v96, v92, v93
    v_cvt_pk_bf16_f32 v97, v94, v95
    v_lshlrev_b32 v44, 16, v48
    v_and_b32 v45, 0xffff0000, v48
    v_lshlrev_b32 v46, 16, v49
    v_and_b32 v47, 0xffff0000, v49
    v_lshlrev_b32 v92, 16, v96
    v_and_b32 v93, 0xffff0000, v96
    v_lshlrev_b32 v94, 16, v97
    v_and_b32 v95, 0xffff0000, v97
    v_fma_f32 v44, v44, s59, v12
    v_fma_f32 v45, v45, s59, v13
    v_fma_f32 v46, v46, s59, v14
    v_fma_f32 v47, v47, s59, v15
    v_fma_f32 v92, v92, s59, v12
    v_fma_f32 v93, v93, s59, v13
    v_fma_f32 v94, v94, s59, v14
    v_fma_f32 v95, v95, s59, v15
    v_max3_f32 v48, v44, v45, v46
    v_max3_f32 v96, v92, v93, v94
    v_max_f32 v48, v48, v47
    v_max_f32 v96, v96, v95
    v_mov_b32 v49, v48
    v_mov_b32 v97, v96
    s_nop 1
    v_permlane16_swap_b32 v48, v49
    v_permlane16_swap_b32 v96, v97
    s_nop 0
    v_max_f32 v48, v48, v49
    v_max_f32 v96, v96, v97
    v_mov_b32 v49, v48
    v_mov_b32 v97, v96
    s_nop 1
    v_permlane32_swap_b32 v48, v49
    v_permlane32_swap_b32 v96, v97
    s_nop 0
    v_max_f32 v48, v48, v49
    v_max_f32 v96, v96, v97
    v_sub_f32 v44, v44, v48
    v_sub_f32 v45, v45, v48
    v_sub_f32 v46, v46, v48
    v_sub_f32 v47, v47, v48
    v_sub_f32 v92, v92, v96
    v_sub_f32 v93, v93, v96
    v_sub_f32 v94, v94, v96
    v_sub_f32 v95, v95, v96
    v_exp_f32 v44, v44
    v_exp_f32 v45, v45
    v_exp_f32 v46, v46
    v_exp_f32 v47, v47
    v_exp_f32 v92, v92
    v_exp_f32 v93, v93
    v_exp_f32 v94, v94
    v_exp_f32 v95, v95
    v_add_f32 v48, v44, v45
    v_add_f32 v49, v46, v47
    v_add_f32 v96, v92, v93
    v_add_f32 v97, v94, v95
    v_add_f32 v48, v48, v49
    v_add_f32 v96, v96, v97
    v_mov_b32 v49, v48
    v_mov_b32 v97, v96
    s_nop 1
    v_permlane16_swap_b32 v48, v49
    v_permlane16_swap_b32 v96, v97
    s_nop 0
    v_add_f32 v48, v48, v49
    v_add_f32 v96, v96, v97
    v_mov_b32 v49, v48
    v_mov_b32 v97, v96
    s_nop 1
    v_permlane32_swap_b32 v48, v49
    v_permlane32_swap_b32 v96, v97
    s_nop 0
    v_add_f32 v48, v48, v49
    v_add_f32 v96, v96, v97
    v_rcp_f32 v48, v48
    v_rcp_f32 v96, v96
    s_nop 0
    v_mul_f32 v44, v44, v48
    v_mul_f32 v45, v45, v48
    v_mul_f32 v46, v46, v48
    v_mul_f32 v47, v47, v48
    v_mul_f32 v92, v92, v96
    v_mul_f32 v93, v93, v96
    v_mul_f32 v94, v94, v96
    v_mul_f32 v95, v95, v96
    v_cvt_pk_bf16_f32 v48, v44, v45
    v_cvt_pk_bf16_f32 v49, v46, v47
    v_cvt_pk_bf16_f32 v96, v92, v93
    v_cvt_pk_bf16_f32 v97, v94, v95
    v_cndmask_b32 v52, 0, v48, s[56:57]
    v_cndmask_b32 v53, 0, v49, s[56:57]
    v_cndmask_b32 v54, v48, 0, s[56:57]
    v_cndmask_b32 v55, v49, 0, s[56:57]
    v_cndmask_b32 v100, 0, v96, s[56:57]
    v_cndmask_b32 v101, 0, v97, s[56:57]
    v_cndmask_b32 v102, v96, 0, s[56:57]
    v_cndmask_b32 v103, v97, 0, s[56:57]
    s_waitcnt lgkmcnt(0)
    s_nop 0
    v_mfma_f32_16x16x32_bf16 v[56:59], v[36:39], v[52:55], 0
    v_mfma_f32_16x16x32_bf16 v[60:63], v[40:43], v[52:55], 0
    v_mfma_f32_16x16x32_bf16 v[104:107], v[84:87], v[100:103], 0
    v_mfma_f32_16x16x32_bf16 v[108:111], v[88:91], v[100:103], 0
    s_nop 7
    v_cvt_pk_bf16_f32 v64, v56, v57
    v_cvt_pk_bf16_f32 v65, v58, v59
    v_cvt_pk_bf16_f32 v66, v60, v61
    v_cvt_pk_bf16_f32 v67, v62, v63
    buffer_store_dwordx4 v[64:67], v9, s[16:19], 0 offen offset:0 sc1
    v_cvt_pk_bf16_f32 v112, v104, v105
    v_cvt_pk_bf16_f32 v113, v106, v107
    v_cvt_pk_bf16_f32 v114, v108, v109
    v_cvt_pk_bf16_f32 v115, v110, v111
    buffer_store_dwordx4 v[112:115], v9, s[16:19], 0 offen offset:2048 sc1
    s_add_u32 s40, s25, 0
    s_lshl_b32 s40, s40, 8
    s_add_u32 s84, s4, 0x300000
    s_addc_u32 s85, s5, 0
    s_mov_b32 s86, 0x4000
    s_mov_b32 s87, 0x20000
    v_mov_b32 v3, s40
    v_mov_b32 v4, 1
    s_waitcnt vmcnt(0)
    s_barrier
    s_cmp_lg_u32 s28, 0
    s_cbranch_scc1 g1_cin
    s_mov_b64 exec, 1
    buffer_atomic_add v4, v3, s[84:87], 0 offen sc1
    s_mov_b64 exec, -1
g1_cin:
    s_branch g2_in
g1_done:
    s_endpgm
.p2align 6
g2_in:
    s_cmp_ge_u32 s2, 256
    s_cbranch_scc1 g2_done
    s_load_dwordx2 s[4:5], s[0:1], 80
    s_load_dwordx2 s[6:7], s[0:1], 0
    s_load_dwordx2 s[30:31], s[0:1], 16
    v_lshrrev_b32 v1, 6, v0
    v_and_b32 v2, 63, v0
    s_and_b32 s40, s2, 3
    s_lshl_b32 s40, s40, 2
    s_bfe_u32 s41, s2, 0x20003
    s_add_u32 s25, s40, s41
    s_bfe_u32 s40, s2, 0x10002
    s_lshl_b32 s40, s40, 3
    s_lshr_b32 s42, s2, 5
    s_add_u32 s24, s40, s42
    s_add_u32 s27, s41, s42
    s_mov_b32 s26, 0
    v_readfirstlane_b32 s28, v1
    s_nop 0
    s_cmp_lt_u32 s28, 4
    s_cbranch_scc1 g2_compute
    s_sub_u32 s28, s28, 4
    s_mov_b32 s40, 2048
    v_lshrrev_b32 v3, 3, v2
    v_mul_lo_u32 v3, v3, s40
    v_bfe_u32 v4, v2, 4, 1
    v_lshlrev_b32 v4, 1, v4
    v_xor_b32 v4, v4, v2
    v_and_b32 v4, 7, v4
    v_lshl_add_u32 v3, v4, 4, v3
    s_mul_i32 s41, s24, 128
    s_mul_i32 s42, s28, 32768
    s_add_u32 s41, s41, s42
    v_xor_b32 v4, 64, v3
    s_add_u32 s42, s41, 0
    v_add_u32 v10, s42, v3
    s_add_u32 s42, s41, 16384
    v_add_u32 v11, s42, v4
    s_mov_b32 s40, 2048
    v_lshrrev_b32 v3, 3, v2
    v_mul_lo_u32 v3, v3, s40
    v_lshrrev_b32 v4, 4, v2
    v_xor_b32 v4, v4, v2
    v_and_b32 v4, 7, v4
    v_lshl_add_u32 v3, v4, 4, v3
    s_mul_i32 s41, s25, 262144
    s_mul_i32 s42, s28, 65536
    s_add_u32 s41, s41, s42
    v_xor_b32 v4, 64, v3
    s_add_u32 s42, s41, 0
    v_add_u32 v12, s42, v3
    s_add_u32 s42, s41, 16384
    v_add_u32 v13, s42, v4
    s_add_u32 s42, s41, 32768
    v_add_u32 v14, s42, v3
    s_add_u32 s42, s41, 49152
    v_add_u32 v15, s42, v4
    s_mul_i32 s36, s28, 2048
    s_mul_i32 s37, s28, 4096
    s_add_u32 s37, s37, 8192
    s_waitcnt lgkmcnt(0)
    s_add_u32 s4, s4, s97
    s_addc_u32 s5, s5, 0
    s_mov_b32 s8, s30
    s_mov_b32 s9, s31
    s_mov_b32 s10, 0x200000
    s_mov_b32 s11, 0x20000
    s_add_u32 s12, s4, 0x400000
    s_addc_u32 s13, s5, 0
    s_mov_b32 s14, 0x400000
    s_mov_b32 s15, 0x20000
    s_mov_b32 s32, 0
    s_mov_b32 s33, 0
g2_ld_pW:
    s_add_u32 s40, s32, s27
    s_and_b32 s40, s40, 1
    s_andn2_b32 s41, s32, 1
    s_or_b32 s40, s40, s41
    s_add_u32 s40, s40, s26
    s_mul_i32 s34, s40, 131072
    s_mul_i32 s35, s40, 128
    s_add_u32 s38, s33, s36
    s_add_u32 s39, s33, s37
    s_add_u32 m0, s38, 0
    s_nop 0
    buffer_load_dwordx4 v10, s[8:11], s34 offen lds
    s_add_u32 m0, s38, 1024
    s_nop 0
    buffer_load_dwordx4 v11, s[8:11], s34 offen lds
    s_add_u32 s33, s33, 24576
    s_add_u32 s32, s32, 1
    s_cmp_lt_u32 s32, 3
    s_cbranch_scc1 g2_ld_pW
    s_lshr_b32 s40, s25, 0
    s_add_u32 s40, s40, 0
    s_lshl_b32 s40, s40, 8
    s_mov_b32 s42, s40
    s_add_u32 s84, s4, 0x300000
    s_addc_u32 s85, s5, 0
    s_mov_b32 s86, 0x4000
    s_mov_b32 s87, 0x20000
    v_cmp_eq_u32 vcc, 1, v2
    v_mov_b32 v21, s40
    v_mov_b32 v23, s42
    v_cndmask_b32 v21, v21, v23, vcc
    v_mov_b32 v22, 16
    v_mov_b32 v23, 16
    v_cndmask_b32 v22, v22, v23, vcc
    s_mov_b32 s41, 0x8000
g2_dep:
    buffer_load_dword v23, v21, s[84:87], 0 offen sc1
    s_sub_u32 s41, s41, 1
    s_waitcnt vmcnt(0)
    v_cmp_lt_u32 vcc, v23, v22
    s_cmp_eq_u32 s41, 0
    s_cbranch_scc1 g2_dep_ok
    s_cbranch_vccz g2_dep_ok
    s_sleep 2
    s_branch g2_dep
g2_dep_ok:
    s_mov_b32 s32, 0
    s_mov_b32 s33, 0
g2_ld_pA:
    s_add_u32 s40, s32, s27
    s_and_b32 s40, s40, 1
    s_andn2_b32 s41, s32, 1
    s_or_b32 s40, s40, s41
    s_add_u32 s40, s40, s26
    s_mul_i32 s34, s40, 131072
    s_mul_i32 s35, s40, 128
    s_add_u32 s38, s33, s36
    s_add_u32 s39, s33, s37
    s_add_u32 m0, s39, 0
    s_nop 0
    buffer_load_dwordx4 v12, s[12:15], s35 offen lds
    s_add_u32 m0, s39, 1024
    s_nop 0
    buffer_load_dwordx4 v13, s[12:15], s35 offen lds
    s_add_u32 m0, s39, 2048
    s_nop 0
    buffer_load_dwordx4 v14, s[12:15], s35 offen lds
    s_add_u32 m0, s39, 3072
    s_nop 0
    buffer_load_dwordx4 v15, s[12:15], s35 offen lds
    s_add_u32 s33, s33, 24576
    s_add_u32 s32, s32, 1
    s_cmp_lt_u32 s32, 3
    s_cbranch_scc1 g2_ld_pA
    s_waitcnt vmcnt(8)
    s_branch g2_ld_bar
g2_ld_loop:
    s_cmp_eq_u32 s32, 4
    s_cbranch_scc1 g2_ld_s4
    s_waitcnt vmcnt(12)
g2_ld_bar:
    s_barrier
    s_add_u32 s40, s32, s27
    s_and_b32 s40, s40, 1
    s_andn2_b32 s41, s32, 1
    s_or_b32 s40, s40, s41
    s_add_u32 s40, s40, s26
    s_mul_i32 s34, s40, 131072
    s_mul_i32 s35, s40, 128
    s_add_u32 s38, s33, s36
    s_add_u32 s39, s33, s37
    s_add_u32 m0, s38, 0
    s_nop 0
    buffer_load_dwordx4 v10, s[8:11], s34 offen lds
    s_add_u32 m0, s38, 1024
    s_nop 0
    buffer_load_dwordx4 v11, s[8:11], s34 offen lds
    s_add_u32 m0, s39, 0
    s_nop 0
    buffer_load_dwordx4 v12, s[12:15], s35 offen lds
    s_add_u32 m0, s39, 1024
    s_nop 0
    buffer_load_dwordx4 v13, s[12:15], s35 offen lds
    s_add_u32 m0, s39, 2048
    s_nop 0
    buffer_load_dwordx4 v14, s[12:15], s35 offen lds
    s_add_u32 m0, s39, 3072
    s_nop 0
    buffer_load_dwordx4 v15, s[12:15], s35 offen lds
    s_add_u32 s33, s33, 24576
    s_add_u32 s32, s32, 1
    s_cmp_eq_u32 s33, 98304
    s_cselect_b32 s33, 0, s33
    s_cmp_lt_u32 s32, 16
    s_cbranch_scc1 g2_ld_loop
    s_waitcnt vmcnt(12)
    s_barrier
    s_waitcnt vmcnt(6)
    s_barrier
    s_waitcnt vmcnt(0)
    s_barrier
    s_branch g2_ld_end
g2_ld_s4:
    s_waitcnt vmcnt(10)
    s_branch g2_ld_bar
g2_ld_end:
    s_barrier
    s_branch g3_in
g2_done:
    s_endpgm
g2_compute:
    v_lshrrev_b32 v5, 4, v2
    v_bfe_u32 v6, v2, 2, 2
    v_and_b32 v7, 3, v2
    v_and_b32 v8, 15, v2
    s_and_b32 s44, s28, 0
    s_lshr_b32 s45, s28, 0
    s_mul_i32 s40, s25, 128
    s_mul_i32 s41, s45, 32
    s_add_u32 s40, s40, s41
    v_add_u32 v20, s40, v8
    s_mov_b32 s41, 2048
    v_mul_lo_u32 v9, v20, s41
    s_mul_i32 s40, s24, 128
    s_mul_i32 s41, s44, 128
    s_add_u32 s46, s40, s41
    v_and_b32 v3, 1, v5
    v_lshlrev_b32 v3, 5, v3
    v_lshrrev_b32 v4, 1, v5
    v_lshl_add_u32 v3, v4, 4, v3
    v_add3_u32 v9, v9, v3, s46
    s_mov_b32 s52, 0
    s_mov_b32 s53, 32768
    s_waitcnt lgkmcnt(0)
    s_add_u32 s4, s4, s97
    s_addc_u32 s5, s5, 0
    s_add_u32 s20, s4, 0x1900000
    s_addc_u32 s21, s5, 0
    s_cmp_eq_u32 s96, 1
    s_cselect_b32 s20, s20, s6
    s_cselect_b32 s21, s21, s7
    s_mov_b32 s22, 0x400000
    s_mov_b32 s23, 0x20000
    s_add_u32 s16, s4, 0x800000
    s_addc_u32 s17, s5, 0
    s_mov_b32 s18, 0x400000
    s_mov_b32 s19, 0x20000
    s_add_u32 s56, s4, 0xc00000
    s_addc_u32 s57, s5, 0
    s_mov_b32 s58, 0x480000
    s_mov_b32 s59, 0x20000
    s_add_u32 s60, s4, 0x200000
    s_addc_u32 s61, s5, 0
    s_mov_b32 s62, 0x40000
    s_mov_b32 s63, 0x20000
    s_mul_i32 s42, s44, 4
    s_mov_b32 s43, 0
    v_and_b32 v3, 1, v5
    v_lshlrev_b32 v3, 1, v3
    v_lshrrev_b32 v4, 1, v6
    v_or_b32 v3, v3, v4
    s_add_u32 s40, s42, 0
    v_xor_b32 v3, s40, v3
    v_lshlrev_b32 v3, 5, v3
    v_lshl_add_u32 v3, v7, 3, v3
    v_lshl_add_u32 v4, v5, 3, v6
    v_lshl_add_u32 v3, v4, 7, v3
    v_add_u32 v10, s43, v3
    v_and_b32 v3, 1, v5
    v_lshlrev_b32 v3, 1, v3
    v_lshrrev_b32 v4, 1, v6
    v_or_b32 v3, v3, v4
    s_add_u32 s40, s42, 1
    v_xor_b32 v3, s40, v3
    v_lshlrev_b32 v3, 5, v3
    v_lshl_add_u32 v3, v7, 3, v3
    v_lshl_add_u32 v4, v5, 3, v6
    v_lshl_add_u32 v3, v4, 7, v3
    v_add_u32 v11, s43, v3
    v_and_b32 v3, 1, v5
    v_lshlrev_b32 v3, 1, v3
    v_lshrrev_b32 v4, 1, v6
    v_or_b32 v3, v3, v4
    s_add_u32 s40, s42, 2
    v_xor_b32 v3, s40, v3
    v_lshlrev_b32 v3, 5, v3
    v_lshl_add_u32 v3, v7, 3, v3
    v_lshl_add_u32 v4, v5, 3, v6
    v_lshl_add_u32 v3, v4, 7, v3
    v_add_u32 v12, s43, v3
    v_and_b32 v3, 1, v5
    v_lshlrev_b32 v3, 1, v3
    v_lshrrev_b32 v4, 1, v6
    v_or_b32 v3, v3, v4
    s_add_u32 s40, s42, 3
    v_xor_b32 v3, s40, v3
    v_lshlrev_b32 v3, 5, v3
    v_lshl_add_u32 v3, v7, 3, v3
    v_lshl_add_u32 v4, v5, 3, v6
    v_lshl_add_u32 v3, v4, 7, v3
    v_add_u32 v13, s43, v3
    s_mul_i32 s42, s45, 32
    v_lshrrev_b32 v3, 1, v8
    v_xor_b32 v3, v3, v5
    v_lshlrev_b32 v3, 4, v3
    v_lshl_add_u32 v3, v8, 7, v3
    s_lshl_b32 s40, s42, 7
    s_add_u32 s40, s40, 8192
    v_add_u32 v14, s40, v3
    v_xor_b32 v15, 64, v14
    v_mov_b32 v84, 0
    v_mov_b32 v85, 0
    v_mov_b32 v86, 0
    v_mov_b32 v87, 0
    v_mov_b32 v88, 0
    v_mov_b32 v89, 0
    v_mov_b32 v90, 0
    v_mov_b32 v91, 0
    v_mov_b32 v92, 0
    v_mov_b32 v93, 0
    v_mov_b32 v94, 0
    v_mov_b32 v95, 0
    v_mov_b32 v96, 0
    v_mov_b32 v97, 0
    v_mov_b32 v98, 0
    v_mov_b32 v99, 0
    v_mov_b32 v100, 0
    v_mov_b32 v101, 0
    v_mov_b32 v102, 0
    v_mov_b32 v103, 0
    v_mov_b32 v104, 0
    v_mov_b32 v105, 0
    v_mov_b32 v106, 0
    v_mov_b32 v107, 0
    s_mov_b32 s48, 16
    s_mov_b32 s50, 0
    s_mov_b32 s51, 24576
    s_mov_b32 s29, 0xfffee000
    v_mov_b32 v28, 0
    v_mov_b32 v29, 0
    v_mov_b32 v30, 0
    v_mov_b32 v31, 0
    v_mov_b32 v32, 0
    v_mov_b32 v33, 0
    v_mov_b32 v34, 0
    v_mov_b32 v35, 0
    v_mov_b32 v36, 0
    v_mov_b32 v37, 0
    v_mov_b32 v38, 0
    v_mov_b32 v39, 0
    v_mov_b32 v40, 0
    v_mov_b32 v41, 0
    v_mov_b32 v42, 0
    v_mov_b32 v43, 0
    v_mov_b32 v44, 0
    v_mov_b32 v45, 0
    v_mov_b32 v46, 0
    v_mov_b32 v47, 0
    v_mov_b32 v48, 0
    v_mov_b32 v49, 0
    v_mov_b32 v50, 0
    v_mov_b32 v51, 0
    v_mov_b32 v52, 0
    v_mov_b32 v53, 0
    v_mov_b32 v54, 0
    v_mov_b32 v55, 0
    v_mov_b32 v56, 0
    v_mov_b32 v57, 0
    v_mov_b32 v58, 0
    v_mov_b32 v59, 0
    s_barrier
    buffer_load_dwordx4 v[124:127], v9, s[20:23], s52 offen offset:0
    buffer_load_dwordx4 v[128:131], v9, s[20:23], s52 offen offset:64
    buffer_load_dwordx4 v[132:135], v9, s[20:23], s53 offen offset:0
    buffer_load_dwordx4 v[136:139], v9, s[20:23], s53 offen offset:64
    s_branch g2_cloop2
g2_mid:
    s_waitcnt vmcnt(0)
    s_nop 7
    v_permlane16_swap_b32 v124, v126
    v_permlane16_swap_b32 v125, v127
    v_permlane16_swap_b32 v128, v130
    v_permlane16_swap_b32 v129, v131
    v_permlane16_swap_b32 v132, v134
    v_permlane16_swap_b32 v133, v135
    v_permlane16_swap_b32 v136, v138
    v_permlane16_swap_b32 v137, v139
    v_lshlrev_b32 v140, 16, v124
    v_and_b32 v141, 0xffff0000, v124
    v_lshlrev_b32 v142, 16, v125
    v_and_b32 v143, 0xffff0000, v125
    v_lshlrev_b32 v144, 16, v126
    v_and_b32 v145, 0xffff0000, v126
    v_lshlrev_b32 v146, 16, v127
    v_and_b32 v147, 0xffff0000, v127
    v_pk_add_f32 v[28:29], v[28:29], v[140:141]
    v_pk_add_f32 v[30:31], v[30:31], v[142:143]
    v_pk_add_f32 v[36:37], v[36:37], v[144:145]
    v_pk_add_f32 v[38:39], v[38:39], v[146:147]
    v_lshlrev_b32 v140, 16, v128
    v_and_b32 v141, 0xffff0000, v128
    v_lshlrev_b32 v142, 16, v129
    v_and_b32 v143, 0xffff0000, v129
    v_lshlrev_b32 v144, 16, v130
    v_and_b32 v145, 0xffff0000, v130
    v_lshlrev_b32 v146, 16, v131
    v_and_b32 v147, 0xffff0000, v131
    v_pk_add_f32 v[44:45], v[44:45], v[140:141]
    v_pk_add_f32 v[46:47], v[46:47], v[142:143]
    v_pk_add_f32 v[52:53], v[52:53], v[144:145]
    v_pk_add_f32 v[54:55], v[54:55], v[146:147]
    v_lshlrev_b32 v140, 16, v132
    v_and_b32 v141, 0xffff0000, v132
    v_lshlrev_b32 v142, 16, v133
    v_and_b32 v143, 0xffff0000, v133
    v_lshlrev_b32 v144, 16, v134
    v_and_b32 v145, 0xffff0000, v134
    v_lshlrev_b32 v146, 16, v135
    v_and_b32 v147, 0xffff0000, v135
    v_pk_add_f32 v[32:33], v[32:33], v[140:141]
    v_pk_add_f32 v[34:35], v[34:35], v[142:143]
    v_pk_add_f32 v[40:41], v[40:41], v[144:145]
    v_pk_add_f32 v[42:43], v[42:43], v[146:147]
    v_lshlrev_b32 v140, 16, v136
    v_and_b32 v141, 0xffff0000, v136
    v_lshlrev_b32 v142, 16, v137
    v_and_b32 v143, 0xffff0000, v137
    v_lshlrev_b32 v144, 16, v138
    v_and_b32 v145, 0xffff0000, v138
    v_lshlrev_b32 v146, 16, v139
    v_and_b32 v147, 0xffff0000, v139
    v_pk_add_f32 v[48:49], v[48:49], v[140:141]
    v_pk_add_f32 v[50:51], v[50:51], v[142:143]
    v_pk_add_f32 v[56:57], v[56:57], v[144:145]
    v_pk_add_f32 v[58:59], v[58:59], v[146:147]
    s_nop 1
    s_branch g2_cloop2
.p2align 3
g2_cloop:
    s_barrier
    s_cmp_eq_u32 s48, 8
    s_cbranch_scc1 g2_mid
g2_cloop2:
    v_mfma_f32_16x16x32_bf16 v[28:31], v[84:87], v[100:103], v[28:31]
    ds_read_b64_tr_b16 v[60:61], v10 offset:0
    ds_read_b64_tr_b16 v[62:63], v10 offset:512
    v_mfma_f32_16x16x32_bf16 v[32:35], v[84:87], v[104:107], v[32:35]
    ds_read_b128 v[76:79], v14 offset:0
    v_mfma_f32_16x16x32_bf16 v[36:39], v[88:91], v[100:103], v[36:39]
    ds_read_b128 v[80:83], v14 offset:2048
    v_mfma_f32_16x16x32_bf16 v[40:43], v[88:91], v[104:107], v[40:43]
    ds_read_b64_tr_b16 v[64:65], v11 offset:0
    ds_read_b64_tr_b16 v[66:67], v11 offset:512
    v_mfma_f32_16x16x32_bf16 v[44:47], v[92:95], v[100:103], v[44:47]
    ds_read_b64_tr_b16 v[68:69], v12 offset:0
    ds_read_b64_tr_b16 v[70:71], v12 offset:512
    v_mfma_f32_16x16x32_bf16 v[48:51], v[92:95], v[104:107], v[48:51]
    ds_read_b64_tr_b16 v[72:73], v13 offset:0
    ds_read_b64_tr_b16 v[74:75], v13 offset:512
    v_mfma_f32_16x16x32_bf16 v[52:55], v[96:99], v[100:103], v[52:55]
    v_mfma_f32_16x16x32_bf16 v[56:59], v[96:99], v[104:107], v[56:59]
    s_waitcnt lgkmcnt(0)
    v_mfma_f32_16x16x32_bf16 v[28:31], v[60:63], v[76:79], v[28:31]
    ds_read_b64_tr_b16 v[84:85], v10 offset:4096
    ds_read_b64_tr_b16 v[86:87], v10 offset:4608
    v_mfma_f32_16x16x32_bf16 v[32:35], v[60:63], v[80:83], v[32:35]
    ds_read_b128 v[100:103], v15 offset:0
    v_mfma_f32_16x16x32_bf16 v[36:39], v[64:67], v[76:79], v[36:39]
    ds_read_b128 v[104:107], v15 offset:2048
    v_mfma_f32_16x16x32_bf16 v[40:43], v[64:67], v[80:83], v[40:43]
    ds_read_b64_tr_b16 v[88:89], v11 offset:4096
    ds_read_b64_tr_b16 v[90:91], v11 offset:4608
    v_mfma_f32_16x16x32_bf16 v[44:47], v[68:71], v[76:79], v[44:47]
    ds_read_b64_tr_b16 v[92:93], v12 offset:4096
    ds_read_b64_tr_b16 v[94:95], v12 offset:4608
    v_mfma_f32_16x16x32_bf16 v[48:51], v[68:71], v[80:83], v[48:51]
    ds_read_b64_tr_b16 v[96:97], v13 offset:4096
    ds_read_b64_tr_b16 v[98:99], v13 offset:4608
    v_mfma_f32_16x16x32_bf16 v[52:55], v[72:75], v[76:79], v[52:55]
    s_add_u32 s50, s50, 1
    s_cmp_eq_u32 s50, 4
    v_mfma_f32_16x16x32_bf16 v[56:59], v[72:75], v[80:83], v[56:59]
    s_cselect_b32 s49, s29, s51
    s_cselect_b32 s50, 0, s50
    v_add_u32 v10, s49, v10
    v_add_u32 v11, s49, v11
    v_add_u32 v12, s49, v12
    v_add_u32 v13, s49, v13
    v_add_u32 v14, s49, v14
    v_add_u32 v15, s49, v15
    s_sub_u32 s48, s48, 1
    s_cmp_lg_u32 s48, 0
    s_waitcnt lgkmcnt(0)
    s_cbranch_scc1 g2_cloop
    v_mfma_f32_16x16x32_bf16 v[28:31], v[84:87], v[100:103], v[28:31]
    v_mfma_f32_16x16x32_bf16 v[32:35], v[84:87], v[104:107], v[32:35]
    v_mfma_f32_16x16x32_bf16 v[36:39], v[88:91], v[100:103], v[36:39]
    v_mfma_f32_16x16x32_bf16 v[40:43], v[88:91], v[104:107], v[40:43]
    v_mfma_f32_16x16x32_bf16 v[44:47], v[92:95], v[100:103], v[44:47]
    v_mfma_f32_16x16x32_bf16 v[48:51], v[92:95], v[104:107], v[48:51]
    v_mfma_f32_16x16x32_bf16 v[52:55], v[96:99], v[100:103], v[52:55]
    v_mfma_f32_16x16x32_bf16 v[56:59], v[96:99], v[104:107], v[56:59]
    s_nop 7
    v_pk_add_f32 v[76:77], v[28:29], v[30:31]
    v_pk_mul_f32 v[78:79], v[28:29], v[28:29]
    v_pk_fma_f32 v[78:79], v[30:31], v[30:31], v[78:79]
    v_pk_add_f32 v[76:77], v[76:77], v[36:37]
    v_pk_fma_f32 v[78:79], v[36:37], v[36:37], v[78:79]
    v_pk_add_f32 v[76:77], v[76:77], v[38:39]
    v_pk_fma_f32 v[78:79], v[38:39], v[38:39], v[78:79]
    v_pk_add_f32 v[76:77], v[76:77], v[44:45]
    v_pk_fma_f32 v[78:79], v[44:45], v[44:45], v[78:79]
    v_pk_add_f32 v[76:77], v[76:77], v[46:47]
    v_pk_fma_f32 v[78:79], v[46:47], v[46:47], v[78:79]
    v_pk_add_f32 v[76:77], v[76:77], v[52:53]
    v_pk_fma_f32 v[78:79], v[52:53], v[52:53], v[78:79]
    v_pk_add_f32 v[76:77], v[76:77], v[54:55]
    v_pk_fma_f32 v[78:79], v[54:55], v[54:55], v[78:79]
    v_pk_add_f32 v[80:81], v[32:33], v[34:35]
    v_pk_mul_f32 v[82:83], v[32:33], v[32:33]
    v_pk_fma_f32 v[82:83], v[34:35], v[34:35], v[82:83]
    v_pk_add_f32 v[80:81], v[80:81], v[40:41]
    v_pk_fma_f32 v[82:83], v[40:41], v[40:41], v[82:83]
    v_pk_add_f32 v[80:81], v[80:81], v[42:43]
    v_pk_fma_f32 v[82:83], v[42:43], v[42:43], v[82:83]
    v_pk_add_f32 v[80:81], v[80:81], v[48:49]
    v_pk_fma_f32 v[82:83], v[48:49], v[48:49], v[82:83]
    v_pk_add_f32 v[80:81], v[80:81], v[50:51]
    v_pk_fma_f32 v[82:83], v[50:51], v[50:51], v[82:83]
    v_pk_add_f32 v[80:81], v[80:81], v[56:57]
    v_pk_fma_f32 v[82:83], v[56:57], v[56:57], v[82:83]
    v_pk_add_f32 v[80:81], v[80:81], v[58:59]
    v_pk_fma_f32 v[82:83], v[58:59], v[58:59], v[82:83]
    v_add_f32 v76, v76, v77
    v_add_f32 v77, v78, v79
    v_add_f32 v80, v80, v81
    v_add_f32 v81, v82, v83
    s_nop 1
    v_permlane16_swap_b32 v76, v80
    v_permlane16_swap_b32 v77, v81
    v_pk_add_f32 v[76:77], v[76:77], v[80:81]
    v_mov_b32 v84, v76
    v_mov_b32 v85, v77
    v_and_b32 v3, 16, v2
    v_add_u32 v3, v3, v20
    v_permlane32_swap_b32 v76, v84
    v_permlane32_swap_b32 v77, v85
    v_pk_add_f32 v[76:77], v[76:77], v[84:85]
    v_lshlrev_b32 v3, 3, v3
    s_mul_i32 s40, s24, 1
    s_add_u32 s40, s40, s44
    s_lshl_b32 s40, s40, 14
    s_mov_b32 exec_hi, 0
    buffer_store_dwordx2 v[76:77], v3, s[60:63], s40 offen sc1
    s_mov_b32 exec_hi, -1
    v_lshrrev_b32 v4, 5, v2
    v_lshl_add_u32 v21, v4, 17, v3
    v_cvt_pk_bf16_f32 v60, v28, v29
    v_cvt_pk_bf16_f32 v61, v30, v31
    v_cvt_pk_bf16_f32 v62, v36, v37
    v_cvt_pk_bf16_f32 v63, v38, v39
    v_lshlrev_b32 v28, 16, v60
    v_and_b32 v29, 0xffff0000, v60
    v_lshlrev_b32 v30, 16, v61
    v_and_b32 v31, 0xffff0000, v61
    v_lshlrev_b32 v36, 16, v62
    v_and_b32 v37, 0xffff0000, v62
    v_lshlrev_b32 v38, 16, v63
    v_and_b32 v39, 0xffff0000, v63
    v_permlane16_swap_b32 v60, v62
    v_permlane16_swap_b32 v61, v63
    buffer_store_dwordx4 v[60:63], v9, s[16:19], s52 offen offset:0 sc1
    v_cvt_pk_bf16_f32 v64, v44, v45
    v_cvt_pk_bf16_f32 v65, v46, v47
    v_cvt_pk_bf16_f32 v66, v52, v53
    v_cvt_pk_bf16_f32 v67, v54, v55
    v_lshlrev_b32 v44, 16, v64
    v_and_b32 v45, 0xffff0000, v64
    v_lshlrev_b32 v46, 16, v65
    v_and_b32 v47, 0xffff0000, v65
    v_lshlrev_b32 v52, 16, v66
    v_and_b32 v53, 0xffff0000, v66
    v_lshlrev_b32 v54, 16, v67
    v_and_b32 v55, 0xffff0000, v67
    v_permlane16_swap_b32 v64, v66
    v_permlane16_swap_b32 v65, v67
    buffer_store_dwordx4 v[64:67], v9, s[16:19], s52 offen offset:64 sc1
    v_cvt_pk_bf16_f32 v68, v32, v33
    v_cvt_pk_bf16_f32 v69, v34, v35
    v_cvt_pk_bf16_f32 v70, v40, v41
    v_cvt_pk_bf16_f32 v71, v42, v43
    v_lshlrev_b32 v32, 16, v68
    v_and_b32 v33, 0xffff0000, v68
    v_lshlrev_b32 v34, 16, v69
    v_and_b32 v35, 0xffff0000, v69
    v_lshlrev_b32 v40, 16, v70
    v_and_b32 v41, 0xffff0000, v70
    v_lshlrev_b32 v42, 16, v71
    v_and_b32 v43, 0xffff0000, v71
    v_permlane16_swap_b32 v68, v70
    v_permlane16_swap_b32 v69, v71
    buffer_store_dwordx4 v[68:71], v9, s[16:19], s53 offen offset:0 sc1
    v_cvt_pk_bf16_f32 v72, v48, v49
    v_cvt_pk_bf16_f32 v73, v50, v51
    v_cvt_pk_bf16_f32 v74, v56, v57
    v_cvt_pk_bf16_f32 v75, v58, v59
    v_lshlrev_b32 v48, 16, v72
    v_and_b32 v49, 0xffff0000, v72
    v_lshlrev_b32 v50, 16, v73
    v_and_b32 v51, 0xffff0000, v73
    v_lshlrev_b32 v56, 16, v74
    v_and_b32 v57, 0xffff0000, v74
    v_lshlrev_b32 v58, 16, v75
    v_and_b32 v59, 0xffff0000, v75
    v_permlane16_swap_b32 v72, v74
    v_permlane16_swap_b32 v73, v75
    buffer_store_dwordx4 v[72:75], v9, s[16:19], s53 offen offset:64 sc1
    s_mov_b32 s48, 0x2000
    v_mul_u32_u24 v19, 256, v20
    v_add_u32 v19, v19, v9
    s_mov_b32 s54, 0
    s_mov_b32 s55, 36864
    s_mov_b32 s40, 0
    buffer_load_dwordx2 v[108:109], v21, s[60:63], s40 offen sc1
    s_mov_b32 s41, 16384
    buffer_load_dwordx2 v[110:111], v21, s[60:63], s41 offen sc1
    s_mov_b32 s40, 32768
    buffer_load_dwordx2 v[112:113], v21, s[60:63], s40 offen sc1
    s_mov_b32 s41, 49152
    buffer_load_dwordx2 v[114:115], v21, s[60:63], s41 offen sc1
    s_mov_b32 s40, 65536
    buffer_load_dwordx2 v[116:117], v21, s[60:63], s40 offen sc1
    s_mov_b32 s41, 81920
    buffer_load_dwordx2 v[118:119], v21, s[60:63], s41 offen sc1
    s_mov_b32 s40, 98304
    buffer_load_dwordx2 v[120:121], v21, s[60:63], s40 offen sc1
    s_mov_b32 s41, 114688
    buffer_load_dwordx2 v[122:123], v21, s[60:63], s41 offen sc1
    s_waitcnt vmcnt(0)
g2_ex:
    v_max3_u32 v4, v108, v109, v110
    v_max3_u32 v4, v4, v111, v112
    v_max3_u32 v4, v4, v113, v114
    v_max3_u32 v4, v4, v115, v116
    v_max3_u32 v4, v4, v117, v118
    v_max3_u32 v4, v4, v119, v120
    v_max3_u32 v4, v4, v121, v122
    v_max_u32 v4, v4, v123
    v_cmp_eq_u32 vcc, -1, v4
    s_sub_u32 s48, s48, 1
    s_cmp_eq_u32 s48, 0
    s_cbranch_scc1 g2_exd
    s_cbranch_vccz g2_exd
    s_sleep 2
    s_mov_b32 s40, 0
    buffer_load_dwordx2 v[108:109], v21, s[60:63], s40 offen sc1
    s_mov_b32 s41, 16384
    buffer_load_dwordx2 v[110:111], v21, s[60:63], s41 offen sc1
    s_mov_b32 s40, 32768
    buffer_load_dwordx2 v[112:113], v21, s[60:63], s40 offen sc1
    s_mov_b32 s41, 49152
    buffer_load_dwordx2 v[114:115], v21, s[60:63], s41 offen sc1
    s_mov_b32 s40, 65536
    buffer_load_dwordx2 v[116:117], v21, s[60:63], s40 offen sc1
    s_mov_b32 s41, 81920
    buffer_load_dwordx2 v[118:119], v21, s[60:63], s41 offen sc1
    s_mov_b32 s40, 98304
    buffer_load_dwordx2 v[120:121], v21, s[60:63], s40 offen sc1
    s_mov_b32 s41, 114688
    buffer_load_dwordx2 v[122:123], v21, s[60:63], s41 offen sc1
    s_waitcnt vmcnt(0)
    s_branch g2_ex
g2_exd:
    v_pk_add_f32 v[108:109], v[108:109], v[116:117]
    v_pk_add_f32 v[110:111], v[110:111], v[118:119]
    v_pk_add_f32 v[112:113], v[112:113], v[120:121]
    v_pk_add_f32 v[114:115], v[114:115], v[122:123]
    v_pk_add_f32 v[108:109], v[108:109], v[112:113]
    v_pk_add_f32 v[110:111], v[110:111], v[114:115]
    v_pk_add_f32 v[108:109], v[108:109], v[110:111]
    v_mov_b32 v110, v108
    v_mov_b32 v111, v109
    s_nop 1
    v_permlane32_swap_b32 v108, v110
    v_permlane32_swap_b32 v109, v111
    v_pk_add_f32 v[108:109], v[108:109], v[110:111]
    v_mul_f32 v108, 0x3a800000, v108
    v_mul_f32 v109, 0x3a800000, v109
    v_fma_f32 v109, -v108, v108, v109
    v_max_f32 v109, 0, v109
    v_mov_b32 v110, v108
    v_mov_b32 v111, v109
    v_cvt_pk_bf16_f32 v110, v110, v110
    v_lshlrev_b32 v110, 16, v110
    v_cvt_pk_bf16_f32 v111, v111, v111
    v_lshlrev_b32 v111, 16, v111
    v_add_f32 v111, 0x3727c5ac, v111
    v_cvt_pk_bf16_f32 v111, v111, v111
    v_lshlrev_b32 v111, 16, v111
    v_sqrt_f32 v111, v111
    s_nop 0
    v_cvt_pk_bf16_f32 v111, v111, v111
    v_lshlrev_b32 v111, 16, v111
    v_rcp_f32 v111, v111
    v_sub_f32 v112, v108, v110
    v_mul_f32 v113, v109, v111
    v_mul_f32 v112, v112, v111
    v_mul_f32 v113, v113, v111
    v_cvt_pk_bf16_f32 v112, v112, v112
    v_lshlrev_b32 v112, 16, v112
    v_cvt_pk_bf16_f32 v113, v113, v113
    v_lshlrev_b32 v113, 16, v113
    v_add_f32 v113, 0x3727c5ac, v113
    v_cvt_pk_bf16_f32 v113, v113, v113
    v_lshlrev_b32 v113, 16, v113
    v_sqrt_f32 v113, v113
    s_nop 0
    v_cvt_pk_bf16_f32 v113, v113, v113
    v_lshlrev_b32 v113, 16, v113
    v_rcp_f32 v113, v113
    v_fma_f32 v112, v110, v111, v112
    v_mul_f32 v114, v111, v113
    v_mul_f32 v115, -v112, v113
    v_mov_b32 v116, v114
    v_mov_b32 v117, v115
    s_nop 1
    v_permlane16_swap_b32 v114, v116
    v_permlane16_swap_b32 v115, v117
    v_pk_fma_f32 v[28:29], v[28:29], v[114:115], v[114:115] op_sel:[0,0,1] op_sel_hi:[1,0,1]
    v_pk_fma_f32 v[30:31], v[30:31], v[114:115], v[114:115] op_sel:[0,0,1] op_sel_hi:[1,0,1]
    v_pk_fma_f32 v[36:37], v[36:37], v[114:115], v[114:115] op_sel:[0,0,1] op_sel_hi:[1,0,1]
    v_pk_fma_f32 v[38:39], v[38:39], v[114:115], v[114:115] op_sel:[0,0,1] op_sel_hi:[1,0,1]
    v_cvt_pk_bf16_f32 v60, v28, v29
    v_cvt_pk_bf16_f32 v61, v30, v31
    v_cvt_pk_bf16_f32 v62, v36, v37
    v_cvt_pk_bf16_f32 v63, v38, v39
    s_nop 1
    v_permlane16_swap_b32 v60, v62
    v_permlane16_swap_b32 v61, v63
    buffer_store_dwordx4 v[60:63], v19, s[56:59], s54 offen offset:0 sc1
    v_pk_fma_f32 v[44:45], v[44:45], v[114:115], v[114:115] op_sel:[0,0,1] op_sel_hi:[1,0,1]
    v_pk_fma_f32 v[46:47], v[46:47], v[114:115], v[114:115] op_sel:[0,0,1] op_sel_hi:[1,0,1]
    v_pk_fma_f32 v[52:53], v[52:53], v[114:115], v[114:115] op_sel:[0,0,1] op_sel_hi:[1,0,1]
    v_pk_fma_f32 v[54:55], v[54:55], v[114:115], v[114:115] op_sel:[0,0,1] op_sel_hi:[1,0,1]
    v_cvt_pk_bf16_f32 v64, v44, v45
    v_cvt_pk_bf16_f32 v65, v46, v47
    v_cvt_pk_bf16_f32 v66, v52, v53
    v_cvt_pk_bf16_f32 v67, v54, v55
    s_nop 1
    v_permlane16_swap_b32 v64, v66
    v_permlane16_swap_b32 v65, v67
    buffer_store_dwordx4 v[64:67], v19, s[56:59], s54 offen offset:64 sc1
    v_pk_fma_f32 v[32:33], v[32:33], v[116:117], v[116:117] op_sel:[0,0,1] op_sel_hi:[1,0,1]
    v_pk_fma_f32 v[34:35], v[34:35], v[116:117], v[116:117] op_sel:[0,0,1] op_sel_hi:[1,0,1]
    v_pk_fma_f32 v[40:41], v[40:41], v[116:117], v[116:117] op_sel:[0,0,1] op_sel_hi:[1,0,1]
    v_pk_fma_f32 v[42:43], v[42:43], v[116:117], v[116:117] op_sel:[0,0,1] op_sel_hi:[1,0,1]
    v_cvt_pk_bf16_f32 v68, v32, v33
    v_cvt_pk_bf16_f32 v69, v34, v35
    v_cvt_pk_bf16_f32 v70, v40, v41
    v_cvt_pk_bf16_f32 v71, v42, v43
    s_nop 1
    v_permlane16_swap_b32 v68, v70
    v_permlane16_swap_b32 v69, v71
    buffer_store_dwordx4 v[68:71], v19, s[56:59], s55 offen offset:0 sc1
    v_pk_fma_f32 v[48:49], v[48:49], v[116:117], v[116:117] op_sel:[0,0,1] op_sel_hi:[1,0,1]
    v_pk_fma_f32 v[50:51], v[50:51], v[116:117], v[116:117] op_sel:[0,0,1] op_sel_hi:[1,0,1]
    v_pk_fma_f32 v[56:57], v[56:57], v[116:117], v[116:117] op_sel:[0,0,1] op_sel_hi:[1,0,1]
    v_pk_fma_f32 v[58:59], v[58:59], v[116:117], v[116:117] op_sel:[0,0,1] op_sel_hi:[1,0,1]
    v_cvt_pk_bf16_f32 v72, v48, v49
    v_cvt_pk_bf16_f32 v73, v50, v51
    v_cvt_pk_bf16_f32 v74, v56, v57
    v_cvt_pk_bf16_f32 v75, v58, v59
    s_nop 1
    v_permlane16_swap_b32 v72, v74
    v_permlane16_swap_b32 v73, v75
    buffer_store_dwordx4 v[72:75], v19, s[56:59], s55 offen offset:64 sc1
    s_lshr_b32 s40, s24, 1
    s_add_u32 s40, s40, 16
    s_lshl_b32 s40, s40, 8
    s_mov_b32 s42, s40
    s_add_u32 s84, s4, 0x300000
    s_addc_u32 s85, s5, 0
    s_mov_b32 s86, 0x4000
    s_mov_b32 s87, 0x20000
    v_mov_b32 v3, s40
    v_mov_b32 v4, 1
    s_waitcnt vmcnt(0)
    s_barrier
    s_cmp_lg_u32 s28, 0
    s_cbranch_scc1 g2_cin
    s_mov_b64 exec, 1
    buffer_atomic_add v4, v3, s[84:87], 0 offen sc1
    s_mov_b64 exec, -1
g2_cin:
    s_branch g3_in
.p2align 6
g3_in:
    s_cmp_ge_u32 s2, 224
    s_cbranch_scc1 g3_spare
    s_load_dwordx2 s[4:5], s[0:1], 80
    s_load_dwordx2 s[30:31], s[0:1], 32
    s_load_dwordx2 s[6:7], s[0:1], 40
    v_lshrrev_b32 v1, 6, v0
    v_and_b32 v2, 63, v0
    s_and_b32 s40, s2, 1
    s_lshl_b32 s40, s40, 2
    s_bfe_u32 s41, s2, 0x20003
    s_add_u32 s25, s40, s41
    s_bfe_u32 s40, s2, 0x20001
    s_mul_i32 s40, s40, 7
    s_lshr_b32 s42, s2, 5
    s_add_u32 s24, s40, s42
    s_add_u32 s27, s41, s42
    s_mov_b32 s26, 0
    s_cmp_eq_u32 s96, 0
    s_cselect_b32 s95, 3, 1
    v_readfirstlane_b32 s28, v1
    s_nop 0
    s_cmp_lt_u32 s28, 4
    s_cbranch_scc1 g3_compute
    s_sub_u32 s28, s28, 4
    s_mov_b32 s40, 7168
    v_lshrrev_b32 v4, 4, v2
    v_mul_lo_u32 v3, v4, s40
    v_lshlrev_b32 v4, 1, v4
    v_xor_b32 v4, v4, v2
    v_and_b32 v4, 15, v4
    v_lshl_add_u32 v3, v4, 4, v3
    s_mul_i32 s41, s24, 256
    s_mul_i32 s42, s28, 114688
    s_add_u32 s41, s41, s42
    v_xor_b32 v4, 128, v3
    s_add_u32 s42, s41, 0
    v_add_u32 v10, s42, v3
    s_add_u32 s42, s41, 28672
    v_add_u32 v11, s42, v3
    s_add_u32 s42, s41, 57344
    v_add_u32 v12, s42, v4
    s_add_u32 s42, s41, 86016
    v_add_u32 v13, s42, v4
    s_mov_b32 s40, 2304
    v_lshrrev_b32 v4, 4, v2
    v_mul_lo_u32 v3, v4, s40
    v_lshlrev_b32 v4, 1, v4
    v_xor_b32 v4, v4, v2
    v_and_b32 v4, 15, v4
    v_lshl_add_u32 v3, v4, 4, v3
    s_mul_i32 s41, s25, 256
    s_mul_i32 s42, s28, 36864
    s_add_u32 s41, s41, s42
    v_xor_b32 v4, 128, v3
    s_add_u32 s42, s41, 0
    v_add_u32 v14, s42, v3
    s_add_u32 s42, s41, 9216
    v_add_u32 v15, s42, v3
    s_add_u32 s42, s41, 18432
    v_add_u32 v16, s42, v4
    s_add_u32 s42, s41, 27648
    v_add_u32 v17, s42, v4
    s_mul_i32 s36, s28, 4096
    s_mul_i32 s37, s28, 4096
    s_add_u32 s37, s37, 16384
    s_waitcnt lgkmcnt(0)
    s_add_u32 s4, s4, s97
    s_addc_u32 s5, s5, 0
    s_mov_b32 s8, s30
    s_mov_b32 s9, s31
    s_mov_b32 s10, 0xe00000
    s_mov_b32 s11, 0x20000
    s_add_u32 s12, s4, 0xc00000
    s_addc_u32 s13, s5, 0
    s_mov_b32 s14, 0x480000
    s_mov_b32 s15, 0x20000
    s_mov_b32 s32, 0
    s_mov_b32 s33, 0
g3_ld_pW:
    s_add_u32 s40, s32, s27
    s_and_b32 s40, s40, s95
    s_andn2_b32 s41, s32, s95
    s_or_b32 s40, s40, s41
    s_add_u32 s40, s40, s26
    s_mul_i32 s34, s40, 458752
    s_mul_i32 s35, s40, 147456
    s_add_u32 s38, s33, s36
    s_add_u32 s39, s33, s37
    s_add_u32 m0, s38, 0
    s_nop 0
    buffer_load_dwordx4 v10, s[8:11], s34 offen lds
    s_add_u32 m0, s38, 1024
    s_nop 0
    buffer_load_dwordx4 v11, s[8:11], s34 offen lds
    s_add_u32 m0, s38, 2048
    s_nop 0
    buffer_load_dwordx4 v12, s[8:11], s34 offen lds
    s_add_u32 m0, s38, 3072
    s_nop 0
    buffer_load_dwordx4 v13, s[8:11], s34 offen lds
    s_add_u32 s33, s33, 32768
    s_add_u32 s32, s32, 1
    s_cmp_lt_u32 s32, 3
    s_cbranch_scc1 g3_ld_pW
    s_lshr_b32 s40, s25, 0
    s_add_u32 s40, s40, 16
    s_lshl_b32 s40, s40, 8
    s_mov_b32 s42, s40
    s_add_u32 s84, s4, 0x300000
    s_addc_u32 s85, s5, 0
    s_mov_b32 s86, 0x4000
    s_mov_b32 s87, 0x20000
    v_cmp_eq_u32 vcc, 1, v2
    v_mov_b32 v21, s40
    v_mov_b32 v23, s42
    v_cndmask_b32 v21, v21, v23, vcc
    v_mov_b32 v22, 32
    v_mov_b32 v23, 32
    v_cndmask_b32 v22, v22, v23, vcc
    s_mov_b32 s41, 0x8000
g3_dep:
    buffer_load_dword v23, v21, s[84:87], 0 offen sc1
    s_sub_u32 s41, s41, 1
    s_waitcnt vmcnt(0)
    v_cmp_lt_u32 vcc, v23, v22
    s_cmp_eq_u32 s41, 0
    s_cbranch_scc1 g3_dep_ok
    s_cbranch_vccz g3_dep_ok
    s_sleep 2
    s_branch g3_dep
g3_dep_ok:
    s_mov_b32 s32, 0
    s_mov_b32 s33, 0
g3_ld_pA:
    s_add_u32 s40, s32, s27
    s_and_b32 s40, s40, s95
    s_andn2_b32 s41, s32, s95
    s_or_b32 s40, s40, s41
    s_add_u32 s40, s40, s26
    s_mul_i32 s34, s40, 458752
    s_mul_i32 s35, s40, 147456
    s_add_u32 s38, s33, s36
    s_add_u32 s39, s33, s37
    s_add_u32 m0, s39, 0
    s_nop 0
    buffer_load_dwordx4 v14, s[12:15], s35 offen lds
    s_add_u32 m0, s39, 1024
    s_nop 0
    buffer_load_dwordx4 v15, s[12:15], s35 offen lds
    s_add_u32 m0, s39, 2048
    s_nop 0
    buffer_load_dwordx4 v16, s[12:15], s35 offen lds
    s_add_u32 m0, s39, 3072
    s_nop 0
    buffer_load_dwordx4 v17, s[12:15], s35 offen lds
    s_add_u32 s33, s33, 32768
    s_add_u32 s32, s32, 1
    s_cmp_lt_u32 s32, 3
    s_cbranch_scc1 g3_ld_pA
    s_waitcnt vmcnt(8)
    s_branch g3_ld_bar
g3_ld_loop:
    s_cmp_eq_u32 s32, 4
    s_cbranch_scc1 g3_ld_s4
    s_waitcnt vmcnt(16)
g3_ld_bar:
    s_barrier
    s_add_u32 s40, s32, s27
    s_and_b32 s40, s40, s95
    s_andn2_b32 s41, s32, s95
    s_or_b32 s40, s40, s41
    s_add_u32 s40, s40, s26
    s_mul_i32 s34, s40, 458752
    s_mul_i32 s35, s40, 147456
    s_add_u32 s38, s33, s36
    s_add_u32 s39, s33, s37
    s_add_u32 m0, s38, 0
    s_nop 0
    buffer_load_dwordx4 v10, s[8:11], s34 offen lds
    s_add_u32 m0, s38, 1024
    s_nop 0
    buffer_load_dwordx4 v11, s[8:11], s34 offen lds
    s_add_u32 m0, s38, 2048
    s_nop 0
    buffer_load_dwordx4 v12, s[8:11], s34 offen lds
    s_add_u32 m0, s38, 3072
    s_nop 0
    buffer_load_dwordx4 v13, s[8:11], s34 offen lds
    s_add_u32 m0, s39, 0
    s_nop 0
    buffer_load_dwordx4 v14, s[12:15], s35 offen lds
    s_add_u32 m0, s39, 1024
    s_nop 0
    buffer_load_dwordx4 v15, s[12:15], s35 offen lds
    s_add_u32 m0, s39, 2048
    s_nop 0
    buffer_load_dwordx4 v16, s[12:15], s35 offen lds
    s_add_u32 m0, s39, 3072
    s_nop 0
    buffer_load_dwordx4 v17, s[12:15], s35 offen lds
    s_add_u32 s33, s33, 32768
    s_add_u32 s32, s32, 1
    s_cmp_eq_u32 s33, 131072
    s_cselect_b32 s33, 0, s33
    s_cmp_lt_u32 s32, 32
    s_cbranch_scc1 g3_ld_loop
    s_waitcnt vmcnt(16)
    s_barrier
    s_waitcnt vmcnt(8)
    s_barrier
    s_waitcnt vmcnt(0)
    s_barrier
    s_branch g3_ld_end
g3_ld_s4:
    s_waitcnt vmcnt(12)
    s_branch g3_ld_bar
g3_ld_end:
    s_barrier
    s_branch g4_in
g3_done:
    s_endpgm
g3_compute:
    v_lshrrev_b32 v5, 4, v2
    v_bfe_u32 v6, v2, 2, 2
    v_and_b32 v7, 3, v2
    v_and_b32 v8, 15, v2
    s_and_b32 s44, s28, 1
    s_lshr_b32 s45, s28, 1
    s_mul_i32 s40, s25, 128
    s_mul_i32 s41, s45, 64
    s_add_u32 s40, s40, s41
    v_add_u32 v20, s40, v8
    s_mov_b32 s41, 8192
    v_mul_lo_u32 v9, v20, s41
    s_mul_i32 s40, s24, 256
    s_mul_i32 s41, s44, 128
    s_add_u32 s46, s40, s41
    v_and_b32 v3, 1, v5
    v_lshlrev_b32 v3, 5, v3
    v_lshrrev_b32 v4, 1, v5
    v_lshl_add_u32 v3, v4, 4, v3
    v_add3_u32 v9, v9, v3, s46
    s_mov_b32 s52, 0
    s_mov_b32 s53, 131072
    s_mov_b32 s54, 262144
    s_mov_b32 s55, 393216
    s_waitcnt lgkmcnt(0)
    s_add_u32 s4, s4, s97
    s_addc_u32 s5, s5, 0
    s_mov_b32 s20, s6
    s_mov_b32 s21, s7
    s_mov_b32 s22, 0x1c00
    s_mov_b32 s23, 0x20000
    s_add_u32 s16, s4, 0x1100000
    s_addc_u32 s17, s5, 0
    s_mov_b32 s18, 0x800000
    s_mov_b32 s19, 0x20000
    v_lshl_add_u32 v3, v5, 3, s46
    buffer_load_dwordx2 v[92:93], v3, s[20:23], 0 offen offset:0
    buffer_load_dwordx2 v[94:95], v3, s[20:23], 0 offen offset:32
    buffer_load_dwordx2 v[96:97], v3, s[20:23], 0 offen offset:64
    buffer_load_dwordx2 v[98:99], v3, s[20:23], 0 offen offset:96
    s_mul_i32 s42, s44, 4
    s_mov_b32 s43, 0
    v_and_b32 v3, 1, v5
    v_lshl_or_b32 v3, v3, 2, v6
    s_add_u32 s40, s42, 0
    v_xor_b32 v3, s40, v3
    v_lshlrev_b32 v3, 5, v3
    v_lshl_add_u32 v3, v7, 3, v3
    v_lshl_add_u32 v4, v5, 3, v6
    v_lshl_add_u32 v3, v4, 8, v3
    v_add_u32 v10, s43, v3
    v_and_b32 v3, 1, v5
    v_lshl_or_b32 v3, v3, 2, v6
    s_add_u32 s40, s42, 1
    v_xor_b32 v3, s40, v3
    v_lshlrev_b32 v3, 5, v3
    v_lshl_add_u32 v3, v7, 3, v3
    v_lshl_add_u32 v4, v5, 3, v6
    v_lshl_add_u32 v3, v4, 8, v3
    v_add_u32 v11, s43, v3
    v_and_b32 v3, 1, v5
    v_lshl_or_b32 v3, v3, 2, v6
    s_add_u32 s40, s42, 2
    v_xor_b32 v3, s40, v3
    v_lshlrev_b32 v3, 5, v3
    v_lshl_add_u32 v3, v7, 3, v3
    v_lshl_add_u32 v4, v5, 3, v6
    v_lshl_add_u32 v3, v4, 8, v3
    v_add_u32 v12, s43, v3
    v_and_b32 v3, 1, v5
    v_lshl_or_b32 v3, v3, 2, v6
    s_add_u32 s40, s42, 3
    v_xor_b32 v3, s40, v3
    v_lshlrev_b32 v3, 5, v3
    v_lshl_add_u32 v3, v7, 3, v3
    v_lshl_add_u32 v4, v5, 3, v6
    v_lshl_add_u32 v3, v4, 8, v3
    v_add_u32 v13, s43, v3
    s_mul_i32 s42, s45, 4
    s_mov_b32 s43, 16384
    v_and_b32 v3, 1, v5
    v_lshl_or_b32 v3, v3, 2, v6
    s_add_u32 s40, s42, 0
    v_xor_b32 v3, s40, v3
    v_lshlrev_b32 v3, 5, v3
    v_lshl_add_u32 v3, v7, 3, v3
    v_lshl_add_u32 v4, v5, 3, v6
    v_lshl_add_u32 v3, v4, 8, v3
    v_add_u32 v14, s43, v3
    v_and_b32 v3, 1, v5
    v_lshl_or_b32 v3, v3, 2, v6
    s_add_u32 s40, s42, 1
    v_xor_b32 v3, s40, v3
    v_lshlrev_b32 v3, 5, v3
    v_lshl_add_u32 v3, v7, 3, v3
    v_lshl_add_u32 v4, v5, 3, v6
    v_lshl_add_u32 v3, v4, 8, v3
    v_add_u32 v15, s43, v3
    v_and_b32 v3, 1, v5
    v_lshl_or_b32 v3, v3, 2, v6
    s_add_u32 s40, s42, 2
    v_xor_b32 v3, s40, v3
    v_lshlrev_b32 v3, 5, v3
    v_lshl_add_u32 v3, v7, 3, v3
    v_lshl_add_u32 v4, v5, 3, v6
    v_lshl_add_u32 v3, v4, 8, v3
    v_add_u32 v16, s43, v3
    v_and_b32 v3, 1, v5
    v_lshl_or_b32 v3, v3, 2, v6
    s_add_u32 s40, s42, 3
    v_xor_b32 v3, s40, v3
    v_lshlrev_b32 v3, 5, v3
    v_lshl_add_u32 v3, v7, 3, v3
    v_lshl_add_u32 v4, v5, 3, v6
    v_lshl_add_u32 v3, v4, 8, v3
    v_add_u32 v17, s43, v3
    v_mov_b32 v124, 0
    v_mov_b32 v125, 0
    v_mov_b32 v126, 0
    v_mov_b32 v127, 0
    v_mov_b32 v128, 0
    v_mov_b32 v129, 0
    v_mov_b32 v130, 0
    v_mov_b32 v131, 0
    v_mov_b32 v132, 0
    v_mov_b32 v133, 0
    v_mov_b32 v134, 0
    v_mov_b32 v135, 0
    v_mov_b32 v136, 0
    v_mov_b32 v137, 0
    v_mov_b32 v138, 0
    v_mov_b32 v139, 0
    v_mov_b32 v140, 0
    v_mov_b32 v141, 0
    v_mov_b32 v142, 0
    v_mov_b32 v143, 0
    v_mov_b32 v144, 0
    v_mov_b32 v145, 0
    v_mov_b32 v146, 0
    v_mov_b32 v147, 0
    v_mov_b32 v148, 0
    v_mov_b32 v149, 0
    v_mov_b32 v150, 0
    v_mov_b32 v151, 0
    v_mov_b32 v152, 0
    v_mov_b32 v153, 0
    v_mov_b32 v154, 0
    v_mov_b32 v155, 0
    s_mov_b32 s48, 32
    s_mov_b32 s50, 0
    s_mov_b32 s51, 32768
    s_mov_b32 s29, 0xfffe8000
    s_waitcnt vmcnt(0)
    v_lshlrev_b32 v28, 16, v92
    v_and_b32 v29, 0xffff0000, v92
    v_lshlrev_b32 v30, 16, v93
    v_and_b32 v31, 0xffff0000, v93
    v_lshlrev_b32 v32, 16, v92
    v_and_b32 v33, 0xffff0000, v92
    v_lshlrev_b32 v34, 16, v93
    v_and_b32 v35, 0xffff0000, v93
    v_lshlrev_b32 v36, 16, v92
    v_and_b32 v37, 0xffff0000, v92
    v_lshlrev_b32 v38, 16, v93
    v_and_b32 v39, 0xffff0000, v93
    v_lshlrev_b32 v40, 16, v92
    v_and_b32 v41, 0xffff0000, v92
    v_lshlrev_b32 v42, 16, v93
    v_and_b32 v43, 0xffff0000, v93
    v_lshlrev_b32 v44, 16, v94
    v_and_b32 v45, 0xffff0000, v94
    v_lshlrev_b32 v46, 16, v95
    v_and_b32 v47, 0xffff0000, v95
    v_lshlrev_b32 v48, 16, v94
    v_and_b32 v49, 0xffff0000, v94
    v_lshlrev_b32 v50, 16, v95
    v_and_b32 v51, 0xffff0000, v95
    v_lshlrev_b32 v52, 16, v94
    v_and_b32 v53, 0xffff0000, v94
    v_lshlrev_b32 v54, 16, v95
    v_and_b32 v55, 0xffff0000, v95
    v_lshlrev_b32 v56, 16, v94
    v_and_b32 v57, 0xffff0000, v94
    v_lshlrev_b32 v58, 16, v95
    v_and_b32 v59, 0xffff0000, v95
    v_lshlrev_b32 v60, 16, v96
    v_and_b32 v61, 0xffff0000, v96
    v_lshlrev_b32 v62, 16, v97
    v_and_b32 v63, 0xffff0000, v97
    v_lshlrev_b32 v64, 16, v96
    v_and_b32 v65, 0xffff0000, v96
    v_lshlrev_b32 v66, 16, v97
    v_and_b32 v67, 0xffff0000, v97
    v_lshlrev_b32 v68, 16, v96
    v_and_b32 v69, 0xffff0000, v96
    v_lshlrev_b32 v70, 16, v97
    v_and_b32 v71, 0xffff0000, v97
    v_lshlrev_b32 v72, 16, v96
    v_and_b32 v73, 0xffff0000, v96
    v_lshlrev_b32 v74, 16, v97
    v_and_b32 v75, 0xffff0000, v97
    v_lshlrev_b32 v76, 16, v98
    v_and_b32 v77, 0xffff0000, v98
    v_lshlrev_b32 v78, 16, v99
    v_and_b32 v79, 0xffff0000, v99
    v_lshlrev_b32 v80, 16, v98
    v_and_b32 v81, 0xffff0000, v98
    v_lshlrev_b32 v82, 16, v99
    v_and_b32 v83, 0xffff0000, v99
    v_lshlrev_b32 v84, 16, v98
    v_and_b32 v85, 0xffff0000, v98
    v_lshlrev_b32 v86, 16, v99
    v_and_b32 v87, 0xffff0000, v99
    v_lshlrev_b32 v88, 16, v98
    v_and_b32 v89, 0xffff0000, v98
    v_lshlrev_b32 v90, 16, v99
    v_and_b32 v91, 0xffff0000, v99
.p2align 3
g3_cloop:
    s_barrier
g3_cloop2:
    v_mfma_f32_16x16x32_bf16 v[28:31], v[124:127], v[140:143], v[28:31]
    ds_read_b64_tr_b16 v[92:93], v10 offset:0
    ds_read_b64_tr_b16 v[94:95], v10 offset:1024
    v_mfma_f32_16x16x32_bf16 v[32:35], v[124:127], v[144:147], v[32:35]
    ds_read_b64_tr_b16 v[108:109], v14 offset:0
    ds_read_b64_tr_b16 v[110:111], v14 offset:1024
    v_mfma_f32_16x16x32_bf16 v[36:39], v[124:127], v[148:151], v[36:39]
    ds_read_b64_tr_b16 v[112:113], v15 offset:0
    ds_read_b64_tr_b16 v[114:115], v15 offset:1024
    v_mfma_f32_16x16x32_bf16 v[40:43], v[124:127], v[152:155], v[40:43]
    ds_read_b64_tr_b16 v[116:117], v16 offset:0
    ds_read_b64_tr_b16 v[118:119], v16 offset:1024
    v_mfma_f32_16x16x32_bf16 v[44:47], v[128:131], v[140:143], v[44:47]
    ds_read_b64_tr_b16 v[120:121], v17 offset:0
    ds_read_b64_tr_b16 v[122:123], v17 offset:1024
    v_mfma_f32_16x16x32_bf16 v[48:51], v[128:131], v[144:147], v[48:51]
    ds_read_b64_tr_b16 v[96:97], v11 offset:0
    ds_read_b64_tr_b16 v[98:99], v11 offset:1024
    v_mfma_f32_16x16x32_bf16 v[52:55], v[128:131], v[148:151], v[52:55]
    ds_read_b64_tr_b16 v[100:101], v12 offset:0
    ds_read_b64_tr_b16 v[102:103], v12 offset:1024
    v_mfma_f32_16x16x32_bf16 v[56:59], v[128:131], v[152:155], v[56:59]
    ds_read_b64_tr_b16 v[104:105], v13 offset:0
    ds_read_b64_tr_b16 v[106:107], v13 offset:1024
    v_mfma_f32_16x16x32_bf16 v[60:63], v[132:135], v[140:143], v[60:63]
    v_mfma_f32_16x16x32_bf16 v[64:67], v[132:135], v[144:147], v[64:67]
    v_mfma_f32_16x16x32_bf16 v[68:71], v[132:135], v[148:151], v[68:71]
    v_mfma_f32_16x16x32_bf16 v[72:75], v[132:135], v[152:155], v[72:75]
    v_mfma_f32_16x16x32_bf16 v[76:79], v[136:139], v[140:143], v[76:79]
    v_mfma_f32_16x16x32_bf16 v[80:83], v[136:139], v[144:147], v[80:83]
    v_mfma_f32_16x16x32_bf16 v[84:87], v[136:139], v[148:151], v[84:87]
    v_mfma_f32_16x16x32_bf16 v[88:91], v[136:139], v[152:155], v[88:91]
    s_waitcnt lgkmcnt(0)
    v_mfma_f32_16x16x32_bf16 v[28:31], v[92:95], v[108:111], v[28:31]
    ds_read_b64_tr_b16 v[124:125], v10 offset:8192
    ds_read_b64_tr_b16 v[126:127], v10 offset:9216
    v_mfma_f32_16x16x32_bf16 v[32:35], v[92:95], v[112:115], v[32:35]
    ds_read_b64_tr_b16 v[140:141], v14 offset:8192
    ds_read_b64_tr_b16 v[142:143], v14 offset:9216
    v_mfma_f32_16x16x32_bf16 v[36:39], v[92:95], v[116:119], v[36:39]
    ds_read_b64_tr_b16 v[144:145], v15 offset:8192
    ds_read_b64_tr_b16 v[146:147], v15 offset:9216
    v_mfma_f32_16x16x32_bf16 v[40:43], v[92:95], v[120:123], v[40:43]
    ds_read_b64_tr_b16 v[148:149], v16 offset:8192
    ds_read_b64_tr_b16 v[150:151], v16 offset:9216
    v_mfma_f32_16x16x32_bf16 v[44:47], v[96:99], v[108:111], v[44:47]
    ds_read_b64_tr_b16 v[152:153], v17 offset:8192
    ds_read_b64_tr_b16 v[154:155], v17 offset:9216
    v_mfma_f32_16x16x32_bf16 v[48:51], v[96:99], v[112:115], v[48:51]
    ds_read_b64_tr_b16 v[128:129], v11 offset:8192
    ds_read_b64_tr_b16 v[130:131], v11 offset:9216
    v_mfma_f32_16x16x32_bf16 v[52:55], v[96:99], v[116:119], v[52:55]
    ds_read_b64_tr_b16 v[132:133], v12 offset:8192
    ds_read_b64_tr_b16 v[134:135], v12 offset:9216
    v_mfma_f32_16x16x32_bf16 v[56:59], v[96:99], v[120:123], v[56:59]
    ds_read_b64_tr_b16 v[136:137], v13 offset:8192
    ds_read_b64_tr_b16 v[138:139], v13 offset:9216
    v_mfma_f32_16x16x32_bf16 v[60:63], v[100:103], v[108:111], v[60:63]
    s_add_u32 s50, s50, 1
    s_cmp_eq_u32 s50, 4
    v_mfma_f32_16x16x32_bf16 v[64:67], v[100:103], v[112:115], v[64:67]
    s_cselect_b32 s49, s29, s51
    s_cselect_b32 s50, 0, s50
    v_mfma_f32_16x16x32_bf16 v[68:71], v[100:103], v[116:119], v[68:71]
    v_add_u32 v10, s49, v10
    v_add_u32 v11, s49, v11
    v_mfma_f32_16x16x32_bf16 v[72:75], v[100:103], v[120:123], v[72:75]
    v_add_u32 v12, s49, v12
    v_add_u32 v13, s49, v13
    v_mfma_f32_16x16x32_bf16 v[76:79], v[104:107], v[108:111], v[76:79]
    v_add_u32 v14, s49, v14
    v_add_u32 v15, s49, v15
    v_mfma_f32_16x16x32_bf16 v[80:83], v[104:107], v[112:115], v[80:83]
    v_add_u32 v16, s49, v16
    v_add_u32 v17, s49, v17
    v_mfma_f32_16x16x32_bf16 v[84:87], v[104:107], v[116:119], v[84:87]
    s_sub_u32 s48, s48, 1
    s_cmp_lg_u32 s48, 0
    v_mfma_f32_16x16x32_bf16 v[88:91], v[104:107], v[120:123], v[88:91]
    s_waitcnt lgkmcnt(0)
    s_cbranch_scc1 g3_cloop
    v_mfma_f32_16x16x32_bf16 v[28:31], v[124:127], v[140:143], v[28:31]
    v_mfma_f32_16x16x32_bf16 v[32:35], v[124:127], v[144:147], v[32:35]
    v_mfma_f32_16x16x32_bf16 v[36:39], v[124:127], v[148:151], v[36:39]
    v_mfma_f32_16x16x32_bf16 v[40:43], v[124:127], v[152:155], v[40:43]
    v_mfma_f32_16x16x32_bf16 v[44:47], v[128:131], v[140:143], v[44:47]
    v_mfma_f32_16x16x32_bf16 v[48:51], v[128:131], v[144:147], v[48:51]
    v_mfma_f32_16x16x32_bf16 v[52:55], v[128:131], v[148:151], v[52:55]
    v_mfma_f32_16x16x32_bf16 v[56:59], v[128:131], v[152:155], v[56:59]
    v_mfma_f32_16x16x32_bf16 v[60:63], v[132:135], v[140:143], v[60:63]
    v_mfma_f32_16x16x32_bf16 v[64:67], v[132:135], v[144:147], v[64:67]
    v_mfma_f32_16x16x32_bf16 v[68:71], v[132:135], v[148:151], v[68:71]
    v_mfma_f32_16x16x32_bf16 v[72:75], v[132:135], v[152:155], v[72:75]
    v_mfma_f32_16x16x32_bf16 v[76:79], v[136:139], v[140:143], v[76:79]
    v_mfma_f32_16x16x32_bf16 v[80:83], v[136:139], v[144:147], v[80:83]
    v_mfma_f32_16x16x32_bf16 v[84:87], v[136:139], v[148:151], v[84:87]
    v_mfma_f32_16x16x32_bf16 v[88:91], v[136:139], v[152:155], v[88:91]
    v_mov_b32 v10, 0xbdd2d3e8
    v_mov_b32 v11, 0xbdd2d3e8
    v_mov_b32 v12, 0xc0135761
    v_mov_b32 v13, 0xc0135761
    v_mov_b32 v14, 0x3f800000
    v_mov_b32 v15, 0x3f800000
    s_nop 7
    v_pk_mul_f32 v[108:109], v[28:29], v[28:29]
    v_pk_mul_f32 v[110:111], v[30:31], v[30:31]
    v_pk_mul_f32 v[112:113], v[44:45], v[44:45]
    v_pk_mul_f32 v[114:115], v[46:47], v[46:47]
    v_pk_fma_f32 v[108:109], v[108:109], v[10:11], v[12:13]
    v_pk_fma_f32 v[110:111], v[110:111], v[10:11], v[12:13]
    v_pk_fma_f32 v[112:113], v[112:113], v[10:11], v[12:13]
    v_pk_fma_f32 v[114:115], v[114:115], v[10:11], v[12:13]
    v_pk_mul_f32 v[108:109], v[108:109], v[28:29]
    v_pk_mul_f32 v[110:111], v[110:111], v[30:31]
    v_pk_mul_f32 v[112:113], v[112:113], v[44:45]
    v_pk_mul_f32 v[114:115], v[114:115], v[46:47]
    v_exp_f32 v108, v108
    v_exp_f32 v109, v109
    v_exp_f32 v110, v110
    v_exp_f32 v111, v111
    v_exp_f32 v112, v112
    v_exp_f32 v113, v113
    v_exp_f32 v114, v114
    v_exp_f32 v115, v115
    v_pk_add_f32 v[108:109], v[108:109], v[14:15]
    v_pk_add_f32 v[110:111], v[110:111], v[14:15]
    v_pk_add_f32 v[112:113], v[112:113], v[14:15]
    v_pk_add_f32 v[114:115], v[114:115], v[14:15]
    v_rcp_f32 v108, v108
    v_rcp_f32 v109, v109
    v_rcp_f32 v110, v110
    v_rcp_f32 v111, v111
    v_rcp_f32 v112, v112
    v_rcp_f32 v113, v113
    v_rcp_f32 v114, v114
    v_rcp_f32 v115, v115
    v_pk_mul_f32 v[28:29], v[28:29], v[108:109]
    v_pk_mul_f32 v[30:31], v[30:31], v[110:111]
    v_pk_mul_f32 v[44:45], v[44:45], v[112:113]
    v_pk_mul_f32 v[46:47], v[46:47], v[114:115]
    v_cvt_pk_bf16_f32 v92, v28, v29
    v_cvt_pk_bf16_f32 v93, v30, v31
    v_cvt_pk_bf16_f32 v94, v44, v45
    v_cvt_pk_bf16_f32 v95, v46, v47
    s_nop 1
    v_permlane16_swap_b32 v92, v94
    v_permlane16_swap_b32 v93, v95
    buffer_store_dwordx4 v[92:95], v9, s[16:19], s52 offen offset:0 sc1
    v_pk_mul_f32 v[108:109], v[60:61], v[60:61]
    v_pk_mul_f32 v[110:111], v[62:63], v[62:63]
    v_pk_mul_f32 v[112:113], v[76:77], v[76:77]
    v_pk_mul_f32 v[114:115], v[78:79], v[78:79]
    v_pk_fma_f32 v[108:109], v[108:109], v[10:11], v[12:13]
    v_pk_fma_f32 v[110:111], v[110:111], v[10:11], v[12:13]
    v_pk_fma_f32 v[112:113], v[112:113], v[10:11], v[12:13]
    v_pk_fma_f32 v[114:115], v[114:115], v[10:11], v[12:13]
    v_pk_mul_f32 v[108:109], v[108:109], v[60:61]
    v_pk_mul_f32 v[110:111], v[110:111], v[62:63]
    v_pk_mul_f32 v[112:113], v[112:113], v[76:77]
    v_pk_mul_f32 v[114:115], v[114:115], v[78:79]
    v_exp_f32 v108, v108
    v_exp_f32 v109, v109
    v_exp_f32 v110, v110
    v_exp_f32 v111, v111
    v_exp_f32 v112, v112
    v_exp_f32 v113, v113
    v_exp_f32 v114, v114
    v_exp_f32 v115, v115
    v_pk_add_f32 v[108:109], v[108:109], v[14:15]
    v_pk_add_f32 v[110:111], v[110:111], v[14:15]
    v_pk_add_f32 v[112:113], v[112:113], v[14:15]
    v_pk_add_f32 v[114:115], v[114:115], v[14:15]
    v_rcp_f32 v108, v108
    v_rcp_f32 v109, v109
    v_rcp_f32 v110, v110
    v_rcp_f32 v111, v111
    v_rcp_f32 v112, v112
    v_rcp_f32 v113, v113
    v_rcp_f32 v114, v114
    v_rcp_f32 v115, v115
    v_pk_mul_f32 v[60:61], v[60:61], v[108:109]
    v_pk_mul_f32 v[62:63], v[62:63], v[110:111]
    v_pk_mul_f32 v[76:77], v[76:77], v[112:113]
    v_pk_mul_f32 v[78:79], v[78:79], v[114:115]
    v_cvt_pk_bf16_f32 v96, v60, v61
    v_cvt_pk_bf16_f32 v97, v62, v63
    v_cvt_pk_bf16_f32 v98, v76, v77
    v_cvt_pk_bf16_f32 v99, v78, v79
    s_nop 1
    v_permlane16_swap_b32 v96, v98
    v_permlane16_swap_b32 v97, v99
    buffer_store_dwordx4 v[96:99], v9, s[16:19], s52 offen offset:64 sc1
    v_pk_mul_f32 v[108:109], v[32:33], v[32:33]
    v_pk_mul_f32 v[110:111], v[34:35], v[34:35]
    v_pk_mul_f32 v[112:113], v[48:49], v[48:49]
    v_pk_mul_f32 v[114:115], v[50:51], v[50:51]
    v_pk_fma_f32 v[108:109], v[108:109], v[10:11], v[12:13]
    v_pk_fma_f32 v[110:111], v[110:111], v[10:11], v[12:13]
    v_pk_fma_f32 v[112:113], v[112:113], v[10:11], v[12:13]
    v_pk_fma_f32 v[114:115], v[114:115], v[10:11], v[12:13]
    v_pk_mul_f32 v[108:109], v[108:109], v[32:33]
    v_pk_mul_f32 v[110:111], v[110:111], v[34:35]
    v_pk_mul_f32 v[112:113], v[112:113], v[48:49]
    v_pk_mul_f32 v[114:115], v[114:115], v[50:51]
    v_exp_f32 v108, v108
    v_exp_f32 v109, v109
    v_exp_f32 v110, v110
    v_exp_f32 v111, v111
    v_exp_f32 v112, v112
    v_exp_f32 v113, v113
    v_exp_f32 v114, v114
    v_exp_f32 v115, v115
    v_pk_add_f32 v[108:109], v[108:109], v[14:15]
    v_pk_add_f32 v[110:111], v[110:111], v[14:15]
    v_pk_add_f32 v[112:113], v[112:113], v[14:15]
    v_pk_add_f32 v[114:115], v[114:115], v[14:15]
    v_rcp_f32 v108, v108
    v_rcp_f32 v109, v109
    v_rcp_f32 v110, v110
    v_rcp_f32 v111, v111
    v_rcp_f32 v112, v112
    v_rcp_f32 v113, v113
    v_rcp_f32 v114, v114
    v_rcp_f32 v115, v115
    v_pk_mul_f32 v[32:33], v[32:33], v[108:109]
    v_pk_mul_f32 v[34:35], v[34:35], v[110:111]
    v_pk_mul_f32 v[48:49], v[48:49], v[112:113]
    v_pk_mul_f32 v[50:51], v[50:51], v[114:115]
    v_cvt_pk_bf16_f32 v100, v32, v33
    v_cvt_pk_bf16_f32 v101, v34, v35
    v_cvt_pk_bf16_f32 v102, v48, v49
    v_cvt_pk_bf16_f32 v103, v50, v51
    s_nop 1
    v_permlane16_swap_b32 v100, v102
    v_permlane16_swap_b32 v101, v103
    buffer_store_dwordx4 v[100:103], v9, s[16:19], s53 offen offset:0 sc1
    v_pk_mul_f32 v[108:109], v[64:65], v[64:65]
    v_pk_mul_f32 v[110:111], v[66:67], v[66:67]
    v_pk_mul_f32 v[112:113], v[80:81], v[80:81]
    v_pk_mul_f32 v[114:115], v[82:83], v[82:83]
    v_pk_fma_f32 v[108:109], v[108:109], v[10:11], v[12:13]
    v_pk_fma_f32 v[110:111], v[110:111], v[10:11], v[12:13]
    v_pk_fma_f32 v[112:113], v[112:113], v[10:11], v[12:13]
    v_pk_fma_f32 v[114:115], v[114:115], v[10:11], v[12:13]
    v_pk_mul_f32 v[108:109], v[108:109], v[64:65]
    v_pk_mul_f32 v[110:111], v[110:111], v[66:67]
    v_pk_mul_f32 v[112:113], v[112:113], v[80:81]
    v_pk_mul_f32 v[114:115], v[114:115], v[82:83]
    v_exp_f32 v108, v108
    v_exp_f32 v109, v109
    v_exp_f32 v110, v110
    v_exp_f32 v111, v111
    v_exp_f32 v112, v112
    v_exp_f32 v113, v113
    v_exp_f32 v114, v114
    v_exp_f32 v115, v115
    v_pk_add_f32 v[108:109], v[108:109], v[14:15]
    v_pk_add_f32 v[110:111], v[110:111], v[14:15]
    v_pk_add_f32 v[112:113], v[112:113], v[14:15]
    v_pk_add_f32 v[114:115], v[114:115], v[14:15]
    v_rcp_f32 v108, v108
    v_rcp_f32 v109, v109
    v_rcp_f32 v110, v110
    v_rcp_f32 v111, v111
    v_rcp_f32 v112, v112
    v_rcp_f32 v113, v113
    v_rcp_f32 v114, v114
    v_rcp_f32 v115, v115
    v_pk_mul_f32 v[64:65], v[64:65], v[108:109]
    v_pk_mul_f32 v[66:67], v[66:67], v[110:111]
    v_pk_mul_f32 v[80:81], v[80:81], v[112:113]
    v_pk_mul_f32 v[82:83], v[82:83], v[114:115]
    v_cvt_pk_bf16_f32 v104, v64, v65
    v_cvt_pk_bf16_f32 v105, v66, v67
    v_cvt_pk_bf16_f32 v106, v80, v81
    v_cvt_pk_bf16_f32 v107, v82, v83
    s_nop 1
    v_permlane16_swap_b32 v104, v106
    v_permlane16_swap_b32 v105, v107
    buffer_store_dwordx4 v[104:107], v9, s[16:19], s53 offen offset:64 sc1
    v_pk_mul_f32 v[108:109], v[36:37], v[36:37]
    v_pk_mul_f32 v[110:111], v[38:39], v[38:39]
    v_pk_mul_f32 v[112:113], v[52:53], v[52:53]
    v_pk_mul_f32 v[114:115], v[54:55], v[54:55]
    v_pk_fma_f32 v[108:109], v[108:109], v[10:11], v[12:13]
    v_pk_fma_f32 v[110:111], v[110:111], v[10:11], v[12:13]
    v_pk_fma_f32 v[112:113], v[112:113], v[10:11], v[12:13]
    v_pk_fma_f32 v[114:115], v[114:115], v[10:11], v[12:13]
    v_pk_mul_f32 v[108:109], v[108:109], v[36:37]
    v_pk_mul_f32 v[110:111], v[110:111], v[38:39]
    v_pk_mul_f32 v[112:113], v[112:113], v[52:53]
    v_pk_mul_f32 v[114:115], v[114:115], v[54:55]
    v_exp_f32 v108, v108
    v_exp_f32 v109, v109
    v_exp_f32 v110, v110
    v_exp_f32 v111, v111
    v_exp_f32 v112, v112
    v_exp_f32 v113, v113
    v_exp_f32 v114, v114
    v_exp_f32 v115, v115
    v_pk_add_f32 v[108:109], v[108:109], v[14:15]
    v_pk_add_f32 v[110:111], v[110:111], v[14:15]
    v_pk_add_f32 v[112:113], v[112:113], v[14:15]
    v_pk_add_f32 v[114:115], v[114:115], v[14:15]
    v_rcp_f32 v108, v108
    v_rcp_f32 v109, v109
    v_rcp_f32 v110, v110
    v_rcp_f32 v111, v111
    v_rcp_f32 v112, v112
    v_rcp_f32 v113, v113
    v_rcp_f32 v114, v114
    v_rcp_f32 v115, v115
    v_pk_mul_f32 v[36:37], v[36:37], v[108:109]
    v_pk_mul_f32 v[38:39], v[38:39], v[110:111]
    v_pk_mul_f32 v[52:53], v[52:53], v[112:113]
    v_pk_mul_f32 v[54:55], v[54:55], v[114:115]
    v_cvt_pk_bf16_f32 v92, v36, v37
    v_cvt_pk_bf16_f32 v93, v38, v39
    v_cvt_pk_bf16_f32 v94, v52, v53
    v_cvt_pk_bf16_f32 v95, v54, v55
    s_nop 1
    v_permlane16_swap_b32 v92, v94
    v_permlane16_swap_b32 v93, v95
    buffer_store_dwordx4 v[92:95], v9, s[16:19], s54 offen offset:0 sc1
    v_pk_mul_f32 v[108:109], v[68:69], v[68:69]
    v_pk_mul_f32 v[110:111], v[70:71], v[70:71]
    v_pk_mul_f32 v[112:113], v[84:85], v[84:85]
    v_pk_mul_f32 v[114:115], v[86:87], v[86:87]
    v_pk_fma_f32 v[108:109], v[108:109], v[10:11], v[12:13]
    v_pk_fma_f32 v[110:111], v[110:111], v[10:11], v[12:13]
    v_pk_fma_f32 v[112:113], v[112:113], v[10:11], v[12:13]
    v_pk_fma_f32 v[114:115], v[114:115], v[10:11], v[12:13]
    v_pk_mul_f32 v[108:109], v[108:109], v[68:69]
    v_pk_mul_f32 v[110:111], v[110:111], v[70:71]
    v_pk_mul_f32 v[112:113], v[112:113], v[84:85]
    v_pk_mul_f32 v[114:115], v[114:115], v[86:87]
    v_exp_f32 v108, v108
    v_exp_f32 v109, v109
    v_exp_f32 v110, v110
    v_exp_f32 v111, v111
    v_exp_f32 v112, v112
    v_exp_f32 v113, v113
    v_exp_f32 v114, v114
    v_exp_f32 v115, v115
    v_pk_add_f32 v[108:109], v[108:109], v[14:15]
    v_pk_add_f32 v[110:111], v[110:111], v[14:15]
    v_pk_add_f32 v[112:113], v[112:113], v[14:15]
    v_pk_add_f32 v[114:115], v[114:115], v[14:15]
    v_rcp_f32 v108, v108
    v_rcp_f32 v109, v109
    v_rcp_f32 v110, v110
    v_rcp_f32 v111, v111
    v_rcp_f32 v112, v112
    v_rcp_f32 v113, v113
    v_rcp_f32 v114, v114
    v_rcp_f32 v115, v115
    v_pk_mul_f32 v[68:69], v[68:69], v[108:109]
    v_pk_mul_f32 v[70:71], v[70:71], v[110:111]
    v_pk_mul_f32 v[84:85], v[84:85], v[112:113]
    v_pk_mul_f32 v[86:87], v[86:87], v[114:115]
    v_cvt_pk_bf16_f32 v96, v68, v69
    v_cvt_pk_bf16_f32 v97, v70, v71
    v_cvt_pk_bf16_f32 v98, v84, v85
    v_cvt_pk_bf16_f32 v99, v86, v87
    s_nop 1
    v_permlane16_swap_b32 v96, v98
    v_permlane16_swap_b32 v97, v99
    buffer_store_dwordx4 v[96:99], v9, s[16:19], s54 offen offset:64 sc1
    v_pk_mul_f32 v[108:109], v[40:41], v[40:41]
    v_pk_mul_f32 v[110:111], v[42:43], v[42:43]
    v_pk_mul_f32 v[112:113], v[56:57], v[56:57]
    v_pk_mul_f32 v[114:115], v[58:59], v[58:59]
    v_pk_fma_f32 v[108:109], v[108:109], v[10:11], v[12:13]
    v_pk_fma_f32 v[110:111], v[110:111], v[10:11], v[12:13]
    v_pk_fma_f32 v[112:113], v[112:113], v[10:11], v[12:13]
    v_pk_fma_f32 v[114:115], v[114:115], v[10:11], v[12:13]
    v_pk_mul_f32 v[108:109], v[108:109], v[40:41]
    v_pk_mul_f32 v[110:111], v[110:111], v[42:43]
    v_pk_mul_f32 v[112:113], v[112:113], v[56:57]
    v_pk_mul_f32 v[114:115], v[114:115], v[58:59]
    v_exp_f32 v108, v108
    v_exp_f32 v109, v109
    v_exp_f32 v110, v110
    v_exp_f32 v111, v111
    v_exp_f32 v112, v112
    v_exp_f32 v113, v113
    v_exp_f32 v114, v114
    v_exp_f32 v115, v115
    v_pk_add_f32 v[108:109], v[108:109], v[14:15]
    v_pk_add_f32 v[110:111], v[110:111], v[14:15]
    v_pk_add_f32 v[112:113], v[112:113], v[14:15]
    v_pk_add_f32 v[114:115], v[114:115], v[14:15]
    v_rcp_f32 v108, v108
    v_rcp_f32 v109, v109
    v_rcp_f32 v110, v110
    v_rcp_f32 v111, v111
    v_rcp_f32 v112, v112
    v_rcp_f32 v113, v113
    v_rcp_f32 v114, v114
    v_rcp_f32 v115, v115
    v_pk_mul_f32 v[40:41], v[40:41], v[108:109]
    v_pk_mul_f32 v[42:43], v[42:43], v[110:111]
    v_pk_mul_f32 v[56:57], v[56:57], v[112:113]
    v_pk_mul_f32 v[58:59], v[58:59], v[114:115]
    v_cvt_pk_bf16_f32 v100, v40, v41
    v_cvt_pk_bf16_f32 v101, v42, v43
    v_cvt_pk_bf16_f32 v102, v56, v57
    v_cvt_pk_bf16_f32 v103, v58, v59
    s_nop 1
    v_permlane16_swap_b32 v100, v102
    v_permlane16_swap_b32 v101, v103
    buffer_store_dwordx4 v[100:103], v9, s[16:19], s55 offen offset:0 sc1
    v_pk_mul_f32 v[108:109], v[72:73], v[72:73]
    v_pk_mul_f32 v[110:111], v[74:75], v[74:75]
    v_pk_mul_f32 v[112:113], v[88:89], v[88:89]
    v_pk_mul_f32 v[114:115], v[90:91], v[90:91]
    v_pk_fma_f32 v[108:109], v[108:109], v[10:11], v[12:13]
    v_pk_fma_f32 v[110:111], v[110:111], v[10:11], v[12:13]
    v_pk_fma_f32 v[112:113], v[112:113], v[10:11], v[12:13]
    v_pk_fma_f32 v[114:115], v[114:115], v[10:11], v[12:13]
    v_pk_mul_f32 v[108:109], v[108:109], v[72:73]
    v_pk_mul_f32 v[110:111], v[110:111], v[74:75]
    v_pk_mul_f32 v[112:113], v[112:113], v[88:89]
    v_pk_mul_f32 v[114:115], v[114:115], v[90:91]
    v_exp_f32 v108, v108
    v_exp_f32 v109, v109
    v_exp_f32 v110, v110
    v_exp_f32 v111, v111
    v_exp_f32 v112, v112
    v_exp_f32 v113, v113
    v_exp_f32 v114, v114
    v_exp_f32 v115, v115
    v_pk_add_f32 v[108:109], v[108:109], v[14:15]
    v_pk_add_f32 v[110:111], v[110:111], v[14:15]
    v_pk_add_f32 v[112:113], v[112:113], v[14:15]
    v_pk_add_f32 v[114:115], v[114:115], v[14:15]
    v_rcp_f32 v108, v108
    v_rcp_f32 v109, v109
    v_rcp_f32 v110, v110
    v_rcp_f32 v111, v111
    v_rcp_f32 v112, v112
    v_rcp_f32 v113, v113
    v_rcp_f32 v114, v114
    v_rcp_f32 v115, v115
    v_pk_mul_f32 v[72:73], v[72:73], v[108:109]
    v_pk_mul_f32 v[74:75], v[74:75], v[110:111]
    v_pk_mul_f32 v[88:89], v[88:89], v[112:113]
    v_pk_mul_f32 v[90:91], v[90:91], v[114:115]
    v_cvt_pk_bf16_f32 v104, v72, v73
    v_cvt_pk_bf16_f32 v105, v74, v75
    v_cvt_pk_bf16_f32 v106, v88, v89
    v_cvt_pk_bf16_f32 v107, v90, v91
    s_nop 1
    v_permlane16_swap_b32 v104, v106
    v_permlane16_swap_b32 v105, v107
    buffer_store_dwordx4 v[104:107], v9, s[16:19], s55 offen offset:64 sc1
    s_cmp_ge_u32 s24, 14
    s_cselect_b32 s40, 25, 24
    s_lshl_b32 s41, s25, 1
    s_add_u32 s40, s40, s41
    s_lshl_b32 s40, s40, 8
    s_add_u32 s84, s4, 0x300000
    s_addc_u32 s85, s5, 0
    s_mov_b32 s86, 0x4000
    s_mov_b32 s87, 0x20000
    v_mov_b32 v3, s40
    v_mov_b32 v4, 1
    s_waitcnt vmcnt(0)
    s_barrier
    s_cmp_lg_u32 s28, 0
    s_cbranch_scc1 g3_cin
    s_mov_b64 exec, 1
    buffer_atomic_add v4, v3, s[84:87], 0 offen sc1
    s_mov_b64 exec, -1
g3_cin:
    s_branch g4_in
g3_spare:
    s_cmp_ge_u32 s2, 256
    s_cbranch_scc1 g3_done
    s_load_dwordx2 s[4:5], s[0:1], 80
    s_load_dwordx2 s[6:7], s[0:1], 48
    s_sub_u32 s3, s2, 224
    v_lshrrev_b32 v2, 6, v0
    v_lshlrev_b32 v1, 4, v0
    v_mov_b32 v8, -1
    v_mov_b32 v9, -1
    v_mov_b32 v10, -1
    v_mov_b32 v11, -1
    v_readfirstlane_b32 s28, v2
    s_lshl_b32 s13, s3, 17
    s_waitcnt lgkmcnt(0)
    s_add_u32 s4, s4, s97
    s_addc_u32 s5, s5, 0
    s_add_u32 s8, s4, 0x1d00000
    s_addc_u32 s9, s5, 0
    s_mov_b32 s10, 0x400000
    s_mov_b32 s11, 0x20000
    buffer_store_dwordx4 v[8:11], v1, s[8:11], s13 offen sc1
    s_add_u32 s13, s13, 8192
    buffer_store_dwordx4 v[8:11], v1, s[8:11], s13 offen sc1
    s_add_u32 s13, s13, 8192
    buffer_store_dwordx4 v[8:11], v1, s[8:11], s13 offen sc1
    s_add_u32 s13, s13, 8192
    buffer_store_dwordx4 v[8:11], v1, s[8:11], s13 offen sc1
    s_add_u32 s13, s13, 8192
    buffer_store_dwordx4 v[8:11], v1, s[8:11], s13 offen sc1
    s_add_u32 s13, s13, 8192
    buffer_store_dwordx4 v[8:11], v1, s[8:11], s13 offen sc1
    s_add_u32 s13, s13, 8192
    buffer_store_dwordx4 v[8:11], v1, s[8:11], s13 offen sc1
    s_add_u32 s13, s13, 8192
    buffer_store_dwordx4 v[8:11], v1, s[8:11], s13 offen sc1
    s_add_u32 s13, s13, 8192
    buffer_store_dwordx4 v[8:11], v1, s[8:11], s13 offen sc1
    s_add_u32 s13, s13, 8192
    buffer_store_dwordx4 v[8:11], v1, s[8:11], s13 offen sc1
    s_add_u32 s13, s13, 8192
    buffer_store_dwordx4 v[8:11], v1, s[8:11], s13 offen sc1
    s_add_u32 s13, s13, 8192
    buffer_store_dwordx4 v[8:11], v1, s[8:11], s13 offen sc1
    s_add_u32 s13, s13, 8192
    buffer_store_dwordx4 v[8:11], v1, s[8:11], s13 offen sc1
    s_add_u32 s13, s13, 8192
    buffer_store_dwordx4 v[8:11], v1, s[8:11], s13 offen sc1
    s_add_u32 s13, s13, 8192
    buffer_store_dwordx4 v[8:11], v1, s[8:11], s13 offen sc1
    s_add_u32 s13, s13, 8192
    buffer_store_dwordx4 v[8:11], v1, s[8:11], s13 offen sc1
    s_add_u32 s13, s13, 8192
    s_mov_b32 s40, 14336
    s_add_u32 s84, s4, 0x300000
    s_addc_u32 s85, s5, 0
    s_mov_b32 s86, 0x4000
    s_mov_b32 s87, 0x20000
    v_mov_b32 v3, s40
    v_mov_b32 v4, 1
    s_waitcnt vmcnt(0)
    s_barrier
    s_cmp_lg_u32 s28, 0
    s_cbranch_scc1 g3_spare_cin
    s_mov_b64 exec, 1
    buffer_atomic_add v4, v3, s[84:87], 0 offen sc1
    s_mov_b64 exec, -1
g3_spare_cin:
    s_cmp_lg_u32 s96, 0
    s_cbranch_scc1 g3_spare_end
    s_mov_b32 s8, s6
    s_mov_b32 s9, s7
    s_mov_b32 s10, 0xe00000
    s_mov_b32 s11, 0x20000
    s_cmp_ge_u32 s3, 16
    s_cselect_b32 s12, 3145728, 0
    s_lshl_b32 s3, s3, 18
    s_add_u32 s3, s3, s12
    s_mov_b32 s12, 4
g3_spare_loop:
    buffer_load_dwordx4 v[4:7], v1, s[8:11], s3 offen
    s_add_u32 s3, s3, 8192
    buffer_load_dwordx4 v[4:7], v1, s[8:11], s3 offen
    s_add_u32 s3, s3, 8192
    buffer_load_dwordx4 v[4:7], v1, s[8:11], s3 offen
    s_add_u32 s3, s3, 8192
    buffer_load_dwordx4 v[4:7], v1, s[8:11], s3 offen
    s_add_u32 s3, s3, 8192
    buffer_load_dwordx4 v[4:7], v1, s[8:11], s3 offen
    s_add_u32 s3, s3, 8192
    buffer_load_dwordx4 v[4:7], v1, s[8:11], s3 offen
    s_add_u32 s3, s3, 8192
    buffer_load_dwordx4 v[4:7], v1, s[8:11], s3 offen
    s_add_u32 s3, s3, 8192
    buffer_load_dwordx4 v[4:7], v1, s[8:11], s3 offen
    s_add_u32 s3, s3, 8192
    s_waitcnt vmcnt(8)
    s_sub_u32 s12, s12, 1
    s_cmp_lg_u32 s12, 0
    s_cbranch_scc1 g3_spare_loop
    s_waitcnt vmcnt(0)
g3_spare_end:
    s_branch g4_in
.p2align 6
g4_in:
    s_cmp_ge_u32 s2, 256
    s_cbranch_scc1 g4_done
    s_load_dwordx2 s[4:5], s[0:1], 80
    s_load_dwordx2 s[6:7], s[0:1], 64
    s_load_dwordx2 s[30:31], s[0:1], 48
    s_load_dwordx2 s[34:35], s[0:1], 56
    v_lshrrev_b32 v1, 6, v0
    v_and_b32 v2, 63, v0
    s_bfe_u32 s40, s2, 0x10001
    s_lshl_b32 s40, s40, 2
    s_bfe_u32 s41, s2, 0x20003
    s_add_u32 s24, s40, s41
    s_bfe_u32 s40, s2, 0x10002
    s_lshl_b32 s40, s40, 3
    s_lshr_b32 s42, s2, 5
    s_add_u32 s25, s40, s42
    s_and_b32 s91, s2, 1
    s_add_u32 s27, s41, s42
    s_lshl_b32 s92, s24, 4
    s_add_u32 s92, s92, s25
    s_mul_i32 s26, s91, 28
    s_cmp_eq_u32 s96, 0
    s_cselect_b32 s95, 3, 1
    v_readfirstlane_b32 s28, v1
    s_nop 0
    s_cmp_lt_u32 s28, 4
    s_cbranch_scc1 g4_compute
    s_sub_u32 s28, s28, 4
    s_mov_b32 s40, 8192
    v_lshrrev_b32 v3, 3, v2
    v_mul_lo_u32 v3, v3, s40
    v_lshrrev_b32 v4, 4, v2
    v_xor_b32 v4, v4, v2
    v_and_b32 v4, 7, v4
    v_lshl_add_u32 v3, v4, 4, v3
    s_mul_i32 s41, s24, 1048576
    s_mul_i32 s42, s28, 262144
    s_add_u32 s41, s41, s42
    v_xor_b32 v4, 64, v3
    s_add_u32 s42, s41, 0
    v_add_u32 v10, s42, v3
    s_add_u32 s42, s41, 65536
    v_add_u32 v11, s42, v4
    s_add_u32 s42, s41, 131072
    v_add_u32 v12, s42, v3
    s_add_u32 s42, s41, 196608
    v_add_u32 v13, s42, v4
    s_mov_b32 s40, 4096
    v_lshrrev_b32 v4, 4, v2
    v_mul_lo_u32 v3, v4, s40
    v_lshlrev_b32 v4, 1, v4
    v_xor_b32 v4, v4, v2
    v_and_b32 v4, 15, v4
    v_lshl_add_u32 v3, v4, 4, v3
    s_mul_i32 s41, s25, 256
    s_mul_i32 s42, s28, 65536
    s_add_u32 s41, s41, s42
    v_xor_b32 v4, 128, v3
    s_add_u32 s42, s41, 0
    v_add_u32 v14, s42, v3
    s_add_u32 s42, s41, 16384
    v_add_u32 v15, s42, v3
    s_add_u32 s42, s41, 32768
    v_add_u32 v16, s42, v4
    s_add_u32 s42, s41, 49152
    v_add_u32 v17, s42, v4
    s_mul_i32 s36, s28, 4096
    s_mul_i32 s37, s28, 4096
    s_add_u32 s37, s37, 16384
    s_waitcnt lgkmcnt(0)
    s_add_u32 s4, s4, s97
    s_addc_u32 s5, s5, 0
    s_add_u32 s8, s4, 0x1100000
    s_addc_u32 s9, s5, 0
    s_mov_b32 s10, 0x800000
    s_mov_b32 s11, 0x20000
    s_mov_b32 s12, s30
    s_mov_b32 s13, s31
    s_mov_b32 s14, 0xe00000
    s_mov_b32 s15, 0x20000
    s_mov_b32 s32, 0
    s_mov_b32 s33, 0
g4_ld_pW:
    s_add_u32 s40, s32, s27
    s_and_b32 s40, s40, s95
    s_andn2_b32 s41, s32, s95
    s_or_b32 s40, s40, s41
    s_add_u32 s40, s40, s26
    s_mul_i32 s34, s40, 128
    s_mul_i32 s35, s40, 262144
    s_add_u32 s38, s33, s36
    s_add_u32 s39, s33, s37
    s_add_u32 m0, s39, 0
    s_nop 0
    buffer_load_dwordx4 v14, s[12:15], s35 offen lds
    s_add_u32 m0, s39, 1024
    s_nop 0
    buffer_load_dwordx4 v15, s[12:15], s35 offen lds
    s_add_u32 m0, s39, 2048
    s_nop 0
    buffer_load_dwordx4 v16, s[12:15], s35 offen lds
    s_add_u32 m0, s39, 3072
    s_nop 0
    buffer_load_dwordx4 v17, s[12:15], s35 offen lds
    s_add_u32 s33, s33, 32768
    s_add_u32 s32, s32, 1
    s_cmp_lt_u32 s32, 3
    s_cbranch_scc1 g4_ld_pW
    s_lshl_b32 s40, s24, 1
    s_add_u32 s40, s40, s91
    s_add_u32 s40, s40, 24
    s_lshl_b32 s40, s40, 8
    s_mov_b32 s42, 14336
    s_add_u32 s84, s4, 0x300000
    s_addc_u32 s85, s5, 0
    s_mov_b32 s86, 0x4000
    s_mov_b32 s87, 0x20000
    v_cmp_eq_u32 vcc, 1, v2
    v_mov_b32 v21, s40
    v_mov_b32 v23, s42
    v_cndmask_b32 v21, v21, v23, vcc
    v_mov_b32 v22, 14
    v_mov_b32 v23, 32
    v_cndmask_b32 v22, v22, v23, vcc
    s_mov_b32 s41, 0x8000
g4_dep:
    buffer_load_dword v23, v21, s[84:87], 0 offen sc1
    s_sub_u32 s41, s41, 1
    s_waitcnt vmcnt(0)
    v_cmp_lt_u32 vcc, v23, v22
    s_cmp_eq_u32 s41, 0
    s_cbranch_scc1 g4_dep_ok
    s_cbranch_vccz g4_dep_ok
    s_sleep 2
    s_branch g4_dep
g4_dep_ok:
    s_mov_b32 s32, 0
    s_mov_b32 s33, 0
g4_ld_pA:
    s_add_u32 s40, s32, s27
    s_and_b32 s40, s40, s95
    s_andn2_b32 s41, s32, s95
    s_or_b32 s40, s40, s41
    s_add_u32 s40, s40, s26
    s_mul_i32 s34, s40, 128
    s_mul_i32 s35, s40, 262144
    s_add_u32 s38, s33, s36
    s_add_u32 s39, s33, s37
    s_add_u32 m0, s38, 0
    s_nop 0
    buffer_load_dwordx4 v10, s[8:11], s34 offen lds
    s_add_u32 m0, s38, 1024
    s_nop 0
    buffer_load_dwordx4 v11, s[8:11], s34 offen lds
    s_add_u32 m0, s38, 2048
    s_nop 0
    buffer_load_dwordx4 v12, s[8:11], s34 offen lds
    s_add_u32 m0, s38, 3072
    s_nop 0
    buffer_load_dwordx4 v13, s[8:11], s34 offen lds
    s_add_u32 s33, s33, 32768
    s_add_u32 s32, s32, 1
    s_cmp_lt_u32 s32, 3
    s_cbranch_scc1 g4_ld_pA
    s_waitcnt vmcnt(8)
    s_branch g4_ld_bar
g4_ld_loop:
    s_cmp_eq_u32 s32, 4
    s_cbranch_scc1 g4_ld_s4
    s_waitcnt vmcnt(16)
g4_ld_bar:
    s_barrier
    s_add_u32 s40, s32, s27
    s_and_b32 s40, s40, s95
    s_andn2_b32 s41, s32, s95
    s_or_b32 s40, s40, s41
    s_add_u32 s40, s40, s26
    s_mul_i32 s34, s40, 128
    s_mul_i32 s35, s40, 262144
    s_add_u32 s38, s33, s36
    s_add_u32 s39, s33, s37
    s_add_u32 m0, s38, 0
    s_nop 0
    buffer_load_dwordx4 v10, s[8:11], s34 offen lds
    s_add_u32 m0, s38, 1024
    s_nop 0
    buffer_load_dwordx4 v11, s[8:11], s34 offen lds
    s_add_u32 m0, s38, 2048
    s_nop 0
    buffer_load_dwordx4 v12, s[8:11], s34 offen lds
    s_add_u32 m0, s38, 3072
    s_nop 0
    buffer_load_dwordx4 v13, s[8:11], s34 offen lds
    s_add_u32 m0, s39, 0
    s_nop 0
    buffer_load_dwordx4 v14, s[12:15], s35 offen lds
    s_add_u32 m0, s39, 1024
    s_nop 0
    buffer_load_dwordx4 v15, s[12:15], s35 offen lds
    s_add_u32 m0, s39, 2048
    s_nop 0
    buffer_load_dwordx4 v16, s[12:15], s35 offen lds
    s_add_u32 m0, s39, 3072
    s_nop 0
    buffer_load_dwordx4 v17, s[12:15], s35 offen lds
    s_add_u32 s33, s33, 32768
    s_add_u32 s32, s32, 1
    s_cmp_eq_u32 s33, 131072
    s_cselect_b32 s33, 0, s33
    s_cmp_lt_u32 s32, 28
    s_cbranch_scc1 g4_ld_loop
    s_waitcnt vmcnt(16)
    s_barrier
    s_waitcnt vmcnt(8)
    s_barrier
    s_waitcnt vmcnt(0)
    s_barrier
    s_branch g4_ld_end
g4_ld_s4:
    s_waitcnt vmcnt(12)
    s_branch g4_ld_bar
g4_ld_end:
    s_cmp_lg_u32 s96, 0
    s_cbranch_scc1 g4_done
    s_barrier
    s_mov_b32 s96, 1
    s_mov_b32 s97, 0x2800000
    s_branch g1_in
g4_done:
    s_endpgm
g4_compute:
    v_lshrrev_b32 v5, 4, v2
    v_bfe_u32 v6, v2, 2, 2
    v_and_b32 v7, 3, v2
    v_and_b32 v8, 15, v2
    s_and_b32 s44, s28, 1
    s_lshr_b32 s45, s28, 1
    s_mul_i32 s40, s25, 128
    s_mul_i32 s41, s45, 64
    s_add_u32 s40, s40, s41
    s_lshl_b32 s41, s91, 5
    s_add_u32 s40, s40, s41
    v_add_u32 v20, s40, v8
    s_mov_b32 s41, 2048
    v_mul_lo_u32 v9, v20, s41
    s_mul_i32 s40, s24, 256
    s_mul_i32 s41, s44, 128
    s_add_u32 s46, s40, s41
    v_and_b32 v3, 1, v5
    v_lshlrev_b32 v3, 5, v3
    v_lshrrev_b32 v4, 1, v5
    v_lshl_add_u32 v3, v4, 4, v3
    v_add3_u32 v9, v9, v3, s46
    s_mov_b32 s52, 0
    s_mov_b32 s53, 32768
    s_mov_b32 s54, 65536
    s_mov_b32 s55, 98304
    s_waitcnt lgkmcnt(0)
    s_add_u32 s4, s4, s97
    s_addc_u32 s5, s5, 0
    s_add_u32 s20, s4, 0x800000
    s_addc_u32 s21, s5, 0
    s_mov_b32 s22, 0x400000
    s_mov_b32 s23, 0x20000
    s_mov_b32 s56, s34
    s_mov_b32 s57, s35
    s_mov_b32 s58, 0x1000
    s_mov_b32 s59, 0x20000
    s_add_u32 s16, s4, 0x4100000
    s_addc_u32 s17, s5, 0
    s_cmp_eq_u32 s96, 0
    s_cselect_b32 s16, s16, s6
    s_cselect_b32 s17, s17, s7
    s_mov_b32 s18, 0x400000
    s_mov_b32 s19, 0x20000
    s_add_u32 s60, s4, 0x2800000
    s_addc_u32 s61, s5, 0
    s_mov_b32 s62, 0x40000
    s_mov_b32 s63, 0x20000
    s_add_u32 s84, s4, 0x1d00000
    s_addc_u32 s85, s5, 0
    s_mov_b32 s86, 0x400000
    s_mov_b32 s87, 0x20000
    s_mul_i32 s42, s44, 64
    v_lshrrev_b32 v3, 1, v8
    v_xor_b32 v3, v3, v5
    v_lshlrev_b32 v3, 4, v3
    v_lshl_add_u32 v3, v8, 7, v3
    s_lshl_b32 s40, s42, 7
    s_add_u32 s40, s40, 0
    v_add_u32 v10, s40, v3
    v_xor_b32 v11, 64, v10
    s_lshl_b32 s90, s91, 1
    s_mul_i32 s42, s45, 4
    s_mov_b32 s43, 16384
    v_and_b32 v3, 1, v5
    v_lshl_or_b32 v3, v3, 2, v6
    s_add_u32 s40, s42, 0
    s_xor_b32 s40, s40, s90
    v_xor_b32 v3, s40, v3
    v_lshlrev_b32 v3, 5, v3
    v_lshl_add_u32 v3, v7, 3, v3
    v_lshl_add_u32 v4, v5, 3, v6
    v_lshl_add_u32 v3, v4, 8, v3
    v_add_u32 v12, s43, v3
    v_and_b32 v3, 1, v5
    v_lshl_or_b32 v3, v3, 2, v6
    s_add_u32 s40, s42, 1
    s_xor_b32 s40, s40, s90
    v_xor_b32 v3, s40, v3
    v_lshlrev_b32 v3, 5, v3
    v_lshl_add_u32 v3, v7, 3, v3
    v_lshl_add_u32 v4, v5, 3, v6
    v_lshl_add_u32 v3, v4, 8, v3
    v_add_u32 v13, s43, v3
    v_and_b32 v3, 1, v5
    v_lshl_or_b32 v3, v3, 2, v6
    s_add_u32 s40, s42, 2
    s_xor_b32 s40, s40, s90
    v_xor_b32 v3, s40, v3
    v_lshlrev_b32 v3, 5, v3
    v_lshl_add_u32 v3, v7, 3, v3
    v_lshl_add_u32 v4, v5, 3, v6
    v_lshl_add_u32 v3, v4, 8, v3
    v_add_u32 v14, s43, v3
    v_and_b32 v3, 1, v5
    v_lshl_or_b32 v3, v3, 2, v6
    s_add_u32 s40, s42, 3
    s_xor_b32 s40, s40, s90
    v_xor_b32 v3, s40, v3
    v_lshlrev_b32 v3, 5, v3
    v_lshl_add_u32 v3, v7, 3, v3
    v_lshl_add_u32 v4, v5, 3, v6
    v_lshl_add_u32 v3, v4, 8, v3
    v_add_u32 v15, s43, v3
    v_mov_b32 v124, 0
    v_mov_b32 v125, 0
    v_mov_b32 v126, 0
    v_mov_b32 v127, 0
    v_mov_b32 v128, 0
    v_mov_b32 v129, 0
    v_mov_b32 v130, 0
    v_mov_b32 v131, 0
    v_mov_b32 v132, 0
    v_mov_b32 v133, 0
    v_mov_b32 v134, 0
    v_mov_b32 v135, 0
    v_mov_b32 v136, 0
    v_mov_b32 v137, 0
    v_mov_b32 v138, 0
    v_mov_b32 v139, 0
    v_mov_b32 v140, 0
    v_mov_b32 v141, 0
    v_mov_b32 v142, 0
    v_mov_b32 v143, 0
    v_mov_b32 v144, 0
    v_mov_b32 v145, 0
    v_mov_b32 v146, 0
    v_mov_b32 v147, 0
    v_mov_b32 v148, 0
    v_mov_b32 v149, 0
    v_mov_b32 v150, 0
    v_mov_b32 v151, 0
    v_mov_b32 v152, 0
    v_mov_b32 v153, 0
    v_mov_b32 v154, 0
    v_mov_b32 v155, 0
    s_mov_b32 s48, 28
    s_mov_b32 s50, 0
    s_mov_b32 s51, 32768
    s_mov_b32 s29, 0xfffe8000
    s_lshl_b32 s40, s28, 12
    v_lshl_add_u32 v21, v2, 4, s40
    s_lshl_b32 s93, s92, 1
    s_add_u32 s93, s93, s91
    s_lshl_b32 s93, s93, 14
    s_xor_b32 s94, s93, 0x4000
    v_mov_b32 v28, 0
    v_mov_b32 v29, 0
    v_mov_b32 v30, 0
    v_mov_b32 v31, 0
    v_mov_b32 v32, 0
    v_mov_b32 v33, 0
    v_mov_b32 v34, 0
    v_mov_b32 v35, 0
    v_mov_b32 v36, 0
    v_mov_b32 v37, 0
    v_mov_b32 v38, 0
    v_mov_b32 v39, 0
    v_mov_b32 v40, 0
    v_mov_b32 v41, 0
    v_mov_b32 v42, 0
    v_mov_b32 v43, 0
    v_mov_b32 v44, 0
    v_mov_b32 v45, 0
    v_mov_b32 v46, 0
    v_mov_b32 v47, 0
    v_mov_b32 v48, 0
    v_mov_b32 v49, 0
    v_mov_b32 v50, 0
    v_mov_b32 v51, 0
    v_mov_b32 v52, 0
    v_mov_b32 v53, 0
    v_mov_b32 v54, 0
    v_mov_b32 v55, 0
    v_mov_b32 v56, 0
    v_mov_b32 v57, 0
    v_mov_b32 v58, 0
    v_mov_b32 v59, 0
    v_mov_b32 v60, 0
    v_mov_b32 v61, 0
    v_mov_b32 v62, 0
    v_mov_b32 v63, 0
    v_mov_b32 v64, 0
    v_mov_b32 v65, 0
    v_mov_b32 v66, 0
    v_mov_b32 v67, 0
    v_mov_b32 v68, 0
    v_mov_b32 v69, 0
    v_mov_b32 v70, 0
    v_mov_b32 v71, 0
    v_mov_b32 v72, 0
    v_mov_b32 v73, 0
    v_mov_b32 v74, 0
    v_mov_b32 v75, 0
    v_mov_b32 v76, 0
    v_mov_b32 v77, 0
    v_mov_b32 v78, 0
    v_mov_b32 v79, 0
    v_mov_b32 v80, 0
    v_mov_b32 v81, 0
    v_mov_b32 v82, 0
    v_mov_b32 v83, 0
    v_mov_b32 v84, 0
    v_mov_b32 v85, 0
    v_mov_b32 v86, 0
    v_mov_b32 v87, 0
    v_mov_b32 v88, 0
    v_mov_b32 v89, 0
    v_mov_b32 v90, 0
    v_mov_b32 v91, 0
    s_barrier
    buffer_load_dwordx4 v[188:191], v9, s[20:23], s52 offen offset:0
    buffer_load_dwordx4 v[192:195], v9, s[20:23], s52 offen offset:64
    buffer_load_dwordx4 v[196:199], v9, s[20:23], s53 offen offset:0
    buffer_load_dwordx4 v[200:203], v9, s[20:23], s53 offen offset:64
    v_lshlrev_b32 v3, 1, v20
    buffer_load_ushort v22, v3, s[56:59], 0 offen offset:0
    buffer_load_ushort v23, v3, s[56:59], 0 offen offset:32
    s_branch g4_cloop2
.p2align 3
g4_cloop:
    s_barrier
g4_cloop2:
    v_mfma_f32_16x16x32_bf16 v[28:31], v[124:127], v[140:143], v[28:31]
    ds_read_b128 v[92:95], v10 offset:0
    v_mfma_f32_16x16x32_bf16 v[32:35], v[124:127], v[144:147], v[32:35]
    ds_read_b64_tr_b16 v[108:109], v12 offset:0
    ds_read_b64_tr_b16 v[110:111], v12 offset:1024
    v_mfma_f32_16x16x32_bf16 v[36:39], v[124:127], v[148:151], v[36:39]
    ds_read_b64_tr_b16 v[112:113], v13 offset:0
    ds_read_b64_tr_b16 v[114:115], v13 offset:1024
    v_mfma_f32_16x16x32_bf16 v[40:43], v[124:127], v[152:155], v[40:43]
    ds_read_b64_tr_b16 v[116:117], v14 offset:0
    ds_read_b64_tr_b16 v[118:119], v14 offset:1024
    v_mfma_f32_16x16x32_bf16 v[44:47], v[128:131], v[140:143], v[44:47]
    ds_read_b64_tr_b16 v[120:121], v15 offset:0
    ds_read_b64_tr_b16 v[122:123], v15 offset:1024
    v_mfma_f32_16x16x32_bf16 v[48:51], v[128:131], v[144:147], v[48:51]
    ds_read_b128 v[96:99], v10 offset:2048
    v_mfma_f32_16x16x32_bf16 v[52:55], v[128:131], v[148:151], v[52:55]
    ds_read_b128 v[100:103], v10 offset:4096
    v_mfma_f32_16x16x32_bf16 v[56:59], v[128:131], v[152:155], v[56:59]
    ds_read_b128 v[104:107], v10 offset:6144
    v_mfma_f32_16x16x32_bf16 v[60:63], v[132:135], v[140:143], v[60:63]
    v_mfma_f32_16x16x32_bf16 v[64:67], v[132:135], v[144:147], v[64:67]
    v_mfma_f32_16x16x32_bf16 v[68:71], v[132:135], v[148:151], v[68:71]
    v_mfma_f32_16x16x32_bf16 v[72:75], v[132:135], v[152:155], v[72:75]
    v_mfma_f32_16x16x32_bf16 v[76:79], v[136:139], v[140:143], v[76:79]
    v_mfma_f32_16x16x32_bf16 v[80:83], v[136:139], v[144:147], v[80:83]
    v_mfma_f32_16x16x32_bf16 v[84:87], v[136:139], v[148:151], v[84:87]
    v_mfma_f32_16x16x32_bf16 v[88:91], v[136:139], v[152:155], v[88:91]
    s_waitcnt lgkmcnt(0)
    v_mfma_f32_16x16x32_bf16 v[28:31], v[92:95], v[108:111], v[28:31]
    ds_read_b128 v[124:127], v11 offset:0
    v_mfma_f32_16x16x32_bf16 v[32:35], v[92:95], v[112:115], v[32:35]
    ds_read_b64_tr_b16 v[140:141], v12 offset:8192
    ds_read_b64_tr_b16 v[142:143], v12 offset:9216
    v_mfma_f32_16x16x32_bf16 v[36:39], v[92:95], v[116:119], v[36:39]
    ds_read_b64_tr_b16 v[144:145], v13 offset:8192
    ds_read_b64_tr_b16 v[146:147], v13 offset:9216
    v_mfma_f32_16x16x32_bf16 v[40:43], v[92:95], v[120:123], v[40:43]
    ds_read_b64_tr_b16 v[148:149], v14 offset:8192
    ds_read_b64_tr_b16 v[150:151], v14 offset:9216
    v_mfma_f32_16x16x32_bf16 v[44:47], v[96:99], v[108:111], v[44:47]
    ds_read_b64_tr_b16 v[152:153], v15 offset:8192
    ds_read_b64_tr_b16 v[154:155], v15 offset:9216
    v_mfma_f32_16x16x32_bf16 v[48:51], v[96:99], v[112:115], v[48:51]
    ds_read_b128 v[128:131], v11 offset:2048
    v_mfma_f32_16x16x32_bf16 v[52:55], v[96:99], v[116:119], v[52:55]
    ds_read_b128 v[132:135], v11 offset:4096
    v_mfma_f32_16x16x32_bf16 v[56:59], v[96:99], v[120:123], v[56:59]
    ds_read_b128 v[136:139], v11 offset:6144
    v_mfma_f32_16x16x32_bf16 v[60:63], v[100:103], v[108:111], v[60:63]
    s_add_u32 s50, s50, 1
    s_cmp_eq_u32 s50, 4
    v_mfma_f32_16x16x32_bf16 v[64:67], v[100:103], v[112:115], v[64:67]
    s_cselect_b32 s49, s29, s51
    s_cselect_b32 s50, 0, s50
    v_mfma_f32_16x16x32_bf16 v[68:71], v[100:103], v[116:119], v[68:71]
    v_add_u32 v10, s49, v10
    v_add_u32 v11, s49, v11
    v_mfma_f32_16x16x32_bf16 v[72:75], v[100:103], v[120:123], v[72:75]
    v_add_u32 v12, s49, v12
    v_add_u32 v13, s49, v13
    v_mfma_f32_16x16x32_bf16 v[76:79], v[104:107], v[108:111], v[76:79]
    v_add_u32 v14, s49, v14
    v_add_u32 v15, s49, v15
    v_mfma_f32_16x16x32_bf16 v[80:83], v[104:107], v[112:115], v[80:83]
    s_sub_u32 s48, s48, 1
    s_cmp_lg_u32 s48, 0
    v_mfma_f32_16x16x32_bf16 v[84:87], v[104:107], v[116:119], v[84:87]
    v_mfma_f32_16x16x32_bf16 v[88:91], v[104:107], v[120:123], v[88:91]
    s_waitcnt lgkmcnt(0)
    s_cbranch_scc1 g4_cloop
    v_mfma_f32_16x16x32_bf16 v[28:31], v[124:127], v[140:143], v[28:31]
    v_mfma_f32_16x16x32_bf16 v[32:35], v[124:127], v[144:147], v[32:35]
    v_mfma_f32_16x16x32_bf16 v[36:39], v[124:127], v[148:151], v[36:39]
    v_mfma_f32_16x16x32_bf16 v[40:43], v[124:127], v[152:155], v[40:43]
    v_mfma_f32_16x16x32_bf16 v[44:47], v[128:131], v[140:143], v[44:47]
    v_mfma_f32_16x16x32_bf16 v[48:51], v[128:131], v[144:147], v[48:51]
    v_mfma_f32_16x16x32_bf16 v[52:55], v[128:131], v[148:151], v[52:55]
    v_mfma_f32_16x16x32_bf16 v[56:59], v[128:131], v[152:155], v[56:59]
    v_mfma_f32_16x16x32_bf16 v[60:63], v[132:135], v[140:143], v[60:63]
    v_mfma_f32_16x16x32_bf16 v[64:67], v[132:135], v[144:147], v[64:67]
    v_mfma_f32_16x16x32_bf16 v[68:71], v[132:135], v[148:151], v[68:71]
    v_mfma_f32_16x16x32_bf16 v[72:75], v[132:135], v[152:155], v[72:75]
    v_mfma_f32_16x16x32_bf16 v[76:79], v[136:139], v[140:143], v[76:79]
    v_mfma_f32_16x16x32_bf16 v[80:83], v[136:139], v[144:147], v[80:83]
    v_mfma_f32_16x16x32_bf16 v[84:87], v[136:139], v[148:151], v[84:87]
    v_mfma_f32_16x16x32_bf16 v[88:91], v[136:139], v[152:155], v[88:91]
    v_cvt_pk_bf16_f32 v156, v36, v37
    v_cvt_pk_bf16_f32 v157, v38, v39
    v_cvt_pk_bf16_f32 v158, v52, v53
    v_cvt_pk_bf16_f32 v159, v54, v55
    buffer_store_dwordx4 v[156:159], v21, s[84:87], s93 offen offset:0 sc1
    v_cvt_pk_bf16_f32 v160, v68, v69
    v_cvt_pk_bf16_f32 v161, v70, v71
    v_cvt_pk_bf16_f32 v162, v84, v85
    v_cvt_pk_bf16_f32 v163, v86, v87
    buffer_store_dwordx4 v[160:163], v21, s[84:87], s93 offen offset:1024 sc1
    v_cvt_pk_bf16_f32 v164, v40, v41
    v_cvt_pk_bf16_f32 v165, v42, v43
    v_cvt_pk_bf16_f32 v166, v56, v57
    v_cvt_pk_bf16_f32 v167, v58, v59
    buffer_store_dwordx4 v[164:167], v21, s[84:87], s93 offen offset:2048 sc1
    v_cvt_pk_bf16_f32 v168, v72, v73
    v_cvt_pk_bf16_f32 v169, v74, v75
    s_nop 3
    v_cvt_pk_bf16_f32 v170, v88, v89
    v_cvt_pk_bf16_f32 v171, v90, v91
    buffer_store_dwordx4 v[168:171], v21, s[84:87], s93 offen offset:3072 sc1
    s_mov_b32 s48, 0x2000
    buffer_load_dwordx4 v[172:175], v21, s[84:87], s94 offen offset:0 sc1
    buffer_load_dwordx4 v[176:179], v21, s[84:87], s94 offen offset:1024 sc1
    buffer_load_dwordx4 v[180:183], v21, s[84:87], s94 offen offset:2048 sc1
    buffer_load_dwordx4 v[184:187], v21, s[84:87], s94 offen offset:3072 sc1
    s_waitcnt vmcnt(8)
    v_permlane16_swap_b32 v188, v190
    v_permlane16_swap_b32 v189, v191
    v_permlane16_swap_b32 v192, v194
    v_permlane16_swap_b32 v193, v195
    v_permlane16_swap_b32 v196, v198
    v_permlane16_swap_b32 v197, v199
    v_permlane16_swap_b32 v200, v202
    v_permlane16_swap_b32 v201, v203
    v_lshlrev_b32 v22, 16, v22
    v_lshlrev_b32 v23, 16, v23
    v_lshlrev_b32 v204, 16, v188
    v_and_b32 v205, 0xffff0000, v188
    v_lshlrev_b32 v206, 16, v189
    v_and_b32 v207, 0xffff0000, v189
    v_lshlrev_b32 v208, 16, v190
    v_and_b32 v209, 0xffff0000, v190
    v_lshlrev_b32 v210, 16, v191
    v_and_b32 v211, 0xffff0000, v191
    v_add_f32 v204, v204, v22
    v_add_f32 v205, v205, v22
    v_add_f32 v206, v206, v22
    v_add_f32 v207, v207, v22
    v_add_f32 v208, v208, v22
    v_add_f32 v209, v209, v22
    v_add_f32 v210, v210, v22
    v_add_f32 v211, v211, v22
    v_pk_add_f32 v[28:29], v[28:29], v[204:205]
    v_pk_add_f32 v[30:31], v[30:31], v[206:207]
    v_pk_add_f32 v[44:45], v[44:45], v[208:209]
    v_pk_add_f32 v[46:47], v[46:47], v[210:211]
    v_lshlrev_b32 v204, 16, v192
    v_and_b32 v205, 0xffff0000, v192
    v_lshlrev_b32 v206, 16, v193
    v_and_b32 v207, 0xffff0000, v193
    v_lshlrev_b32 v208, 16, v194
    v_and_b32 v209, 0xffff0000, v194
    v_lshlrev_b32 v210, 16, v195
    v_and_b32 v211, 0xffff0000, v195
    v_add_f32 v204, v204, v22
    v_add_f32 v205, v205, v22
    v_add_f32 v206, v206, v22
    v_add_f32 v207, v207, v22
    v_add_f32 v208, v208, v22
    v_add_f32 v209, v209, v22
    v_add_f32 v210, v210, v22
    v_add_f32 v211, v211, v22
    v_pk_add_f32 v[60:61], v[60:61], v[204:205]
    v_pk_add_f32 v[62:63], v[62:63], v[206:207]
    v_pk_add_f32 v[76:77], v[76:77], v[208:209]
    v_pk_add_f32 v[78:79], v[78:79], v[210:211]
    v_lshlrev_b32 v204, 16, v196
    v_and_b32 v205, 0xffff0000, v196
    v_lshlrev_b32 v206, 16, v197
    v_and_b32 v207, 0xffff0000, v197
    v_lshlrev_b32 v208, 16, v198
    v_and_b32 v209, 0xffff0000, v198
    v_lshlrev_b32 v210, 16, v199
    v_and_b32 v211, 0xffff0000, v199
    v_add_f32 v204, v204, v23
    v_add_f32 v205, v205, v23
    v_add_f32 v206, v206, v23
    v_add_f32 v207, v207, v23
    v_add_f32 v208, v208, v23
    v_add_f32 v209, v209, v23
    v_add_f32 v210, v210, v23
    v_add_f32 v211, v211, v23
    v_pk_add_f32 v[32:33], v[32:33], v[204:205]
    v_pk_add_f32 v[34:35], v[34:35], v[206:207]
    v_pk_add_f32 v[48:49], v[48:49], v[208:209]
    v_pk_add_f32 v[50:51], v[50:51], v[210:211]
    v_lshlrev_b32 v204, 16, v200
    v_and_b32 v205, 0xffff0000, v200
    v_lshlrev_b32 v206, 16, v201
    v_and_b32 v207, 0xffff0000, v201
    v_lshlrev_b32 v208, 16, v202
    v_and_b32 v209, 0xffff0000, v202
    v_lshlrev_b32 v210, 16, v203
    v_and_b32 v211, 0xffff0000, v203
    v_add_f32 v204, v204, v23
    v_add_f32 v205, v205, v23
    v_add_f32 v206, v206, v23
    v_add_f32 v207, v207, v23
    v_add_f32 v208, v208, v23
    v_add_f32 v209, v209, v23
    v_add_f32 v210, v210, v23
    v_add_f32 v211, v211, v23
    v_pk_add_f32 v[64:65], v[64:65], v[204:205]
    v_pk_add_f32 v[66:67], v[66:67], v[206:207]
    v_pk_add_f32 v[80:81], v[80:81], v[208:209]
    v_pk_add_f32 v[82:83], v[82:83], v[210:211]
    s_waitcnt vmcnt(0)
g4_rcv:
    v_max3_u32 v4, v172, v173, v174
    v_max3_u32 v4, v4, v175, v176
    v_max3_u32 v4, v4, v177, v178
    v_max3_u32 v4, v4, v179, v180
    v_max3_u32 v4, v4, v181, v182
    v_max3_u32 v4, v4, v183, v184
    v_max3_u32 v4, v4, v185, v186
    v_max_u32 v4, v4, v187
    v_cmp_eq_u32 vcc, -1, v4
    s_sub_u32 s48, s48, 1
    s_cmp_eq_u32 s48, 0
    s_cbranch_scc1 g4_rcvd
    s_cbranch_vccz g4_rcvd
    s_sleep 2
    buffer_load_dwordx4 v[172:175], v21, s[84:87], s94 offen offset:0 sc1
    buffer_load_dwordx4 v[176:179], v21, s[84:87], s94 offen offset:1024 sc1
    buffer_load_dwordx4 v[180:183], v21, s[84:87], s94 offen offset:2048 sc1
    buffer_load_dwordx4 v[184:187], v21, s[84:87], s94 offen offset:3072 sc1
    s_waitcnt vmcnt(0)
    s_branch g4_rcv
g4_rcvd:
    v_lshlrev_b32 v108, 16, v172
    v_and_b32 v109, 0xffff0000, v172
    v_lshlrev_b32 v110, 16, v173
    v_and_b32 v111, 0xffff0000, v173
    v_pk_add_f32 v[28:29], v[28:29], v[108:109]
    v_pk_add_f32 v[30:31], v[30:31], v[110:111]
    v_lshlrev_b32 v112, 16, v174
    v_and_b32 v113, 0xffff0000, v174
    v_lshlrev_b32 v114, 16, v175
    v_and_b32 v115, 0xffff0000, v175
    v_pk_add_f32 v[44:45], v[44:45], v[112:113]
    v_pk_add_f32 v[46:47], v[46:47], v[114:115]
    v_lshlrev_b32 v116, 16, v176
    v_and_b32 v117, 0xffff0000, v176
    v_lshlrev_b32 v118, 16, v177
    v_and_b32 v119, 0xffff0000, v177
    v_pk_add_f32 v[60:61], v[60:61], v[116:117]
    v_pk_add_f32 v[62:63], v[62:63], v[118:119]
    v_lshlrev_b32 v120, 16, v178
    v_and_b32 v121, 0xffff0000, v178
    v_lshlrev_b32 v122, 16, v179
    v_and_b32 v123, 0xffff0000, v179
    v_pk_add_f32 v[76:77], v[76:77], v[120:121]
    v_pk_add_f32 v[78:79], v[78:79], v[122:123]
    v_lshlrev_b32 v108, 16, v180
    v_and_b32 v109, 0xffff0000, v180
    v_lshlrev_b32 v110, 16, v181
    v_and_b32 v111, 0xffff0000, v181
    v_pk_add_f32 v[32:33], v[32:33], v[108:109]
    v_pk_add_f32 v[34:35], v[34:35], v[110:111]
    v_lshlrev_b32 v112, 16, v182
    v_and_b32 v113, 0xffff0000, v182
    v_lshlrev_b32 v114, 16, v183
    v_and_b32 v115, 0xffff0000, v183
    v_pk_add_f32 v[48:49], v[48:49], v[112:113]
    v_pk_add_f32 v[50:51], v[50:51], v[114:115]
    v_lshlrev_b32 v116, 16, v184
    v_and_b32 v117, 0xffff0000, v184
    v_lshlrev_b32 v118, 16, v185
    v_and_b32 v119, 0xffff0000, v185
    v_pk_add_f32 v[64:65], v[64:65], v[116:117]
    v_pk_add_f32 v[66:67], v[66:67], v[118:119]
    v_lshlrev_b32 v120, 16, v186
    v_and_b32 v121, 0xffff0000, v186
    v_lshlrev_b32 v122, 16, v187
    v_and_b32 v123, 0xffff0000, v187
    v_pk_add_f32 v[80:81], v[80:81], v[120:121]
    v_pk_add_f32 v[82:83], v[82:83], v[122:123]
    s_nop 7
    v_cvt_pk_bf16_f32 v92, v28, v29
    v_cvt_pk_bf16_f32 v93, v30, v31
    v_cvt_pk_bf16_f32 v94, v44, v45
    v_cvt_pk_bf16_f32 v95, v46, v47
    s_nop 1
    v_permlane16_swap_b32 v92, v94
    v_permlane16_swap_b32 v93, v95
    buffer_store_dwordx4 v[92:95], v9, s[16:19], s52 offen offset:0 sc1
    v_cvt_pk_bf16_f32 v96, v60, v61
    v_cvt_pk_bf16_f32 v97, v62, v63
    v_cvt_pk_bf16_f32 v98, v76, v77
    v_cvt_pk_bf16_f32 v99, v78, v79
    s_nop 1
    v_permlane16_swap_b32 v96, v98
    v_permlane16_swap_b32 v97, v99
    buffer_store_dwordx4 v[96:99], v9, s[16:19], s52 offen offset:64 sc1
    v_cvt_pk_bf16_f32 v100, v32, v33
    v_cvt_pk_bf16_f32 v101, v34, v35
    v_cvt_pk_bf16_f32 v102, v48, v49
    v_cvt_pk_bf16_f32 v103, v50, v51
    s_nop 1
    v_permlane16_swap_b32 v100, v102
    v_permlane16_swap_b32 v101, v103
    buffer_store_dwordx4 v[100:103], v9, s[16:19], s53 offen offset:0 sc1
    v_cvt_pk_bf16_f32 v104, v64, v65
    v_cvt_pk_bf16_f32 v105, v66, v67
    v_cvt_pk_bf16_f32 v106, v80, v81
    v_cvt_pk_bf16_f32 v107, v82, v83
    s_nop 1
    v_permlane16_swap_b32 v104, v106
    v_permlane16_swap_b32 v105, v107
    buffer_store_dwordx4 v[104:107], v9, s[16:19], s53 offen offset:64 sc1
    v_pk_add_f32 v[108:109], v[28:29], v[30:31]
    v_pk_mul_f32 v[110:111], v[28:29], v[28:29]
    v_pk_fma_f32 v[110:111], v[30:31], v[30:31], v[110:111]
    v_pk_add_f32 v[108:109], v[108:109], v[44:45]
    v_pk_fma_f32 v[110:111], v[44:45], v[44:45], v[110:111]
    v_pk_add_f32 v[108:109], v[108:109], v[46:47]
    v_pk_fma_f32 v[110:111], v[46:47], v[46:47], v[110:111]
    v_pk_add_f32 v[108:109], v[108:109], v[60:61]
    v_pk_fma_f32 v[110:111], v[60:61], v[60:61], v[110:111]
    v_pk_add_f32 v[108:109], v[108:109], v[62:63]
    v_pk_fma_f32 v[110:111], v[62:63], v[62:63], v[110:111]
    v_pk_add_f32 v[108:109], v[108:109], v[76:77]
    v_pk_fma_f32 v[110:111], v[76:77], v[76:77], v[110:111]
    v_pk_add_f32 v[108:109], v[108:109], v[78:79]
    v_pk_fma_f32 v[110:111], v[78:79], v[78:79], v[110:111]
    v_pk_add_f32 v[112:113], v[32:33], v[34:35]
    v_pk_mul_f32 v[114:115], v[32:33], v[32:33]
    v_pk_fma_f32 v[114:115], v[34:35], v[34:35], v[114:115]
    v_pk_add_f32 v[112:113], v[112:113], v[48:49]
    v_pk_fma_f32 v[114:115], v[48:49], v[48:49], v[114:115]
    v_pk_add_f32 v[112:113], v[112:113], v[50:51]
    v_pk_fma_f32 v[114:115], v[50:51], v[50:51], v[114:115]
    v_pk_add_f32 v[112:113], v[112:113], v[64:65]
    v_pk_fma_f32 v[114:115], v[64:65], v[64:65], v[114:115]
    v_pk_add_f32 v[112:113], v[112:113], v[66:67]
    v_pk_fma_f32 v[114:115], v[66:67], v[66:67], v[114:115]
    v_pk_add_f32 v[112:113], v[112:113], v[80:81]
    v_pk_fma_f32 v[114:115], v[80:81], v[80:81], v[114:115]
    v_pk_add_f32 v[112:113], v[112:113], v[82:83]
    v_pk_fma_f32 v[114:115], v[82:83], v[82:83], v[114:115]
    v_add_f32 v108, v108, v109
    v_add_f32 v109, v110, v111
    v_add_f32 v112, v112, v113
    v_add_f32 v113, v114, v115
    s_nop 1
    v_permlane16_swap_b32 v108, v112
    v_permlane16_swap_b32 v109, v113
    v_pk_add_f32 v[108:109], v[108:109], v[112:113]
    v_mov_b32 v116, v108
    v_mov_b32 v117, v109
    v_and_b32 v3, 16, v2
    v_add_u32 v3, v3, v20
    v_permlane32_swap_b32 v108, v116
    v_permlane32_swap_b32 v109, v117
    v_pk_add_f32 v[108:109], v[108:109], v[116:117]
    v_lshlrev_b32 v3, 3, v3
    s_mul_i32 s40, s24, 2
    s_add_u32 s40, s40, s44
    s_lshl_b32 s40, s40, 14
    s_mov_b32 exec_hi, 0
    buffer_store_dwordx2 v[108:109], v3, s[60:63], s40 offen sc1
    s_mov_b32 exec_hi, -1
    s_cmp_lg_u32 s96, 0
    s_cbranch_scc1 g4_done
    s_lshr_b32 s40, s25, 0
    s_add_u32 s40, s40, 40
    s_lshl_b32 s40, s40, 8
    s_mov_b32 s42, s40
    s_add_u32 s84, s4, 0x2b00000
    s_addc_u32 s85, s5, 0
    s_mov_b32 s86, 0x4000
    s_mov_b32 s87, 0x20000
    v_mov_b32 v3, s40
    v_mov_b32 v4, 1
    s_waitcnt vmcnt(0)
    s_barrier
    s_cmp_lg_u32 s28, 0
    s_cbranch_scc1 g4_cin
    s_mov_b64 exec, 1
    buffer_atomic_add v4, v3, s[84:87], 0 offen sc1
    s_mov_b64 exec, -1
g4_cin:
    s_mov_b32 s96, 1
    s_mov_b32 s97, 0x2800000
    s_branch g1_in
code_end:
.section .rodata,"a"
.p2align 6
.amdhsa_kernel g1a_kernel
  .amdhsa_next_free_vgpr 220
  .amdhsa_next_free_sgpr 100
  .amdhsa_accum_offset 220
  .amdhsa_group_segment_fixed_size 0
  .amdhsa_kernarg_size 88
  .amdhsa_user_sgpr_count 2
  .amdhsa_user_sgpr_kernarg_segment_ptr 1
  .amdhsa_system_sgpr_workgroup_id_x 1
.end_amdhsa_kernel
```

```asm
; @launch kernel=g1a_kernel grid=(256,1,1) block=(512,1,1) lds=131328
.amdgcn_target "amdgcn-amd-amdhsa--gfx950"
.text
.globl g1a_kernel
.p2align 8
.type g1a_kernel,@function
g1a_kernel:
    s_mov_b32 s96, 0
    s_mov_b32 s97, 0x0
    v_mov_b32 v1, 131072
    v_mov_b32 v2, 0
    ds_write_b32 v1, v2
    s_branch g1_in
.p2align 6
g1_in:
    s_cmp_ge_u32 s2, 256
    s_cbranch_scc1 g1_done
    s_load_dwordx2 s[4:5], s[0:1], 80
    s_load_dwordx2 s[6:7], s[0:1], 0
    s_xor_b32 s53, s96, 1
    s_load_dwordx2 s[30:31], s[0:1], 8
    s_load_dwordx2 s[16:17], s[0:1], 72
    s_load_dwordx2 s[18:19], s[0:1], 16
    v_lshrrev_b32 v1, 6, v0
    v_and_b32 v2, 63, v0
    s_and_b32 s40, s2, 1
    s_lshl_b32 s40, s40, 3
    s_bfe_u32 s41, s2, 0x30003
    s_add_u32 s25, s40, s41
    s_bfe_u32 s40, s2, 0x20001
    s_lshl_b32 s40, s40, 2
    s_lshr_b32 s42, s2, 6
    s_add_u32 s24, s40, s42
    s_add_u32 s27, s41, s42
    s_add_u32 s52, s24, s25
    s_and_b32 s52, s52, 15
    s_and_b32 s26, s52, 12
    s_mul_i32 s26, s26, s53
    v_readfirstlane_b32 s28, v1
    v_lshrrev_b32 v5, 4, v2
    v_bfe_u32 v6, v2, 2, 2
    v_and_b32 v7, 3, v2
    v_and_b32 v8, 15, v2
    s_cmp_lt_u32 s28, 4
    s_cbranch_scc1 g1_compute
    s_sub_u32 s28, s28, 4
    s_mov_b32 s40, 2048
    v_lshrrev_b32 v3, 3, v2
    v_mul_lo_u32 v3, v3, s40
    v_lshrrev_b32 v4, 4, v2
    v_xor_b32 v4, v4, v2
    v_and_b32 v4, 7, v4
    v_lshl_add_u32 v3, v4, 4, v3
    s_mul_i32 s41, s25, 262144
    s_mul_i32 s42, s28, 65536
    s_add_u32 s41, s41, s42
    v_xor_b32 v4, 64, v3
    s_add_u32 s42, s41, 0
    v_add_u32 v16, s42, v3
    s_add_u32 s42, s41, 16384
    v_add_u32 v17, s42, v4
    s_add_u32 s42, s41, 32768
    v_add_u32 v18, s42, v3
    s_add_u32 s42, s41, 49152
    v_add_u32 v19, s42, v4
    s_mov_b32 s40, 6144
    v_lshrrev_b32 v3, 3, v2
    v_mul_lo_u32 v3, v3, s40
    v_bfe_u32 v4, v2, 4, 1
    v_lshlrev_b32 v4, 1, v4
    v_xor_b32 v4, v4, v2
    v_and_b32 v4, 7, v4
    v_lshl_add_u32 v3, v4, 4, v3
    s_mul_i32 s41, s24, 128
    s_mul_i32 s42, s28, 98304
    s_add_u32 s41, s41, s42
    v_xor_b32 v4, 64, v3
    s_add_u32 s42, s41, 0
    v_add_u32 v10, s42, v3
    s_add_u32 s42, s41, 49152
    v_add_u32 v11, s42, v4
    s_mov_b32 s40, 6144
    v_lshrrev_b32 v3, 3, v2
    v_mul_lo_u32 v3, v3, s40
    v_bfe_u32 v4, v2, 4, 1
    v_lshlrev_b32 v4, 1, v4
    v_xor_b32 v4, v4, v2
    v_and_b32 v4, 7, v4
    v_lshl_add_u32 v3, v4, 4, v3
    s_mul_i32 s41, s24, 128
    s_mul_i32 s42, s28, 98304
    s_add_u32 s41, s41, s42
    v_xor_b32 v4, 64, v3
    s_add_u32 s42, s41, 2048
    v_add_u32 v12, s42, v3
    s_add_u32 s42, s41, 51200
    v_add_u32 v13, s42, v4
    s_mov_b32 s40, 6144
    v_lshrrev_b32 v3, 3, v2
    v_mul_lo_u32 v3, v3, s40
    v_bfe_u32 v4, v2, 4, 1
    v_lshlrev_b32 v4, 1, v4
    v_xor_b32 v4, v4, v2
    v_and_b32 v4, 7, v4
    v_lshl_add_u32 v3, v4, 4, v3
    s_mul_i32 s41, s24, 128
    s_mul_i32 s42, s28, 98304
    s_add_u32 s41, s41, s42
    v_xor_b32 v4, 64, v3
    s_add_u32 s42, s41, 4096
    v_add_u32 v14, s42, v3
    s_add_u32 s42, s41, 53248
    v_add_u32 v15, s42, v4
    v_lshrrev_b32 v3, 3, v2
    s_lshl_b32 s40, s28, 2
    v_add_u32 v3, s40, v3
    v_lshrrev_b32 v4, 1, v3
    v_xor_b32 v4, v4, v2
    v_and_b32 v4, 7, v4
    s_lshl_b32 s40, s25, 7
    s_sub_u32 s40, s40, 16
    v_add_u32 v3, s40, v3
    v_max_i32 v3, 0, v3
    v_lshlrev_b32 v3, 11, v3
    v_lshl_add_u32 v20, v4, 4, v3
    s_mul_i32 s36, s28, 2048
    s_mul_i32 s37, s28, 4096
    s_add_u32 s37, s37, 26624
    s_mul_i32 s46, s28, 512
    s_add_u32 s46, s46, 24576
    s_waitcnt lgkmcnt(0)
    s_mov_b32 s8, s30
    s_mov_b32 s9, s31
    s_mov_b32 s10, 0x600000
    s_mov_b32 s11, 0x20000
    s_add_u32 s56, s4, 0x100000
    s_addc_u32 s57, s5, 0
    s_mov_b32 s58, 0x30000
    s_mov_b32 s59, 0x20000
    s_add_u32 s4, s4, s97
    s_addc_u32 s5, s5, 0
    s_add_u32 s12, s4, 0x1900000
    s_addc_u32 s13, s5, 0
    s_cmp_eq_u32 s96, 1
    s_cselect_b32 s12, s12, s6
    s_cselect_b32 s13, s13, s7
    s_mov_b32 s14, 0x400000
    s_mov_b32 s15, 0x20000
    s_mov_b32 s20, s4
    s_mov_b32 s21, s5
    s_mov_b32 s22, 0x40000
    s_mov_b32 s23, 0x20000
    s_mov_b32 s60, s16
    s_mov_b32 s61, s17
    s_mov_b32 s62, 0x100
    s_mov_b32 s63, 0x20000
    s_sub_u32 s40, s52, s27
    s_and_b32 s40, s40, 1
    s_and_b32 s41, s52, 2
    s_or_b32 s40, s40, s41
    s_add_u32 s54, s40, 2
    s_cmp_eq_u32 s53, 0
    s_cselect_b32 s54, 0x7fff, s54
    s_add_u32 s55, s54, 3
    s_cmp_lg_u32 s28, 0
    s_cselect_b32 s55, 0x7fff, s55
    s_cmp_lt_u32 s55, 0x7fff
    s_cselect_b32 s29, 12, 0x7fff
    s_add_u32 s50, s29, 1
    s_mov_b32 s51, 14
    s_mov_b32 s32, 0
    s_mov_b32 s33, 0
g1_ld_pW:
    s_add_u32 s40, s32, s27
    s_and_b32 s40, s40, 1
    s_andn2_b32 s41, s32, 1
    s_or_b32 s40, s40, s41
    s_add_u32 s40, s40, s26
    s_and_b32 s40, s40, 15
    s_mul_i32 s34, s40, 393216
    s_mul_i32 s35, s40, 128
    s_add_u32 s38, s33, s36
    s_add_u32 s39, s33, s37
    s_add_u32 m0, s38, 0
    s_nop 0
    buffer_load_dwordx4 v10, s[8:11], s34 offen lds
    s_add_u32 m0, s38, 1024
    s_nop 0
    buffer_load_dwordx4 v11, s[8:11], s34 offen lds
    s_add_u32 m0, s38, 8192
    s_nop 0
    buffer_load_dwordx4 v12, s[8:11], s34 offen lds
    s_add_u32 m0, s38, 9216
    s_nop 0
    buffer_load_dwordx4 v13, s[8:11], s34 offen lds
    s_add_u32 m0, s38, 16384
    s_nop 0
    buffer_load_dwordx4 v14, s[8:11], s34 offen lds
    s_add_u32 m0, s38, 17408
    s_nop 0
    buffer_load_dwordx4 v15, s[8:11], s34 offen lds
    s_add_u32 s33, s33, 43008
    s_add_u32 s32, s32, 1
    s_cmp_lt_u32 s32, 2
    s_cbranch_scc1 g1_ld_pW
    s_cmp_eq_u32 s96, 0
    s_cbranch_scc1 g1_dep_ok
    s_add_u32 s40, s25, 40
    s_lshl_b32 s40, s40, 8
    s_sub_u32 s42, s40, 256
    s_max_u32 s42, s42, 10240
    s_lshl_b32 s43, s96, 2
    s_add_u32 s43, s43, 1
    s_mov_b32 s41, 0x80000
    v_mov_b32 v24, 131072
    s_cmp_lg_u32 s28, 0
    s_cbranch_scc1 g1_dep_lds
    s_mov_b32 s41, 0x8000
    s_add_u32 s84, s4, 0x300000
    s_addc_u32 s85, s5, 0
    s_mov_b32 s86, 0x4000
    s_mov_b32 s87, 0x20000
    v_cmp_eq_u32 vcc, 1, v2
    v_mov_b32 v21, s40
    v_mov_b32 v23, s42
    v_cndmask_b32 v21, v21, v23, vcc
    v_mov_b32 v22, 16
    v_mov_b32 v23, 16
    v_cndmask_b32 v22, v22, v23, vcc
g1_dep:
    buffer_load_dword v23, v21, s[84:87], 0 offen sc1
    s_sub_u32 s41, s41, 1
    s_waitcnt vmcnt(0)
    v_cmp_lt_u32 vcc, v23, v22
    s_cmp_eq_u32 s41, 0
    s_cbranch_scc1 g1_dep_seen
    s_cbranch_vccz g1_dep_seen
    s_sleep 2
    s_branch g1_dep
g1_dep_seen:
    v_mov_b32 v23, s43
    ds_write_b32 v24, v23
    s_branch g1_dep_ok
g1_dep_lds:
    ds_read_b32 v23, v24
    s_sub_u32 s41, s41, 1
    s_waitcnt lgkmcnt(0)
    v_readfirstlane_b32 s40, v23
    s_cmp_eq_u32 s41, 0
    s_cbranch_scc1 g1_dep_ok
    s_cmp_eq_u32 s40, s43
    s_cbranch_scc1 g1_dep_ok
    s_sleep 1
    s_branch g1_dep_lds
g1_dep_ok:
    s_mov_b32 s32, 0
    s_mov_b32 s33, 0
g1_ld_pA:
    s_add_u32 s40, s32, s27
    s_and_b32 s40, s40, 1
    s_andn2_b32 s41, s32, 1
    s_or_b32 s40, s40, s41
    s_add_u32 s40, s40, s26
    s_and_b32 s40, s40, 15
    s_mul_i32 s34, s40, 393216
    s_mul_i32 s35, s40, 128
    s_add_u32 s38, s33, s36
    s_add_u32 s39, s33, s37
    s_add_u32 m0, s39, 0
    s_nop 0
    buffer_load_dwordx4 v16, s[12:15], s35 offen sc1 lds
    s_add_u32 m0, s39, 1024
    s_nop 0
    buffer_load_dwordx4 v17, s[12:15], s35 offen sc1 lds
    s_add_u32 m0, s39, 2048
    s_nop 0
    buffer_load_dwordx4 v18, s[12:15], s35 offen sc1 lds
    s_add_u32 m0, s39, 3072
    s_nop 0
    buffer_load_dwordx4 v19, s[12:15], s35 offen sc1 lds
    s_add_u32 m0, s33, s46
    s_mov_b32 exec_hi, 0
    buffer_load_dwordx4 v20, s[12:15], s35 offen sc1 lds
    s_mov_b32 exec_hi, -1
    s_add_u32 s33, s33, 43008
    s_add_u32 s32, s32, 1
    s_cmp_lt_u32 s32, 2
    s_cbranch_scc1 g1_ld_pA
    s_waitcnt vmcnt(5)
    s_branch g1_ld_bar
g1_ld_loop:
    s_sub_u32 s40, s32, s54
    s_sub_u32 s40, s40, 1
    s_cmp_lt_u32 s40, 2
    s_cbranch_scc1 g1_ld_w0
    s_sub_u32 s40, s32, s55
    s_sub_u32 s40, s40, 1
    s_cmp_lt_u32 s40, 2
    s_cbranch_scc1 g1_ld_w1
    s_sub_u32 s40, s32, s29
    s_sub_u32 s40, s40, 1
    s_cmp_lt_u32 s40, 2
    s_cbranch_scc1 g1_ld_w2
    s_sub_u32 s40, s32, s51
    s_sub_u32 s40, s40, 1
    s_cmp_lt_u32 s40, 2
    s_cbranch_scc1 g1_ld_w4
    s_waitcnt vmcnt(11)
g1_ld_bar:
    s_barrier
    s_add_u32 s40, s32, s27
    s_and_b32 s40, s40, 1
    s_andn2_b32 s41, s32, 1
    s_or_b32 s40, s40, s41
    s_add_u32 s40, s40, s26
    s_and_b32 s40, s40, 15
    s_mul_i32 s34, s40, 393216
    s_mul_i32 s35, s40, 128
    s_add_u32 s38, s33, s36
    s_add_u32 s39, s33, s37
    s_add_u32 m0, s39, 0
    s_nop 0
    buffer_load_dwordx4 v16, s[12:15], s35 offen sc1 lds
    s_add_u32 m0, s39, 1024
    s_nop 0
    buffer_load_dwordx4 v17, s[12:15], s35 offen sc1 lds
    s_add_u32 m0, s39, 2048
    s_nop 0
    buffer_load_dwordx4 v18, s[12:15], s35 offen sc1 lds
    s_add_u32 m0, s39, 3072
    s_nop 0
    buffer_load_dwordx4 v19, s[12:15], s35 offen sc1 lds
    s_add_u32 m0, s38, 0
    s_nop 0
    buffer_load_dwordx4 v10, s[8:11], s34 offen lds
    s_add_u32 m0, s38, 1024
    s_nop 0
    buffer_load_dwordx4 v11, s[8:11], s34 offen lds
    s_add_u32 m0, s38, 8192
    s_nop 0
    buffer_load_dwordx4 v12, s[8:11], s34 offen lds
    s_add_u32 m0, s38, 9216
    s_nop 0
    buffer_load_dwordx4 v13, s[8:11], s34 offen lds
    s_add_u32 m0, s38, 16384
    s_nop 0
    buffer_load_dwordx4 v14, s[8:11], s34 offen lds
    s_add_u32 m0, s38, 17408
    s_nop 0
    buffer_load_dwordx4 v15, s[8:11], s34 offen lds
    s_add_u32 m0, s33, s46
    s_mov_b32 exec_hi, 0
    buffer_load_dwordx4 v20, s[12:15], s35 offen sc1 lds
    s_mov_b32 exec_hi, -1
    s_cmp_eq_u32 s32, s54
    s_cbranch_scc1 g1_ld_h0
g1_ld_c0:
    s_cmp_eq_u32 s32, s55
    s_cbranch_scc1 g1_ld_h1
g1_ld_c1:
    s_cmp_eq_u32 s32, s29
    s_cbranch_scc1 g1_ld_h2
g1_ld_c2:
    s_cmp_eq_u32 s32, s50
    s_cbranch_scc1 g1_ld_h3
g1_ld_c3:
    s_cmp_eq_u32 s32, s51
    s_cbranch_scc1 g1_ld_h4
g1_ld_c4:
    s_add_u32 s33, s33, 43008
    s_add_u32 s32, s32, 1
    s_cmp_eq_u32 s33, 129024
    s_cselect_b32 s33, 0, s33
    s_cmp_lt_u32 s32, 16
    s_cbranch_scc1 g1_ld_loop
    s_waitcnt vmcnt(43)
    s_barrier
    s_waitcnt vmcnt(0)
    v_pk_add_f32 v[24:25], v[24:25], v[40:41]
    v_add_f32 v56, v56, v64
    v_pk_add_f32 v[26:27], v[26:27], v[42:43]
    v_add_f32 v57, v57, v65
    v_pk_add_f32 v[28:29], v[28:29], v[44:45]
    v_add_f32 v58, v58, v66
    v_pk_add_f32 v[30:31], v[30:31], v[46:47]
    v_add_f32 v59, v59, v67
    v_pk_add_f32 v[32:33], v[32:33], v[48:49]
    v_add_f32 v60, v60, v68
    v_pk_add_f32 v[34:35], v[34:35], v[50:51]
    v_add_f32 v61, v61, v69
    v_pk_add_f32 v[36:37], v[36:37], v[52:53]
    v_add_f32 v62, v62, v70
    v_pk_add_f32 v[38:39], v[38:39], v[54:55]
    v_add_f32 v63, v63, v71
    v_pk_add_f32 v[24:25], v[24:25], v[32:33]
    v_add_f32 v56, v56, v60
    v_pk_add_f32 v[26:27], v[26:27], v[34:35]
    v_add_f32 v57, v57, v61
    v_pk_add_f32 v[28:29], v[28:29], v[36:37]
    v_add_f32 v58, v58, v62
    v_pk_add_f32 v[30:31], v[30:31], v[38:39]
    v_add_f32 v59, v59, v63
    v_pk_add_f32 v[24:25], v[24:25], v[28:29]
    v_add_f32 v56, v56, v58
    v_pk_add_f32 v[26:27], v[26:27], v[30:31]
    v_add_f32 v57, v57, v59
    v_pk_add_f32 v[24:25], v[24:25], v[26:27]
    v_add_f32 v56, v56, v57
    v_mul_f32 v24, 0x3a800000, v24
    v_mul_f32 v25, 0x3a800000, v25
    v_fma_f32 v25, -v24, v24, v25
    v_max_f32 v25, 0, v25
    v_cvt_pk_bf16_f32 v24, v24, v24
    v_lshlrev_b32 v24, 16, v24
    v_cvt_pk_bf16_f32 v25, v25, v25
    v_lshlrev_b32 v25, 16, v25
    v_add_f32 v25, 0x3727c5ac, v25
    v_cvt_pk_bf16_f32 v25, v25, v25
    v_lshlrev_b32 v25, 16, v25
    v_sqrt_f32 v25, v25
    s_nop 0
    v_cvt_pk_bf16_f32 v25, v25, v25
    v_lshlrev_b32 v25, 16, v25
    v_rcp_f32 v26, v25
    v_lshlrev_b32 v3, 3, v21
    v_lshlrev_b32 v4, 2, v21
    v_mul_f32 v27, -v24, v26
    v_cmp_gt_u32 vcc, 144, v21
    s_and_saveexec_b64 s[40:41], vcc
    v_add_u32 v3, 129024, v3
    ds_write_b64 v3, v[26:27]
    s_mov_b64 exec, s[40:41]
    v_cmp_gt_u32 vcc, 192, v21
    s_and_saveexec_b64 s[40:41], vcc
    v_add_u32 v4, 130304, v4
    ds_write_b32 v4, v56
    s_mov_b64 exec, s[40:41]
    s_waitcnt lgkmcnt(0)
    s_barrier
    s_add_u32 s20, s4, 0x200000
    s_addc_u32 s21, s5, 0
    s_mov_b32 s22, 0x40000
    s_mov_b32 s23, 0x20000
    s_lshl_b32 s40, s24, 4
    s_add_u32 s40, s40, s25
    s_lshl_b32 s40, s40, 10
    s_lshl_b32 s41, s28, 8
    s_add_u32 s40, s40, s41
    v_lshlrev_b32 v3, 2, v2
    v_mov_b32 v4, -1
    buffer_store_dword v4, v3, s[20:23], s40 offen sc1
    s_cmp_eq_u32 s53, 0
    s_cbranch_scc1 g1_nopf
    s_mov_b32 s20, s18
    s_mov_b32 s21, s19
    s_mov_b32 s22, 0x200000
    s_mov_b32 s23, 0x20000
    s_lshl_b32 s40, s2, 13
    s_lshl_b32 s41, s28, 11
    s_add_u32 s40, s40, s41
    v_lshlrev_b32 v3, 4, v2
    buffer_load_dwordx4 v[120:123], v3, s[20:23], s40 offen
    buffer_load_dwordx4 v[120:123], v3, s[20:23], s40 offen offset:1024
g1_nopf:
    s_branch g1_ld_end
g1_ld_w0:
    s_waitcnt vmcnt(16)
    s_branch g1_ld_bar
g1_ld_h0:
    s_add_u32 s44, s33, 43008
    s_cmp_eq_u32 s44, 129024
    s_cselect_b32 s44, 0, s44
    s_mul_i32 s42, s28, 3
    s_add_u32 s42, s42, 0
    s_lshr_b32 s43, s42, 2
    s_lshl_b32 s43, s43, 13
    s_add_u32 s43, s43, s44
    s_and_b32 s42, s42, 3
    v_and_b32 v3, 1, v5
    v_lshlrev_b32 v3, 1, v3
    v_lshrrev_b32 v4, 1, v6
    v_or_b32 v3, v3, v4
    s_add_u32 s40, s42, 0
    v_xor_b32 v3, s40, v3
    v_lshlrev_b32 v3, 5, v3
    v_lshl_add_u32 v3, v7, 3, v3
    v_lshl_add_u32 v4, v5, 3, v6
    v_lshl_add_u32 v3, v4, 7, v3
    v_add_u32 v21, s43, v3
    ds_read_b64_tr_b16 v[24:25], v21 offset:0
    ds_read_b64_tr_b16 v[26:27], v21 offset:512
    ds_read_b64_tr_b16 v[28:29], v21 offset:4096
    ds_read_b64_tr_b16 v[30:31], v21 offset:4608
    s_mul_i32 s42, s28, 3
    s_add_u32 s42, s42, 1
    s_lshr_b32 s43, s42, 2
    s_lshl_b32 s43, s43, 13
    s_add_u32 s43, s43, s44
    s_and_b32 s42, s42, 3
    v_and_b32 v3, 1, v5
    v_lshlrev_b32 v3, 1, v3
    v_lshrrev_b32 v4, 1, v6
    v_or_b32 v3, v3, v4
    s_add_u32 s40, s42, 0
    v_xor_b32 v3, s40, v3
    v_lshlrev_b32 v3, 5, v3
    v_lshl_add_u32 v3, v7, 3, v3
    v_lshl_add_u32 v4, v5, 3, v6
    v_lshl_add_u32 v3, v4, 7, v3
    v_add_u32 v21, s43, v3
    ds_read_b64_tr_b16 v[32:33], v21 offset:0
    ds_read_b64_tr_b16 v[34:35], v21 offset:512
    ds_read_b64_tr_b16 v[36:37], v21 offset:4096
    ds_read_b64_tr_b16 v[38:39], v21 offset:4608
    s_mul_i32 s42, s28, 3
    s_add_u32 s42, s42, 2
    s_lshr_b32 s43, s42, 2
    s_lshl_b32 s43, s43, 13
    s_add_u32 s43, s43, s44
    s_and_b32 s42, s42, 3
    v_and_b32 v3, 1, v5
    v_lshlrev_b32 v3, 1, v3
    v_lshrrev_b32 v4, 1, v6
    v_or_b32 v3, v3, v4
    s_add_u32 s40, s42, 0
    v_xor_b32 v3, s40, v3
    v_lshlrev_b32 v3, 5, v3
    v_lshl_add_u32 v3, v7, 3, v3
    v_lshl_add_u32 v4, v5, 3, v6
    v_lshl_add_u32 v3, v4, 7, v3
    v_add_u32 v21, s43, v3
    ds_read_b64_tr_b16 v[40:41], v21 offset:0
    ds_read_b64_tr_b16 v[42:43], v21 offset:512
    ds_read_b64_tr_b16 v[44:45], v21 offset:4096
    ds_read_b64_tr_b16 v[46:47], v21 offset:4608
    s_lshr_b32 s42, s44, 7
    s_lshl_b32 s43, s28, 5
    s_add_u32 s42, s42, s43
    s_add_u32 s42, s42, 16
    v_lshrrev_b32 v3, 1, v8
    v_xor_b32 v3, v3, v5
    v_lshlrev_b32 v3, 4, v3
    v_lshl_add_u32 v3, v8, 7, v3
    s_lshl_b32 s40, s42, 7
    s_add_u32 s40, s40, 24576
    v_add_u32 v22, s40, v3
    v_xor_b32 v23, 64, v22
    ds_read_b128 v[48:51], v22 offset:0
    ds_read_b128 v[52:55], v23 offset:0
    ds_read_b128 v[56:59], v22 offset:2048
    ds_read_b128 v[60:63], v23 offset:2048
    v_mov_b32 v64, 0x3f803f80
    v_mov_b32 v65, 0x3f803f80
    v_mov_b32 v66, 0x3f803f80
    v_mov_b32 v67, 0x3f803f80
    s_mul_i32 s42, s52, 12288
    s_lshl_b32 s43, s24, 8
    s_add_u32 s42, s42, s43
    v_lshl_add_u32 v21, v5, 4, s42
    s_lshl_b32 s42, s52, 14
    s_lshl_b32 s43, s25, 10
    s_add_u32 s42, s42, s43
    s_lshl_b32 s43, s28, 8
    s_add_u32 s42, s42, s43
    v_lshl_add_u32 v22, v8, 3, s42
    s_waitcnt lgkmcnt(0)
    v_mfma_f32_16x16x32_bf16 v[68:71], v[24:27], v[64:67], 0
    v_mfma_f32_16x16x32_bf16 v[72:75], v[32:35], v[64:67], 0
    v_mfma_f32_16x16x32_bf16 v[76:79], v[40:43], v[64:67], 0
    v_mfma_f32_16x16x32_bf16 v[80:83], v[64:67], v[48:51], 0
    v_mfma_f32_16x16x32_bf16 v[84:87], v[48:51], v[48:51], 0
    v_mfma_f32_16x16x32_bf16 v[88:91], v[64:67], v[56:59], 0
    v_mfma_f32_16x16x32_bf16 v[92:95], v[56:59], v[56:59], 0
    v_mfma_f32_16x16x32_bf16 v[68:71], v[28:31], v[64:67], v[68:71]
    v_mfma_f32_16x16x32_bf16 v[72:75], v[36:39], v[64:67], v[72:75]
    v_mfma_f32_16x16x32_bf16 v[76:79], v[44:47], v[64:67], v[76:79]
    v_mfma_f32_16x16x32_bf16 v[80:83], v[64:67], v[52:55], v[80:83]
    v_mfma_f32_16x16x32_bf16 v[84:87], v[52:55], v[52:55], v[84:87]
    v_mfma_f32_16x16x32_bf16 v[88:91], v[64:67], v[60:63], v[88:91]
    v_mfma_f32_16x16x32_bf16 v[92:95], v[60:63], v[60:63], v[92:95]
    v_cmp_eq_u32 s[40:41], 1, v7
    v_cmp_eq_u32 s[42:43], 2, v7
    v_cmp_eq_u32 vcc, 3, v7
    s_nop 7
    v_cndmask_b32 v81, v84, v85, s[40:41]
    v_cndmask_b32 v81, v81, v86, s[42:43]
    v_cndmask_b32 v81, v81, v87, vcc
    v_cndmask_b32 v89, v92, v93, s[40:41]
    v_cndmask_b32 v89, v89, v94, s[42:43]
    v_cndmask_b32 v89, v89, v95, vcc
    s_mov_b32 exec_lo, 0x00f0000f
    s_mov_b32 exec_hi, 0xf0000f00
    buffer_store_dwordx2 v[80:81], v22, s[20:23], 0 offen offset:0 sc1
    buffer_store_dwordx2 v[88:89], v22, s[20:23], 0 offen offset:128 sc1
    s_mov_b32 exec_lo, 0x00010001
    s_mov_b32 exec_hi, 0x00010001
    s_mul_i32 s42, s28, 3
    s_add_u32 s42, s42, 0
    s_lshr_b32 s43, s42, 2
    s_lshl_b32 s43, s43, 12
    s_and_b32 s42, s42, 3
    s_lshl_b32 s42, s42, 6
    s_add_u32 s42, s42, s43
    buffer_store_dwordx4 v[68:71], v21, s[56:59], s42 offen sc1
    s_mul_i32 s42, s28, 3
    s_add_u32 s42, s42, 1
    s_lshr_b32 s43, s42, 2
    s_lshl_b32 s43, s43, 12
    s_and_b32 s42, s42, 3
    s_lshl_b32 s42, s42, 6
    s_add_u32 s42, s42, s43
    buffer_store_dwordx4 v[72:75], v21, s[56:59], s42 offen sc1
    s_mul_i32 s42, s28, 3
    s_add_u32 s42, s42, 2
    s_lshr_b32 s43, s42, 2
    s_lshl_b32 s43, s43, 12
    s_and_b32 s42, s42, 3
    s_lshl_b32 s42, s42, 6
    s_add_u32 s42, s42, s43
    buffer_store_dwordx4 v[76:79], v21, s[56:59], s42 offen sc1
    s_mov_b64 exec, -1
    s_or_b32 s40, s24, s25
    s_or_b32 s40, s40, s28
    s_cmp_lg_u32 s40, 0
    s_cbranch_scc1 g1_nocr
    v_lshlrev_b32 v21, 8, v2
    v_mov_b32 v22, 0
    s_add_u32 s84, s4, 0x300000
    s_addc_u32 s85, s5, 0
    s_mov_b32 s86, 0x4000
    s_mov_b32 s87, 0x20000
    buffer_store_dword v22, v21, s[84:87], 0 offen sc1
    s_add_u32 s84, s4, 0x2b00000
    s_addc_u32 s85, s5, 0
    s_mov_b32 s86, 0x4000
    s_mov_b32 s87, 0x20000
    buffer_store_dword v22, v21, s[84:87], 0 offen sc1
g1_nocr:
    s_branch g1_ld_c0
g1_ld_w1:
    s_waitcnt vmcnt(12)
    s_branch g1_ld_bar
g1_ld_h1:
    v_mov_b32 v21, 0
    v_mov_b32 v22, 1
    s_mov_b64 exec, 1
    buffer_atomic_add v22, v21, s[60:63], 0 offen sc1
    s_mov_b64 exec, -1
    s_branch g1_ld_c1
g1_ld_w2:
    s_waitcnt vmcnt(12)
    s_branch g1_ld_bar
g1_ld_h2:
    v_mov_b32 v21, 0
    buffer_load_dword v23, v21, s[60:63], 0 offen sc1
    s_branch g1_ld_c2
g1_ld_h3:
    s_mov_b32 s41, 0x20000
    v_mov_b32 v21, 0
    s_waitcnt vmcnt(11)
g1_poll:
    v_readfirstlane_b32 s40, v23
    s_sub_u32 s41, s41, 1
    s_cmp_eq_u32 s41, 0
    s_cbranch_scc1 g1_polled
    s_cmp_ge_u32 s40, 256
    s_cbranch_scc1 g1_polled
    s_sleep 8
    buffer_load_dword v23, v21, s[60:63], 0 offen sc1
    s_waitcnt vmcnt(0)
    s_branch g1_poll
g1_polled:
    s_branch g1_ld_c3
g1_ld_w4:
    s_waitcnt vmcnt(43)
    s_branch g1_ld_bar
g1_ld_h4:
    s_lshl_b32 s40, s28, 6
    v_add_u32 v21, s40, v2
    s_lshl_b32 s41, s25, 7
    s_sub_u32 s41, s41, 16
    v_add_u32 v3, s41, v21
    v_max_i32 v3, 0, v3
    v_min_u32 v3, 2047, v3
    v_lshlrev_b32 v3, 3, v3
    s_min_u32 s40, s28, 2
    s_lshl_b32 s40, s40, 12
    s_lshl_b32 s41, s24, 8
    s_add_u32 s40, s40, s41
    v_lshl_add_u32 v4, v2, 2, s40
    s_mov_b32 s40, 0
    buffer_load_dwordx2 v[24:25], v3, s[20:23], s40 offen sc1
    s_mov_b32 s41, 0
    buffer_load_dword v56, v4, s[56:59], s41 offen sc1
    s_mov_b32 s40, 16384
    buffer_load_dwordx2 v[26:27], v3, s[20:23], s40 offen sc1
    s_mov_b32 s41, 12288
    buffer_load_dword v57, v4, s[56:59], s41 offen sc1
    s_mov_b32 s40, 32768
    buffer_load_dwordx2 v[28:29], v3, s[20:23], s40 offen sc1
    s_mov_b32 s41, 24576
    buffer_load_dword v58, v4, s[56:59], s41 offen sc1
    s_mov_b32 s40, 49152
    buffer_load_dwordx2 v[30:31], v3, s[20:23], s40 offen sc1
    s_mov_b32 s41, 36864
    buffer_load_dword v59, v4, s[56:59], s41 offen sc1
    s_mov_b32 s40, 65536
    buffer_load_dwordx2 v[32:33], v3, s[20:23], s40 offen sc1
    s_mov_b32 s41, 49152
    buffer_load_dword v60, v4, s[56:59], s41 offen sc1
    s_mov_b32 s40, 81920
    buffer_load_dwordx2 v[34:35], v3, s[20:23], s40 offen sc1
    s_mov_b32 s41, 61440
    buffer_load_dword v61, v4, s[56:59], s41 offen sc1
    s_mov_b32 s40, 98304
    buffer_load_dwordx2 v[36:37], v3, s[20:23], s40 offen sc1
    s_mov_b32 s41, 73728
    buffer_load_dword v62, v4, s[56:59], s41 offen sc1
    s_mov_b32 s40, 114688
    buffer_load_dwordx2 v[38:39], v3, s[20:23], s40 offen sc1
    s_mov_b32 s41, 86016
    buffer_load_dword v63, v4, s[56:59], s41 offen sc1
    s_mov_b32 s40, 131072
    buffer_load_dwordx2 v[40:41], v3, s[20:23], s40 offen sc1
    s_mov_b32 s41, 98304
    buffer_load_dword v64, v4, s[56:59], s41 offen sc1
    s_mov_b32 s40, 147456
    buffer_load_dwordx2 v[42:43], v3, s[20:23], s40 offen sc1
    s_mov_b32 s41, 110592
    buffer_load_dword v65, v4, s[56:59], s41 offen sc1
    s_mov_b32 s40, 163840
    buffer_load_dwordx2 v[44:45], v3, s[20:23], s40 offen sc1
    s_mov_b32 s41, 122880
    buffer_load_dword v66, v4, s[56:59], s41 offen sc1
    s_mov_b32 s40, 180224
    buffer_load_dwordx2 v[46:47], v3, s[20:23], s40 offen sc1
    s_mov_b32 s41, 135168
    buffer_load_dword v67, v4, s[56:59], s41 offen sc1
    s_mov_b32 s40, 196608
    buffer_load_dwordx2 v[48:49], v3, s[20:23], s40 offen sc1
    s_mov_b32 s41, 147456
    buffer_load_dword v68, v4, s[56:59], s41 offen sc1
    s_mov_b32 s40, 212992
    buffer_load_dwordx2 v[50:51], v3, s[20:23], s40 offen sc1
    s_mov_b32 s41, 159744
    buffer_load_dword v69, v4, s[56:59], s41 offen sc1
    s_mov_b32 s40, 229376
    buffer_load_dwordx2 v[52:53], v3, s[20:23], s40 offen sc1
    s_mov_b32 s41, 172032
    buffer_load_dword v70, v4, s[56:59], s41 offen sc1
    s_mov_b32 s40, 245760
    buffer_load_dwordx2 v[54:55], v3, s[20:23], s40 offen sc1
    s_mov_b32 s41, 184320
    buffer_load_dword v71, v4, s[56:59], s41 offen sc1
    s_branch g1_ld_c4
g1_ld_end:
    s_add_u32 s28, s28, 4
    s_add_u32 s16, s4, 0x400000
    s_addc_u32 s17, s5, 0
    s_mov_b32 s18, 0x400000
    s_mov_b32 s19, 0x20000
    s_and_b32 s44, s28, 1
    s_lshr_b32 s45, s28, 1
    s_lshl_b32 s40, s44, 2
    v_add_u32 v3, s40, v5
    v_and_b32 v4, 7, v8
    v_xor_b32 v3, v3, v4
    v_lshlrev_b32 v3, 4, v3
    v_lshl_add_u32 v3, v8, 8, v3
    s_mul_i32 s41, s45, 4096
    s_add_u32 s41, s41, 43008
    v_add_u32 v226, s41, v3
    v_lshl_add_u32 v3, v5, 2, v6
    v_and_b32 v4, 7, v3
    v_add_u32 v228, s40, v7
    v_xor_b32 v4, v4, v228
    v_lshlrev_b32 v4, 4, v4
    v_lshl_add_u32 v3, v3, 8, v4
    s_add_u32 s41, s41, 36864
    v_add_u32 v227, s41, v3
    v_and_b32 v3, 7, v8
    v_add_u32 v4, 1, v3
    s_or_b32 s40, s25, s45
    s_cmp_eq_u32 s40, 0
    s_cselect_b32 s40, 8, 0
    v_cmp_gt_u32 vcc, 8, v8
    v_mov_b32 v21, s40
    s_mov_b64 s[56:57], vcc
    v_cndmask_b32 v21, 0, v21, vcc
    v_max_u32 v4, v4, v21
    v_add_u32 v3, 8, v3
    v_sub_u32 v3, v3, v4
    v_lshlrev_b32 v21, 2, v5
    v_sub_u32 v21, v21, v4
    v_mov_b32 v22, 0xf149f2ca
    v_add_u32 v23, 0, v21
    v_cmp_ge_u32 vcc, v3, v23
    s_nop 1
    v_cndmask_b32 v228, v22, 0, vcc
    v_add_u32 v23, 1, v21
    v_cmp_ge_u32 vcc, v3, v23
    s_nop 1
    v_cndmask_b32 v229, v22, 0, vcc
    v_add_u32 v23, 2, v21
    v_cmp_ge_u32 vcc, v3, v23
    s_nop 1
    v_cndmask_b32 v230, v22, 0, vcc
    v_add_u32 v23, 3, v21
    v_cmp_ge_u32 vcc, v3, v23
    s_nop 1
    v_cndmask_b32 v231, v22, 0, vcc
    s_lshl_b32 s40, s25, 7
    s_lshl_b32 s41, s45, 5
    s_add_u32 s40, s40, s41
    s_lshl_b32 s40, s40, 11
    s_lshl_b32 s41, s24, 7
    s_add_u32 s40, s40, s41
    s_lshl_b32 s41, s44, 6
    s_add_u32 s40, s40, s41
    v_lshlrev_b32 v225, 12, v8
    v_lshl_add_u32 v225, v5, 4, v225
    v_add_u32 v225, s40, v225
    s_mov_b32 s58, 0x3e3504f3
    s_mov_b32 s59, 0x3fb8aa3b
    s_branch g1_attn
g1_compute:
    s_and_b32 s44, s28, 1
    s_lshr_b32 s45, s28, 1
    s_lshl_b32 s42, s44, 1
    s_mov_b32 s43, 0
    v_and_b32 v3, 1, v5
    v_lshlrev_b32 v3, 1, v3
    v_lshrrev_b32 v4, 1, v6
    v_or_b32 v3, v3, v4
    s_add_u32 s40, s42, 0
    v_xor_b32 v3, s40, v3
    v_lshlrev_b32 v3, 5, v3
    v_lshl_add_u32 v3, v7, 3, v3
    v_lshl_add_u32 v4, v5, 3, v6
    v_lshl_add_u32 v3, v4, 7, v3
    v_add_u32 v10, s43, v3
    v_and_b32 v3, 1, v5
    v_lshlrev_b32 v3, 1, v3
    v_lshrrev_b32 v4, 1, v6
    v_or_b32 v3, v3, v4
    s_add_u32 s40, s42, 1
    v_xor_b32 v3, s40, v3
    v_lshlrev_b32 v3, 5, v3
    v_lshl_add_u32 v3, v7, 3, v3
    v_lshl_add_u32 v4, v5, 3, v6
    v_lshl_add_u32 v3, v4, 7, v3
    v_add_u32 v11, s43, v3
    s_xor_b32 s43, s45, 1
    s_add_u32 s43, s43, 1
    s_mul_i32 s43, s43, 8192
    v_and_b32 v3, 1, v5
    v_lshlrev_b32 v3, 1, v3
    v_lshrrev_b32 v4, 1, v6
    v_or_b32 v3, v3, v4
    s_add_u32 s40, s42, 0
    v_xor_b32 v3, s40, v3
    v_lshlrev_b32 v3, 5, v3
    v_lshl_add_u32 v3, v7, 3, v3
    v_lshl_add_u32 v4, v5, 3, v6
    v_lshl_add_u32 v3, v4, 7, v3
    v_add_u32 v12, s43, v3
    v_and_b32 v3, 1, v5
    v_lshlrev_b32 v3, 1, v3
    v_lshrrev_b32 v4, 1, v6
    v_or_b32 v3, v3, v4
    s_add_u32 s40, s42, 1
    v_xor_b32 v3, s40, v3
    v_lshlrev_b32 v3, 5, v3
    v_lshl_add_u32 v3, v7, 3, v3
    v_lshl_add_u32 v4, v5, 3, v6
    v_lshl_add_u32 v3, v4, 7, v3
    v_add_u32 v13, s43, v3
    s_xor_b32 s43, s45, 0
    s_add_u32 s43, s43, 1
    s_mul_i32 s43, s43, 8192
    v_and_b32 v3, 1, v5
    v_lshlrev_b32 v3, 1, v3
    v_lshrrev_b32 v4, 1, v6
    v_or_b32 v3, v3, v4
    s_add_u32 s40, s42, 0
    v_xor_b32 v3, s40, v3
    v_lshlrev_b32 v3, 5, v3
    v_lshl_add_u32 v3, v7, 3, v3
    v_lshl_add_u32 v4, v5, 3, v6
    v_lshl_add_u32 v3, v4, 7, v3
    v_add_u32 v14, s43, v3
    v_and_b32 v3, 1, v5
    v_lshlrev_b32 v3, 1, v3
    v_lshrrev_b32 v4, 1, v6
    v_or_b32 v3, v3, v4
    s_add_u32 s40, s42, 1
    v_xor_b32 v3, s40, v3
    v_lshlrev_b32 v3, 5, v3
    v_lshl_add_u32 v3, v7, 3, v3
    v_lshl_add_u32 v4, v5, 3, v6
    v_lshl_add_u32 v3, v4, 7, v3
    v_add_u32 v15, s43, v3
    s_mul_i32 s42, s45, 64
    s_add_u32 s42, s42, 16
    v_lshrrev_b32 v3, 1, v8
    v_xor_b32 v3, v3, v5
    v_lshlrev_b32 v3, 4, v3
    v_lshl_add_u32 v3, v8, 7, v3
    s_lshl_b32 s40, s42, 7
    s_add_u32 s40, s40, 24576
    v_add_u32 v16, s40, v3
    v_xor_b32 v17, 64, v16
    v_lshrrev_b32 v3, 1, v8
    v_xor_b32 v3, v3, v5
    v_lshlrev_b32 v3, 4, v3
    v_lshl_add_u32 v3, v8, 7, v3
    v_add_u32 v18, 24576, v3
    v_xor_b32 v19, 64, v18
    v_mov_b32 v24, 0
    v_mov_b32 v25, 0
    v_mov_b32 v26, 0
    v_mov_b32 v27, 0
    v_mov_b32 v28, 0
    v_mov_b32 v29, 0
    v_mov_b32 v30, 0
    v_mov_b32 v31, 0
    v_mov_b32 v32, 0
    v_mov_b32 v33, 0
    v_mov_b32 v34, 0
    v_mov_b32 v35, 0
    v_mov_b32 v36, 0
    v_mov_b32 v37, 0
    v_mov_b32 v38, 0
    v_mov_b32 v39, 0
    v_mov_b32 v40, 0
    v_mov_b32 v41, 0
    v_mov_b32 v42, 0
    v_mov_b32 v43, 0
    v_mov_b32 v44, 0
    v_mov_b32 v45, 0
    v_mov_b32 v46, 0
    v_mov_b32 v47, 0
    v_mov_b32 v48, 0
    v_mov_b32 v49, 0
    v_mov_b32 v50, 0
    v_mov_b32 v51, 0
    v_mov_b32 v52, 0
    v_mov_b32 v53, 0
    v_mov_b32 v54, 0
    v_mov_b32 v55, 0
    v_mov_b32 v56, 0
    v_mov_b32 v57, 0
    v_mov_b32 v58, 0
    v_mov_b32 v59, 0
    v_mov_b32 v60, 0
    v_mov_b32 v61, 0
    v_mov_b32 v62, 0
    v_mov_b32 v63, 0
    v_mov_b32 v64, 0
    v_mov_b32 v65, 0
    v_mov_b32 v66, 0
    v_mov_b32 v67, 0
    v_mov_b32 v68, 0
    v_mov_b32 v69, 0
    v_mov_b32 v70, 0
    v_mov_b32 v71, 0
    v_mov_b32 v72, 0
    v_mov_b32 v73, 0
    v_mov_b32 v74, 0
    v_mov_b32 v75, 0
    v_mov_b32 v76, 0
    v_mov_b32 v77, 0
    v_mov_b32 v78, 0
    v_mov_b32 v79, 0
    v_mov_b32 v80, 0
    v_mov_b32 v81, 0
    v_mov_b32 v82, 0
    v_mov_b32 v83, 0
    v_mov_b32 v84, 0
    v_mov_b32 v85, 0
    v_mov_b32 v86, 0
    v_mov_b32 v87, 0
    v_mov_b32 v88, 0
    v_mov_b32 v89, 0
    v_mov_b32 v90, 0
    v_mov_b32 v91, 0
    v_mov_b32 v92, 0
    v_mov_b32 v93, 0
    v_mov_b32 v94, 0
    v_mov_b32 v95, 0
    v_mov_b32 v96, 0
    v_mov_b32 v97, 0
    v_mov_b32 v98, 0
    v_mov_b32 v99, 0
    v_mov_b32 v100, 0
    v_mov_b32 v101, 0
    v_mov_b32 v102, 0
    v_mov_b32 v103, 0
    v_mov_b32 v104, 0
    v_mov_b32 v105, 0
    v_mov_b32 v106, 0
    v_mov_b32 v107, 0
    v_mov_b32 v108, 0
    v_mov_b32 v109, 0
    v_mov_b32 v110, 0
    v_mov_b32 v111, 0
    v_mov_b32 v112, 0
    v_mov_b32 v113, 0
    v_mov_b32 v114, 0
    v_mov_b32 v115, 0
    v_mov_b32 v116, 0
    v_mov_b32 v117, 0
    v_mov_b32 v118, 0
    v_mov_b32 v119, 0
    v_mov_b32 v120, 0
    v_mov_b32 v121, 0
    v_mov_b32 v122, 0
    v_mov_b32 v123, 0
    v_mov_b32 v124, 0
    v_mov_b32 v125, 0
    v_mov_b32 v126, 0
    v_mov_b32 v127, 0
    v_mov_b32 v172, 0
    v_mov_b32 v173, 0
    v_mov_b32 v174, 0
    v_mov_b32 v175, 0
    v_mov_b32 v176, 0
    v_mov_b32 v177, 0
    v_mov_b32 v178, 0
    v_mov_b32 v179, 0
    v_mov_b32 v180, 0
    v_mov_b32 v181, 0
    v_mov_b32 v182, 0
    v_mov_b32 v183, 0
    v_mov_b32 v184, 0
    v_mov_b32 v185, 0
    v_mov_b32 v186, 0
    v_mov_b32 v187, 0
    v_mov_b32 v188, 0
    v_mov_b32 v189, 0
    v_mov_b32 v190, 0
    v_mov_b32 v191, 0
    v_mov_b32 v192, 0
    v_mov_b32 v193, 0
    v_mov_b32 v194, 0
    v_mov_b32 v195, 0
    v_mov_b32 v196, 0
    v_mov_b32 v197, 0
    v_mov_b32 v198, 0
    v_mov_b32 v199, 0
    v_mov_b32 v200, 0
    v_mov_b32 v201, 0
    v_mov_b32 v202, 0
    v_mov_b32 v203, 0
    v_mov_b32 v204, 0
    v_mov_b32 v205, 0
    v_mov_b32 v206, 0
    v_mov_b32 v207, 0
    v_mov_b32 v208, 0
    v_mov_b32 v209, 0
    v_mov_b32 v210, 0
    v_mov_b32 v211, 0
    v_mov_b32 v212, 0
    v_mov_b32 v213, 0
    v_mov_b32 v214, 0
    v_mov_b32 v215, 0
    s_mov_b32 s48, 16
    s_mov_b32 s50, 0
    s_mov_b32 s51, 43008
    s_mov_b32 s29, 0xfffeb000
    s_waitcnt lgkmcnt(0)
    s_add_u32 s4, s4, s97
    s_addc_u32 s5, s5, 0
    v_lshlrev_b32 v3, 3, v8
    v_add_u32 v217, 129024, v3
    s_mul_i32 s40, s45, 512
    s_add_u32 s40, s40, 129152
    v_add_u32 v216, s40, v3
    s_lshl_b32 s40, s44, 7
    s_add_u32 s40, s40, 130304
    v_lshl_add_u32 v3, v5, 4, s40
    s_mov_b32 s43, 0
    v_add_u32 v218, s43, v3
    s_xor_b32 s43, s45, 1
    s_add_u32 s43, s43, 1
    s_mul_i32 s43, s43, 256
    v_add_u32 v219, s43, v3
    s_xor_b32 s43, s45, 0
    s_add_u32 s43, s43, 1
    s_mul_i32 s43, s43, 256
    v_add_u32 v220, s43, v3
    v_and_b32 v3, 1, v5
    v_lshlrev_b32 v3, 1, v3
    v_lshrrev_b32 v4, 1, v5
    v_add_u32 v3, v3, v4
    s_lshl_b32 s40, s44, 2
    v_add_u32 v3, s40, v3
    v_lshrrev_b32 v4, 1, v8
    v_xor_b32 v3, v3, v4
    v_lshlrev_b32 v3, 4, v3
    v_lshl_add_u32 v3, v8, 7, v3
    s_mul_i32 s42, s45, 8192
    s_add_u32 s42, s42, 45056
    s_mov_b32 s43, 0
    s_add_u32 s40, s42, s43
    v_add_u32 v221, s40, v3
    s_xor_b32 s43, s45, 1
    s_add_u32 s43, s43, 1
    s_mul_i32 s43, s43, 18432
    s_add_u32 s40, s42, s43
    v_add_u32 v222, s40, v3
    s_xor_b32 s43, s45, 0
    s_add_u32 s43, s43, 1
    s_mul_i32 s43, s43, 18432
    s_add_u32 s40, s42, s43
    v_add_u32 v223, s40, v3
    s_add_u32 s40, s43, 43008
    v_add_u32 v224, s40, v3
    s_add_u32 s16, s4, 0x400000
    s_addc_u32 s17, s5, 0
    s_mov_b32 s18, 0x400000
    s_mov_b32 s19, 0x20000
    s_and_b32 s44, s28, 1
    s_lshr_b32 s45, s28, 1
    s_lshl_b32 s40, s44, 2
    v_add_u32 v3, s40, v5
    v_and_b32 v4, 7, v8
    v_xor_b32 v3, v3, v4
    v_lshlrev_b32 v3, 4, v3
    v_lshl_add_u32 v3, v8, 8, v3
    s_mul_i32 s41, s45, 4096
    s_add_u32 s41, s41, 43008
    v_add_u32 v226, s41, v3
    v_lshl_add_u32 v3, v5, 2, v6
    v_and_b32 v4, 7, v3
    v_add_u32 v228, s40, v7
    v_xor_b32 v4, v4, v228
    v_lshlrev_b32 v4, 4, v4
    v_lshl_add_u32 v3, v3, 8, v4
    s_add_u32 s41, s41, 36864
    v_add_u32 v227, s41, v3
    v_and_b32 v3, 7, v8
    v_add_u32 v4, 1, v3
    s_or_b32 s40, s25, s45
    s_cmp_eq_u32 s40, 0
    s_cselect_b32 s40, 8, 0
    v_cmp_gt_u32 vcc, 8, v8
    v_mov_b32 v21, s40
    s_mov_b64 s[56:57], vcc
    v_cndmask_b32 v21, 0, v21, vcc
    v_max_u32 v4, v4, v21
    v_add_u32 v3, 8, v3
    v_sub_u32 v3, v3, v4
    v_lshlrev_b32 v21, 2, v5
    v_sub_u32 v21, v21, v4
    v_mov_b32 v22, 0xf149f2ca
    v_add_u32 v23, 0, v21
    v_cmp_ge_u32 vcc, v3, v23
    s_nop 1
    v_cndmask_b32 v228, v22, 0, vcc
    v_add_u32 v23, 1, v21
    v_cmp_ge_u32 vcc, v3, v23
    s_nop 1
    v_cndmask_b32 v229, v22, 0, vcc
    v_add_u32 v23, 2, v21
    v_cmp_ge_u32 vcc, v3, v23
    s_nop 1
    v_cndmask_b32 v230, v22, 0, vcc
    v_add_u32 v23, 3, v21
    v_cmp_ge_u32 vcc, v3, v23
    s_nop 1
    v_cndmask_b32 v231, v22, 0, vcc
    s_lshl_b32 s40, s25, 7
    s_lshl_b32 s41, s45, 5
    s_add_u32 s40, s40, s41
    s_lshl_b32 s40, s40, 11
    s_lshl_b32 s41, s24, 7
    s_add_u32 s40, s40, s41
    s_lshl_b32 s41, s44, 6
    s_add_u32 s40, s40, s41
    v_lshlrev_b32 v225, 12, v8
    v_lshl_add_u32 v225, v5, 4, v225
    v_add_u32 v225, s40, v225
    s_mov_b32 s58, 0x3e3504f3
    s_mov_b32 s59, 0x3fb8aa3b
.p2align 3
g1_cloop:
    s_barrier
g1_cloop2:
    v_mfma_f32_16x16x32_bf16 v[24:27], v[172:175], v[196:199], v[24:27]
    ds_read_b64_tr_b16 v[128:129], v10 offset:0
    ds_read_b64_tr_b16 v[130:131], v10 offset:512
    v_mfma_f32_16x16x32_bf16 v[28:31], v[172:175], v[200:203], v[28:31]
    ds_read_b128 v[152:155], v16 offset:0
    v_mfma_f32_16x16x32_bf16 v[32:35], v[172:175], v[204:207], v[32:35]
    ds_read_b128 v[156:159], v16 offset:2048
    v_mfma_f32_16x16x32_bf16 v[36:39], v[172:175], v[208:211], v[36:39]
    ds_read_b128 v[160:163], v16 offset:4096
    v_mfma_f32_16x16x32_bf16 v[40:43], v[176:179], v[196:199], v[40:43]
    ds_read_b128 v[164:167], v16 offset:6144
    v_mfma_f32_16x16x32_bf16 v[44:47], v[176:179], v[200:203], v[44:47]
    ds_read_b64_tr_b16 v[132:133], v11 offset:0
    ds_read_b64_tr_b16 v[134:135], v11 offset:512
    v_mfma_f32_16x16x32_bf16 v[48:51], v[176:179], v[204:207], v[48:51]
    ds_read_b64_tr_b16 v[136:137], v12 offset:0
    ds_read_b64_tr_b16 v[138:139], v12 offset:512
    v_mfma_f32_16x16x32_bf16 v[52:55], v[176:179], v[208:211], v[52:55]
    ds_read_b64_tr_b16 v[140:141], v13 offset:0
    ds_read_b64_tr_b16 v[142:143], v13 offset:512
    v_mfma_f32_16x16x32_bf16 v[56:59], v[180:183], v[196:199], v[56:59]
    ds_read_b64_tr_b16 v[144:145], v14 offset:0
    ds_read_b64_tr_b16 v[146:147], v14 offset:512
    v_mfma_f32_16x16x32_bf16 v[60:63], v[180:183], v[200:203], v[60:63]
    ds_read_b64_tr_b16 v[148:149], v15 offset:0
    ds_read_b64_tr_b16 v[150:151], v15 offset:512
    v_mfma_f32_16x16x32_bf16 v[64:67], v[180:183], v[204:207], v[64:67]
    ds_read_b128 v[168:171], v18 offset:0
    v_mfma_f32_16x16x32_bf16 v[68:71], v[180:183], v[208:211], v[68:71]
    v_mfma_f32_16x16x32_bf16 v[72:75], v[184:187], v[196:199], v[72:75]
    v_mfma_f32_16x16x32_bf16 v[76:79], v[184:187], v[200:203], v[76:79]
    v_mfma_f32_16x16x32_bf16 v[80:83], v[184:187], v[204:207], v[80:83]
    v_mfma_f32_16x16x32_bf16 v[84:87], v[184:187], v[208:211], v[84:87]
    v_mfma_f32_16x16x32_bf16 v[88:91], v[188:191], v[196:199], v[88:91]
    v_mfma_f32_16x16x32_bf16 v[92:95], v[188:191], v[200:203], v[92:95]
    v_mfma_f32_16x16x32_bf16 v[96:99], v[188:191], v[204:207], v[96:99]
    v_mfma_f32_16x16x32_bf16 v[100:103], v[188:191], v[208:211], v[100:103]
    v_mfma_f32_16x16x32_bf16 v[104:107], v[192:195], v[196:199], v[104:107]
    v_mfma_f32_16x16x32_bf16 v[108:111], v[192:195], v[200:203], v[108:111]
    v_mfma_f32_16x16x32_bf16 v[112:115], v[192:195], v[204:207], v[112:115]
    v_mfma_f32_16x16x32_bf16 v[116:119], v[192:195], v[208:211], v[116:119]
    v_mfma_f32_16x16x32_bf16 v[120:123], v[188:191], v[212:215], v[120:123]
    v_mfma_f32_16x16x32_bf16 v[124:127], v[192:195], v[212:215], v[124:127]
    s_waitcnt lgkmcnt(0)
    v_mfma_f32_16x16x32_bf16 v[24:27], v[128:131], v[152:155], v[24:27]
    ds_read_b64_tr_b16 v[172:173], v10 offset:4096
    ds_read_b64_tr_b16 v[174:175], v10 offset:4608
    v_mfma_f32_16x16x32_bf16 v[28:31], v[128:131], v[156:159], v[28:31]
    ds_read_b128 v[196:199], v17 offset:0
    v_mfma_f32_16x16x32_bf16 v[32:35], v[128:131], v[160:163], v[32:35]
    ds_read_b128 v[200:203], v17 offset:2048
    v_mfma_f32_16x16x32_bf16 v[36:39], v[128:131], v[164:167], v[36:39]
    ds_read_b128 v[204:207], v17 offset:4096
    v_mfma_f32_16x16x32_bf16 v[40:43], v[132:135], v[152:155], v[40:43]
    ds_read_b128 v[208:211], v17 offset:6144
    v_mfma_f32_16x16x32_bf16 v[44:47], v[132:135], v[156:159], v[44:47]
    ds_read_b64_tr_b16 v[176:177], v11 offset:4096
    ds_read_b64_tr_b16 v[178:179], v11 offset:4608
    v_mfma_f32_16x16x32_bf16 v[48:51], v[132:135], v[160:163], v[48:51]
    ds_read_b64_tr_b16 v[180:181], v12 offset:4096
    ds_read_b64_tr_b16 v[182:183], v12 offset:4608
    v_mfma_f32_16x16x32_bf16 v[52:55], v[132:135], v[164:167], v[52:55]
    ds_read_b64_tr_b16 v[184:185], v13 offset:4096
    ds_read_b64_tr_b16 v[186:187], v13 offset:4608
    v_mfma_f32_16x16x32_bf16 v[56:59], v[136:139], v[152:155], v[56:59]
    ds_read_b64_tr_b16 v[188:189], v14 offset:4096
    ds_read_b64_tr_b16 v[190:191], v14 offset:4608
    v_mfma_f32_16x16x32_bf16 v[60:63], v[136:139], v[156:159], v[60:63]
    ds_read_b64_tr_b16 v[192:193], v15 offset:4096
    ds_read_b64_tr_b16 v[194:195], v15 offset:4608
    v_mfma_f32_16x16x32_bf16 v[64:67], v[136:139], v[160:163], v[64:67]
    ds_read_b128 v[212:215], v19 offset:0
    v_mfma_f32_16x16x32_bf16 v[68:71], v[136:139], v[164:167], v[68:71]
    s_add_u32 s50, s50, 1
    s_cmp_eq_u32 s50, 3
    v_mfma_f32_16x16x32_bf16 v[72:75], v[140:143], v[152:155], v[72:75]
    s_cselect_b32 s49, s29, s51
    s_cselect_b32 s50, 0, s50
    v_mfma_f32_16x16x32_bf16 v[76:79], v[140:143], v[156:159], v[76:79]
    v_add_u32 v10, s49, v10
    v_add_u32 v11, s49, v11
    v_mfma_f32_16x16x32_bf16 v[80:83], v[140:143], v[160:163], v[80:83]
    v_add_u32 v12, s49, v12
    v_add_u32 v13, s49, v13
    v_mfma_f32_16x16x32_bf16 v[84:87], v[140:143], v[164:167], v[84:87]
    v_add_u32 v14, s49, v14
    v_add_u32 v15, s49, v15
    v_mfma_f32_16x16x32_bf16 v[88:91], v[144:147], v[152:155], v[88:91]
    v_add_u32 v16, s49, v16
    v_add_u32 v17, s49, v17
    v_mfma_f32_16x16x32_bf16 v[92:95], v[144:147], v[156:159], v[92:95]
    v_add_u32 v18, s49, v18
    v_add_u32 v19, s49, v19
    v_mfma_f32_16x16x32_bf16 v[96:99], v[144:147], v[160:163], v[96:99]
    s_sub_u32 s48, s48, 1
    s_cmp_lg_u32 s48, 0
    v_mfma_f32_16x16x32_bf16 v[100:103], v[144:147], v[164:167], v[100:103]
    v_mfma_f32_16x16x32_bf16 v[104:107], v[148:151], v[152:155], v[104:107]
    v_mfma_f32_16x16x32_bf16 v[108:111], v[148:151], v[156:159], v[108:111]
    v_mfma_f32_16x16x32_bf16 v[112:115], v[148:151], v[160:163], v[112:115]
    v_mfma_f32_16x16x32_bf16 v[116:119], v[148:151], v[164:167], v[116:119]
    v_mfma_f32_16x16x32_bf16 v[120:123], v[144:147], v[168:171], v[120:123]
    v_mfma_f32_16x16x32_bf16 v[124:127], v[148:151], v[168:171], v[124:127]
    s_waitcnt lgkmcnt(0)
    s_cbranch_scc1 g1_cloop
    ds_read_b64 v[128:129], v216 offset:0
    ds_read_b64 v[130:131], v216 offset:128
    ds_read_b64 v[132:133], v216 offset:256
    ds_read_b64 v[134:135], v216 offset:384
    ds_read_b64 v[136:137], v217
    ds_read_b128 v[140:143], v218 offset:0
    ds_read_b128 v[144:147], v218 offset:64
    ds_read_b128 v[148:151], v219 offset:0
    ds_read_b128 v[152:155], v219 offset:64
    ds_read_b128 v[156:159], v220 offset:0
    ds_read_b128 v[160:163], v220 offset:64
    v_mfma_f32_16x16x32_bf16 v[24:27], v[172:175], v[196:199], v[24:27]
    v_mfma_f32_16x16x32_bf16 v[40:43], v[176:179], v[196:199], v[40:43]
    v_mfma_f32_16x16x32_bf16 v[28:31], v[172:175], v[200:203], v[28:31]
    v_mfma_f32_16x16x32_bf16 v[44:47], v[176:179], v[200:203], v[44:47]
    v_mfma_f32_16x16x32_bf16 v[32:35], v[172:175], v[204:207], v[32:35]
    v_mfma_f32_16x16x32_bf16 v[48:51], v[176:179], v[204:207], v[48:51]
    s_waitcnt lgkmcnt(0)
    v_mfma_f32_16x16x32_bf16 v[36:39], v[172:175], v[208:211], v[36:39]
    v_pk_mul_f32 v[164:165], v[140:141], v[128:129] op_sel:[0,1] op_sel_hi:[1,1]
    v_pk_mul_f32 v[166:167], v[142:143], v[128:129] op_sel:[0,1] op_sel_hi:[1,1]
    v_pk_mul_f32 v[168:169], v[144:145], v[128:129] op_sel:[0,1] op_sel_hi:[1,1]
    v_pk_mul_f32 v[170:171], v[146:147], v[128:129] op_sel:[0,1] op_sel_hi:[1,1]
    v_pk_fma_f32 v[24:25], v[24:25], v[128:129], v[164:165] op_sel:[0,0,0] op_sel_hi:[1,0,1]
    v_pk_fma_f32 v[26:27], v[26:27], v[128:129], v[166:167] op_sel:[0,0,0] op_sel_hi:[1,0,1]
    v_pk_fma_f32 v[40:41], v[40:41], v[128:129], v[168:169] op_sel:[0,0,0] op_sel_hi:[1,0,1]
    v_pk_fma_f32 v[42:43], v[42:43], v[128:129], v[170:171] op_sel:[0,0,0] op_sel_hi:[1,0,1]
    v_mfma_f32_16x16x32_bf16 v[52:55], v[176:179], v[208:211], v[52:55]
    v_cvt_pk_bf16_f32 v232, v24, v25
    v_cvt_pk_bf16_f32 v233, v26, v27
    v_cvt_pk_bf16_f32 v234, v40, v41
    v_cvt_pk_bf16_f32 v235, v42, v43
    s_nop 1
    v_permlane16_swap_b32 v232, v234
    v_permlane16_swap_b32 v233, v235
    ds_write_b128 v221, v[232:235] offset:0
    v_mfma_f32_16x16x32_bf16 v[56:59], v[180:183], v[196:199], v[56:59]
    v_pk_mul_f32 v[164:165], v[140:141], v[130:131] op_sel:[0,1] op_sel_hi:[1,1]
    v_pk_mul_f32 v[166:167], v[142:143], v[130:131] op_sel:[0,1] op_sel_hi:[1,1]
    v_pk_mul_f32 v[168:169], v[144:145], v[130:131] op_sel:[0,1] op_sel_hi:[1,1]
    v_pk_mul_f32 v[170:171], v[146:147], v[130:131] op_sel:[0,1] op_sel_hi:[1,1]
    v_pk_fma_f32 v[28:29], v[28:29], v[130:131], v[164:165] op_sel:[0,0,0] op_sel_hi:[1,0,1]
    v_pk_fma_f32 v[30:31], v[30:31], v[130:131], v[166:167] op_sel:[0,0,0] op_sel_hi:[1,0,1]
    v_pk_fma_f32 v[44:45], v[44:45], v[130:131], v[168:169] op_sel:[0,0,0] op_sel_hi:[1,0,1]
    v_pk_fma_f32 v[46:47], v[46:47], v[130:131], v[170:171] op_sel:[0,0,0] op_sel_hi:[1,0,1]
    v_mfma_f32_16x16x32_bf16 v[72:75], v[184:187], v[196:199], v[72:75]
    v_cvt_pk_bf16_f32 v236, v28, v29
    v_cvt_pk_bf16_f32 v237, v30, v31
    v_cvt_pk_bf16_f32 v238, v44, v45
    v_cvt_pk_bf16_f32 v239, v46, v47
    s_nop 1
    v_permlane16_swap_b32 v236, v238
    v_permlane16_swap_b32 v237, v239
    ds_write_b128 v221, v[236:239] offset:2048
    v_mfma_f32_16x16x32_bf16 v[60:63], v[180:183], v[200:203], v[60:63]
    v_pk_mul_f32 v[164:165], v[140:141], v[132:133] op_sel:[0,1] op_sel_hi:[1,1]
    v_pk_mul_f32 v[166:167], v[142:143], v[132:133] op_sel:[0,1] op_sel_hi:[1,1]
    v_pk_mul_f32 v[168:169], v[144:145], v[132:133] op_sel:[0,1] op_sel_hi:[1,1]
    v_pk_mul_f32 v[170:171], v[146:147], v[132:133] op_sel:[0,1] op_sel_hi:[1,1]
    v_pk_fma_f32 v[32:33], v[32:33], v[132:133], v[164:165] op_sel:[0,0,0] op_sel_hi:[1,0,1]
    v_pk_fma_f32 v[34:35], v[34:35], v[132:133], v[166:167] op_sel:[0,0,0] op_sel_hi:[1,0,1]
    v_pk_fma_f32 v[48:49], v[48:49], v[132:133], v[168:169] op_sel:[0,0,0] op_sel_hi:[1,0,1]
    v_pk_fma_f32 v[50:51], v[50:51], v[132:133], v[170:171] op_sel:[0,0,0] op_sel_hi:[1,0,1]
    v_mfma_f32_16x16x32_bf16 v[76:79], v[184:187], v[200:203], v[76:79]
    v_cvt_pk_bf16_f32 v240, v32, v33
    v_cvt_pk_bf16_f32 v241, v34, v35
    v_cvt_pk_bf16_f32 v242, v48, v49
    v_cvt_pk_bf16_f32 v243, v50, v51
    s_nop 1
    v_permlane16_swap_b32 v240, v242
    v_permlane16_swap_b32 v241, v243
    ds_write_b128 v221, v[240:243] offset:4096
    v_mfma_f32_16x16x32_bf16 v[64:67], v[180:183], v[204:207], v[64:67]
    v_pk_mul_f32 v[164:165], v[140:141], v[134:135] op_sel:[0,1] op_sel_hi:[1,1]
    v_pk_mul_f32 v[166:167], v[142:143], v[134:135] op_sel:[0,1] op_sel_hi:[1,1]
    v_pk_mul_f32 v[168:169], v[144:145], v[134:135] op_sel:[0,1] op_sel_hi:[1,1]
    v_pk_mul_f32 v[170:171], v[146:147], v[134:135] op_sel:[0,1] op_sel_hi:[1,1]
    v_pk_fma_f32 v[36:37], v[36:37], v[134:135], v[164:165] op_sel:[0,0,0] op_sel_hi:[1,0,1]
    v_pk_fma_f32 v[38:39], v[38:39], v[134:135], v[166:167] op_sel:[0,0,0] op_sel_hi:[1,0,1]
    v_pk_fma_f32 v[52:53], v[52:53], v[134:135], v[168:169] op_sel:[0,0,0] op_sel_hi:[1,0,1]
    v_pk_fma_f32 v[54:55], v[54:55], v[134:135], v[170:171] op_sel:[0,0,0] op_sel_hi:[1,0,1]
    v_mfma_f32_16x16x32_bf16 v[80:83], v[184:187], v[204:207], v[80:83]
    v_cvt_pk_bf16_f32 v244, v36, v37
    v_cvt_pk_bf16_f32 v245, v38, v39
    v_cvt_pk_bf16_f32 v246, v52, v53
    v_cvt_pk_bf16_f32 v247, v54, v55
    s_nop 1
    v_permlane16_swap_b32 v244, v246
    v_permlane16_swap_b32 v245, v247
    ds_write_b128 v221, v[244:247] offset:6144
    v_mfma_f32_16x16x32_bf16 v[68:71], v[180:183], v[208:211], v[68:71]
    v_pk_mul_f32 v[164:165], v[148:149], v[128:129] op_sel:[0,1] op_sel_hi:[1,1]
    v_pk_mul_f32 v[166:167], v[150:151], v[128:129] op_sel:[0,1] op_sel_hi:[1,1]
    v_pk_mul_f32 v[168:169], v[152:153], v[128:129] op_sel:[0,1] op_sel_hi:[1,1]
    v_pk_mul_f32 v[170:171], v[154:155], v[128:129] op_sel:[0,1] op_sel_hi:[1,1]
    v_pk_fma_f32 v[56:57], v[56:57], v[128:129], v[164:165] op_sel:[0,0,0] op_sel_hi:[1,0,1]
    v_pk_fma_f32 v[58:59], v[58:59], v[128:129], v[166:167] op_sel:[0,0,0] op_sel_hi:[1,0,1]
    v_pk_fma_f32 v[72:73], v[72:73], v[128:129], v[168:169] op_sel:[0,0,0] op_sel_hi:[1,0,1]
    v_pk_fma_f32 v[74:75], v[74:75], v[128:129], v[170:171] op_sel:[0,0,0] op_sel_hi:[1,0,1]
    v_mfma_f32_16x16x32_bf16 v[84:87], v[184:187], v[208:211], v[84:87]
    v_cvt_pk_bf16_f32 v232, v56, v57
    v_cvt_pk_bf16_f32 v233, v58, v59
    v_cvt_pk_bf16_f32 v234, v72, v73
    v_cvt_pk_bf16_f32 v235, v74, v75
    s_nop 1
    v_permlane16_swap_b32 v232, v234
    v_permlane16_swap_b32 v233, v235
    ds_write_b128 v222, v[232:235] offset:0
    v_mfma_f32_16x16x32_bf16 v[88:91], v[188:191], v[196:199], v[88:91]
    v_pk_mul_f32 v[164:165], v[148:149], v[130:131] op_sel:[0,1] op_sel_hi:[1,1]
    v_pk_mul_f32 v[166:167], v[150:151], v[130:131] op_sel:[0,1] op_sel_hi:[1,1]
    v_pk_mul_f32 v[168:169], v[152:153], v[130:131] op_sel:[0,1] op_sel_hi:[1,1]
    v_pk_mul_f32 v[170:171], v[154:155], v[130:131] op_sel:[0,1] op_sel_hi:[1,1]
    v_pk_fma_f32 v[60:61], v[60:61], v[130:131], v[164:165] op_sel:[0,0,0] op_sel_hi:[1,0,1]
    v_pk_fma_f32 v[62:63], v[62:63], v[130:131], v[166:167] op_sel:[0,0,0] op_sel_hi:[1,0,1]
    v_pk_fma_f32 v[76:77], v[76:77], v[130:131], v[168:169] op_sel:[0,0,0] op_sel_hi:[1,0,1]
    v_pk_fma_f32 v[78:79], v[78:79], v[130:131], v[170:171] op_sel:[0,0,0] op_sel_hi:[1,0,1]
    v_mfma_f32_16x16x32_bf16 v[104:107], v[192:195], v[196:199], v[104:107]
    v_cvt_pk_bf16_f32 v236, v60, v61
    v_cvt_pk_bf16_f32 v237, v62, v63
    v_cvt_pk_bf16_f32 v238, v76, v77
    v_cvt_pk_bf16_f32 v239, v78, v79
    s_nop 1
    v_permlane16_swap_b32 v236, v238
    v_permlane16_swap_b32 v237, v239
    ds_write_b128 v222, v[236:239] offset:2048
    v_mfma_f32_16x16x32_bf16 v[92:95], v[188:191], v[200:203], v[92:95]
    v_pk_mul_f32 v[164:165], v[148:149], v[132:133] op_sel:[0,1] op_sel_hi:[1,1]
    v_pk_mul_f32 v[166:167], v[150:151], v[132:133] op_sel:[0,1] op_sel_hi:[1,1]
    v_pk_mul_f32 v[168:169], v[152:153], v[132:133] op_sel:[0,1] op_sel_hi:[1,1]
    v_pk_mul_f32 v[170:171], v[154:155], v[132:133] op_sel:[0,1] op_sel_hi:[1,1]
    v_pk_fma_f32 v[64:65], v[64:65], v[132:133], v[164:165] op_sel:[0,0,0] op_sel_hi:[1,0,1]
    v_pk_fma_f32 v[66:67], v[66:67], v[132:133], v[166:167] op_sel:[0,0,0] op_sel_hi:[1,0,1]
    v_pk_fma_f32 v[80:81], v[80:81], v[132:133], v[168:169] op_sel:[0,0,0] op_sel_hi:[1,0,1]
    v_pk_fma_f32 v[82:83], v[82:83], v[132:133], v[170:171] op_sel:[0,0,0] op_sel_hi:[1,0,1]
    v_mfma_f32_16x16x32_bf16 v[108:111], v[192:195], v[200:203], v[108:111]
    v_cvt_pk_bf16_f32 v240, v64, v65
    v_cvt_pk_bf16_f32 v241, v66, v67
    v_cvt_pk_bf16_f32 v242, v80, v81
    v_cvt_pk_bf16_f32 v243, v82, v83
    s_nop 1
    v_permlane16_swap_b32 v240, v242
    v_permlane16_swap_b32 v241, v243
    ds_write_b128 v222, v[240:243] offset:4096
    v_mfma_f32_16x16x32_bf16 v[96:99], v[188:191], v[204:207], v[96:99]
    v_pk_mul_f32 v[164:165], v[148:149], v[134:135] op_sel:[0,1] op_sel_hi:[1,1]
    v_pk_mul_f32 v[166:167], v[150:151], v[134:135] op_sel:[0,1] op_sel_hi:[1,1]
    v_pk_mul_f32 v[168:169], v[152:153], v[134:135] op_sel:[0,1] op_sel_hi:[1,1]
    v_pk_mul_f32 v[170:171], v[154:155], v[134:135] op_sel:[0,1] op_sel_hi:[1,1]
    v_pk_fma_f32 v[68:69], v[68:69], v[134:135], v[164:165] op_sel:[0,0,0] op_sel_hi:[1,0,1]
    v_pk_fma_f32 v[70:71], v[70:71], v[134:135], v[166:167] op_sel:[0,0,0] op_sel_hi:[1,0,1]
    v_pk_fma_f32 v[84:85], v[84:85], v[134:135], v[168:169] op_sel:[0,0,0] op_sel_hi:[1,0,1]
    v_pk_fma_f32 v[86:87], v[86:87], v[134:135], v[170:171] op_sel:[0,0,0] op_sel_hi:[1,0,1]
    v_mfma_f32_16x16x32_bf16 v[112:115], v[192:195], v[204:207], v[112:115]
    v_cvt_pk_bf16_f32 v244, v68, v69
    v_cvt_pk_bf16_f32 v245, v70, v71
    v_cvt_pk_bf16_f32 v246, v84, v85
    v_cvt_pk_bf16_f32 v247, v86, v87
    s_nop 1
    v_permlane16_swap_b32 v244, v246
    v_permlane16_swap_b32 v245, v247
    ds_write_b128 v222, v[244:247] offset:6144
    v_mfma_f32_16x16x32_bf16 v[100:103], v[188:191], v[208:211], v[100:103]
    v_pk_mul_f32 v[164:165], v[156:157], v[128:129] op_sel:[0,1] op_sel_hi:[1,1]
    v_pk_mul_f32 v[166:167], v[158:159], v[128:129] op_sel:[0,1] op_sel_hi:[1,1]
    v_pk_mul_f32 v[168:169], v[160:161], v[128:129] op_sel:[0,1] op_sel_hi:[1,1]
    v_pk_mul_f32 v[170:171], v[162:163], v[128:129] op_sel:[0,1] op_sel_hi:[1,1]
    v_pk_fma_f32 v[88:89], v[88:89], v[128:129], v[164:165] op_sel:[0,0,0] op_sel_hi:[1,0,1]
    v_pk_fma_f32 v[90:91], v[90:91], v[128:129], v[166:167] op_sel:[0,0,0] op_sel_hi:[1,0,1]
    v_pk_fma_f32 v[104:105], v[104:105], v[128:129], v[168:169] op_sel:[0,0,0] op_sel_hi:[1,0,1]
    v_pk_fma_f32 v[106:107], v[106:107], v[128:129], v[170:171] op_sel:[0,0,0] op_sel_hi:[1,0,1]
    v_mfma_f32_16x16x32_bf16 v[116:119], v[192:195], v[208:211], v[116:119]
    v_cvt_pk_bf16_f32 v232, v88, v89
    v_cvt_pk_bf16_f32 v233, v90, v91
    v_cvt_pk_bf16_f32 v234, v104, v105
    v_cvt_pk_bf16_f32 v235, v106, v107
    s_nop 1
    v_permlane16_swap_b32 v232, v234
    v_permlane16_swap_b32 v233, v235
    ds_write_b128 v223, v[232:235] offset:0
    v_mfma_f32_16x16x32_bf16 v[120:123], v[188:191], v[212:215], v[120:123]
    v_pk_mul_f32 v[164:165], v[156:157], v[130:131] op_sel:[0,1] op_sel_hi:[1,1]
    v_pk_mul_f32 v[166:167], v[158:159], v[130:131] op_sel:[0,1] op_sel_hi:[1,1]
    v_pk_mul_f32 v[168:169], v[160:161], v[130:131] op_sel:[0,1] op_sel_hi:[1,1]
    v_pk_mul_f32 v[170:171], v[162:163], v[130:131] op_sel:[0,1] op_sel_hi:[1,1]
    v_pk_fma_f32 v[92:93], v[92:93], v[130:131], v[164:165] op_sel:[0,0,0] op_sel_hi:[1,0,1]
    v_pk_fma_f32 v[94:95], v[94:95], v[130:131], v[166:167] op_sel:[0,0,0] op_sel_hi:[1,0,1]
    v_pk_fma_f32 v[108:109], v[108:109], v[130:131], v[168:169] op_sel:[0,0,0] op_sel_hi:[1,0,1]
    v_pk_fma_f32 v[110:111], v[110:111], v[130:131], v[170:171] op_sel:[0,0,0] op_sel_hi:[1,0,1]
    v_mfma_f32_16x16x32_bf16 v[124:127], v[192:195], v[212:215], v[124:127]
    v_cvt_pk_bf16_f32 v236, v92, v93
    v_cvt_pk_bf16_f32 v237, v94, v95
    v_cvt_pk_bf16_f32 v238, v108, v109
    v_cvt_pk_bf16_f32 v239, v110, v111
    s_nop 1
    v_permlane16_swap_b32 v236, v238
    v_permlane16_swap_b32 v237, v239
    ds_write_b128 v223, v[236:239] offset:2048
    v_pk_mul_f32 v[164:165], v[156:157], v[132:133] op_sel:[0,1] op_sel_hi:[1,1]
    v_pk_mul_f32 v[166:167], v[158:159], v[132:133] op_sel:[0,1] op_sel_hi:[1,1]
    v_pk_mul_f32 v[168:169], v[160:161], v[132:133] op_sel:[0,1] op_sel_hi:[1,1]
    v_pk_mul_f32 v[170:171], v[162:163], v[132:133] op_sel:[0,1] op_sel_hi:[1,1]
    v_pk_fma_f32 v[96:97], v[96:97], v[132:133], v[164:165] op_sel:[0,0,0] op_sel_hi:[1,0,1]
    v_pk_fma_f32 v[98:99], v[98:99], v[132:133], v[166:167] op_sel:[0,0,0] op_sel_hi:[1,0,1]
    v_pk_fma_f32 v[112:113], v[112:113], v[132:133], v[168:169] op_sel:[0,0,0] op_sel_hi:[1,0,1]
    v_pk_fma_f32 v[114:115], v[114:115], v[132:133], v[170:171] op_sel:[0,0,0] op_sel_hi:[1,0,1]
    v_cvt_pk_bf16_f32 v240, v96, v97
    v_cvt_pk_bf16_f32 v241, v98, v99
    v_cvt_pk_bf16_f32 v242, v112, v113
    v_cvt_pk_bf16_f32 v243, v114, v115
    s_nop 1
    v_permlane16_swap_b32 v240, v242
    v_permlane16_swap_b32 v241, v243
    ds_write_b128 v223, v[240:243] offset:4096
    v_pk_mul_f32 v[164:165], v[156:157], v[134:135] op_sel:[0,1] op_sel_hi:[1,1]
    v_pk_mul_f32 v[166:167], v[158:159], v[134:135] op_sel:[0,1] op_sel_hi:[1,1]
    v_pk_mul_f32 v[168:169], v[160:161], v[134:135] op_sel:[0,1] op_sel_hi:[1,1]
    v_pk_mul_f32 v[170:171], v[162:163], v[134:135] op_sel:[0,1] op_sel_hi:[1,1]
    v_pk_fma_f32 v[100:101], v[100:101], v[134:135], v[164:165] op_sel:[0,0,0] op_sel_hi:[1,0,1]
    v_pk_fma_f32 v[102:103], v[102:103], v[134:135], v[166:167] op_sel:[0,0,0] op_sel_hi:[1,0,1]
    v_pk_fma_f32 v[116:117], v[116:117], v[134:135], v[168:169] op_sel:[0,0,0] op_sel_hi:[1,0,1]
    v_pk_fma_f32 v[118:119], v[118:119], v[134:135], v[170:171] op_sel:[0,0,0] op_sel_hi:[1,0,1]
    v_cvt_pk_bf16_f32 v244, v100, v101
    v_cvt_pk_bf16_f32 v245, v102, v103
    v_cvt_pk_bf16_f32 v246, v116, v117
    v_cvt_pk_bf16_f32 v247, v118, v119
    s_nop 1
    v_permlane16_swap_b32 v244, v246
    v_permlane16_swap_b32 v245, v247
    ds_write_b128 v223, v[244:247] offset:6144
    v_pk_mul_f32 v[164:165], v[156:157], v[136:137] op_sel:[0,1] op_sel_hi:[1,1]
    v_pk_mul_f32 v[166:167], v[158:159], v[136:137] op_sel:[0,1] op_sel_hi:[1,1]
    v_pk_mul_f32 v[168:169], v[160:161], v[136:137] op_sel:[0,1] op_sel_hi:[1,1]
    v_pk_mul_f32 v[170:171], v[162:163], v[136:137] op_sel:[0,1] op_sel_hi:[1,1]
    v_pk_fma_f32 v[120:121], v[120:121], v[136:137], v[164:165] op_sel:[0,0,0] op_sel_hi:[1,0,1]
    v_pk_fma_f32 v[122:123], v[122:123], v[136:137], v[166:167] op_sel:[0,0,0] op_sel_hi:[1,0,1]
    v_pk_fma_f32 v[124:125], v[124:125], v[136:137], v[168:169] op_sel:[0,0,0] op_sel_hi:[1,0,1]
    v_pk_fma_f32 v[126:127], v[126:127], v[136:137], v[170:171] op_sel:[0,0,0] op_sel_hi:[1,0,1]
    v_cvt_pk_bf16_f32 v232, v120, v121
    v_cvt_pk_bf16_f32 v233, v122, v123
    v_cvt_pk_bf16_f32 v234, v124, v125
    v_cvt_pk_bf16_f32 v235, v126, v127
    s_nop 1
    v_permlane16_swap_b32 v232, v234
    v_permlane16_swap_b32 v233, v235
    ds_write_b128 v224, v[232:235]
    s_waitcnt lgkmcnt(0)
g1_attn:
    s_barrier
    ds_read_b128 v[24:27], v226 offset:2048
    ds_read_b128 v[28:31], v226 offset:18432
    ds_read_b128 v[32:35], v226 offset:20480
    ds_read_b128 v[72:75], v226 offset:2176
    ds_read_b128 v[76:79], v226 offset:18560
    ds_read_b128 v[80:83], v226 offset:20608
    ds_read_b64_tr_b16 v[36:37], v227 offset:0
    ds_read_b64_tr_b16 v[38:39], v227 offset:2048
    ds_read_b64_tr_b16 v[40:41], v227 offset:8
    ds_read_b64_tr_b16 v[42:43], v227 offset:2056
    ds_read_b64_tr_b16 v[84:85], v227 offset:128
    ds_read_b64_tr_b16 v[86:87], v227 offset:2176
    ds_read_b64_tr_b16 v[88:89], v227 offset:136
    ds_read_b64_tr_b16 v[90:91], v227 offset:2184
    s_waitcnt lgkmcnt(8)
    v_mfma_f32_16x16x32_bf16 v[44:47], v[28:31], v[24:27], 0
    v_mfma_f32_16x16x32_bf16 v[48:51], v[32:35], v[24:27], 0
    v_mfma_f32_16x16x32_bf16 v[92:95], v[76:79], v[72:75], 0
    v_mfma_f32_16x16x32_bf16 v[96:99], v[80:83], v[72:75], 0
    s_nop 7
    v_cndmask_b32 v44, v48, v44, s[56:57]
    v_cndmask_b32 v45, v49, v45, s[56:57]
    v_cndmask_b32 v46, v50, v46, s[56:57]
    v_cndmask_b32 v47, v51, v47, s[56:57]
    v_cndmask_b32 v92, v96, v92, s[56:57]
    v_cndmask_b32 v93, v97, v93, s[56:57]
    v_cndmask_b32 v94, v98, v94, s[56:57]
    v_cndmask_b32 v95, v99, v95, s[56:57]
    v_cvt_pk_bf16_f32 v48, v44, v45
    v_cvt_pk_bf16_f32 v49, v46, v47
    v_cvt_pk_bf16_f32 v96, v92, v93
    v_cvt_pk_bf16_f32 v97, v94, v95
    v_lshlrev_b32 v44, 16, v48
    v_and_b32 v45, 0xffff0000, v48
    v_lshlrev_b32 v46, 16, v49
    v_and_b32 v47, 0xffff0000, v49
    v_lshlrev_b32 v92, 16, v96
    v_and_b32 v93, 0xffff0000, v96
    v_lshlrev_b32 v94, 16, v97
    v_and_b32 v95, 0xffff0000, v97
    v_mul_f32 v44, s58, v44
    v_mul_f32 v45, s58, v45
    v_mul_f32 v46, s58, v46
    v_mul_f32 v47, s58, v47
    v_mul_f32 v92, s58, v92
    v_mul_f32 v93, s58, v93
    v_mul_f32 v94, s58, v94
    v_mul_f32 v95, s58, v95
    v_cvt_pk_bf16_f32 v48, v44, v45
    v_cvt_pk_bf16_f32 v49, v46, v47
    v_cvt_pk_bf16_f32 v96, v92, v93
    v_cvt_pk_bf16_f32 v97, v94, v95
    v_lshlrev_b32 v44, 16, v48
    v_and_b32 v45, 0xffff0000, v48
    v_lshlrev_b32 v46, 16, v49
    v_and_b32 v47, 0xffff0000, v49
    v_lshlrev_b32 v92, 16, v96
    v_and_b32 v93, 0xffff0000, v96
    v_lshlrev_b32 v94, 16, v97
    v_and_b32 v95, 0xffff0000, v97
    v_fma_f32 v44, v44, s59, v228
    v_fma_f32 v45, v45, s59, v229
    v_fma_f32 v46, v46, s59, v230
    v_fma_f32 v47, v47, s59, v231
    v_fma_f32 v92, v92, s59, v228
    v_fma_f32 v93, v93, s59, v229
    v_fma_f32 v94, v94, s59, v230
    v_fma_f32 v95, v95, s59, v231
    v_max3_f32 v48, v44, v45, v46
    v_max3_f32 v96, v92, v93, v94
    v_max_f32 v48, v48, v47
    v_max_f32 v96, v96, v95
    v_mov_b32 v49, v48
    v_mov_b32 v97, v96
    s_nop 1
    v_permlane16_swap_b32 v48, v49
    v_permlane16_swap_b32 v96, v97
    s_nop 0
    v_max_f32 v48, v48, v49
    v_max_f32 v96, v96, v97
    v_mov_b32 v49, v48
    v_mov_b32 v97, v96
    s_nop 1
    v_permlane32_swap_b32 v48, v49
    v_permlane32_swap_b32 v96, v97
    s_nop 0
    v_max_f32 v48, v48, v49
    v_max_f32 v96, v96, v97
    v_sub_f32 v44, v44, v48
    v_sub_f32 v45, v45, v48
    v_sub_f32 v46, v46, v48
    v_sub_f32 v47, v47, v48
    v_sub_f32 v92, v92, v96
    v_sub_f32 v93, v93, v96
    v_sub_f32 v94, v94, v96
    v_sub_f32 v95, v95, v96
    v_exp_f32 v44, v44
    v_exp_f32 v45, v45
    v_exp_f32 v46, v46
    v_exp_f32 v47, v47
    v_exp_f32 v92, v92
    v_exp_f32 v93, v93
    v_exp_f32 v94, v94
    v_exp_f32 v95, v95
    v_add_f32 v48, v44, v45
    v_add_f32 v49, v46, v47
    v_add_f32 v96, v92, v93
    v_add_f32 v97, v94, v95
    v_add_f32 v48, v48, v49
    v_add_f32 v96, v96, v97
    v_mov_b32 v49, v48
    v_mov_b32 v97, v96
    s_nop 1
    v_permlane16_swap_b32 v48, v49
    v_permlane16_swap_b32 v96, v97
    s_nop 0
    v_add_f32 v48, v48, v49
    v_add_f32 v96, v96, v97
    v_mov_b32 v49, v48
    v_mov_b32 v97, v96
    s_nop 1
    v_permlane32_swap_b32 v48, v49
    v_permlane32_swap_b32 v96, v97
    s_nop 0
    v_add_f32 v48, v48, v49
    v_add_f32 v96, v96, v97
    v_rcp_f32 v48, v48
    v_rcp_f32 v96, v96
    s_nop 0
    v_mul_f32 v44, v44, v48
    v_mul_f32 v45, v45, v48
    v_mul_f32 v46, v46, v48
    v_mul_f32 v47, v47, v48
    v_mul_f32 v92, v92, v96
    v_mul_f32 v93, v93, v96
    v_mul_f32 v94, v94, v96
    v_mul_f32 v95, v95, v96
    v_cvt_pk_bf16_f32 v48, v44, v45
    v_cvt_pk_bf16_f32 v49, v46, v47
    v_cvt_pk_bf16_f32 v96, v92, v93
    v_cvt_pk_bf16_f32 v97, v94, v95
    v_cndmask_b32 v52, 0, v48, s[56:57]
    v_cndmask_b32 v53, 0, v49, s[56:57]
    v_cndmask_b32 v54, v48, 0, s[56:57]
    v_cndmask_b32 v55, v49, 0, s[56:57]
    v_cndmask_b32 v100, 0, v96, s[56:57]
    v_cndmask_b32 v101, 0, v97, s[56:57]
    v_cndmask_b32 v102, v96, 0, s[56:57]
    v_cndmask_b32 v103, v97, 0, s[56:57]
    s_waitcnt lgkmcnt(0)
    s_nop 0
    v_mfma_f32_16x16x32_bf16 v[56:59], v[36:39], v[52:55], 0
    v_mfma_f32_16x16x32_bf16 v[60:63], v[40:43], v[52:55], 0
    v_mfma_f32_16x16x32_bf16 v[104:107], v[84:87], v[100:103], 0
    v_mfma_f32_16x16x32_bf16 v[108:111], v[88:91], v[100:103], 0
    s_nop 7
    v_cvt_pk_bf16_f32 v64, v56, v57
    v_cvt_pk_bf16_f32 v65, v58, v59
    v_cvt_pk_bf16_f32 v66, v60, v61
    v_cvt_pk_bf16_f32 v67, v62, v63
    buffer_store_dwordx4 v[64:67], v225, s[16:19], 0 offen offset:0 sc1
    v_cvt_pk_bf16_f32 v112, v104, v105
    v_cvt_pk_bf16_f32 v113, v106, v107
    v_cvt_pk_bf16_f32 v114, v108, v109
    v_cvt_pk_bf16_f32 v115, v110, v111
    buffer_store_dwordx4 v[112:115], v225, s[16:19], 0 offen offset:2048 sc1
    s_add_u32 s40, s25, 0
    s_lshl_b32 s40, s40, 8
    s_add_u32 s84, s4, 0x300000
    s_addc_u32 s85, s5, 0
    s_mov_b32 s86, 0x4000
    s_mov_b32 s87, 0x20000
    v_mov_b32 v3, s40
    v_mov_b32 v4, 1
    s_waitcnt vmcnt(0)
    s_barrier
    s_cmp_lg_u32 s28, 0
    s_cbranch_scc1 g1_cin
    s_mov_b64 exec, 1
    buffer_atomic_add v4, v3, s[84:87], 0 offen sc1
    s_mov_b64 exec, -1
g1_cin:
    s_branch g2_in
g1_done:
    s_endpgm
.p2align 6
g2_in:
    s_cmp_ge_u32 s2, 256
    s_cbranch_scc1 g2_done
    s_load_dwordx2 s[4:5], s[0:1], 80
    s_load_dwordx2 s[6:7], s[0:1], 0
    s_load_dwordx2 s[30:31], s[0:1], 16
    v_lshrrev_b32 v1, 6, v0
    v_and_b32 v2, 63, v0
    s_and_b32 s40, s2, 3
    s_lshl_b32 s40, s40, 2
    s_bfe_u32 s41, s2, 0x20003
    s_add_u32 s25, s40, s41
    s_bfe_u32 s40, s2, 0x10002
    s_lshl_b32 s40, s40, 3
    s_lshr_b32 s42, s2, 5
    s_add_u32 s24, s40, s42
    s_add_u32 s27, s41, s42
    s_mov_b32 s26, 0
    v_readfirstlane_b32 s28, v1
    s_nop 0
    s_cmp_lt_u32 s28, 4
    s_cbranch_scc1 g2_compute
    s_sub_u32 s28, s28, 4
    s_mov_b32 s40, 2048
    v_lshrrev_b32 v3, 3, v2
    v_mul_lo_u32 v3, v3, s40
    v_bfe_u32 v4, v2, 4, 1
    v_lshlrev_b32 v4, 1, v4
    v_xor_b32 v4, v4, v2
    v_and_b32 v4, 7, v4
    v_lshl_add_u32 v3, v4, 4, v3
    s_mul_i32 s41, s24, 128
    s_mul_i32 s42, s28, 32768
    s_add_u32 s41, s41, s42
    v_xor_b32 v4, 64, v3
    s_add_u32 s42, s41, 0
    v_add_u32 v10, s42, v3
    s_add_u32 s42, s41, 16384
    v_add_u32 v11, s42, v4
    s_mov_b32 s40, 2048
    v_lshrrev_b32 v3, 3, v2
    v_mul_lo_u32 v3, v3, s40
    v_lshrrev_b32 v4, 4, v2
    v_xor_b32 v4, v4, v2
    v_and_b32 v4, 7, v4
    v_lshl_add_u32 v3, v4, 4, v3
    s_mul_i32 s41, s25, 262144
    s_mul_i32 s42, s28, 65536
    s_add_u32 s41, s41, s42
    v_xor_b32 v4, 64, v3
    s_add_u32 s42, s41, 0
    v_add_u32 v12, s42, v3
    s_add_u32 s42, s41, 16384
    v_add_u32 v13, s42, v4
    s_add_u32 s42, s41, 32768
    v_add_u32 v14, s42, v3
    s_add_u32 s42, s41, 49152
    v_add_u32 v15, s42, v4
    s_mul_i32 s36, s28, 2048
    s_mul_i32 s37, s28, 4096
    s_add_u32 s37, s37, 8192
    s_waitcnt lgkmcnt(0)
    s_add_u32 s4, s4, s97
    s_addc_u32 s5, s5, 0
    s_mov_b32 s8, s30
    s_mov_b32 s9, s31
    s_mov_b32 s10, 0x200000
    s_mov_b32 s11, 0x20000
    s_add_u32 s12, s4, 0x400000
    s_addc_u32 s13, s5, 0
    s_mov_b32 s14, 0x400000
    s_mov_b32 s15, 0x20000
    s_mov_b32 s32, 0
    s_mov_b32 s33, 0
g2_ld_pW:
    s_add_u32 s40, s32, s27
    s_and_b32 s40, s40, 1
    s_andn2_b32 s41, s32, 1
    s_or_b32 s40, s40, s41
    s_add_u32 s40, s40, s26
    s_mul_i32 s34, s40, 131072
    s_mul_i32 s35, s40, 128
    s_add_u32 s38, s33, s36
    s_add_u32 s39, s33, s37
    s_add_u32 m0, s38, 0
    s_nop 0
    buffer_load_dwordx4 v10, s[8:11], s34 offen lds
    s_add_u32 m0, s38, 1024
    s_nop 0
    buffer_load_dwordx4 v11, s[8:11], s34 offen lds
    s_add_u32 s33, s33, 24576
    s_add_u32 s32, s32, 1
    s_cmp_lt_u32 s32, 3
    s_cbranch_scc1 g2_ld_pW
    s_lshr_b32 s40, s25, 0
    s_add_u32 s40, s40, 0
    s_lshl_b32 s40, s40, 8
    s_mov_b32 s42, s40
    s_lshl_b32 s43, s96, 2
    s_add_u32 s43, s43, 2
    s_mov_b32 s41, 0x80000
    v_mov_b32 v24, 131072
    s_cmp_lg_u32 s28, 0
    s_cbranch_scc1 g2_dep_lds
    s_mov_b32 s41, 0x8000
    s_add_u32 s84, s4, 0x300000
    s_addc_u32 s85, s5, 0
    s_mov_b32 s86, 0x4000
    s_mov_b32 s87, 0x20000
    v_cmp_eq_u32 vcc, 1, v2
    v_mov_b32 v21, s40
    v_mov_b32 v23, s42
    v_cndmask_b32 v21, v21, v23, vcc
    v_mov_b32 v22, 16
    v_mov_b32 v23, 16
    v_cndmask_b32 v22, v22, v23, vcc
g2_dep:
    buffer_load_dword v23, v21, s[84:87], 0 offen sc1
    s_sub_u32 s41, s41, 1
    s_waitcnt vmcnt(0)
    v_cmp_lt_u32 vcc, v23, v22
    s_cmp_eq_u32 s41, 0
    s_cbranch_scc1 g2_dep_seen
    s_cbranch_vccz g2_dep_seen
    s_sleep 2
    s_branch g2_dep
g2_dep_seen:
    v_mov_b32 v23, s43
    ds_write_b32 v24, v23
    s_branch g2_dep_ok
g2_dep_lds:
    ds_read_b32 v23, v24
    s_sub_u32 s41, s41, 1
    s_waitcnt lgkmcnt(0)
    v_readfirstlane_b32 s40, v23
    s_cmp_eq_u32 s41, 0
    s_cbranch_scc1 g2_dep_ok
    s_cmp_eq_u32 s40, s43
    s_cbranch_scc1 g2_dep_ok
    s_sleep 1
    s_branch g2_dep_lds
g2_dep_ok:
    s_mov_b32 s32, 0
    s_mov_b32 s33, 0
g2_ld_pA:
    s_add_u32 s40, s32, s27
    s_and_b32 s40, s40, 1
    s_andn2_b32 s41, s32, 1
    s_or_b32 s40, s40, s41
    s_add_u32 s40, s40, s26
    s_mul_i32 s34, s40, 131072
    s_mul_i32 s35, s40, 128
    s_add_u32 s38, s33, s36
    s_add_u32 s39, s33, s37
    s_add_u32 m0, s39, 0
    s_nop 0
    buffer_load_dwordx4 v12, s[12:15], s35 offen sc1 lds
    s_add_u32 m0, s39, 1024
    s_nop 0
    buffer_load_dwordx4 v13, s[12:15], s35 offen sc1 lds
    s_add_u32 m0, s39, 2048
    s_nop 0
    buffer_load_dwordx4 v14, s[12:15], s35 offen sc1 lds
    s_add_u32 m0, s39, 3072
    s_nop 0
    buffer_load_dwordx4 v15, s[12:15], s35 offen sc1 lds
    s_add_u32 s33, s33, 24576
    s_add_u32 s32, s32, 1
    s_cmp_lt_u32 s32, 3
    s_cbranch_scc1 g2_ld_pA
    s_waitcnt vmcnt(8)
    s_branch g2_ld_bar
g2_ld_loop:
    s_cmp_eq_u32 s32, 4
    s_cbranch_scc1 g2_ld_s4
    s_waitcnt vmcnt(12)
g2_ld_bar:
    s_barrier
    s_add_u32 s40, s32, s27
    s_and_b32 s40, s40, 1
    s_andn2_b32 s41, s32, 1
    s_or_b32 s40, s40, s41
    s_add_u32 s40, s40, s26
    s_mul_i32 s34, s40, 131072
    s_mul_i32 s35, s40, 128
    s_add_u32 s38, s33, s36
    s_add_u32 s39, s33, s37
    s_add_u32 m0, s38, 0
    s_nop 0
    buffer_load_dwordx4 v10, s[8:11], s34 offen lds
    s_add_u32 m0, s38, 1024
    s_nop 0
    buffer_load_dwordx4 v11, s[8:11], s34 offen lds
    s_add_u32 m0, s39, 0
    s_nop 0
    buffer_load_dwordx4 v12, s[12:15], s35 offen sc1 lds
    s_add_u32 m0, s39, 1024
    s_nop 0
    buffer_load_dwordx4 v13, s[12:15], s35 offen sc1 lds
    s_add_u32 m0, s39, 2048
    s_nop 0
    buffer_load_dwordx4 v14, s[12:15], s35 offen sc1 lds
    s_add_u32 m0, s39, 3072
    s_nop 0
    buffer_load_dwordx4 v15, s[12:15], s35 offen sc1 lds
    s_add_u32 s33, s33, 24576
    s_add_u32 s32, s32, 1
    s_cmp_eq_u32 s33, 98304
    s_cselect_b32 s33, 0, s33
    s_cmp_lt_u32 s32, 16
    s_cbranch_scc1 g2_ld_loop
    s_waitcnt vmcnt(12)
    s_barrier
    s_waitcnt vmcnt(6)
    s_barrier
    s_waitcnt vmcnt(0)
    s_barrier
    s_branch g2_ld_end
g2_ld_s4:
    s_waitcnt vmcnt(10)
    s_branch g2_ld_bar
g2_ld_end:
    s_barrier
    s_branch g3_in
g2_done:
    s_endpgm
g2_compute:
    v_lshrrev_b32 v5, 4, v2
    v_bfe_u32 v6, v2, 2, 2
    v_and_b32 v7, 3, v2
    v_and_b32 v8, 15, v2
    s_and_b32 s44, s28, 0
    s_lshr_b32 s45, s28, 0
    s_mul_i32 s40, s25, 128
    s_mul_i32 s41, s45, 32
    s_add_u32 s40, s40, s41
    v_add_u32 v20, s40, v8
    s_mov_b32 s41, 2048
    v_mul_lo_u32 v9, v20, s41
    s_mul_i32 s40, s24, 128
    s_mul_i32 s41, s44, 128
    s_add_u32 s46, s40, s41
    v_and_b32 v3, 1, v5
    v_lshlrev_b32 v3, 5, v3
    v_lshrrev_b32 v4, 1, v5
    v_lshl_add_u32 v3, v4, 4, v3
    v_add3_u32 v9, v9, v3, s46
    s_mov_b32 s52, 0
    s_mov_b32 s53, 32768
    s_waitcnt lgkmcnt(0)
    s_add_u32 s4, s4, s97
    s_addc_u32 s5, s5, 0
    s_add_u32 s20, s4, 0x1900000
    s_addc_u32 s21, s5, 0
    s_cmp_eq_u32 s96, 1
    s_cselect_b32 s20, s20, s6
    s_cselect_b32 s21, s21, s7
    s_mov_b32 s22, 0x400000
    s_mov_b32 s23, 0x20000
    s_add_u32 s16, s4, 0x800000
    s_addc_u32 s17, s5, 0
    s_mov_b32 s18, 0x400000
    s_mov_b32 s19, 0x20000
    s_add_u32 s56, s4, 0xc00000
    s_addc_u32 s57, s5, 0
    s_mov_b32 s58, 0x480000
    s_mov_b32 s59, 0x20000
    s_add_u32 s60, s4, 0x200000
    s_addc_u32 s61, s5, 0
    s_mov_b32 s62, 0x40000
    s_mov_b32 s63, 0x20000
    s_mul_i32 s42, s44, 4
    s_mov_b32 s43, 0
    v_and_b32 v3, 1, v5
    v_lshlrev_b32 v3, 1, v3
    v_lshrrev_b32 v4, 1, v6
    v_or_b32 v3, v3, v4
    s_add_u32 s40, s42, 0
    v_xor_b32 v3, s40, v3
    v_lshlrev_b32 v3, 5, v3
    v_lshl_add_u32 v3, v7, 3, v3
    v_lshl_add_u32 v4, v5, 3, v6
    v_lshl_add_u32 v3, v4, 7, v3
    v_add_u32 v10, s43, v3
    v_and_b32 v3, 1, v5
    v_lshlrev_b32 v3, 1, v3
    v_lshrrev_b32 v4, 1, v6
    v_or_b32 v3, v3, v4
    s_add_u32 s40, s42, 1
    v_xor_b32 v3, s40, v3
    v_lshlrev_b32 v3, 5, v3
    v_lshl_add_u32 v3, v7, 3, v3
    v_lshl_add_u32 v4, v5, 3, v6
    v_lshl_add_u32 v3, v4, 7, v3
    v_add_u32 v11, s43, v3
    v_and_b32 v3, 1, v5
    v_lshlrev_b32 v3, 1, v3
    v_lshrrev_b32 v4, 1, v6
    v_or_b32 v3, v3, v4
    s_add_u32 s40, s42, 2
    v_xor_b32 v3, s40, v3
    v_lshlrev_b32 v3, 5, v3
    v_lshl_add_u32 v3, v7, 3, v3
    v_lshl_add_u32 v4, v5, 3, v6
    v_lshl_add_u32 v3, v4, 7, v3
    v_add_u32 v12, s43, v3
    v_and_b32 v3, 1, v5
    v_lshlrev_b32 v3, 1, v3
    v_lshrrev_b32 v4, 1, v6
    v_or_b32 v3, v3, v4
    s_add_u32 s40, s42, 3
    v_xor_b32 v3, s40, v3
    v_lshlrev_b32 v3, 5, v3
    v_lshl_add_u32 v3, v7, 3, v3
    v_lshl_add_u32 v4, v5, 3, v6
    v_lshl_add_u32 v3, v4, 7, v3
    v_add_u32 v13, s43, v3
    s_mul_i32 s42, s45, 32
    v_lshrrev_b32 v3, 1, v8
    v_xor_b32 v3, v3, v5
    v_lshlrev_b32 v3, 4, v3
    v_lshl_add_u32 v3, v8, 7, v3
    s_lshl_b32 s40, s42, 7
    s_add_u32 s40, s40, 8192
    v_add_u32 v14, s40, v3
    v_xor_b32 v15, 64, v14
    v_mov_b32 v84, 0
    v_mov_b32 v85, 0
    v_mov_b32 v86, 0
    v_mov_b32 v87, 0
    v_mov_b32 v88, 0
    v_mov_b32 v89, 0
    v_mov_b32 v90, 0
    v_mov_b32 v91, 0
    v_mov_b32 v92, 0
    v_mov_b32 v93, 0
    v_mov_b32 v94, 0
    v_mov_b32 v95, 0
    v_mov_b32 v96, 0
    v_mov_b32 v97, 0
    v_mov_b32 v98, 0
    v_mov_b32 v99, 0
    v_mov_b32 v100, 0
    v_mov_b32 v101, 0
    v_mov_b32 v102, 0
    v_mov_b32 v103, 0
    v_mov_b32 v104, 0
    v_mov_b32 v105, 0
    v_mov_b32 v106, 0
    v_mov_b32 v107, 0
    s_mov_b32 s48, 16
    s_mov_b32 s50, 0
    s_mov_b32 s51, 24576
    s_mov_b32 s29, 0xfffee000
    v_mov_b32 v28, 0
    v_mov_b32 v29, 0
    v_mov_b32 v30, 0
    v_mov_b32 v31, 0
    v_mov_b32 v32, 0
    v_mov_b32 v33, 0
    v_mov_b32 v34, 0
    v_mov_b32 v35, 0
    v_mov_b32 v36, 0
    v_mov_b32 v37, 0
    v_mov_b32 v38, 0
    v_mov_b32 v39, 0
    v_mov_b32 v40, 0
    v_mov_b32 v41, 0
    v_mov_b32 v42, 0
    v_mov_b32 v43, 0
    v_mov_b32 v44, 0
    v_mov_b32 v45, 0
    v_mov_b32 v46, 0
    v_mov_b32 v47, 0
    v_mov_b32 v48, 0
    v_mov_b32 v49, 0
    v_mov_b32 v50, 0
    v_mov_b32 v51, 0
    v_mov_b32 v52, 0
    v_mov_b32 v53, 0
    v_mov_b32 v54, 0
    v_mov_b32 v55, 0
    v_mov_b32 v56, 0
    v_mov_b32 v57, 0
    v_mov_b32 v58, 0
    v_mov_b32 v59, 0
    s_barrier
    buffer_load_dwordx4 v[124:127], v9, s[20:23], s52 offen offset:0 sc1
    buffer_load_dwordx4 v[128:131], v9, s[20:23], s52 offen offset:64 sc1
    buffer_load_dwordx4 v[132:135], v9, s[20:23], s53 offen offset:0 sc1
    buffer_load_dwordx4 v[136:139], v9, s[20:23], s53 offen offset:64 sc1
    s_branch g2_cloop2
g2_mid:
    s_waitcnt vmcnt(0)
    s_nop 7
    v_permlane16_swap_b32 v124, v126
    v_permlane16_swap_b32 v125, v127
    v_permlane16_swap_b32 v128, v130
    v_permlane16_swap_b32 v129, v131
    v_permlane16_swap_b32 v132, v134
    v_permlane16_swap_b32 v133, v135
    v_permlane16_swap_b32 v136, v138
    v_permlane16_swap_b32 v137, v139
    v_lshlrev_b32 v140, 16, v124
    v_and_b32 v141, 0xffff0000, v124
    v_lshlrev_b32 v142, 16, v125
    v_and_b32 v143, 0xffff0000, v125
    v_lshlrev_b32 v144, 16, v126
    v_and_b32 v145, 0xffff0000, v126
    v_lshlrev_b32 v146, 16, v127
    v_and_b32 v147, 0xffff0000, v127
    v_pk_add_f32 v[28:29], v[28:29], v[140:141]
    v_pk_add_f32 v[30:31], v[30:31], v[142:143]
    v_pk_add_f32 v[36:37], v[36:37], v[144:145]
    v_pk_add_f32 v[38:39], v[38:39], v[146:147]
    v_lshlrev_b32 v140, 16, v128
    v_and_b32 v141, 0xffff0000, v128
    v_lshlrev_b32 v142, 16, v129
    v_and_b32 v143, 0xffff0000, v129
    v_lshlrev_b32 v144, 16, v130
    v_and_b32 v145, 0xffff0000, v130
    v_lshlrev_b32 v146, 16, v131
    v_and_b32 v147, 0xffff0000, v131
    v_pk_add_f32 v[44:45], v[44:45], v[140:141]
    v_pk_add_f32 v[46:47], v[46:47], v[142:143]
    v_pk_add_f32 v[52:53], v[52:53], v[144:145]
    v_pk_add_f32 v[54:55], v[54:55], v[146:147]
    v_lshlrev_b32 v140, 16, v132
    v_and_b32 v141, 0xffff0000, v132
    v_lshlrev_b32 v142, 16, v133
    v_and_b32 v143, 0xffff0000, v133
    v_lshlrev_b32 v144, 16, v134
    v_and_b32 v145, 0xffff0000, v134
    v_lshlrev_b32 v146, 16, v135
    v_and_b32 v147, 0xffff0000, v135
    v_pk_add_f32 v[32:33], v[32:33], v[140:141]
    v_pk_add_f32 v[34:35], v[34:35], v[142:143]
    v_pk_add_f32 v[40:41], v[40:41], v[144:145]
    v_pk_add_f32 v[42:43], v[42:43], v[146:147]
    v_lshlrev_b32 v140, 16, v136
    v_and_b32 v141, 0xffff0000, v136
    v_lshlrev_b32 v142, 16, v137
    v_and_b32 v143, 0xffff0000, v137
    v_lshlrev_b32 v144, 16, v138
    v_and_b32 v145, 0xffff0000, v138
    v_lshlrev_b32 v146, 16, v139
    v_and_b32 v147, 0xffff0000, v139
    v_pk_add_f32 v[48:49], v[48:49], v[140:141]
    v_pk_add_f32 v[50:51], v[50:51], v[142:143]
    v_pk_add_f32 v[56:57], v[56:57], v[144:145]
    v_pk_add_f32 v[58:59], v[58:59], v[146:147]
    s_nop 1
    s_branch g2_cloop2
.p2align 3
g2_cloop:
    s_barrier
    s_cmp_eq_u32 s48, 8
    s_cbranch_scc1 g2_mid
g2_cloop2:
    v_mfma_f32_16x16x32_bf16 v[28:31], v[84:87], v[100:103], v[28:31]
    ds_read_b64_tr_b16 v[60:61], v10 offset:0
    ds_read_b64_tr_b16 v[62:63], v10 offset:512
    v_mfma_f32_16x16x32_bf16 v[32:35], v[84:87], v[104:107], v[32:35]
    ds_read_b128 v[76:79], v14 offset:0
    v_mfma_f32_16x16x32_bf16 v[36:39], v[88:91], v[100:103], v[36:39]
    ds_read_b128 v[80:83], v14 offset:2048
    v_mfma_f32_16x16x32_bf16 v[40:43], v[88:91], v[104:107], v[40:43]
    ds_read_b64_tr_b16 v[64:65], v11 offset:0
    ds_read_b64_tr_b16 v[66:67], v11 offset:512
    v_mfma_f32_16x16x32_bf16 v[44:47], v[92:95], v[100:103], v[44:47]
    ds_read_b64_tr_b16 v[68:69], v12 offset:0
    ds_read_b64_tr_b16 v[70:71], v12 offset:512
    v_mfma_f32_16x16x32_bf16 v[48:51], v[92:95], v[104:107], v[48:51]
    ds_read_b64_tr_b16 v[72:73], v13 offset:0
    ds_read_b64_tr_b16 v[74:75], v13 offset:512
    v_mfma_f32_16x16x32_bf16 v[52:55], v[96:99], v[100:103], v[52:55]
    v_mfma_f32_16x16x32_bf16 v[56:59], v[96:99], v[104:107], v[56:59]
    s_waitcnt lgkmcnt(0)
    v_mfma_f32_16x16x32_bf16 v[28:31], v[60:63], v[76:79], v[28:31]
    ds_read_b64_tr_b16 v[84:85], v10 offset:4096
    ds_read_b64_tr_b16 v[86:87], v10 offset:4608
    v_mfma_f32_16x16x32_bf16 v[32:35], v[60:63], v[80:83], v[32:35]
    ds_read_b128 v[100:103], v15 offset:0
    v_mfma_f32_16x16x32_bf16 v[36:39], v[64:67], v[76:79], v[36:39]
    ds_read_b128 v[104:107], v15 offset:2048
    v_mfma_f32_16x16x32_bf16 v[40:43], v[64:67], v[80:83], v[40:43]
    ds_read_b64_tr_b16 v[88:89], v11 offset:4096
    ds_read_b64_tr_b16 v[90:91], v11 offset:4608
    v_mfma_f32_16x16x32_bf16 v[44:47], v[68:71], v[76:79], v[44:47]
    ds_read_b64_tr_b16 v[92:93], v12 offset:4096
    ds_read_b64_tr_b16 v[94:95], v12 offset:4608
    v_mfma_f32_16x16x32_bf16 v[48:51], v[68:71], v[80:83], v[48:51]
    ds_read_b64_tr_b16 v[96:97], v13 offset:4096
    ds_read_b64_tr_b16 v[98:99], v13 offset:4608
    v_mfma_f32_16x16x32_bf16 v[52:55], v[72:75], v[76:79], v[52:55]
    s_add_u32 s50, s50, 1
    s_cmp_eq_u32 s50, 4
    v_mfma_f32_16x16x32_bf16 v[56:59], v[72:75], v[80:83], v[56:59]
    s_cselect_b32 s49, s29, s51
    s_cselect_b32 s50, 0, s50
    v_add_u32 v10, s49, v10
    v_add_u32 v11, s49, v11
    v_add_u32 v12, s49, v12
    v_add_u32 v13, s49, v13
    v_add_u32 v14, s49, v14
    v_add_u32 v15, s49, v15
    s_sub_u32 s48, s48, 1
    s_cmp_lg_u32 s48, 0
    s_waitcnt lgkmcnt(0)
    s_cbranch_scc1 g2_cloop
    v_mfma_f32_16x16x32_bf16 v[28:31], v[84:87], v[100:103], v[28:31]
    v_mfma_f32_16x16x32_bf16 v[32:35], v[84:87], v[104:107], v[32:35]
    v_mfma_f32_16x16x32_bf16 v[36:39], v[88:91], v[100:103], v[36:39]
    v_mfma_f32_16x16x32_bf16 v[40:43], v[88:91], v[104:107], v[40:43]
    v_mfma_f32_16x16x32_bf16 v[44:47], v[92:95], v[100:103], v[44:47]
    v_mfma_f32_16x16x32_bf16 v[48:51], v[92:95], v[104:107], v[48:51]
    v_mfma_f32_16x16x32_bf16 v[52:55], v[96:99], v[100:103], v[52:55]
    v_mfma_f32_16x16x32_bf16 v[56:59], v[96:99], v[104:107], v[56:59]
    s_nop 7
    v_pk_add_f32 v[76:77], v[28:29], v[30:31]
    v_pk_mul_f32 v[78:79], v[28:29], v[28:29]
    v_pk_fma_f32 v[78:79], v[30:31], v[30:31], v[78:79]
    v_pk_add_f32 v[76:77], v[76:77], v[36:37]
    v_pk_fma_f32 v[78:79], v[36:37], v[36:37], v[78:79]
    v_pk_add_f32 v[76:77], v[76:77], v[38:39]
    v_pk_fma_f32 v[78:79], v[38:39], v[38:39], v[78:79]
    v_pk_add_f32 v[76:77], v[76:77], v[44:45]
    v_pk_fma_f32 v[78:79], v[44:45], v[44:45], v[78:79]
    v_pk_add_f32 v[76:77], v[76:77], v[46:47]
    v_pk_fma_f32 v[78:79], v[46:47], v[46:47], v[78:79]
    v_pk_add_f32 v[76:77], v[76:77], v[52:53]
    v_pk_fma_f32 v[78:79], v[52:53], v[52:53], v[78:79]
    v_pk_add_f32 v[76:77], v[76:77], v[54:55]
    v_pk_fma_f32 v[78:79], v[54:55], v[54:55], v[78:79]
    v_pk_add_f32 v[80:81], v[32:33], v[34:35]
    v_pk_mul_f32 v[82:83], v[32:33], v[32:33]
    v_pk_fma_f32 v[82:83], v[34:35], v[34:35], v[82:83]
    v_pk_add_f32 v[80:81], v[80:81], v[40:41]
    v_pk_fma_f32 v[82:83], v[40:41], v[40:41], v[82:83]
    v_pk_add_f32 v[80:81], v[80:81], v[42:43]
    v_pk_fma_f32 v[82:83], v[42:43], v[42:43], v[82:83]
    v_pk_add_f32 v[80:81], v[80:81], v[48:49]
    v_pk_fma_f32 v[82:83], v[48:49], v[48:49], v[82:83]
    v_pk_add_f32 v[80:81], v[80:81], v[50:51]
    v_pk_fma_f32 v[82:83], v[50:51], v[50:51], v[82:83]
    v_pk_add_f32 v[80:81], v[80:81], v[56:57]
    v_pk_fma_f32 v[82:83], v[56:57], v[56:57], v[82:83]
    v_pk_add_f32 v[80:81], v[80:81], v[58:59]
    v_pk_fma_f32 v[82:83], v[58:59], v[58:59], v[82:83]
    v_add_f32 v76, v76, v77
    v_add_f32 v77, v78, v79
    v_add_f32 v80, v80, v81
    v_add_f32 v81, v82, v83
    s_nop 1
    v_permlane16_swap_b32 v76, v80
    v_permlane16_swap_b32 v77, v81
    v_pk_add_f32 v[76:77], v[76:77], v[80:81]
    v_mov_b32 v84, v76
    v_mov_b32 v85, v77
    v_and_b32 v3, 16, v2
    v_add_u32 v3, v3, v20
    v_permlane32_swap_b32 v76, v84
    v_permlane32_swap_b32 v77, v85
    v_pk_add_f32 v[76:77], v[76:77], v[84:85]
    v_lshlrev_b32 v3, 3, v3
    s_mul_i32 s40, s24, 1
    s_add_u32 s40, s40, s44
    s_lshl_b32 s40, s40, 14
    s_mov_b32 exec_hi, 0
    buffer_store_dwordx2 v[76:77], v3, s[60:63], s40 offen sc1
    s_mov_b32 exec_hi, -1
    v_lshrrev_b32 v4, 5, v2
    v_lshl_add_u32 v21, v4, 17, v3
    v_cvt_pk_bf16_f32 v60, v28, v29
    v_cvt_pk_bf16_f32 v61, v30, v31
    v_cvt_pk_bf16_f32 v62, v36, v37
    v_cvt_pk_bf16_f32 v63, v38, v39
    v_lshlrev_b32 v28, 16, v60
    v_and_b32 v29, 0xffff0000, v60
    v_lshlrev_b32 v30, 16, v61
    v_and_b32 v31, 0xffff0000, v61
    v_lshlrev_b32 v36, 16, v62
    v_and_b32 v37, 0xffff0000, v62
    v_lshlrev_b32 v38, 16, v63
    v_and_b32 v39, 0xffff0000, v63
    v_permlane16_swap_b32 v60, v62
    v_permlane16_swap_b32 v61, v63
    buffer_store_dwordx4 v[60:63], v9, s[16:19], s52 offen offset:0 sc1
    v_cvt_pk_bf16_f32 v64, v44, v45
    v_cvt_pk_bf16_f32 v65, v46, v47
    v_cvt_pk_bf16_f32 v66, v52, v53
    v_cvt_pk_bf16_f32 v67, v54, v55
    v_lshlrev_b32 v44, 16, v64
    v_and_b32 v45, 0xffff0000, v64
    v_lshlrev_b32 v46, 16, v65
    v_and_b32 v47, 0xffff0000, v65
    v_lshlrev_b32 v52, 16, v66
    v_and_b32 v53, 0xffff0000, v66
    v_lshlrev_b32 v54, 16, v67
    v_and_b32 v55, 0xffff0000, v67
    v_permlane16_swap_b32 v64, v66
    v_permlane16_swap_b32 v65, v67
    buffer_store_dwordx4 v[64:67], v9, s[16:19], s52 offen offset:64 sc1
    v_cvt_pk_bf16_f32 v68, v32, v33
    v_cvt_pk_bf16_f32 v69, v34, v35
    v_cvt_pk_bf16_f32 v70, v40, v41
    v_cvt_pk_bf16_f32 v71, v42, v43
    v_lshlrev_b32 v32, 16, v68
    v_and_b32 v33, 0xffff0000, v68
    v_lshlrev_b32 v34, 16, v69
    v_and_b32 v35, 0xffff0000, v69
    v_lshlrev_b32 v40, 16, v70
    v_and_b32 v41, 0xffff0000, v70
    v_lshlrev_b32 v42, 16, v71
    v_and_b32 v43, 0xffff0000, v71
    v_permlane16_swap_b32 v68, v70
    v_permlane16_swap_b32 v69, v71
    buffer_store_dwordx4 v[68:71], v9, s[16:19], s53 offen offset:0 sc1
    v_cvt_pk_bf16_f32 v72, v48, v49
    v_cvt_pk_bf16_f32 v73, v50, v51
    v_cvt_pk_bf16_f32 v74, v56, v57
    v_cvt_pk_bf16_f32 v75, v58, v59
    v_lshlrev_b32 v48, 16, v72
    v_and_b32 v49, 0xffff0000, v72
    v_lshlrev_b32 v50, 16, v73
    v_and_b32 v51, 0xffff0000, v73
    v_lshlrev_b32 v56, 16, v74
    v_and_b32 v57, 0xffff0000, v74
    v_lshlrev_b32 v58, 16, v75
    v_and_b32 v59, 0xffff0000, v75
    v_permlane16_swap_b32 v72, v74
    v_permlane16_swap_b32 v73, v75
    buffer_store_dwordx4 v[72:75], v9, s[16:19], s53 offen offset:64 sc1
    s_mov_b32 s48, 0x2000
    v_mul_u32_u24 v19, 256, v20
    v_add_u32 v19, v19, v9
    s_mov_b32 s54, 0
    s_mov_b32 s55, 36864
    s_mov_b32 s40, 0
    buffer_load_dwordx2 v[108:109], v21, s[60:63], s40 offen sc1
    s_mov_b32 s41, 16384
    buffer_load_dwordx2 v[110:111], v21, s[60:63], s41 offen sc1
    s_mov_b32 s40, 32768
    buffer_load_dwordx2 v[112:113], v21, s[60:63], s40 offen sc1
    s_mov_b32 s41, 49152
    buffer_load_dwordx2 v[114:115], v21, s[60:63], s41 offen sc1
    s_mov_b32 s40, 65536
    buffer_load_dwordx2 v[116:117], v21, s[60:63], s40 offen sc1
    s_mov_b32 s41, 81920
    buffer_load_dwordx2 v[118:119], v21, s[60:63], s41 offen sc1
    s_mov_b32 s40, 98304
    buffer_load_dwordx2 v[120:121], v21, s[60:63], s40 offen sc1
    s_mov_b32 s41, 114688
    buffer_load_dwordx2 v[122:123], v21, s[60:63], s41 offen sc1
    s_waitcnt vmcnt(0)
g2_ex:
    v_max3_u32 v4, v108, v109, v110
    v_max3_u32 v4, v4, v111, v112
    v_max3_u32 v4, v4, v113, v114
    v_max3_u32 v4, v4, v115, v116
    v_max3_u32 v4, v4, v117, v118
    v_max3_u32 v4, v4, v119, v120
    v_max3_u32 v4, v4, v121, v122
    v_max_u32 v4, v4, v123
    v_cmp_eq_u32 vcc, -1, v4
    s_sub_u32 s48, s48, 1
    s_cmp_eq_u32 s48, 0
    s_cbranch_scc1 g2_exd
    s_cbranch_vccz g2_exd
    s_sleep 2
    s_mov_b32 s40, 0
    buffer_load_dwordx2 v[108:109], v21, s[60:63], s40 offen sc1
    s_mov_b32 s41, 16384
    buffer_load_dwordx2 v[110:111], v21, s[60:63], s41 offen sc1
    s_mov_b32 s40, 32768
    buffer_load_dwordx2 v[112:113], v21, s[60:63], s40 offen sc1
    s_mov_b32 s41, 49152
    buffer_load_dwordx2 v[114:115], v21, s[60:63], s41 offen sc1
    s_mov_b32 s40, 65536
    buffer_load_dwordx2 v[116:117], v21, s[60:63], s40 offen sc1
    s_mov_b32 s41, 81920
    buffer_load_dwordx2 v[118:119], v21, s[60:63], s41 offen sc1
    s_mov_b32 s40, 98304
    buffer_load_dwordx2 v[120:121], v21, s[60:63], s40 offen sc1
    s_mov_b32 s41, 114688
    buffer_load_dwordx2 v[122:123], v21, s[60:63], s41 offen sc1
    s_waitcnt vmcnt(0)
    s_branch g2_ex
g2_exd:
    v_pk_add_f32 v[108:109], v[108:109], v[116:117]
    v_pk_add_f32 v[110:111], v[110:111], v[118:119]
    v_pk_add_f32 v[112:113], v[112:113], v[120:121]
    v_pk_add_f32 v[114:115], v[114:115], v[122:123]
    v_pk_add_f32 v[108:109], v[108:109], v[112:113]
    v_pk_add_f32 v[110:111], v[110:111], v[114:115]
    v_pk_add_f32 v[108:109], v[108:109], v[110:111]
    v_mov_b32 v110, v108
    v_mov_b32 v111, v109
    s_nop 1
    v_permlane32_swap_b32 v108, v110
    v_permlane32_swap_b32 v109, v111
    v_pk_add_f32 v[108:109], v[108:109], v[110:111]
    v_mul_f32 v108, 0x3a800000, v108
    v_mul_f32 v109, 0x3a800000, v109
    v_fma_f32 v109, -v108, v108, v109
    v_max_f32 v109, 0, v109
    v_mov_b32 v110, v108
    v_mov_b32 v111, v109
    v_cvt_pk_bf16_f32 v110, v110, v110
    v_lshlrev_b32 v110, 16, v110
    v_cvt_pk_bf16_f32 v111, v111, v111
    v_lshlrev_b32 v111, 16, v111
    v_add_f32 v111, 0x3727c5ac, v111
    v_cvt_pk_bf16_f32 v111, v111, v111
    v_lshlrev_b32 v111, 16, v111
    v_sqrt_f32 v111, v111
    s_nop 0
    v_cvt_pk_bf16_f32 v111, v111, v111
    v_lshlrev_b32 v111, 16, v111
    v_rcp_f32 v111, v111
    v_sub_f32 v112, v108, v110
    v_mul_f32 v113, v109, v111
    v_mul_f32 v112, v112, v111
    v_mul_f32 v113, v113, v111
    v_cvt_pk_bf16_f32 v112, v112, v112
    v_lshlrev_b32 v112, 16, v112
    v_cvt_pk_bf16_f32 v113, v113, v113
    v_lshlrev_b32 v113, 16, v113
    v_add_f32 v113, 0x3727c5ac, v113
    v_cvt_pk_bf16_f32 v113, v113, v113
    v_lshlrev_b32 v113, 16, v113
    v_sqrt_f32 v113, v113
    s_nop 0
    v_cvt_pk_bf16_f32 v113, v113, v113
    v_lshlrev_b32 v113, 16, v113
    v_rcp_f32 v113, v113
    v_fma_f32 v112, v110, v111, v112
    v_mul_f32 v114, v111, v113
    v_mul_f32 v115, -v112, v113
    v_mov_b32 v116, v114
    v_mov_b32 v117, v115
    s_nop 1
    v_permlane16_swap_b32 v114, v116
    v_permlane16_swap_b32 v115, v117
    v_pk_fma_f32 v[28:29], v[28:29], v[114:115], v[114:115] op_sel:[0,0,1] op_sel_hi:[1,0,1]
    v_pk_fma_f32 v[30:31], v[30:31], v[114:115], v[114:115] op_sel:[0,0,1] op_sel_hi:[1,0,1]
    v_pk_fma_f32 v[36:37], v[36:37], v[114:115], v[114:115] op_sel:[0,0,1] op_sel_hi:[1,0,1]
    v_pk_fma_f32 v[38:39], v[38:39], v[114:115], v[114:115] op_sel:[0,0,1] op_sel_hi:[1,0,1]
    v_cvt_pk_bf16_f32 v60, v28, v29
    v_cvt_pk_bf16_f32 v61, v30, v31
    v_cvt_pk_bf16_f32 v62, v36, v37
    v_cvt_pk_bf16_f32 v63, v38, v39
    s_nop 1
    v_permlane16_swap_b32 v60, v62
    v_permlane16_swap_b32 v61, v63
    buffer_store_dwordx4 v[60:63], v19, s[56:59], s54 offen offset:0 sc1
    v_pk_fma_f32 v[44:45], v[44:45], v[114:115], v[114:115] op_sel:[0,0,1] op_sel_hi:[1,0,1]
    v_pk_fma_f32 v[46:47], v[46:47], v[114:115], v[114:115] op_sel:[0,0,1] op_sel_hi:[1,0,1]
    v_pk_fma_f32 v[52:53], v[52:53], v[114:115], v[114:115] op_sel:[0,0,1] op_sel_hi:[1,0,1]
    v_pk_fma_f32 v[54:55], v[54:55], v[114:115], v[114:115] op_sel:[0,0,1] op_sel_hi:[1,0,1]
    v_cvt_pk_bf16_f32 v64, v44, v45
    v_cvt_pk_bf16_f32 v65, v46, v47
    v_cvt_pk_bf16_f32 v66, v52, v53
    v_cvt_pk_bf16_f32 v67, v54, v55
    s_nop 1
    v_permlane16_swap_b32 v64, v66
    v_permlane16_swap_b32 v65, v67
    buffer_store_dwordx4 v[64:67], v19, s[56:59], s54 offen offset:64 sc1
    v_pk_fma_f32 v[32:33], v[32:33], v[116:117], v[116:117] op_sel:[0,0,1] op_sel_hi:[1,0,1]
    v_pk_fma_f32 v[34:35], v[34:35], v[116:117], v[116:117] op_sel:[0,0,1] op_sel_hi:[1,0,1]
    v_pk_fma_f32 v[40:41], v[40:41], v[116:117], v[116:117] op_sel:[0,0,1] op_sel_hi:[1,0,1]
    v_pk_fma_f32 v[42:43], v[42:43], v[116:117], v[116:117] op_sel:[0,0,1] op_sel_hi:[1,0,1]
    v_cvt_pk_bf16_f32 v68, v32, v33
    v_cvt_pk_bf16_f32 v69, v34, v35
    v_cvt_pk_bf16_f32 v70, v40, v41
    v_cvt_pk_bf16_f32 v71, v42, v43
    s_nop 1
    v_permlane16_swap_b32 v68, v70
    v_permlane16_swap_b32 v69, v71
    buffer_store_dwordx4 v[68:71], v19, s[56:59], s55 offen offset:0 sc1
    v_pk_fma_f32 v[48:49], v[48:49], v[116:117], v[116:117] op_sel:[0,0,1] op_sel_hi:[1,0,1]
    v_pk_fma_f32 v[50:51], v[50:51], v[116:117], v[116:117] op_sel:[0,0,1] op_sel_hi:[1,0,1]
    v_pk_fma_f32 v[56:57], v[56:57], v[116:117], v[116:117] op_sel:[0,0,1] op_sel_hi:[1,0,1]
    v_pk_fma_f32 v[58:59], v[58:59], v[116:117], v[116:117] op_sel:[0,0,1] op_sel_hi:[1,0,1]
    v_cvt_pk_bf16_f32 v72, v48, v49
    v_cvt_pk_bf16_f32 v73, v50, v51
    v_cvt_pk_bf16_f32 v74, v56, v57
    v_cvt_pk_bf16_f32 v75, v58, v59
    s_nop 1
    v_permlane16_swap_b32 v72, v74
    v_permlane16_swap_b32 v73, v75
    buffer_store_dwordx4 v[72:75], v19, s[56:59], s55 offen offset:64 sc1
    s_lshr_b32 s40, s24, 1
    s_add_u32 s40, s40, 16
    s_lshl_b32 s40, s40, 8
    s_mov_b32 s42, s40
    s_add_u32 s84, s4, 0x300000
    s_addc_u32 s85, s5, 0
    s_mov_b32 s86, 0x4000
    s_mov_b32 s87, 0x20000
    v_mov_b32 v3, s40
    v_mov_b32 v4, 1
    s_waitcnt vmcnt(0)
    s_barrier
    s_cmp_lg_u32 s28, 0
    s_cbranch_scc1 g2_cin
    s_mov_b64 exec, 1
    buffer_atomic_add v4, v3, s[84:87], 0 offen sc1
    s_mov_b64 exec, -1
g2_cin:
    s_branch g3_in
.p2align 6
g3_in:
    s_cmp_ge_u32 s2, 224
    s_cbranch_scc1 g3_spare
    s_load_dwordx2 s[4:5], s[0:1], 80
    s_load_dwordx2 s[30:31], s[0:1], 32
    s_load_dwordx2 s[6:7], s[0:1], 40
    v_lshrrev_b32 v1, 6, v0
    v_and_b32 v2, 63, v0
    s_and_b32 s40, s2, 1
    s_lshl_b32 s40, s40, 2
    s_bfe_u32 s41, s2, 0x20003
    s_add_u32 s25, s40, s41
    s_bfe_u32 s40, s2, 0x20001
    s_mul_i32 s40, s40, 7
    s_lshr_b32 s42, s2, 5
    s_add_u32 s24, s40, s42
    s_add_u32 s27, s41, s42
    s_mov_b32 s26, 0
    s_cmp_eq_u32 s96, 0
    s_cselect_b32 s95, 3, 1
    v_readfirstlane_b32 s28, v1
    s_nop 0
    s_cmp_lt_u32 s28, 4
    s_cbranch_scc1 g3_compute
    s_sub_u32 s28, s28, 4
    s_mov_b32 s40, 7168
    v_lshrrev_b32 v4, 4, v2
    v_mul_lo_u32 v3, v4, s40
    v_lshlrev_b32 v4, 1, v4
    v_xor_b32 v4, v4, v2
    v_and_b32 v4, 15, v4
    v_lshl_add_u32 v3, v4, 4, v3
    s_mul_i32 s41, s24, 256
    s_mul_i32 s42, s28, 114688
    s_add_u32 s41, s41, s42
    v_xor_b32 v4, 128, v3
    s_add_u32 s42, s41, 0
    v_add_u32 v10, s42, v3
    s_add_u32 s42, s41, 28672
    v_add_u32 v11, s42, v3
    s_add_u32 s42, s41, 57344
    v_add_u32 v12, s42, v4
    s_add_u32 s42, s41, 86016
    v_add_u32 v13, s42, v4
    s_mov_b32 s40, 2304
    v_lshrrev_b32 v4, 4, v2
    v_mul_lo_u32 v3, v4, s40
    v_lshlrev_b32 v4, 1, v4
    v_xor_b32 v4, v4, v2
    v_and_b32 v4, 15, v4
    v_lshl_add_u32 v3, v4, 4, v3
    s_mul_i32 s41, s25, 256
    s_mul_i32 s42, s28, 36864
    s_add_u32 s41, s41, s42
    v_xor_b32 v4, 128, v3
    s_add_u32 s42, s41, 0
    v_add_u32 v14, s42, v3
    s_add_u32 s42, s41, 9216
    v_add_u32 v15, s42, v3
    s_add_u32 s42, s41, 18432
    v_add_u32 v16, s42, v4
    s_add_u32 s42, s41, 27648
    v_add_u32 v17, s42, v4
    s_mul_i32 s36, s28, 4096
    s_mul_i32 s37, s28, 4096
    s_add_u32 s37, s37, 16384
    s_waitcnt lgkmcnt(0)
    s_add_u32 s4, s4, s97
    s_addc_u32 s5, s5, 0
    s_mov_b32 s8, s30
    s_mov_b32 s9, s31
    s_mov_b32 s10, 0xe00000
    s_mov_b32 s11, 0x20000
    s_add_u32 s12, s4, 0xc00000
    s_addc_u32 s13, s5, 0
    s_mov_b32 s14, 0x480000
    s_mov_b32 s15, 0x20000
    s_mov_b32 s32, 0
    s_mov_b32 s33, 0
g3_ld_pW:
    s_add_u32 s40, s32, s27
    s_and_b32 s40, s40, s95
    s_andn2_b32 s41, s32, s95
    s_or_b32 s40, s40, s41
    s_add_u32 s40, s40, s26
    s_mul_i32 s34, s40, 458752
    s_mul_i32 s35, s40, 147456
    s_add_u32 s38, s33, s36
    s_add_u32 s39, s33, s37
    s_add_u32 m0, s38, 0
    s_nop 0
    buffer_load_dwordx4 v10, s[8:11], s34 offen lds
    s_add_u32 m0, s38, 1024
    s_nop 0
    buffer_load_dwordx4 v11, s[8:11], s34 offen lds
    s_add_u32 m0, s38, 2048
    s_nop 0
    buffer_load_dwordx4 v12, s[8:11], s34 offen lds
    s_add_u32 m0, s38, 3072
    s_nop 0
    buffer_load_dwordx4 v13, s[8:11], s34 offen lds
    s_add_u32 s33, s33, 32768
    s_add_u32 s32, s32, 1
    s_cmp_lt_u32 s32, 3
    s_cbranch_scc1 g3_ld_pW
    s_lshr_b32 s40, s25, 0
    s_add_u32 s40, s40, 16
    s_lshl_b32 s40, s40, 8
    s_mov_b32 s42, s40
    s_lshl_b32 s43, s96, 2
    s_add_u32 s43, s43, 3
    s_mov_b32 s41, 0x80000
    v_mov_b32 v24, 131072
    s_cmp_lg_u32 s28, 0
    s_cbranch_scc1 g3_dep_lds
    s_mov_b32 s41, 0x8000
    s_add_u32 s84, s4, 0x300000
    s_addc_u32 s85, s5, 0
    s_mov_b32 s86, 0x4000
    s_mov_b32 s87, 0x20000
    v_cmp_eq_u32 vcc, 1, v2
    v_mov_b32 v21, s40
    v_mov_b32 v23, s42
    v_cndmask_b32 v21, v21, v23, vcc
    v_mov_b32 v22, 32
    v_mov_b32 v23, 32
    v_cndmask_b32 v22, v22, v23, vcc
g3_dep:
    buffer_load_dword v23, v21, s[84:87], 0 offen sc1
    s_sub_u32 s41, s41, 1
    s_waitcnt vmcnt(0)
    v_cmp_lt_u32 vcc, v23, v22
    s_cmp_eq_u32 s41, 0
    s_cbranch_scc1 g3_dep_seen
    s_cbranch_vccz g3_dep_seen
    s_sleep 2
    s_branch g3_dep
g3_dep_seen:
    v_mov_b32 v23, s43
    ds_write_b32 v24, v23
    s_branch g3_dep_ok
g3_dep_lds:
    ds_read_b32 v23, v24
    s_sub_u32 s41, s41, 1
    s_waitcnt lgkmcnt(0)
    v_readfirstlane_b32 s40, v23
    s_cmp_eq_u32 s41, 0
    s_cbranch_scc1 g3_dep_ok
    s_cmp_eq_u32 s40, s43
    s_cbranch_scc1 g3_dep_ok
    s_sleep 1
    s_branch g3_dep_lds
g3_dep_ok:
    s_mov_b32 s32, 0
    s_mov_b32 s33, 0
g3_ld_pA:
    s_add_u32 s40, s32, s27
    s_and_b32 s40, s40, s95
    s_andn2_b32 s41, s32, s95
    s_or_b32 s40, s40, s41
    s_add_u32 s40, s40, s26
    s_mul_i32 s34, s40, 458752
    s_mul_i32 s35, s40, 147456
    s_add_u32 s38, s33, s36
    s_add_u32 s39, s33, s37
    s_add_u32 m0, s39, 0
    s_nop 0
    buffer_load_dwordx4 v14, s[12:15], s35 offen sc1 lds
    s_add_u32 m0, s39, 1024
    s_nop 0
    buffer_load_dwordx4 v15, s[12:15], s35 offen sc1 lds
    s_add_u32 m0, s39, 2048
    s_nop 0
    buffer_load_dwordx4 v16, s[12:15], s35 offen sc1 lds
    s_add_u32 m0, s39, 3072
    s_nop 0
    buffer_load_dwordx4 v17, s[12:15], s35 offen sc1 lds
    s_add_u32 s33, s33, 32768
    s_add_u32 s32, s32, 1
    s_cmp_lt_u32 s32, 3
    s_cbranch_scc1 g3_ld_pA
    s_waitcnt vmcnt(8)
    s_branch g3_ld_bar
g3_ld_loop:
    s_cmp_eq_u32 s32, 4
    s_cbranch_scc1 g3_ld_s4
    s_waitcnt vmcnt(16)
g3_ld_bar:
    s_barrier
    s_add_u32 s40, s32, s27
    s_and_b32 s40, s40, s95
    s_andn2_b32 s41, s32, s95
    s_or_b32 s40, s40, s41
    s_add_u32 s40, s40, s26
    s_mul_i32 s34, s40, 458752
    s_mul_i32 s35, s40, 147456
    s_add_u32 s38, s33, s36
    s_add_u32 s39, s33, s37
    s_add_u32 m0, s38, 0
    s_nop 0
    buffer_load_dwordx4 v10, s[8:11], s34 offen lds
    s_add_u32 m0, s38, 1024
    s_nop 0
    buffer_load_dwordx4 v11, s[8:11], s34 offen lds
    s_add_u32 m0, s38, 2048
    s_nop 0
    buffer_load_dwordx4 v12, s[8:11], s34 offen lds
    s_add_u32 m0, s38, 3072
    s_nop 0
    buffer_load_dwordx4 v13, s[8:11], s34 offen lds
    s_add_u32 m0, s39, 0
    s_nop 0
    buffer_load_dwordx4 v14, s[12:15], s35 offen sc1 lds
    s_add_u32 m0, s39, 1024
    s_nop 0
    buffer_load_dwordx4 v15, s[12:15], s35 offen sc1 lds
    s_add_u32 m0, s39, 2048
    s_nop 0
    buffer_load_dwordx4 v16, s[12:15], s35 offen sc1 lds
    s_add_u32 m0, s39, 3072
    s_nop 0
    buffer_load_dwordx4 v17, s[12:15], s35 offen sc1 lds
    s_add_u32 s33, s33, 32768
    s_add_u32 s32, s32, 1
    s_cmp_eq_u32 s33, 131072
    s_cselect_b32 s33, 0, s33
    s_cmp_lt_u32 s32, 32
    s_cbranch_scc1 g3_ld_loop
    s_waitcnt vmcnt(16)
    s_barrier
    s_waitcnt vmcnt(8)
    s_barrier
    s_waitcnt vmcnt(0)
    s_barrier
    s_branch g3_ld_end
g3_ld_s4:
    s_waitcnt vmcnt(12)
    s_branch g3_ld_bar
g3_ld_end:
    s_barrier
    s_branch g4_in
g3_done:
    s_endpgm
g3_compute:
    v_lshrrev_b32 v5, 4, v2
    v_bfe_u32 v6, v2, 2, 2
    v_and_b32 v7, 3, v2
    v_and_b32 v8, 15, v2
    s_and_b32 s44, s28, 1
    s_lshr_b32 s45, s28, 1
    s_mul_i32 s40, s25, 128
    s_mul_i32 s41, s45, 64
    s_add_u32 s40, s40, s41
    v_add_u32 v20, s40, v8
    s_mov_b32 s41, 8192
    v_mul_lo_u32 v9, v20, s41
    s_mul_i32 s40, s24, 256
    s_mul_i32 s41, s44, 128
    s_add_u32 s46, s40, s41
    v_and_b32 v3, 1, v5
    v_lshlrev_b32 v3, 5, v3
    v_lshrrev_b32 v4, 1, v5
    v_lshl_add_u32 v3, v4, 4, v3
    v_add3_u32 v9, v9, v3, s46
    s_mov_b32 s52, 0
    s_mov_b32 s53, 131072
    s_mov_b32 s54, 262144
    s_mov_b32 s55, 393216
    s_waitcnt lgkmcnt(0)
    s_add_u32 s4, s4, s97
    s_addc_u32 s5, s5, 0
    s_mov_b32 s20, s6
    s_mov_b32 s21, s7
    s_mov_b32 s22, 0x1c00
    s_mov_b32 s23, 0x20000
    s_add_u32 s16, s4, 0x1100000
    s_addc_u32 s17, s5, 0
    s_mov_b32 s18, 0x800000
    s_mov_b32 s19, 0x20000
    v_lshl_add_u32 v3, v5, 3, s46
    buffer_load_dwordx2 v[92:93], v3, s[20:23], 0 offen offset:0
    buffer_load_dwordx2 v[94:95], v3, s[20:23], 0 offen offset:32
    buffer_load_dwordx2 v[96:97], v3, s[20:23], 0 offen offset:64
    buffer_load_dwordx2 v[98:99], v3, s[20:23], 0 offen offset:96
    s_mul_i32 s42, s44, 4
    s_mov_b32 s43, 0
    v_and_b32 v3, 1, v5
    v_lshl_or_b32 v3, v3, 2, v6
    s_add_u32 s40, s42, 0
    v_xor_b32 v3, s40, v3
    v_lshlrev_b32 v3, 5, v3
    v_lshl_add_u32 v3, v7, 3, v3
    v_lshl_add_u32 v4, v5, 3, v6
    v_lshl_add_u32 v3, v4, 8, v3
    v_add_u32 v10, s43, v3
    v_and_b32 v3, 1, v5
    v_lshl_or_b32 v3, v3, 2, v6
    s_add_u32 s40, s42, 1
    v_xor_b32 v3, s40, v3
    v_lshlrev_b32 v3, 5, v3
    v_lshl_add_u32 v3, v7, 3, v3
    v_lshl_add_u32 v4, v5, 3, v6
    v_lshl_add_u32 v3, v4, 8, v3
    v_add_u32 v11, s43, v3
    v_and_b32 v3, 1, v5
    v_lshl_or_b32 v3, v3, 2, v6
    s_add_u32 s40, s42, 2
    v_xor_b32 v3, s40, v3
    v_lshlrev_b32 v3, 5, v3
    v_lshl_add_u32 v3, v7, 3, v3
    v_lshl_add_u32 v4, v5, 3, v6
    v_lshl_add_u32 v3, v4, 8, v3
    v_add_u32 v12, s43, v3
    v_and_b32 v3, 1, v5
    v_lshl_or_b32 v3, v3, 2, v6
    s_add_u32 s40, s42, 3
    v_xor_b32 v3, s40, v3
    v_lshlrev_b32 v3, 5, v3
    v_lshl_add_u32 v3, v7, 3, v3
    v_lshl_add_u32 v4, v5, 3, v6
    v_lshl_add_u32 v3, v4, 8, v3
    v_add_u32 v13, s43, v3
    s_mul_i32 s42, s45, 4
    s_mov_b32 s43, 16384
    v_and_b32 v3, 1, v5
    v_lshl_or_b32 v3, v3, 2, v6
    s_add_u32 s40, s42, 0
    v_xor_b32 v3, s40, v3
    v_lshlrev_b32 v3, 5, v3
    v_lshl_add_u32 v3, v7, 3, v3
    v_lshl_add_u32 v4, v5, 3, v6
    v_lshl_add_u32 v3, v4, 8, v3
    v_add_u32 v14, s43, v3
    v_and_b32 v3, 1, v5
    v_lshl_or_b32 v3, v3, 2, v6
    s_add_u32 s40, s42, 1
    v_xor_b32 v3, s40, v3
    v_lshlrev_b32 v3, 5, v3
    v_lshl_add_u32 v3, v7, 3, v3
    v_lshl_add_u32 v4, v5, 3, v6
    v_lshl_add_u32 v3, v4, 8, v3
    v_add_u32 v15, s43, v3
    v_and_b32 v3, 1, v5
    v_lshl_or_b32 v3, v3, 2, v6
    s_add_u32 s40, s42, 2
    v_xor_b32 v3, s40, v3
    v_lshlrev_b32 v3, 5, v3
    v_lshl_add_u32 v3, v7, 3, v3
    v_lshl_add_u32 v4, v5, 3, v6
    v_lshl_add_u32 v3, v4, 8, v3
    v_add_u32 v16, s43, v3
    v_and_b32 v3, 1, v5
    v_lshl_or_b32 v3, v3, 2, v6
    s_add_u32 s40, s42, 3
    v_xor_b32 v3, s40, v3
    v_lshlrev_b32 v3, 5, v3
    v_lshl_add_u32 v3, v7, 3, v3
    v_lshl_add_u32 v4, v5, 3, v6
    v_lshl_add_u32 v3, v4, 8, v3
    v_add_u32 v17, s43, v3
    v_mov_b32 v124, 0
    v_mov_b32 v125, 0
    v_mov_b32 v126, 0
    v_mov_b32 v127, 0
    v_mov_b32 v128, 0
    v_mov_b32 v129, 0
    v_mov_b32 v130, 0
    v_mov_b32 v131, 0
    v_mov_b32 v132, 0
    v_mov_b32 v133, 0
    v_mov_b32 v134, 0
    v_mov_b32 v135, 0
    v_mov_b32 v136, 0
    v_mov_b32 v137, 0
    v_mov_b32 v138, 0
    v_mov_b32 v139, 0
    v_mov_b32 v140, 0
    v_mov_b32 v141, 0
    v_mov_b32 v142, 0
    v_mov_b32 v143, 0
    v_mov_b32 v144, 0
    v_mov_b32 v145, 0
    v_mov_b32 v146, 0
    v_mov_b32 v147, 0
    v_mov_b32 v148, 0
    v_mov_b32 v149, 0
    v_mov_b32 v150, 0
    v_mov_b32 v151, 0
    v_mov_b32 v152, 0
    v_mov_b32 v153, 0
    v_mov_b32 v154, 0
    v_mov_b32 v155, 0
    s_mov_b32 s48, 32
    s_mov_b32 s50, 0
    s_mov_b32 s51, 32768
    s_mov_b32 s29, 0xfffe8000
    s_waitcnt vmcnt(0)
    v_lshlrev_b32 v28, 16, v92
    v_and_b32 v29, 0xffff0000, v92
    v_lshlrev_b32 v30, 16, v93
    v_and_b32 v31, 0xffff0000, v93
    v_lshlrev_b32 v32, 16, v92
    v_and_b32 v33, 0xffff0000, v92
    v_lshlrev_b32 v34, 16, v93
    v_and_b32 v35, 0xffff0000, v93
    v_lshlrev_b32 v36, 16, v92
    v_and_b32 v37, 0xffff0000, v92
    v_lshlrev_b32 v38, 16, v93
    v_and_b32 v39, 0xffff0000, v93
    v_lshlrev_b32 v40, 16, v92
    v_and_b32 v41, 0xffff0000, v92
    v_lshlrev_b32 v42, 16, v93
    v_and_b32 v43, 0xffff0000, v93
    v_lshlrev_b32 v44, 16, v94
    v_and_b32 v45, 0xffff0000, v94
    v_lshlrev_b32 v46, 16, v95
    v_and_b32 v47, 0xffff0000, v95
    v_lshlrev_b32 v48, 16, v94
    v_and_b32 v49, 0xffff0000, v94
    v_lshlrev_b32 v50, 16, v95
    v_and_b32 v51, 0xffff0000, v95
    v_lshlrev_b32 v52, 16, v94
    v_and_b32 v53, 0xffff0000, v94
    v_lshlrev_b32 v54, 16, v95
    v_and_b32 v55, 0xffff0000, v95
    v_lshlrev_b32 v56, 16, v94
    v_and_b32 v57, 0xffff0000, v94
    v_lshlrev_b32 v58, 16, v95
    v_and_b32 v59, 0xffff0000, v95
    v_lshlrev_b32 v60, 16, v96
    v_and_b32 v61, 0xffff0000, v96
    v_lshlrev_b32 v62, 16, v97
    v_and_b32 v63, 0xffff0000, v97
    v_lshlrev_b32 v64, 16, v96
    v_and_b32 v65, 0xffff0000, v96
    v_lshlrev_b32 v66, 16, v97
    v_and_b32 v67, 0xffff0000, v97
    v_lshlrev_b32 v68, 16, v96
    v_and_b32 v69, 0xffff0000, v96
    v_lshlrev_b32 v70, 16, v97
    v_and_b32 v71, 0xffff0000, v97
    v_lshlrev_b32 v72, 16, v96
    v_and_b32 v73, 0xffff0000, v96
    v_lshlrev_b32 v74, 16, v97
    v_and_b32 v75, 0xffff0000, v97
    v_lshlrev_b32 v76, 16, v98
    v_and_b32 v77, 0xffff0000, v98
    v_lshlrev_b32 v78, 16, v99
    v_and_b32 v79, 0xffff0000, v99
    v_lshlrev_b32 v80, 16, v98
    v_and_b32 v81, 0xffff0000, v98
    v_lshlrev_b32 v82, 16, v99
    v_and_b32 v83, 0xffff0000, v99
    v_lshlrev_b32 v84, 16, v98
    v_and_b32 v85, 0xffff0000, v98
    v_lshlrev_b32 v86, 16, v99
    v_and_b32 v87, 0xffff0000, v99
    v_lshlrev_b32 v88, 16, v98
    v_and_b32 v89, 0xffff0000, v98
    v_lshlrev_b32 v90, 16, v99
    v_and_b32 v91, 0xffff0000, v99
    v_mov_b32 v156, 0xbdd2d3e8
    v_mov_b32 v157, 0xbdd2d3e8
    v_mov_b32 v158, 0xc0135761
    v_mov_b32 v159, 0xc0135761
    v_mov_b32 v160, 0x3f800000
    v_mov_b32 v161, 0x3f800000
.p2align 3
g3_cloop:
    s_barrier
g3_cloop2:
    v_mfma_f32_16x16x32_bf16 v[28:31], v[124:127], v[140:143], v[28:31]
    ds_read_b64_tr_b16 v[92:93], v10 offset:0
    ds_read_b64_tr_b16 v[94:95], v10 offset:1024
    v_mfma_f32_16x16x32_bf16 v[32:35], v[124:127], v[144:147], v[32:35]
    ds_read_b64_tr_b16 v[108:109], v14 offset:0
    ds_read_b64_tr_b16 v[110:111], v14 offset:1024
    v_mfma_f32_16x16x32_bf16 v[36:39], v[124:127], v[148:151], v[36:39]
    ds_read_b64_tr_b16 v[112:113], v15 offset:0
    ds_read_b64_tr_b16 v[114:115], v15 offset:1024
    v_mfma_f32_16x16x32_bf16 v[40:43], v[124:127], v[152:155], v[40:43]
    ds_read_b64_tr_b16 v[116:117], v16 offset:0
    ds_read_b64_tr_b16 v[118:119], v16 offset:1024
    v_mfma_f32_16x16x32_bf16 v[44:47], v[128:131], v[140:143], v[44:47]
    ds_read_b64_tr_b16 v[120:121], v17 offset:0
    ds_read_b64_tr_b16 v[122:123], v17 offset:1024
    v_mfma_f32_16x16x32_bf16 v[48:51], v[128:131], v[144:147], v[48:51]
    ds_read_b64_tr_b16 v[96:97], v11 offset:0
    ds_read_b64_tr_b16 v[98:99], v11 offset:1024
    v_mfma_f32_16x16x32_bf16 v[52:55], v[128:131], v[148:151], v[52:55]
    ds_read_b64_tr_b16 v[100:101], v12 offset:0
    ds_read_b64_tr_b16 v[102:103], v12 offset:1024
    v_mfma_f32_16x16x32_bf16 v[56:59], v[128:131], v[152:155], v[56:59]
    ds_read_b64_tr_b16 v[104:105], v13 offset:0
    ds_read_b64_tr_b16 v[106:107], v13 offset:1024
    v_mfma_f32_16x16x32_bf16 v[60:63], v[132:135], v[140:143], v[60:63]
    v_mfma_f32_16x16x32_bf16 v[64:67], v[132:135], v[144:147], v[64:67]
    v_mfma_f32_16x16x32_bf16 v[68:71], v[132:135], v[148:151], v[68:71]
    v_mfma_f32_16x16x32_bf16 v[72:75], v[132:135], v[152:155], v[72:75]
    v_mfma_f32_16x16x32_bf16 v[76:79], v[136:139], v[140:143], v[76:79]
    v_mfma_f32_16x16x32_bf16 v[80:83], v[136:139], v[144:147], v[80:83]
    v_mfma_f32_16x16x32_bf16 v[84:87], v[136:139], v[148:151], v[84:87]
    v_mfma_f32_16x16x32_bf16 v[88:91], v[136:139], v[152:155], v[88:91]
    s_waitcnt lgkmcnt(0)
    v_mfma_f32_16x16x32_bf16 v[28:31], v[92:95], v[108:111], v[28:31]
    ds_read_b64_tr_b16 v[124:125], v10 offset:8192
    ds_read_b64_tr_b16 v[126:127], v10 offset:9216
    v_mfma_f32_16x16x32_bf16 v[32:35], v[92:95], v[112:115], v[32:35]
    ds_read_b64_tr_b16 v[140:141], v14 offset:8192
    ds_read_b64_tr_b16 v[142:143], v14 offset:9216
    v_mfma_f32_16x16x32_bf16 v[36:39], v[92:95], v[116:119], v[36:39]
    ds_read_b64_tr_b16 v[144:145], v15 offset:8192
    ds_read_b64_tr_b16 v[146:147], v15 offset:9216
    v_mfma_f32_16x16x32_bf16 v[40:43], v[92:95], v[120:123], v[40:43]
    ds_read_b64_tr_b16 v[148:149], v16 offset:8192
    ds_read_b64_tr_b16 v[150:151], v16 offset:9216
    v_mfma_f32_16x16x32_bf16 v[44:47], v[96:99], v[108:111], v[44:47]
    ds_read_b64_tr_b16 v[152:153], v17 offset:8192
    ds_read_b64_tr_b16 v[154:155], v17 offset:9216
    v_mfma_f32_16x16x32_bf16 v[48:51], v[96:99], v[112:115], v[48:51]
    ds_read_b64_tr_b16 v[128:129], v11 offset:8192
    ds_read_b64_tr_b16 v[130:131], v11 offset:9216
    v_mfma_f32_16x16x32_bf16 v[52:55], v[96:99], v[116:119], v[52:55]
    ds_read_b64_tr_b16 v[132:133], v12 offset:8192
    ds_read_b64_tr_b16 v[134:135], v12 offset:9216
    v_mfma_f32_16x16x32_bf16 v[56:59], v[96:99], v[120:123], v[56:59]
    ds_read_b64_tr_b16 v[136:137], v13 offset:8192
    ds_read_b64_tr_b16 v[138:139], v13 offset:9216
    v_mfma_f32_16x16x32_bf16 v[60:63], v[100:103], v[108:111], v[60:63]
    s_add_u32 s50, s50, 1
    s_cmp_eq_u32 s50, 4
    v_mfma_f32_16x16x32_bf16 v[64:67], v[100:103], v[112:115], v[64:67]
    s_cselect_b32 s49, s29, s51
    s_cselect_b32 s50, 0, s50
    v_mfma_f32_16x16x32_bf16 v[68:71], v[100:103], v[116:119], v[68:71]
    v_add_u32 v10, s49, v10
    v_add_u32 v11, s49, v11
    v_mfma_f32_16x16x32_bf16 v[72:75], v[100:103], v[120:123], v[72:75]
    v_add_u32 v12, s49, v12
    v_add_u32 v13, s49, v13
    v_mfma_f32_16x16x32_bf16 v[76:79], v[104:107], v[108:111], v[76:79]
    v_add_u32 v14, s49, v14
    v_add_u32 v15, s49, v15
    v_mfma_f32_16x16x32_bf16 v[80:83], v[104:107], v[112:115], v[80:83]
    v_add_u32 v16, s49, v16
    v_add_u32 v17, s49, v17
    v_mfma_f32_16x16x32_bf16 v[84:87], v[104:107], v[116:119], v[84:87]
    s_sub_u32 s48, s48, 1
    s_cmp_lg_u32 s48, 0
    v_mfma_f32_16x16x32_bf16 v[88:91], v[104:107], v[120:123], v[88:91]
    s_waitcnt lgkmcnt(0)
    s_cbranch_scc1 g3_cloop
    v_mfma_f32_16x16x32_bf16 v[28:31], v[124:127], v[140:143], v[28:31]
    v_mfma_f32_16x16x32_bf16 v[44:47], v[128:131], v[140:143], v[44:47]
    v_mfma_f32_16x16x32_bf16 v[60:63], v[132:135], v[140:143], v[60:63]
    v_mfma_f32_16x16x32_bf16 v[76:79], v[136:139], v[140:143], v[76:79]
    v_mfma_f32_16x16x32_bf16 v[32:35], v[124:127], v[144:147], v[32:35]
    v_mfma_f32_16x16x32_bf16 v[48:51], v[128:131], v[144:147], v[48:51]
    v_mfma_f32_16x16x32_bf16 v[64:67], v[132:135], v[144:147], v[64:67]
    v_mfma_f32_16x16x32_bf16 v[80:83], v[136:139], v[144:147], v[80:83]
    s_nop 1
    v_mfma_f32_16x16x32_bf16 v[36:39], v[124:127], v[148:151], v[36:39]
    v_pk_mul_f32 v[108:109], v[28:29], v[28:29]
    v_pk_mul_f32 v[110:111], v[30:31], v[30:31]
    v_pk_mul_f32 v[112:113], v[44:45], v[44:45]
    v_pk_mul_f32 v[114:115], v[46:47], v[46:47]
    v_pk_fma_f32 v[108:109], v[108:109], v[156:157], v[158:159]
    v_pk_fma_f32 v[110:111], v[110:111], v[156:157], v[158:159]
    v_pk_fma_f32 v[112:113], v[112:113], v[156:157], v[158:159]
    v_pk_fma_f32 v[114:115], v[114:115], v[156:157], v[158:159]
    v_pk_mul_f32 v[108:109], v[108:109], v[28:29]
    v_pk_mul_f32 v[110:111], v[110:111], v[30:31]
    v_pk_mul_f32 v[112:113], v[112:113], v[44:45]
    v_pk_mul_f32 v[114:115], v[114:115], v[46:47]
    v_exp_f32 v108, v108
    v_exp_f32 v109, v109
    v_exp_f32 v110, v110
    v_exp_f32 v111, v111
    v_exp_f32 v112, v112
    v_exp_f32 v113, v113
    v_exp_f32 v114, v114
    v_exp_f32 v115, v115
    v_pk_add_f32 v[108:109], v[108:109], v[160:161]
    v_pk_add_f32 v[110:111], v[110:111], v[160:161]
    v_mfma_f32_16x16x32_bf16 v[52:55], v[128:131], v[148:151], v[52:55]
    v_pk_add_f32 v[112:113], v[112:113], v[160:161]
    v_pk_add_f32 v[114:115], v[114:115], v[160:161]
    v_rcp_f32 v108, v108
    v_rcp_f32 v109, v109
    v_rcp_f32 v110, v110
    v_rcp_f32 v111, v111
    v_rcp_f32 v112, v112
    v_rcp_f32 v113, v113
    v_rcp_f32 v114, v114
    v_rcp_f32 v115, v115
    v_pk_mul_f32 v[28:29], v[28:29], v[108:109]
    v_pk_mul_f32 v[30:31], v[30:31], v[110:111]
    v_pk_mul_f32 v[44:45], v[44:45], v[112:113]
    v_pk_mul_f32 v[46:47], v[46:47], v[114:115]
    v_cvt_pk_bf16_f32 v92, v28, v29
    v_cvt_pk_bf16_f32 v93, v30, v31
    v_cvt_pk_bf16_f32 v94, v44, v45
    v_cvt_pk_bf16_f32 v95, v46, v47
    s_nop 1
    v_permlane16_swap_b32 v92, v94
    v_permlane16_swap_b32 v93, v95
    buffer_store_dwordx4 v[92:95], v9, s[16:19], s52 offen offset:0 sc1
    v_mfma_f32_16x16x32_bf16 v[68:71], v[132:135], v[148:151], v[68:71]
    v_pk_mul_f32 v[108:109], v[60:61], v[60:61]
    v_pk_mul_f32 v[110:111], v[62:63], v[62:63]
    v_pk_mul_f32 v[112:113], v[76:77], v[76:77]
    v_pk_mul_f32 v[114:115], v[78:79], v[78:79]
    v_pk_fma_f32 v[108:109], v[108:109], v[156:157], v[158:159]
    v_pk_fma_f32 v[110:111], v[110:111], v[156:157], v[158:159]
    v_pk_fma_f32 v[112:113], v[112:113], v[156:157], v[158:159]
    v_pk_fma_f32 v[114:115], v[114:115], v[156:157], v[158:159]
    v_pk_mul_f32 v[108:109], v[108:109], v[60:61]
    v_pk_mul_f32 v[110:111], v[110:111], v[62:63]
    v_pk_mul_f32 v[112:113], v[112:113], v[76:77]
    v_pk_mul_f32 v[114:115], v[114:115], v[78:79]
    v_exp_f32 v108, v108
    v_exp_f32 v109, v109
    v_exp_f32 v110, v110
    v_exp_f32 v111, v111
    v_exp_f32 v112, v112
    v_exp_f32 v113, v113
    v_exp_f32 v114, v114
    v_exp_f32 v115, v115
    v_pk_add_f32 v[108:109], v[108:109], v[160:161]
    v_pk_add_f32 v[110:111], v[110:111], v[160:161]
    v_mfma_f32_16x16x32_bf16 v[84:87], v[136:139], v[148:151], v[84:87]
    v_pk_add_f32 v[112:113], v[112:113], v[160:161]
    v_pk_add_f32 v[114:115], v[114:115], v[160:161]
    v_rcp_f32 v108, v108
    v_rcp_f32 v109, v109
    v_rcp_f32 v110, v110
    v_rcp_f32 v111, v111
    v_rcp_f32 v112, v112
    v_rcp_f32 v113, v113
    v_rcp_f32 v114, v114
    v_rcp_f32 v115, v115
    v_pk_mul_f32 v[60:61], v[60:61], v[108:109]
    v_pk_mul_f32 v[62:63], v[62:63], v[110:111]
    v_pk_mul_f32 v[76:77], v[76:77], v[112:113]
    v_pk_mul_f32 v[78:79], v[78:79], v[114:115]
    v_cvt_pk_bf16_f32 v96, v60, v61
    v_cvt_pk_bf16_f32 v97, v62, v63
    v_cvt_pk_bf16_f32 v98, v76, v77
    v_cvt_pk_bf16_f32 v99, v78, v79
    s_nop 1
    v_permlane16_swap_b32 v96, v98
    v_permlane16_swap_b32 v97, v99
    buffer_store_dwordx4 v[96:99], v9, s[16:19], s52 offen offset:64 sc1
    v_mfma_f32_16x16x32_bf16 v[40:43], v[124:127], v[152:155], v[40:43]
    v_pk_mul_f32 v[108:109], v[32:33], v[32:33]
    v_pk_mul_f32 v[110:111], v[34:35], v[34:35]
    v_pk_mul_f32 v[112:113], v[48:49], v[48:49]
    v_pk_mul_f32 v[114:115], v[50:51], v[50:51]
    v_pk_fma_f32 v[108:109], v[108:109], v[156:157], v[158:159]
    v_pk_fma_f32 v[110:111], v[110:111], v[156:157], v[158:159]
    v_pk_fma_f32 v[112:113], v[112:113], v[156:157], v[158:159]
    v_pk_fma_f32 v[114:115], v[114:115], v[156:157], v[158:159]
    v_pk_mul_f32 v[108:109], v[108:109], v[32:33]
    v_pk_mul_f32 v[110:111], v[110:111], v[34:35]
    v_pk_mul_f32 v[112:113], v[112:113], v[48:49]
    v_pk_mul_f32 v[114:115], v[114:115], v[50:51]
    v_exp_f32 v108, v108
    v_exp_f32 v109, v109
    v_exp_f32 v110, v110
    v_exp_f32 v111, v111
    v_exp_f32 v112, v112
    v_exp_f32 v113, v113
    v_exp_f32 v114, v114
    v_exp_f32 v115, v115
    v_pk_add_f32 v[108:109], v[108:109], v[160:161]
    v_pk_add_f32 v[110:111], v[110:111], v[160:161]
    v_mfma_f32_16x16x32_bf16 v[56:59], v[128:131], v[152:155], v[56:59]
    v_pk_add_f32 v[112:113], v[112:113], v[160:161]
    v_pk_add_f32 v[114:115], v[114:115], v[160:161]
    v_rcp_f32 v108, v108
    v_rcp_f32 v109, v109
    v_rcp_f32 v110, v110
    v_rcp_f32 v111, v111
    v_rcp_f32 v112, v112
    v_rcp_f32 v113, v113
    v_rcp_f32 v114, v114
    v_rcp_f32 v115, v115
    v_pk_mul_f32 v[32:33], v[32:33], v[108:109]
    v_pk_mul_f32 v[34:35], v[34:35], v[110:111]
    v_pk_mul_f32 v[48:49], v[48:49], v[112:113]
    v_pk_mul_f32 v[50:51], v[50:51], v[114:115]
    v_cvt_pk_bf16_f32 v100, v32, v33
    v_cvt_pk_bf16_f32 v101, v34, v35
    v_cvt_pk_bf16_f32 v102, v48, v49
    v_cvt_pk_bf16_f32 v103, v50, v51
    s_nop 1
    v_permlane16_swap_b32 v100, v102
    v_permlane16_swap_b32 v101, v103
    buffer_store_dwordx4 v[100:103], v9, s[16:19], s53 offen offset:0 sc1
    v_mfma_f32_16x16x32_bf16 v[72:75], v[132:135], v[152:155], v[72:75]
    v_pk_mul_f32 v[108:109], v[64:65], v[64:65]
    v_pk_mul_f32 v[110:111], v[66:67], v[66:67]
    v_pk_mul_f32 v[112:113], v[80:81], v[80:81]
    v_pk_mul_f32 v[114:115], v[82:83], v[82:83]
    v_pk_fma_f32 v[108:109], v[108:109], v[156:157], v[158:159]
    v_pk_fma_f32 v[110:111], v[110:111], v[156:157], v[158:159]
    v_pk_fma_f32 v[112:113], v[112:113], v[156:157], v[158:159]
    v_pk_fma_f32 v[114:115], v[114:115], v[156:157], v[158:159]
    v_pk_mul_f32 v[108:109], v[108:109], v[64:65]
    v_pk_mul_f32 v[110:111], v[110:111], v[66:67]
    v_pk_mul_f32 v[112:113], v[112:113], v[80:81]
    v_pk_mul_f32 v[114:115], v[114:115], v[82:83]
    v_exp_f32 v108, v108
    v_exp_f32 v109, v109
    v_exp_f32 v110, v110
    v_exp_f32 v111, v111
    v_exp_f32 v112, v112
    v_exp_f32 v113, v113
    v_exp_f32 v114, v114
    v_exp_f32 v115, v115
    v_pk_add_f32 v[108:109], v[108:109], v[160:161]
    v_pk_add_f32 v[110:111], v[110:111], v[160:161]
    v_mfma_f32_16x16x32_bf16 v[88:91], v[136:139], v[152:155], v[88:91]
    v_pk_add_f32 v[112:113], v[112:113], v[160:161]
    v_pk_add_f32 v[114:115], v[114:115], v[160:161]
    v_rcp_f32 v108, v108
    v_rcp_f32 v109, v109
    v_rcp_f32 v110, v110
    v_rcp_f32 v111, v111
    v_rcp_f32 v112, v112
    v_rcp_f32 v113, v113
    v_rcp_f32 v114, v114
    v_rcp_f32 v115, v115
    v_pk_mul_f32 v[64:65], v[64:65], v[108:109]
    v_pk_mul_f32 v[66:67], v[66:67], v[110:111]
    v_pk_mul_f32 v[80:81], v[80:81], v[112:113]
    v_pk_mul_f32 v[82:83], v[82:83], v[114:115]
    v_cvt_pk_bf16_f32 v104, v64, v65
    v_cvt_pk_bf16_f32 v105, v66, v67
    v_cvt_pk_bf16_f32 v106, v80, v81
    v_cvt_pk_bf16_f32 v107, v82, v83
    s_nop 1
    v_permlane16_swap_b32 v104, v106
    v_permlane16_swap_b32 v105, v107
    buffer_store_dwordx4 v[104:107], v9, s[16:19], s53 offen offset:64 sc1
    v_pk_mul_f32 v[108:109], v[36:37], v[36:37]
    v_pk_mul_f32 v[110:111], v[38:39], v[38:39]
    v_pk_mul_f32 v[112:113], v[52:53], v[52:53]
    v_pk_mul_f32 v[114:115], v[54:55], v[54:55]
    v_pk_fma_f32 v[108:109], v[108:109], v[156:157], v[158:159]
    v_pk_fma_f32 v[110:111], v[110:111], v[156:157], v[158:159]
    v_pk_fma_f32 v[112:113], v[112:113], v[156:157], v[158:159]
    v_pk_fma_f32 v[114:115], v[114:115], v[156:157], v[158:159]
    v_pk_mul_f32 v[108:109], v[108:109], v[36:37]
    v_pk_mul_f32 v[110:111], v[110:111], v[38:39]
    v_pk_mul_f32 v[112:113], v[112:113], v[52:53]
    v_pk_mul_f32 v[114:115], v[114:115], v[54:55]
    v_exp_f32 v108, v108
    v_exp_f32 v109, v109
    v_exp_f32 v110, v110
    v_exp_f32 v111, v111
    v_exp_f32 v112, v112
    v_exp_f32 v113, v113
    v_exp_f32 v114, v114
    v_exp_f32 v115, v115
    v_pk_add_f32 v[108:109], v[108:109], v[160:161]
    v_pk_add_f32 v[110:111], v[110:111], v[160:161]
    v_pk_add_f32 v[112:113], v[112:113], v[160:161]
    v_pk_add_f32 v[114:115], v[114:115], v[160:161]
    v_rcp_f32 v108, v108
    v_rcp_f32 v109, v109
    v_rcp_f32 v110, v110
    v_rcp_f32 v111, v111
    v_rcp_f32 v112, v112
    v_rcp_f32 v113, v113
    v_rcp_f32 v114, v114
    v_rcp_f32 v115, v115
    v_pk_mul_f32 v[36:37], v[36:37], v[108:109]
    v_pk_mul_f32 v[38:39], v[38:39], v[110:111]
    v_pk_mul_f32 v[52:53], v[52:53], v[112:113]
    v_pk_mul_f32 v[54:55], v[54:55], v[114:115]
    v_cvt_pk_bf16_f32 v92, v36, v37
    v_cvt_pk_bf16_f32 v93, v38, v39
    v_cvt_pk_bf16_f32 v94, v52, v53
    v_cvt_pk_bf16_f32 v95, v54, v55
    s_nop 1
    v_permlane16_swap_b32 v92, v94
    v_permlane16_swap_b32 v93, v95
    buffer_store_dwordx4 v[92:95], v9, s[16:19], s54 offen offset:0 sc1
    v_pk_mul_f32 v[108:109], v[68:69], v[68:69]
    v_pk_mul_f32 v[110:111], v[70:71], v[70:71]
    v_pk_mul_f32 v[112:113], v[84:85], v[84:85]
    v_pk_mul_f32 v[114:115], v[86:87], v[86:87]
    v_pk_fma_f32 v[108:109], v[108:109], v[156:157], v[158:159]
    v_pk_fma_f32 v[110:111], v[110:111], v[156:157], v[158:159]
    v_pk_fma_f32 v[112:113], v[112:113], v[156:157], v[158:159]
    v_pk_fma_f32 v[114:115], v[114:115], v[156:157], v[158:159]
    v_pk_mul_f32 v[108:109], v[108:109], v[68:69]
    v_pk_mul_f32 v[110:111], v[110:111], v[70:71]
    v_pk_mul_f32 v[112:113], v[112:113], v[84:85]
    v_pk_mul_f32 v[114:115], v[114:115], v[86:87]
    v_exp_f32 v108, v108
    v_exp_f32 v109, v109
    v_exp_f32 v110, v110
    v_exp_f32 v111, v111
    v_exp_f32 v112, v112
    v_exp_f32 v113, v113
    v_exp_f32 v114, v114
    v_exp_f32 v115, v115
    v_pk_add_f32 v[108:109], v[108:109], v[160:161]
    v_pk_add_f32 v[110:111], v[110:111], v[160:161]
    v_pk_add_f32 v[112:113], v[112:113], v[160:161]
    v_pk_add_f32 v[114:115], v[114:115], v[160:161]
    v_rcp_f32 v108, v108
    v_rcp_f32 v109, v109
    v_rcp_f32 v110, v110
    v_rcp_f32 v111, v111
    v_rcp_f32 v112, v112
    v_rcp_f32 v113, v113
    v_rcp_f32 v114, v114
    v_rcp_f32 v115, v115
    v_pk_mul_f32 v[68:69], v[68:69], v[108:109]
    v_pk_mul_f32 v[70:71], v[70:71], v[110:111]
    v_pk_mul_f32 v[84:85], v[84:85], v[112:113]
    v_pk_mul_f32 v[86:87], v[86:87], v[114:115]
    v_cvt_pk_bf16_f32 v96, v68, v69
    v_cvt_pk_bf16_f32 v97, v70, v71
    v_cvt_pk_bf16_f32 v98, v84, v85
    v_cvt_pk_bf16_f32 v99, v86, v87
    s_nop 1
    v_permlane16_swap_b32 v96, v98
    v_permlane16_swap_b32 v97, v99
    buffer_store_dwordx4 v[96:99], v9, s[16:19], s54 offen offset:64 sc1
    v_pk_mul_f32 v[108:109], v[40:41], v[40:41]
    v_pk_mul_f32 v[110:111], v[42:43], v[42:43]
    v_pk_mul_f32 v[112:113], v[56:57], v[56:57]
    v_pk_mul_f32 v[114:115], v[58:59], v[58:59]
    v_pk_fma_f32 v[108:109], v[108:109], v[156:157], v[158:159]
    v_pk_fma_f32 v[110:111], v[110:111], v[156:157], v[158:159]
    v_pk_fma_f32 v[112:113], v[112:113], v[156:157], v[158:159]
    v_pk_fma_f32 v[114:115], v[114:115], v[156:157], v[158:159]
    v_pk_mul_f32 v[108:109], v[108:109], v[40:41]
    v_pk_mul_f32 v[110:111], v[110:111], v[42:43]
    v_pk_mul_f32 v[112:113], v[112:113], v[56:57]
    v_pk_mul_f32 v[114:115], v[114:115], v[58:59]
    v_exp_f32 v108, v108
    v_exp_f32 v109, v109
    v_exp_f32 v110, v110
    v_exp_f32 v111, v111
    v_exp_f32 v112, v112
    v_exp_f32 v113, v113
    v_exp_f32 v114, v114
    v_exp_f32 v115, v115
    v_pk_add_f32 v[108:109], v[108:109], v[160:161]
    v_pk_add_f32 v[110:111], v[110:111], v[160:161]
    v_pk_add_f32 v[112:113], v[112:113], v[160:161]
    v_pk_add_f32 v[114:115], v[114:115], v[160:161]
    v_rcp_f32 v108, v108
    v_rcp_f32 v109, v109
    v_rcp_f32 v110, v110
    v_rcp_f32 v111, v111
    v_rcp_f32 v112, v112
    v_rcp_f32 v113, v113
    v_rcp_f32 v114, v114
    v_rcp_f32 v115, v115
    v_pk_mul_f32 v[40:41], v[40:41], v[108:109]
    v_pk_mul_f32 v[42:43], v[42:43], v[110:111]
    v_pk_mul_f32 v[56:57], v[56:57], v[112:113]
    v_pk_mul_f32 v[58:59], v[58:59], v[114:115]
    v_cvt_pk_bf16_f32 v100, v40, v41
    v_cvt_pk_bf16_f32 v101, v42, v43
    v_cvt_pk_bf16_f32 v102, v56, v57
    v_cvt_pk_bf16_f32 v103, v58, v59
    s_nop 1
    v_permlane16_swap_b32 v100, v102
    v_permlane16_swap_b32 v101, v103
    buffer_store_dwordx4 v[100:103], v9, s[16:19], s55 offen offset:0 sc1
    v_pk_mul_f32 v[108:109], v[72:73], v[72:73]
    v_pk_mul_f32 v[110:111], v[74:75], v[74:75]
    v_pk_mul_f32 v[112:113], v[88:89], v[88:89]
    v_pk_mul_f32 v[114:115], v[90:91], v[90:91]
    v_pk_fma_f32 v[108:109], v[108:109], v[156:157], v[158:159]
    v_pk_fma_f32 v[110:111], v[110:111], v[156:157], v[158:159]
    v_pk_fma_f32 v[112:113], v[112:113], v[156:157], v[158:159]
    v_pk_fma_f32 v[114:115], v[114:115], v[156:157], v[158:159]
    v_pk_mul_f32 v[108:109], v[108:109], v[72:73]
    v_pk_mul_f32 v[110:111], v[110:111], v[74:75]
    v_pk_mul_f32 v[112:113], v[112:113], v[88:89]
    v_pk_mul_f32 v[114:115], v[114:115], v[90:91]
    v_exp_f32 v108, v108
    v_exp_f32 v109, v109
    v_exp_f32 v110, v110
    v_exp_f32 v111, v111
    v_exp_f32 v112, v112
    v_exp_f32 v113, v113
    v_exp_f32 v114, v114
    v_exp_f32 v115, v115
    v_pk_add_f32 v[108:109], v[108:109], v[160:161]
    v_pk_add_f32 v[110:111], v[110:111], v[160:161]
    v_pk_add_f32 v[112:113], v[112:113], v[160:161]
    v_pk_add_f32 v[114:115], v[114:115], v[160:161]
    v_rcp_f32 v108, v108
    v_rcp_f32 v109, v109
    v_rcp_f32 v110, v110
    v_rcp_f32 v111, v111
    v_rcp_f32 v112, v112
    v_rcp_f32 v113, v113
    v_rcp_f32 v114, v114
    v_rcp_f32 v115, v115
    v_pk_mul_f32 v[72:73], v[72:73], v[108:109]
    v_pk_mul_f32 v[74:75], v[74:75], v[110:111]
    v_pk_mul_f32 v[88:89], v[88:89], v[112:113]
    v_pk_mul_f32 v[90:91], v[90:91], v[114:115]
    v_cvt_pk_bf16_f32 v104, v72, v73
    v_cvt_pk_bf16_f32 v105, v74, v75
    v_cvt_pk_bf16_f32 v106, v88, v89
    v_cvt_pk_bf16_f32 v107, v90, v91
    s_nop 1
    v_permlane16_swap_b32 v104, v106
    v_permlane16_swap_b32 v105, v107
    buffer_store_dwordx4 v[104:107], v9, s[16:19], s55 offen offset:64 sc1
    s_cmp_ge_u32 s24, 14
    s_cselect_b32 s40, 25, 24
    s_lshl_b32 s41, s25, 1
    s_add_u32 s40, s40, s41
    s_lshl_b32 s40, s40, 8
    s_add_u32 s84, s4, 0x300000
    s_addc_u32 s85, s5, 0
    s_mov_b32 s86, 0x4000
    s_mov_b32 s87, 0x20000
    v_mov_b32 v3, s40
    v_mov_b32 v4, 1
    s_waitcnt vmcnt(0)
    s_barrier
    s_cmp_lg_u32 s28, 0
    s_cbranch_scc1 g3_cin
    s_mov_b64 exec, 1
    buffer_atomic_add v4, v3, s[84:87], 0 offen sc1
    s_mov_b64 exec, -1
g3_cin:
    s_branch g4_in
g3_spare:
    s_cmp_ge_u32 s2, 256
    s_cbranch_scc1 g3_done
    s_load_dwordx2 s[4:5], s[0:1], 80
    s_load_dwordx2 s[6:7], s[0:1], 48
    s_sub_u32 s3, s2, 224
    v_lshrrev_b32 v2, 6, v0
    v_lshlrev_b32 v1, 4, v0
    v_mov_b32 v8, -1
    v_mov_b32 v9, -1
    v_mov_b32 v10, -1
    v_mov_b32 v11, -1
    v_readfirstlane_b32 s28, v2
    s_lshl_b32 s13, s3, 17
    s_waitcnt lgkmcnt(0)
    s_add_u32 s4, s4, s97
    s_addc_u32 s5, s5, 0
    s_add_u32 s8, s4, 0x1d00000
    s_addc_u32 s9, s5, 0
    s_mov_b32 s10, 0x400000
    s_mov_b32 s11, 0x20000
    buffer_store_dwordx4 v[8:11], v1, s[8:11], s13 offen sc1
    s_add_u32 s13, s13, 8192
    buffer_store_dwordx4 v[8:11], v1, s[8:11], s13 offen sc1
    s_add_u32 s13, s13, 8192
    buffer_store_dwordx4 v[8:11], v1, s[8:11], s13 offen sc1
    s_add_u32 s13, s13, 8192
    buffer_store_dwordx4 v[8:11], v1, s[8:11], s13 offen sc1
    s_add_u32 s13, s13, 8192
    buffer_store_dwordx4 v[8:11], v1, s[8:11], s13 offen sc1
    s_add_u32 s13, s13, 8192
    buffer_store_dwordx4 v[8:11], v1, s[8:11], s13 offen sc1
    s_add_u32 s13, s13, 8192
    buffer_store_dwordx4 v[8:11], v1, s[8:11], s13 offen sc1
    s_add_u32 s13, s13, 8192
    buffer_store_dwordx4 v[8:11], v1, s[8:11], s13 offen sc1
    s_add_u32 s13, s13, 8192
    buffer_store_dwordx4 v[8:11], v1, s[8:11], s13 offen sc1
    s_add_u32 s13, s13, 8192
    buffer_store_dwordx4 v[8:11], v1, s[8:11], s13 offen sc1
    s_add_u32 s13, s13, 8192
    buffer_store_dwordx4 v[8:11], v1, s[8:11], s13 offen sc1
    s_add_u32 s13, s13, 8192
    buffer_store_dwordx4 v[8:11], v1, s[8:11], s13 offen sc1
    s_add_u32 s13, s13, 8192
    buffer_store_dwordx4 v[8:11], v1, s[8:11], s13 offen sc1
    s_add_u32 s13, s13, 8192
    buffer_store_dwordx4 v[8:11], v1, s[8:11], s13 offen sc1
    s_add_u32 s13, s13, 8192
    buffer_store_dwordx4 v[8:11], v1, s[8:11], s13 offen sc1
    s_add_u32 s13, s13, 8192
    buffer_store_dwordx4 v[8:11], v1, s[8:11], s13 offen sc1
    s_add_u32 s13, s13, 8192
    s_mov_b32 s40, 14336
    s_add_u32 s84, s4, 0x300000
    s_addc_u32 s85, s5, 0
    s_mov_b32 s86, 0x4000
    s_mov_b32 s87, 0x20000
    v_mov_b32 v3, s40
    v_mov_b32 v4, 1
    s_waitcnt vmcnt(0)
    s_barrier
    s_cmp_lg_u32 s28, 0
    s_cbranch_scc1 g3_spare_cin
    s_mov_b64 exec, 1
    buffer_atomic_add v4, v3, s[84:87], 0 offen sc1
    s_mov_b64 exec, -1
g3_spare_cin:
    s_cmp_lg_u32 s96, 0
    s_cbranch_scc1 g3_spare_end
    s_mov_b32 s8, s6
    s_mov_b32 s9, s7
    s_mov_b32 s10, 0xe00000
    s_mov_b32 s11, 0x20000
    s_cmp_ge_u32 s3, 16
    s_cselect_b32 s12, 3145728, 0
    s_lshl_b32 s3, s3, 18
    s_add_u32 s3, s3, s12
    s_mov_b32 s12, 4
g3_spare_loop:
    buffer_load_dwordx4 v[4:7], v1, s[8:11], s3 offen
    s_add_u32 s3, s3, 8192
    buffer_load_dwordx4 v[4:7], v1, s[8:11], s3 offen
    s_add_u32 s3, s3, 8192
    buffer_load_dwordx4 v[4:7], v1, s[8:11], s3 offen
    s_add_u32 s3, s3, 8192
    buffer_load_dwordx4 v[4:7], v1, s[8:11], s3 offen
    s_add_u32 s3, s3, 8192
    buffer_load_dwordx4 v[4:7], v1, s[8:11], s3 offen
    s_add_u32 s3, s3, 8192
    buffer_load_dwordx4 v[4:7], v1, s[8:11], s3 offen
    s_add_u32 s3, s3, 8192
    buffer_load_dwordx4 v[4:7], v1, s[8:11], s3 offen
    s_add_u32 s3, s3, 8192
    buffer_load_dwordx4 v[4:7], v1, s[8:11], s3 offen
    s_add_u32 s3, s3, 8192
    s_waitcnt vmcnt(8)
    s_sub_u32 s12, s12, 1
    s_cmp_lg_u32 s12, 0
    s_cbranch_scc1 g3_spare_loop
    s_waitcnt vmcnt(0)
g3_spare_end:
    s_branch g4_in
.p2align 6
g4_in:
    s_cmp_ge_u32 s2, 256
    s_cbranch_scc1 g4_done
    s_load_dwordx2 s[4:5], s[0:1], 80
    s_load_dwordx2 s[6:7], s[0:1], 64
    s_load_dwordx2 s[30:31], s[0:1], 48
    s_load_dwordx2 s[34:35], s[0:1], 56
    v_lshrrev_b32 v1, 6, v0
    v_and_b32 v2, 63, v0
    s_bfe_u32 s40, s2, 0x10001
    s_lshl_b32 s40, s40, 2
    s_bfe_u32 s41, s2, 0x20003
    s_add_u32 s24, s40, s41
    s_bfe_u32 s40, s2, 0x10002
    s_lshl_b32 s40, s40, 3
    s_lshr_b32 s42, s2, 5
    s_add_u32 s25, s40, s42
    s_and_b32 s91, s2, 1
    s_add_u32 s27, s41, s42
    s_lshl_b32 s92, s24, 4
    s_add_u32 s92, s92, s25
    s_mul_i32 s26, s91, 28
    s_cmp_eq_u32 s96, 0
    s_cselect_b32 s95, 3, 1
    v_readfirstlane_b32 s28, v1
    s_nop 0
    s_cmp_lt_u32 s28, 4
    s_cbranch_scc1 g4_compute
    s_sub_u32 s28, s28, 4
    s_mov_b32 s40, 8192
    v_lshrrev_b32 v3, 3, v2
    v_mul_lo_u32 v3, v3, s40
    v_lshrrev_b32 v4, 4, v2
    v_xor_b32 v4, v4, v2
    v_and_b32 v4, 7, v4
    v_lshl_add_u32 v3, v4, 4, v3
    s_mul_i32 s41, s24, 1048576
    s_mul_i32 s42, s28, 262144
    s_add_u32 s41, s41, s42
    v_xor_b32 v4, 64, v3
    s_add_u32 s42, s41, 0
    v_add_u32 v10, s42, v3
    s_add_u32 s42, s41, 65536
    v_add_u32 v11, s42, v4
    s_add_u32 s42, s41, 131072
    v_add_u32 v12, s42, v3
    s_add_u32 s42, s41, 196608
    v_add_u32 v13, s42, v4
    s_mov_b32 s40, 4096
    v_lshrrev_b32 v4, 4, v2
    v_mul_lo_u32 v3, v4, s40
    v_lshlrev_b32 v4, 1, v4
    v_xor_b32 v4, v4, v2
    v_and_b32 v4, 15, v4
    v_lshl_add_u32 v3, v4, 4, v3
    s_mul_i32 s41, s25, 256
    s_mul_i32 s42, s28, 65536
    s_add_u32 s41, s41, s42
    v_xor_b32 v4, 128, v3
    s_add_u32 s42, s41, 0
    v_add_u32 v14, s42, v3
    s_add_u32 s42, s41, 16384
    v_add_u32 v15, s42, v3
    s_add_u32 s42, s41, 32768
    v_add_u32 v16, s42, v4
    s_add_u32 s42, s41, 49152
    v_add_u32 v17, s42, v4
    s_mul_i32 s36, s28, 4096
    s_mul_i32 s37, s28, 4096
    s_add_u32 s37, s37, 16384
    s_waitcnt lgkmcnt(0)
    s_add_u32 s4, s4, s97
    s_addc_u32 s5, s5, 0
    s_add_u32 s8, s4, 0x1100000
    s_addc_u32 s9, s5, 0
    s_mov_b32 s10, 0x800000
    s_mov_b32 s11, 0x20000
    s_mov_b32 s12, s30
    s_mov_b32 s13, s31
    s_mov_b32 s14, 0xe00000
    s_mov_b32 s15, 0x20000
    s_mov_b32 s32, 0
    s_mov_b32 s33, 0
g4_ld_pW:
    s_add_u32 s40, s32, s27
    s_and_b32 s40, s40, s95
    s_andn2_b32 s41, s32, s95
    s_or_b32 s40, s40, s41
    s_add_u32 s40, s40, s26
    s_mul_i32 s34, s40, 128
    s_mul_i32 s35, s40, 262144
    s_add_u32 s38, s33, s36
    s_add_u32 s39, s33, s37
    s_add_u32 m0, s39, 0
    s_nop 0
    buffer_load_dwordx4 v14, s[12:15], s35 offen lds
    s_add_u32 m0, s39, 1024
    s_nop 0
    buffer_load_dwordx4 v15, s[12:15], s35 offen lds
    s_add_u32 m0, s39, 2048
    s_nop 0
    buffer_load_dwordx4 v16, s[12:15], s35 offen lds
    s_add_u32 m0, s39, 3072
    s_nop 0
    buffer_load_dwordx4 v17, s[12:15], s35 offen lds
    s_add_u32 s33, s33, 32768
    s_add_u32 s32, s32, 1
    s_cmp_lt_u32 s32, 3
    s_cbranch_scc1 g4_ld_pW
    s_lshl_b32 s40, s24, 1
    s_add_u32 s40, s40, s91
    s_add_u32 s40, s40, 24
    s_lshl_b32 s40, s40, 8
    s_mov_b32 s42, 14336
    s_lshl_b32 s43, s96, 2
    s_add_u32 s43, s43, 4
    s_mov_b32 s41, 0x80000
    v_mov_b32 v24, 131072
    s_cmp_lg_u32 s28, 0
    s_cbranch_scc1 g4_dep_lds
    s_mov_b32 s41, 0x8000
    s_add_u32 s84, s4, 0x300000
    s_addc_u32 s85, s5, 0
    s_mov_b32 s86, 0x4000
    s_mov_b32 s87, 0x20000
    v_cmp_eq_u32 vcc, 1, v2
    v_mov_b32 v21, s40
    v_mov_b32 v23, s42
    v_cndmask_b32 v21, v21, v23, vcc
    v_mov_b32 v22, 14
    v_mov_b32 v23, 32
    v_cndmask_b32 v22, v22, v23, vcc
g4_dep:
    buffer_load_dword v23, v21, s[84:87], 0 offen sc1
    s_sub_u32 s41, s41, 1
    s_waitcnt vmcnt(0)
    v_cmp_lt_u32 vcc, v23, v22
    s_cmp_eq_u32 s41, 0
    s_cbranch_scc1 g4_dep_seen
    s_cbranch_vccz g4_dep_seen
    s_sleep 2
    s_branch g4_dep
g4_dep_seen:
    v_mov_b32 v23, s43
    ds_write_b32 v24, v23
    s_branch g4_dep_ok
g4_dep_lds:
    ds_read_b32 v23, v24
    s_sub_u32 s41, s41, 1
    s_waitcnt lgkmcnt(0)
    v_readfirstlane_b32 s40, v23
    s_cmp_eq_u32 s41, 0
    s_cbranch_scc1 g4_dep_ok
    s_cmp_eq_u32 s40, s43
    s_cbranch_scc1 g4_dep_ok
    s_sleep 1
    s_branch g4_dep_lds
g4_dep_ok:
    s_mov_b32 s32, 0
    s_mov_b32 s33, 0
g4_ld_pA:
    s_add_u32 s40, s32, s27
    s_and_b32 s40, s40, s95
    s_andn2_b32 s41, s32, s95
    s_or_b32 s40, s40, s41
    s_add_u32 s40, s40, s26
    s_mul_i32 s34, s40, 128
    s_mul_i32 s35, s40, 262144
    s_add_u32 s38, s33, s36
    s_add_u32 s39, s33, s37
    s_add_u32 m0, s38, 0
    s_nop 0
    buffer_load_dwordx4 v10, s[8:11], s34 offen sc1 lds
    s_add_u32 m0, s38, 1024
    s_nop 0
    buffer_load_dwordx4 v11, s[8:11], s34 offen sc1 lds
    s_add_u32 m0, s38, 2048
    s_nop 0
    buffer_load_dwordx4 v12, s[8:11], s34 offen sc1 lds
    s_add_u32 m0, s38, 3072
    s_nop 0
    buffer_load_dwordx4 v13, s[8:11], s34 offen sc1 lds
    s_add_u32 s33, s33, 32768
    s_add_u32 s32, s32, 1
    s_cmp_lt_u32 s32, 3
    s_cbranch_scc1 g4_ld_pA
    s_waitcnt vmcnt(8)
    s_branch g4_ld_bar
g4_ld_loop:
    s_cmp_eq_u32 s32, 4
    s_cbranch_scc1 g4_ld_s4
    s_waitcnt vmcnt(16)
g4_ld_bar:
    s_barrier
    s_add_u32 s40, s32, s27
    s_and_b32 s40, s40, s95
    s_andn2_b32 s41, s32, s95
    s_or_b32 s40, s40, s41
    s_add_u32 s40, s40, s26
    s_mul_i32 s34, s40, 128
    s_mul_i32 s35, s40, 262144
    s_add_u32 s38, s33, s36
    s_add_u32 s39, s33, s37
    s_add_u32 m0, s38, 0
    s_nop 0
    buffer_load_dwordx4 v10, s[8:11], s34 offen sc1 lds
    s_add_u32 m0, s38, 1024
    s_nop 0
    buffer_load_dwordx4 v11, s[8:11], s34 offen sc1 lds
    s_add_u32 m0, s38, 2048
    s_nop 0
    buffer_load_dwordx4 v12, s[8:11], s34 offen sc1 lds
    s_add_u32 m0, s38, 3072
    s_nop 0
    buffer_load_dwordx4 v13, s[8:11], s34 offen sc1 lds
    s_add_u32 m0, s39, 0
    s_nop 0
    buffer_load_dwordx4 v14, s[12:15], s35 offen lds
    s_add_u32 m0, s39, 1024
    s_nop 0
    buffer_load_dwordx4 v15, s[12:15], s35 offen lds
    s_add_u32 m0, s39, 2048
    s_nop 0
    buffer_load_dwordx4 v16, s[12:15], s35 offen lds
    s_add_u32 m0, s39, 3072
    s_nop 0
    buffer_load_dwordx4 v17, s[12:15], s35 offen lds
    s_add_u32 s33, s33, 32768
    s_add_u32 s32, s32, 1
    s_cmp_eq_u32 s33, 131072
    s_cselect_b32 s33, 0, s33
    s_cmp_lt_u32 s32, 28
    s_cbranch_scc1 g4_ld_loop
    s_waitcnt vmcnt(16)
    s_barrier
    s_waitcnt vmcnt(8)
    s_barrier
    s_waitcnt vmcnt(0)
    s_barrier
    s_branch g4_ld_end
g4_ld_s4:
    s_waitcnt vmcnt(12)
    s_branch g4_ld_bar
g4_ld_end:
    s_cmp_lg_u32 s96, 0
    s_cbranch_scc1 g4_done
    s_barrier
    s_mov_b32 s96, 1
    s_mov_b32 s97, 0x2800000
    s_branch g1_in
g4_done:
    s_endpgm
g4_compute:
    v_lshrrev_b32 v5, 4, v2
    v_bfe_u32 v6, v2, 2, 2
    v_and_b32 v7, 3, v2
    v_and_b32 v8, 15, v2
    s_and_b32 s44, s28, 1
    s_lshr_b32 s45, s28, 1
    s_mul_i32 s40, s25, 128
    s_mul_i32 s41, s45, 64
    s_add_u32 s40, s40, s41
    s_lshl_b32 s41, s91, 5
    s_add_u32 s40, s40, s41
    v_add_u32 v20, s40, v8
    s_mov_b32 s41, 2048
    v_mul_lo_u32 v9, v20, s41
    s_mul_i32 s40, s24, 256
    s_mul_i32 s41, s44, 128
    s_add_u32 s46, s40, s41
    v_and_b32 v3, 1, v5
    v_lshlrev_b32 v3, 5, v3
    v_lshrrev_b32 v4, 1, v5
    v_lshl_add_u32 v3, v4, 4, v3
    v_add3_u32 v9, v9, v3, s46
    s_mov_b32 s52, 0
    s_mov_b32 s53, 32768
    s_mov_b32 s54, 65536
    s_mov_b32 s55, 98304
    s_waitcnt lgkmcnt(0)
    s_add_u32 s4, s4, s97
    s_addc_u32 s5, s5, 0
    s_add_u32 s20, s4, 0x800000
    s_addc_u32 s21, s5, 0
    s_mov_b32 s22, 0x400000
    s_mov_b32 s23, 0x20000
    s_mov_b32 s56, s34
    s_mov_b32 s57, s35
    s_mov_b32 s58, 0x1000
    s_mov_b32 s59, 0x20000
    s_add_u32 s16, s4, 0x4100000
    s_addc_u32 s17, s5, 0
    s_cmp_eq_u32 s96, 0
    s_cselect_b32 s16, s16, s6
    s_cselect_b32 s17, s17, s7
    s_mov_b32 s18, 0x400000
    s_mov_b32 s19, 0x20000
    s_add_u32 s60, s4, 0x2800000
    s_addc_u32 s61, s5, 0
    s_mov_b32 s62, 0x40000
    s_mov_b32 s63, 0x20000
    s_add_u32 s84, s4, 0x1d00000
    s_addc_u32 s85, s5, 0
    s_mov_b32 s86, 0x400000
    s_mov_b32 s87, 0x20000
    s_mul_i32 s42, s44, 64
    v_lshrrev_b32 v3, 1, v8
    v_xor_b32 v3, v3, v5
    v_lshlrev_b32 v3, 4, v3
    v_lshl_add_u32 v3, v8, 7, v3
    s_lshl_b32 s40, s42, 7
    s_add_u32 s40, s40, 0
    v_add_u32 v10, s40, v3
    v_xor_b32 v11, 64, v10
    s_lshl_b32 s90, s91, 1
    s_mul_i32 s42, s45, 4
    s_mov_b32 s43, 16384
    v_and_b32 v3, 1, v5
    v_lshl_or_b32 v3, v3, 2, v6
    s_add_u32 s40, s42, 0
    s_xor_b32 s40, s40, s90
    v_xor_b32 v3, s40, v3
    v_lshlrev_b32 v3, 5, v3
    v_lshl_add_u32 v3, v7, 3, v3
    v_lshl_add_u32 v4, v5, 3, v6
    v_lshl_add_u32 v3, v4, 8, v3
    v_add_u32 v12, s43, v3
    v_and_b32 v3, 1, v5
    v_lshl_or_b32 v3, v3, 2, v6
    s_add_u32 s40, s42, 1
    s_xor_b32 s40, s40, s90
    v_xor_b32 v3, s40, v3
    v_lshlrev_b32 v3, 5, v3
    v_lshl_add_u32 v3, v7, 3, v3
    v_lshl_add_u32 v4, v5, 3, v6
    v_lshl_add_u32 v3, v4, 8, v3
    v_add_u32 v13, s43, v3
    v_and_b32 v3, 1, v5
    v_lshl_or_b32 v3, v3, 2, v6
    s_add_u32 s40, s42, 2
    s_xor_b32 s40, s40, s90
    v_xor_b32 v3, s40, v3
    v_lshlrev_b32 v3, 5, v3
    v_lshl_add_u32 v3, v7, 3, v3
    v_lshl_add_u32 v4, v5, 3, v6
    v_lshl_add_u32 v3, v4, 8, v3
    v_add_u32 v14, s43, v3
    v_and_b32 v3, 1, v5
    v_lshl_or_b32 v3, v3, 2, v6
    s_add_u32 s40, s42, 3
    s_xor_b32 s40, s40, s90
    v_xor_b32 v3, s40, v3
    v_lshlrev_b32 v3, 5, v3
    v_lshl_add_u32 v3, v7, 3, v3
    v_lshl_add_u32 v4, v5, 3, v6
    v_lshl_add_u32 v3, v4, 8, v3
    v_add_u32 v15, s43, v3
    v_mov_b32 v124, 0
    v_mov_b32 v125, 0
    v_mov_b32 v126, 0
    v_mov_b32 v127, 0
    v_mov_b32 v128, 0
    v_mov_b32 v129, 0
    v_mov_b32 v130, 0
    v_mov_b32 v131, 0
    v_mov_b32 v132, 0
    v_mov_b32 v133, 0
    v_mov_b32 v134, 0
    v_mov_b32 v135, 0
    v_mov_b32 v136, 0
    v_mov_b32 v137, 0
    v_mov_b32 v138, 0
    v_mov_b32 v139, 0
    v_mov_b32 v140, 0
    v_mov_b32 v141, 0
    v_mov_b32 v142, 0
    v_mov_b32 v143, 0
    v_mov_b32 v144, 0
    v_mov_b32 v145, 0
    v_mov_b32 v146, 0
    v_mov_b32 v147, 0
    v_mov_b32 v148, 0
    v_mov_b32 v149, 0
    v_mov_b32 v150, 0
    v_mov_b32 v151, 0
    v_mov_b32 v152, 0
    v_mov_b32 v153, 0
    v_mov_b32 v154, 0
    v_mov_b32 v155, 0
    s_mov_b32 s48, 28
    s_mov_b32 s50, 0
    s_mov_b32 s51, 32768
    s_mov_b32 s29, 0xfffe8000
    s_lshl_b32 s40, s28, 12
    v_lshl_add_u32 v21, v2, 4, s40
    s_lshl_b32 s93, s92, 1
    s_add_u32 s93, s93, s91
    s_lshl_b32 s93, s93, 14
    s_xor_b32 s94, s93, 0x4000
    v_mov_b32 v28, 0
    v_mov_b32 v29, 0
    v_mov_b32 v30, 0
    v_mov_b32 v31, 0
    v_mov_b32 v32, 0
    v_mov_b32 v33, 0
    v_mov_b32 v34, 0
    v_mov_b32 v35, 0
    v_mov_b32 v36, 0
    v_mov_b32 v37, 0
    v_mov_b32 v38, 0
    v_mov_b32 v39, 0
    v_mov_b32 v40, 0
    v_mov_b32 v41, 0
    v_mov_b32 v42, 0
    v_mov_b32 v43, 0
    v_mov_b32 v44, 0
    v_mov_b32 v45, 0
    v_mov_b32 v46, 0
    v_mov_b32 v47, 0
    v_mov_b32 v48, 0
    v_mov_b32 v49, 0
    v_mov_b32 v50, 0
    v_mov_b32 v51, 0
    v_mov_b32 v52, 0
    v_mov_b32 v53, 0
    v_mov_b32 v54, 0
    v_mov_b32 v55, 0
    v_mov_b32 v56, 0
    v_mov_b32 v57, 0
    v_mov_b32 v58, 0
    v_mov_b32 v59, 0
    v_mov_b32 v60, 0
    v_mov_b32 v61, 0
    v_mov_b32 v62, 0
    v_mov_b32 v63, 0
    v_mov_b32 v64, 0
    v_mov_b32 v65, 0
    v_mov_b32 v66, 0
    v_mov_b32 v67, 0
    v_mov_b32 v68, 0
    v_mov_b32 v69, 0
    v_mov_b32 v70, 0
    v_mov_b32 v71, 0
    v_mov_b32 v72, 0
    v_mov_b32 v73, 0
    v_mov_b32 v74, 0
    v_mov_b32 v75, 0
    v_mov_b32 v76, 0
    v_mov_b32 v77, 0
    v_mov_b32 v78, 0
    v_mov_b32 v79, 0
    v_mov_b32 v80, 0
    v_mov_b32 v81, 0
    v_mov_b32 v82, 0
    v_mov_b32 v83, 0
    v_mov_b32 v84, 0
    v_mov_b32 v85, 0
    v_mov_b32 v86, 0
    v_mov_b32 v87, 0
    v_mov_b32 v88, 0
    v_mov_b32 v89, 0
    v_mov_b32 v90, 0
    v_mov_b32 v91, 0
    s_barrier
    buffer_load_dwordx4 v[188:191], v9, s[20:23], s52 offen offset:0 sc1
    buffer_load_dwordx4 v[192:195], v9, s[20:23], s52 offen offset:64 sc1
    buffer_load_dwordx4 v[196:199], v9, s[20:23], s53 offen offset:0 sc1
    buffer_load_dwordx4 v[200:203], v9, s[20:23], s53 offen offset:64 sc1
    v_lshlrev_b32 v3, 1, v20
    buffer_load_ushort v22, v3, s[56:59], 0 offen offset:0
    buffer_load_ushort v23, v3, s[56:59], 0 offen offset:32
    s_branch g4_cloop2
.p2align 3
g4_cloop:
    s_barrier
g4_cloop2:
    v_mfma_f32_16x16x32_bf16 v[28:31], v[124:127], v[140:143], v[28:31]
    ds_read_b128 v[92:95], v10 offset:0
    v_mfma_f32_16x16x32_bf16 v[32:35], v[124:127], v[144:147], v[32:35]
    ds_read_b64_tr_b16 v[108:109], v12 offset:0
    ds_read_b64_tr_b16 v[110:111], v12 offset:1024
    v_mfma_f32_16x16x32_bf16 v[36:39], v[124:127], v[148:151], v[36:39]
    ds_read_b64_tr_b16 v[112:113], v13 offset:0
    ds_read_b64_tr_b16 v[114:115], v13 offset:1024
    v_mfma_f32_16x16x32_bf16 v[40:43], v[124:127], v[152:155], v[40:43]
    ds_read_b64_tr_b16 v[116:117], v14 offset:0
    ds_read_b64_tr_b16 v[118:119], v14 offset:1024
    v_mfma_f32_16x16x32_bf16 v[44:47], v[128:131], v[140:143], v[44:47]
    ds_read_b64_tr_b16 v[120:121], v15 offset:0
    ds_read_b64_tr_b16 v[122:123], v15 offset:1024
    v_mfma_f32_16x16x32_bf16 v[48:51], v[128:131], v[144:147], v[48:51]
    ds_read_b128 v[96:99], v10 offset:2048
    v_mfma_f32_16x16x32_bf16 v[52:55], v[128:131], v[148:151], v[52:55]
    ds_read_b128 v[100:103], v10 offset:4096
    v_mfma_f32_16x16x32_bf16 v[56:59], v[128:131], v[152:155], v[56:59]
    ds_read_b128 v[104:107], v10 offset:6144
    v_mfma_f32_16x16x32_bf16 v[60:63], v[132:135], v[140:143], v[60:63]
    v_mfma_f32_16x16x32_bf16 v[64:67], v[132:135], v[144:147], v[64:67]
    v_mfma_f32_16x16x32_bf16 v[68:71], v[132:135], v[148:151], v[68:71]
    v_mfma_f32_16x16x32_bf16 v[72:75], v[132:135], v[152:155], v[72:75]
    v_mfma_f32_16x16x32_bf16 v[76:79], v[136:139], v[140:143], v[76:79]
    v_mfma_f32_16x16x32_bf16 v[80:83], v[136:139], v[144:147], v[80:83]
    v_mfma_f32_16x16x32_bf16 v[84:87], v[136:139], v[148:151], v[84:87]
    v_mfma_f32_16x16x32_bf16 v[88:91], v[136:139], v[152:155], v[88:91]
    s_waitcnt lgkmcnt(0)
    v_mfma_f32_16x16x32_bf16 v[28:31], v[92:95], v[108:111], v[28:31]
    ds_read_b128 v[124:127], v11 offset:0
    v_mfma_f32_16x16x32_bf16 v[32:35], v[92:95], v[112:115], v[32:35]
    ds_read_b64_tr_b16 v[140:141], v12 offset:8192
    ds_read_b64_tr_b16 v[142:143], v12 offset:9216
    v_mfma_f32_16x16x32_bf16 v[36:39], v[92:95], v[116:119], v[36:39]
    ds_read_b64_tr_b16 v[144:145], v13 offset:8192
    ds_read_b64_tr_b16 v[146:147], v13 offset:9216
    v_mfma_f32_16x16x32_bf16 v[40:43], v[92:95], v[120:123], v[40:43]
    ds_read_b64_tr_b16 v[148:149], v14 offset:8192
    ds_read_b64_tr_b16 v[150:151], v14 offset:9216
    v_mfma_f32_16x16x32_bf16 v[44:47], v[96:99], v[108:111], v[44:47]
    ds_read_b64_tr_b16 v[152:153], v15 offset:8192
    ds_read_b64_tr_b16 v[154:155], v15 offset:9216
    v_mfma_f32_16x16x32_bf16 v[48:51], v[96:99], v[112:115], v[48:51]
    ds_read_b128 v[128:131], v11 offset:2048
    v_mfma_f32_16x16x32_bf16 v[52:55], v[96:99], v[116:119], v[52:55]
    ds_read_b128 v[132:135], v11 offset:4096
    v_mfma_f32_16x16x32_bf16 v[56:59], v[96:99], v[120:123], v[56:59]
    ds_read_b128 v[136:139], v11 offset:6144
    v_mfma_f32_16x16x32_bf16 v[60:63], v[100:103], v[108:111], v[60:63]
    s_add_u32 s50, s50, 1
    s_cmp_eq_u32 s50, 4
    v_mfma_f32_16x16x32_bf16 v[64:67], v[100:103], v[112:115], v[64:67]
    s_cselect_b32 s49, s29, s51
    s_cselect_b32 s50, 0, s50
    v_mfma_f32_16x16x32_bf16 v[68:71], v[100:103], v[116:119], v[68:71]
    v_add_u32 v10, s49, v10
    v_add_u32 v11, s49, v11
    v_mfma_f32_16x16x32_bf16 v[72:75], v[100:103], v[120:123], v[72:75]
    v_add_u32 v12, s49, v12
    v_add_u32 v13, s49, v13
    v_mfma_f32_16x16x32_bf16 v[76:79], v[104:107], v[108:111], v[76:79]
    v_add_u32 v14, s49, v14
    v_add_u32 v15, s49, v15
    v_mfma_f32_16x16x32_bf16 v[80:83], v[104:107], v[112:115], v[80:83]
    s_sub_u32 s48, s48, 1
    s_cmp_lg_u32 s48, 0
    v_mfma_f32_16x16x32_bf16 v[84:87], v[104:107], v[116:119], v[84:87]
    v_mfma_f32_16x16x32_bf16 v[88:91], v[104:107], v[120:123], v[88:91]
    s_waitcnt lgkmcnt(0)
    s_cbranch_scc1 g4_cloop
    v_mfma_f32_16x16x32_bf16 v[36:39], v[124:127], v[148:151], v[36:39]
    v_mfma_f32_16x16x32_bf16 v[52:55], v[128:131], v[148:151], v[52:55]
    v_mfma_f32_16x16x32_bf16 v[68:71], v[132:135], v[148:151], v[68:71]
    v_mfma_f32_16x16x32_bf16 v[84:87], v[136:139], v[148:151], v[84:87]
    v_mfma_f32_16x16x32_bf16 v[40:43], v[124:127], v[152:155], v[40:43]
    v_mfma_f32_16x16x32_bf16 v[56:59], v[128:131], v[152:155], v[56:59]
    v_mfma_f32_16x16x32_bf16 v[72:75], v[132:135], v[152:155], v[72:75]
    v_mfma_f32_16x16x32_bf16 v[88:91], v[136:139], v[152:155], v[88:91]
    v_mfma_f32_16x16x32_bf16 v[28:31], v[124:127], v[140:143], v[28:31]
    v_cvt_pk_bf16_f32 v156, v36, v37
    v_cvt_pk_bf16_f32 v157, v38, v39
    v_mfma_f32_16x16x32_bf16 v[44:47], v[128:131], v[140:143], v[44:47]
    v_cvt_pk_bf16_f32 v158, v52, v53
    v_cvt_pk_bf16_f32 v159, v54, v55
    buffer_store_dwordx4 v[156:159], v21, s[84:87], s93 offen offset:0 sc1
    v_mfma_f32_16x16x32_bf16 v[60:63], v[132:135], v[140:143], v[60:63]
    v_cvt_pk_bf16_f32 v160, v68, v69
    v_cvt_pk_bf16_f32 v161, v70, v71
    v_mfma_f32_16x16x32_bf16 v[76:79], v[136:139], v[140:143], v[76:79]
    v_cvt_pk_bf16_f32 v162, v84, v85
    v_cvt_pk_bf16_f32 v163, v86, v87
    buffer_store_dwordx4 v[160:163], v21, s[84:87], s93 offen offset:1024 sc1
    v_mfma_f32_16x16x32_bf16 v[32:35], v[124:127], v[144:147], v[32:35]
    v_cvt_pk_bf16_f32 v164, v40, v41
    v_cvt_pk_bf16_f32 v165, v42, v43
    v_mfma_f32_16x16x32_bf16 v[48:51], v[128:131], v[144:147], v[48:51]
    v_cvt_pk_bf16_f32 v166, v56, v57
    v_cvt_pk_bf16_f32 v167, v58, v59
    buffer_store_dwordx4 v[164:167], v21, s[84:87], s93 offen offset:2048 sc1
    v_mfma_f32_16x16x32_bf16 v[64:67], v[132:135], v[144:147], v[64:67]
    v_cvt_pk_bf16_f32 v168, v72, v73
    v_cvt_pk_bf16_f32 v169, v74, v75
    v_mfma_f32_16x16x32_bf16 v[80:83], v[136:139], v[144:147], v[80:83]
    s_nop 1
    v_cvt_pk_bf16_f32 v170, v88, v89
    v_cvt_pk_bf16_f32 v171, v90, v91
    buffer_store_dwordx4 v[168:171], v21, s[84:87], s93 offen offset:3072 sc1
    s_mov_b32 s48, 0x2000
    buffer_load_dwordx4 v[172:175], v21, s[84:87], s94 offen offset:0 sc1
    buffer_load_dwordx4 v[176:179], v21, s[84:87], s94 offen offset:1024 sc1
    buffer_load_dwordx4 v[180:183], v21, s[84:87], s94 offen offset:2048 sc1
    buffer_load_dwordx4 v[184:187], v21, s[84:87], s94 offen offset:3072 sc1
    s_waitcnt vmcnt(8)
    s_nop 3
    v_permlane16_swap_b32 v188, v190
    v_permlane16_swap_b32 v189, v191
    v_permlane16_swap_b32 v192, v194
    v_permlane16_swap_b32 v193, v195
    v_permlane16_swap_b32 v196, v198
    v_permlane16_swap_b32 v197, v199
    v_permlane16_swap_b32 v200, v202
    v_permlane16_swap_b32 v201, v203
    v_lshlrev_b32 v22, 16, v22
    v_lshlrev_b32 v23, 16, v23
    v_lshlrev_b32 v204, 16, v188
    v_and_b32 v205, 0xffff0000, v188
    v_lshlrev_b32 v206, 16, v189
    v_and_b32 v207, 0xffff0000, v189
    v_lshlrev_b32 v208, 16, v190
    v_and_b32 v209, 0xffff0000, v190
    v_lshlrev_b32 v210, 16, v191
    v_and_b32 v211, 0xffff0000, v191
    v_add_f32 v204, v204, v22
    v_add_f32 v205, v205, v22
    v_add_f32 v206, v206, v22
    v_add_f32 v207, v207, v22
    v_add_f32 v208, v208, v22
    v_add_f32 v209, v209, v22
    v_add_f32 v210, v210, v22
    v_add_f32 v211, v211, v22
    v_pk_add_f32 v[28:29], v[28:29], v[204:205]
    v_pk_add_f32 v[30:31], v[30:31], v[206:207]
    v_pk_add_f32 v[44:45], v[44:45], v[208:209]
    v_pk_add_f32 v[46:47], v[46:47], v[210:211]
    v_lshlrev_b32 v204, 16, v192
    v_and_b32 v205, 0xffff0000, v192
    v_lshlrev_b32 v206, 16, v193
    v_and_b32 v207, 0xffff0000, v193
    v_lshlrev_b32 v208, 16, v194
    v_and_b32 v209, 0xffff0000, v194
    v_lshlrev_b32 v210, 16, v195
    v_and_b32 v211, 0xffff0000, v195
    v_add_f32 v204, v204, v22
    v_add_f32 v205, v205, v22
    v_add_f32 v206, v206, v22
    v_add_f32 v207, v207, v22
    v_add_f32 v208, v208, v22
    v_add_f32 v209, v209, v22
    v_add_f32 v210, v210, v22
    v_add_f32 v211, v211, v22
    v_pk_add_f32 v[60:61], v[60:61], v[204:205]
    v_pk_add_f32 v[62:63], v[62:63], v[206:207]
    v_pk_add_f32 v[76:77], v[76:77], v[208:209]
    v_pk_add_f32 v[78:79], v[78:79], v[210:211]
    v_lshlrev_b32 v204, 16, v196
    v_and_b32 v205, 0xffff0000, v196
    v_lshlrev_b32 v206, 16, v197
    v_and_b32 v207, 0xffff0000, v197
    v_lshlrev_b32 v208, 16, v198
    v_and_b32 v209, 0xffff0000, v198
    v_lshlrev_b32 v210, 16, v199
    v_and_b32 v211, 0xffff0000, v199
    v_add_f32 v204, v204, v23
    v_add_f32 v205, v205, v23
    v_add_f32 v206, v206, v23
    v_add_f32 v207, v207, v23
    v_add_f32 v208, v208, v23
    v_add_f32 v209, v209, v23
    v_add_f32 v210, v210, v23
    v_add_f32 v211, v211, v23
    v_pk_add_f32 v[32:33], v[32:33], v[204:205]
    v_pk_add_f32 v[34:35], v[34:35], v[206:207]
    v_pk_add_f32 v[48:49], v[48:49], v[208:209]
    v_pk_add_f32 v[50:51], v[50:51], v[210:211]
    v_lshlrev_b32 v204, 16, v200
    v_and_b32 v205, 0xffff0000, v200
    v_lshlrev_b32 v206, 16, v201
    v_and_b32 v207, 0xffff0000, v201
    v_lshlrev_b32 v208, 16, v202
    v_and_b32 v209, 0xffff0000, v202
    v_lshlrev_b32 v210, 16, v203
    v_and_b32 v211, 0xffff0000, v203
    v_add_f32 v204, v204, v23
    v_add_f32 v205, v205, v23
    v_add_f32 v206, v206, v23
    v_add_f32 v207, v207, v23
    v_add_f32 v208, v208, v23
    v_add_f32 v209, v209, v23
    v_add_f32 v210, v210, v23
    v_add_f32 v211, v211, v23
    v_pk_add_f32 v[64:65], v[64:65], v[204:205]
    v_pk_add_f32 v[66:67], v[66:67], v[206:207]
    v_pk_add_f32 v[80:81], v[80:81], v[208:209]
    v_pk_add_f32 v[82:83], v[82:83], v[210:211]
    s_waitcnt vmcnt(0)
g4_rcv:
    v_max3_u32 v4, v172, v173, v174
    v_max3_u32 v4, v4, v175, v176
    v_max3_u32 v4, v4, v177, v178
    v_max3_u32 v4, v4, v179, v180
    v_max3_u32 v4, v4, v181, v182
    v_max3_u32 v4, v4, v183, v184
    v_max3_u32 v4, v4, v185, v186
    v_max_u32 v4, v4, v187
    v_cmp_eq_u32 vcc, -1, v4
    s_sub_u32 s48, s48, 1
    s_cmp_eq_u32 s48, 0
    s_cbranch_scc1 g4_rcvd
    s_cbranch_vccz g4_rcvd
    s_sleep 2
    buffer_load_dwordx4 v[172:175], v21, s[84:87], s94 offen offset:0 sc1
    buffer_load_dwordx4 v[176:179], v21, s[84:87], s94 offen offset:1024 sc1
    buffer_load_dwordx4 v[180:183], v21, s[84:87], s94 offen offset:2048 sc1
    buffer_load_dwordx4 v[184:187], v21, s[84:87], s94 offen offset:3072 sc1
    s_waitcnt vmcnt(0)
    s_branch g4_rcv
g4_rcvd:
    v_lshlrev_b32 v108, 16, v172
    v_and_b32 v109, 0xffff0000, v172
    v_lshlrev_b32 v110, 16, v173
    v_and_b32 v111, 0xffff0000, v173
    v_pk_add_f32 v[28:29], v[28:29], v[108:109]
    v_pk_add_f32 v[30:31], v[30:31], v[110:111]
    v_lshlrev_b32 v112, 16, v174
    v_and_b32 v113, 0xffff0000, v174
    v_lshlrev_b32 v114, 16, v175
    v_and_b32 v115, 0xffff0000, v175
    v_pk_add_f32 v[44:45], v[44:45], v[112:113]
    v_pk_add_f32 v[46:47], v[46:47], v[114:115]
    v_lshlrev_b32 v116, 16, v176
    v_and_b32 v117, 0xffff0000, v176
    v_lshlrev_b32 v118, 16, v177
    v_and_b32 v119, 0xffff0000, v177
    v_pk_add_f32 v[60:61], v[60:61], v[116:117]
    v_pk_add_f32 v[62:63], v[62:63], v[118:119]
    v_lshlrev_b32 v120, 16, v178
    v_and_b32 v121, 0xffff0000, v178
    v_lshlrev_b32 v122, 16, v179
    v_and_b32 v123, 0xffff0000, v179
    v_pk_add_f32 v[76:77], v[76:77], v[120:121]
    v_pk_add_f32 v[78:79], v[78:79], v[122:123]
    v_lshlrev_b32 v108, 16, v180
    v_and_b32 v109, 0xffff0000, v180
    v_lshlrev_b32 v110, 16, v181
    v_and_b32 v111, 0xffff0000, v181
    v_pk_add_f32 v[32:33], v[32:33], v[108:109]
    v_pk_add_f32 v[34:35], v[34:35], v[110:111]
    v_lshlrev_b32 v112, 16, v182
    v_and_b32 v113, 0xffff0000, v182
    v_lshlrev_b32 v114, 16, v183
    v_and_b32 v115, 0xffff0000, v183
    v_pk_add_f32 v[48:49], v[48:49], v[112:113]
    v_pk_add_f32 v[50:51], v[50:51], v[114:115]
    v_lshlrev_b32 v116, 16, v184
    v_and_b32 v117, 0xffff0000, v184
    v_lshlrev_b32 v118, 16, v185
    v_and_b32 v119, 0xffff0000, v185
    v_pk_add_f32 v[64:65], v[64:65], v[116:117]
    v_pk_add_f32 v[66:67], v[66:67], v[118:119]
    v_lshlrev_b32 v120, 16, v186
    v_and_b32 v121, 0xffff0000, v186
    v_lshlrev_b32 v122, 16, v187
    v_and_b32 v123, 0xffff0000, v187
    v_pk_add_f32 v[80:81], v[80:81], v[120:121]
    v_pk_add_f32 v[82:83], v[82:83], v[122:123]
    v_cvt_pk_bf16_f32 v92, v28, v29
    v_cvt_pk_bf16_f32 v93, v30, v31
    v_cvt_pk_bf16_f32 v94, v44, v45
    v_cvt_pk_bf16_f32 v95, v46, v47
    s_nop 1
    v_permlane16_swap_b32 v92, v94
    v_permlane16_swap_b32 v93, v95
    buffer_store_dwordx4 v[92:95], v9, s[16:19], s52 offen offset:0 sc1
    v_cvt_pk_bf16_f32 v96, v60, v61
    v_cvt_pk_bf16_f32 v97, v62, v63
    v_cvt_pk_bf16_f32 v98, v76, v77
    v_cvt_pk_bf16_f32 v99, v78, v79
    s_nop 1
    v_permlane16_swap_b32 v96, v98
    v_permlane16_swap_b32 v97, v99
    buffer_store_dwordx4 v[96:99], v9, s[16:19], s52 offen offset:64 sc1
    v_cvt_pk_bf16_f32 v100, v32, v33
    v_cvt_pk_bf16_f32 v101, v34, v35
    v_cvt_pk_bf16_f32 v102, v48, v49
    v_cvt_pk_bf16_f32 v103, v50, v51
    s_nop 1
    v_permlane16_swap_b32 v100, v102
    v_permlane16_swap_b32 v101, v103
    buffer_store_dwordx4 v[100:103], v9, s[16:19], s53 offen offset:0 sc1
    v_cvt_pk_bf16_f32 v104, v64, v65
    v_cvt_pk_bf16_f32 v105, v66, v67
    v_cvt_pk_bf16_f32 v106, v80, v81
    v_cvt_pk_bf16_f32 v107, v82, v83
    s_nop 1
    v_permlane16_swap_b32 v104, v106
    v_permlane16_swap_b32 v105, v107
    buffer_store_dwordx4 v[104:107], v9, s[16:19], s53 offen offset:64 sc1
    v_pk_add_f32 v[108:109], v[28:29], v[30:31]
    v_pk_mul_f32 v[110:111], v[28:29], v[28:29]
    v_pk_fma_f32 v[110:111], v[30:31], v[30:31], v[110:111]
    v_pk_add_f32 v[108:109], v[108:109], v[44:45]
    v_pk_fma_f32 v[110:111], v[44:45], v[44:45], v[110:111]
    v_pk_add_f32 v[108:109], v[108:109], v[46:47]
    v_pk_fma_f32 v[110:111], v[46:47], v[46:47], v[110:111]
    v_pk_add_f32 v[108:109], v[108:109], v[60:61]
    v_pk_fma_f32 v[110:111], v[60:61], v[60:61], v[110:111]
    v_pk_add_f32 v[108:109], v[108:109], v[62:63]
    v_pk_fma_f32 v[110:111], v[62:63], v[62:63], v[110:111]
    v_pk_add_f32 v[108:109], v[108:109], v[76:77]
    v_pk_fma_f32 v[110:111], v[76:77], v[76:77], v[110:111]
    v_pk_add_f32 v[108:109], v[108:109], v[78:79]
    v_pk_fma_f32 v[110:111], v[78:79], v[78:79], v[110:111]
    v_pk_add_f32 v[112:113], v[32:33], v[34:35]
    v_pk_mul_f32 v[114:115], v[32:33], v[32:33]
    v_pk_fma_f32 v[114:115], v[34:35], v[34:35], v[114:115]
    v_pk_add_f32 v[112:113], v[112:113], v[48:49]
    v_pk_fma_f32 v[114:115], v[48:49], v[48:49], v[114:115]
    v_pk_add_f32 v[112:113], v[112:113], v[50:51]
    v_pk_fma_f32 v[114:115], v[50:51], v[50:51], v[114:115]
    v_pk_add_f32 v[112:113], v[112:113], v[64:65]
    v_pk_fma_f32 v[114:115], v[64:65], v[64:65], v[114:115]
    v_pk_add_f32 v[112:113], v[112:113], v[66:67]
    v_pk_fma_f32 v[114:115], v[66:67], v[66:67], v[114:115]
    v_pk_add_f32 v[112:113], v[112:113], v[80:81]
    v_pk_fma_f32 v[114:115], v[80:81], v[80:81], v[114:115]
    v_pk_add_f32 v[112:113], v[112:113], v[82:83]
    v_pk_fma_f32 v[114:115], v[82:83], v[82:83], v[114:115]
    v_add_f32 v108, v108, v109
    v_add_f32 v109, v110, v111
    v_add_f32 v112, v112, v113
    v_add_f32 v113, v114, v115
    s_nop 1
    v_permlane16_swap_b32 v108, v112
    v_permlane16_swap_b32 v109, v113
    v_pk_add_f32 v[108:109], v[108:109], v[112:113]
    v_mov_b32 v116, v108
    v_mov_b32 v117, v109
    v_and_b32 v3, 16, v2
    v_add_u32 v3, v3, v20
    v_permlane32_swap_b32 v108, v116
    v_permlane32_swap_b32 v109, v117
    v_pk_add_f32 v[108:109], v[108:109], v[116:117]
    v_lshlrev_b32 v3, 3, v3
    s_mul_i32 s40, s24, 2
    s_add_u32 s40, s40, s44
    s_lshl_b32 s40, s40, 14
    s_mov_b32 exec_hi, 0
    buffer_store_dwordx2 v[108:109], v3, s[60:63], s40 offen sc1
    s_mov_b32 exec_hi, -1
    s_cmp_lg_u32 s96, 0
    s_cbranch_scc1 g4_done
    s_lshr_b32 s40, s25, 0
    s_add_u32 s40, s40, 40
    s_lshl_b32 s40, s40, 8
    s_mov_b32 s42, s40
    s_add_u32 s84, s4, 0x2b00000
    s_addc_u32 s85, s5, 0
    s_mov_b32 s86, 0x4000
    s_mov_b32 s87, 0x20000
    v_mov_b32 v3, s40
    v_mov_b32 v4, 1
    s_waitcnt vmcnt(0)
    s_barrier
    s_cmp_lg_u32 s28, 0
    s_cbranch_scc1 g4_cin
    s_mov_b64 exec, 1
    buffer_atomic_add v4, v3, s[84:87], 0 offen sc1
    s_mov_b64 exec, -1
g4_cin:
    s_mov_b32 s96, 1
    s_mov_b32 s97, 0x2800000
    s_branch g1_in
code_end:
.section .rodata,"a"
.p2align 6
.amdhsa_kernel g1a_kernel
  .amdhsa_next_free_vgpr 248
  .amdhsa_next_free_sgpr 100
  .amdhsa_accum_offset 248
  .amdhsa_group_segment_fixed_size 0
  .amdhsa_kernarg_size 88
  .amdhsa_user_sgpr_count 2
  .amdhsa_user_sgpr_kernarg_segment_ptr 1
  .amdhsa_system_sgpr_workgroup_id_x 1
.end_amdhsa_kernel
```

```asm
; @launch kernel=g1a_kernel grid=(256,1,1) block=(512,1,1) lds=131328
.amdgcn_target "amdgcn-amd-amdhsa--gfx950"
.text
.globl g1a_kernel
.p2align 8
.type g1a_kernel,@function
g1a_kernel:
    s_mov_b32 s96, 0
    s_mov_b32 s97, 0x0
    v_mov_b32 v1, 131072
    v_mov_b32 v2, 0
    ds_write_b32 v1, v2
    s_branch g1_in
.p2align 6
g1_in:
    s_cmp_ge_u32 s2, 256
    s_cbranch_scc1 g1_done
    s_load_dwordx2 s[4:5], s[0:1], 80
    s_load_dwordx2 s[6:7], s[0:1], 0
    s_xor_b32 s53, s96, 1
    s_load_dwordx2 s[30:31], s[0:1], 8
    s_load_dwordx2 s[16:17], s[0:1], 72
    s_load_dwordx2 s[18:19], s[0:1], 16
    v_lshrrev_b32 v1, 6, v0
    v_and_b32 v2, 63, v0
    s_and_b32 s40, s2, 1
    s_lshl_b32 s40, s40, 3
    s_bfe_u32 s41, s2, 0x30003
    s_add_u32 s25, s40, s41
    s_bfe_u32 s40, s2, 0x20001
    s_lshl_b32 s40, s40, 2
    s_lshr_b32 s42, s2, 6
    s_add_u32 s24, s40, s42
    s_add_u32 s27, s41, s42
    s_add_u32 s52, s24, s25
    s_and_b32 s52, s52, 15
    s_and_b32 s26, s52, 12
    s_mul_i32 s26, s26, s53
    v_readfirstlane_b32 s28, v1
    v_lshrrev_b32 v5, 4, v2
    v_bfe_u32 v6, v2, 2, 2
    v_and_b32 v7, 3, v2
    v_and_b32 v8, 15, v2
    s_cmp_lt_u32 s28, 4
    s_cbranch_scc1 g1_compute
    s_sub_u32 s28, s28, 4
    s_mov_b32 s40, 2048
    v_lshrrev_b32 v3, 3, v2
    v_mul_lo_u32 v3, v3, s40
    v_lshrrev_b32 v4, 4, v2
    v_xor_b32 v4, v4, v2
    v_and_b32 v4, 7, v4
    v_lshl_add_u32 v3, v4, 4, v3
    s_mul_i32 s41, s25, 262144
    s_mul_i32 s42, s28, 65536
    s_add_u32 s41, s41, s42
    v_xor_b32 v4, 64, v3
    s_add_u32 s42, s41, 0
    v_add_u32 v16, s42, v3
    s_add_u32 s42, s41, 16384
    v_add_u32 v17, s42, v4
    s_add_u32 s42, s41, 32768
    v_add_u32 v18, s42, v3
    s_add_u32 s42, s41, 49152
    v_add_u32 v19, s42, v4
    s_mov_b32 s40, 6144
    v_lshrrev_b32 v3, 3, v2
    v_mul_lo_u32 v3, v3, s40
    v_bfe_u32 v4, v2, 4, 1
    v_lshlrev_b32 v4, 1, v4
    v_xor_b32 v4, v4, v2
    v_and_b32 v4, 7, v4
    v_lshl_add_u32 v3, v4, 4, v3
    s_mul_i32 s41, s24, 128
    s_mul_i32 s42, s28, 98304
    s_add_u32 s41, s41, s42
    v_xor_b32 v4, 64, v3
    s_add_u32 s42, s41, 0
    v_add_u32 v10, s42, v3
    s_add_u32 s42, s41, 49152
    v_add_u32 v11, s42, v4
    s_mov_b32 s40, 6144
    v_lshrrev_b32 v3, 3, v2
    v_mul_lo_u32 v3, v3, s40
    v_bfe_u32 v4, v2, 4, 1
    v_lshlrev_b32 v4, 1, v4
    v_xor_b32 v4, v4, v2
    v_and_b32 v4, 7, v4
    v_lshl_add_u32 v3, v4, 4, v3
    s_mul_i32 s41, s24, 128
    s_mul_i32 s42, s28, 98304
    s_add_u32 s41, s41, s42
    v_xor_b32 v4, 64, v3
    s_add_u32 s42, s41, 2048
    v_add_u32 v12, s42, v3
    s_add_u32 s42, s41, 51200
    v_add_u32 v13, s42, v4
    s_mov_b32 s40, 6144
    v_lshrrev_b32 v3, 3, v2
    v_mul_lo_u32 v3, v3, s40
    v_bfe_u32 v4, v2, 4, 1
    v_lshlrev_b32 v4, 1, v4
    v_xor_b32 v4, v4, v2
    v_and_b32 v4, 7, v4
    v_lshl_add_u32 v3, v4, 4, v3
    s_mul_i32 s41, s24, 128
    s_mul_i32 s42, s28, 98304
    s_add_u32 s41, s41, s42
    v_xor_b32 v4, 64, v3
    s_add_u32 s42, s41, 4096
    v_add_u32 v14, s42, v3
    s_add_u32 s42, s41, 53248
    v_add_u32 v15, s42, v4
    v_lshrrev_b32 v3, 3, v2
    s_lshl_b32 s40, s28, 2
    v_add_u32 v3, s40, v3
    v_lshrrev_b32 v4, 1, v3
    v_xor_b32 v4, v4, v2
    v_and_b32 v4, 7, v4
    s_lshl_b32 s40, s25, 7
    s_sub_u32 s40, s40, 16
    v_add_u32 v3, s40, v3
    v_max_i32 v3, 0, v3
    v_lshlrev_b32 v3, 11, v3
    v_lshl_add_u32 v20, v4, 4, v3
    s_mul_i32 s36, s28, 2048
    s_mul_i32 s37, s28, 4096
    s_add_u32 s37, s37, 26624
    s_mul_i32 s46, s28, 512
    s_add_u32 s46, s46, 24576
    s_waitcnt lgkmcnt(0)
    s_mov_b32 s8, s30
    s_mov_b32 s9, s31
    s_mov_b32 s10, 0x600000
    s_mov_b32 s11, 0x20000
    s_add_u32 s56, s4, 0x100000
    s_addc_u32 s57, s5, 0
    s_mov_b32 s58, 0x30000
    s_mov_b32 s59, 0x20000
    s_add_u32 s4, s4, s97
    s_addc_u32 s5, s5, 0
    s_add_u32 s12, s4, 0x1900000
    s_addc_u32 s13, s5, 0
    s_cmp_eq_u32 s96, 1
    s_cselect_b32 s12, s12, s6
    s_cselect_b32 s13, s13, s7
    s_mov_b32 s14, 0x400000
    s_mov_b32 s15, 0x20000
    s_mov_b32 s20, s4
    s_mov_b32 s21, s5
    s_mov_b32 s22, 0x40000
    s_mov_b32 s23, 0x20000
    s_mov_b32 s60, s16
    s_mov_b32 s61, s17
    s_mov_b32 s62, 0x100
    s_mov_b32 s63, 0x20000
    s_sub_u32 s40, s52, s27
    s_and_b32 s40, s40, 1
    s_and_b32 s41, s52, 2
    s_or_b32 s40, s40, s41
    s_add_u32 s54, s40, 2
    s_cmp_eq_u32 s53, 0
    s_cselect_b32 s54, 0x7fff, s54
    s_add_u32 s55, s54, 3
    s_cmp_lg_u32 s28, 0
    s_cselect_b32 s55, 0x7fff, s55
    s_cmp_lt_u32 s55, 0x7fff
    s_cselect_b32 s29, 12, 0x7fff
    s_add_u32 s50, s29, 1
    s_mov_b32 s51, 14
    s_mov_b32 s32, 0
    s_mov_b32 s33, 0
g1_ld_pW:
    s_add_u32 s40, s32, s27
    s_and_b32 s40, s40, 1
    s_andn2_b32 s41, s32, 1
    s_or_b32 s40, s40, s41
    s_add_u32 s40, s40, s26
    s_and_b32 s40, s40, 15
    s_mul_i32 s34, s40, 393216
    s_mul_i32 s35, s40, 128
    s_add_u32 s38, s33, s36
    s_add_u32 s39, s33, s37
    s_add_u32 m0, s38, 0
    s_nop 0
    buffer_load_dwordx4 v10, s[8:11], s34 offen lds
    s_add_u32 m0, s38, 1024
    s_nop 0
    buffer_load_dwordx4 v11, s[8:11], s34 offen lds
    s_add_u32 m0, s38, 8192
    s_nop 0
    buffer_load_dwordx4 v12, s[8:11], s34 offen lds
    s_add_u32 m0, s38, 9216
    s_nop 0
    buffer_load_dwordx4 v13, s[8:11], s34 offen lds
    s_add_u32 m0, s38, 16384
    s_nop 0
    buffer_load_dwordx4 v14, s[8:11], s34 offen lds
    s_add_u32 m0, s38, 17408
    s_nop 0
    buffer_load_dwordx4 v15, s[8:11], s34 offen lds
    s_add_u32 s33, s33, 43008
    s_add_u32 s32, s32, 1
    s_cmp_lt_u32 s32, 2
    s_cbranch_scc1 g1_ld_pW
    s_cmp_eq_u32 s96, 0
    s_cbranch_scc1 g1_dep_ok
    s_add_u32 s40, s25, 40
    s_lshl_b32 s40, s40, 8
    s_sub_u32 s42, s40, 256
    s_max_u32 s42, s42, 10240
    s_lshl_b32 s43, s96, 2
    s_add_u32 s43, s43, 1
    s_mov_b32 s41, 0x80000
    v_mov_b32 v24, 131072
    s_cmp_lg_u32 s28, 0
    s_cbranch_scc1 g1_dep_lds
    s_mov_b32 s41, 0x8000
    s_add_u32 s84, s4, 0x300000
    s_addc_u32 s85, s5, 0
    s_mov_b32 s86, 0x4000
    s_mov_b32 s87, 0x20000
    v_cmp_eq_u32 vcc, 1, v2
    v_mov_b32 v21, s40
    v_mov_b32 v23, s42
    v_cndmask_b32 v21, v21, v23, vcc
    v_mov_b32 v22, 16
    v_mov_b32 v23, 16
    v_cndmask_b32 v22, v22, v23, vcc
g1_dep:
    buffer_load_dword v23, v21, s[84:87], 0 offen sc1
    s_sub_u32 s41, s41, 1
    s_waitcnt vmcnt(0)
    v_cmp_lt_u32 vcc, v23, v22
    s_cmp_eq_u32 s41, 0
    s_cbranch_scc1 g1_dep_seen
    s_cbranch_vccz g1_dep_seen
    s_sleep 2
    s_branch g1_dep
g1_dep_seen:
    v_mov_b32 v23, s43
    ds_write_b32 v24, v23
    s_branch g1_dep_ok
g1_dep_lds:
    ds_read_b32 v23, v24
    s_sub_u32 s41, s41, 1
    s_waitcnt lgkmcnt(0)
    v_readfirstlane_b32 s40, v23
    s_cmp_eq_u32 s41, 0
    s_cbranch_scc1 g1_dep_ok
    s_cmp_eq_u32 s40, s43
    s_cbranch_scc1 g1_dep_ok
    s_sleep 1
    s_branch g1_dep_lds
g1_dep_ok:
    s_mov_b32 s32, 0
    s_mov_b32 s33, 0
g1_ld_pA:
    s_add_u32 s40, s32, s27
    s_and_b32 s40, s40, 1
    s_andn2_b32 s41, s32, 1
    s_or_b32 s40, s40, s41
    s_add_u32 s40, s40, s26
    s_and_b32 s40, s40, 15
    s_mul_i32 s34, s40, 393216
    s_mul_i32 s35, s40, 128
    s_add_u32 s38, s33, s36
    s_add_u32 s39, s33, s37
    s_add_u32 m0, s39, 0
    s_nop 0
    buffer_load_dwordx4 v16, s[12:15], s35 offen sc1 lds
    s_add_u32 m0, s39, 1024
    s_nop 0
    buffer_load_dwordx4 v17, s[12:15], s35 offen sc1 lds
    s_add_u32 m0, s39, 2048
    s_nop 0
    buffer_load_dwordx4 v18, s[12:15], s35 offen sc1 lds
    s_add_u32 m0, s39, 3072
    s_nop 0
    buffer_load_dwordx4 v19, s[12:15], s35 offen sc1 lds
    s_add_u32 m0, s33, s46
    s_mov_b32 exec_hi, 0
    buffer_load_dwordx4 v20, s[12:15], s35 offen sc1 lds
    s_mov_b32 exec_hi, -1
    s_add_u32 s33, s33, 43008
    s_add_u32 s32, s32, 1
    s_cmp_lt_u32 s32, 2
    s_cbranch_scc1 g1_ld_pA
    s_waitcnt vmcnt(5)
    s_branch g1_ld_bar
g1_ld_loop:
    s_sub_u32 s40, s32, s54
    s_sub_u32 s40, s40, 1
    s_cmp_lt_u32 s40, 2
    s_cbranch_scc1 g1_ld_w0
    s_sub_u32 s40, s32, s55
    s_sub_u32 s40, s40, 1
    s_cmp_lt_u32 s40, 2
    s_cbranch_scc1 g1_ld_w1
    s_sub_u32 s40, s32, s29
    s_sub_u32 s40, s40, 1
    s_cmp_lt_u32 s40, 2
    s_cbranch_scc1 g1_ld_w2
    s_sub_u32 s40, s32, s51
    s_sub_u32 s40, s40, 1
    s_cmp_lt_u32 s40, 2
    s_cbranch_scc1 g1_ld_w4
    s_waitcnt vmcnt(11)
g1_ld_bar:
    s_barrier
    s_add_u32 s40, s32, s27
    s_and_b32 s40, s40, 1
    s_andn2_b32 s41, s32, 1
    s_or_b32 s40, s40, s41
    s_add_u32 s40, s40, s26
    s_and_b32 s40, s40, 15
    s_mul_i32 s34, s40, 393216
    s_mul_i32 s35, s40, 128
    s_add_u32 s38, s33, s36
    s_add_u32 s39, s33, s37
    s_add_u32 m0, s39, 0
    s_nop 0
    buffer_load_dwordx4 v16, s[12:15], s35 offen sc1 lds
    s_add_u32 m0, s39, 1024
    s_nop 0
    buffer_load_dwordx4 v17, s[12:15], s35 offen sc1 lds
    s_add_u32 m0, s39, 2048
    s_nop 0
    buffer_load_dwordx4 v18, s[12:15], s35 offen sc1 lds
    s_add_u32 m0, s39, 3072
    s_nop 0
    buffer_load_dwordx4 v19, s[12:15], s35 offen sc1 lds
    s_add_u32 m0, s38, 0
    s_nop 0
    buffer_load_dwordx4 v10, s[8:11], s34 offen lds
    s_add_u32 m0, s38, 1024
    s_nop 0
    buffer_load_dwordx4 v11, s[8:11], s34 offen lds
    s_add_u32 m0, s38, 8192
    s_nop 0
    buffer_load_dwordx4 v12, s[8:11], s34 offen lds
    s_add_u32 m0, s38, 9216
    s_nop 0
    buffer_load_dwordx4 v13, s[8:11], s34 offen lds
    s_add_u32 m0, s38, 16384
    s_nop 0
    buffer_load_dwordx4 v14, s[8:11], s34 offen lds
    s_add_u32 m0, s38, 17408
    s_nop 0
    buffer_load_dwordx4 v15, s[8:11], s34 offen lds
    s_add_u32 m0, s33, s46
    s_mov_b32 exec_hi, 0
    buffer_load_dwordx4 v20, s[12:15], s35 offen sc1 lds
    s_mov_b32 exec_hi, -1
    s_cmp_eq_u32 s32, s54
    s_cbranch_scc1 g1_ld_h0
g1_ld_c0:
    s_cmp_eq_u32 s32, s55
    s_cbranch_scc1 g1_ld_h1
g1_ld_c1:
    s_cmp_eq_u32 s32, s29
    s_cbranch_scc1 g1_ld_h2
g1_ld_c2:
    s_cmp_eq_u32 s32, s50
    s_cbranch_scc1 g1_ld_h3
g1_ld_c3:
    s_cmp_eq_u32 s32, s51
    s_cbranch_scc1 g1_ld_h4
g1_ld_c4:
    s_add_u32 s33, s33, 43008
    s_add_u32 s32, s32, 1
    s_cmp_eq_u32 s33, 129024
    s_cselect_b32 s33, 0, s33
    s_cmp_lt_u32 s32, 16
    s_cbranch_scc1 g1_ld_loop
    s_waitcnt vmcnt(43)
    s_barrier
    s_waitcnt vmcnt(0)
    v_pk_add_f32 v[24:25], v[24:25], v[40:41]
    v_add_f32 v56, v56, v64
    v_pk_add_f32 v[26:27], v[26:27], v[42:43]
    v_add_f32 v57, v57, v65
    v_pk_add_f32 v[28:29], v[28:29], v[44:45]
    v_add_f32 v58, v58, v66
    v_pk_add_f32 v[30:31], v[30:31], v[46:47]
    v_add_f32 v59, v59, v67
    v_pk_add_f32 v[32:33], v[32:33], v[48:49]
    v_add_f32 v60, v60, v68
    v_pk_add_f32 v[34:35], v[34:35], v[50:51]
    v_add_f32 v61, v61, v69
    v_pk_add_f32 v[36:37], v[36:37], v[52:53]
    v_add_f32 v62, v62, v70
    v_pk_add_f32 v[38:39], v[38:39], v[54:55]
    v_add_f32 v63, v63, v71
    v_pk_add_f32 v[24:25], v[24:25], v[32:33]
    v_add_f32 v56, v56, v60
    v_pk_add_f32 v[26:27], v[26:27], v[34:35]
    v_add_f32 v57, v57, v61
    v_pk_add_f32 v[28:29], v[28:29], v[36:37]
    v_add_f32 v58, v58, v62
    v_pk_add_f32 v[30:31], v[30:31], v[38:39]
    v_add_f32 v59, v59, v63
    v_pk_add_f32 v[24:25], v[24:25], v[28:29]
    v_add_f32 v56, v56, v58
    v_pk_add_f32 v[26:27], v[26:27], v[30:31]
    v_add_f32 v57, v57, v59
    v_pk_add_f32 v[24:25], v[24:25], v[26:27]
    v_add_f32 v56, v56, v57
    v_mul_f32 v24, 0x3a800000, v24
    v_mul_f32 v25, 0x3a800000, v25
    v_fma_f32 v25, -v24, v24, v25
    v_max_f32 v25, 0, v25
    v_cvt_pk_bf16_f32 v24, v24, v24
    v_lshlrev_b32 v24, 16, v24
    v_cvt_pk_bf16_f32 v25, v25, v25
    v_lshlrev_b32 v25, 16, v25
    v_add_f32 v25, 0x3727c5ac, v25
    v_cvt_pk_bf16_f32 v25, v25, v25
    v_lshlrev_b32 v25, 16, v25
    v_sqrt_f32 v25, v25
    s_nop 0
    v_cvt_pk_bf16_f32 v25, v25, v25
    v_lshlrev_b32 v25, 16, v25
    v_rcp_f32 v26, v25
    v_lshlrev_b32 v3, 3, v21
    v_lshlrev_b32 v4, 2, v21
    v_mul_f32 v27, -v24, v26
    v_cmp_gt_u32 vcc, 144, v21
    s_and_saveexec_b64 s[40:41], vcc
    v_add_u32 v3, 129024, v3
    ds_write_b64 v3, v[26:27]
    s_mov_b64 exec, s[40:41]
    v_cmp_gt_u32 vcc, 192, v21
    s_and_saveexec_b64 s[40:41], vcc
    v_add_u32 v4, 130304, v4
    ds_write_b32 v4, v56
    s_mov_b64 exec, s[40:41]
    s_waitcnt lgkmcnt(0)
    s_barrier
    s_add_u32 s20, s4, 0x200000
    s_addc_u32 s21, s5, 0
    s_mov_b32 s22, 0x40000
    s_mov_b32 s23, 0x20000
    s_lshl_b32 s40, s24, 4
    s_add_u32 s40, s40, s25
    s_lshl_b32 s40, s40, 10
    s_lshl_b32 s41, s28, 8
    s_add_u32 s40, s40, s41
    v_lshlrev_b32 v3, 2, v2
    v_mov_b32 v4, -1
    buffer_store_dword v4, v3, s[20:23], s40 offen sc1
    s_cmp_eq_u32 s53, 0
    s_cbranch_scc1 g1_nopf
    s_mov_b32 s20, s18
    s_mov_b32 s21, s19
    s_mov_b32 s22, 0x200000
    s_mov_b32 s23, 0x20000
    s_lshl_b32 s40, s2, 13
    s_lshl_b32 s41, s28, 11
    s_add_u32 s40, s40, s41
    v_lshlrev_b32 v3, 4, v2
    buffer_load_dwordx4 v[120:123], v3, s[20:23], s40 offen
    buffer_load_dwordx4 v[120:123], v3, s[20:23], s40 offen offset:1024
g1_nopf:
    s_branch g1_ld_end
g1_ld_w0:
    s_waitcnt vmcnt(16)
    s_branch g1_ld_bar
g1_ld_h0:
    s_add_u32 s44, s33, 43008
    s_cmp_eq_u32 s44, 129024
    s_cselect_b32 s44, 0, s44
    s_mul_i32 s42, s28, 3
    s_add_u32 s42, s42, 0
    s_lshr_b32 s43, s42, 2
    s_lshl_b32 s43, s43, 13
    s_add_u32 s43, s43, s44
    s_and_b32 s42, s42, 3
    v_and_b32 v3, 1, v5
    v_lshlrev_b32 v3, 1, v3
    v_lshrrev_b32 v4, 1, v6
    v_or_b32 v3, v3, v4
    s_add_u32 s40, s42, 0
    v_xor_b32 v3, s40, v3
    v_lshlrev_b32 v3, 5, v3
    v_lshl_add_u32 v3, v7, 3, v3
    v_lshl_add_u32 v4, v5, 3, v6
    v_lshl_add_u32 v3, v4, 7, v3
    v_add_u32 v21, s43, v3
    ds_read_b64_tr_b16 v[24:25], v21 offset:0
    ds_read_b64_tr_b16 v[26:27], v21 offset:512
    ds_read_b64_tr_b16 v[28:29], v21 offset:4096
    ds_read_b64_tr_b16 v[30:31], v21 offset:4608
    s_mul_i32 s42, s28, 3
    s_add_u32 s42, s42, 1
    s_lshr_b32 s43, s42, 2
    s_lshl_b32 s43, s43, 13
    s_add_u32 s43, s43, s44
    s_and_b32 s42, s42, 3
    v_and_b32 v3, 1, v5
    v_lshlrev_b32 v3, 1, v3
    v_lshrrev_b32 v4, 1, v6
    v_or_b32 v3, v3, v4
    s_add_u32 s40, s42, 0
    v_xor_b32 v3, s40, v3
    v_lshlrev_b32 v3, 5, v3
    v_lshl_add_u32 v3, v7, 3, v3
    v_lshl_add_u32 v4, v5, 3, v6
    v_lshl_add_u32 v3, v4, 7, v3
    v_add_u32 v21, s43, v3
    ds_read_b64_tr_b16 v[32:33], v21 offset:0
    ds_read_b64_tr_b16 v[34:35], v21 offset:512
    ds_read_b64_tr_b16 v[36:37], v21 offset:4096
    ds_read_b64_tr_b16 v[38:39], v21 offset:4608
    s_mul_i32 s42, s28, 3
    s_add_u32 s42, s42, 2
    s_lshr_b32 s43, s42, 2
    s_lshl_b32 s43, s43, 13
    s_add_u32 s43, s43, s44
    s_and_b32 s42, s42, 3
    v_and_b32 v3, 1, v5
    v_lshlrev_b32 v3, 1, v3
    v_lshrrev_b32 v4, 1, v6
    v_or_b32 v3, v3, v4
    s_add_u32 s40, s42, 0
    v_xor_b32 v3, s40, v3
    v_lshlrev_b32 v3, 5, v3
    v_lshl_add_u32 v3, v7, 3, v3
    v_lshl_add_u32 v4, v5, 3, v6
    v_lshl_add_u32 v3, v4, 7, v3
    v_add_u32 v21, s43, v3
    ds_read_b64_tr_b16 v[40:41], v21 offset:0
    ds_read_b64_tr_b16 v[42:43], v21 offset:512
    ds_read_b64_tr_b16 v[44:45], v21 offset:4096
    ds_read_b64_tr_b16 v[46:47], v21 offset:4608
    s_lshr_b32 s42, s44, 7
    s_lshl_b32 s43, s28, 5
    s_add_u32 s42, s42, s43
    s_add_u32 s42, s42, 16
    v_lshrrev_b32 v3, 1, v8
    v_xor_b32 v3, v3, v5
    v_lshlrev_b32 v3, 4, v3
    v_lshl_add_u32 v3, v8, 7, v3
    s_lshl_b32 s40, s42, 7
    s_add_u32 s40, s40, 24576
    v_add_u32 v22, s40, v3
    v_xor_b32 v23, 64, v22
    ds_read_b128 v[48:51], v22 offset:0
    ds_read_b128 v[52:55], v23 offset:0
    ds_read_b128 v[56:59], v22 offset:2048
    ds_read_b128 v[60:63], v23 offset:2048
    v_mov_b32 v64, 0x3f803f80
    v_mov_b32 v65, 0x3f803f80
    v_mov_b32 v66, 0x3f803f80
    v_mov_b32 v67, 0x3f803f80
    s_mul_i32 s42, s52, 12288
    s_lshl_b32 s43, s24, 8
    s_add_u32 s42, s42, s43
    v_lshl_add_u32 v21, v5, 4, s42
    s_lshl_b32 s42, s52, 14
    s_lshl_b32 s43, s25, 10
    s_add_u32 s42, s42, s43
    s_lshl_b32 s43, s28, 8
    s_add_u32 s42, s42, s43
    v_lshl_add_u32 v22, v8, 3, s42
    s_waitcnt lgkmcnt(0)
    v_mfma_f32_16x16x32_bf16 v[68:71], v[24:27], v[64:67], 0
    v_mfma_f32_16x16x32_bf16 v[72:75], v[32:35], v[64:67], 0
    v_mfma_f32_16x16x32_bf16 v[76:79], v[40:43], v[64:67], 0
    v_mfma_f32_16x16x32_bf16 v[80:83], v[64:67], v[48:51], 0
    v_mfma_f32_16x16x32_bf16 v[84:87], v[48:51], v[48:51], 0
    v_mfma_f32_16x16x32_bf16 v[88:91], v[64:67], v[56:59], 0
    v_mfma_f32_16x16x32_bf16 v[92:95], v[56:59], v[56:59], 0
    v_mfma_f32_16x16x32_bf16 v[68:71], v[28:31], v[64:67], v[68:71]
    v_mfma_f32_16x16x32_bf16 v[72:75], v[36:39], v[64:67], v[72:75]
    v_mfma_f32_16x16x32_bf16 v[76:79], v[44:47], v[64:67], v[76:79]
    v_mfma_f32_16x16x32_bf16 v[80:83], v[64:67], v[52:55], v[80:83]
    v_mfma_f32_16x16x32_bf16 v[84:87], v[52:55], v[52:55], v[84:87]
    v_mfma_f32_16x16x32_bf16 v[88:91], v[64:67], v[60:63], v[88:91]
    v_mfma_f32_16x16x32_bf16 v[92:95], v[60:63], v[60:63], v[92:95]
    v_cmp_eq_u32 s[40:41], 1, v7
    v_cmp_eq_u32 s[42:43], 2, v7
    v_cmp_eq_u32 vcc, 3, v7
    s_nop 7
    v_cndmask_b32 v81, v84, v85, s[40:41]
    v_cndmask_b32 v81, v81, v86, s[42:43]
    v_cndmask_b32 v81, v81, v87, vcc
    v_cndmask_b32 v89, v92, v93, s[40:41]
    v_cndmask_b32 v89, v89, v94, s[42:43]
    v_cndmask_b32 v89, v89, v95, vcc
    s_mov_b32 exec_lo, 0x00f0000f
    s_mov_b32 exec_hi, 0xf0000f00
    buffer_store_dwordx2 v[80:81], v22, s[20:23], 0 offen offset:0 sc1
    buffer_store_dwordx2 v[88:89], v22, s[20:23], 0 offen offset:128 sc1
    s_mov_b32 exec_lo, 0x00010001
    s_mov_b32 exec_hi, 0x00010001
    s_mul_i32 s42, s28, 3
    s_add_u32 s42, s42, 0
    s_lshr_b32 s43, s42, 2
    s_lshl_b32 s43, s43, 12
    s_and_b32 s42, s42, 3
    s_lshl_b32 s42, s42, 6
    s_add_u32 s42, s42, s43
    buffer_store_dwordx4 v[68:71], v21, s[56:59], s42 offen sc1
    s_mul_i32 s42, s28, 3
    s_add_u32 s42, s42, 1
    s_lshr_b32 s43, s42, 2
    s_lshl_b32 s43, s43, 12
    s_and_b32 s42, s42, 3
    s_lshl_b32 s42, s42, 6
    s_add_u32 s42, s42, s43
    buffer_store_dwordx4 v[72:75], v21, s[56:59], s42 offen sc1
    s_mul_i32 s42, s28, 3
    s_add_u32 s42, s42, 2
    s_lshr_b32 s43, s42, 2
    s_lshl_b32 s43, s43, 12
    s_and_b32 s42, s42, 3
    s_lshl_b32 s42, s42, 6
    s_add_u32 s42, s42, s43
    buffer_store_dwordx4 v[76:79], v21, s[56:59], s42 offen sc1
    s_mov_b64 exec, -1
    s_or_b32 s40, s24, s25
    s_or_b32 s40, s40, s28
    s_cmp_lg_u32 s40, 0
    s_cbranch_scc1 g1_nocr
    v_lshlrev_b32 v21, 8, v2
    v_mov_b32 v22, 0
    s_add_u32 s84, s4, 0x300000
    s_addc_u32 s85, s5, 0
    s_mov_b32 s86, 0x4000
    s_mov_b32 s87, 0x20000
    buffer_store_dword v22, v21, s[84:87], 0 offen sc1
    s_add_u32 s84, s4, 0x2b00000
    s_addc_u32 s85, s5, 0
    s_mov_b32 s86, 0x4000
    s_mov_b32 s87, 0x20000
    buffer_store_dword v22, v21, s[84:87], 0 offen sc1
g1_nocr:
    s_branch g1_ld_c0
g1_ld_w1:
    s_waitcnt vmcnt(12)
    s_branch g1_ld_bar
g1_ld_h1:
    v_mov_b32 v21, 0
    v_mov_b32 v22, 1
    s_mov_b64 exec, 1
    buffer_atomic_add v22, v21, s[60:63], 0 offen sc1
    s_mov_b64 exec, -1
    s_branch g1_ld_c1
g1_ld_w2:
    s_waitcnt vmcnt(12)
    s_branch g1_ld_bar
g1_ld_h2:
    v_mov_b32 v21, 0
    buffer_load_dword v23, v21, s[60:63], 0 offen sc1
    s_branch g1_ld_c2
g1_ld_h3:
    s_mov_b32 s41, 0x20000
    v_mov_b32 v21, 0
    s_waitcnt vmcnt(11)
g1_poll:
    v_readfirstlane_b32 s40, v23
    s_sub_u32 s41, s41, 1
    s_cmp_eq_u32 s41, 0
    s_cbranch_scc1 g1_polled
    s_cmp_ge_u32 s40, 256
    s_cbranch_scc1 g1_polled
    s_sleep 8
    buffer_load_dword v23, v21, s[60:63], 0 offen sc1
    s_waitcnt vmcnt(0)
    s_branch g1_poll
g1_polled:
    s_branch g1_ld_c3
g1_ld_w4:
    s_waitcnt vmcnt(43)
    s_branch g1_ld_bar
g1_ld_h4:
    s_lshl_b32 s40, s28, 6
    v_add_u32 v21, s40, v2
    s_lshl_b32 s41, s25, 7
    s_sub_u32 s41, s41, 16
    v_add_u32 v3, s41, v21
    v_max_i32 v3, 0, v3
    v_min_u32 v3, 2047, v3
    v_lshlrev_b32 v3, 3, v3
    s_min_u32 s40, s28, 2
    s_lshl_b32 s40, s40, 12
    s_lshl_b32 s41, s24, 8
    s_add_u32 s40, s40, s41
    v_lshl_add_u32 v4, v2, 2, s40
    s_mov_b32 s40, 0
    buffer_load_dwordx2 v[24:25], v3, s[20:23], s40 offen sc1
    s_mov_b32 s41, 0
    buffer_load_dword v56, v4, s[56:59], s41 offen sc1
    s_mov_b32 s40, 16384
    buffer_load_dwordx2 v[26:27], v3, s[20:23], s40 offen sc1
    s_mov_b32 s41, 12288
    buffer_load_dword v57, v4, s[56:59], s41 offen sc1
    s_mov_b32 s40, 32768
    buffer_load_dwordx2 v[28:29], v3, s[20:23], s40 offen sc1
    s_mov_b32 s41, 24576
    buffer_load_dword v58, v4, s[56:59], s41 offen sc1
    s_mov_b32 s40, 49152
    buffer_load_dwordx2 v[30:31], v3, s[20:23], s40 offen sc1
    s_mov_b32 s41, 36864
    buffer_load_dword v59, v4, s[56:59], s41 offen sc1
    s_mov_b32 s40, 65536
    buffer_load_dwordx2 v[32:33], v3, s[20:23], s40 offen sc1
    s_mov_b32 s41, 49152
    buffer_load_dword v60, v4, s[56:59], s41 offen sc1
    s_mov_b32 s40, 81920
    buffer_load_dwordx2 v[34:35], v3, s[20:23], s40 offen sc1
    s_mov_b32 s41, 61440
    buffer_load_dword v61, v4, s[56:59], s41 offen sc1
    s_mov_b32 s40, 98304
    buffer_load_dwordx2 v[36:37], v3, s[20:23], s40 offen sc1
    s_mov_b32 s41, 73728
    buffer_load_dword v62, v4, s[56:59], s41 offen sc1
    s_mov_b32 s40, 114688
    buffer_load_dwordx2 v[38:39], v3, s[20:23], s40 offen sc1
    s_mov_b32 s41, 86016
    buffer_load_dword v63, v4, s[56:59], s41 offen sc1
    s_mov_b32 s40, 131072
    buffer_load_dwordx2 v[40:41], v3, s[20:23], s40 offen sc1
    s_mov_b32 s41, 98304
    buffer_load_dword v64, v4, s[56:59], s41 offen sc1
    s_mov_b32 s40, 147456
    buffer_load_dwordx2 v[42:43], v3, s[20:23], s40 offen sc1
    s_mov_b32 s41, 110592
    buffer_load_dword v65, v4, s[56:59], s41 offen sc1
    s_mov_b32 s40, 163840
    buffer_load_dwordx2 v[44:45], v3, s[20:23], s40 offen sc1
    s_mov_b32 s41, 122880
    buffer_load_dword v66, v4, s[56:59], s41 offen sc1
    s_mov_b32 s40, 180224
    buffer_load_dwordx2 v[46:47], v3, s[20:23], s40 offen sc1
    s_mov_b32 s41, 135168
    buffer_load_dword v67, v4, s[56:59], s41 offen sc1
    s_mov_b32 s40, 196608
    buffer_load_dwordx2 v[48:49], v3, s[20:23], s40 offen sc1
    s_mov_b32 s41, 147456
    buffer_load_dword v68, v4, s[56:59], s41 offen sc1
    s_mov_b32 s40, 212992
    buffer_load_dwordx2 v[50:51], v3, s[20:23], s40 offen sc1
    s_mov_b32 s41, 159744
    buffer_load_dword v69, v4, s[56:59], s41 offen sc1
    s_mov_b32 s40, 229376
    buffer_load_dwordx2 v[52:53], v3, s[20:23], s40 offen sc1
    s_mov_b32 s41, 172032
    buffer_load_dword v70, v4, s[56:59], s41 offen sc1
    s_mov_b32 s40, 245760
    buffer_load_dwordx2 v[54:55], v3, s[20:23], s40 offen sc1
    s_mov_b32 s41, 184320
    buffer_load_dword v71, v4, s[56:59], s41 offen sc1
    s_branch g1_ld_c4
g1_ld_end:
    s_add_u32 s28, s28, 4
    s_add_u32 s16, s4, 0x400000
    s_addc_u32 s17, s5, 0
    s_mov_b32 s18, 0x400000
    s_mov_b32 s19, 0x20000
    s_and_b32 s44, s28, 1
    s_lshr_b32 s45, s28, 1
    s_lshl_b32 s40, s44, 2
    v_add_u32 v3, s40, v5
    v_and_b32 v4, 7, v8
    v_xor_b32 v3, v3, v4
    v_lshlrev_b32 v3, 4, v3
    v_lshl_add_u32 v3, v8, 8, v3
    s_mul_i32 s41, s45, 4096
    s_add_u32 s41, s41, 43008
    v_add_u32 v226, s41, v3
    v_lshl_add_u32 v3, v5, 2, v6
    v_and_b32 v4, 7, v3
    v_add_u32 v228, s40, v7
    v_xor_b32 v4, v4, v228
    v_lshlrev_b32 v4, 4, v4
    v_lshl_add_u32 v3, v3, 8, v4
    s_add_u32 s41, s41, 36864
    v_add_u32 v227, s41, v3
    v_and_b32 v3, 7, v8
    v_add_u32 v4, 1, v3
    s_or_b32 s40, s25, s45
    s_cmp_eq_u32 s40, 0
    s_cselect_b32 s40, 8, 0
    v_cmp_gt_u32 vcc, 8, v8
    v_mov_b32 v21, s40
    s_mov_b64 s[56:57], vcc
    v_cndmask_b32 v21, 0, v21, vcc
    v_max_u32 v4, v4, v21
    v_add_u32 v3, 8, v3
    v_sub_u32 v3, v3, v4
    v_lshlrev_b32 v21, 2, v5
    v_sub_u32 v21, v21, v4
    v_mov_b32 v22, 0xf149f2ca
    v_add_u32 v23, 0, v21
    v_cmp_ge_u32 vcc, v3, v23
    s_nop 1
    v_cndmask_b32 v228, v22, 0, vcc
    v_add_u32 v23, 1, v21
    v_cmp_ge_u32 vcc, v3, v23
    s_nop 1
    v_cndmask_b32 v229, v22, 0, vcc
    v_add_u32 v23, 2, v21
    v_cmp_ge_u32 vcc, v3, v23
    s_nop 1
    v_cndmask_b32 v230, v22, 0, vcc
    v_add_u32 v23, 3, v21
    v_cmp_ge_u32 vcc, v3, v23
    s_nop 1
    v_cndmask_b32 v231, v22, 0, vcc
    s_lshl_b32 s40, s25, 7
    s_lshl_b32 s41, s45, 5
    s_add_u32 s40, s40, s41
    s_lshl_b32 s40, s40, 11
    s_lshl_b32 s41, s24, 7
    s_add_u32 s40, s40, s41
    s_lshl_b32 s41, s44, 6
    s_add_u32 s40, s40, s41
    v_lshlrev_b32 v225, 12, v8
    v_lshl_add_u32 v225, v5, 4, v225
    v_add_u32 v225, s40, v225
    s_mov_b32 s58, 0x3e3504f3
    s_mov_b32 s59, 0x3fb8aa3b
    s_branch g1_attn
g1_compute:
    s_and_b32 s44, s28, 1
    s_lshr_b32 s45, s28, 1
    s_lshl_b32 s42, s44, 1
    s_mov_b32 s43, 0
    v_and_b32 v3, 1, v5
    v_lshlrev_b32 v3, 1, v3
    v_lshrrev_b32 v4, 1, v6
    v_or_b32 v3, v3, v4
    s_add_u32 s40, s42, 0
    v_xor_b32 v3, s40, v3
    v_lshlrev_b32 v3, 5, v3
    v_lshl_add_u32 v3, v7, 3, v3
    v_lshl_add_u32 v4, v5, 3, v6
    v_lshl_add_u32 v3, v4, 7, v3
    v_add_u32 v10, s43, v3
    v_and_b32 v3, 1, v5
    v_lshlrev_b32 v3, 1, v3
    v_lshrrev_b32 v4, 1, v6
    v_or_b32 v3, v3, v4
    s_add_u32 s40, s42, 1
    v_xor_b32 v3, s40, v3
    v_lshlrev_b32 v3, 5, v3
    v_lshl_add_u32 v3, v7, 3, v3
    v_lshl_add_u32 v4, v5, 3, v6
    v_lshl_add_u32 v3, v4, 7, v3
    v_add_u32 v11, s43, v3
    s_xor_b32 s43, s45, 1
    s_add_u32 s43, s43, 1
    s_mul_i32 s43, s43, 8192
    v_and_b32 v3, 1, v5
    v_lshlrev_b32 v3, 1, v3
    v_lshrrev_b32 v4, 1, v6
    v_or_b32 v3, v3, v4
    s_add_u32 s40, s42, 0
    v_xor_b32 v3, s40, v3
    v_lshlrev_b32 v3, 5, v3
    v_lshl_add_u32 v3, v7, 3, v3
    v_lshl_add_u32 v4, v5, 3, v6
    v_lshl_add_u32 v3, v4, 7, v3
    v_add_u32 v12, s43, v3
    v_and_b32 v3, 1, v5
    v_lshlrev_b32 v3, 1, v3
    v_lshrrev_b32 v4, 1, v6
    v_or_b32 v3, v3, v4
    s_add_u32 s40, s42, 1
    v_xor_b32 v3, s40, v3
    v_lshlrev_b32 v3, 5, v3
    v_lshl_add_u32 v3, v7, 3, v3
    v_lshl_add_u32 v4, v5, 3, v6
    v_lshl_add_u32 v3, v4, 7, v3
    v_add_u32 v13, s43, v3
    s_xor_b32 s43, s45, 0
    s_add_u32 s43, s43, 1
    s_mul_i32 s43, s43, 8192
    v_and_b32 v3, 1, v5
    v_lshlrev_b32 v3, 1, v3
    v_lshrrev_b32 v4, 1, v6
    v_or_b32 v3, v3, v4
    s_add_u32 s40, s42, 0
    v_xor_b32 v3, s40, v3
    v_lshlrev_b32 v3, 5, v3
    v_lshl_add_u32 v3, v7, 3, v3
    v_lshl_add_u32 v4, v5, 3, v6
    v_lshl_add_u32 v3, v4, 7, v3
    v_add_u32 v14, s43, v3
    v_and_b32 v3, 1, v5
    v_lshlrev_b32 v3, 1, v3
    v_lshrrev_b32 v4, 1, v6
    v_or_b32 v3, v3, v4
    s_add_u32 s40, s42, 1
    v_xor_b32 v3, s40, v3
    v_lshlrev_b32 v3, 5, v3
    v_lshl_add_u32 v3, v7, 3, v3
    v_lshl_add_u32 v4, v5, 3, v6
    v_lshl_add_u32 v3, v4, 7, v3
    v_add_u32 v15, s43, v3
    s_mul_i32 s42, s45, 64
    s_add_u32 s42, s42, 16
    v_lshrrev_b32 v3, 1, v8
    v_xor_b32 v3, v3, v5
    v_lshlrev_b32 v3, 4, v3
    v_lshl_add_u32 v3, v8, 7, v3
    s_lshl_b32 s40, s42, 7
    s_add_u32 s40, s40, 24576
    v_add_u32 v16, s40, v3
    v_xor_b32 v17, 64, v16
    v_lshrrev_b32 v3, 1, v8
    v_xor_b32 v3, v3, v5
    v_lshlrev_b32 v3, 4, v3
    v_lshl_add_u32 v3, v8, 7, v3
    v_add_u32 v18, 24576, v3
    v_xor_b32 v19, 64, v18
    v_mov_b32 v24, 0
    v_mov_b32 v25, 0
    v_mov_b32 v26, 0
    v_mov_b32 v27, 0
    v_mov_b32 v28, 0
    v_mov_b32 v29, 0
    v_mov_b32 v30, 0
    v_mov_b32 v31, 0
    v_mov_b32 v32, 0
    v_mov_b32 v33, 0
    v_mov_b32 v34, 0
    v_mov_b32 v35, 0
    v_mov_b32 v36, 0
    v_mov_b32 v37, 0
    v_mov_b32 v38, 0
    v_mov_b32 v39, 0
    v_mov_b32 v40, 0
    v_mov_b32 v41, 0
    v_mov_b32 v42, 0
    v_mov_b32 v43, 0
    v_mov_b32 v44, 0
    v_mov_b32 v45, 0
    v_mov_b32 v46, 0
    v_mov_b32 v47, 0
    v_mov_b32 v48, 0
    v_mov_b32 v49, 0
    v_mov_b32 v50, 0
    v_mov_b32 v51, 0
    v_mov_b32 v52, 0
    v_mov_b32 v53, 0
    v_mov_b32 v54, 0
    v_mov_b32 v55, 0
    v_mov_b32 v56, 0
    v_mov_b32 v57, 0
    v_mov_b32 v58, 0
    v_mov_b32 v59, 0
    v_mov_b32 v60, 0
    v_mov_b32 v61, 0
    v_mov_b32 v62, 0
    v_mov_b32 v63, 0
    v_mov_b32 v64, 0
    v_mov_b32 v65, 0
    v_mov_b32 v66, 0
    v_mov_b32 v67, 0
    v_mov_b32 v68, 0
    v_mov_b32 v69, 0
    v_mov_b32 v70, 0
    v_mov_b32 v71, 0
    v_mov_b32 v72, 0
    v_mov_b32 v73, 0
    v_mov_b32 v74, 0
    v_mov_b32 v75, 0
    v_mov_b32 v76, 0
    v_mov_b32 v77, 0
    v_mov_b32 v78, 0
    v_mov_b32 v79, 0
    v_mov_b32 v80, 0
    v_mov_b32 v81, 0
    v_mov_b32 v82, 0
    v_mov_b32 v83, 0
    v_mov_b32 v84, 0
    v_mov_b32 v85, 0
    v_mov_b32 v86, 0
    v_mov_b32 v87, 0
    v_mov_b32 v88, 0
    v_mov_b32 v89, 0
    v_mov_b32 v90, 0
    v_mov_b32 v91, 0
    v_mov_b32 v92, 0
    v_mov_b32 v93, 0
    v_mov_b32 v94, 0
    v_mov_b32 v95, 0
    v_mov_b32 v96, 0
    v_mov_b32 v97, 0
    v_mov_b32 v98, 0
    v_mov_b32 v99, 0
    v_mov_b32 v100, 0
    v_mov_b32 v101, 0
    v_mov_b32 v102, 0
    v_mov_b32 v103, 0
    v_mov_b32 v104, 0
    v_mov_b32 v105, 0
    v_mov_b32 v106, 0
    v_mov_b32 v107, 0
    v_mov_b32 v108, 0
    v_mov_b32 v109, 0
    v_mov_b32 v110, 0
    v_mov_b32 v111, 0
    v_mov_b32 v112, 0
    v_mov_b32 v113, 0
    v_mov_b32 v114, 0
    v_mov_b32 v115, 0
    v_mov_b32 v116, 0
    v_mov_b32 v117, 0
    v_mov_b32 v118, 0
    v_mov_b32 v119, 0
    v_mov_b32 v120, 0
    v_mov_b32 v121, 0
    v_mov_b32 v122, 0
    v_mov_b32 v123, 0
    v_mov_b32 v124, 0
    v_mov_b32 v125, 0
    v_mov_b32 v126, 0
    v_mov_b32 v127, 0
    v_mov_b32 v172, 0
    v_mov_b32 v173, 0
    v_mov_b32 v174, 0
    v_mov_b32 v175, 0
    v_mov_b32 v176, 0
    v_mov_b32 v177, 0
    v_mov_b32 v178, 0
    v_mov_b32 v179, 0
    v_mov_b32 v180, 0
    v_mov_b32 v181, 0
    v_mov_b32 v182, 0
    v_mov_b32 v183, 0
    v_mov_b32 v184, 0
    v_mov_b32 v185, 0
    v_mov_b32 v186, 0
    v_mov_b32 v187, 0
    v_mov_b32 v188, 0
    v_mov_b32 v189, 0
    v_mov_b32 v190, 0
    v_mov_b32 v191, 0
    v_mov_b32 v192, 0
    v_mov_b32 v193, 0
    v_mov_b32 v194, 0
    v_mov_b32 v195, 0
    v_mov_b32 v196, 0
    v_mov_b32 v197, 0
    v_mov_b32 v198, 0
    v_mov_b32 v199, 0
    v_mov_b32 v200, 0
    v_mov_b32 v201, 0
    v_mov_b32 v202, 0
    v_mov_b32 v203, 0
    v_mov_b32 v204, 0
    v_mov_b32 v205, 0
    v_mov_b32 v206, 0
    v_mov_b32 v207, 0
    v_mov_b32 v208, 0
    v_mov_b32 v209, 0
    v_mov_b32 v210, 0
    v_mov_b32 v211, 0
    v_mov_b32 v212, 0
    v_mov_b32 v213, 0
    v_mov_b32 v214, 0
    v_mov_b32 v215, 0
    s_mov_b32 s48, 16
    s_mov_b32 s50, 0
    s_mov_b32 s51, 43008
    s_mov_b32 s29, 0xfffeb000
    s_waitcnt lgkmcnt(0)
    s_add_u32 s4, s4, s97
    s_addc_u32 s5, s5, 0
    v_lshlrev_b32 v3, 3, v8
    v_add_u32 v217, 129024, v3
    s_mul_i32 s40, s45, 512
    s_add_u32 s40, s40, 129152
    v_add_u32 v216, s40, v3
    s_lshl_b32 s40, s44, 7
    s_add_u32 s40, s40, 130304
    v_lshl_add_u32 v3, v5, 4, s40
    s_mov_b32 s43, 0
    v_add_u32 v218, s43, v3
    s_xor_b32 s43, s45, 1
    s_add_u32 s43, s43, 1
    s_mul_i32 s43, s43, 256
    v_add_u32 v219, s43, v3
    s_xor_b32 s43, s45, 0
    s_add_u32 s43, s43, 1
    s_mul_i32 s43, s43, 256
    v_add_u32 v220, s43, v3
    v_and_b32 v3, 1, v5
    v_lshlrev_b32 v3, 1, v3
    v_lshrrev_b32 v4, 1, v5
    v_add_u32 v3, v3, v4
    s_lshl_b32 s40, s44, 2
    v_add_u32 v3, s40, v3
    v_lshrrev_b32 v4, 1, v8
    v_xor_b32 v3, v3, v4
    v_lshlrev_b32 v3, 4, v3
    v_lshl_add_u32 v3, v8, 7, v3
    s_mul_i32 s42, s45, 8192
    s_add_u32 s42, s42, 45056
    s_mov_b32 s43, 0
    s_add_u32 s40, s42, s43
    v_add_u32 v221, s40, v3
    s_xor_b32 s43, s45, 1
    s_add_u32 s43, s43, 1
    s_mul_i32 s43, s43, 18432
    s_add_u32 s40, s42, s43
    v_add_u32 v222, s40, v3
    s_xor_b32 s43, s45, 0
    s_add_u32 s43, s43, 1
    s_mul_i32 s43, s43, 18432
    s_add_u32 s40, s42, s43
    v_add_u32 v223, s40, v3
    s_add_u32 s40, s43, 43008
    v_add_u32 v224, s40, v3
    s_add_u32 s16, s4, 0x400000
    s_addc_u32 s17, s5, 0
    s_mov_b32 s18, 0x400000
    s_mov_b32 s19, 0x20000
    s_and_b32 s44, s28, 1
    s_lshr_b32 s45, s28, 1
    s_lshl_b32 s40, s44, 2
    v_add_u32 v3, s40, v5
    v_and_b32 v4, 7, v8
    v_xor_b32 v3, v3, v4
    v_lshlrev_b32 v3, 4, v3
    v_lshl_add_u32 v3, v8, 8, v3
    s_mul_i32 s41, s45, 4096
    s_add_u32 s41, s41, 43008
    v_add_u32 v226, s41, v3
    v_lshl_add_u32 v3, v5, 2, v6
    v_and_b32 v4, 7, v3
    v_add_u32 v228, s40, v7
    v_xor_b32 v4, v4, v228
    v_lshlrev_b32 v4, 4, v4
    v_lshl_add_u32 v3, v3, 8, v4
    s_add_u32 s41, s41, 36864
    v_add_u32 v227, s41, v3
    v_and_b32 v3, 7, v8
    v_add_u32 v4, 1, v3
    s_or_b32 s40, s25, s45
    s_cmp_eq_u32 s40, 0
    s_cselect_b32 s40, 8, 0
    v_cmp_gt_u32 vcc, 8, v8
    v_mov_b32 v21, s40
    s_mov_b64 s[56:57], vcc
    v_cndmask_b32 v21, 0, v21, vcc
    v_max_u32 v4, v4, v21
    v_add_u32 v3, 8, v3
    v_sub_u32 v3, v3, v4
    v_lshlrev_b32 v21, 2, v5
    v_sub_u32 v21, v21, v4
    v_mov_b32 v22, 0xf149f2ca
    v_add_u32 v23, 0, v21
    v_cmp_ge_u32 vcc, v3, v23
    s_nop 1
    v_cndmask_b32 v228, v22, 0, vcc
    v_add_u32 v23, 1, v21
    v_cmp_ge_u32 vcc, v3, v23
    s_nop 1
    v_cndmask_b32 v229, v22, 0, vcc
    v_add_u32 v23, 2, v21
    v_cmp_ge_u32 vcc, v3, v23
    s_nop 1
    v_cndmask_b32 v230, v22, 0, vcc
    v_add_u32 v23, 3, v21
    v_cmp_ge_u32 vcc, v3, v23
    s_nop 1
    v_cndmask_b32 v231, v22, 0, vcc
    s_lshl_b32 s40, s25, 7
    s_lshl_b32 s41, s45, 5
    s_add_u32 s40, s40, s41
    s_lshl_b32 s40, s40, 11
    s_lshl_b32 s41, s24, 7
    s_add_u32 s40, s40, s41
    s_lshl_b32 s41, s44, 6
    s_add_u32 s40, s40, s41
    v_lshlrev_b32 v225, 12, v8
    v_lshl_add_u32 v225, v5, 4, v225
    v_add_u32 v225, s40, v225
    s_mov_b32 s58, 0x3e3504f3
    s_mov_b32 s59, 0x3fb8aa3b
.p2align 3
g1_cloop:
    s_barrier
g1_cloop2:
    v_mfma_f32_16x16x32_bf16 v[24:27], v[172:175], v[196:199], v[24:27]
    ds_read_b64_tr_b16 v[128:129], v10 offset:0
    ds_read_b64_tr_b16 v[130:131], v10 offset:512
    v_mfma_f32_16x16x32_bf16 v[28:31], v[172:175], v[200:203], v[28:31]
    ds_read_b128 v[152:155], v16 offset:0
    v_mfma_f32_16x16x32_bf16 v[32:35], v[172:175], v[204:207], v[32:35]
    ds_read_b128 v[156:159], v16 offset:2048
    v_mfma_f32_16x16x32_bf16 v[36:39], v[172:175], v[208:211], v[36:39]
    ds_read_b128 v[160:163], v16 offset:4096
    v_mfma_f32_16x16x32_bf16 v[40:43], v[176:179], v[196:199], v[40:43]
    ds_read_b128 v[164:167], v16 offset:6144
    v_mfma_f32_16x16x32_bf16 v[44:47], v[176:179], v[200:203], v[44:47]
    ds_read_b64_tr_b16 v[132:133], v11 offset:0
    ds_read_b64_tr_b16 v[134:135], v11 offset:512
    v_mfma_f32_16x16x32_bf16 v[48:51], v[176:179], v[204:207], v[48:51]
    ds_read_b64_tr_b16 v[136:137], v12 offset:0
    ds_read_b64_tr_b16 v[138:139], v12 offset:512
    v_mfma_f32_16x16x32_bf16 v[52:55], v[176:179], v[208:211], v[52:55]
    ds_read_b64_tr_b16 v[140:141], v13 offset:0
    ds_read_b64_tr_b16 v[142:143], v13 offset:512
    v_mfma_f32_16x16x32_bf16 v[56:59], v[180:183], v[196:199], v[56:59]
    ds_read_b64_tr_b16 v[144:145], v14 offset:0
    ds_read_b64_tr_b16 v[146:147], v14 offset:512
    v_mfma_f32_16x16x32_bf16 v[60:63], v[180:183], v[200:203], v[60:63]
    ds_read_b64_tr_b16 v[148:149], v15 offset:0
    ds_read_b64_tr_b16 v[150:151], v15 offset:512
    v_mfma_f32_16x16x32_bf16 v[64:67], v[180:183], v[204:207], v[64:67]
    ds_read_b128 v[168:171], v18 offset:0
    v_mfma_f32_16x16x32_bf16 v[68:71], v[180:183], v[208:211], v[68:71]
    v_mfma_f32_16x16x32_bf16 v[72:75], v[184:187], v[196:199], v[72:75]
    v_mfma_f32_16x16x32_bf16 v[76:79], v[184:187], v[200:203], v[76:79]
    v_mfma_f32_16x16x32_bf16 v[80:83], v[184:187], v[204:207], v[80:83]
    v_mfma_f32_16x16x32_bf16 v[84:87], v[184:187], v[208:211], v[84:87]
    v_mfma_f32_16x16x32_bf16 v[88:91], v[188:191], v[196:199], v[88:91]
    v_mfma_f32_16x16x32_bf16 v[92:95], v[188:191], v[200:203], v[92:95]
    v_mfma_f32_16x16x32_bf16 v[96:99], v[188:191], v[204:207], v[96:99]
    v_mfma_f32_16x16x32_bf16 v[100:103], v[188:191], v[208:211], v[100:103]
    v_mfma_f32_16x16x32_bf16 v[104:107], v[192:195], v[196:199], v[104:107]
    v_mfma_f32_16x16x32_bf16 v[108:111], v[192:195], v[200:203], v[108:111]
    v_mfma_f32_16x16x32_bf16 v[112:115], v[192:195], v[204:207], v[112:115]
    v_mfma_f32_16x16x32_bf16 v[116:119], v[192:195], v[208:211], v[116:119]
    v_mfma_f32_16x16x32_bf16 v[120:123], v[188:191], v[212:215], v[120:123]
    v_mfma_f32_16x16x32_bf16 v[124:127], v[192:195], v[212:215], v[124:127]
    s_waitcnt lgkmcnt(0)
    v_mfma_f32_16x16x32_bf16 v[24:27], v[128:131], v[152:155], v[24:27]
    ds_read_b64_tr_b16 v[172:173], v10 offset:4096
    ds_read_b64_tr_b16 v[174:175], v10 offset:4608
    v_mfma_f32_16x16x32_bf16 v[28:31], v[128:131], v[156:159], v[28:31]
    ds_read_b128 v[196:199], v17 offset:0
    v_mfma_f32_16x16x32_bf16 v[32:35], v[128:131], v[160:163], v[32:35]
    ds_read_b128 v[200:203], v17 offset:2048
    v_mfma_f32_16x16x32_bf16 v[36:39], v[128:131], v[164:167], v[36:39]
    ds_read_b128 v[204:207], v17 offset:4096
    v_mfma_f32_16x16x32_bf16 v[40:43], v[132:135], v[152:155], v[40:43]
    ds_read_b128 v[208:211], v17 offset:6144
    v_mfma_f32_16x16x32_bf16 v[44:47], v[132:135], v[156:159], v[44:47]
    ds_read_b64_tr_b16 v[176:177], v11 offset:4096
    ds_read_b64_tr_b16 v[178:179], v11 offset:4608
    v_mfma_f32_16x16x32_bf16 v[48:51], v[132:135], v[160:163], v[48:51]
    ds_read_b64_tr_b16 v[180:181], v12 offset:4096
    ds_read_b64_tr_b16 v[182:183], v12 offset:4608
    v_mfma_f32_16x16x32_bf16 v[52:55], v[132:135], v[164:167], v[52:55]
    ds_read_b64_tr_b16 v[184:185], v13 offset:4096
    ds_read_b64_tr_b16 v[186:187], v13 offset:4608
    v_mfma_f32_16x16x32_bf16 v[56:59], v[136:139], v[152:155], v[56:59]
    ds_read_b64_tr_b16 v[188:189], v14 offset:4096
    ds_read_b64_tr_b16 v[190:191], v14 offset:4608
    v_mfma_f32_16x16x32_bf16 v[60:63], v[136:139], v[156:159], v[60:63]
    ds_read_b64_tr_b16 v[192:193], v15 offset:4096
    ds_read_b64_tr_b16 v[194:195], v15 offset:4608
    v_mfma_f32_16x16x32_bf16 v[64:67], v[136:139], v[160:163], v[64:67]
    ds_read_b128 v[212:215], v19 offset:0
    v_mfma_f32_16x16x32_bf16 v[68:71], v[136:139], v[164:167], v[68:71]
    s_add_u32 s50, s50, 1
    s_cmp_eq_u32 s50, 3
    v_mfma_f32_16x16x32_bf16 v[72:75], v[140:143], v[152:155], v[72:75]
    s_cselect_b32 s49, s29, s51
    s_cselect_b32 s50, 0, s50
    v_mfma_f32_16x16x32_bf16 v[76:79], v[140:143], v[156:159], v[76:79]
    v_add_u32 v10, s49, v10
    v_add_u32 v11, s49, v11
    v_mfma_f32_16x16x32_bf16 v[80:83], v[140:143], v[160:163], v[80:83]
    v_add_u32 v12, s49, v12
    v_add_u32 v13, s49, v13
    v_mfma_f32_16x16x32_bf16 v[84:87], v[140:143], v[164:167], v[84:87]
    v_add_u32 v14, s49, v14
    v_add_u32 v15, s49, v15
    v_mfma_f32_16x16x32_bf16 v[88:91], v[144:147], v[152:155], v[88:91]
    v_add_u32 v16, s49, v16
    v_add_u32 v17, s49, v17
    v_mfma_f32_16x16x32_bf16 v[92:95], v[144:147], v[156:159], v[92:95]
    v_add_u32 v18, s49, v18
    v_add_u32 v19, s49, v19
    v_mfma_f32_16x16x32_bf16 v[96:99], v[144:147], v[160:163], v[96:99]
    s_sub_u32 s48, s48, 1
    s_cmp_lg_u32 s48, 0
    v_mfma_f32_16x16x32_bf16 v[100:103], v[144:147], v[164:167], v[100:103]
    v_mfma_f32_16x16x32_bf16 v[104:107], v[148:151], v[152:155], v[104:107]
    v_mfma_f32_16x16x32_bf16 v[108:111], v[148:151], v[156:159], v[108:111]
    v_mfma_f32_16x16x32_bf16 v[112:115], v[148:151], v[160:163], v[112:115]
    v_mfma_f32_16x16x32_bf16 v[116:119], v[148:151], v[164:167], v[116:119]
    v_mfma_f32_16x16x32_bf16 v[120:123], v[144:147], v[168:171], v[120:123]
    v_mfma_f32_16x16x32_bf16 v[124:127], v[148:151], v[168:171], v[124:127]
    s_waitcnt lgkmcnt(0)
    s_cbranch_scc1 g1_cloop
    ds_read_b64 v[128:129], v216 offset:0
    ds_read_b64 v[130:131], v216 offset:128
    ds_read_b64 v[132:133], v216 offset:256
    ds_read_b64 v[134:135], v216 offset:384
    ds_read_b64 v[136:137], v217
    ds_read_b128 v[140:143], v218 offset:0
    ds_read_b128 v[144:147], v218 offset:64
    ds_read_b128 v[148:151], v219 offset:0
    ds_read_b128 v[152:155], v219 offset:64
    ds_read_b128 v[156:159], v220 offset:0
    ds_read_b128 v[160:163], v220 offset:64
    v_mfma_f32_16x16x32_bf16 v[24:27], v[172:175], v[196:199], v[24:27]
    v_mfma_f32_16x16x32_bf16 v[40:43], v[176:179], v[196:199], v[40:43]
    v_mfma_f32_16x16x32_bf16 v[28:31], v[172:175], v[200:203], v[28:31]
    v_mfma_f32_16x16x32_bf16 v[44:47], v[176:179], v[200:203], v[44:47]
    v_mfma_f32_16x16x32_bf16 v[32:35], v[172:175], v[204:207], v[32:35]
    v_mfma_f32_16x16x32_bf16 v[48:51], v[176:179], v[204:207], v[48:51]
    s_waitcnt lgkmcnt(0)
    v_mfma_f32_16x16x32_bf16 v[36:39], v[172:175], v[208:211], v[36:39]
    v_pk_mul_f32 v[164:165], v[140:141], v[128:129] op_sel:[0,1] op_sel_hi:[1,1]
    v_pk_mul_f32 v[166:167], v[142:143], v[128:129] op_sel:[0,1] op_sel_hi:[1,1]
    v_pk_mul_f32 v[168:169], v[144:145], v[128:129] op_sel:[0,1] op_sel_hi:[1,1]
    v_pk_mul_f32 v[170:171], v[146:147], v[128:129] op_sel:[0,1] op_sel_hi:[1,1]
    v_pk_fma_f32 v[24:25], v[24:25], v[128:129], v[164:165] op_sel:[0,0,0] op_sel_hi:[1,0,1]
    v_pk_fma_f32 v[26:27], v[26:27], v[128:129], v[166:167] op_sel:[0,0,0] op_sel_hi:[1,0,1]
    v_pk_fma_f32 v[40:41], v[40:41], v[128:129], v[168:169] op_sel:[0,0,0] op_sel_hi:[1,0,1]
    v_pk_fma_f32 v[42:43], v[42:43], v[128:129], v[170:171] op_sel:[0,0,0] op_sel_hi:[1,0,1]
    v_mfma_f32_16x16x32_bf16 v[52:55], v[176:179], v[208:211], v[52:55]
    v_cvt_pk_bf16_f32 v232, v24, v25
    v_cvt_pk_bf16_f32 v233, v26, v27
    v_cvt_pk_bf16_f32 v234, v40, v41
    v_cvt_pk_bf16_f32 v235, v42, v43
    s_nop 1
    v_permlane16_swap_b32 v232, v234
    v_permlane16_swap_b32 v233, v235
    ds_write_b128 v221, v[232:235] offset:0
    v_mfma_f32_16x16x32_bf16 v[56:59], v[180:183], v[196:199], v[56:59]
    v_pk_mul_f32 v[164:165], v[140:141], v[130:131] op_sel:[0,1] op_sel_hi:[1,1]
    v_pk_mul_f32 v[166:167], v[142:143], v[130:131] op_sel:[0,1] op_sel_hi:[1,1]
    v_pk_mul_f32 v[168:169], v[144:145], v[130:131] op_sel:[0,1] op_sel_hi:[1,1]
    v_pk_mul_f32 v[170:171], v[146:147], v[130:131] op_sel:[0,1] op_sel_hi:[1,1]
    v_pk_fma_f32 v[28:29], v[28:29], v[130:131], v[164:165] op_sel:[0,0,0] op_sel_hi:[1,0,1]
    v_pk_fma_f32 v[30:31], v[30:31], v[130:131], v[166:167] op_sel:[0,0,0] op_sel_hi:[1,0,1]
    v_pk_fma_f32 v[44:45], v[44:45], v[130:131], v[168:169] op_sel:[0,0,0] op_sel_hi:[1,0,1]
    v_pk_fma_f32 v[46:47], v[46:47], v[130:131], v[170:171] op_sel:[0,0,0] op_sel_hi:[1,0,1]
    v_mfma_f32_16x16x32_bf16 v[72:75], v[184:187], v[196:199], v[72:75]
    v_cvt_pk_bf16_f32 v236, v28, v29
    v_cvt_pk_bf16_f32 v237, v30, v31
    v_cvt_pk_bf16_f32 v238, v44, v45
    v_cvt_pk_bf16_f32 v239, v46, v47
    s_nop 1
    v_permlane16_swap_b32 v236, v238
    v_permlane16_swap_b32 v237, v239
    ds_write_b128 v221, v[236:239] offset:2048
    v_mfma_f32_16x16x32_bf16 v[60:63], v[180:183], v[200:203], v[60:63]
    v_pk_mul_f32 v[164:165], v[140:141], v[132:133] op_sel:[0,1] op_sel_hi:[1,1]
    v_pk_mul_f32 v[166:167], v[142:143], v[132:133] op_sel:[0,1] op_sel_hi:[1,1]
    v_pk_mul_f32 v[168:169], v[144:145], v[132:133] op_sel:[0,1] op_sel_hi:[1,1]
    v_pk_mul_f32 v[170:171], v[146:147], v[132:133] op_sel:[0,1] op_sel_hi:[1,1]
    v_pk_fma_f32 v[32:33], v[32:33], v[132:133], v[164:165] op_sel:[0,0,0] op_sel_hi:[1,0,1]
    v_pk_fma_f32 v[34:35], v[34:35], v[132:133], v[166:167] op_sel:[0,0,0] op_sel_hi:[1,0,1]
    v_pk_fma_f32 v[48:49], v[48:49], v[132:133], v[168:169] op_sel:[0,0,0] op_sel_hi:[1,0,1]
    v_pk_fma_f32 v[50:51], v[50:51], v[132:133], v[170:171] op_sel:[0,0,0] op_sel_hi:[1,0,1]
    v_mfma_f32_16x16x32_bf16 v[76:79], v[184:187], v[200:203], v[76:79]
    v_cvt_pk_bf16_f32 v240, v32, v33
    v_cvt_pk_bf16_f32 v241, v34, v35
    v_cvt_pk_bf16_f32 v242, v48, v49
    v_cvt_pk_bf16_f32 v243, v50, v51
    s_nop 1
    v_permlane16_swap_b32 v240, v242
    v_permlane16_swap_b32 v241, v243
    ds_write_b128 v221, v[240:243] offset:4096
    v_mfma_f32_16x16x32_bf16 v[64:67], v[180:183], v[204:207], v[64:67]
    v_pk_mul_f32 v[164:165], v[140:141], v[134:135] op_sel:[0,1] op_sel_hi:[1,1]
    v_pk_mul_f32 v[166:167], v[142:143], v[134:135] op_sel:[0,1] op_sel_hi:[1,1]
    v_pk_mul_f32 v[168:169], v[144:145], v[134:135] op_sel:[0,1] op_sel_hi:[1,1]
    v_pk_mul_f32 v[170:171], v[146:147], v[134:135] op_sel:[0,1] op_sel_hi:[1,1]
    v_pk_fma_f32 v[36:37], v[36:37], v[134:135], v[164:165] op_sel:[0,0,0] op_sel_hi:[1,0,1]
    v_pk_fma_f32 v[38:39], v[38:39], v[134:135], v[166:167] op_sel:[0,0,0] op_sel_hi:[1,0,1]
    v_pk_fma_f32 v[52:53], v[52:53], v[134:135], v[168:169] op_sel:[0,0,0] op_sel_hi:[1,0,1]
    v_pk_fma_f32 v[54:55], v[54:55], v[134:135], v[170:171] op_sel:[0,0,0] op_sel_hi:[1,0,1]
    v_mfma_f32_16x16x32_bf16 v[80:83], v[184:187], v[204:207], v[80:83]
    v_cvt_pk_bf16_f32 v244, v36, v37
    v_cvt_pk_bf16_f32 v245, v38, v39
    v_cvt_pk_bf16_f32 v246, v52, v53
    v_cvt_pk_bf16_f32 v247, v54, v55
    s_nop 1
    v_permlane16_swap_b32 v244, v246
    v_permlane16_swap_b32 v245, v247
    ds_write_b128 v221, v[244:247] offset:6144
    v_mfma_f32_16x16x32_bf16 v[68:71], v[180:183], v[208:211], v[68:71]
    v_pk_mul_f32 v[164:165], v[148:149], v[128:129] op_sel:[0,1] op_sel_hi:[1,1]
    v_pk_mul_f32 v[166:167], v[150:151], v[128:129] op_sel:[0,1] op_sel_hi:[1,1]
    v_pk_mul_f32 v[168:169], v[152:153], v[128:129] op_sel:[0,1] op_sel_hi:[1,1]
    v_pk_mul_f32 v[170:171], v[154:155], v[128:129] op_sel:[0,1] op_sel_hi:[1,1]
    v_pk_fma_f32 v[56:57], v[56:57], v[128:129], v[164:165] op_sel:[0,0,0] op_sel_hi:[1,0,1]
    v_pk_fma_f32 v[58:59], v[58:59], v[128:129], v[166:167] op_sel:[0,0,0] op_sel_hi:[1,0,1]
    v_pk_fma_f32 v[72:73], v[72:73], v[128:129], v[168:169] op_sel:[0,0,0] op_sel_hi:[1,0,1]
    v_pk_fma_f32 v[74:75], v[74:75], v[128:129], v[170:171] op_sel:[0,0,0] op_sel_hi:[1,0,1]
    v_mfma_f32_16x16x32_bf16 v[84:87], v[184:187], v[208:211], v[84:87]
    v_cvt_pk_bf16_f32 v232, v56, v57
    v_cvt_pk_bf16_f32 v233, v58, v59
    v_cvt_pk_bf16_f32 v234, v72, v73
    v_cvt_pk_bf16_f32 v235, v74, v75
    s_nop 1
    v_permlane16_swap_b32 v232, v234
    v_permlane16_swap_b32 v233, v235
    ds_write_b128 v222, v[232:235] offset:0
    v_mfma_f32_16x16x32_bf16 v[88:91], v[188:191], v[196:199], v[88:91]
    v_pk_mul_f32 v[164:165], v[148:149], v[130:131] op_sel:[0,1] op_sel_hi:[1,1]
    v_pk_mul_f32 v[166:167], v[150:151], v[130:131] op_sel:[0,1] op_sel_hi:[1,1]
    v_pk_mul_f32 v[168:169], v[152:153], v[130:131] op_sel:[0,1] op_sel_hi:[1,1]
    v_pk_mul_f32 v[170:171], v[154:155], v[130:131] op_sel:[0,1] op_sel_hi:[1,1]
    v_pk_fma_f32 v[60:61], v[60:61], v[130:131], v[164:165] op_sel:[0,0,0] op_sel_hi:[1,0,1]
    v_pk_fma_f32 v[62:63], v[62:63], v[130:131], v[166:167] op_sel:[0,0,0] op_sel_hi:[1,0,1]
    v_pk_fma_f32 v[76:77], v[76:77], v[130:131], v[168:169] op_sel:[0,0,0] op_sel_hi:[1,0,1]
    v_pk_fma_f32 v[78:79], v[78:79], v[130:131], v[170:171] op_sel:[0,0,0] op_sel_hi:[1,0,1]
    v_mfma_f32_16x16x32_bf16 v[104:107], v[192:195], v[196:199], v[104:107]
    v_cvt_pk_bf16_f32 v236, v60, v61
    v_cvt_pk_bf16_f32 v237, v62, v63
    v_cvt_pk_bf16_f32 v238, v76, v77
    v_cvt_pk_bf16_f32 v239, v78, v79
    s_nop 1
    v_permlane16_swap_b32 v236, v238
    v_permlane16_swap_b32 v237, v239
    ds_write_b128 v222, v[236:239] offset:2048
    v_mfma_f32_16x16x32_bf16 v[92:95], v[188:191], v[200:203], v[92:95]
    v_pk_mul_f32 v[164:165], v[148:149], v[132:133] op_sel:[0,1] op_sel_hi:[1,1]
    v_pk_mul_f32 v[166:167], v[150:151], v[132:133] op_sel:[0,1] op_sel_hi:[1,1]
    v_pk_mul_f32 v[168:169], v[152:153], v[132:133] op_sel:[0,1] op_sel_hi:[1,1]
    v_pk_mul_f32 v[170:171], v[154:155], v[132:133] op_sel:[0,1] op_sel_hi:[1,1]
    v_pk_fma_f32 v[64:65], v[64:65], v[132:133], v[164:165] op_sel:[0,0,0] op_sel_hi:[1,0,1]
    v_pk_fma_f32 v[66:67], v[66:67], v[132:133], v[166:167] op_sel:[0,0,0] op_sel_hi:[1,0,1]
    v_pk_fma_f32 v[80:81], v[80:81], v[132:133], v[168:169] op_sel:[0,0,0] op_sel_hi:[1,0,1]
    v_pk_fma_f32 v[82:83], v[82:83], v[132:133], v[170:171] op_sel:[0,0,0] op_sel_hi:[1,0,1]
    v_mfma_f32_16x16x32_bf16 v[108:111], v[192:195], v[200:203], v[108:111]
    v_cvt_pk_bf16_f32 v240, v64, v65
    v_cvt_pk_bf16_f32 v241, v66, v67
    v_cvt_pk_bf16_f32 v242, v80, v81
    v_cvt_pk_bf16_f32 v243, v82, v83
    s_nop 1
    v_permlane16_swap_b32 v240, v242
    v_permlane16_swap_b32 v241, v243
    ds_write_b128 v222, v[240:243] offset:4096
    v_mfma_f32_16x16x32_bf16 v[96:99], v[188:191], v[204:207], v[96:99]
    v_pk_mul_f32 v[164:165], v[148:149], v[134:135] op_sel:[0,1] op_sel_hi:[1,1]
    v_pk_mul_f32 v[166:167], v[150:151], v[134:135] op_sel:[0,1] op_sel_hi:[1,1]
    v_pk_mul_f32 v[168:169], v[152:153], v[134:135] op_sel:[0,1] op_sel_hi:[1,1]
    v_pk_mul_f32 v[170:171], v[154:155], v[134:135] op_sel:[0,1] op_sel_hi:[1,1]
    v_pk_fma_f32 v[68:69], v[68:69], v[134:135], v[164:165] op_sel:[0,0,0] op_sel_hi:[1,0,1]
    v_pk_fma_f32 v[70:71], v[70:71], v[134:135], v[166:167] op_sel:[0,0,0] op_sel_hi:[1,0,1]
    v_pk_fma_f32 v[84:85], v[84:85], v[134:135], v[168:169] op_sel:[0,0,0] op_sel_hi:[1,0,1]
    v_pk_fma_f32 v[86:87], v[86:87], v[134:135], v[170:171] op_sel:[0,0,0] op_sel_hi:[1,0,1]
    v_mfma_f32_16x16x32_bf16 v[112:115], v[192:195], v[204:207], v[112:115]
    v_cvt_pk_bf16_f32 v244, v68, v69
    v_cvt_pk_bf16_f32 v245, v70, v71
    v_cvt_pk_bf16_f32 v246, v84, v85
    v_cvt_pk_bf16_f32 v247, v86, v87
    s_nop 1
    v_permlane16_swap_b32 v244, v246
    v_permlane16_swap_b32 v245, v247
    ds_write_b128 v222, v[244:247] offset:6144
    v_mfma_f32_16x16x32_bf16 v[100:103], v[188:191], v[208:211], v[100:103]
    v_pk_mul_f32 v[164:165], v[156:157], v[128:129] op_sel:[0,1] op_sel_hi:[1,1]
    v_pk_mul_f32 v[166:167], v[158:159], v[128:129] op_sel:[0,1] op_sel_hi:[1,1]
    v_pk_mul_f32 v[168:169], v[160:161], v[128:129] op_sel:[0,1] op_sel_hi:[1,1]
    v_pk_mul_f32 v[170:171], v[162:163], v[128:129] op_sel:[0,1] op_sel_hi:[1,1]
    v_pk_fma_f32 v[88:89], v[88:89], v[128:129], v[164:165] op_sel:[0,0,0] op_sel_hi:[1,0,1]
    v_pk_fma_f32 v[90:91], v[90:91], v[128:129], v[166:167] op_sel:[0,0,0] op_sel_hi:[1,0,1]
    v_pk_fma_f32 v[104:105], v[104:105], v[128:129], v[168:169] op_sel:[0,0,0] op_sel_hi:[1,0,1]
    v_pk_fma_f32 v[106:107], v[106:107], v[128:129], v[170:171] op_sel:[0,0,0] op_sel_hi:[1,0,1]
    v_mfma_f32_16x16x32_bf16 v[116:119], v[192:195], v[208:211], v[116:119]
    v_cvt_pk_bf16_f32 v232, v88, v89
    v_cvt_pk_bf16_f32 v233, v90, v91
    v_cvt_pk_bf16_f32 v234, v104, v105
    v_cvt_pk_bf16_f32 v235, v106, v107
    s_nop 1
    v_permlane16_swap_b32 v232, v234
    v_permlane16_swap_b32 v233, v235
    ds_write_b128 v223, v[232:235] offset:0
    v_mfma_f32_16x16x32_bf16 v[120:123], v[188:191], v[212:215], v[120:123]
    v_pk_mul_f32 v[164:165], v[156:157], v[130:131] op_sel:[0,1] op_sel_hi:[1,1]
    v_pk_mul_f32 v[166:167], v[158:159], v[130:131] op_sel:[0,1] op_sel_hi:[1,1]
    v_pk_mul_f32 v[168:169], v[160:161], v[130:131] op_sel:[0,1] op_sel_hi:[1,1]
    v_pk_mul_f32 v[170:171], v[162:163], v[130:131] op_sel:[0,1] op_sel_hi:[1,1]
    v_pk_fma_f32 v[92:93], v[92:93], v[130:131], v[164:165] op_sel:[0,0,0] op_sel_hi:[1,0,1]
    v_pk_fma_f32 v[94:95], v[94:95], v[130:131], v[166:167] op_sel:[0,0,0] op_sel_hi:[1,0,1]
    v_pk_fma_f32 v[108:109], v[108:109], v[130:131], v[168:169] op_sel:[0,0,0] op_sel_hi:[1,0,1]
    v_pk_fma_f32 v[110:111], v[110:111], v[130:131], v[170:171] op_sel:[0,0,0] op_sel_hi:[1,0,1]
    v_mfma_f32_16x16x32_bf16 v[124:127], v[192:195], v[212:215], v[124:127]
    v_cvt_pk_bf16_f32 v236, v92, v93
    v_cvt_pk_bf16_f32 v237, v94, v95
    v_cvt_pk_bf16_f32 v238, v108, v109
    v_cvt_pk_bf16_f32 v239, v110, v111
    s_nop 1
    v_permlane16_swap_b32 v236, v238
    v_permlane16_swap_b32 v237, v239
    ds_write_b128 v223, v[236:239] offset:2048
    v_pk_mul_f32 v[164:165], v[156:157], v[132:133] op_sel:[0,1] op_sel_hi:[1,1]
    v_pk_mul_f32 v[166:167], v[158:159], v[132:133] op_sel:[0,1] op_sel_hi:[1,1]
    v_pk_mul_f32 v[168:169], v[160:161], v[132:133] op_sel:[0,1] op_sel_hi:[1,1]
    v_pk_mul_f32 v[170:171], v[162:163], v[132:133] op_sel:[0,1] op_sel_hi:[1,1]
    v_pk_fma_f32 v[96:97], v[96:97], v[132:133], v[164:165] op_sel:[0,0,0] op_sel_hi:[1,0,1]
    v_pk_fma_f32 v[98:99], v[98:99], v[132:133], v[166:167] op_sel:[0,0,0] op_sel_hi:[1,0,1]
    v_pk_fma_f32 v[112:113], v[112:113], v[132:133], v[168:169] op_sel:[0,0,0] op_sel_hi:[1,0,1]
    v_pk_fma_f32 v[114:115], v[114:115], v[132:133], v[170:171] op_sel:[0,0,0] op_sel_hi:[1,0,1]
    v_cvt_pk_bf16_f32 v240, v96, v97
    v_cvt_pk_bf16_f32 v241, v98, v99
    v_cvt_pk_bf16_f32 v242, v112, v113
    v_cvt_pk_bf16_f32 v243, v114, v115
    s_nop 1
    v_permlane16_swap_b32 v240, v242
    v_permlane16_swap_b32 v241, v243
    ds_write_b128 v223, v[240:243] offset:4096
    v_pk_mul_f32 v[164:165], v[156:157], v[134:135] op_sel:[0,1] op_sel_hi:[1,1]
    v_pk_mul_f32 v[166:167], v[158:159], v[134:135] op_sel:[0,1] op_sel_hi:[1,1]
    v_pk_mul_f32 v[168:169], v[160:161], v[134:135] op_sel:[0,1] op_sel_hi:[1,1]
    v_pk_mul_f32 v[170:171], v[162:163], v[134:135] op_sel:[0,1] op_sel_hi:[1,1]
    v_pk_fma_f32 v[100:101], v[100:101], v[134:135], v[164:165] op_sel:[0,0,0] op_sel_hi:[1,0,1]
    v_pk_fma_f32 v[102:103], v[102:103], v[134:135], v[166:167] op_sel:[0,0,0] op_sel_hi:[1,0,1]
    v_pk_fma_f32 v[116:117], v[116:117], v[134:135], v[168:169] op_sel:[0,0,0] op_sel_hi:[1,0,1]
    v_pk_fma_f32 v[118:119], v[118:119], v[134:135], v[170:171] op_sel:[0,0,0] op_sel_hi:[1,0,1]
    v_cvt_pk_bf16_f32 v244, v100, v101
    v_cvt_pk_bf16_f32 v245, v102, v103
    v_cvt_pk_bf16_f32 v246, v116, v117
    v_cvt_pk_bf16_f32 v247, v118, v119
    s_nop 1
    v_permlane16_swap_b32 v244, v246
    v_permlane16_swap_b32 v245, v247
    ds_write_b128 v223, v[244:247] offset:6144
    v_pk_mul_f32 v[164:165], v[156:157], v[136:137] op_sel:[0,1] op_sel_hi:[1,1]
    v_pk_mul_f32 v[166:167], v[158:159], v[136:137] op_sel:[0,1] op_sel_hi:[1,1]
    v_pk_mul_f32 v[168:169], v[160:161], v[136:137] op_sel:[0,1] op_sel_hi:[1,1]
    v_pk_mul_f32 v[170:171], v[162:163], v[136:137] op_sel:[0,1] op_sel_hi:[1,1]
    v_pk_fma_f32 v[120:121], v[120:121], v[136:137], v[164:165] op_sel:[0,0,0] op_sel_hi:[1,0,1]
    v_pk_fma_f32 v[122:123], v[122:123], v[136:137], v[166:167] op_sel:[0,0,0] op_sel_hi:[1,0,1]
    v_pk_fma_f32 v[124:125], v[124:125], v[136:137], v[168:169] op_sel:[0,0,0] op_sel_hi:[1,0,1]
    v_pk_fma_f32 v[126:127], v[126:127], v[136:137], v[170:171] op_sel:[0,0,0] op_sel_hi:[1,0,1]
    v_cvt_pk_bf16_f32 v232, v120, v121
    v_cvt_pk_bf16_f32 v233, v122, v123
    v_cvt_pk_bf16_f32 v234, v124, v125
    v_cvt_pk_bf16_f32 v235, v126, v127
    s_nop 1
    v_permlane16_swap_b32 v232, v234
    v_permlane16_swap_b32 v233, v235
    ds_write_b128 v224, v[232:235]
    s_waitcnt lgkmcnt(0)
g1_attn:
    s_barrier
    ds_read_b128 v[24:27], v226 offset:2048
    ds_read_b128 v[28:31], v226 offset:18432
    ds_read_b128 v[32:35], v226 offset:20480
    ds_read_b128 v[72:75], v226 offset:2176
    ds_read_b128 v[76:79], v226 offset:18560
    ds_read_b128 v[80:83], v226 offset:20608
    ds_read_b64_tr_b16 v[36:37], v227 offset:0
    ds_read_b64_tr_b16 v[38:39], v227 offset:2048
    ds_read_b64_tr_b16 v[40:41], v227 offset:8
    ds_read_b64_tr_b16 v[42:43], v227 offset:2056
    ds_read_b64_tr_b16 v[84:85], v227 offset:128
    ds_read_b64_tr_b16 v[86:87], v227 offset:2176
    ds_read_b64_tr_b16 v[88:89], v227 offset:136
    ds_read_b64_tr_b16 v[90:91], v227 offset:2184
    s_waitcnt lgkmcnt(8)
    v_mfma_f32_16x16x32_bf16 v[44:47], v[28:31], v[24:27], 0
    v_mfma_f32_16x16x32_bf16 v[48:51], v[32:35], v[24:27], 0
    v_mfma_f32_16x16x32_bf16 v[92:95], v[76:79], v[72:75], 0
    v_mfma_f32_16x16x32_bf16 v[96:99], v[80:83], v[72:75], 0
    s_nop 7
    v_cndmask_b32 v44, v48, v44, s[56:57]
    v_cndmask_b32 v45, v49, v45, s[56:57]
    v_cndmask_b32 v46, v50, v46, s[56:57]
    v_cndmask_b32 v47, v51, v47, s[56:57]
    v_cndmask_b32 v92, v96, v92, s[56:57]
    v_cndmask_b32 v93, v97, v93, s[56:57]
    v_cndmask_b32 v94, v98, v94, s[56:57]
    v_cndmask_b32 v95, v99, v95, s[56:57]
    v_cvt_pk_bf16_f32 v48, v44, v45
    v_cvt_pk_bf16_f32 v49, v46, v47
    v_cvt_pk_bf16_f32 v96, v92, v93
    v_cvt_pk_bf16_f32 v97, v94, v95
    v_lshlrev_b32 v44, 16, v48
    v_and_b32 v45, 0xffff0000, v48
    v_lshlrev_b32 v46, 16, v49
    v_and_b32 v47, 0xffff0000, v49
    v_lshlrev_b32 v92, 16, v96
    v_and_b32 v93, 0xffff0000, v96
    v_lshlrev_b32 v94, 16, v97
    v_and_b32 v95, 0xffff0000, v97
    v_mul_f32 v44, s58, v44
    v_mul_f32 v45, s58, v45
    v_mul_f32 v46, s58, v46
    v_mul_f32 v47, s58, v47
    v_mul_f32 v92, s58, v92
    v_mul_f32 v93, s58, v93
    v_mul_f32 v94, s58, v94
    v_mul_f32 v95, s58, v95
    v_cvt_pk_bf16_f32 v48, v44, v45
    v_cvt_pk_bf16_f32 v49, v46, v47
    v_cvt_pk_bf16_f32 v96, v92, v93
    v_cvt_pk_bf16_f32 v97, v94, v95
    v_lshlrev_b32 v44, 16, v48
    v_and_b32 v45, 0xffff0000, v48
    v_lshlrev_b32 v46, 16, v49
    v_and_b32 v47, 0xffff0000, v49
    v_lshlrev_b32 v92, 16, v96
    v_and_b32 v93, 0xffff0000, v96
    v_lshlrev_b32 v94, 16, v97
    v_and_b32 v95, 0xffff0000, v97
    v_fma_f32 v44, v44, s59, v228
    v_fma_f32 v45, v45, s59, v229
    v_fma_f32 v46, v46, s59, v230
    v_fma_f32 v47, v47, s59, v231
    v_fma_f32 v92, v92, s59, v228
    v_fma_f32 v93, v93, s59, v229
    v_fma_f32 v94, v94, s59, v230
    v_fma_f32 v95, v95, s59, v231
    v_max3_f32 v48, v44, v45, v46
    v_max3_f32 v96, v92, v93, v94
    v_max_f32 v48, v48, v47
    v_max_f32 v96, v96, v95
    v_mov_b32 v49, v48
    v_mov_b32 v97, v96
    s_nop 1
    v_permlane16_swap_b32 v48, v49
    v_permlane16_swap_b32 v96, v97
    s_nop 0
    v_max_f32 v48, v48, v49
    v_max_f32 v96, v96, v97
    v_mov_b32 v49, v48
    v_mov_b32 v97, v96
    s_nop 1
    v_permlane32_swap_b32 v48, v49
    v_permlane32_swap_b32 v96, v97
    s_nop 0
    v_max_f32 v48, v48, v49
    v_max_f32 v96, v96, v97
    v_sub_f32 v44, v44, v48
    v_sub_f32 v45, v45, v48
    v_sub_f32 v46, v46, v48
    v_sub_f32 v47, v47, v48
    v_sub_f32 v92, v92, v96
    v_sub_f32 v93, v93, v96
    v_sub_f32 v94, v94, v96
    v_sub_f32 v95, v95, v96
    v_exp_f32 v44, v44
    v_exp_f32 v45, v45
    v_exp_f32 v46, v46
    v_exp_f32 v47, v47
    v_exp_f32 v92, v92
    v_exp_f32 v93, v93
    v_exp_f32 v94, v94
    v_exp_f32 v95, v95
    v_add_f32 v48, v44, v45
    v_add_f32 v49, v46, v47
    v_add_f32 v96, v92, v93
    v_add_f32 v97, v94, v95
    v_add_f32 v48, v48, v49
    v_add_f32 v96, v96, v97
    v_mov_b32 v49, v48
    v_mov_b32 v97, v96
    s_nop 1
    v_permlane16_swap_b32 v48, v49
    v_permlane16_swap_b32 v96, v97
    s_nop 0
    v_add_f32 v48, v48, v49
    v_add_f32 v96, v96, v97
    v_mov_b32 v49, v48
    v_mov_b32 v97, v96
    s_nop 1
    v_permlane32_swap_b32 v48, v49
    v_permlane32_swap_b32 v96, v97
    s_nop 0
    v_add_f32 v48, v48, v49
    v_add_f32 v96, v96, v97
    v_rcp_f32 v48, v48
    v_rcp_f32 v96, v96
    s_nop 0
    v_mul_f32 v44, v44, v48
    v_mul_f32 v45, v45, v48
    v_mul_f32 v46, v46, v48
    v_mul_f32 v47, v47, v48
    v_mul_f32 v92, v92, v96
    v_mul_f32 v93, v93, v96
    v_mul_f32 v94, v94, v96
    v_mul_f32 v95, v95, v96
    v_cvt_pk_bf16_f32 v48, v44, v45
    v_cvt_pk_bf16_f32 v49, v46, v47
    v_cvt_pk_bf16_f32 v96, v92, v93
    v_cvt_pk_bf16_f32 v97, v94, v95
    v_cndmask_b32 v52, 0, v48, s[56:57]
    v_cndmask_b32 v53, 0, v49, s[56:57]
    v_cndmask_b32 v54, v48, 0, s[56:57]
    v_cndmask_b32 v55, v49, 0, s[56:57]
    v_cndmask_b32 v100, 0, v96, s[56:57]
    v_cndmask_b32 v101, 0, v97, s[56:57]
    v_cndmask_b32 v102, v96, 0, s[56:57]
    v_cndmask_b32 v103, v97, 0, s[56:57]
    s_waitcnt lgkmcnt(0)
    s_nop 0
    v_mfma_f32_16x16x32_bf16 v[56:59], v[36:39], v[52:55], 0
    v_mfma_f32_16x16x32_bf16 v[60:63], v[40:43], v[52:55], 0
    v_mfma_f32_16x16x32_bf16 v[104:107], v[84:87], v[100:103], 0
    v_mfma_f32_16x16x32_bf16 v[108:111], v[88:91], v[100:103], 0
    s_nop 7
    v_cvt_pk_bf16_f32 v64, v56, v57
    v_cvt_pk_bf16_f32 v65, v58, v59
    v_cvt_pk_bf16_f32 v66, v60, v61
    v_cvt_pk_bf16_f32 v67, v62, v63
    buffer_store_dwordx4 v[64:67], v225, s[16:19], 0 offen offset:0 sc1
    v_cvt_pk_bf16_f32 v112, v104, v105
    v_cvt_pk_bf16_f32 v113, v106, v107
    v_cvt_pk_bf16_f32 v114, v108, v109
    v_cvt_pk_bf16_f32 v115, v110, v111
    buffer_store_dwordx4 v[112:115], v225, s[16:19], 0 offen offset:2048 sc1
    s_add_u32 s40, s25, 0
    s_lshl_b32 s40, s40, 8
    s_add_u32 s84, s4, 0x300000
    s_addc_u32 s85, s5, 0
    s_mov_b32 s86, 0x4000
    s_mov_b32 s87, 0x20000
    v_mov_b32 v3, s40
    v_mov_b32 v4, 1
    s_waitcnt vmcnt(0)
    s_barrier
    s_cmp_lg_u32 s28, 0
    s_cbranch_scc1 g1_cin
    s_mov_b64 exec, 1
    buffer_atomic_add v4, v3, s[84:87], 0 offen sc1
    s_mov_b64 exec, -1
g1_cin:
    s_branch g2_in
g1_done:
    s_endpgm
.p2align 6
g2_in:
    s_cmp_ge_u32 s2, 256
    s_cbranch_scc1 g2_done
    s_load_dwordx2 s[4:5], s[0:1], 80
    s_load_dwordx2 s[6:7], s[0:1], 0
    s_load_dwordx2 s[30:31], s[0:1], 16
    v_lshrrev_b32 v1, 6, v0
    v_and_b32 v2, 63, v0
    s_and_b32 s40, s2, 3
    s_lshl_b32 s40, s40, 2
    s_bfe_u32 s41, s2, 0x20003
    s_add_u32 s25, s40, s41
    s_bfe_u32 s40, s2, 0x10002
    s_lshl_b32 s40, s40, 3
    s_lshr_b32 s42, s2, 5
    s_add_u32 s24, s40, s42
    s_add_u32 s27, s41, s42
    s_mov_b32 s26, 0
    v_readfirstlane_b32 s28, v1
    s_nop 0
    s_cmp_lt_u32 s28, 4
    s_cbranch_scc1 g2_compute
    s_sub_u32 s28, s28, 4
    s_mov_b32 s40, 2048
    v_lshrrev_b32 v3, 3, v2
    v_mul_lo_u32 v3, v3, s40
    v_bfe_u32 v4, v2, 4, 1
    v_lshlrev_b32 v4, 1, v4
    v_xor_b32 v4, v4, v2
    v_and_b32 v4, 7, v4
    v_lshl_add_u32 v3, v4, 4, v3
    s_mul_i32 s41, s24, 128
    s_mul_i32 s42, s28, 32768
    s_add_u32 s41, s41, s42
    v_xor_b32 v4, 64, v3
    s_add_u32 s42, s41, 0
    v_add_u32 v10, s42, v3
    s_add_u32 s42, s41, 16384
    v_add_u32 v11, s42, v4
    s_mov_b32 s40, 2048
    v_lshrrev_b32 v3, 3, v2
    v_mul_lo_u32 v3, v3, s40
    v_lshrrev_b32 v4, 4, v2
    v_xor_b32 v4, v4, v2
    v_and_b32 v4, 7, v4
    v_lshl_add_u32 v3, v4, 4, v3
    s_mul_i32 s41, s25, 262144
    s_mul_i32 s42, s28, 65536
    s_add_u32 s41, s41, s42
    v_xor_b32 v4, 64, v3
    s_add_u32 s42, s41, 0
    v_add_u32 v12, s42, v3
    s_add_u32 s42, s41, 16384
    v_add_u32 v13, s42, v4
    s_add_u32 s42, s41, 32768
    v_add_u32 v14, s42, v3
    s_add_u32 s42, s41, 49152
    v_add_u32 v15, s42, v4
    s_mul_i32 s36, s28, 2048
    s_mul_i32 s37, s28, 4096
    s_add_u32 s37, s37, 8192
    s_waitcnt lgkmcnt(0)
    s_add_u32 s4, s4, s97
    s_addc_u32 s5, s5, 0
    s_mov_b32 s8, s30
    s_mov_b32 s9, s31
    s_mov_b32 s10, 0x200000
    s_mov_b32 s11, 0x20000
    s_add_u32 s12, s4, 0x400000
    s_addc_u32 s13, s5, 0
    s_mov_b32 s14, 0x400000
    s_mov_b32 s15, 0x20000
    s_mov_b32 s32, 0
    s_mov_b32 s33, 0
g2_ld_pW:
    s_add_u32 s40, s32, s27
    s_and_b32 s40, s40, 1
    s_andn2_b32 s41, s32, 1
    s_or_b32 s40, s40, s41
    s_add_u32 s40, s40, s26
    s_mul_i32 s34, s40, 131072
    s_mul_i32 s35, s40, 128
    s_add_u32 s38, s33, s36
    s_add_u32 s39, s33, s37
    s_add_u32 m0, s38, 0
    s_nop 0
    buffer_load_dwordx4 v10, s[8:11], s34 offen lds
    s_add_u32 m0, s38, 1024
    s_nop 0
    buffer_load_dwordx4 v11, s[8:11], s34 offen lds
    s_add_u32 s33, s33, 24576
    s_add_u32 s32, s32, 1
    s_cmp_lt_u32 s32, 3
    s_cbranch_scc1 g2_ld_pW
    s_lshr_b32 s40, s25, 0
    s_add_u32 s40, s40, 0
    s_lshl_b32 s40, s40, 8
    s_mov_b32 s42, s40
    s_lshl_b32 s43, s96, 2
    s_add_u32 s43, s43, 2
    s_mov_b32 s41, 0x80000
    v_mov_b32 v24, 131072
    s_cmp_lg_u32 s28, 0
    s_cbranch_scc1 g2_dep_lds
    s_mov_b32 s41, 0x8000
    s_add_u32 s84, s4, 0x300000
    s_addc_u32 s85, s5, 0
    s_mov_b32 s86, 0x4000
    s_mov_b32 s87, 0x20000
    v_cmp_eq_u32 vcc, 1, v2
    v_mov_b32 v21, s40
    v_mov_b32 v23, s42
    v_cndmask_b32 v21, v21, v23, vcc
    v_mov_b32 v22, 16
    v_mov_b32 v23, 16
    v_cndmask_b32 v22, v22, v23, vcc
g2_dep:
    buffer_load_dword v23, v21, s[84:87], 0 offen sc1
    s_sub_u32 s41, s41, 1
    s_waitcnt vmcnt(0)
    v_cmp_lt_u32 vcc, v23, v22
    s_cmp_eq_u32 s41, 0
    s_cbranch_scc1 g2_dep_seen
    s_cbranch_vccz g2_dep_seen
    s_sleep 2
    s_branch g2_dep
g2_dep_seen:
    v_mov_b32 v23, s43
    ds_write_b32 v24, v23
    s_branch g2_dep_ok
g2_dep_lds:
    ds_read_b32 v23, v24
    s_sub_u32 s41, s41, 1
    s_waitcnt lgkmcnt(0)
    v_readfirstlane_b32 s40, v23
    s_cmp_eq_u32 s41, 0
    s_cbranch_scc1 g2_dep_ok
    s_cmp_eq_u32 s40, s43
    s_cbranch_scc1 g2_dep_ok
    s_sleep 1
    s_branch g2_dep_lds
g2_dep_ok:
    s_mov_b32 s32, 0
    s_mov_b32 s33, 0
g2_ld_pA:
    s_add_u32 s40, s32, s27
    s_and_b32 s40, s40, 1
    s_andn2_b32 s41, s32, 1
    s_or_b32 s40, s40, s41
    s_add_u32 s40, s40, s26
    s_mul_i32 s34, s40, 131072
    s_mul_i32 s35, s40, 128
    s_add_u32 s38, s33, s36
    s_add_u32 s39, s33, s37
    s_add_u32 m0, s39, 0
    s_nop 0
    buffer_load_dwordx4 v12, s[12:15], s35 offen sc1 lds
    s_add_u32 m0, s39, 1024
    s_nop 0
    buffer_load_dwordx4 v13, s[12:15], s35 offen sc1 lds
    s_add_u32 m0, s39, 2048
    s_nop 0
    buffer_load_dwordx4 v14, s[12:15], s35 offen sc1 lds
    s_add_u32 m0, s39, 3072
    s_nop 0
    buffer_load_dwordx4 v15, s[12:15], s35 offen sc1 lds
    s_add_u32 s33, s33, 24576
    s_add_u32 s32, s32, 1
    s_cmp_lt_u32 s32, 3
    s_cbranch_scc1 g2_ld_pA
    s_waitcnt vmcnt(8)
    s_branch g2_ld_bar
g2_ld_loop:
    s_cmp_eq_u32 s32, 4
    s_cbranch_scc1 g2_ld_s4
    s_waitcnt vmcnt(12)
g2_ld_bar:
    s_barrier
    s_add_u32 s40, s32, s27
    s_and_b32 s40, s40, 1
    s_andn2_b32 s41, s32, 1
    s_or_b32 s40, s40, s41
    s_add_u32 s40, s40, s26
    s_mul_i32 s34, s40, 131072
    s_mul_i32 s35, s40, 128
    s_add_u32 s38, s33, s36
    s_add_u32 s39, s33, s37
    s_add_u32 m0, s38, 0
    s_nop 0
    buffer_load_dwordx4 v10, s[8:11], s34 offen lds
    s_add_u32 m0, s38, 1024
    s_nop 0
    buffer_load_dwordx4 v11, s[8:11], s34 offen lds
    s_add_u32 m0, s39, 0
    s_nop 0
    buffer_load_dwordx4 v12, s[12:15], s35 offen sc1 lds
    s_add_u32 m0, s39, 1024
    s_nop 0
    buffer_load_dwordx4 v13, s[12:15], s35 offen sc1 lds
    s_add_u32 m0, s39, 2048
    s_nop 0
    buffer_load_dwordx4 v14, s[12:15], s35 offen sc1 lds
    s_add_u32 m0, s39, 3072
    s_nop 0
    buffer_load_dwordx4 v15, s[12:15], s35 offen sc1 lds
    s_add_u32 s33, s33, 24576
    s_add_u32 s32, s32, 1
    s_cmp_eq_u32 s33, 98304
    s_cselect_b32 s33, 0, s33
    s_cmp_lt_u32 s32, 16
    s_cbranch_scc1 g2_ld_loop
    s_waitcnt vmcnt(12)
    s_barrier
    s_waitcnt vmcnt(6)
    s_barrier
    s_waitcnt vmcnt(0)
    s_barrier
    s_branch g2_ld_end
g2_ld_s4:
    s_waitcnt vmcnt(10)
    s_branch g2_ld_bar
g2_ld_end:
    s_barrier
    s_branch g3_in
g2_done:
    s_endpgm
g2_compute:
    v_lshrrev_b32 v5, 4, v2
    v_bfe_u32 v6, v2, 2, 2
    v_and_b32 v7, 3, v2
    v_and_b32 v8, 15, v2
    s_and_b32 s44, s28, 0
    s_lshr_b32 s45, s28, 0
    s_mul_i32 s40, s25, 128
    s_mul_i32 s41, s45, 32
    s_add_u32 s40, s40, s41
    v_add_u32 v20, s40, v8
    s_mov_b32 s41, 2048
    v_mul_lo_u32 v9, v20, s41
    s_mul_i32 s40, s24, 128
    s_mul_i32 s41, s44, 128
    s_add_u32 s46, s40, s41
    v_and_b32 v3, 1, v5
    v_lshlrev_b32 v3, 5, v3
    v_lshrrev_b32 v4, 1, v5
    v_lshl_add_u32 v3, v4, 4, v3
    v_add3_u32 v9, v9, v3, s46
    s_mov_b32 s52, 0
    s_mov_b32 s53, 32768
    s_waitcnt lgkmcnt(0)
    s_add_u32 s4, s4, s97
    s_addc_u32 s5, s5, 0
    s_add_u32 s20, s4, 0x1900000
    s_addc_u32 s21, s5, 0
    s_cmp_eq_u32 s96, 1
    s_cselect_b32 s20, s20, s6
    s_cselect_b32 s21, s21, s7
    s_mov_b32 s22, 0x400000
    s_mov_b32 s23, 0x20000
    s_add_u32 s16, s4, 0x800000
    s_addc_u32 s17, s5, 0
    s_mov_b32 s18, 0x400000
    s_mov_b32 s19, 0x20000
    s_add_u32 s56, s4, 0xc00000
    s_addc_u32 s57, s5, 0
    s_mov_b32 s58, 0x480000
    s_mov_b32 s59, 0x20000
    s_add_u32 s60, s4, 0x200000
    s_addc_u32 s61, s5, 0
    s_mov_b32 s62, 0x40000
    s_mov_b32 s63, 0x20000
    s_mul_i32 s42, s44, 4
    s_mov_b32 s43, 0
    v_and_b32 v3, 1, v5
    v_lshlrev_b32 v3, 1, v3
    v_lshrrev_b32 v4, 1, v6
    v_or_b32 v3, v3, v4
    s_add_u32 s40, s42, 0
    v_xor_b32 v3, s40, v3
    v_lshlrev_b32 v3, 5, v3
    v_lshl_add_u32 v3, v7, 3, v3
    v_lshl_add_u32 v4, v5, 3, v6
    v_lshl_add_u32 v3, v4, 7, v3
    v_add_u32 v10, s43, v3
    v_and_b32 v3, 1, v5
    v_lshlrev_b32 v3, 1, v3
    v_lshrrev_b32 v4, 1, v6
    v_or_b32 v3, v3, v4
    s_add_u32 s40, s42, 1
    v_xor_b32 v3, s40, v3
    v_lshlrev_b32 v3, 5, v3
    v_lshl_add_u32 v3, v7, 3, v3
    v_lshl_add_u32 v4, v5, 3, v6
    v_lshl_add_u32 v3, v4, 7, v3
    v_add_u32 v11, s43, v3
    v_and_b32 v3, 1, v5
    v_lshlrev_b32 v3, 1, v3
    v_lshrrev_b32 v4, 1, v6
    v_or_b32 v3, v3, v4
    s_add_u32 s40, s42, 2
    v_xor_b32 v3, s40, v3
    v_lshlrev_b32 v3, 5, v3
    v_lshl_add_u32 v3, v7, 3, v3
    v_lshl_add_u32 v4, v5, 3, v6
    v_lshl_add_u32 v3, v4, 7, v3
    v_add_u32 v12, s43, v3
    v_and_b32 v3, 1, v5
    v_lshlrev_b32 v3, 1, v3
    v_lshrrev_b32 v4, 1, v6
    v_or_b32 v3, v3, v4
    s_add_u32 s40, s42, 3
    v_xor_b32 v3, s40, v3
    v_lshlrev_b32 v3, 5, v3
    v_lshl_add_u32 v3, v7, 3, v3
    v_lshl_add_u32 v4, v5, 3, v6
    v_lshl_add_u32 v3, v4, 7, v3
    v_add_u32 v13, s43, v3
    s_mul_i32 s42, s45, 32
    v_lshrrev_b32 v3, 1, v8
    v_xor_b32 v3, v3, v5
    v_lshlrev_b32 v3, 4, v3
    v_lshl_add_u32 v3, v8, 7, v3
    s_lshl_b32 s40, s42, 7
    s_add_u32 s40, s40, 8192
    v_add_u32 v14, s40, v3
    v_xor_b32 v15, 64, v14
    v_mov_b32 v84, 0
    v_mov_b32 v85, 0
    v_mov_b32 v86, 0
    v_mov_b32 v87, 0
    v_mov_b32 v88, 0
    v_mov_b32 v89, 0
    v_mov_b32 v90, 0
    v_mov_b32 v91, 0
    v_mov_b32 v92, 0
    v_mov_b32 v93, 0
    v_mov_b32 v94, 0
    v_mov_b32 v95, 0
    v_mov_b32 v96, 0
    v_mov_b32 v97, 0
    v_mov_b32 v98, 0
    v_mov_b32 v99, 0
    v_mov_b32 v100, 0
    v_mov_b32 v101, 0
    v_mov_b32 v102, 0
    v_mov_b32 v103, 0
    v_mov_b32 v104, 0
    v_mov_b32 v105, 0
    v_mov_b32 v106, 0
    v_mov_b32 v107, 0
    s_mov_b32 s48, 16
    s_mov_b32 s50, 0
    s_mov_b32 s51, 24576
    s_mov_b32 s29, 0xfffee000
    v_mov_b32 v28, 0
    v_mov_b32 v29, 0
    v_mov_b32 v30, 0
    v_mov_b32 v31, 0
    v_mov_b32 v32, 0
    v_mov_b32 v33, 0
    v_mov_b32 v34, 0
    v_mov_b32 v35, 0
    v_mov_b32 v36, 0
    v_mov_b32 v37, 0
    v_mov_b32 v38, 0
    v_mov_b32 v39, 0
    v_mov_b32 v40, 0
    v_mov_b32 v41, 0
    v_mov_b32 v42, 0
    v_mov_b32 v43, 0
    v_mov_b32 v44, 0
    v_mov_b32 v45, 0
    v_mov_b32 v46, 0
    v_mov_b32 v47, 0
    v_mov_b32 v48, 0
    v_mov_b32 v49, 0
    v_mov_b32 v50, 0
    v_mov_b32 v51, 0
    v_mov_b32 v52, 0
    v_mov_b32 v53, 0
    v_mov_b32 v54, 0
    v_mov_b32 v55, 0
    v_mov_b32 v56, 0
    v_mov_b32 v57, 0
    v_mov_b32 v58, 0
    v_mov_b32 v59, 0
    s_barrier
    buffer_load_dwordx4 v[124:127], v9, s[20:23], s52 offen offset:0 sc1
    buffer_load_dwordx4 v[128:131], v9, s[20:23], s52 offen offset:64 sc1
    buffer_load_dwordx4 v[132:135], v9, s[20:23], s53 offen offset:0 sc1
    buffer_load_dwordx4 v[136:139], v9, s[20:23], s53 offen offset:64 sc1
    s_branch g2_cloop2
g2_mid:
    s_waitcnt vmcnt(0)
    s_nop 7
    v_permlane16_swap_b32 v124, v126
    v_permlane16_swap_b32 v125, v127
    v_permlane16_swap_b32 v128, v130
    v_permlane16_swap_b32 v129, v131
    v_permlane16_swap_b32 v132, v134
    v_permlane16_swap_b32 v133, v135
    v_permlane16_swap_b32 v136, v138
    v_permlane16_swap_b32 v137, v139
    v_lshlrev_b32 v140, 16, v124
    v_and_b32 v141, 0xffff0000, v124
    v_lshlrev_b32 v142, 16, v125
    v_and_b32 v143, 0xffff0000, v125
    v_lshlrev_b32 v144, 16, v126
    v_and_b32 v145, 0xffff0000, v126
    v_lshlrev_b32 v146, 16, v127
    v_and_b32 v147, 0xffff0000, v127
    v_pk_add_f32 v[28:29], v[28:29], v[140:141]
    v_pk_add_f32 v[30:31], v[30:31], v[142:143]
    v_pk_add_f32 v[36:37], v[36:37], v[144:145]
    v_pk_add_f32 v[38:39], v[38:39], v[146:147]
    v_lshlrev_b32 v140, 16, v128
    v_and_b32 v141, 0xffff0000, v128
    v_lshlrev_b32 v142, 16, v129
    v_and_b32 v143, 0xffff0000, v129
    v_lshlrev_b32 v144, 16, v130
    v_and_b32 v145, 0xffff0000, v130
    v_lshlrev_b32 v146, 16, v131
    v_and_b32 v147, 0xffff0000, v131
    v_pk_add_f32 v[44:45], v[44:45], v[140:141]
    v_pk_add_f32 v[46:47], v[46:47], v[142:143]
    v_pk_add_f32 v[52:53], v[52:53], v[144:145]
    v_pk_add_f32 v[54:55], v[54:55], v[146:147]
    v_lshlrev_b32 v140, 16, v132
    v_and_b32 v141, 0xffff0000, v132
    v_lshlrev_b32 v142, 16, v133
    v_and_b32 v143, 0xffff0000, v133
    v_lshlrev_b32 v144, 16, v134
    v_and_b32 v145, 0xffff0000, v134
    v_lshlrev_b32 v146, 16, v135
    v_and_b32 v147, 0xffff0000, v135
    v_pk_add_f32 v[32:33], v[32:33], v[140:141]
    v_pk_add_f32 v[34:35], v[34:35], v[142:143]
    v_pk_add_f32 v[40:41], v[40:41], v[144:145]
    v_pk_add_f32 v[42:43], v[42:43], v[146:147]
    v_lshlrev_b32 v140, 16, v136
    v_and_b32 v141, 0xffff0000, v136
    v_lshlrev_b32 v142, 16, v137
    v_and_b32 v143, 0xffff0000, v137
    v_lshlrev_b32 v144, 16, v138
    v_and_b32 v145, 0xffff0000, v138
    v_lshlrev_b32 v146, 16, v139
    v_and_b32 v147, 0xffff0000, v139
    v_pk_add_f32 v[48:49], v[48:49], v[140:141]
    v_pk_add_f32 v[50:51], v[50:51], v[142:143]
    v_pk_add_f32 v[56:57], v[56:57], v[144:145]
    v_pk_add_f32 v[58:59], v[58:59], v[146:147]
    s_nop 1
    s_branch g2_cloop2
.p2align 3
g2_cloop:
    s_barrier
    s_cmp_eq_u32 s48, 8
    s_cbranch_scc1 g2_mid
g2_cloop2:
    v_mfma_f32_16x16x32_bf16 v[28:31], v[84:87], v[100:103], v[28:31]
    ds_read_b64_tr_b16 v[60:61], v10 offset:0
    ds_read_b64_tr_b16 v[62:63], v10 offset:512
    v_mfma_f32_16x16x32_bf16 v[32:35], v[84:87], v[104:107], v[32:35]
    ds_read_b128 v[76:79], v14 offset:0
    v_mfma_f32_16x16x32_bf16 v[36:39], v[88:91], v[100:103], v[36:39]
    ds_read_b128 v[80:83], v14 offset:2048
    v_mfma_f32_16x16x32_bf16 v[40:43], v[88:91], v[104:107], v[40:43]
    ds_read_b64_tr_b16 v[64:65], v11 offset:0
    ds_read_b64_tr_b16 v[66:67], v11 offset:512
    v_mfma_f32_16x16x32_bf16 v[44:47], v[92:95], v[100:103], v[44:47]
    ds_read_b64_tr_b16 v[68:69], v12 offset:0
    ds_read_b64_tr_b16 v[70:71], v12 offset:512
    v_mfma_f32_16x16x32_bf16 v[48:51], v[92:95], v[104:107], v[48:51]
    ds_read_b64_tr_b16 v[72:73], v13 offset:0
    ds_read_b64_tr_b16 v[74:75], v13 offset:512
    v_mfma_f32_16x16x32_bf16 v[52:55], v[96:99], v[100:103], v[52:55]
    v_mfma_f32_16x16x32_bf16 v[56:59], v[96:99], v[104:107], v[56:59]
    s_waitcnt lgkmcnt(0)
    v_mfma_f32_16x16x32_bf16 v[28:31], v[60:63], v[76:79], v[28:31]
    ds_read_b64_tr_b16 v[84:85], v10 offset:4096
    ds_read_b64_tr_b16 v[86:87], v10 offset:4608
    v_mfma_f32_16x16x32_bf16 v[32:35], v[60:63], v[80:83], v[32:35]
    ds_read_b128 v[100:103], v15 offset:0
    v_mfma_f32_16x16x32_bf16 v[36:39], v[64:67], v[76:79], v[36:39]
    ds_read_b128 v[104:107], v15 offset:2048
    v_mfma_f32_16x16x32_bf16 v[40:43], v[64:67], v[80:83], v[40:43]
    ds_read_b64_tr_b16 v[88:89], v11 offset:4096
    ds_read_b64_tr_b16 v[90:91], v11 offset:4608
    v_mfma_f32_16x16x32_bf16 v[44:47], v[68:71], v[76:79], v[44:47]
    ds_read_b64_tr_b16 v[92:93], v12 offset:4096
    ds_read_b64_tr_b16 v[94:95], v12 offset:4608
    v_mfma_f32_16x16x32_bf16 v[48:51], v[68:71], v[80:83], v[48:51]
    ds_read_b64_tr_b16 v[96:97], v13 offset:4096
    ds_read_b64_tr_b16 v[98:99], v13 offset:4608
    v_mfma_f32_16x16x32_bf16 v[52:55], v[72:75], v[76:79], v[52:55]
    s_add_u32 s50, s50, 1
    s_cmp_eq_u32 s50, 4
    v_mfma_f32_16x16x32_bf16 v[56:59], v[72:75], v[80:83], v[56:59]
    s_cselect_b32 s49, s29, s51
    s_cselect_b32 s50, 0, s50
    v_add_u32 v10, s49, v10
    v_add_u32 v11, s49, v11
    v_add_u32 v12, s49, v12
    v_add_u32 v13, s49, v13
    v_add_u32 v14, s49, v14
    v_add_u32 v15, s49, v15
    s_sub_u32 s48, s48, 1
    s_cmp_lg_u32 s48, 0
    s_waitcnt lgkmcnt(0)
    s_cbranch_scc1 g2_cloop
    v_mfma_f32_16x16x32_bf16 v[28:31], v[84:87], v[100:103], v[28:31]
    v_mfma_f32_16x16x32_bf16 v[32:35], v[84:87], v[104:107], v[32:35]
    v_mfma_f32_16x16x32_bf16 v[36:39], v[88:91], v[100:103], v[36:39]
    v_mfma_f32_16x16x32_bf16 v[40:43], v[88:91], v[104:107], v[40:43]
    v_mfma_f32_16x16x32_bf16 v[44:47], v[92:95], v[100:103], v[44:47]
    v_mfma_f32_16x16x32_bf16 v[48:51], v[92:95], v[104:107], v[48:51]
    v_mfma_f32_16x16x32_bf16 v[52:55], v[96:99], v[100:103], v[52:55]
    v_mfma_f32_16x16x32_bf16 v[56:59], v[96:99], v[104:107], v[56:59]
    s_nop 7
    v_pk_add_f32 v[76:77], v[28:29], v[30:31]
    v_pk_mul_f32 v[78:79], v[28:29], v[28:29]
    v_pk_fma_f32 v[78:79], v[30:31], v[30:31], v[78:79]
    v_pk_add_f32 v[76:77], v[76:77], v[36:37]
    v_pk_fma_f32 v[78:79], v[36:37], v[36:37], v[78:79]
    v_pk_add_f32 v[76:77], v[76:77], v[38:39]
    v_pk_fma_f32 v[78:79], v[38:39], v[38:39], v[78:79]
    v_pk_add_f32 v[76:77], v[76:77], v[44:45]
    v_pk_fma_f32 v[78:79], v[44:45], v[44:45], v[78:79]
    v_pk_add_f32 v[76:77], v[76:77], v[46:47]
    v_pk_fma_f32 v[78:79], v[46:47], v[46:47], v[78:79]
    v_pk_add_f32 v[76:77], v[76:77], v[52:53]
    v_pk_fma_f32 v[78:79], v[52:53], v[52:53], v[78:79]
    v_pk_add_f32 v[76:77], v[76:77], v[54:55]
    v_pk_fma_f32 v[78:79], v[54:55], v[54:55], v[78:79]
    v_pk_add_f32 v[80:81], v[32:33], v[34:35]
    v_pk_mul_f32 v[82:83], v[32:33], v[32:33]
    v_pk_fma_f32 v[82:83], v[34:35], v[34:35], v[82:83]
    v_pk_add_f32 v[80:81], v[80:81], v[40:41]
    v_pk_fma_f32 v[82:83], v[40:41], v[40:41], v[82:83]
    v_pk_add_f32 v[80:81], v[80:81], v[42:43]
    v_pk_fma_f32 v[82:83], v[42:43], v[42:43], v[82:83]
    v_pk_add_f32 v[80:81], v[80:81], v[48:49]
    v_pk_fma_f32 v[82:83], v[48:49], v[48:49], v[82:83]
    v_pk_add_f32 v[80:81], v[80:81], v[50:51]
    v_pk_fma_f32 v[82:83], v[50:51], v[50:51], v[82:83]
    v_pk_add_f32 v[80:81], v[80:81], v[56:57]
    v_pk_fma_f32 v[82:83], v[56:57], v[56:57], v[82:83]
    v_pk_add_f32 v[80:81], v[80:81], v[58:59]
    v_pk_fma_f32 v[82:83], v[58:59], v[58:59], v[82:83]
    v_add_f32 v76, v76, v77
    v_add_f32 v77, v78, v79
    v_add_f32 v80, v80, v81
    v_add_f32 v81, v82, v83
    s_nop 1
    v_permlane16_swap_b32 v76, v80
    v_permlane16_swap_b32 v77, v81
    v_pk_add_f32 v[76:77], v[76:77], v[80:81]
    v_mov_b32 v84, v76
    v_mov_b32 v85, v77
    v_and_b32 v3, 16, v2
    v_add_u32 v3, v3, v20
    v_permlane32_swap_b32 v76, v84
    v_permlane32_swap_b32 v77, v85
    v_pk_add_f32 v[76:77], v[76:77], v[84:85]
    v_lshlrev_b32 v3, 3, v3
    s_mul_i32 s40, s24, 1
    s_add_u32 s40, s40, s44
    s_lshl_b32 s40, s40, 14
    s_mov_b32 exec_hi, 0
    buffer_store_dwordx2 v[76:77], v3, s[60:63], s40 offen sc1
    s_mov_b32 exec_hi, -1
    v_lshrrev_b32 v4, 5, v2
    v_lshl_add_u32 v21, v4, 17, v3
    v_cvt_pk_bf16_f32 v60, v28, v29
    v_cvt_pk_bf16_f32 v61, v30, v31
    v_cvt_pk_bf16_f32 v62, v36, v37
    v_cvt_pk_bf16_f32 v63, v38, v39
    v_lshlrev_b32 v28, 16, v60
    v_and_b32 v29, 0xffff0000, v60
    v_lshlrev_b32 v30, 16, v61
    v_and_b32 v31, 0xffff0000, v61
    v_lshlrev_b32 v36, 16, v62
    v_and_b32 v37, 0xffff0000, v62
    v_lshlrev_b32 v38, 16, v63
    v_and_b32 v39, 0xffff0000, v63
    v_permlane16_swap_b32 v60, v62
    v_permlane16_swap_b32 v61, v63
    buffer_store_dwordx4 v[60:63], v9, s[16:19], s52 offen offset:0 sc1
    v_cvt_pk_bf16_f32 v64, v44, v45
    v_cvt_pk_bf16_f32 v65, v46, v47
    v_cvt_pk_bf16_f32 v66, v52, v53
    v_cvt_pk_bf16_f32 v67, v54, v55
    v_lshlrev_b32 v44, 16, v64
    v_and_b32 v45, 0xffff0000, v64
    v_lshlrev_b32 v46, 16, v65
    v_and_b32 v47, 0xffff0000, v65
    v_lshlrev_b32 v52, 16, v66
    v_and_b32 v53, 0xffff0000, v66
    v_lshlrev_b32 v54, 16, v67
    v_and_b32 v55, 0xffff0000, v67
    v_permlane16_swap_b32 v64, v66
    v_permlane16_swap_b32 v65, v67
    buffer_store_dwordx4 v[64:67], v9, s[16:19], s52 offen offset:64 sc1
    v_cvt_pk_bf16_f32 v68, v32, v33
    v_cvt_pk_bf16_f32 v69, v34, v35
    v_cvt_pk_bf16_f32 v70, v40, v41
    v_cvt_pk_bf16_f32 v71, v42, v43
    v_lshlrev_b32 v32, 16, v68
    v_and_b32 v33, 0xffff0000, v68
    v_lshlrev_b32 v34, 16, v69
    v_and_b32 v35, 0xffff0000, v69
    v_lshlrev_b32 v40, 16, v70
    v_and_b32 v41, 0xffff0000, v70
    v_lshlrev_b32 v42, 16, v71
    v_and_b32 v43, 0xffff0000, v71
    v_permlane16_swap_b32 v68, v70
    v_permlane16_swap_b32 v69, v71
    buffer_store_dwordx4 v[68:71], v9, s[16:19], s53 offen offset:0 sc1
    v_cvt_pk_bf16_f32 v72, v48, v49
    v_cvt_pk_bf16_f32 v73, v50, v51
    v_cvt_pk_bf16_f32 v74, v56, v57
    v_cvt_pk_bf16_f32 v75, v58, v59
    v_lshlrev_b32 v48, 16, v72
    v_and_b32 v49, 0xffff0000, v72
    v_lshlrev_b32 v50, 16, v73
    v_and_b32 v51, 0xffff0000, v73
    v_lshlrev_b32 v56, 16, v74
    v_and_b32 v57, 0xffff0000, v74
    v_lshlrev_b32 v58, 16, v75
    v_and_b32 v59, 0xffff0000, v75
    v_permlane16_swap_b32 v72, v74
    v_permlane16_swap_b32 v73, v75
    buffer_store_dwordx4 v[72:75], v9, s[16:19], s53 offen offset:64 sc1
    s_mov_b32 s48, 0x2000
    v_mul_u32_u24 v19, 256, v20
    v_add_u32 v19, v19, v9
    s_mov_b32 s54, 0
    s_mov_b32 s55, 36864
    s_mov_b32 s40, 0
    buffer_load_dwordx2 v[108:109], v21, s[60:63], s40 offen sc1
    s_mov_b32 s41, 16384
    buffer_load_dwordx2 v[110:111], v21, s[60:63], s41 offen sc1
    s_mov_b32 s40, 32768
    buffer_load_dwordx2 v[112:113], v21, s[60:63], s40 offen sc1
    s_mov_b32 s41, 49152
    buffer_load_dwordx2 v[114:115], v21, s[60:63], s41 offen sc1
    s_mov_b32 s40, 65536
    buffer_load_dwordx2 v[116:117], v21, s[60:63], s40 offen sc1
    s_mov_b32 s41, 81920
    buffer_load_dwordx2 v[118:119], v21, s[60:63], s41 offen sc1
    s_mov_b32 s40, 98304
    buffer_load_dwordx2 v[120:121], v21, s[60:63], s40 offen sc1
    s_mov_b32 s41, 114688
    buffer_load_dwordx2 v[122:123], v21, s[60:63], s41 offen sc1
    s_waitcnt vmcnt(0)
g2_ex:
    v_max3_u32 v4, v108, v109, v110
    v_max3_u32 v4, v4, v111, v112
    v_max3_u32 v4, v4, v113, v114
    v_max3_u32 v4, v4, v115, v116
    v_max3_u32 v4, v4, v117, v118
    v_max3_u32 v4, v4, v119, v120
    v_max3_u32 v4, v4, v121, v122
    v_max_u32 v4, v4, v123
    v_cmp_eq_u32 vcc, -1, v4
    s_sub_u32 s48, s48, 1
    s_cmp_eq_u32 s48, 0
    s_cbranch_scc1 g2_exd
    s_cbranch_vccz g2_exd
    s_sleep 2
    s_mov_b32 s40, 0
    buffer_load_dwordx2 v[108:109], v21, s[60:63], s40 offen sc1
    s_mov_b32 s41, 16384
    buffer_load_dwordx2 v[110:111], v21, s[60:63], s41 offen sc1
    s_mov_b32 s40, 32768
    buffer_load_dwordx2 v[112:113], v21, s[60:63], s40 offen sc1
    s_mov_b32 s41, 49152
    buffer_load_dwordx2 v[114:115], v21, s[60:63], s41 offen sc1
    s_mov_b32 s40, 65536
    buffer_load_dwordx2 v[116:117], v21, s[60:63], s40 offen sc1
    s_mov_b32 s41, 81920
    buffer_load_dwordx2 v[118:119], v21, s[60:63], s41 offen sc1
    s_mov_b32 s40, 98304
    buffer_load_dwordx2 v[120:121], v21, s[60:63], s40 offen sc1
    s_mov_b32 s41, 114688
    buffer_load_dwordx2 v[122:123], v21, s[60:63], s41 offen sc1
    s_waitcnt vmcnt(0)
    s_branch g2_ex
g2_exd:
    v_pk_add_f32 v[108:109], v[108:109], v[116:117]
    v_pk_add_f32 v[110:111], v[110:111], v[118:119]
    v_pk_add_f32 v[112:113], v[112:113], v[120:121]
    v_pk_add_f32 v[114:115], v[114:115], v[122:123]
    v_pk_add_f32 v[108:109], v[108:109], v[112:113]
    v_pk_add_f32 v[110:111], v[110:111], v[114:115]
    v_pk_add_f32 v[108:109], v[108:109], v[110:111]
    v_mov_b32 v110, v108
    v_mov_b32 v111, v109
    s_nop 1
    v_permlane32_swap_b32 v108, v110
    v_permlane32_swap_b32 v109, v111
    v_pk_add_f32 v[108:109], v[108:109], v[110:111]
    v_mul_f32 v108, 0x3a800000, v108
    v_mul_f32 v109, 0x3a800000, v109
    v_fma_f32 v109, -v108, v108, v109
    v_max_f32 v109, 0, v109
    v_mov_b32 v110, v108
    v_mov_b32 v111, v109
    v_cvt_pk_bf16_f32 v110, v110, v110
    v_lshlrev_b32 v110, 16, v110
    v_cvt_pk_bf16_f32 v111, v111, v111
    v_lshlrev_b32 v111, 16, v111
    v_add_f32 v111, 0x3727c5ac, v111
    v_cvt_pk_bf16_f32 v111, v111, v111
    v_lshlrev_b32 v111, 16, v111
    v_sqrt_f32 v111, v111
    s_nop 0
    v_cvt_pk_bf16_f32 v111, v111, v111
    v_lshlrev_b32 v111, 16, v111
    v_rcp_f32 v111, v111
    v_sub_f32 v112, v108, v110
    v_mul_f32 v113, v109, v111
    v_mul_f32 v112, v112, v111
    v_mul_f32 v113, v113, v111
    v_cvt_pk_bf16_f32 v112, v112, v112
    v_lshlrev_b32 v112, 16, v112
    v_cvt_pk_bf16_f32 v113, v113, v113
    v_lshlrev_b32 v113, 16, v113
    v_add_f32 v113, 0x3727c5ac, v113
    v_cvt_pk_bf16_f32 v113, v113, v113
    v_lshlrev_b32 v113, 16, v113
    v_sqrt_f32 v113, v113
    s_nop 0
    v_cvt_pk_bf16_f32 v113, v113, v113
    v_lshlrev_b32 v113, 16, v113
    v_rcp_f32 v113, v113
    v_fma_f32 v112, v110, v111, v112
    v_mul_f32 v114, v111, v113
    v_mul_f32 v115, -v112, v113
    v_mov_b32 v116, v114
    v_mov_b32 v117, v115
    s_nop 1
    v_permlane16_swap_b32 v114, v116
    v_permlane16_swap_b32 v115, v117
    v_pk_fma_f32 v[28:29], v[28:29], v[114:115], v[114:115] op_sel:[0,0,1] op_sel_hi:[1,0,1]
    v_pk_fma_f32 v[30:31], v[30:31], v[114:115], v[114:115] op_sel:[0,0,1] op_sel_hi:[1,0,1]
    v_pk_fma_f32 v[36:37], v[36:37], v[114:115], v[114:115] op_sel:[0,0,1] op_sel_hi:[1,0,1]
    v_pk_fma_f32 v[38:39], v[38:39], v[114:115], v[114:115] op_sel:[0,0,1] op_sel_hi:[1,0,1]
    v_cvt_pk_bf16_f32 v60, v28, v29
    v_cvt_pk_bf16_f32 v61, v30, v31
    v_cvt_pk_bf16_f32 v62, v36, v37
    v_cvt_pk_bf16_f32 v63, v38, v39
    s_nop 1
    v_permlane16_swap_b32 v60, v62
    v_permlane16_swap_b32 v61, v63
    buffer_store_dwordx4 v[60:63], v19, s[56:59], s54 offen offset:0 sc1
    v_pk_fma_f32 v[44:45], v[44:45], v[114:115], v[114:115] op_sel:[0,0,1] op_sel_hi:[1,0,1]
    v_pk_fma_f32 v[46:47], v[46:47], v[114:115], v[114:115] op_sel:[0,0,1] op_sel_hi:[1,0,1]
    v_pk_fma_f32 v[52:53], v[52:53], v[114:115], v[114:115] op_sel:[0,0,1] op_sel_hi:[1,0,1]
    v_pk_fma_f32 v[54:55], v[54:55], v[114:115], v[114:115] op_sel:[0,0,1] op_sel_hi:[1,0,1]
    v_cvt_pk_bf16_f32 v64, v44, v45
    v_cvt_pk_bf16_f32 v65, v46, v47
    v_cvt_pk_bf16_f32 v66, v52, v53
    v_cvt_pk_bf16_f32 v67, v54, v55
    s_nop 1
    v_permlane16_swap_b32 v64, v66
    v_permlane16_swap_b32 v65, v67
    buffer_store_dwordx4 v[64:67], v19, s[56:59], s54 offen offset:64 sc1
    v_pk_fma_f32 v[32:33], v[32:33], v[116:117], v[116:117] op_sel:[0,0,1] op_sel_hi:[1,0,1]
    v_pk_fma_f32 v[34:35], v[34:35], v[116:117], v[116:117] op_sel:[0,0,1] op_sel_hi:[1,0,1]
    v_pk_fma_f32 v[40:41], v[40:41], v[116:117], v[116:117] op_sel:[0,0,1] op_sel_hi:[1,0,1]
    v_pk_fma_f32 v[42:43], v[42:43], v[116:117], v[116:117] op_sel:[0,0,1] op_sel_hi:[1,0,1]
    v_cvt_pk_bf16_f32 v68, v32, v33
    v_cvt_pk_bf16_f32 v69, v34, v35
    v_cvt_pk_bf16_f32 v70, v40, v41
    v_cvt_pk_bf16_f32 v71, v42, v43
    s_nop 1
    v_permlane16_swap_b32 v68, v70
    v_permlane16_swap_b32 v69, v71
    buffer_store_dwordx4 v[68:71], v19, s[56:59], s55 offen offset:0 sc1
    v_pk_fma_f32 v[48:49], v[48:49], v[116:117], v[116:117] op_sel:[0,0,1] op_sel_hi:[1,0,1]
    v_pk_fma_f32 v[50:51], v[50:51], v[116:117], v[116:117] op_sel:[0,0,1] op_sel_hi:[1,0,1]
    v_pk_fma_f32 v[56:57], v[56:57], v[116:117], v[116:117] op_sel:[0,0,1] op_sel_hi:[1,0,1]
    v_pk_fma_f32 v[58:59], v[58:59], v[116:117], v[116:117] op_sel:[0,0,1] op_sel_hi:[1,0,1]
    v_cvt_pk_bf16_f32 v72, v48, v49
    v_cvt_pk_bf16_f32 v73, v50, v51
    v_cvt_pk_bf16_f32 v74, v56, v57
    v_cvt_pk_bf16_f32 v75, v58, v59
    s_nop 1
    v_permlane16_swap_b32 v72, v74
    v_permlane16_swap_b32 v73, v75
    buffer_store_dwordx4 v[72:75], v19, s[56:59], s55 offen offset:64 sc1
    s_lshr_b32 s40, s24, 1
    s_add_u32 s40, s40, 16
    s_lshl_b32 s40, s40, 8
    s_mov_b32 s42, s40
    s_add_u32 s84, s4, 0x300000
    s_addc_u32 s85, s5, 0
    s_mov_b32 s86, 0x4000
    s_mov_b32 s87, 0x20000
    v_mov_b32 v3, s40
    v_mov_b32 v4, 1
    s_waitcnt vmcnt(0)
    s_barrier
    s_cmp_lg_u32 s28, 0
    s_cbranch_scc1 g2_cin
    s_mov_b64 exec, 1
    buffer_atomic_add v4, v3, s[84:87], 0 offen sc1
    s_mov_b64 exec, -1
g2_cin:
    s_branch g3_in
.p2align 6
g3_in:
    s_cmp_ge_u32 s2, 224
    s_cbranch_scc1 g3_spare
    s_load_dwordx2 s[4:5], s[0:1], 80
    s_load_dwordx2 s[30:31], s[0:1], 32
    s_load_dwordx2 s[6:7], s[0:1], 40
    v_lshrrev_b32 v1, 6, v0
    v_and_b32 v2, 63, v0
    s_and_b32 s40, s2, 1
    s_lshl_b32 s40, s40, 2
    s_bfe_u32 s41, s2, 0x20003
    s_add_u32 s25, s40, s41
    s_bfe_u32 s40, s2, 0x20001
    s_mul_i32 s40, s40, 7
    s_lshr_b32 s42, s2, 5
    s_add_u32 s24, s40, s42
    s_add_u32 s27, s41, s42
    s_mov_b32 s26, 0
    s_cmp_eq_u32 s96, 0
    s_cselect_b32 s95, 3, 1
    v_readfirstlane_b32 s28, v1
    s_nop 0
    s_cmp_lt_u32 s28, 4
    s_cbranch_scc1 g3_compute
    s_sub_u32 s28, s28, 4
    s_mov_b32 s40, 7168
    v_lshrrev_b32 v4, 4, v2
    v_mul_lo_u32 v3, v4, s40
    v_lshlrev_b32 v4, 1, v4
    v_xor_b32 v4, v4, v2
    v_and_b32 v4, 15, v4
    v_lshl_add_u32 v3, v4, 4, v3
    s_mul_i32 s41, s24, 256
    s_mul_i32 s42, s28, 114688
    s_add_u32 s41, s41, s42
    v_xor_b32 v4, 128, v3
    s_add_u32 s42, s41, 0
    v_add_u32 v10, s42, v3
    s_add_u32 s42, s41, 28672
    v_add_u32 v11, s42, v3
    s_add_u32 s42, s41, 57344
    v_add_u32 v12, s42, v4
    s_add_u32 s42, s41, 86016
    v_add_u32 v13, s42, v4
    s_mov_b32 s40, 2304
    v_lshrrev_b32 v4, 4, v2
    v_mul_lo_u32 v3, v4, s40
    v_lshlrev_b32 v4, 1, v4
    v_xor_b32 v4, v4, v2
    v_and_b32 v4, 15, v4
    v_lshl_add_u32 v3, v4, 4, v3
    s_mul_i32 s41, s25, 256
    s_mul_i32 s42, s28, 36864
    s_add_u32 s41, s41, s42
    v_xor_b32 v4, 128, v3
    s_add_u32 s42, s41, 0
    v_add_u32 v14, s42, v3
    s_add_u32 s42, s41, 9216
    v_add_u32 v15, s42, v3
    s_add_u32 s42, s41, 18432
    v_add_u32 v16, s42, v4
    s_add_u32 s42, s41, 27648
    v_add_u32 v17, s42, v4
    s_mul_i32 s36, s28, 4096
    s_mul_i32 s37, s28, 4096
    s_add_u32 s37, s37, 16384
    s_waitcnt lgkmcnt(0)
    s_add_u32 s4, s4, s97
    s_addc_u32 s5, s5, 0
    s_mov_b32 s8, s30
    s_mov_b32 s9, s31
    s_mov_b32 s10, 0xe00000
    s_mov_b32 s11, 0x20000
    s_add_u32 s12, s4, 0xc00000
    s_addc_u32 s13, s5, 0
    s_mov_b32 s14, 0x480000
    s_mov_b32 s15, 0x20000
    s_mov_b32 s32, 0
    s_mov_b32 s33, 0
g3_ld_pW:
    s_add_u32 s40, s32, s27
    s_and_b32 s40, s40, s95
    s_andn2_b32 s41, s32, s95
    s_or_b32 s40, s40, s41
    s_add_u32 s40, s40, s26
    s_mul_i32 s34, s40, 458752
    s_mul_i32 s35, s40, 147456
    s_add_u32 s38, s33, s36
    s_add_u32 s39, s33, s37
    s_add_u32 m0, s38, 0
    s_nop 0
    buffer_load_dwordx4 v10, s[8:11], s34 offen lds
    s_add_u32 m0, s38, 1024
    s_nop 0
    buffer_load_dwordx4 v11, s[8:11], s34 offen lds
    s_add_u32 m0, s38, 2048
    s_nop 0
    buffer_load_dwordx4 v12, s[8:11], s34 offen lds
    s_add_u32 m0, s38, 3072
    s_nop 0
    buffer_load_dwordx4 v13, s[8:11], s34 offen lds
    s_add_u32 s33, s33, 32768
    s_add_u32 s32, s32, 1
    s_cmp_lt_u32 s32, 3
    s_cbranch_scc1 g3_ld_pW
    s_lshr_b32 s40, s25, 0
    s_add_u32 s40, s40, 16
    s_lshl_b32 s40, s40, 8
    s_mov_b32 s42, s40
    s_lshl_b32 s43, s96, 2
    s_add_u32 s43, s43, 3
    s_mov_b32 s41, 0x80000
    v_mov_b32 v24, 131072
    s_cmp_lg_u32 s28, 0
    s_cbranch_scc1 g3_dep_lds
    s_mov_b32 s41, 0x8000
    s_add_u32 s84, s4, 0x300000
    s_addc_u32 s85, s5, 0
    s_mov_b32 s86, 0x4000
    s_mov_b32 s87, 0x20000
    v_cmp_eq_u32 vcc, 1, v2
    v_mov_b32 v21, s40
    v_mov_b32 v23, s42
    v_cndmask_b32 v21, v21, v23, vcc
    v_mov_b32 v22, 32
    v_mov_b32 v23, 32
    v_cndmask_b32 v22, v22, v23, vcc
g3_dep:
    buffer_load_dword v23, v21, s[84:87], 0 offen sc1
    s_sub_u32 s41, s41, 1
    s_waitcnt vmcnt(0)
    v_cmp_lt_u32 vcc, v23, v22
    s_cmp_eq_u32 s41, 0
    s_cbranch_scc1 g3_dep_seen
    s_cbranch_vccz g3_dep_seen
    s_sleep 2
    s_branch g3_dep
g3_dep_seen:
    v_mov_b32 v23, s43
    ds_write_b32 v24, v23
    s_branch g3_dep_ok
g3_dep_lds:
    ds_read_b32 v23, v24
    s_sub_u32 s41, s41, 1
    s_waitcnt lgkmcnt(0)
    v_readfirstlane_b32 s40, v23
    s_cmp_eq_u32 s41, 0
    s_cbranch_scc1 g3_dep_ok
    s_cmp_eq_u32 s40, s43
    s_cbranch_scc1 g3_dep_ok
    s_sleep 1
    s_branch g3_dep_lds
g3_dep_ok:
    s_mov_b32 s32, 0
    s_mov_b32 s33, 0
g3_ld_pA:
    s_add_u32 s40, s32, s27
    s_and_b32 s40, s40, s95
    s_andn2_b32 s41, s32, s95
    s_or_b32 s40, s40, s41
    s_add_u32 s40, s40, s26
    s_mul_i32 s34, s40, 458752
    s_mul_i32 s35, s40, 147456
    s_add_u32 s38, s33, s36
    s_add_u32 s39, s33, s37
    s_add_u32 m0, s39, 0
    s_nop 0
    buffer_load_dwordx4 v14, s[12:15], s35 offen sc1 lds
    s_add_u32 m0, s39, 1024
    s_nop 0
    buffer_load_dwordx4 v15, s[12:15], s35 offen sc1 lds
    s_add_u32 m0, s39, 2048
    s_nop 0
    buffer_load_dwordx4 v16, s[12:15], s35 offen sc1 lds
    s_add_u32 m0, s39, 3072
    s_nop 0
    buffer_load_dwordx4 v17, s[12:15], s35 offen sc1 lds
    s_add_u32 s33, s33, 32768
    s_add_u32 s32, s32, 1
    s_cmp_lt_u32 s32, 3
    s_cbranch_scc1 g3_ld_pA
    s_waitcnt vmcnt(8)
    s_branch g3_ld_bar
g3_ld_loop:
    s_cmp_eq_u32 s32, 4
    s_cbranch_scc1 g3_ld_s4
    s_waitcnt vmcnt(16)
g3_ld_bar:
    s_barrier
    s_add_u32 s40, s32, s27
    s_and_b32 s40, s40, s95
    s_andn2_b32 s41, s32, s95
    s_or_b32 s40, s40, s41
    s_add_u32 s40, s40, s26
    s_mul_i32 s34, s40, 458752
    s_mul_i32 s35, s40, 147456
    s_add_u32 s38, s33, s36
    s_add_u32 s39, s33, s37
    s_add_u32 m0, s38, 0
    s_nop 0
    buffer_load_dwordx4 v10, s[8:11], s34 offen lds
    s_add_u32 m0, s38, 1024
    s_nop 0
    buffer_load_dwordx4 v11, s[8:11], s34 offen lds
    s_add_u32 m0, s38, 2048
    s_nop 0
    buffer_load_dwordx4 v12, s[8:11], s34 offen lds
    s_add_u32 m0, s38, 3072
    s_nop 0
    buffer_load_dwordx4 v13, s[8:11], s34 offen lds
    s_add_u32 m0, s39, 0
    s_nop 0
    buffer_load_dwordx4 v14, s[12:15], s35 offen sc1 lds
    s_add_u32 m0, s39, 1024
    s_nop 0
    buffer_load_dwordx4 v15, s[12:15], s35 offen sc1 lds
    s_add_u32 m0, s39, 2048
    s_nop 0
    buffer_load_dwordx4 v16, s[12:15], s35 offen sc1 lds
    s_add_u32 m0, s39, 3072
    s_nop 0
    buffer_load_dwordx4 v17, s[12:15], s35 offen sc1 lds
    s_add_u32 s33, s33, 32768
    s_add_u32 s32, s32, 1
    s_cmp_eq_u32 s33, 131072
    s_cselect_b32 s33, 0, s33
    s_cmp_lt_u32 s32, 32
    s_cbranch_scc1 g3_ld_loop
    s_waitcnt vmcnt(16)
    s_barrier
    s_waitcnt vmcnt(8)
    s_barrier
    s_waitcnt vmcnt(0)
    s_barrier
    s_branch g3_ld_end
g3_ld_s4:
    s_waitcnt vmcnt(12)
    s_branch g3_ld_bar
g3_ld_end:
    s_barrier
    s_branch g4_in
g3_done:
    s_endpgm
g3_compute:
    v_lshrrev_b32 v5, 4, v2
    v_bfe_u32 v6, v2, 2, 2
    v_and_b32 v7, 3, v2
    v_and_b32 v8, 15, v2
    s_and_b32 s44, s28, 1
    s_lshr_b32 s45, s28, 1
    s_mul_i32 s40, s25, 128
    s_mul_i32 s41, s45, 64
    s_add_u32 s40, s40, s41
    v_add_u32 v20, s40, v8
    s_mov_b32 s41, 8192
    v_mul_lo_u32 v9, v20, s41
    s_mul_i32 s40, s24, 256
    s_mul_i32 s41, s44, 128
    s_add_u32 s46, s40, s41
    v_and_b32 v3, 1, v5
    v_lshlrev_b32 v3, 5, v3
    v_lshrrev_b32 v4, 1, v5
    v_lshl_add_u32 v3, v4, 4, v3
    v_add3_u32 v9, v9, v3, s46
    s_mov_b32 s52, 0
    s_mov_b32 s53, 131072
    s_mov_b32 s54, 262144
    s_mov_b32 s55, 393216
    s_waitcnt lgkmcnt(0)
    s_add_u32 s4, s4, s97
    s_addc_u32 s5, s5, 0
    s_mov_b32 s20, s6
    s_mov_b32 s21, s7
    s_mov_b32 s22, 0x1c00
    s_mov_b32 s23, 0x20000
    s_add_u32 s16, s4, 0x1100000
    s_addc_u32 s17, s5, 0
    s_mov_b32 s18, 0x800000
    s_mov_b32 s19, 0x20000
    v_lshl_add_u32 v3, v5, 3, s46
    buffer_load_dwordx2 v[92:93], v3, s[20:23], 0 offen offset:0
    buffer_load_dwordx2 v[94:95], v3, s[20:23], 0 offen offset:32
    buffer_load_dwordx2 v[96:97], v3, s[20:23], 0 offen offset:64
    buffer_load_dwordx2 v[98:99], v3, s[20:23], 0 offen offset:96
    s_mul_i32 s42, s44, 4
    s_mov_b32 s43, 0
    v_and_b32 v3, 1, v5
    v_lshl_or_b32 v3, v3, 2, v6
    s_add_u32 s40, s42, 0
    v_xor_b32 v3, s40, v3
    v_lshlrev_b32 v3, 5, v3
    v_lshl_add_u32 v3, v7, 3, v3
    v_lshl_add_u32 v4, v5, 3, v6
    v_lshl_add_u32 v3, v4, 8, v3
    v_add_u32 v10, s43, v3
    v_and_b32 v3, 1, v5
    v_lshl_or_b32 v3, v3, 2, v6
    s_add_u32 s40, s42, 1
    v_xor_b32 v3, s40, v3
    v_lshlrev_b32 v3, 5, v3
    v_lshl_add_u32 v3, v7, 3, v3
    v_lshl_add_u32 v4, v5, 3, v6
    v_lshl_add_u32 v3, v4, 8, v3
    v_add_u32 v11, s43, v3
    v_and_b32 v3, 1, v5
    v_lshl_or_b32 v3, v3, 2, v6
    s_add_u32 s40, s42, 2
    v_xor_b32 v3, s40, v3
    v_lshlrev_b32 v3, 5, v3
    v_lshl_add_u32 v3, v7, 3, v3
    v_lshl_add_u32 v4, v5, 3, v6
    v_lshl_add_u32 v3, v4, 8, v3
    v_add_u32 v12, s43, v3
    v_and_b32 v3, 1, v5
    v_lshl_or_b32 v3, v3, 2, v6
    s_add_u32 s40, s42, 3
    v_xor_b32 v3, s40, v3
    v_lshlrev_b32 v3, 5, v3
    v_lshl_add_u32 v3, v7, 3, v3
    v_lshl_add_u32 v4, v5, 3, v6
    v_lshl_add_u32 v3, v4, 8, v3
    v_add_u32 v13, s43, v3
    s_mul_i32 s42, s45, 4
    s_mov_b32 s43, 16384
    v_and_b32 v3, 1, v5
    v_lshl_or_b32 v3, v3, 2, v6
    s_add_u32 s40, s42, 0
    v_xor_b32 v3, s40, v3
    v_lshlrev_b32 v3, 5, v3
    v_lshl_add_u32 v3, v7, 3, v3
    v_lshl_add_u32 v4, v5, 3, v6
    v_lshl_add_u32 v3, v4, 8, v3
    v_add_u32 v14, s43, v3
    v_and_b32 v3, 1, v5
    v_lshl_or_b32 v3, v3, 2, v6
    s_add_u32 s40, s42, 1
    v_xor_b32 v3, s40, v3
    v_lshlrev_b32 v3, 5, v3
    v_lshl_add_u32 v3, v7, 3, v3
    v_lshl_add_u32 v4, v5, 3, v6
    v_lshl_add_u32 v3, v4, 8, v3
    v_add_u32 v15, s43, v3
    v_and_b32 v3, 1, v5
    v_lshl_or_b32 v3, v3, 2, v6
    s_add_u32 s40, s42, 2
    v_xor_b32 v3, s40, v3
    v_lshlrev_b32 v3, 5, v3
    v_lshl_add_u32 v3, v7, 3, v3
    v_lshl_add_u32 v4, v5, 3, v6
    v_lshl_add_u32 v3, v4, 8, v3
    v_add_u32 v16, s43, v3
    v_and_b32 v3, 1, v5
    v_lshl_or_b32 v3, v3, 2, v6
    s_add_u32 s40, s42, 3
    v_xor_b32 v3, s40, v3
    v_lshlrev_b32 v3, 5, v3
    v_lshl_add_u32 v3, v7, 3, v3
    v_lshl_add_u32 v4, v5, 3, v6
    v_lshl_add_u32 v3, v4, 8, v3
    v_add_u32 v17, s43, v3
    v_mov_b32 v124, 0
    v_mov_b32 v125, 0
    v_mov_b32 v126, 0
    v_mov_b32 v127, 0
    v_mov_b32 v128, 0
    v_mov_b32 v129, 0
    v_mov_b32 v130, 0
    v_mov_b32 v131, 0
    v_mov_b32 v132, 0
    v_mov_b32 v133, 0
    v_mov_b32 v134, 0
    v_mov_b32 v135, 0
    v_mov_b32 v136, 0
    v_mov_b32 v137, 0
    v_mov_b32 v138, 0
    v_mov_b32 v139, 0
    v_mov_b32 v140, 0
    v_mov_b32 v141, 0
    v_mov_b32 v142, 0
    v_mov_b32 v143, 0
    v_mov_b32 v144, 0
    v_mov_b32 v145, 0
    v_mov_b32 v146, 0
    v_mov_b32 v147, 0
    v_mov_b32 v148, 0
    v_mov_b32 v149, 0
    v_mov_b32 v150, 0
    v_mov_b32 v151, 0
    v_mov_b32 v152, 0
    v_mov_b32 v153, 0
    v_mov_b32 v154, 0
    v_mov_b32 v155, 0
    s_mov_b32 s48, 32
    s_mov_b32 s50, 0
    s_mov_b32 s51, 32768
    s_mov_b32 s29, 0xfffe8000
    s_waitcnt vmcnt(0)
    v_lshlrev_b32 v28, 16, v92
    v_and_b32 v29, 0xffff0000, v92
    v_lshlrev_b32 v30, 16, v93
    v_and_b32 v31, 0xffff0000, v93
    v_lshlrev_b32 v32, 16, v92
    v_and_b32 v33, 0xffff0000, v92
    v_lshlrev_b32 v34, 16, v93
    v_and_b32 v35, 0xffff0000, v93
    v_lshlrev_b32 v36, 16, v92
    v_and_b32 v37, 0xffff0000, v92
    v_lshlrev_b32 v38, 16, v93
    v_and_b32 v39, 0xffff0000, v93
    v_lshlrev_b32 v40, 16, v92
    v_and_b32 v41, 0xffff0000, v92
    v_lshlrev_b32 v42, 16, v93
    v_and_b32 v43, 0xffff0000, v93
    v_lshlrev_b32 v44, 16, v94
    v_and_b32 v45, 0xffff0000, v94
    v_lshlrev_b32 v46, 16, v95
    v_and_b32 v47, 0xffff0000, v95
    v_lshlrev_b32 v48, 16, v94
    v_and_b32 v49, 0xffff0000, v94
    v_lshlrev_b32 v50, 16, v95
    v_and_b32 v51, 0xffff0000, v95
    v_lshlrev_b32 v52, 16, v94
    v_and_b32 v53, 0xffff0000, v94
    v_lshlrev_b32 v54, 16, v95
    v_and_b32 v55, 0xffff0000, v95
    v_lshlrev_b32 v56, 16, v94
    v_and_b32 v57, 0xffff0000, v94
    v_lshlrev_b32 v58, 16, v95
    v_and_b32 v59, 0xffff0000, v95
    v_lshlrev_b32 v60, 16, v96
    v_and_b32 v61, 0xffff0000, v96
    v_lshlrev_b32 v62, 16, v97
    v_and_b32 v63, 0xffff0000, v97
    v_lshlrev_b32 v64, 16, v96
    v_and_b32 v65, 0xffff0000, v96
    v_lshlrev_b32 v66, 16, v97
    v_and_b32 v67, 0xffff0000, v97
    v_lshlrev_b32 v68, 16, v96
    v_and_b32 v69, 0xffff0000, v96
    v_lshlrev_b32 v70, 16, v97
    v_and_b32 v71, 0xffff0000, v97
    v_lshlrev_b32 v72, 16, v96
    v_and_b32 v73, 0xffff0000, v96
    v_lshlrev_b32 v74, 16, v97
    v_and_b32 v75, 0xffff0000, v97
    v_lshlrev_b32 v76, 16, v98
    v_and_b32 v77, 0xffff0000, v98
    v_lshlrev_b32 v78, 16, v99
    v_and_b32 v79, 0xffff0000, v99
    v_lshlrev_b32 v80, 16, v98
    v_and_b32 v81, 0xffff0000, v98
    v_lshlrev_b32 v82, 16, v99
    v_and_b32 v83, 0xffff0000, v99
    v_lshlrev_b32 v84, 16, v98
    v_and_b32 v85, 0xffff0000, v98
    v_lshlrev_b32 v86, 16, v99
    v_and_b32 v87, 0xffff0000, v99
    v_lshlrev_b32 v88, 16, v98
    v_and_b32 v89, 0xffff0000, v98
    v_lshlrev_b32 v90, 16, v99
    v_and_b32 v91, 0xffff0000, v99
    v_mov_b32 v156, 0xbdd2d3e8
    v_mov_b32 v157, 0xbdd2d3e8
    v_mov_b32 v158, 0xc0135761
    v_mov_b32 v159, 0xc0135761
    v_mov_b32 v160, 0x3f800000
    v_mov_b32 v161, 0x3f800000
.p2align 3
g3_cloop:
    s_barrier
g3_cloop2:
    v_mfma_f32_16x16x32_bf16 v[28:31], v[124:127], v[140:143], v[28:31]
    ds_read_b64_tr_b16 v[92:93], v10 offset:0
    ds_read_b64_tr_b16 v[94:95], v10 offset:1024
    v_mfma_f32_16x16x32_bf16 v[32:35], v[124:127], v[144:147], v[32:35]
    ds_read_b64_tr_b16 v[108:109], v14 offset:0
    ds_read_b64_tr_b16 v[110:111], v14 offset:1024
    v_mfma_f32_16x16x32_bf16 v[36:39], v[124:127], v[148:151], v[36:39]
    ds_read_b64_tr_b16 v[112:113], v15 offset:0
    ds_read_b64_tr_b16 v[114:115], v15 offset:1024
    v_mfma_f32_16x16x32_bf16 v[40:43], v[124:127], v[152:155], v[40:43]
    ds_read_b64_tr_b16 v[116:117], v16 offset:0
    ds_read_b64_tr_b16 v[118:119], v16 offset:1024
    v_mfma_f32_16x16x32_bf16 v[44:47], v[128:131], v[140:143], v[44:47]
    ds_read_b64_tr_b16 v[120:121], v17 offset:0
    ds_read_b64_tr_b16 v[122:123], v17 offset:1024
    v_mfma_f32_16x16x32_bf16 v[48:51], v[128:131], v[144:147], v[48:51]
    ds_read_b64_tr_b16 v[96:97], v11 offset:0
    ds_read_b64_tr_b16 v[98:99], v11 offset:1024
    v_mfma_f32_16x16x32_bf16 v[52:55], v[128:131], v[148:151], v[52:55]
    ds_read_b64_tr_b16 v[100:101], v12 offset:0
    ds_read_b64_tr_b16 v[102:103], v12 offset:1024
    v_mfma_f32_16x16x32_bf16 v[56:59], v[128:131], v[152:155], v[56:59]
    ds_read_b64_tr_b16 v[104:105], v13 offset:0
    ds_read_b64_tr_b16 v[106:107], v13 offset:1024
    v_mfma_f32_16x16x32_bf16 v[60:63], v[132:135], v[140:143], v[60:63]
    v_mfma_f32_16x16x32_bf16 v[64:67], v[132:135], v[144:147], v[64:67]
    v_mfma_f32_16x16x32_bf16 v[68:71], v[132:135], v[148:151], v[68:71]
    v_mfma_f32_16x16x32_bf16 v[72:75], v[132:135], v[152:155], v[72:75]
    v_mfma_f32_16x16x32_bf16 v[76:79], v[136:139], v[140:143], v[76:79]
    v_mfma_f32_16x16x32_bf16 v[80:83], v[136:139], v[144:147], v[80:83]
    v_mfma_f32_16x16x32_bf16 v[84:87], v[136:139], v[148:151], v[84:87]
    v_mfma_f32_16x16x32_bf16 v[88:91], v[136:139], v[152:155], v[88:91]
    s_waitcnt lgkmcnt(0)
    v_mfma_f32_16x16x32_bf16 v[28:31], v[92:95], v[108:111], v[28:31]
    ds_read_b64_tr_b16 v[124:125], v10 offset:8192
    ds_read_b64_tr_b16 v[126:127], v10 offset:9216
    v_mfma_f32_16x16x32_bf16 v[32:35], v[92:95], v[112:115], v[32:35]
    ds_read_b64_tr_b16 v[140:141], v14 offset:8192
    ds_read_b64_tr_b16 v[142:143], v14 offset:9216
    v_mfma_f32_16x16x32_bf16 v[36:39], v[92:95], v[116:119], v[36:39]
    ds_read_b64_tr_b16 v[144:145], v15 offset:8192
    ds_read_b64_tr_b16 v[146:147], v15 offset:9216
    v_mfma_f32_16x16x32_bf16 v[40:43], v[92:95], v[120:123], v[40:43]
    ds_read_b64_tr_b16 v[148:149], v16 offset:8192
    ds_read_b64_tr_b16 v[150:151], v16 offset:9216
    v_mfma_f32_16x16x32_bf16 v[44:47], v[96:99], v[108:111], v[44:47]
    ds_read_b64_tr_b16 v[152:153], v17 offset:8192
    ds_read_b64_tr_b16 v[154:155], v17 offset:9216
    v_mfma_f32_16x16x32_bf16 v[48:51], v[96:99], v[112:115], v[48:51]
    ds_read_b64_tr_b16 v[128:129], v11 offset:8192
    ds_read_b64_tr_b16 v[130:131], v11 offset:9216
    v_mfma_f32_16x16x32_bf16 v[52:55], v[96:99], v[116:119], v[52:55]
    ds_read_b64_tr_b16 v[132:133], v12 offset:8192
    ds_read_b64_tr_b16 v[134:135], v12 offset:9216
    v_mfma_f32_16x16x32_bf16 v[56:59], v[96:99], v[120:123], v[56:59]
    ds_read_b64_tr_b16 v[136:137], v13 offset:8192
    ds_read_b64_tr_b16 v[138:139], v13 offset:9216
    v_mfma_f32_16x16x32_bf16 v[60:63], v[100:103], v[108:111], v[60:63]
    s_add_u32 s50, s50, 1
    s_cmp_eq_u32 s50, 4
    v_mfma_f32_16x16x32_bf16 v[64:67], v[100:103], v[112:115], v[64:67]
    s_cselect_b32 s49, s29, s51
    s_cselect_b32 s50, 0, s50
    v_mfma_f32_16x16x32_bf16 v[68:71], v[100:103], v[116:119], v[68:71]
    v_add_u32 v10, s49, v10
    v_add_u32 v11, s49, v11
    v_mfma_f32_16x16x32_bf16 v[72:75], v[100:103], v[120:123], v[72:75]
    v_add_u32 v12, s49, v12
    v_add_u32 v13, s49, v13
    v_mfma_f32_16x16x32_bf16 v[76:79], v[104:107], v[108:111], v[76:79]
    v_add_u32 v14, s49, v14
    v_add_u32 v15, s49, v15
    v_mfma_f32_16x16x32_bf16 v[80:83], v[104:107], v[112:115], v[80:83]
    v_add_u32 v16, s49, v16
    v_add_u32 v17, s49, v17
    v_mfma_f32_16x16x32_bf16 v[84:87], v[104:107], v[116:119], v[84:87]
    s_sub_u32 s48, s48, 1
    s_cmp_lg_u32 s48, 0
    v_mfma_f32_16x16x32_bf16 v[88:91], v[104:107], v[120:123], v[88:91]
    s_waitcnt lgkmcnt(0)
    s_cbranch_scc1 g3_cloop
    v_mfma_f32_16x16x32_bf16 v[28:31], v[124:127], v[140:143], v[28:31]
    v_mfma_f32_16x16x32_bf16 v[44:47], v[128:131], v[140:143], v[44:47]
    v_mfma_f32_16x16x32_bf16 v[60:63], v[132:135], v[140:143], v[60:63]
    v_mfma_f32_16x16x32_bf16 v[76:79], v[136:139], v[140:143], v[76:79]
    v_mfma_f32_16x16x32_bf16 v[32:35], v[124:127], v[144:147], v[32:35]
    v_mfma_f32_16x16x32_bf16 v[48:51], v[128:131], v[144:147], v[48:51]
    v_mfma_f32_16x16x32_bf16 v[64:67], v[132:135], v[144:147], v[64:67]
    v_mfma_f32_16x16x32_bf16 v[80:83], v[136:139], v[144:147], v[80:83]
    s_nop 1
    v_mfma_f32_16x16x32_bf16 v[36:39], v[124:127], v[148:151], v[36:39]
    v_pk_mul_f32 v[108:109], v[28:29], v[28:29]
    v_pk_mul_f32 v[110:111], v[30:31], v[30:31]
    v_pk_mul_f32 v[112:113], v[44:45], v[44:45]
    v_pk_mul_f32 v[114:115], v[46:47], v[46:47]
    v_pk_fma_f32 v[108:109], v[108:109], v[156:157], v[158:159]
    v_pk_fma_f32 v[110:111], v[110:111], v[156:157], v[158:159]
    v_pk_fma_f32 v[112:113], v[112:113], v[156:157], v[158:159]
    v_pk_fma_f32 v[114:115], v[114:115], v[156:157], v[158:159]
    v_pk_mul_f32 v[108:109], v[108:109], v[28:29]
    v_pk_mul_f32 v[110:111], v[110:111], v[30:31]
    v_pk_mul_f32 v[112:113], v[112:113], v[44:45]
    v_pk_mul_f32 v[114:115], v[114:115], v[46:47]
    v_exp_f32 v108, v108
    v_exp_f32 v109, v109
    v_exp_f32 v110, v110
    v_exp_f32 v111, v111
    v_exp_f32 v112, v112
    v_exp_f32 v113, v113
    v_exp_f32 v114, v114
    v_exp_f32 v115, v115
    v_pk_add_f32 v[108:109], v[108:109], v[160:161]
    v_pk_add_f32 v[110:111], v[110:111], v[160:161]
    v_mfma_f32_16x16x32_bf16 v[52:55], v[128:131], v[148:151], v[52:55]
    v_pk_add_f32 v[112:113], v[112:113], v[160:161]
    v_pk_add_f32 v[114:115], v[114:115], v[160:161]
    v_rcp_f32 v108, v108
    v_rcp_f32 v109, v109
    v_rcp_f32 v110, v110
    v_rcp_f32 v111, v111
    v_rcp_f32 v112, v112
    v_rcp_f32 v113, v113
    v_rcp_f32 v114, v114
    v_rcp_f32 v115, v115
    v_pk_mul_f32 v[28:29], v[28:29], v[108:109]
    v_pk_mul_f32 v[30:31], v[30:31], v[110:111]
    v_pk_mul_f32 v[44:45], v[44:45], v[112:113]
    v_pk_mul_f32 v[46:47], v[46:47], v[114:115]
    v_cvt_pk_bf16_f32 v92, v28, v29
    v_cvt_pk_bf16_f32 v93, v30, v31
    v_cvt_pk_bf16_f32 v94, v44, v45
    v_cvt_pk_bf16_f32 v95, v46, v47
    s_nop 1
    v_permlane16_swap_b32 v92, v94
    v_permlane16_swap_b32 v93, v95
    buffer_store_dwordx4 v[92:95], v9, s[16:19], s52 offen offset:0 sc1
    v_mfma_f32_16x16x32_bf16 v[68:71], v[132:135], v[148:151], v[68:71]
    v_pk_mul_f32 v[108:109], v[60:61], v[60:61]
    v_pk_mul_f32 v[110:111], v[62:63], v[62:63]
    v_pk_mul_f32 v[112:113], v[76:77], v[76:77]
    v_pk_mul_f32 v[114:115], v[78:79], v[78:79]
    v_pk_fma_f32 v[108:109], v[108:109], v[156:157], v[158:159]
    v_pk_fma_f32 v[110:111], v[110:111], v[156:157], v[158:159]
    v_pk_fma_f32 v[112:113], v[112:113], v[156:157], v[158:159]
    v_pk_fma_f32 v[114:115], v[114:115], v[156:157], v[158:159]
    v_pk_mul_f32 v[108:109], v[108:109], v[60:61]
    v_pk_mul_f32 v[110:111], v[110:111], v[62:63]
    v_pk_mul_f32 v[112:113], v[112:113], v[76:77]
    v_pk_mul_f32 v[114:115], v[114:115], v[78:79]
    v_exp_f32 v108, v108
    v_exp_f32 v109, v109
    v_exp_f32 v110, v110
    v_exp_f32 v111, v111
    v_exp_f32 v112, v112
    v_exp_f32 v113, v113
    v_exp_f32 v114, v114
    v_exp_f32 v115, v115
    v_pk_add_f32 v[108:109], v[108:109], v[160:161]
    v_pk_add_f32 v[110:111], v[110:111], v[160:161]
    v_mfma_f32_16x16x32_bf16 v[84:87], v[136:139], v[148:151], v[84:87]
    v_pk_add_f32 v[112:113], v[112:113], v[160:161]
    v_pk_add_f32 v[114:115], v[114:115], v[160:161]
    v_rcp_f32 v108, v108
    v_rcp_f32 v109, v109
    v_rcp_f32 v110, v110
    v_rcp_f32 v111, v111
    v_rcp_f32 v112, v112
    v_rcp_f32 v113, v113
    v_rcp_f32 v114, v114
    v_rcp_f32 v115, v115
    v_pk_mul_f32 v[60:61], v[60:61], v[108:109]
    v_pk_mul_f32 v[62:63], v[62:63], v[110:111]
    v_pk_mul_f32 v[76:77], v[76:77], v[112:113]
    v_pk_mul_f32 v[78:79], v[78:79], v[114:115]
    v_cvt_pk_bf16_f32 v96, v60, v61
    v_cvt_pk_bf16_f32 v97, v62, v63
    v_cvt_pk_bf16_f32 v98, v76, v77
    v_cvt_pk_bf16_f32 v99, v78, v79
    s_nop 1
    v_permlane16_swap_b32 v96, v98
    v_permlane16_swap_b32 v97, v99
    buffer_store_dwordx4 v[96:99], v9, s[16:19], s52 offen offset:64 sc1
    v_mfma_f32_16x16x32_bf16 v[40:43], v[124:127], v[152:155], v[40:43]
    v_pk_mul_f32 v[108:109], v[32:33], v[32:33]
    v_pk_mul_f32 v[110:111], v[34:35], v[34:35]
    v_pk_mul_f32 v[112:113], v[48:49], v[48:49]
    v_pk_mul_f32 v[114:115], v[50:51], v[50:51]
    v_pk_fma_f32 v[108:109], v[108:109], v[156:157], v[158:159]
    v_pk_fma_f32 v[110:111], v[110:111], v[156:157], v[158:159]
    v_pk_fma_f32 v[112:113], v[112:113], v[156:157], v[158:159]
    v_pk_fma_f32 v[114:115], v[114:115], v[156:157], v[158:159]
    v_pk_mul_f32 v[108:109], v[108:109], v[32:33]
    v_pk_mul_f32 v[110:111], v[110:111], v[34:35]
    v_pk_mul_f32 v[112:113], v[112:113], v[48:49]
    v_pk_mul_f32 v[114:115], v[114:115], v[50:51]
    v_exp_f32 v108, v108
    v_exp_f32 v109, v109
    v_exp_f32 v110, v110
    v_exp_f32 v111, v111
    v_exp_f32 v112, v112
    v_exp_f32 v113, v113
    v_exp_f32 v114, v114
    v_exp_f32 v115, v115
    v_pk_add_f32 v[108:109], v[108:109], v[160:161]
    v_pk_add_f32 v[110:111], v[110:111], v[160:161]
    v_mfma_f32_16x16x32_bf16 v[56:59], v[128:131], v[152:155], v[56:59]
    v_pk_add_f32 v[112:113], v[112:113], v[160:161]
    v_pk_add_f32 v[114:115], v[114:115], v[160:161]
    v_rcp_f32 v108, v108
    v_rcp_f32 v109, v109
    v_rcp_f32 v110, v110
    v_rcp_f32 v111, v111
    v_rcp_f32 v112, v112
    v_rcp_f32 v113, v113
    v_rcp_f32 v114, v114
    v_rcp_f32 v115, v115
    v_pk_mul_f32 v[32:33], v[32:33], v[108:109]
    v_pk_mul_f32 v[34:35], v[34:35], v[110:111]
    v_pk_mul_f32 v[48:49], v[48:49], v[112:113]
    v_pk_mul_f32 v[50:51], v[50:51], v[114:115]
    v_cvt_pk_bf16_f32 v100, v32, v33
    v_cvt_pk_bf16_f32 v101, v34, v35
    v_cvt_pk_bf16_f32 v102, v48, v49
    v_cvt_pk_bf16_f32 v103, v50, v51
    s_nop 1
    v_permlane16_swap_b32 v100, v102
    v_permlane16_swap_b32 v101, v103
    buffer_store_dwordx4 v[100:103], v9, s[16:19], s53 offen offset:0 sc1
    v_mfma_f32_16x16x32_bf16 v[72:75], v[132:135], v[152:155], v[72:75]
    v_pk_mul_f32 v[108:109], v[64:65], v[64:65]
    v_pk_mul_f32 v[110:111], v[66:67], v[66:67]
    v_pk_mul_f32 v[112:113], v[80:81], v[80:81]
    v_pk_mul_f32 v[114:115], v[82:83], v[82:83]
    v_pk_fma_f32 v[108:109], v[108:109], v[156:157], v[158:159]
    v_pk_fma_f32 v[110:111], v[110:111], v[156:157], v[158:159]
    v_pk_fma_f32 v[112:113], v[112:113], v[156:157], v[158:159]
    v_pk_fma_f32 v[114:115], v[114:115], v[156:157], v[158:159]
    v_pk_mul_f32 v[108:109], v[108:109], v[64:65]
    v_pk_mul_f32 v[110:111], v[110:111], v[66:67]
    v_pk_mul_f32 v[112:113], v[112:113], v[80:81]
    v_pk_mul_f32 v[114:115], v[114:115], v[82:83]
    v_exp_f32 v108, v108
    v_exp_f32 v109, v109
    v_exp_f32 v110, v110
    v_exp_f32 v111, v111
    v_exp_f32 v112, v112
    v_exp_f32 v113, v113
    v_exp_f32 v114, v114
    v_exp_f32 v115, v115
    v_pk_add_f32 v[108:109], v[108:109], v[160:161]
    v_pk_add_f32 v[110:111], v[110:111], v[160:161]
    v_mfma_f32_16x16x32_bf16 v[88:91], v[136:139], v[152:155], v[88:91]
    v_pk_add_f32 v[112:113], v[112:113], v[160:161]
    v_pk_add_f32 v[114:115], v[114:115], v[160:161]
    v_rcp_f32 v108, v108
    v_rcp_f32 v109, v109
    v_rcp_f32 v110, v110
    v_rcp_f32 v111, v111
    v_rcp_f32 v112, v112
    v_rcp_f32 v113, v113
    v_rcp_f32 v114, v114
    v_rcp_f32 v115, v115
    v_pk_mul_f32 v[64:65], v[64:65], v[108:109]
    v_pk_mul_f32 v[66:67], v[66:67], v[110:111]
    v_pk_mul_f32 v[80:81], v[80:81], v[112:113]
    v_pk_mul_f32 v[82:83], v[82:83], v[114:115]
    v_cvt_pk_bf16_f32 v104, v64, v65
    v_cvt_pk_bf16_f32 v105, v66, v67
    v_cvt_pk_bf16_f32 v106, v80, v81
    v_cvt_pk_bf16_f32 v107, v82, v83
    s_nop 1
    v_permlane16_swap_b32 v104, v106
    v_permlane16_swap_b32 v105, v107
    buffer_store_dwordx4 v[104:107], v9, s[16:19], s53 offen offset:64 sc1
    v_pk_mul_f32 v[108:109], v[36:37], v[36:37]
    v_pk_mul_f32 v[110:111], v[38:39], v[38:39]
    v_pk_mul_f32 v[112:113], v[52:53], v[52:53]
    v_pk_mul_f32 v[114:115], v[54:55], v[54:55]
    v_pk_fma_f32 v[108:109], v[108:109], v[156:157], v[158:159]
    v_pk_fma_f32 v[110:111], v[110:111], v[156:157], v[158:159]
    v_pk_fma_f32 v[112:113], v[112:113], v[156:157], v[158:159]
    v_pk_fma_f32 v[114:115], v[114:115], v[156:157], v[158:159]
    v_pk_mul_f32 v[108:109], v[108:109], v[36:37]
    v_pk_mul_f32 v[110:111], v[110:111], v[38:39]
    v_pk_mul_f32 v[112:113], v[112:113], v[52:53]
    v_pk_mul_f32 v[114:115], v[114:115], v[54:55]
    v_exp_f32 v108, v108
    v_exp_f32 v109, v109
    v_exp_f32 v110, v110
    v_exp_f32 v111, v111
    v_exp_f32 v112, v112
    v_exp_f32 v113, v113
    v_exp_f32 v114, v114
    v_exp_f32 v115, v115
    v_pk_add_f32 v[108:109], v[108:109], v[160:161]
    v_pk_add_f32 v[110:111], v[110:111], v[160:161]
    v_pk_add_f32 v[112:113], v[112:113], v[160:161]
    v_pk_add_f32 v[114:115], v[114:115], v[160:161]
    v_rcp_f32 v108, v108
    v_rcp_f32 v109, v109
    v_rcp_f32 v110, v110
    v_rcp_f32 v111, v111
    v_rcp_f32 v112, v112
    v_rcp_f32 v113, v113
    v_rcp_f32 v114, v114
    v_rcp_f32 v115, v115
    v_pk_mul_f32 v[36:37], v[36:37], v[108:109]
    v_pk_mul_f32 v[38:39], v[38:39], v[110:111]
    v_pk_mul_f32 v[52:53], v[52:53], v[112:113]
    v_pk_mul_f32 v[54:55], v[54:55], v[114:115]
    v_cvt_pk_bf16_f32 v92, v36, v37
    v_cvt_pk_bf16_f32 v93, v38, v39
    v_cvt_pk_bf16_f32 v94, v52, v53
    v_cvt_pk_bf16_f32 v95, v54, v55
    s_nop 1
    v_permlane16_swap_b32 v92, v94
    v_permlane16_swap_b32 v93, v95
    buffer_store_dwordx4 v[92:95], v9, s[16:19], s54 offen offset:0 sc1
    v_pk_mul_f32 v[108:109], v[68:69], v[68:69]
    v_pk_mul_f32 v[110:111], v[70:71], v[70:71]
    v_pk_mul_f32 v[112:113], v[84:85], v[84:85]
    v_pk_mul_f32 v[114:115], v[86:87], v[86:87]
    v_pk_fma_f32 v[108:109], v[108:109], v[156:157], v[158:159]
    v_pk_fma_f32 v[110:111], v[110:111], v[156:157], v[158:159]
    v_pk_fma_f32 v[112:113], v[112:113], v[156:157], v[158:159]
    v_pk_fma_f32 v[114:115], v[114:115], v[156:157], v[158:159]
    v_pk_mul_f32 v[108:109], v[108:109], v[68:69]
    v_pk_mul_f32 v[110:111], v[110:111], v[70:71]
    v_pk_mul_f32 v[112:113], v[112:113], v[84:85]
    v_pk_mul_f32 v[114:115], v[114:115], v[86:87]
    v_exp_f32 v108, v108
    v_exp_f32 v109, v109
    v_exp_f32 v110, v110
    v_exp_f32 v111, v111
    v_exp_f32 v112, v112
    v_exp_f32 v113, v113
    v_exp_f32 v114, v114
    v_exp_f32 v115, v115
    v_pk_add_f32 v[108:109], v[108:109], v[160:161]
    v_pk_add_f32 v[110:111], v[110:111], v[160:161]
    v_pk_add_f32 v[112:113], v[112:113], v[160:161]
    v_pk_add_f32 v[114:115], v[114:115], v[160:161]
    v_rcp_f32 v108, v108
    v_rcp_f32 v109, v109
    v_rcp_f32 v110, v110
    v_rcp_f32 v111, v111
    v_rcp_f32 v112, v112
    v_rcp_f32 v113, v113
    v_rcp_f32 v114, v114
    v_rcp_f32 v115, v115
    v_pk_mul_f32 v[68:69], v[68:69], v[108:109]
    v_pk_mul_f32 v[70:71], v[70:71], v[110:111]
    v_pk_mul_f32 v[84:85], v[84:85], v[112:113]
    v_pk_mul_f32 v[86:87], v[86:87], v[114:115]
    v_cvt_pk_bf16_f32 v96, v68, v69
    v_cvt_pk_bf16_f32 v97, v70, v71
    v_cvt_pk_bf16_f32 v98, v84, v85
    v_cvt_pk_bf16_f32 v99, v86, v87
    s_nop 1
    v_permlane16_swap_b32 v96, v98
    v_permlane16_swap_b32 v97, v99
    buffer_store_dwordx4 v[96:99], v9, s[16:19], s54 offen offset:64 sc1
    v_pk_mul_f32 v[108:109], v[40:41], v[40:41]
    v_pk_mul_f32 v[110:111], v[42:43], v[42:43]
    v_pk_mul_f32 v[112:113], v[56:57], v[56:57]
    v_pk_mul_f32 v[114:115], v[58:59], v[58:59]
    v_pk_fma_f32 v[108:109], v[108:109], v[156:157], v[158:159]
    v_pk_fma_f32 v[110:111], v[110:111], v[156:157], v[158:159]
    v_pk_fma_f32 v[112:113], v[112:113], v[156:157], v[158:159]
    v_pk_fma_f32 v[114:115], v[114:115], v[156:157], v[158:159]
    v_pk_mul_f32 v[108:109], v[108:109], v[40:41]
    v_pk_mul_f32 v[110:111], v[110:111], v[42:43]
    v_pk_mul_f32 v[112:113], v[112:113], v[56:57]
    v_pk_mul_f32 v[114:115], v[114:115], v[58:59]
    v_exp_f32 v108, v108
    v_exp_f32 v109, v109
    v_exp_f32 v110, v110
    v_exp_f32 v111, v111
    v_exp_f32 v112, v112
    v_exp_f32 v113, v113
    v_exp_f32 v114, v114
    v_exp_f32 v115, v115
    v_pk_add_f32 v[108:109], v[108:109], v[160:161]
    v_pk_add_f32 v[110:111], v[110:111], v[160:161]
    v_pk_add_f32 v[112:113], v[112:113], v[160:161]
    v_pk_add_f32 v[114:115], v[114:115], v[160:161]
    v_rcp_f32 v108, v108
    v_rcp_f32 v109, v109
    v_rcp_f32 v110, v110
    v_rcp_f32 v111, v111
    v_rcp_f32 v112, v112
    v_rcp_f32 v113, v113
    v_rcp_f32 v114, v114
    v_rcp_f32 v115, v115
    v_pk_mul_f32 v[40:41], v[40:41], v[108:109]
    v_pk_mul_f32 v[42:43], v[42:43], v[110:111]
    v_pk_mul_f32 v[56:57], v[56:57], v[112:113]
    v_pk_mul_f32 v[58:59], v[58:59], v[114:115]
    v_cvt_pk_bf16_f32 v100, v40, v41
    v_cvt_pk_bf16_f32 v101, v42, v43
    v_cvt_pk_bf16_f32 v102, v56, v57
    v_cvt_pk_bf16_f32 v103, v58, v59
    s_nop 1
    v_permlane16_swap_b32 v100, v102
    v_permlane16_swap_b32 v101, v103
    buffer_store_dwordx4 v[100:103], v9, s[16:19], s55 offen offset:0 sc1
    v_pk_mul_f32 v[108:109], v[72:73], v[72:73]
    v_pk_mul_f32 v[110:111], v[74:75], v[74:75]
    v_pk_mul_f32 v[112:113], v[88:89], v[88:89]
    v_pk_mul_f32 v[114:115], v[90:91], v[90:91]
    v_pk_fma_f32 v[108:109], v[108:109], v[156:157], v[158:159]
    v_pk_fma_f32 v[110:111], v[110:111], v[156:157], v[158:159]
    v_pk_fma_f32 v[112:113], v[112:113], v[156:157], v[158:159]
    v_pk_fma_f32 v[114:115], v[114:115], v[156:157], v[158:159]
    v_pk_mul_f32 v[108:109], v[108:109], v[72:73]
    v_pk_mul_f32 v[110:111], v[110:111], v[74:75]
    v_pk_mul_f32 v[112:113], v[112:113], v[88:89]
    v_pk_mul_f32 v[114:115], v[114:115], v[90:91]
    v_exp_f32 v108, v108
    v_exp_f32 v109, v109
    v_exp_f32 v110, v110
    v_exp_f32 v111, v111
    v_exp_f32 v112, v112
    v_exp_f32 v113, v113
    v_exp_f32 v114, v114
    v_exp_f32 v115, v115
    v_pk_add_f32 v[108:109], v[108:109], v[160:161]
    v_pk_add_f32 v[110:111], v[110:111], v[160:161]
    v_pk_add_f32 v[112:113], v[112:113], v[160:161]
    v_pk_add_f32 v[114:115], v[114:115], v[160:161]
    v_rcp_f32 v108, v108
    v_rcp_f32 v109, v109
    v_rcp_f32 v110, v110
    v_rcp_f32 v111, v111
    v_rcp_f32 v112, v112
    v_rcp_f32 v113, v113
    v_rcp_f32 v114, v114
    v_rcp_f32 v115, v115
    v_pk_mul_f32 v[72:73], v[72:73], v[108:109]
    v_pk_mul_f32 v[74:75], v[74:75], v[110:111]
    v_pk_mul_f32 v[88:89], v[88:89], v[112:113]
    v_pk_mul_f32 v[90:91], v[90:91], v[114:115]
    v_cvt_pk_bf16_f32 v104, v72, v73
    v_cvt_pk_bf16_f32 v105, v74, v75
    v_cvt_pk_bf16_f32 v106, v88, v89
    v_cvt_pk_bf16_f32 v107, v90, v91
    s_nop 1
    v_permlane16_swap_b32 v104, v106
    v_permlane16_swap_b32 v105, v107
    buffer_store_dwordx4 v[104:107], v9, s[16:19], s55 offen offset:64 sc1
    s_cmp_ge_u32 s24, 14
    s_cselect_b32 s40, 25, 24
    s_lshl_b32 s41, s25, 1
    s_add_u32 s40, s40, s41
    s_lshl_b32 s40, s40, 8
    s_add_u32 s84, s4, 0x300000
    s_addc_u32 s85, s5, 0
    s_mov_b32 s86, 0x4000
    s_mov_b32 s87, 0x20000
    v_mov_b32 v3, s40
    v_mov_b32 v4, 1
    s_waitcnt vmcnt(0)
    s_barrier
    s_cmp_lg_u32 s28, 0
    s_cbranch_scc1 g3_cin
    s_mov_b64 exec, 1
    buffer_atomic_add v4, v3, s[84:87], 0 offen sc1
    s_mov_b64 exec, -1
g3_cin:
    s_branch g4_in
g3_spare:
    s_cmp_ge_u32 s2, 256
    s_cbranch_scc1 g3_done
    s_load_dwordx2 s[4:5], s[0:1], 80
    s_load_dwordx2 s[6:7], s[0:1], 48
    s_sub_u32 s3, s2, 224
    v_lshrrev_b32 v2, 6, v0
    v_lshlrev_b32 v1, 4, v0
    v_mov_b32 v8, -1
    v_mov_b32 v9, -1
    v_mov_b32 v10, -1
    v_mov_b32 v11, -1
    v_readfirstlane_b32 s28, v2
    s_lshl_b32 s13, s3, 17
    s_waitcnt lgkmcnt(0)
    s_add_u32 s4, s4, s97
    s_addc_u32 s5, s5, 0
    s_add_u32 s8, s4, 0x1d00000
    s_addc_u32 s9, s5, 0
    s_mov_b32 s10, 0x400000
    s_mov_b32 s11, 0x20000
    buffer_store_dwordx4 v[8:11], v1, s[8:11], s13 offen sc1
    s_add_u32 s13, s13, 8192
    buffer_store_dwordx4 v[8:11], v1, s[8:11], s13 offen sc1
    s_add_u32 s13, s13, 8192
    buffer_store_dwordx4 v[8:11], v1, s[8:11], s13 offen sc1
    s_add_u32 s13, s13, 8192
    buffer_store_dwordx4 v[8:11], v1, s[8:11], s13 offen sc1
    s_add_u32 s13, s13, 8192
    buffer_store_dwordx4 v[8:11], v1, s[8:11], s13 offen sc1
    s_add_u32 s13, s13, 8192
    buffer_store_dwordx4 v[8:11], v1, s[8:11], s13 offen sc1
    s_add_u32 s13, s13, 8192
    buffer_store_dwordx4 v[8:11], v1, s[8:11], s13 offen sc1
    s_add_u32 s13, s13, 8192
    buffer_store_dwordx4 v[8:11], v1, s[8:11], s13 offen sc1
    s_add_u32 s13, s13, 8192
    buffer_store_dwordx4 v[8:11], v1, s[8:11], s13 offen sc1
    s_add_u32 s13, s13, 8192
    buffer_store_dwordx4 v[8:11], v1, s[8:11], s13 offen sc1
    s_add_u32 s13, s13, 8192
    buffer_store_dwordx4 v[8:11], v1, s[8:11], s13 offen sc1
    s_add_u32 s13, s13, 8192
    buffer_store_dwordx4 v[8:11], v1, s[8:11], s13 offen sc1
    s_add_u32 s13, s13, 8192
    buffer_store_dwordx4 v[8:11], v1, s[8:11], s13 offen sc1
    s_add_u32 s13, s13, 8192
    buffer_store_dwordx4 v[8:11], v1, s[8:11], s13 offen sc1
    s_add_u32 s13, s13, 8192
    buffer_store_dwordx4 v[8:11], v1, s[8:11], s13 offen sc1
    s_add_u32 s13, s13, 8192
    buffer_store_dwordx4 v[8:11], v1, s[8:11], s13 offen sc1
    s_add_u32 s13, s13, 8192
    s_mov_b32 s40, 14336
    s_add_u32 s84, s4, 0x300000
    s_addc_u32 s85, s5, 0
    s_mov_b32 s86, 0x4000
    s_mov_b32 s87, 0x20000
    v_mov_b32 v3, s40
    v_mov_b32 v4, 1
    s_waitcnt vmcnt(0)
    s_barrier
    s_cmp_lg_u32 s28, 0
    s_cbranch_scc1 g3_spare_cin
    s_mov_b64 exec, 1
    buffer_atomic_add v4, v3, s[84:87], 0 offen sc1
    s_mov_b64 exec, -1
g3_spare_cin:
    s_cmp_lg_u32 s96, 0
    s_cbranch_scc1 g3_spare_end
g3_spare_end:
    s_branch g4_in
.p2align 6
g4_in:
    s_cmp_ge_u32 s2, 256
    s_cbranch_scc1 g4_done
    s_load_dwordx2 s[4:5], s[0:1], 80
    s_load_dwordx2 s[6:7], s[0:1], 64
    s_load_dwordx2 s[30:31], s[0:1], 48
    s_load_dwordx2 s[34:35], s[0:1], 56
    v_lshrrev_b32 v1, 6, v0
    v_and_b32 v2, 63, v0
    s_bfe_u32 s40, s2, 0x10001
    s_lshl_b32 s40, s40, 2
    s_bfe_u32 s41, s2, 0x20003
    s_add_u32 s24, s40, s41
    s_bfe_u32 s40, s2, 0x10002
    s_lshl_b32 s40, s40, 3
    s_lshr_b32 s42, s2, 5
    s_add_u32 s25, s40, s42
    s_and_b32 s91, s2, 1
    s_add_u32 s27, s41, s42
    s_lshl_b32 s92, s24, 4
    s_add_u32 s92, s92, s25
    s_mul_i32 s26, s91, 28
    s_cmp_eq_u32 s96, 0
    s_cselect_b32 s95, 3, 1
    v_readfirstlane_b32 s28, v1
    s_nop 0
    s_cmp_lt_u32 s28, 4
    s_cbranch_scc1 g4_compute
    s_sub_u32 s28, s28, 4
    s_mov_b32 s40, 8192
    v_lshrrev_b32 v3, 3, v2
    v_mul_lo_u32 v3, v3, s40
    v_lshrrev_b32 v4, 4, v2
    v_xor_b32 v4, v4, v2
    v_and_b32 v4, 7, v4
    v_lshl_add_u32 v3, v4, 4, v3
    s_mul_i32 s41, s24, 1048576
    s_mul_i32 s42, s28, 262144
    s_add_u32 s41, s41, s42
    v_xor_b32 v4, 64, v3
    s_add_u32 s42, s41, 0
    v_add_u32 v10, s42, v3
    s_add_u32 s42, s41, 65536
    v_add_u32 v11, s42, v4
    s_add_u32 s42, s41, 131072
    v_add_u32 v12, s42, v3
    s_add_u32 s42, s41, 196608
    v_add_u32 v13, s42, v4
    s_mov_b32 s40, 4096
    v_lshrrev_b32 v4, 4, v2
    v_mul_lo_u32 v3, v4, s40
    v_lshlrev_b32 v4, 1, v4
    v_xor_b32 v4, v4, v2
    v_and_b32 v4, 15, v4
    v_lshl_add_u32 v3, v4, 4, v3
    s_mul_i32 s41, s25, 256
    s_mul_i32 s42, s28, 65536
    s_add_u32 s41, s41, s42
    v_xor_b32 v4, 128, v3
    s_add_u32 s42, s41, 0
    v_add_u32 v14, s42, v3
    s_add_u32 s42, s41, 16384
    v_add_u32 v15, s42, v3
    s_add_u32 s42, s41, 32768
    v_add_u32 v16, s42, v4
    s_add_u32 s42, s41, 49152
    v_add_u32 v17, s42, v4
    s_mul_i32 s36, s28, 4096
    s_mul_i32 s37, s28, 4096
    s_add_u32 s37, s37, 16384
    s_waitcnt lgkmcnt(0)
    s_add_u32 s4, s4, s97
    s_addc_u32 s5, s5, 0
    s_add_u32 s8, s4, 0x1100000
    s_addc_u32 s9, s5, 0
    s_mov_b32 s10, 0x800000
    s_mov_b32 s11, 0x20000
    s_mov_b32 s12, s30
    s_mov_b32 s13, s31
    s_mov_b32 s14, 0xe00000
    s_mov_b32 s15, 0x20000
    s_mov_b32 s32, 0
    s_mov_b32 s33, 0
g4_ld_pW:
    s_add_u32 s40, s32, s27
    s_and_b32 s40, s40, s95
    s_andn2_b32 s41, s32, s95
    s_or_b32 s40, s40, s41
    s_add_u32 s40, s40, s26
    s_mul_i32 s34, s40, 128
    s_mul_i32 s35, s40, 262144
    s_add_u32 s38, s33, s36
    s_add_u32 s39, s33, s37
    s_add_u32 m0, s39, 0
    s_nop 0
    buffer_load_dwordx4 v14, s[12:15], s35 offen lds
    s_add_u32 m0, s39, 1024
    s_nop 0
    buffer_load_dwordx4 v15, s[12:15], s35 offen lds
    s_add_u32 m0, s39, 2048
    s_nop 0
    buffer_load_dwordx4 v16, s[12:15], s35 offen lds
    s_add_u32 m0, s39, 3072
    s_nop 0
    buffer_load_dwordx4 v17, s[12:15], s35 offen lds
    s_add_u32 s33, s33, 32768
    s_add_u32 s32, s32, 1
    s_cmp_lt_u32 s32, 3
    s_cbranch_scc1 g4_ld_pW
    s_lshl_b32 s40, s24, 1
    s_add_u32 s40, s40, s91
    s_add_u32 s40, s40, 24
    s_lshl_b32 s40, s40, 8
    s_mov_b32 s42, 14336
    s_lshl_b32 s43, s96, 2
    s_add_u32 s43, s43, 4
    s_mov_b32 s41, 0x80000
    v_mov_b32 v24, 131072
    s_cmp_lg_u32 s28, 0
    s_cbranch_scc1 g4_dep_lds
    s_mov_b32 s41, 0x8000
    s_add_u32 s84, s4, 0x300000
    s_addc_u32 s85, s5, 0
    s_mov_b32 s86, 0x4000
    s_mov_b32 s87, 0x20000
    v_cmp_eq_u32 vcc, 1, v2
    v_mov_b32 v21, s40
    v_mov_b32 v23, s42
    v_cndmask_b32 v21, v21, v23, vcc
    v_mov_b32 v22, 14
    v_mov_b32 v23, 32
    v_cndmask_b32 v22, v22, v23, vcc
g4_dep:
    buffer_load_dword v23, v21, s[84:87], 0 offen sc1
    s_sub_u32 s41, s41, 1
    s_waitcnt vmcnt(0)
    v_cmp_lt_u32 vcc, v23, v22
    s_cmp_eq_u32 s41, 0
    s_cbranch_scc1 g4_dep_seen
    s_cbranch_vccz g4_dep_seen
    s_sleep 2
    s_branch g4_dep
g4_dep_seen:
    v_mov_b32 v23, s43
    ds_write_b32 v24, v23
    s_branch g4_dep_ok
g4_dep_lds:
    ds_read_b32 v23, v24
    s_sub_u32 s41, s41, 1
    s_waitcnt lgkmcnt(0)
    v_readfirstlane_b32 s40, v23
    s_cmp_eq_u32 s41, 0
    s_cbranch_scc1 g4_dep_ok
    s_cmp_eq_u32 s40, s43
    s_cbranch_scc1 g4_dep_ok
    s_sleep 1
    s_branch g4_dep_lds
g4_dep_ok:
    s_mov_b32 s32, 0
    s_mov_b32 s33, 0
g4_ld_pA:
    s_add_u32 s40, s32, s27
    s_and_b32 s40, s40, s95
    s_andn2_b32 s41, s32, s95
    s_or_b32 s40, s40, s41
    s_add_u32 s40, s40, s26
    s_mul_i32 s34, s40, 128
    s_mul_i32 s35, s40, 262144
    s_add_u32 s38, s33, s36
    s_add_u32 s39, s33, s37
    s_add_u32 m0, s38, 0
    s_nop 0
    buffer_load_dwordx4 v10, s[8:11], s34 offen sc1 lds
    s_add_u32 m0, s38, 1024
    s_nop 0
    buffer_load_dwordx4 v11, s[8:11], s34 offen sc1 lds
    s_add_u32 m0, s38, 2048
    s_nop 0
    buffer_load_dwordx4 v12, s[8:11], s34 offen sc1 lds
    s_add_u32 m0, s38, 3072
    s_nop 0
    buffer_load_dwordx4 v13, s[8:11], s34 offen sc1 lds
    s_add_u32 s33, s33, 32768
    s_add_u32 s32, s32, 1
    s_cmp_lt_u32 s32, 3
    s_cbranch_scc1 g4_ld_pA
    s_waitcnt vmcnt(8)
    s_branch g4_ld_bar
g4_ld_loop:
    s_cmp_eq_u32 s32, 4
    s_cbranch_scc1 g4_ld_s4
    s_waitcnt vmcnt(16)
g4_ld_bar:
    s_barrier
    s_add_u32 s40, s32, s27
    s_and_b32 s40, s40, s95
    s_andn2_b32 s41, s32, s95
    s_or_b32 s40, s40, s41
    s_add_u32 s40, s40, s26
    s_mul_i32 s34, s40, 128
    s_mul_i32 s35, s40, 262144
    s_add_u32 s38, s33, s36
    s_add_u32 s39, s33, s37
    s_add_u32 m0, s38, 0
    s_nop 0
    buffer_load_dwordx4 v10, s[8:11], s34 offen sc1 lds
    s_add_u32 m0, s38, 1024
    s_nop 0
    buffer_load_dwordx4 v11, s[8:11], s34 offen sc1 lds
    s_add_u32 m0, s38, 2048
    s_nop 0
    buffer_load_dwordx4 v12, s[8:11], s34 offen sc1 lds
    s_add_u32 m0, s38, 3072
    s_nop 0
    buffer_load_dwordx4 v13, s[8:11], s34 offen sc1 lds
    s_add_u32 m0, s39, 0
    s_nop 0
    buffer_load_dwordx4 v14, s[12:15], s35 offen lds
    s_add_u32 m0, s39, 1024
    s_nop 0
    buffer_load_dwordx4 v15, s[12:15], s35 offen lds
    s_add_u32 m0, s39, 2048
    s_nop 0
    buffer_load_dwordx4 v16, s[12:15], s35 offen lds
    s_add_u32 m0, s39, 3072
    s_nop 0
    buffer_load_dwordx4 v17, s[12:15], s35 offen lds
    s_add_u32 s33, s33, 32768
    s_add_u32 s32, s32, 1
    s_cmp_eq_u32 s33, 131072
    s_cselect_b32 s33, 0, s33
    s_cmp_lt_u32 s32, 28
    s_cbranch_scc1 g4_ld_loop
    s_waitcnt vmcnt(16)
    s_barrier
    s_waitcnt vmcnt(8)
    s_barrier
    s_waitcnt vmcnt(0)
    s_barrier
    s_branch g4_ld_end
g4_ld_s4:
    s_waitcnt vmcnt(12)
    s_branch g4_ld_bar
g4_ld_end:
    s_cmp_lg_u32 s96, 0
    s_cbranch_scc1 g4_done
    s_barrier
    s_mov_b32 s96, 1
    s_mov_b32 s97, 0x2800000
    s_branch g1_in
g4_done:
    s_endpgm
g4_compute:
    v_lshrrev_b32 v5, 4, v2
    v_bfe_u32 v6, v2, 2, 2
    v_and_b32 v7, 3, v2
    v_and_b32 v8, 15, v2
    s_and_b32 s44, s28, 1
    s_lshr_b32 s45, s28, 1
    s_mul_i32 s40, s25, 128
    s_mul_i32 s41, s45, 64
    s_add_u32 s40, s40, s41
    s_lshl_b32 s41, s91, 5
    s_add_u32 s40, s40, s41
    v_add_u32 v20, s40, v8
    s_mov_b32 s41, 2048
    v_mul_lo_u32 v9, v20, s41
    s_mul_i32 s40, s24, 256
    s_mul_i32 s41, s44, 128
    s_add_u32 s46, s40, s41
    v_and_b32 v3, 1, v5
    v_lshlrev_b32 v3, 5, v3
    v_lshrrev_b32 v4, 1, v5
    v_lshl_add_u32 v3, v4, 4, v3
    v_add3_u32 v9, v9, v3, s46
    s_mov_b32 s52, 0
    s_mov_b32 s53, 32768
    s_mov_b32 s54, 65536
    s_mov_b32 s55, 98304
    s_waitcnt lgkmcnt(0)
    s_add_u32 s4, s4, s97
    s_addc_u32 s5, s5, 0
    s_add_u32 s20, s4, 0x800000
    s_addc_u32 s21, s5, 0
    s_mov_b32 s22, 0x400000
    s_mov_b32 s23, 0x20000
    s_mov_b32 s56, s34
    s_mov_b32 s57, s35
    s_mov_b32 s58, 0x1000
    s_mov_b32 s59, 0x20000
    s_add_u32 s16, s4, 0x4100000
    s_addc_u32 s17, s5, 0
    s_cmp_eq_u32 s96, 0
    s_cselect_b32 s16, s16, s6
    s_cselect_b32 s17, s17, s7
    s_mov_b32 s18, 0x400000
    s_mov_b32 s19, 0x20000
    s_add_u32 s60, s4, 0x2800000
    s_addc_u32 s61, s5, 0
    s_mov_b32 s62, 0x40000
    s_mov_b32 s63, 0x20000
    s_add_u32 s84, s4, 0x1d00000
    s_addc_u32 s85, s5, 0
    s_mov_b32 s86, 0x400000
    s_mov_b32 s87, 0x20000
    s_mul_i32 s42, s44, 64
    v_lshrrev_b32 v3, 1, v8
    v_xor_b32 v3, v3, v5
    v_lshlrev_b32 v3, 4, v3
    v_lshl_add_u32 v3, v8, 7, v3
    s_lshl_b32 s40, s42, 7
    s_add_u32 s40, s40, 0
    v_add_u32 v10, s40, v3
    v_xor_b32 v11, 64, v10
    s_lshl_b32 s90, s91, 1
    s_mul_i32 s42, s45, 4
    s_mov_b32 s43, 16384
    v_and_b32 v3, 1, v5
    v_lshl_or_b32 v3, v3, 2, v6
    s_add_u32 s40, s42, 0
    s_xor_b32 s40, s40, s90
    v_xor_b32 v3, s40, v3
    v_lshlrev_b32 v3, 5, v3
    v_lshl_add_u32 v3, v7, 3, v3
    v_lshl_add_u32 v4, v5, 3, v6
    v_lshl_add_u32 v3, v4, 8, v3
    v_add_u32 v12, s43, v3
    v_and_b32 v3, 1, v5
    v_lshl_or_b32 v3, v3, 2, v6
    s_add_u32 s40, s42, 1
    s_xor_b32 s40, s40, s90
    v_xor_b32 v3, s40, v3
    v_lshlrev_b32 v3, 5, v3
    v_lshl_add_u32 v3, v7, 3, v3
    v_lshl_add_u32 v4, v5, 3, v6
    v_lshl_add_u32 v3, v4, 8, v3
    v_add_u32 v13, s43, v3
    v_and_b32 v3, 1, v5
    v_lshl_or_b32 v3, v3, 2, v6
    s_add_u32 s40, s42, 2
    s_xor_b32 s40, s40, s90
    v_xor_b32 v3, s40, v3
    v_lshlrev_b32 v3, 5, v3
    v_lshl_add_u32 v3, v7, 3, v3
    v_lshl_add_u32 v4, v5, 3, v6
    v_lshl_add_u32 v3, v4, 8, v3
    v_add_u32 v14, s43, v3
    v_and_b32 v3, 1, v5
    v_lshl_or_b32 v3, v3, 2, v6
    s_add_u32 s40, s42, 3
    s_xor_b32 s40, s40, s90
    v_xor_b32 v3, s40, v3
    v_lshlrev_b32 v3, 5, v3
    v_lshl_add_u32 v3, v7, 3, v3
    v_lshl_add_u32 v4, v5, 3, v6
    v_lshl_add_u32 v3, v4, 8, v3
    v_add_u32 v15, s43, v3
    v_mov_b32 v124, 0
    v_mov_b32 v125, 0
    v_mov_b32 v126, 0
    v_mov_b32 v127, 0
    v_mov_b32 v128, 0
    v_mov_b32 v129, 0
    v_mov_b32 v130, 0
    v_mov_b32 v131, 0
    v_mov_b32 v132, 0
    v_mov_b32 v133, 0
    v_mov_b32 v134, 0
    v_mov_b32 v135, 0
    v_mov_b32 v136, 0
    v_mov_b32 v137, 0
    v_mov_b32 v138, 0
    v_mov_b32 v139, 0
    v_mov_b32 v140, 0
    v_mov_b32 v141, 0
    v_mov_b32 v142, 0
    v_mov_b32 v143, 0
    v_mov_b32 v144, 0
    v_mov_b32 v145, 0
    v_mov_b32 v146, 0
    v_mov_b32 v147, 0
    v_mov_b32 v148, 0
    v_mov_b32 v149, 0
    v_mov_b32 v150, 0
    v_mov_b32 v151, 0
    v_mov_b32 v152, 0
    v_mov_b32 v153, 0
    v_mov_b32 v154, 0
    v_mov_b32 v155, 0
    s_mov_b32 s48, 28
    s_mov_b32 s50, 0
    s_mov_b32 s51, 32768
    s_mov_b32 s29, 0xfffe8000
    s_lshl_b32 s40, s28, 12
    v_lshl_add_u32 v21, v2, 4, s40
    s_lshl_b32 s93, s92, 1
    s_add_u32 s93, s93, s91
    s_lshl_b32 s93, s93, 14
    s_xor_b32 s94, s93, 0x4000
    v_mov_b32 v28, 0
    v_mov_b32 v29, 0
    v_mov_b32 v30, 0
    v_mov_b32 v31, 0
    v_mov_b32 v32, 0
    v_mov_b32 v33, 0
    v_mov_b32 v34, 0
    v_mov_b32 v35, 0
    v_mov_b32 v36, 0
    v_mov_b32 v37, 0
    v_mov_b32 v38, 0
    v_mov_b32 v39, 0
    v_mov_b32 v40, 0
    v_mov_b32 v41, 0
    v_mov_b32 v42, 0
    v_mov_b32 v43, 0
    v_mov_b32 v44, 0
    v_mov_b32 v45, 0
    v_mov_b32 v46, 0
    v_mov_b32 v47, 0
    v_mov_b32 v48, 0
    v_mov_b32 v49, 0
    v_mov_b32 v50, 0
    v_mov_b32 v51, 0
    v_mov_b32 v52, 0
    v_mov_b32 v53, 0
    v_mov_b32 v54, 0
    v_mov_b32 v55, 0
    v_mov_b32 v56, 0
    v_mov_b32 v57, 0
    v_mov_b32 v58, 0
    v_mov_b32 v59, 0
    v_mov_b32 v60, 0
    v_mov_b32 v61, 0
    v_mov_b32 v62, 0
    v_mov_b32 v63, 0
    v_mov_b32 v64, 0
    v_mov_b32 v65, 0
    v_mov_b32 v66, 0
    v_mov_b32 v67, 0
    v_mov_b32 v68, 0
    v_mov_b32 v69, 0
    v_mov_b32 v70, 0
    v_mov_b32 v71, 0
    v_mov_b32 v72, 0
    v_mov_b32 v73, 0
    v_mov_b32 v74, 0
    v_mov_b32 v75, 0
    v_mov_b32 v76, 0
    v_mov_b32 v77, 0
    v_mov_b32 v78, 0
    v_mov_b32 v79, 0
    v_mov_b32 v80, 0
    v_mov_b32 v81, 0
    v_mov_b32 v82, 0
    v_mov_b32 v83, 0
    v_mov_b32 v84, 0
    v_mov_b32 v85, 0
    v_mov_b32 v86, 0
    v_mov_b32 v87, 0
    v_mov_b32 v88, 0
    v_mov_b32 v89, 0
    v_mov_b32 v90, 0
    v_mov_b32 v91, 0
    s_barrier
    buffer_load_dwordx4 v[188:191], v9, s[20:23], s52 offen offset:0 sc1
    buffer_load_dwordx4 v[192:195], v9, s[20:23], s52 offen offset:64 sc1
    buffer_load_dwordx4 v[196:199], v9, s[20:23], s53 offen offset:0 sc1
    buffer_load_dwordx4 v[200:203], v9, s[20:23], s53 offen offset:64 sc1
    v_lshlrev_b32 v3, 1, v20
    buffer_load_ushort v22, v3, s[56:59], 0 offen offset:0
    buffer_load_ushort v23, v3, s[56:59], 0 offen offset:32
    s_branch g4_cloop2
.p2align 3
g4_cloop:
    s_barrier
g4_cloop2:
    v_mfma_f32_16x16x32_bf16 v[28:31], v[124:127], v[140:143], v[28:31]
    ds_read_b128 v[92:95], v10 offset:0
    v_mfma_f32_16x16x32_bf16 v[32:35], v[124:127], v[144:147], v[32:35]
    ds_read_b64_tr_b16 v[108:109], v12 offset:0
    ds_read_b64_tr_b16 v[110:111], v12 offset:1024
    v_mfma_f32_16x16x32_bf16 v[36:39], v[124:127], v[148:151], v[36:39]
    ds_read_b64_tr_b16 v[112:113], v13 offset:0
    ds_read_b64_tr_b16 v[114:115], v13 offset:1024
    v_mfma_f32_16x16x32_bf16 v[40:43], v[124:127], v[152:155], v[40:43]
    ds_read_b64_tr_b16 v[116:117], v14 offset:0
    ds_read_b64_tr_b16 v[118:119], v14 offset:1024
    v_mfma_f32_16x16x32_bf16 v[44:47], v[128:131], v[140:143], v[44:47]
    ds_read_b64_tr_b16 v[120:121], v15 offset:0
    ds_read_b64_tr_b16 v[122:123], v15 offset:1024
    v_mfma_f32_16x16x32_bf16 v[48:51], v[128:131], v[144:147], v[48:51]
    ds_read_b128 v[96:99], v10 offset:2048
    v_mfma_f32_16x16x32_bf16 v[52:55], v[128:131], v[148:151], v[52:55]
    ds_read_b128 v[100:103], v10 offset:4096
    v_mfma_f32_16x16x32_bf16 v[56:59], v[128:131], v[152:155], v[56:59]
    ds_read_b128 v[104:107], v10 offset:6144
    v_mfma_f32_16x16x32_bf16 v[60:63], v[132:135], v[140:143], v[60:63]
    v_mfma_f32_16x16x32_bf16 v[64:67], v[132:135], v[144:147], v[64:67]
    v_mfma_f32_16x16x32_bf16 v[68:71], v[132:135], v[148:151], v[68:71]
    v_mfma_f32_16x16x32_bf16 v[72:75], v[132:135], v[152:155], v[72:75]
    v_mfma_f32_16x16x32_bf16 v[76:79], v[136:139], v[140:143], v[76:79]
    v_mfma_f32_16x16x32_bf16 v[80:83], v[136:139], v[144:147], v[80:83]
    v_mfma_f32_16x16x32_bf16 v[84:87], v[136:139], v[148:151], v[84:87]
    v_mfma_f32_16x16x32_bf16 v[88:91], v[136:139], v[152:155], v[88:91]
    s_waitcnt lgkmcnt(0)
    v_mfma_f32_16x16x32_bf16 v[28:31], v[92:95], v[108:111], v[28:31]
    ds_read_b128 v[124:127], v11 offset:0
    v_mfma_f32_16x16x32_bf16 v[32:35], v[92:95], v[112:115], v[32:35]
    ds_read_b64_tr_b16 v[140:141], v12 offset:8192
    ds_read_b64_tr_b16 v[142:143], v12 offset:9216
    v_mfma_f32_16x16x32_bf16 v[36:39], v[92:95], v[116:119], v[36:39]
    ds_read_b64_tr_b16 v[144:145], v13 offset:8192
    ds_read_b64_tr_b16 v[146:147], v13 offset:9216
    v_mfma_f32_16x16x32_bf16 v[40:43], v[92:95], v[120:123], v[40:43]
    ds_read_b64_tr_b16 v[148:149], v14 offset:8192
    ds_read_b64_tr_b16 v[150:151], v14 offset:9216
    v_mfma_f32_16x16x32_bf16 v[44:47], v[96:99], v[108:111], v[44:47]
    ds_read_b64_tr_b16 v[152:153], v15 offset:8192
    ds_read_b64_tr_b16 v[154:155], v15 offset:9216
    v_mfma_f32_16x16x32_bf16 v[48:51], v[96:99], v[112:115], v[48:51]
    ds_read_b128 v[128:131], v11 offset:2048
    v_mfma_f32_16x16x32_bf16 v[52:55], v[96:99], v[116:119], v[52:55]
    ds_read_b128 v[132:135], v11 offset:4096
    v_mfma_f32_16x16x32_bf16 v[56:59], v[96:99], v[120:123], v[56:59]
    ds_read_b128 v[136:139], v11 offset:6144
    v_mfma_f32_16x16x32_bf16 v[60:63], v[100:103], v[108:111], v[60:63]
    s_add_u32 s50, s50, 1
    s_cmp_eq_u32 s50, 4
    v_mfma_f32_16x16x32_bf16 v[64:67], v[100:103], v[112:115], v[64:67]
    s_cselect_b32 s49, s29, s51
    s_cselect_b32 s50, 0, s50
    v_mfma_f32_16x16x32_bf16 v[68:71], v[100:103], v[116:119], v[68:71]
    v_add_u32 v10, s49, v10
    v_add_u32 v11, s49, v11
    v_mfma_f32_16x16x32_bf16 v[72:75], v[100:103], v[120:123], v[72:75]
    v_add_u32 v12, s49, v12
    v_add_u32 v13, s49, v13
    v_mfma_f32_16x16x32_bf16 v[76:79], v[104:107], v[108:111], v[76:79]
    v_add_u32 v14, s49, v14
    v_add_u32 v15, s49, v15
    v_mfma_f32_16x16x32_bf16 v[80:83], v[104:107], v[112:115], v[80:83]
    s_sub_u32 s48, s48, 1
    s_cmp_lg_u32 s48, 0
    v_mfma_f32_16x16x32_bf16 v[84:87], v[104:107], v[116:119], v[84:87]
    v_mfma_f32_16x16x32_bf16 v[88:91], v[104:107], v[120:123], v[88:91]
    s_waitcnt lgkmcnt(0)
    s_cbranch_scc1 g4_cloop
    v_mfma_f32_16x16x32_bf16 v[36:39], v[124:127], v[148:151], v[36:39]
    v_mfma_f32_16x16x32_bf16 v[52:55], v[128:131], v[148:151], v[52:55]
    v_mfma_f32_16x16x32_bf16 v[68:71], v[132:135], v[148:151], v[68:71]
    v_mfma_f32_16x16x32_bf16 v[84:87], v[136:139], v[148:151], v[84:87]
    v_mfma_f32_16x16x32_bf16 v[40:43], v[124:127], v[152:155], v[40:43]
    v_mfma_f32_16x16x32_bf16 v[56:59], v[128:131], v[152:155], v[56:59]
    v_mfma_f32_16x16x32_bf16 v[72:75], v[132:135], v[152:155], v[72:75]
    v_mfma_f32_16x16x32_bf16 v[88:91], v[136:139], v[152:155], v[88:91]
    v_mfma_f32_16x16x32_bf16 v[28:31], v[124:127], v[140:143], v[28:31]
    v_cvt_pk_bf16_f32 v156, v36, v37
    v_cvt_pk_bf16_f32 v157, v38, v39
    v_mfma_f32_16x16x32_bf16 v[44:47], v[128:131], v[140:143], v[44:47]
    v_cvt_pk_bf16_f32 v158, v52, v53
    v_cvt_pk_bf16_f32 v159, v54, v55
    buffer_store_dwordx4 v[156:159], v21, s[84:87], s93 offen offset:0 sc1
    v_mfma_f32_16x16x32_bf16 v[60:63], v[132:135], v[140:143], v[60:63]
    v_cvt_pk_bf16_f32 v160, v68, v69
    v_cvt_pk_bf16_f32 v161, v70, v71
    v_mfma_f32_16x16x32_bf16 v[76:79], v[136:139], v[140:143], v[76:79]
    v_cvt_pk_bf16_f32 v162, v84, v85
    v_cvt_pk_bf16_f32 v163, v86, v87
    buffer_store_dwordx4 v[160:163], v21, s[84:87], s93 offen offset:1024 sc1
    v_mfma_f32_16x16x32_bf16 v[32:35], v[124:127], v[144:147], v[32:35]
    v_cvt_pk_bf16_f32 v164, v40, v41
    v_cvt_pk_bf16_f32 v165, v42, v43
    v_mfma_f32_16x16x32_bf16 v[48:51], v[128:131], v[144:147], v[48:51]
    v_cvt_pk_bf16_f32 v166, v56, v57
    v_cvt_pk_bf16_f32 v167, v58, v59
    buffer_store_dwordx4 v[164:167], v21, s[84:87], s93 offen offset:2048 sc1
    v_mfma_f32_16x16x32_bf16 v[64:67], v[132:135], v[144:147], v[64:67]
    v_cvt_pk_bf16_f32 v168, v72, v73
    v_cvt_pk_bf16_f32 v169, v74, v75
    v_mfma_f32_16x16x32_bf16 v[80:83], v[136:139], v[144:147], v[80:83]
    s_nop 1
    v_cvt_pk_bf16_f32 v170, v88, v89
    v_cvt_pk_bf16_f32 v171, v90, v91
    buffer_store_dwordx4 v[168:171], v21, s[84:87], s93 offen offset:3072 sc1
    s_mov_b32 s48, 0x2000
    buffer_load_dwordx4 v[172:175], v21, s[84:87], s94 offen offset:0 sc1
    buffer_load_dwordx4 v[176:179], v21, s[84:87], s94 offen offset:1024 sc1
    buffer_load_dwordx4 v[180:183], v21, s[84:87], s94 offen offset:2048 sc1
    buffer_load_dwordx4 v[184:187], v21, s[84:87], s94 offen offset:3072 sc1
    s_waitcnt vmcnt(8)
    s_nop 3
    v_permlane16_swap_b32 v188, v190
    v_permlane16_swap_b32 v189, v191
    v_permlane16_swap_b32 v192, v194
    v_permlane16_swap_b32 v193, v195
    v_permlane16_swap_b32 v196, v198
    v_permlane16_swap_b32 v197, v199
    v_permlane16_swap_b32 v200, v202
    v_permlane16_swap_b32 v201, v203
    v_lshlrev_b32 v22, 16, v22
    v_lshlrev_b32 v23, 16, v23
    v_lshlrev_b32 v204, 16, v188
    v_and_b32 v205, 0xffff0000, v188
    v_lshlrev_b32 v206, 16, v189
    v_and_b32 v207, 0xffff0000, v189
    v_lshlrev_b32 v208, 16, v190
    v_and_b32 v209, 0xffff0000, v190
    v_lshlrev_b32 v210, 16, v191
    v_and_b32 v211, 0xffff0000, v191
    v_add_f32 v204, v204, v22
    v_add_f32 v205, v205, v22
    v_add_f32 v206, v206, v22
    v_add_f32 v207, v207, v22
    v_add_f32 v208, v208, v22
    v_add_f32 v209, v209, v22
    v_add_f32 v210, v210, v22
    v_add_f32 v211, v211, v22
    v_pk_add_f32 v[28:29], v[28:29], v[204:205]
    v_pk_add_f32 v[30:31], v[30:31], v[206:207]
    v_pk_add_f32 v[44:45], v[44:45], v[208:209]
    v_pk_add_f32 v[46:47], v[46:47], v[210:211]
    v_lshlrev_b32 v204, 16, v192
    v_and_b32 v205, 0xffff0000, v192
    v_lshlrev_b32 v206, 16, v193
    v_and_b32 v207, 0xffff0000, v193
    v_lshlrev_b32 v208, 16, v194
    v_and_b32 v209, 0xffff0000, v194
    v_lshlrev_b32 v210, 16, v195
    v_and_b32 v211, 0xffff0000, v195
    v_add_f32 v204, v204, v22
    v_add_f32 v205, v205, v22
    v_add_f32 v206, v206, v22
    v_add_f32 v207, v207, v22
    v_add_f32 v208, v208, v22
    v_add_f32 v209, v209, v22
    v_add_f32 v210, v210, v22
    v_add_f32 v211, v211, v22
    v_pk_add_f32 v[60:61], v[60:61], v[204:205]
    v_pk_add_f32 v[62:63], v[62:63], v[206:207]
    v_pk_add_f32 v[76:77], v[76:77], v[208:209]
    v_pk_add_f32 v[78:79], v[78:79], v[210:211]
    v_lshlrev_b32 v204, 16, v196
    v_and_b32 v205, 0xffff0000, v196
    v_lshlrev_b32 v206, 16, v197
    v_and_b32 v207, 0xffff0000, v197
    v_lshlrev_b32 v208, 16, v198
    v_and_b32 v209, 0xffff0000, v198
    v_lshlrev_b32 v210, 16, v199
    v_and_b32 v211, 0xffff0000, v199
    v_add_f32 v204, v204, v23
    v_add_f32 v205, v205, v23
    v_add_f32 v206, v206, v23
    v_add_f32 v207, v207, v23
    v_add_f32 v208, v208, v23
    v_add_f32 v209, v209, v23
    v_add_f32 v210, v210, v23
    v_add_f32 v211, v211, v23
    v_pk_add_f32 v[32:33], v[32:33], v[204:205]
    v_pk_add_f32 v[34:35], v[34:35], v[206:207]
    v_pk_add_f32 v[48:49], v[48:49], v[208:209]
    v_pk_add_f32 v[50:51], v[50:51], v[210:211]
    v_lshlrev_b32 v204, 16, v200
    v_and_b32 v205, 0xffff0000, v200
    v_lshlrev_b32 v206, 16, v201
    v_and_b32 v207, 0xffff0000, v201
    v_lshlrev_b32 v208, 16, v202
    v_and_b32 v209, 0xffff0000, v202
    v_lshlrev_b32 v210, 16, v203
    v_and_b32 v211, 0xffff0000, v203
    v_add_f32 v204, v204, v23
    v_add_f32 v205, v205, v23
    v_add_f32 v206, v206, v23
    v_add_f32 v207, v207, v23
    v_add_f32 v208, v208, v23
    v_add_f32 v209, v209, v23
    v_add_f32 v210, v210, v23
    v_add_f32 v211, v211, v23
    v_pk_add_f32 v[64:65], v[64:65], v[204:205]
    v_pk_add_f32 v[66:67], v[66:67], v[206:207]
    v_pk_add_f32 v[80:81], v[80:81], v[208:209]
    v_pk_add_f32 v[82:83], v[82:83], v[210:211]
    s_waitcnt vmcnt(0)
g4_rcv:
    v_max3_u32 v4, v172, v173, v174
    v_max3_u32 v4, v4, v175, v176
    v_max3_u32 v4, v4, v177, v178
    v_max3_u32 v4, v4, v179, v180
    v_max3_u32 v4, v4, v181, v182
    v_max3_u32 v4, v4, v183, v184
    v_max3_u32 v4, v4, v185, v186
    v_max_u32 v4, v4, v187
    v_cmp_eq_u32 vcc, -1, v4
    s_sub_u32 s48, s48, 1
    s_cmp_eq_u32 s48, 0
    s_cbranch_scc1 g4_rcvd
    s_cbranch_vccz g4_rcvd
    s_sleep 2
    buffer_load_dwordx4 v[172:175], v21, s[84:87], s94 offen offset:0 sc1
    buffer_load_dwordx4 v[176:179], v21, s[84:87], s94 offen offset:1024 sc1
    buffer_load_dwordx4 v[180:183], v21, s[84:87], s94 offen offset:2048 sc1
    buffer_load_dwordx4 v[184:187], v21, s[84:87], s94 offen offset:3072 sc1
    s_waitcnt vmcnt(0)
    s_branch g4_rcv
g4_rcvd:
    v_lshlrev_b32 v108, 16, v172
    v_and_b32 v109, 0xffff0000, v172
    v_lshlrev_b32 v110, 16, v173
    v_and_b32 v111, 0xffff0000, v173
    v_pk_add_f32 v[28:29], v[28:29], v[108:109]
    v_pk_add_f32 v[30:31], v[30:31], v[110:111]
    v_lshlrev_b32 v112, 16, v174
    v_and_b32 v113, 0xffff0000, v174
    v_lshlrev_b32 v114, 16, v175
    v_and_b32 v115, 0xffff0000, v175
    v_pk_add_f32 v[44:45], v[44:45], v[112:113]
    v_pk_add_f32 v[46:47], v[46:47], v[114:115]
    v_lshlrev_b32 v116, 16, v176
    v_and_b32 v117, 0xffff0000, v176
    v_lshlrev_b32 v118, 16, v177
    v_and_b32 v119, 0xffff0000, v177
    v_pk_add_f32 v[60:61], v[60:61], v[116:117]
    v_pk_add_f32 v[62:63], v[62:63], v[118:119]
    v_lshlrev_b32 v120, 16, v178
    v_and_b32 v121, 0xffff0000, v178
    v_lshlrev_b32 v122, 16, v179
    v_and_b32 v123, 0xffff0000, v179
    v_pk_add_f32 v[76:77], v[76:77], v[120:121]
    v_pk_add_f32 v[78:79], v[78:79], v[122:123]
    v_lshlrev_b32 v108, 16, v180
    v_and_b32 v109, 0xffff0000, v180
    v_lshlrev_b32 v110, 16, v181
    v_and_b32 v111, 0xffff0000, v181
    v_pk_add_f32 v[32:33], v[32:33], v[108:109]
    v_pk_add_f32 v[34:35], v[34:35], v[110:111]
    v_lshlrev_b32 v112, 16, v182
    v_and_b32 v113, 0xffff0000, v182
    v_lshlrev_b32 v114, 16, v183
    v_and_b32 v115, 0xffff0000, v183
    v_pk_add_f32 v[48:49], v[48:49], v[112:113]
    v_pk_add_f32 v[50:51], v[50:51], v[114:115]
    v_lshlrev_b32 v116, 16, v184
    v_and_b32 v117, 0xffff0000, v184
    v_lshlrev_b32 v118, 16, v185
    v_and_b32 v119, 0xffff0000, v185
    v_pk_add_f32 v[64:65], v[64:65], v[116:117]
    v_pk_add_f32 v[66:67], v[66:67], v[118:119]
    v_lshlrev_b32 v120, 16, v186
    v_and_b32 v121, 0xffff0000, v186
    v_lshlrev_b32 v122, 16, v187
    v_and_b32 v123, 0xffff0000, v187
    v_pk_add_f32 v[80:81], v[80:81], v[120:121]
    v_pk_add_f32 v[82:83], v[82:83], v[122:123]
    v_cvt_pk_bf16_f32 v92, v28, v29
    v_cvt_pk_bf16_f32 v93, v30, v31
    v_cvt_pk_bf16_f32 v94, v44, v45
    v_cvt_pk_bf16_f32 v95, v46, v47
    s_nop 1
    v_permlane16_swap_b32 v92, v94
    v_permlane16_swap_b32 v93, v95
    buffer_store_dwordx4 v[92:95], v9, s[16:19], s52 offen offset:0 sc1
    v_cvt_pk_bf16_f32 v96, v60, v61
    v_cvt_pk_bf16_f32 v97, v62, v63
    v_cvt_pk_bf16_f32 v98, v76, v77
    v_cvt_pk_bf16_f32 v99, v78, v79
    s_nop 1
    v_permlane16_swap_b32 v96, v98
    v_permlane16_swap_b32 v97, v99
    buffer_store_dwordx4 v[96:99], v9, s[16:19], s52 offen offset:64 sc1
    v_cvt_pk_bf16_f32 v100, v32, v33
    v_cvt_pk_bf16_f32 v101, v34, v35
    v_cvt_pk_bf16_f32 v102, v48, v49
    v_cvt_pk_bf16_f32 v103, v50, v51
    s_nop 1
    v_permlane16_swap_b32 v100, v102
    v_permlane16_swap_b32 v101, v103
    buffer_store_dwordx4 v[100:103], v9, s[16:19], s53 offen offset:0 sc1
    v_cvt_pk_bf16_f32 v104, v64, v65
    v_cvt_pk_bf16_f32 v105, v66, v67
    v_cvt_pk_bf16_f32 v106, v80, v81
    v_cvt_pk_bf16_f32 v107, v82, v83
    s_nop 1
    v_permlane16_swap_b32 v104, v106
    v_permlane16_swap_b32 v105, v107
    buffer_store_dwordx4 v[104:107], v9, s[16:19], s53 offen offset:64 sc1
    v_pk_add_f32 v[108:109], v[28:29], v[30:31]
    v_pk_mul_f32 v[110:111], v[28:29], v[28:29]
    v_pk_fma_f32 v[110:111], v[30:31], v[30:31], v[110:111]
    v_pk_add_f32 v[108:109], v[108:109], v[44:45]
    v_pk_fma_f32 v[110:111], v[44:45], v[44:45], v[110:111]
    v_pk_add_f32 v[108:109], v[108:109], v[46:47]
    v_pk_fma_f32 v[110:111], v[46:47], v[46:47], v[110:111]
    v_pk_add_f32 v[108:109], v[108:109], v[60:61]
    v_pk_fma_f32 v[110:111], v[60:61], v[60:61], v[110:111]
    v_pk_add_f32 v[108:109], v[108:109], v[62:63]
    v_pk_fma_f32 v[110:111], v[62:63], v[62:63], v[110:111]
    v_pk_add_f32 v[108:109], v[108:109], v[76:77]
    v_pk_fma_f32 v[110:111], v[76:77], v[76:77], v[110:111]
    v_pk_add_f32 v[108:109], v[108:109], v[78:79]
    v_pk_fma_f32 v[110:111], v[78:79], v[78:79], v[110:111]
    v_pk_add_f32 v[112:113], v[32:33], v[34:35]
    v_pk_mul_f32 v[114:115], v[32:33], v[32:33]
    v_pk_fma_f32 v[114:115], v[34:35], v[34:35], v[114:115]
    v_pk_add_f32 v[112:113], v[112:113], v[48:49]
    v_pk_fma_f32 v[114:115], v[48:49], v[48:49], v[114:115]
    v_pk_add_f32 v[112:113], v[112:113], v[50:51]
    v_pk_fma_f32 v[114:115], v[50:51], v[50:51], v[114:115]
    v_pk_add_f32 v[112:113], v[112:113], v[64:65]
    v_pk_fma_f32 v[114:115], v[64:65], v[64:65], v[114:115]
    v_pk_add_f32 v[112:113], v[112:113], v[66:67]
    v_pk_fma_f32 v[114:115], v[66:67], v[66:67], v[114:115]
    v_pk_add_f32 v[112:113], v[112:113], v[80:81]
    v_pk_fma_f32 v[114:115], v[80:81], v[80:81], v[114:115]
    v_pk_add_f32 v[112:113], v[112:113], v[82:83]
    v_pk_fma_f32 v[114:115], v[82:83], v[82:83], v[114:115]
    v_add_f32 v108, v108, v109
    v_add_f32 v109, v110, v111
    v_add_f32 v112, v112, v113
    v_add_f32 v113, v114, v115
    s_nop 1
    v_permlane16_swap_b32 v108, v112
    v_permlane16_swap_b32 v109, v113
    v_pk_add_f32 v[108:109], v[108:109], v[112:113]
    v_mov_b32 v116, v108
    v_mov_b32 v117, v109
    v_and_b32 v3, 16, v2
    v_add_u32 v3, v3, v20
    v_permlane32_swap_b32 v108, v116
    v_permlane32_swap_b32 v109, v117
    v_pk_add_f32 v[108:109], v[108:109], v[116:117]
    v_lshlrev_b32 v3, 3, v3
    s_mul_i32 s40, s24, 2
    s_add_u32 s40, s40, s44
    s_lshl_b32 s40, s40, 14
    s_mov_b32 exec_hi, 0
    buffer_store_dwordx2 v[108:109], v3, s[60:63], s40 offen sc1
    s_mov_b32 exec_hi, -1
    s_cmp_lg_u32 s96, 0
    s_cbranch_scc1 g4_done
    s_lshr_b32 s40, s25, 0
    s_add_u32 s40, s40, 40
    s_lshl_b32 s40, s40, 8
    s_mov_b32 s42, s40
    s_add_u32 s84, s4, 0x2b00000
    s_addc_u32 s85, s5, 0
    s_mov_b32 s86, 0x4000
    s_mov_b32 s87, 0x20000
    v_mov_b32 v3, s40
    v_mov_b32 v4, 1
    s_waitcnt vmcnt(0)
    s_barrier
    s_cmp_lg_u32 s28, 0
    s_cbranch_scc1 g4_cin
    s_mov_b64 exec, 1
    buffer_atomic_add v4, v3, s[84:87], 0 offen sc1
    s_mov_b64 exec, -1
g4_cin:
    s_mov_b32 s96, 1
    s_mov_b32 s97, 0x2800000
    s_branch g1_in
code_end:
.section .rodata,"a"
.p2align 6
.amdhsa_kernel g1a_kernel
  .amdhsa_next_free_vgpr 248
  .amdhsa_next_free_sgpr 100
  .amdhsa_accum_offset 248
  .amdhsa_group_segment_fixed_size 0
  .amdhsa_kernarg_size 88
  .amdhsa_user_sgpr_count 2
  .amdhsa_user_sgpr_kernarg_segment_ptr 1
  .amdhsa_system_sgpr_workgroup_id_x 1
.end_amdhsa_kernel
```

```asm
; @launch kernel=g1a_kernel grid=(256,1,1) block=(512,1,1) lds=131328
.amdgcn_target "amdgcn-amd-amdhsa--gfx950"
.text
.globl g1a_kernel
.p2align 8
.type g1a_kernel,@function
g1a_kernel:
    s_mov_b32 s96, 0
    s_mov_b32 s97, 0x0
    v_mov_b32 v1, 131072
    v_mov_b32 v2, 0
    ds_write_b32 v1, v2
    s_branch g1_in
.p2align 6
g1_in:
    s_cmp_ge_u32 s2, 256
    s_cbranch_scc1 g1_done
    s_load_dwordx2 s[4:5], s[0:1], 80
    s_load_dwordx2 s[6:7], s[0:1], 0
    s_xor_b32 s53, s96, 1
    s_load_dwordx2 s[30:31], s[0:1], 8
    s_load_dwordx2 s[16:17], s[0:1], 72
    s_load_dwordx2 s[18:19], s[0:1], 16
    v_lshrrev_b32 v1, 6, v0
    v_and_b32 v2, 63, v0
    s_and_b32 s40, s2, 1
    s_lshl_b32 s40, s40, 3
    s_bfe_u32 s41, s2, 0x30003
    s_add_u32 s25, s40, s41
    s_bfe_u32 s40, s2, 0x20001
    s_lshl_b32 s40, s40, 2
    s_lshr_b32 s42, s2, 6
    s_add_u32 s24, s40, s42
    s_add_u32 s27, s41, s42
    s_add_u32 s52, s24, s25
    s_and_b32 s52, s52, 15
    s_and_b32 s26, s52, 12
    s_mul_i32 s26, s26, s53
    v_readfirstlane_b32 s28, v1
    v_lshrrev_b32 v5, 4, v2
    v_bfe_u32 v6, v2, 2, 2
    v_and_b32 v7, 3, v2
    v_and_b32 v8, 15, v2
    s_cmp_lt_u32 s28, 4
    s_cbranch_scc1 g1_compute
    s_sub_u32 s28, s28, 4
    s_mov_b32 s40, 2048
    v_lshrrev_b32 v3, 3, v2
    v_mul_lo_u32 v3, v3, s40
    v_lshrrev_b32 v4, 4, v2
    v_xor_b32 v4, v4, v2
    v_and_b32 v4, 7, v4
    v_lshl_add_u32 v3, v4, 4, v3
    s_mul_i32 s41, s25, 262144
    s_mul_i32 s42, s28, 65536
    s_add_u32 s41, s41, s42
    v_xor_b32 v4, 64, v3
    s_add_u32 s42, s41, 0
    v_add_u32 v16, s42, v3
    s_add_u32 s42, s41, 16384
    v_add_u32 v17, s42, v4
    s_add_u32 s42, s41, 32768
    v_add_u32 v18, s42, v3
    s_add_u32 s42, s41, 49152
    v_add_u32 v19, s42, v4
    s_mov_b32 s40, 6144
    v_lshrrev_b32 v3, 3, v2
    v_mul_lo_u32 v3, v3, s40
    v_bfe_u32 v4, v2, 4, 1
    v_lshlrev_b32 v4, 1, v4
    v_xor_b32 v4, v4, v2
    v_and_b32 v4, 7, v4
    v_lshl_add_u32 v3, v4, 4, v3
    s_mul_i32 s41, s24, 128
    s_mul_i32 s42, s28, 98304
    s_add_u32 s41, s41, s42
    v_xor_b32 v4, 64, v3
    s_add_u32 s42, s41, 0
    v_add_u32 v10, s42, v3
    s_add_u32 s42, s41, 49152
    v_add_u32 v11, s42, v4
    s_mov_b32 s40, 6144
    v_lshrrev_b32 v3, 3, v2
    v_mul_lo_u32 v3, v3, s40
    v_bfe_u32 v4, v2, 4, 1
    v_lshlrev_b32 v4, 1, v4
    v_xor_b32 v4, v4, v2
    v_and_b32 v4, 7, v4
    v_lshl_add_u32 v3, v4, 4, v3
    s_mul_i32 s41, s24, 128
    s_mul_i32 s42, s28, 98304
    s_add_u32 s41, s41, s42
    v_xor_b32 v4, 64, v3
    s_add_u32 s42, s41, 2048
    v_add_u32 v12, s42, v3
    s_add_u32 s42, s41, 51200
    v_add_u32 v13, s42, v4
    s_mov_b32 s40, 6144
    v_lshrrev_b32 v3, 3, v2
    v_mul_lo_u32 v3, v3, s40
    v_bfe_u32 v4, v2, 4, 1
    v_lshlrev_b32 v4, 1, v4
    v_xor_b32 v4, v4, v2
    v_and_b32 v4, 7, v4
    v_lshl_add_u32 v3, v4, 4, v3
    s_mul_i32 s41, s24, 128
    s_mul_i32 s42, s28, 98304
    s_add_u32 s41, s41, s42
    v_xor_b32 v4, 64, v3
    s_add_u32 s42, s41, 4096
    v_add_u32 v14, s42, v3
    s_add_u32 s42, s41, 53248
    v_add_u32 v15, s42, v4
    v_lshrrev_b32 v3, 3, v2
    s_lshl_b32 s40, s28, 2
    v_add_u32 v3, s40, v3
    v_lshrrev_b32 v4, 1, v3
    v_xor_b32 v4, v4, v2
    v_and_b32 v4, 7, v4
    s_lshl_b32 s40, s25, 7
    s_sub_u32 s40, s40, 16
    v_add_u32 v3, s40, v3
    v_max_i32 v3, 0, v3
    v_lshlrev_b32 v3, 11, v3
    v_lshl_add_u32 v20, v4, 4, v3
    s_mul_i32 s36, s28, 2048
    s_mul_i32 s37, s28, 4096
    s_add_u32 s37, s37, 26624
    s_mul_i32 s46, s28, 512
    s_add_u32 s46, s46, 24576
    s_waitcnt lgkmcnt(0)
    s_mov_b32 s8, s30
    s_mov_b32 s9, s31
    s_mov_b32 s10, 0x600000
    s_mov_b32 s11, 0x20000
    s_add_u32 s56, s4, 0x100000
    s_addc_u32 s57, s5, 0
    s_mov_b32 s58, 0x30000
    s_mov_b32 s59, 0x20000
    s_add_u32 s4, s4, s97
    s_addc_u32 s5, s5, 0
    s_add_u32 s12, s4, 0x1900000
    s_addc_u32 s13, s5, 0
    s_cmp_eq_u32 s96, 1
    s_cselect_b32 s12, s12, s6
    s_cselect_b32 s13, s13, s7
    s_mov_b32 s14, 0x400000
    s_mov_b32 s15, 0x20000
    s_mov_b32 s20, s4
    s_mov_b32 s21, s5
    s_mov_b32 s22, 0x40000
    s_mov_b32 s23, 0x20000
    s_mov_b32 s60, s16
    s_mov_b32 s61, s17
    s_mov_b32 s62, 0x100
    s_mov_b32 s63, 0x20000
    s_sub_u32 s40, s52, s27
    s_and_b32 s40, s40, 1
    s_and_b32 s41, s52, 2
    s_or_b32 s40, s40, s41
    s_add_u32 s54, s40, 2
    s_cmp_eq_u32 s53, 0
    s_cselect_b32 s54, 0x7fff, s54
    s_add_u32 s55, s54, 3
    s_cmp_lg_u32 s28, 0
    s_cselect_b32 s55, 0x7fff, s55
    s_cmp_lt_u32 s55, 0x7fff
    s_cselect_b32 s29, 12, 0x7fff
    s_add_u32 s50, s29, 1
    s_mov_b32 s51, 14
    s_mov_b32 s32, 0
    s_mov_b32 s33, 0
g1_ld_pW:
    s_add_u32 s40, s32, s27
    s_and_b32 s40, s40, 1
    s_andn2_b32 s41, s32, 1
    s_or_b32 s40, s40, s41
    s_add_u32 s40, s40, s26
    s_and_b32 s40, s40, 15
    s_mul_i32 s34, s40, 393216
    s_mul_i32 s35, s40, 128
    s_add_u32 s38, s33, s36
    s_add_u32 s39, s33, s37
    s_add_u32 m0, s38, 0
    s_nop 0
    buffer_load_dwordx4 v10, s[8:11], s34 offen lds
    s_add_u32 m0, s38, 1024
    s_nop 0
    buffer_load_dwordx4 v11, s[8:11], s34 offen lds
    s_add_u32 m0, s38, 8192
    s_nop 0
    buffer_load_dwordx4 v12, s[8:11], s34 offen lds
    s_add_u32 m0, s38, 9216
    s_nop 0
    buffer_load_dwordx4 v13, s[8:11], s34 offen lds
    s_add_u32 m0, s38, 16384
    s_nop 0
    buffer_load_dwordx4 v14, s[8:11], s34 offen lds
    s_add_u32 m0, s38, 17408
    s_nop 0
    buffer_load_dwordx4 v15, s[8:11], s34 offen lds
    s_add_u32 s33, s33, 43008
    s_add_u32 s32, s32, 1
    s_cmp_lt_u32 s32, 2
    s_cbranch_scc1 g1_ld_pW
    s_cmp_eq_u32 s96, 0
    s_cbranch_scc1 g1_dep_ok
    s_add_u32 s40, s25, 40
    s_lshl_b32 s40, s40, 8
    s_sub_u32 s42, s40, 256
    s_max_u32 s42, s42, 10240
    s_lshl_b32 s43, s96, 2
    s_add_u32 s43, s43, 1
    s_mov_b32 s41, 0x80000
    v_mov_b32 v24, 131072
    s_cmp_lg_u32 s28, 0
    s_cbranch_scc1 g1_dep_lds
    s_mov_b32 s41, 0x8000
    s_add_u32 s84, s4, 0x300000
    s_addc_u32 s85, s5, 0
    s_mov_b32 s86, 0x4000
    s_mov_b32 s87, 0x20000
    v_cmp_eq_u32 vcc, 1, v2
    v_mov_b32 v21, s40
    v_mov_b32 v23, s42
    v_cndmask_b32 v21, v21, v23, vcc
    v_mov_b32 v22, 16
    v_mov_b32 v23, 16
    v_cndmask_b32 v22, v22, v23, vcc
g1_dep:
    buffer_load_dword v23, v21, s[84:87], 0 offen sc1
    s_sub_u32 s41, s41, 1
    s_waitcnt vmcnt(0)
    v_cmp_lt_u32 vcc, v23, v22
    s_cmp_eq_u32 s41, 0
    s_cbranch_scc1 g1_dep_seen
    s_cbranch_vccz g1_dep_seen
    s_sleep 2
    s_branch g1_dep
g1_dep_seen:
    v_mov_b32 v23, s43
    ds_write_b32 v24, v23
    s_branch g1_dep_ok
g1_dep_lds:
    ds_read_b32 v23, v24
    s_sub_u32 s41, s41, 1
    s_waitcnt lgkmcnt(0)
    v_readfirstlane_b32 s40, v23
    s_cmp_eq_u32 s41, 0
    s_cbranch_scc1 g1_dep_ok
    s_cmp_eq_u32 s40, s43
    s_cbranch_scc1 g1_dep_ok
    s_sleep 1
    s_branch g1_dep_lds
g1_dep_ok:
    s_mov_b32 s32, 0
    s_mov_b32 s33, 0
g1_ld_pA:
    s_add_u32 s40, s32, s27
    s_and_b32 s40, s40, 1
    s_andn2_b32 s41, s32, 1
    s_or_b32 s40, s40, s41
    s_add_u32 s40, s40, s26
    s_and_b32 s40, s40, 15
    s_mul_i32 s34, s40, 393216
    s_mul_i32 s35, s40, 128
    s_add_u32 s38, s33, s36
    s_add_u32 s39, s33, s37
    s_add_u32 m0, s39, 0
    s_nop 0
    buffer_load_dwordx4 v16, s[12:15], s35 offen sc1 lds
    s_add_u32 m0, s39, 1024
    s_nop 0
    buffer_load_dwordx4 v17, s[12:15], s35 offen sc1 lds
    s_add_u32 m0, s39, 2048
    s_nop 0
    buffer_load_dwordx4 v18, s[12:15], s35 offen sc1 lds
    s_add_u32 m0, s39, 3072
    s_nop 0
    buffer_load_dwordx4 v19, s[12:15], s35 offen sc1 lds
    s_add_u32 m0, s33, s46
    s_mov_b32 exec_hi, 0
    buffer_load_dwordx4 v20, s[12:15], s35 offen sc1 lds
    s_mov_b32 exec_hi, -1
    s_add_u32 s33, s33, 43008
    s_add_u32 s32, s32, 1
    s_cmp_lt_u32 s32, 2
    s_cbranch_scc1 g1_ld_pA
    s_waitcnt vmcnt(5)
    s_branch g1_ld_bar
g1_ld_loop:
    s_sub_u32 s40, s32, s54
    s_sub_u32 s40, s40, 1
    s_cmp_lt_u32 s40, 2
    s_cbranch_scc1 g1_ld_w0
    s_sub_u32 s40, s32, s55
    s_sub_u32 s40, s40, 1
    s_cmp_lt_u32 s40, 2
    s_cbranch_scc1 g1_ld_w1
    s_sub_u32 s40, s32, s29
    s_sub_u32 s40, s40, 1
    s_cmp_lt_u32 s40, 2
    s_cbranch_scc1 g1_ld_w2
    s_sub_u32 s40, s32, s51
    s_sub_u32 s40, s40, 1
    s_cmp_lt_u32 s40, 2
    s_cbranch_scc1 g1_ld_w4
    s_waitcnt vmcnt(11)
g1_ld_bar:
    s_barrier
    s_add_u32 s40, s32, s27
    s_and_b32 s40, s40, 1
    s_andn2_b32 s41, s32, 1
    s_or_b32 s40, s40, s41
    s_add_u32 s40, s40, s26
    s_and_b32 s40, s40, 15
    s_mul_i32 s34, s40, 393216
    s_mul_i32 s35, s40, 128
    s_add_u32 s38, s33, s36
    s_add_u32 s39, s33, s37
    s_add_u32 m0, s39, 0
    s_nop 0
    buffer_load_dwordx4 v16, s[12:15], s35 offen sc1 lds
    s_add_u32 m0, s39, 1024
    s_nop 0
    buffer_load_dwordx4 v17, s[12:15], s35 offen sc1 lds
    s_add_u32 m0, s39, 2048
    s_nop 0
    buffer_load_dwordx4 v18, s[12:15], s35 offen sc1 lds
    s_add_u32 m0, s39, 3072
    s_nop 0
    buffer_load_dwordx4 v19, s[12:15], s35 offen sc1 lds
    s_add_u32 m0, s38, 0
    s_nop 0
    buffer_load_dwordx4 v10, s[8:11], s34 offen lds
    s_add_u32 m0, s38, 1024
    s_nop 0
    buffer_load_dwordx4 v11, s[8:11], s34 offen lds
    s_add_u32 m0, s38, 8192
    s_nop 0
    buffer_load_dwordx4 v12, s[8:11], s34 offen lds
    s_add_u32 m0, s38, 9216
    s_nop 0
    buffer_load_dwordx4 v13, s[8:11], s34 offen lds
    s_add_u32 m0, s38, 16384
    s_nop 0
    buffer_load_dwordx4 v14, s[8:11], s34 offen lds
    s_add_u32 m0, s38, 17408
    s_nop 0
    buffer_load_dwordx4 v15, s[8:11], s34 offen lds
    s_add_u32 m0, s33, s46
    s_mov_b32 exec_hi, 0
    buffer_load_dwordx4 v20, s[12:15], s35 offen sc1 lds
    s_mov_b32 exec_hi, -1
    s_cmp_eq_u32 s32, s54
    s_cbranch_scc1 g1_ld_h0
g1_ld_c0:
    s_cmp_eq_u32 s32, s55
    s_cbranch_scc1 g1_ld_h1
g1_ld_c1:
    s_cmp_eq_u32 s32, s29
    s_cbranch_scc1 g1_ld_h2
g1_ld_c2:
    s_cmp_eq_u32 s32, s50
    s_cbranch_scc1 g1_ld_h3
g1_ld_c3:
    s_cmp_eq_u32 s32, s51
    s_cbranch_scc1 g1_ld_h4
g1_ld_c4:
    s_add_u32 s33, s33, 43008
    s_add_u32 s32, s32, 1
    s_cmp_eq_u32 s33, 129024
    s_cselect_b32 s33, 0, s33
    s_cmp_lt_u32 s32, 16
    s_cbranch_scc1 g1_ld_loop
    s_waitcnt vmcnt(43)
    s_barrier
    s_waitcnt vmcnt(0)
    v_pk_add_f32 v[24:25], v[24:25], v[40:41]
    v_add_f32 v56, v56, v64
    v_pk_add_f32 v[26:27], v[26:27], v[42:43]
    v_add_f32 v57, v57, v65
    v_pk_add_f32 v[28:29], v[28:29], v[44:45]
    v_add_f32 v58, v58, v66
    v_pk_add_f32 v[30:31], v[30:31], v[46:47]
    v_add_f32 v59, v59, v67
    v_pk_add_f32 v[32:33], v[32:33], v[48:49]
    v_add_f32 v60, v60, v68
    v_pk_add_f32 v[34:35], v[34:35], v[50:51]
    v_add_f32 v61, v61, v69
    v_pk_add_f32 v[36:37], v[36:37], v[52:53]
    v_add_f32 v62, v62, v70
    v_pk_add_f32 v[38:39], v[38:39], v[54:55]
    v_add_f32 v63, v63, v71
    v_pk_add_f32 v[24:25], v[24:25], v[32:33]
    v_add_f32 v56, v56, v60
    v_pk_add_f32 v[26:27], v[26:27], v[34:35]
    v_add_f32 v57, v57, v61
    v_pk_add_f32 v[28:29], v[28:29], v[36:37]
    v_add_f32 v58, v58, v62
    v_pk_add_f32 v[30:31], v[30:31], v[38:39]
    v_add_f32 v59, v59, v63
    v_pk_add_f32 v[24:25], v[24:25], v[28:29]
    v_add_f32 v56, v56, v58
    v_pk_add_f32 v[26:27], v[26:27], v[30:31]
    v_add_f32 v57, v57, v59
    v_pk_add_f32 v[24:25], v[24:25], v[26:27]
    v_add_f32 v56, v56, v57
    v_mul_f32 v24, 0x3a800000, v24
    v_mul_f32 v25, 0x3a800000, v25
    v_fma_f32 v25, -v24, v24, v25
    v_max_f32 v25, 0, v25
    v_cvt_pk_bf16_f32 v24, v24, v24
    v_lshlrev_b32 v24, 16, v24
    v_cvt_pk_bf16_f32 v25, v25, v25
    v_lshlrev_b32 v25, 16, v25
    v_add_f32 v25, 0x3727c5ac, v25
    v_cvt_pk_bf16_f32 v25, v25, v25
    v_lshlrev_b32 v25, 16, v25
    v_sqrt_f32 v25, v25
    s_nop 0
    v_cvt_pk_bf16_f32 v25, v25, v25
    v_lshlrev_b32 v25, 16, v25
    v_rcp_f32 v26, v25
    v_lshlrev_b32 v3, 3, v21
    v_lshlrev_b32 v4, 2, v21
    v_mul_f32 v27, -v24, v26
    v_cmp_gt_u32 vcc, 144, v21
    s_and_saveexec_b64 s[40:41], vcc
    v_add_u32 v3, 129024, v3
    ds_write_b64 v3, v[26:27]
    s_mov_b64 exec, s[40:41]
    v_cmp_gt_u32 vcc, 192, v21
    s_and_saveexec_b64 s[40:41], vcc
    v_add_u32 v4, 130304, v4
    ds_write_b32 v4, v56
    s_mov_b64 exec, s[40:41]
    s_waitcnt lgkmcnt(0)
    s_barrier
    s_add_u32 s20, s4, 0x200000
    s_addc_u32 s21, s5, 0
    s_mov_b32 s22, 0x40000
    s_mov_b32 s23, 0x20000
    s_lshl_b32 s40, s24, 4
    s_add_u32 s40, s40, s25
    s_lshl_b32 s40, s40, 10
    s_lshl_b32 s41, s28, 8
    s_add_u32 s40, s40, s41
    v_lshlrev_b32 v3, 2, v2
    v_mov_b32 v4, -1
    buffer_store_dword v4, v3, s[20:23], s40 offen sc1
    s_cmp_eq_u32 s53, 0
    s_cbranch_scc1 g1_nopf
    s_mov_b32 s20, s18
    s_mov_b32 s21, s19
    s_mov_b32 s22, 0x200000
    s_mov_b32 s23, 0x20000
    s_lshl_b32 s40, s2, 13
    s_lshl_b32 s41, s28, 11
    s_add_u32 s40, s40, s41
    v_lshlrev_b32 v3, 4, v2
    buffer_load_dwordx4 v[120:123], v3, s[20:23], s40 offen
    buffer_load_dwordx4 v[120:123], v3, s[20:23], s40 offen offset:1024
g1_nopf:
    s_branch g1_ld_end
g1_ld_w0:
    s_waitcnt vmcnt(16)
    s_branch g1_ld_bar
g1_ld_h0:
    s_add_u32 s44, s33, 43008
    s_cmp_eq_u32 s44, 129024
    s_cselect_b32 s44, 0, s44
    s_mul_i32 s42, s28, 3
    s_add_u32 s42, s42, 0
    s_lshr_b32 s43, s42, 2
    s_lshl_b32 s43, s43, 13
    s_add_u32 s43, s43, s44
    s_and_b32 s42, s42, 3
    v_and_b32 v3, 1, v5
    v_lshlrev_b32 v3, 1, v3
    v_lshrrev_b32 v4, 1, v6
    v_or_b32 v3, v3, v4
    s_add_u32 s40, s42, 0
    v_xor_b32 v3, s40, v3
    v_lshlrev_b32 v3, 5, v3
    v_lshl_add_u32 v3, v7, 3, v3
    v_lshl_add_u32 v4, v5, 3, v6
    v_lshl_add_u32 v3, v4, 7, v3
    v_add_u32 v21, s43, v3
    ds_read_b64_tr_b16 v[24:25], v21 offset:0
    ds_read_b64_tr_b16 v[26:27], v21 offset:512
    ds_read_b64_tr_b16 v[28:29], v21 offset:4096
    ds_read_b64_tr_b16 v[30:31], v21 offset:4608
    s_mul_i32 s42, s28, 3
    s_add_u32 s42, s42, 1
    s_lshr_b32 s43, s42, 2
    s_lshl_b32 s43, s43, 13
    s_add_u32 s43, s43, s44
    s_and_b32 s42, s42, 3
    v_and_b32 v3, 1, v5
    v_lshlrev_b32 v3, 1, v3
    v_lshrrev_b32 v4, 1, v6
    v_or_b32 v3, v3, v4
    s_add_u32 s40, s42, 0
    v_xor_b32 v3, s40, v3
    v_lshlrev_b32 v3, 5, v3
    v_lshl_add_u32 v3, v7, 3, v3
    v_lshl_add_u32 v4, v5, 3, v6
    v_lshl_add_u32 v3, v4, 7, v3
    v_add_u32 v21, s43, v3
    ds_read_b64_tr_b16 v[32:33], v21 offset:0
    ds_read_b64_tr_b16 v[34:35], v21 offset:512
    ds_read_b64_tr_b16 v[36:37], v21 offset:4096
    ds_read_b64_tr_b16 v[38:39], v21 offset:4608
    s_mul_i32 s42, s28, 3
    s_add_u32 s42, s42, 2
    s_lshr_b32 s43, s42, 2
    s_lshl_b32 s43, s43, 13
    s_add_u32 s43, s43, s44
    s_and_b32 s42, s42, 3
    v_and_b32 v3, 1, v5
    v_lshlrev_b32 v3, 1, v3
    v_lshrrev_b32 v4, 1, v6
    v_or_b32 v3, v3, v4
    s_add_u32 s40, s42, 0
    v_xor_b32 v3, s40, v3
    v_lshlrev_b32 v3, 5, v3
    v_lshl_add_u32 v3, v7, 3, v3
    v_lshl_add_u32 v4, v5, 3, v6
    v_lshl_add_u32 v3, v4, 7, v3
    v_add_u32 v21, s43, v3
    ds_read_b64_tr_b16 v[40:41], v21 offset:0
    ds_read_b64_tr_b16 v[42:43], v21 offset:512
    ds_read_b64_tr_b16 v[44:45], v21 offset:4096
    ds_read_b64_tr_b16 v[46:47], v21 offset:4608
    s_lshr_b32 s42, s44, 7
    s_lshl_b32 s43, s28, 5
    s_add_u32 s42, s42, s43
    s_add_u32 s42, s42, 16
    v_lshrrev_b32 v3, 1, v8
    v_xor_b32 v3, v3, v5
    v_lshlrev_b32 v3, 4, v3
    v_lshl_add_u32 v3, v8, 7, v3
    s_lshl_b32 s40, s42, 7
    s_add_u32 s40, s40, 24576
    v_add_u32 v22, s40, v3
    v_xor_b32 v23, 64, v22
    ds_read_b128 v[48:51], v22 offset:0
    ds_read_b128 v[52:55], v23 offset:0
    ds_read_b128 v[56:59], v22 offset:2048
    ds_read_b128 v[60:63], v23 offset:2048
    v_mov_b32 v64, 0x3f803f80
    v_mov_b32 v65, 0x3f803f80
    v_mov_b32 v66, 0x3f803f80
    v_mov_b32 v67, 0x3f803f80
    s_mul_i32 s42, s52, 12288
    s_lshl_b32 s43, s24, 8
    s_add_u32 s42, s42, s43
    v_lshl_add_u32 v21, v5, 4, s42
    s_lshl_b32 s42, s52, 14
    s_lshl_b32 s43, s25, 10
    s_add_u32 s42, s42, s43
    s_lshl_b32 s43, s28, 8
    s_add_u32 s42, s42, s43
    v_lshl_add_u32 v22, v8, 3, s42
    s_waitcnt lgkmcnt(0)
    v_mfma_f32_16x16x32_bf16 v[68:71], v[24:27], v[64:67], 0
    v_mfma_f32_16x16x32_bf16 v[72:75], v[32:35], v[64:67], 0
    v_mfma_f32_16x16x32_bf16 v[76:79], v[40:43], v[64:67], 0
    v_mfma_f32_16x16x32_bf16 v[80:83], v[64:67], v[48:51], 0
    v_mfma_f32_16x16x32_bf16 v[84:87], v[48:51], v[48:51], 0
    v_mfma_f32_16x16x32_bf16 v[88:91], v[64:67], v[56:59], 0
    v_mfma_f32_16x16x32_bf16 v[92:95], v[56:59], v[56:59], 0
    v_mfma_f32_16x16x32_bf16 v[68:71], v[28:31], v[64:67], v[68:71]
    v_mfma_f32_16x16x32_bf16 v[72:75], v[36:39], v[64:67], v[72:75]
    v_mfma_f32_16x16x32_bf16 v[76:79], v[44:47], v[64:67], v[76:79]
    v_mfma_f32_16x16x32_bf16 v[80:83], v[64:67], v[52:55], v[80:83]
    v_mfma_f32_16x16x32_bf16 v[84:87], v[52:55], v[52:55], v[84:87]
    v_mfma_f32_16x16x32_bf16 v[88:91], v[64:67], v[60:63], v[88:91]
    v_mfma_f32_16x16x32_bf16 v[92:95], v[60:63], v[60:63], v[92:95]
    v_cmp_eq_u32 s[40:41], 1, v7
    v_cmp_eq_u32 s[42:43], 2, v7
    v_cmp_eq_u32 vcc, 3, v7
    s_nop 7
    v_cndmask_b32 v81, v84, v85, s[40:41]
    v_cndmask_b32 v81, v81, v86, s[42:43]
    v_cndmask_b32 v81, v81, v87, vcc
    v_cndmask_b32 v89, v92, v93, s[40:41]
    v_cndmask_b32 v89, v89, v94, s[42:43]
    v_cndmask_b32 v89, v89, v95, vcc
    s_mov_b32 exec_lo, 0x00f0000f
    s_mov_b32 exec_hi, 0xf0000f00
    buffer_store_dwordx2 v[80:81], v22, s[20:23], 0 offen offset:0 sc1
    buffer_store_dwordx2 v[88:89], v22, s[20:23], 0 offen offset:128 sc1
    s_mov_b32 exec_lo, 0x00010001
    s_mov_b32 exec_hi, 0x00010001
    s_mul_i32 s42, s28, 3
    s_add_u32 s42, s42, 0
    s_lshr_b32 s43, s42, 2
    s_lshl_b32 s43, s43, 12
    s_and_b32 s42, s42, 3
    s_lshl_b32 s42, s42, 6
    s_add_u32 s42, s42, s43
    buffer_store_dwordx4 v[68:71], v21, s[56:59], s42 offen sc1
    s_mul_i32 s42, s28, 3
    s_add_u32 s42, s42, 1
    s_lshr_b32 s43, s42, 2
    s_lshl_b32 s43, s43, 12
    s_and_b32 s42, s42, 3
    s_lshl_b32 s42, s42, 6
    s_add_u32 s42, s42, s43
    buffer_store_dwordx4 v[72:75], v21, s[56:59], s42 offen sc1
    s_mul_i32 s42, s28, 3
    s_add_u32 s42, s42, 2
    s_lshr_b32 s43, s42, 2
    s_lshl_b32 s43, s43, 12
    s_and_b32 s42, s42, 3
    s_lshl_b32 s42, s42, 6
    s_add_u32 s42, s42, s43
    buffer_store_dwordx4 v[76:79], v21, s[56:59], s42 offen sc1
    s_mov_b64 exec, -1
    s_or_b32 s40, s24, s25
    s_or_b32 s40, s40, s28
    s_cmp_lg_u32 s40, 0
    s_cbranch_scc1 g1_nocr
    v_lshlrev_b32 v21, 8, v2
    v_mov_b32 v22, 0
    s_add_u32 s84, s4, 0x300000
    s_addc_u32 s85, s5, 0
    s_mov_b32 s86, 0x4000
    s_mov_b32 s87, 0x20000
    buffer_store_dword v22, v21, s[84:87], 0 offen sc1
    s_add_u32 s84, s4, 0x2b00000
    s_addc_u32 s85, s5, 0
    s_mov_b32 s86, 0x4000
    s_mov_b32 s87, 0x20000
    buffer_store_dword v22, v21, s[84:87], 0 offen sc1
g1_nocr:
    s_branch g1_ld_c0
g1_ld_w1:
    s_waitcnt vmcnt(12)
    s_branch g1_ld_bar
g1_ld_h1:
    v_mov_b32 v21, 0
    v_mov_b32 v22, 1
    s_mov_b64 exec, 1
    buffer_atomic_add v22, v21, s[60:63], 0 offen sc1
    s_mov_b64 exec, -1
    s_branch g1_ld_c1
g1_ld_w2:
    s_waitcnt vmcnt(12)
    s_branch g1_ld_bar
g1_ld_h2:
    v_mov_b32 v21, 0
    buffer_load_dword v23, v21, s[60:63], 0 offen sc1
    s_branch g1_ld_c2
g1_ld_h3:
    s_mov_b32 s41, 0x20000
    v_mov_b32 v21, 0
    s_waitcnt vmcnt(11)
g1_poll:
    v_readfirstlane_b32 s40, v23
    s_sub_u32 s41, s41, 1
    s_cmp_eq_u32 s41, 0
    s_cbranch_scc1 g1_polled
    s_cmp_ge_u32 s40, 256
    s_cbranch_scc1 g1_polled
    s_sleep 8
    buffer_load_dword v23, v21, s[60:63], 0 offen sc1
    s_waitcnt vmcnt(0)
    s_branch g1_poll
g1_polled:
    s_branch g1_ld_c3
g1_ld_w4:
    s_waitcnt vmcnt(43)
    s_branch g1_ld_bar
g1_ld_h4:
    s_lshl_b32 s40, s28, 6
    v_add_u32 v21, s40, v2
    s_lshl_b32 s41, s25, 7
    s_sub_u32 s41, s41, 16
    v_add_u32 v3, s41, v21
    v_max_i32 v3, 0, v3
    v_min_u32 v3, 2047, v3
    v_lshlrev_b32 v3, 3, v3
    s_min_u32 s40, s28, 2
    s_lshl_b32 s40, s40, 12
    s_lshl_b32 s41, s24, 8
    s_add_u32 s40, s40, s41
    v_lshl_add_u32 v4, v2, 2, s40
    s_mov_b32 s40, 0
    buffer_load_dwordx2 v[24:25], v3, s[20:23], s40 offen sc1
    s_mov_b32 s41, 0
    buffer_load_dword v56, v4, s[56:59], s41 offen sc1
    s_mov_b32 s40, 16384
    buffer_load_dwordx2 v[26:27], v3, s[20:23], s40 offen sc1
    s_mov_b32 s41, 12288
    buffer_load_dword v57, v4, s[56:59], s41 offen sc1
    s_mov_b32 s40, 32768
    buffer_load_dwordx2 v[28:29], v3, s[20:23], s40 offen sc1
    s_mov_b32 s41, 24576
    buffer_load_dword v58, v4, s[56:59], s41 offen sc1
    s_mov_b32 s40, 49152
    buffer_load_dwordx2 v[30:31], v3, s[20:23], s40 offen sc1
    s_mov_b32 s41, 36864
    buffer_load_dword v59, v4, s[56:59], s41 offen sc1
    s_mov_b32 s40, 65536
    buffer_load_dwordx2 v[32:33], v3, s[20:23], s40 offen sc1
    s_mov_b32 s41, 49152
    buffer_load_dword v60, v4, s[56:59], s41 offen sc1
    s_mov_b32 s40, 81920
    buffer_load_dwordx2 v[34:35], v3, s[20:23], s40 offen sc1
    s_mov_b32 s41, 61440
    buffer_load_dword v61, v4, s[56:59], s41 offen sc1
    s_mov_b32 s40, 98304
    buffer_load_dwordx2 v[36:37], v3, s[20:23], s40 offen sc1
    s_mov_b32 s41, 73728
    buffer_load_dword v62, v4, s[56:59], s41 offen sc1
    s_mov_b32 s40, 114688
    buffer_load_dwordx2 v[38:39], v3, s[20:23], s40 offen sc1
    s_mov_b32 s41, 86016
    buffer_load_dword v63, v4, s[56:59], s41 offen sc1
    s_mov_b32 s40, 131072
    buffer_load_dwordx2 v[40:41], v3, s[20:23], s40 offen sc1
    s_mov_b32 s41, 98304
    buffer_load_dword v64, v4, s[56:59], s41 offen sc1
    s_mov_b32 s40, 147456
    buffer_load_dwordx2 v[42:43], v3, s[20:23], s40 offen sc1
    s_mov_b32 s41, 110592
    buffer_load_dword v65, v4, s[56:59], s41 offen sc1
    s_mov_b32 s40, 163840
    buffer_load_dwordx2 v[44:45], v3, s[20:23], s40 offen sc1
    s_mov_b32 s41, 122880
    buffer_load_dword v66, v4, s[56:59], s41 offen sc1
    s_mov_b32 s40, 180224
    buffer_load_dwordx2 v[46:47], v3, s[20:23], s40 offen sc1
    s_mov_b32 s41, 135168
    buffer_load_dword v67, v4, s[56:59], s41 offen sc1
    s_mov_b32 s40, 196608
    buffer_load_dwordx2 v[48:49], v3, s[20:23], s40 offen sc1
    s_mov_b32 s41, 147456
    buffer_load_dword v68, v4, s[56:59], s41 offen sc1
    s_mov_b32 s40, 212992
    buffer_load_dwordx2 v[50:51], v3, s[20:23], s40 offen sc1
    s_mov_b32 s41, 159744
    buffer_load_dword v69, v4, s[56:59], s41 offen sc1
    s_mov_b32 s40, 229376
    buffer_load_dwordx2 v[52:53], v3, s[20:23], s40 offen sc1
    s_mov_b32 s41, 172032
    buffer_load_dword v70, v4, s[56:59], s41 offen sc1
    s_mov_b32 s40, 245760
    buffer_load_dwordx2 v[54:55], v3, s[20:23], s40 offen sc1
    s_mov_b32 s41, 184320
    buffer_load_dword v71, v4, s[56:59], s41 offen sc1
    s_branch g1_ld_c4
g1_ld_end:
    s_add_u32 s28, s28, 4
    s_add_u32 s16, s4, 0x400000
    s_addc_u32 s17, s5, 0
    s_mov_b32 s18, 0x400000
    s_mov_b32 s19, 0x20000
    s_and_b32 s44, s28, 1
    s_lshr_b32 s45, s28, 1
    s_lshl_b32 s40, s44, 2
    v_add_u32 v3, s40, v5
    v_and_b32 v4, 7, v8
    v_xor_b32 v3, v3, v4
    v_lshlrev_b32 v3, 4, v3
    v_lshl_add_u32 v3, v8, 8, v3
    s_mul_i32 s41, s45, 4096
    s_add_u32 s41, s41, 43008
    v_add_u32 v226, s41, v3
    v_lshl_add_u32 v3, v5, 2, v6
    v_and_b32 v4, 7, v3
    v_add_u32 v228, s40, v7
    v_xor_b32 v4, v4, v228
    v_lshlrev_b32 v4, 4, v4
    v_lshl_add_u32 v3, v3, 8, v4
    s_add_u32 s41, s41, 36864
    v_add_u32 v227, s41, v3
    v_and_b32 v3, 7, v8
    v_add_u32 v4, 1, v3
    s_or_b32 s40, s25, s45
    s_cmp_eq_u32 s40, 0
    s_cselect_b32 s40, 8, 0
    v_cmp_gt_u32 vcc, 8, v8
    v_mov_b32 v21, s40
    s_mov_b64 s[56:57], vcc
    v_cndmask_b32 v21, 0, v21, vcc
    v_max_u32 v4, v4, v21
    v_add_u32 v3, 8, v3
    v_sub_u32 v3, v3, v4
    v_lshlrev_b32 v21, 2, v5
    v_sub_u32 v21, v21, v4
    v_mov_b32 v22, 0xf149f2ca
    v_add_u32 v23, 0, v21
    v_cmp_ge_u32 vcc, v3, v23
    s_nop 1
    v_cndmask_b32 v228, v22, 0, vcc
    v_add_u32 v23, 1, v21
    v_cmp_ge_u32 vcc, v3, v23
    s_nop 1
    v_cndmask_b32 v229, v22, 0, vcc
    v_add_u32 v23, 2, v21
    v_cmp_ge_u32 vcc, v3, v23
    s_nop 1
    v_cndmask_b32 v230, v22, 0, vcc
    v_add_u32 v23, 3, v21
    v_cmp_ge_u32 vcc, v3, v23
    s_nop 1
    v_cndmask_b32 v231, v22, 0, vcc
    s_lshl_b32 s40, s25, 7
    s_lshl_b32 s41, s45, 5
    s_add_u32 s40, s40, s41
    s_lshl_b32 s40, s40, 11
    s_lshl_b32 s41, s24, 7
    s_add_u32 s40, s40, s41
    s_lshl_b32 s41, s44, 6
    s_add_u32 s40, s40, s41
    v_lshlrev_b32 v225, 12, v8
    v_lshl_add_u32 v225, v5, 4, v225
    v_add_u32 v225, s40, v225
    s_mov_b32 s58, 0x3e3504f3
    s_mov_b32 s59, 0x3fb8aa3b
    s_branch g1_attn
g1_compute:
    s_and_b32 s44, s28, 1
    s_lshr_b32 s45, s28, 1
    s_lshl_b32 s42, s44, 1
    s_mov_b32 s43, 0
    v_and_b32 v3, 1, v5
    v_lshlrev_b32 v3, 1, v3
    v_lshrrev_b32 v4, 1, v6
    v_or_b32 v3, v3, v4
    s_add_u32 s40, s42, 0
    v_xor_b32 v3, s40, v3
    v_lshlrev_b32 v3, 5, v3
    v_lshl_add_u32 v3, v7, 3, v3
    v_lshl_add_u32 v4, v5, 3, v6
    v_lshl_add_u32 v3, v4, 7, v3
    v_add_u32 v10, s43, v3
    v_and_b32 v3, 1, v5
    v_lshlrev_b32 v3, 1, v3
    v_lshrrev_b32 v4, 1, v6
    v_or_b32 v3, v3, v4
    s_add_u32 s40, s42, 1
    v_xor_b32 v3, s40, v3
    v_lshlrev_b32 v3, 5, v3
    v_lshl_add_u32 v3, v7, 3, v3
    v_lshl_add_u32 v4, v5, 3, v6
    v_lshl_add_u32 v3, v4, 7, v3
    v_add_u32 v11, s43, v3
    s_xor_b32 s43, s45, 1
    s_add_u32 s43, s43, 1
    s_mul_i32 s43, s43, 8192
    v_and_b32 v3, 1, v5
    v_lshlrev_b32 v3, 1, v3
    v_lshrrev_b32 v4, 1, v6
    v_or_b32 v3, v3, v4
    s_add_u32 s40, s42, 0
    v_xor_b32 v3, s40, v3
    v_lshlrev_b32 v3, 5, v3
    v_lshl_add_u32 v3, v7, 3, v3
    v_lshl_add_u32 v4, v5, 3, v6
    v_lshl_add_u32 v3, v4, 7, v3
    v_add_u32 v12, s43, v3
    v_and_b32 v3, 1, v5
    v_lshlrev_b32 v3, 1, v3
    v_lshrrev_b32 v4, 1, v6
    v_or_b32 v3, v3, v4
    s_add_u32 s40, s42, 1
    v_xor_b32 v3, s40, v3
    v_lshlrev_b32 v3, 5, v3
    v_lshl_add_u32 v3, v7, 3, v3
    v_lshl_add_u32 v4, v5, 3, v6
    v_lshl_add_u32 v3, v4, 7, v3
    v_add_u32 v13, s43, v3
    s_xor_b32 s43, s45, 0
    s_add_u32 s43, s43, 1
    s_mul_i32 s43, s43, 8192
    v_and_b32 v3, 1, v5
    v_lshlrev_b32 v3, 1, v3
    v_lshrrev_b32 v4, 1, v6
    v_or_b32 v3, v3, v4
    s_add_u32 s40, s42, 0
    v_xor_b32 v3, s40, v3
    v_lshlrev_b32 v3, 5, v3
    v_lshl_add_u32 v3, v7, 3, v3
    v_lshl_add_u32 v4, v5, 3, v6
    v_lshl_add_u32 v3, v4, 7, v3
    v_add_u32 v14, s43, v3
    v_and_b32 v3, 1, v5
    v_lshlrev_b32 v3, 1, v3
    v_lshrrev_b32 v4, 1, v6
    v_or_b32 v3, v3, v4
    s_add_u32 s40, s42, 1
    v_xor_b32 v3, s40, v3
    v_lshlrev_b32 v3, 5, v3
    v_lshl_add_u32 v3, v7, 3, v3
    v_lshl_add_u32 v4, v5, 3, v6
    v_lshl_add_u32 v3, v4, 7, v3
    v_add_u32 v15, s43, v3
    s_mul_i32 s42, s45, 64
    s_add_u32 s42, s42, 16
    v_lshrrev_b32 v3, 1, v8
    v_xor_b32 v3, v3, v5
    v_lshlrev_b32 v3, 4, v3
    v_lshl_add_u32 v3, v8, 7, v3
    s_lshl_b32 s40, s42, 7
    s_add_u32 s40, s40, 24576
    v_add_u32 v16, s40, v3
    v_xor_b32 v17, 64, v16
    v_lshrrev_b32 v3, 1, v8
    v_xor_b32 v3, v3, v5
    v_lshlrev_b32 v3, 4, v3
    v_lshl_add_u32 v3, v8, 7, v3
    v_add_u32 v18, 24576, v3
    v_xor_b32 v19, 64, v18
    v_mov_b32 v24, 0
    v_mov_b32 v25, 0
    v_mov_b32 v26, 0
    v_mov_b32 v27, 0
    v_mov_b32 v28, 0
    v_mov_b32 v29, 0
    v_mov_b32 v30, 0
    v_mov_b32 v31, 0
    v_mov_b32 v32, 0
    v_mov_b32 v33, 0
    v_mov_b32 v34, 0
    v_mov_b32 v35, 0
    v_mov_b32 v36, 0
    v_mov_b32 v37, 0
    v_mov_b32 v38, 0
    v_mov_b32 v39, 0
    v_mov_b32 v40, 0
    v_mov_b32 v41, 0
    v_mov_b32 v42, 0
    v_mov_b32 v43, 0
    v_mov_b32 v44, 0
    v_mov_b32 v45, 0
    v_mov_b32 v46, 0
    v_mov_b32 v47, 0
    v_mov_b32 v48, 0
    v_mov_b32 v49, 0
    v_mov_b32 v50, 0
    v_mov_b32 v51, 0
    v_mov_b32 v52, 0
    v_mov_b32 v53, 0
    v_mov_b32 v54, 0
    v_mov_b32 v55, 0
    v_mov_b32 v56, 0
    v_mov_b32 v57, 0
    v_mov_b32 v58, 0
    v_mov_b32 v59, 0
    v_mov_b32 v60, 0
    v_mov_b32 v61, 0
    v_mov_b32 v62, 0
    v_mov_b32 v63, 0
    v_mov_b32 v64, 0
    v_mov_b32 v65, 0
    v_mov_b32 v66, 0
    v_mov_b32 v67, 0
    v_mov_b32 v68, 0
    v_mov_b32 v69, 0
    v_mov_b32 v70, 0
    v_mov_b32 v71, 0
    v_mov_b32 v72, 0
    v_mov_b32 v73, 0
    v_mov_b32 v74, 0
    v_mov_b32 v75, 0
    v_mov_b32 v76, 0
    v_mov_b32 v77, 0
    v_mov_b32 v78, 0
    v_mov_b32 v79, 0
    v_mov_b32 v80, 0
    v_mov_b32 v81, 0
    v_mov_b32 v82, 0
    v_mov_b32 v83, 0
    v_mov_b32 v84, 0
    v_mov_b32 v85, 0
    v_mov_b32 v86, 0
    v_mov_b32 v87, 0
    v_mov_b32 v88, 0
    v_mov_b32 v89, 0
    v_mov_b32 v90, 0
    v_mov_b32 v91, 0
    v_mov_b32 v92, 0
    v_mov_b32 v93, 0
    v_mov_b32 v94, 0
    v_mov_b32 v95, 0
    v_mov_b32 v96, 0
    v_mov_b32 v97, 0
    v_mov_b32 v98, 0
    v_mov_b32 v99, 0
    v_mov_b32 v100, 0
    v_mov_b32 v101, 0
    v_mov_b32 v102, 0
    v_mov_b32 v103, 0
    v_mov_b32 v104, 0
    v_mov_b32 v105, 0
    v_mov_b32 v106, 0
    v_mov_b32 v107, 0
    v_mov_b32 v108, 0
    v_mov_b32 v109, 0
    v_mov_b32 v110, 0
    v_mov_b32 v111, 0
    v_mov_b32 v112, 0
    v_mov_b32 v113, 0
    v_mov_b32 v114, 0
    v_mov_b32 v115, 0
    v_mov_b32 v116, 0
    v_mov_b32 v117, 0
    v_mov_b32 v118, 0
    v_mov_b32 v119, 0
    v_mov_b32 v120, 0
    v_mov_b32 v121, 0
    v_mov_b32 v122, 0
    v_mov_b32 v123, 0
    v_mov_b32 v124, 0
    v_mov_b32 v125, 0
    v_mov_b32 v126, 0
    v_mov_b32 v127, 0
    v_mov_b32 v172, 0
    v_mov_b32 v173, 0
    v_mov_b32 v174, 0
    v_mov_b32 v175, 0
    v_mov_b32 v176, 0
    v_mov_b32 v177, 0
    v_mov_b32 v178, 0
    v_mov_b32 v179, 0
    v_mov_b32 v180, 0
    v_mov_b32 v181, 0
    v_mov_b32 v182, 0
    v_mov_b32 v183, 0
    v_mov_b32 v184, 0
    v_mov_b32 v185, 0
    v_mov_b32 v186, 0
    v_mov_b32 v187, 0
    v_mov_b32 v188, 0
    v_mov_b32 v189, 0
    v_mov_b32 v190, 0
    v_mov_b32 v191, 0
    v_mov_b32 v192, 0
    v_mov_b32 v193, 0
    v_mov_b32 v194, 0
    v_mov_b32 v195, 0
    v_mov_b32 v196, 0
    v_mov_b32 v197, 0
    v_mov_b32 v198, 0
    v_mov_b32 v199, 0
    v_mov_b32 v200, 0
    v_mov_b32 v201, 0
    v_mov_b32 v202, 0
    v_mov_b32 v203, 0
    v_mov_b32 v204, 0
    v_mov_b32 v205, 0
    v_mov_b32 v206, 0
    v_mov_b32 v207, 0
    v_mov_b32 v208, 0
    v_mov_b32 v209, 0
    v_mov_b32 v210, 0
    v_mov_b32 v211, 0
    v_mov_b32 v212, 0
    v_mov_b32 v213, 0
    v_mov_b32 v214, 0
    v_mov_b32 v215, 0
    s_mov_b32 s48, 16
    s_mov_b32 s50, 0
    s_mov_b32 s51, 43008
    s_mov_b32 s29, 0xfffeb000
    s_waitcnt lgkmcnt(0)
    s_add_u32 s4, s4, s97
    s_addc_u32 s5, s5, 0
    v_lshlrev_b32 v3, 3, v8
    v_add_u32 v217, 129024, v3
    s_mul_i32 s40, s45, 512
    s_add_u32 s40, s40, 129152
    v_add_u32 v216, s40, v3
    s_lshl_b32 s40, s44, 7
    s_add_u32 s40, s40, 130304
    v_lshl_add_u32 v3, v5, 4, s40
    s_mov_b32 s43, 0
    v_add_u32 v218, s43, v3
    s_xor_b32 s43, s45, 1
    s_add_u32 s43, s43, 1
    s_mul_i32 s43, s43, 256
    v_add_u32 v219, s43, v3
    s_xor_b32 s43, s45, 0
    s_add_u32 s43, s43, 1
    s_mul_i32 s43, s43, 256
    v_add_u32 v220, s43, v3
    v_and_b32 v3, 1, v5
    v_lshlrev_b32 v3, 1, v3
    v_lshrrev_b32 v4, 1, v5
    v_add_u32 v3, v3, v4
    s_lshl_b32 s40, s44, 2
    v_add_u32 v3, s40, v3
    v_lshrrev_b32 v4, 1, v8
    v_xor_b32 v3, v3, v4
    v_lshlrev_b32 v3, 4, v3
    v_lshl_add_u32 v3, v8, 7, v3
    s_mul_i32 s42, s45, 8192
    s_add_u32 s42, s42, 45056
    s_mov_b32 s43, 0
    s_add_u32 s40, s42, s43
    v_add_u32 v221, s40, v3
    s_xor_b32 s43, s45, 1
    s_add_u32 s43, s43, 1
    s_mul_i32 s43, s43, 18432
    s_add_u32 s40, s42, s43
    v_add_u32 v222, s40, v3
    s_xor_b32 s43, s45, 0
    s_add_u32 s43, s43, 1
    s_mul_i32 s43, s43, 18432
    s_add_u32 s40, s42, s43
    v_add_u32 v223, s40, v3
    s_add_u32 s40, s43, 43008
    v_add_u32 v224, s40, v3
    s_add_u32 s16, s4, 0x400000
    s_addc_u32 s17, s5, 0
    s_mov_b32 s18, 0x400000
    s_mov_b32 s19, 0x20000
    s_and_b32 s44, s28, 1
    s_lshr_b32 s45, s28, 1
    s_lshl_b32 s40, s44, 2
    v_add_u32 v3, s40, v5
    v_and_b32 v4, 7, v8
    v_xor_b32 v3, v3, v4
    v_lshlrev_b32 v3, 4, v3
    v_lshl_add_u32 v3, v8, 8, v3
    s_mul_i32 s41, s45, 4096
    s_add_u32 s41, s41, 43008
    v_add_u32 v226, s41, v3
    v_lshl_add_u32 v3, v5, 2, v6
    v_and_b32 v4, 7, v3
    v_add_u32 v228, s40, v7
    v_xor_b32 v4, v4, v228
    v_lshlrev_b32 v4, 4, v4
    v_lshl_add_u32 v3, v3, 8, v4
    s_add_u32 s41, s41, 36864
    v_add_u32 v227, s41, v3
    v_and_b32 v3, 7, v8
    v_add_u32 v4, 1, v3
    s_or_b32 s40, s25, s45
    s_cmp_eq_u32 s40, 0
    s_cselect_b32 s40, 8, 0
    v_cmp_gt_u32 vcc, 8, v8
    v_mov_b32 v21, s40
    s_mov_b64 s[56:57], vcc
    v_cndmask_b32 v21, 0, v21, vcc
    v_max_u32 v4, v4, v21
    v_add_u32 v3, 8, v3
    v_sub_u32 v3, v3, v4
    v_lshlrev_b32 v21, 2, v5
    v_sub_u32 v21, v21, v4
    v_mov_b32 v22, 0xf149f2ca
    v_add_u32 v23, 0, v21
    v_cmp_ge_u32 vcc, v3, v23
    s_nop 1
    v_cndmask_b32 v228, v22, 0, vcc
    v_add_u32 v23, 1, v21
    v_cmp_ge_u32 vcc, v3, v23
    s_nop 1
    v_cndmask_b32 v229, v22, 0, vcc
    v_add_u32 v23, 2, v21
    v_cmp_ge_u32 vcc, v3, v23
    s_nop 1
    v_cndmask_b32 v230, v22, 0, vcc
    v_add_u32 v23, 3, v21
    v_cmp_ge_u32 vcc, v3, v23
    s_nop 1
    v_cndmask_b32 v231, v22, 0, vcc
    s_lshl_b32 s40, s25, 7
    s_lshl_b32 s41, s45, 5
    s_add_u32 s40, s40, s41
    s_lshl_b32 s40, s40, 11
    s_lshl_b32 s41, s24, 7
    s_add_u32 s40, s40, s41
    s_lshl_b32 s41, s44, 6
    s_add_u32 s40, s40, s41
    v_lshlrev_b32 v225, 12, v8
    v_lshl_add_u32 v225, v5, 4, v225
    v_add_u32 v225, s40, v225
    s_mov_b32 s58, 0x3e3504f3
    s_mov_b32 s59, 0x3fb8aa3b
.p2align 3
g1_cloop:
    s_barrier
g1_cloop2:
    v_mfma_f32_16x16x32_bf16 v[24:27], v[172:175], v[196:199], v[24:27]
    ds_read_b64_tr_b16 v[128:129], v10 offset:0
    ds_read_b64_tr_b16 v[130:131], v10 offset:512
    v_mfma_f32_16x16x32_bf16 v[28:31], v[172:175], v[200:203], v[28:31]
    ds_read_b128 v[152:155], v16 offset:0
    v_mfma_f32_16x16x32_bf16 v[32:35], v[172:175], v[204:207], v[32:35]
    ds_read_b128 v[156:159], v16 offset:2048
    v_mfma_f32_16x16x32_bf16 v[36:39], v[172:175], v[208:211], v[36:39]
    ds_read_b128 v[160:163], v16 offset:4096
    v_mfma_f32_16x16x32_bf16 v[52:55], v[176:179], v[208:211], v[52:55]
    ds_read_b128 v[164:167], v16 offset:6144
    v_mfma_f32_16x16x32_bf16 v[48:51], v[176:179], v[204:207], v[48:51]
    ds_read_b64_tr_b16 v[132:133], v11 offset:0
    ds_read_b64_tr_b16 v[134:135], v11 offset:512
    v_mfma_f32_16x16x32_bf16 v[44:47], v[176:179], v[200:203], v[44:47]
    ds_read_b64_tr_b16 v[136:137], v12 offset:0
    ds_read_b64_tr_b16 v[138:139], v12 offset:512
    v_mfma_f32_16x16x32_bf16 v[40:43], v[176:179], v[196:199], v[40:43]
    ds_read_b64_tr_b16 v[140:141], v13 offset:0
    ds_read_b64_tr_b16 v[142:143], v13 offset:512
    v_mfma_f32_16x16x32_bf16 v[56:59], v[180:183], v[196:199], v[56:59]
    ds_read_b64_tr_b16 v[144:145], v14 offset:0
    ds_read_b64_tr_b16 v[146:147], v14 offset:512
    v_mfma_f32_16x16x32_bf16 v[60:63], v[180:183], v[200:203], v[60:63]
    ds_read_b64_tr_b16 v[148:149], v15 offset:0
    ds_read_b64_tr_b16 v[150:151], v15 offset:512
    v_mfma_f32_16x16x32_bf16 v[64:67], v[180:183], v[204:207], v[64:67]
    ds_read_b128 v[168:171], v18 offset:0
    v_mfma_f32_16x16x32_bf16 v[68:71], v[180:183], v[208:211], v[68:71]
    v_mfma_f32_16x16x32_bf16 v[84:87], v[184:187], v[208:211], v[84:87]
    v_mfma_f32_16x16x32_bf16 v[80:83], v[184:187], v[204:207], v[80:83]
    v_mfma_f32_16x16x32_bf16 v[76:79], v[184:187], v[200:203], v[76:79]
    v_mfma_f32_16x16x32_bf16 v[72:75], v[184:187], v[196:199], v[72:75]
    v_mfma_f32_16x16x32_bf16 v[88:91], v[188:191], v[196:199], v[88:91]
    v_mfma_f32_16x16x32_bf16 v[92:95], v[188:191], v[200:203], v[92:95]
    v_mfma_f32_16x16x32_bf16 v[96:99], v[188:191], v[204:207], v[96:99]
    v_mfma_f32_16x16x32_bf16 v[100:103], v[188:191], v[208:211], v[100:103]
    v_mfma_f32_16x16x32_bf16 v[120:123], v[188:191], v[212:215], v[120:123]
    v_mfma_f32_16x16x32_bf16 v[124:127], v[192:195], v[212:215], v[124:127]
    v_mfma_f32_16x16x32_bf16 v[116:119], v[192:195], v[208:211], v[116:119]
    v_mfma_f32_16x16x32_bf16 v[112:115], v[192:195], v[204:207], v[112:115]
    v_mfma_f32_16x16x32_bf16 v[108:111], v[192:195], v[200:203], v[108:111]
    v_mfma_f32_16x16x32_bf16 v[104:107], v[192:195], v[196:199], v[104:107]
    s_waitcnt lgkmcnt(0)
    v_mfma_f32_16x16x32_bf16 v[24:27], v[128:131], v[152:155], v[24:27]
    ds_read_b64_tr_b16 v[172:173], v10 offset:4096
    ds_read_b64_tr_b16 v[174:175], v10 offset:4608
    v_mfma_f32_16x16x32_bf16 v[28:31], v[128:131], v[156:159], v[28:31]
    ds_read_b128 v[196:199], v17 offset:0
    v_mfma_f32_16x16x32_bf16 v[32:35], v[128:131], v[160:163], v[32:35]
    ds_read_b128 v[200:203], v17 offset:2048
    v_mfma_f32_16x16x32_bf16 v[36:39], v[128:131], v[164:167], v[36:39]
    ds_read_b128 v[204:207], v17 offset:4096
    v_mfma_f32_16x16x32_bf16 v[52:55], v[132:135], v[164:167], v[52:55]
    ds_read_b128 v[208:211], v17 offset:6144
    v_mfma_f32_16x16x32_bf16 v[48:51], v[132:135], v[160:163], v[48:51]
    ds_read_b64_tr_b16 v[176:177], v11 offset:4096
    ds_read_b64_tr_b16 v[178:179], v11 offset:4608
    v_mfma_f32_16x16x32_bf16 v[44:47], v[132:135], v[156:159], v[44:47]
    ds_read_b64_tr_b16 v[180:181], v12 offset:4096
    ds_read_b64_tr_b16 v[182:183], v12 offset:4608
    v_mfma_f32_16x16x32_bf16 v[40:43], v[132:135], v[152:155], v[40:43]
    ds_read_b64_tr_b16 v[184:185], v13 offset:4096
    ds_read_b64_tr_b16 v[186:187], v13 offset:4608
    v_mfma_f32_16x16x32_bf16 v[56:59], v[136:139], v[152:155], v[56:59]
    ds_read_b64_tr_b16 v[188:189], v14 offset:4096
    ds_read_b64_tr_b16 v[190:191], v14 offset:4608
    v_mfma_f32_16x16x32_bf16 v[60:63], v[136:139], v[156:159], v[60:63]
    ds_read_b64_tr_b16 v[192:193], v15 offset:4096
    ds_read_b64_tr_b16 v[194:195], v15 offset:4608
    v_mfma_f32_16x16x32_bf16 v[64:67], v[136:139], v[160:163], v[64:67]
    ds_read_b128 v[212:215], v19 offset:0
    v_mfma_f32_16x16x32_bf16 v[68:71], v[136:139], v[164:167], v[68:71]
    s_add_u32 s50, s50, 1
    s_cmp_eq_u32 s50, 3
    v_mfma_f32_16x16x32_bf16 v[84:87], v[140:143], v[164:167], v[84:87]
    s_cselect_b32 s49, s29, s51
    s_cselect_b32 s50, 0, s50
    v_mfma_f32_16x16x32_bf16 v[80:83], v[140:143], v[160:163], v[80:83]
    v_add_u32 v10, s49, v10
    v_add_u32 v11, s49, v11
    v_mfma_f32_16x16x32_bf16 v[76:79], v[140:143], v[156:159], v[76:79]
    v_add_u32 v12, s49, v12
    v_add_u32 v13, s49, v13
    v_mfma_f32_16x16x32_bf16 v[72:75], v[140:143], v[152:155], v[72:75]
    v_add_u32 v14, s49, v14
    v_add_u32 v15, s49, v15
    v_mfma_f32_16x16x32_bf16 v[88:91], v[144:147], v[152:155], v[88:91]
    v_add_u32 v16, s49, v16
    v_add_u32 v17, s49, v17
    v_mfma_f32_16x16x32_bf16 v[92:95], v[144:147], v[156:159], v[92:95]
    v_add_u32 v18, s49, v18
    v_add_u32 v19, s49, v19
    v_mfma_f32_16x16x32_bf16 v[96:99], v[144:147], v[160:163], v[96:99]
    s_sub_u32 s48, s48, 1
    s_cmp_lg_u32 s48, 0
    v_mfma_f32_16x16x32_bf16 v[100:103], v[144:147], v[164:167], v[100:103]
    v_mfma_f32_16x16x32_bf16 v[120:123], v[144:147], v[168:171], v[120:123]
    v_mfma_f32_16x16x32_bf16 v[124:127], v[148:151], v[168:171], v[124:127]
    v_mfma_f32_16x16x32_bf16 v[116:119], v[148:151], v[164:167], v[116:119]
    v_mfma_f32_16x16x32_bf16 v[112:115], v[148:151], v[160:163], v[112:115]
    v_mfma_f32_16x16x32_bf16 v[108:111], v[148:151], v[156:159], v[108:111]
    v_mfma_f32_16x16x32_bf16 v[104:107], v[148:151], v[152:155], v[104:107]
    s_waitcnt lgkmcnt(0)
    s_cbranch_scc1 g1_cloop
    ds_read_b64 v[128:129], v216 offset:0
    ds_read_b64 v[130:131], v216 offset:128
    ds_read_b64 v[132:133], v216 offset:256
    ds_read_b64 v[134:135], v216 offset:384
    ds_read_b64 v[136:137], v217
    ds_read_b128 v[140:143], v218 offset:0
    ds_read_b128 v[144:147], v218 offset:64
    ds_read_b128 v[148:151], v219 offset:0
    ds_read_b128 v[152:155], v219 offset:64
    ds_read_b128 v[156:159], v220 offset:0
    ds_read_b128 v[160:163], v220 offset:64
    v_mfma_f32_16x16x32_bf16 v[24:27], v[172:175], v[196:199], v[24:27]
    v_mfma_f32_16x16x32_bf16 v[40:43], v[176:179], v[196:199], v[40:43]
    v_mfma_f32_16x16x32_bf16 v[28:31], v[172:175], v[200:203], v[28:31]
    v_mfma_f32_16x16x32_bf16 v[44:47], v[176:179], v[200:203], v[44:47]
    v_mfma_f32_16x16x32_bf16 v[32:35], v[172:175], v[204:207], v[32:35]
    v_mfma_f32_16x16x32_bf16 v[48:51], v[176:179], v[204:207], v[48:51]
    s_waitcnt lgkmcnt(0)
    v_mfma_f32_16x16x32_bf16 v[36:39], v[172:175], v[208:211], v[36:39]
    v_pk_mul_f32 v[164:165], v[140:141], v[128:129] op_sel:[0,1] op_sel_hi:[1,1]
    v_pk_mul_f32 v[166:167], v[142:143], v[128:129] op_sel:[0,1] op_sel_hi:[1,1]
    v_pk_mul_f32 v[168:169], v[144:145], v[128:129] op_sel:[0,1] op_sel_hi:[1,1]
    v_pk_mul_f32 v[170:171], v[146:147], v[128:129] op_sel:[0,1] op_sel_hi:[1,1]
    v_pk_fma_f32 v[24:25], v[24:25], v[128:129], v[164:165] op_sel:[0,0,0] op_sel_hi:[1,0,1]
    v_pk_fma_f32 v[26:27], v[26:27], v[128:129], v[166:167] op_sel:[0,0,0] op_sel_hi:[1,0,1]
    v_pk_fma_f32 v[40:41], v[40:41], v[128:129], v[168:169] op_sel:[0,0,0] op_sel_hi:[1,0,1]
    v_pk_fma_f32 v[42:43], v[42:43], v[128:129], v[170:171] op_sel:[0,0,0] op_sel_hi:[1,0,1]
    v_mfma_f32_16x16x32_bf16 v[52:55], v[176:179], v[208:211], v[52:55]
    v_cvt_pk_bf16_f32 v232, v24, v25
    v_cvt_pk_bf16_f32 v233, v26, v27
    v_cvt_pk_bf16_f32 v234, v40, v41
    v_cvt_pk_bf16_f32 v235, v42, v43
    s_nop 1
    v_permlane16_swap_b32 v232, v234
    v_permlane16_swap_b32 v233, v235
    ds_write_b128 v221, v[232:235] offset:0
    v_mfma_f32_16x16x32_bf16 v[56:59], v[180:183], v[196:199], v[56:59]
    v_pk_mul_f32 v[164:165], v[140:141], v[130:131] op_sel:[0,1] op_sel_hi:[1,1]
    v_pk_mul_f32 v[166:167], v[142:143], v[130:131] op_sel:[0,1] op_sel_hi:[1,1]
    v_pk_mul_f32 v[168:169], v[144:145], v[130:131] op_sel:[0,1] op_sel_hi:[1,1]
    v_pk_mul_f32 v[170:171], v[146:147], v[130:131] op_sel:[0,1] op_sel_hi:[1,1]
    v_pk_fma_f32 v[28:29], v[28:29], v[130:131], v[164:165] op_sel:[0,0,0] op_sel_hi:[1,0,1]
    v_pk_fma_f32 v[30:31], v[30:31], v[130:131], v[166:167] op_sel:[0,0,0] op_sel_hi:[1,0,1]
    v_pk_fma_f32 v[44:45], v[44:45], v[130:131], v[168:169] op_sel:[0,0,0] op_sel_hi:[1,0,1]
    v_pk_fma_f32 v[46:47], v[46:47], v[130:131], v[170:171] op_sel:[0,0,0] op_sel_hi:[1,0,1]
    v_mfma_f32_16x16x32_bf16 v[72:75], v[184:187], v[196:199], v[72:75]
    v_cvt_pk_bf16_f32 v236, v28, v29
    v_cvt_pk_bf16_f32 v237, v30, v31
    v_cvt_pk_bf16_f32 v238, v44, v45
    v_cvt_pk_bf16_f32 v239, v46, v47
    s_nop 1
    v_permlane16_swap_b32 v236, v238
    v_permlane16_swap_b32 v237, v239
    ds_write_b128 v221, v[236:239] offset:2048
    v_mfma_f32_16x16x32_bf16 v[60:63], v[180:183], v[200:203], v[60:63]
    v_pk_mul_f32 v[164:165], v[140:141], v[132:133] op_sel:[0,1] op_sel_hi:[1,1]
    v_pk_mul_f32 v[166:167], v[142:143], v[132:133] op_sel:[0,1] op_sel_hi:[1,1]
    v_pk_mul_f32 v[168:169], v[144:145], v[132:133] op_sel:[0,1] op_sel_hi:[1,1]
    v_pk_mul_f32 v[170:171], v[146:147], v[132:133] op_sel:[0,1] op_sel_hi:[1,1]
    v_pk_fma_f32 v[32:33], v[32:33], v[132:133], v[164:165] op_sel:[0,0,0] op_sel_hi:[1,0,1]
    v_pk_fma_f32 v[34:35], v[34:35], v[132:133], v[166:167] op_sel:[0,0,0] op_sel_hi:[1,0,1]
    v_pk_fma_f32 v[48:49], v[48:49], v[132:133], v[168:169] op_sel:[0,0,0] op_sel_hi:[1,0,1]
    v_pk_fma_f32 v[50:51], v[50:51], v[132:133], v[170:171] op_sel:[0,0,0] op_sel_hi:[1,0,1]
    v_mfma_f32_16x16x32_bf16 v[76:79], v[184:187], v[200:203], v[76:79]
    v_cvt_pk_bf16_f32 v240, v32, v33
    v_cvt_pk_bf16_f32 v241, v34, v35
    v_cvt_pk_bf16_f32 v242, v48, v49
    v_cvt_pk_bf16_f32 v243, v50, v51
    s_nop 1
    v_permlane16_swap_b32 v240, v242
    v_permlane16_swap_b32 v241, v243
    ds_write_b128 v221, v[240:243] offset:4096
    v_mfma_f32_16x16x32_bf16 v[64:67], v[180:183], v[204:207], v[64:67]
    v_pk_mul_f32 v[164:165], v[140:141], v[134:135] op_sel:[0,1] op_sel_hi:[1,1]
    v_pk_mul_f32 v[166:167], v[142:143], v[134:135] op_sel:[0,1] op_sel_hi:[1,1]
    v_pk_mul_f32 v[168:169], v[144:145], v[134:135] op_sel:[0,1] op_sel_hi:[1,1]
    v_pk_mul_f32 v[170:171], v[146:147], v[134:135] op_sel:[0,1] op_sel_hi:[1,1]
    v_pk_fma_f32 v[36:37], v[36:37], v[134:135], v[164:165] op_sel:[0,0,0] op_sel_hi:[1,0,1]
    v_pk_fma_f32 v[38:39], v[38:39], v[134:135], v[166:167] op_sel:[0,0,0] op_sel_hi:[1,0,1]
    v_pk_fma_f32 v[52:53], v[52:53], v[134:135], v[168:169] op_sel:[0,0,0] op_sel_hi:[1,0,1]
    v_pk_fma_f32 v[54:55], v[54:55], v[134:135], v[170:171] op_sel:[0,0,0] op_sel_hi:[1,0,1]
    v_mfma_f32_16x16x32_bf16 v[80:83], v[184:187], v[204:207], v[80:83]
    v_cvt_pk_bf16_f32 v244, v36, v37
    v_cvt_pk_bf16_f32 v245, v38, v39
    v_cvt_pk_bf16_f32 v246, v52, v53
    v_cvt_pk_bf16_f32 v247, v54, v55
    s_nop 1
    v_permlane16_swap_b32 v244, v246
    v_permlane16_swap_b32 v245, v247
    ds_write_b128 v221, v[244:247] offset:6144
    v_mfma_f32_16x16x32_bf16 v[68:71], v[180:183], v[208:211], v[68:71]
    v_pk_mul_f32 v[164:165], v[148:149], v[128:129] op_sel:[0,1] op_sel_hi:[1,1]
    v_pk_mul_f32 v[166:167], v[150:151], v[128:129] op_sel:[0,1] op_sel_hi:[1,1]
    v_pk_mul_f32 v[168:169], v[152:153], v[128:129] op_sel:[0,1] op_sel_hi:[1,1]
    v_pk_mul_f32 v[170:171], v[154:155], v[128:129] op_sel:[0,1] op_sel_hi:[1,1]
    v_pk_fma_f32 v[56:57], v[56:57], v[128:129], v[164:165] op_sel:[0,0,0] op_sel_hi:[1,0,1]
    v_pk_fma_f32 v[58:59], v[58:59], v[128:129], v[166:167] op_sel:[0,0,0] op_sel_hi:[1,0,1]
    v_pk_fma_f32 v[72:73], v[72:73], v[128:129], v[168:169] op_sel:[0,0,0] op_sel_hi:[1,0,1]
    v_pk_fma_f32 v[74:75], v[74:75], v[128:129], v[170:171] op_sel:[0,0,0] op_sel_hi:[1,0,1]
    v_mfma_f32_16x16x32_bf16 v[84:87], v[184:187], v[208:211], v[84:87]
    v_cvt_pk_bf16_f32 v232, v56, v57
    v_cvt_pk_bf16_f32 v233, v58, v59
    v_cvt_pk_bf16_f32 v234, v72, v73
    v_cvt_pk_bf16_f32 v235, v74, v75
    s_nop 1
    v_permlane16_swap_b32 v232, v234
    v_permlane16_swap_b32 v233, v235
    ds_write_b128 v222, v[232:235] offset:0
    v_mfma_f32_16x16x32_bf16 v[88:91], v[188:191], v[196:199], v[88:91]
    v_pk_mul_f32 v[164:165], v[148:149], v[130:131] op_sel:[0,1] op_sel_hi:[1,1]
    v_pk_mul_f32 v[166:167], v[150:151], v[130:131] op_sel:[0,1] op_sel_hi:[1,1]
    v_pk_mul_f32 v[168:169], v[152:153], v[130:131] op_sel:[0,1] op_sel_hi:[1,1]
    v_pk_mul_f32 v[170:171], v[154:155], v[130:131] op_sel:[0,1] op_sel_hi:[1,1]
    v_pk_fma_f32 v[60:61], v[60:61], v[130:131], v[164:165] op_sel:[0,0,0] op_sel_hi:[1,0,1]
    v_pk_fma_f32 v[62:63], v[62:63], v[130:131], v[166:167] op_sel:[0,0,0] op_sel_hi:[1,0,1]
    v_pk_fma_f32 v[76:77], v[76:77], v[130:131], v[168:169] op_sel:[0,0,0] op_sel_hi:[1,0,1]
    v_pk_fma_f32 v[78:79], v[78:79], v[130:131], v[170:171] op_sel:[0,0,0] op_sel_hi:[1,0,1]
    v_mfma_f32_16x16x32_bf16 v[104:107], v[192:195], v[196:199], v[104:107]
    v_cvt_pk_bf16_f32 v236, v60, v61
    v_cvt_pk_bf16_f32 v237, v62, v63
    v_cvt_pk_bf16_f32 v238, v76, v77
    v_cvt_pk_bf16_f32 v239, v78, v79
    s_nop 1
    v_permlane16_swap_b32 v236, v238
    v_permlane16_swap_b32 v237, v239
    ds_write_b128 v222, v[236:239] offset:2048
    v_mfma_f32_16x16x32_bf16 v[92:95], v[188:191], v[200:203], v[92:95]
    v_pk_mul_f32 v[164:165], v[148:149], v[132:133] op_sel:[0,1] op_sel_hi:[1,1]
    v_pk_mul_f32 v[166:167], v[150:151], v[132:133] op_sel:[0,1] op_sel_hi:[1,1]
    v_pk_mul_f32 v[168:169], v[152:153], v[132:133] op_sel:[0,1] op_sel_hi:[1,1]
    v_pk_mul_f32 v[170:171], v[154:155], v[132:133] op_sel:[0,1] op_sel_hi:[1,1]
    v_pk_fma_f32 v[64:65], v[64:65], v[132:133], v[164:165] op_sel:[0,0,0] op_sel_hi:[1,0,1]
    v_pk_fma_f32 v[66:67], v[66:67], v[132:133], v[166:167] op_sel:[0,0,0] op_sel_hi:[1,0,1]
    v_pk_fma_f32 v[80:81], v[80:81], v[132:133], v[168:169] op_sel:[0,0,0] op_sel_hi:[1,0,1]
    v_pk_fma_f32 v[82:83], v[82:83], v[132:133], v[170:171] op_sel:[0,0,0] op_sel_hi:[1,0,1]
    v_mfma_f32_16x16x32_bf16 v[108:111], v[192:195], v[200:203], v[108:111]
    v_cvt_pk_bf16_f32 v240, v64, v65
    v_cvt_pk_bf16_f32 v241, v66, v67
    v_cvt_pk_bf16_f32 v242, v80, v81
    v_cvt_pk_bf16_f32 v243, v82, v83
    s_nop 1
    v_permlane16_swap_b32 v240, v242
    v_permlane16_swap_b32 v241, v243
    ds_write_b128 v222, v[240:243] offset:4096
    v_mfma_f32_16x16x32_bf16 v[96:99], v[188:191], v[204:207], v[96:99]
    v_pk_mul_f32 v[164:165], v[148:149], v[134:135] op_sel:[0,1] op_sel_hi:[1,1]
    v_pk_mul_f32 v[166:167], v[150:151], v[134:135] op_sel:[0,1] op_sel_hi:[1,1]
    v_pk_mul_f32 v[168:169], v[152:153], v[134:135] op_sel:[0,1] op_sel_hi:[1,1]
    v_pk_mul_f32 v[170:171], v[154:155], v[134:135] op_sel:[0,1] op_sel_hi:[1,1]
    v_pk_fma_f32 v[68:69], v[68:69], v[134:135], v[164:165] op_sel:[0,0,0] op_sel_hi:[1,0,1]
    v_pk_fma_f32 v[70:71], v[70:71], v[134:135], v[166:167] op_sel:[0,0,0] op_sel_hi:[1,0,1]
    v_pk_fma_f32 v[84:85], v[84:85], v[134:135], v[168:169] op_sel:[0,0,0] op_sel_hi:[1,0,1]
    v_pk_fma_f32 v[86:87], v[86:87], v[134:135], v[170:171] op_sel:[0,0,0] op_sel_hi:[1,0,1]
    v_mfma_f32_16x16x32_bf16 v[112:115], v[192:195], v[204:207], v[112:115]
    v_cvt_pk_bf16_f32 v244, v68, v69
    v_cvt_pk_bf16_f32 v245, v70, v71
    v_cvt_pk_bf16_f32 v246, v84, v85
    v_cvt_pk_bf16_f32 v247, v86, v87
    s_nop 1
    v_permlane16_swap_b32 v244, v246
    v_permlane16_swap_b32 v245, v247
    ds_write_b128 v222, v[244:247] offset:6144
    v_mfma_f32_16x16x32_bf16 v[100:103], v[188:191], v[208:211], v[100:103]
    v_pk_mul_f32 v[164:165], v[156:157], v[128:129] op_sel:[0,1] op_sel_hi:[1,1]
    v_pk_mul_f32 v[166:167], v[158:159], v[128:129] op_sel:[0,1] op_sel_hi:[1,1]
    v_pk_mul_f32 v[168:169], v[160:161], v[128:129] op_sel:[0,1] op_sel_hi:[1,1]
    v_pk_mul_f32 v[170:171], v[162:163], v[128:129] op_sel:[0,1] op_sel_hi:[1,1]
    v_pk_fma_f32 v[88:89], v[88:89], v[128:129], v[164:165] op_sel:[0,0,0] op_sel_hi:[1,0,1]
    v_pk_fma_f32 v[90:91], v[90:91], v[128:129], v[166:167] op_sel:[0,0,0] op_sel_hi:[1,0,1]
    v_pk_fma_f32 v[104:105], v[104:105], v[128:129], v[168:169] op_sel:[0,0,0] op_sel_hi:[1,0,1]
    v_pk_fma_f32 v[106:107], v[106:107], v[128:129], v[170:171] op_sel:[0,0,0] op_sel_hi:[1,0,1]
    v_mfma_f32_16x16x32_bf16 v[116:119], v[192:195], v[208:211], v[116:119]
    v_cvt_pk_bf16_f32 v232, v88, v89
    v_cvt_pk_bf16_f32 v233, v90, v91
    v_cvt_pk_bf16_f32 v234, v104, v105
    v_cvt_pk_bf16_f32 v235, v106, v107
    s_nop 1
    v_permlane16_swap_b32 v232, v234
    v_permlane16_swap_b32 v233, v235
    ds_write_b128 v223, v[232:235] offset:0
    v_mfma_f32_16x16x32_bf16 v[120:123], v[188:191], v[212:215], v[120:123]
    v_pk_mul_f32 v[164:165], v[156:157], v[130:131] op_sel:[0,1] op_sel_hi:[1,1]
    v_pk_mul_f32 v[166:167], v[158:159], v[130:131] op_sel:[0,1] op_sel_hi:[1,1]
    v_pk_mul_f32 v[168:169], v[160:161], v[130:131] op_sel:[0,1] op_sel_hi:[1,1]
    v_pk_mul_f32 v[170:171], v[162:163], v[130:131] op_sel:[0,1] op_sel_hi:[1,1]
    v_pk_fma_f32 v[92:93], v[92:93], v[130:131], v[164:165] op_sel:[0,0,0] op_sel_hi:[1,0,1]
    v_pk_fma_f32 v[94:95], v[94:95], v[130:131], v[166:167] op_sel:[0,0,0] op_sel_hi:[1,0,1]
    v_pk_fma_f32 v[108:109], v[108:109], v[130:131], v[168:169] op_sel:[0,0,0] op_sel_hi:[1,0,1]
    v_pk_fma_f32 v[110:111], v[110:111], v[130:131], v[170:171] op_sel:[0,0,0] op_sel_hi:[1,0,1]
    v_mfma_f32_16x16x32_bf16 v[124:127], v[192:195], v[212:215], v[124:127]
    v_cvt_pk_bf16_f32 v236, v92, v93
    v_cvt_pk_bf16_f32 v237, v94, v95
    v_cvt_pk_bf16_f32 v238, v108, v109
    v_cvt_pk_bf16_f32 v239, v110, v111
    s_nop 1
    v_permlane16_swap_b32 v236, v238
    v_permlane16_swap_b32 v237, v239
    ds_write_b128 v223, v[236:239] offset:2048
    v_pk_mul_f32 v[164:165], v[156:157], v[132:133] op_sel:[0,1] op_sel_hi:[1,1]
    v_pk_mul_f32 v[166:167], v[158:159], v[132:133] op_sel:[0,1] op_sel_hi:[1,1]
    v_pk_mul_f32 v[168:169], v[160:161], v[132:133] op_sel:[0,1] op_sel_hi:[1,1]
    v_pk_mul_f32 v[170:171], v[162:163], v[132:133] op_sel:[0,1] op_sel_hi:[1,1]
    v_pk_fma_f32 v[96:97], v[96:97], v[132:133], v[164:165] op_sel:[0,0,0] op_sel_hi:[1,0,1]
    v_pk_fma_f32 v[98:99], v[98:99], v[132:133], v[166:167] op_sel:[0,0,0] op_sel_hi:[1,0,1]
    v_pk_fma_f32 v[112:113], v[112:113], v[132:133], v[168:169] op_sel:[0,0,0] op_sel_hi:[1,0,1]
    v_pk_fma_f32 v[114:115], v[114:115], v[132:133], v[170:171] op_sel:[0,0,0] op_sel_hi:[1,0,1]
    v_cvt_pk_bf16_f32 v240, v96, v97
    v_cvt_pk_bf16_f32 v241, v98, v99
    v_cvt_pk_bf16_f32 v242, v112, v113
    v_cvt_pk_bf16_f32 v243, v114, v115
    s_nop 1
    v_permlane16_swap_b32 v240, v242
    v_permlane16_swap_b32 v241, v243
    ds_write_b128 v223, v[240:243] offset:4096
    v_pk_mul_f32 v[164:165], v[156:157], v[134:135] op_sel:[0,1] op_sel_hi:[1,1]
    v_pk_mul_f32 v[166:167], v[158:159], v[134:135] op_sel:[0,1] op_sel_hi:[1,1]
    v_pk_mul_f32 v[168:169], v[160:161], v[134:135] op_sel:[0,1] op_sel_hi:[1,1]
    v_pk_mul_f32 v[170:171], v[162:163], v[134:135] op_sel:[0,1] op_sel_hi:[1,1]
    v_pk_fma_f32 v[100:101], v[100:101], v[134:135], v[164:165] op_sel:[0,0,0] op_sel_hi:[1,0,1]
    v_pk_fma_f32 v[102:103], v[102:103], v[134:135], v[166:167] op_sel:[0,0,0] op_sel_hi:[1,0,1]
    v_pk_fma_f32 v[116:117], v[116:117], v[134:135], v[168:169] op_sel:[0,0,0] op_sel_hi:[1,0,1]
    v_pk_fma_f32 v[118:119], v[118:119], v[134:135], v[170:171] op_sel:[0,0,0] op_sel_hi:[1,0,1]
    v_cvt_pk_bf16_f32 v244, v100, v101
    v_cvt_pk_bf16_f32 v245, v102, v103
    v_cvt_pk_bf16_f32 v246, v116, v117
    v_cvt_pk_bf16_f32 v247, v118, v119
    s_nop 1
    v_permlane16_swap_b32 v244, v246
    v_permlane16_swap_b32 v245, v247
    ds_write_b128 v223, v[244:247] offset:6144
    v_pk_mul_f32 v[164:165], v[156:157], v[136:137] op_sel:[0,1] op_sel_hi:[1,1]
    v_pk_mul_f32 v[166:167], v[158:159], v[136:137] op_sel:[0,1] op_sel_hi:[1,1]
    v_pk_mul_f32 v[168:169], v[160:161], v[136:137] op_sel:[0,1] op_sel_hi:[1,1]
    v_pk_mul_f32 v[170:171], v[162:163], v[136:137] op_sel:[0,1] op_sel_hi:[1,1]
    v_pk_fma_f32 v[120:121], v[120:121], v[136:137], v[164:165] op_sel:[0,0,0] op_sel_hi:[1,0,1]
    v_pk_fma_f32 v[122:123], v[122:123], v[136:137], v[166:167] op_sel:[0,0,0] op_sel_hi:[1,0,1]
    v_pk_fma_f32 v[124:125], v[124:125], v[136:137], v[168:169] op_sel:[0,0,0] op_sel_hi:[1,0,1]
    v_pk_fma_f32 v[126:127], v[126:127], v[136:137], v[170:171] op_sel:[0,0,0] op_sel_hi:[1,0,1]
    v_cvt_pk_bf16_f32 v232, v120, v121
    v_cvt_pk_bf16_f32 v233, v122, v123
    v_cvt_pk_bf16_f32 v234, v124, v125
    v_cvt_pk_bf16_f32 v235, v126, v127
    s_nop 1
    v_permlane16_swap_b32 v232, v234
    v_permlane16_swap_b32 v233, v235
    ds_write_b128 v224, v[232:235]
    s_waitcnt lgkmcnt(0)
g1_attn:
    s_barrier
    ds_read_b128 v[24:27], v226 offset:2048
    ds_read_b128 v[28:31], v226 offset:18432
    ds_read_b128 v[32:35], v226 offset:20480
    ds_read_b128 v[72:75], v226 offset:2176
    ds_read_b128 v[76:79], v226 offset:18560
    ds_read_b128 v[80:83], v226 offset:20608
    ds_read_b64_tr_b16 v[36:37], v227 offset:0
    ds_read_b64_tr_b16 v[38:39], v227 offset:2048
    ds_read_b64_tr_b16 v[40:41], v227 offset:8
    ds_read_b64_tr_b16 v[42:43], v227 offset:2056
    ds_read_b64_tr_b16 v[84:85], v227 offset:128
    ds_read_b64_tr_b16 v[86:87], v227 offset:2176
    ds_read_b64_tr_b16 v[88:89], v227 offset:136
    ds_read_b64_tr_b16 v[90:91], v227 offset:2184
    s_waitcnt lgkmcnt(8)
    v_mfma_f32_16x16x32_bf16 v[44:47], v[28:31], v[24:27], 0
    v_mfma_f32_16x16x32_bf16 v[48:51], v[32:35], v[24:27], 0
    v_mfma_f32_16x16x32_bf16 v[92:95], v[76:79], v[72:75], 0
    v_mfma_f32_16x16x32_bf16 v[96:99], v[80:83], v[72:75], 0
    s_nop 7
    v_cndmask_b32 v44, v48, v44, s[56:57]
    v_cndmask_b32 v45, v49, v45, s[56:57]
    v_cndmask_b32 v46, v50, v46, s[56:57]
    v_cndmask_b32 v47, v51, v47, s[56:57]
    v_cndmask_b32 v92, v96, v92, s[56:57]
    v_cndmask_b32 v93, v97, v93, s[56:57]
    v_cndmask_b32 v94, v98, v94, s[56:57]
    v_cndmask_b32 v95, v99, v95, s[56:57]
    v_cvt_pk_bf16_f32 v48, v44, v45
    v_cvt_pk_bf16_f32 v49, v46, v47
    v_cvt_pk_bf16_f32 v96, v92, v93
    v_cvt_pk_bf16_f32 v97, v94, v95
    v_lshlrev_b32 v44, 16, v48
    v_and_b32 v45, 0xffff0000, v48
    v_lshlrev_b32 v46, 16, v49
    v_and_b32 v47, 0xffff0000, v49
    v_lshlrev_b32 v92, 16, v96
    v_and_b32 v93, 0xffff0000, v96
    v_lshlrev_b32 v94, 16, v97
    v_and_b32 v95, 0xffff0000, v97
    v_mul_f32 v44, s58, v44
    v_mul_f32 v45, s58, v45
    v_mul_f32 v46, s58, v46
    v_mul_f32 v47, s58, v47
    v_mul_f32 v92, s58, v92
    v_mul_f32 v93, s58, v93
    v_mul_f32 v94, s58, v94
    v_mul_f32 v95, s58, v95
    v_cvt_pk_bf16_f32 v48, v44, v45
    v_cvt_pk_bf16_f32 v49, v46, v47
    v_cvt_pk_bf16_f32 v96, v92, v93
    v_cvt_pk_bf16_f32 v97, v94, v95
    v_lshlrev_b32 v44, 16, v48
    v_and_b32 v45, 0xffff0000, v48
    v_lshlrev_b32 v46, 16, v49
    v_and_b32 v47, 0xffff0000, v49
    v_lshlrev_b32 v92, 16, v96
    v_and_b32 v93, 0xffff0000, v96
    v_lshlrev_b32 v94, 16, v97
    v_and_b32 v95, 0xffff0000, v97
    v_fma_f32 v44, v44, s59, v228
    v_fma_f32 v45, v45, s59, v229
    v_fma_f32 v46, v46, s59, v230
    v_fma_f32 v47, v47, s59, v231
    v_fma_f32 v92, v92, s59, v228
    v_fma_f32 v93, v93, s59, v229
    v_fma_f32 v94, v94, s59, v230
    v_fma_f32 v95, v95, s59, v231
    v_max3_f32 v48, v44, v45, v46
    v_max3_f32 v96, v92, v93, v94
    v_max_f32 v48, v48, v47
    v_max_f32 v96, v96, v95
    v_mov_b32 v49, v48
    v_mov_b32 v97, v96
    s_nop 1
    v_permlane16_swap_b32 v48, v49
    v_permlane16_swap_b32 v96, v97
    s_nop 0
    v_max_f32 v48, v48, v49
    v_max_f32 v96, v96, v97
    v_mov_b32 v49, v48
    v_mov_b32 v97, v96
    s_nop 1
    v_permlane32_swap_b32 v48, v49
    v_permlane32_swap_b32 v96, v97
    s_nop 0
    v_max_f32 v48, v48, v49
    v_max_f32 v96, v96, v97
    v_sub_f32 v44, v44, v48
    v_sub_f32 v45, v45, v48
    v_sub_f32 v46, v46, v48
    v_sub_f32 v47, v47, v48
    v_sub_f32 v92, v92, v96
    v_sub_f32 v93, v93, v96
    v_sub_f32 v94, v94, v96
    v_sub_f32 v95, v95, v96
    v_exp_f32 v44, v44
    v_exp_f32 v45, v45
    v_exp_f32 v46, v46
    v_exp_f32 v47, v47
    v_exp_f32 v92, v92
    v_exp_f32 v93, v93
    v_exp_f32 v94, v94
    v_exp_f32 v95, v95
    v_add_f32 v48, v44, v45
    v_add_f32 v49, v46, v47
    v_add_f32 v96, v92, v93
    v_add_f32 v97, v94, v95
    v_add_f32 v48, v48, v49
    v_add_f32 v96, v96, v97
    v_mov_b32 v49, v48
    v_mov_b32 v97, v96
    s_nop 1
    v_permlane16_swap_b32 v48, v49
    v_permlane16_swap_b32 v96, v97
    s_nop 0
    v_add_f32 v48, v48, v49
    v_add_f32 v96, v96, v97
    v_mov_b32 v49, v48
    v_mov_b32 v97, v96
    s_nop 1
    v_permlane32_swap_b32 v48, v49
    v_permlane32_swap_b32 v96, v97
    s_nop 0
    v_add_f32 v48, v48, v49
    v_add_f32 v96, v96, v97
    v_rcp_f32 v48, v48
    v_rcp_f32 v96, v96
    s_nop 0
    v_mul_f32 v44, v44, v48
    v_mul_f32 v45, v45, v48
    v_mul_f32 v46, v46, v48
    v_mul_f32 v47, v47, v48
    v_mul_f32 v92, v92, v96
    v_mul_f32 v93, v93, v96
    v_mul_f32 v94, v94, v96
    v_mul_f32 v95, v95, v96
    v_cvt_pk_bf16_f32 v48, v44, v45
    v_cvt_pk_bf16_f32 v49, v46, v47
    v_cvt_pk_bf16_f32 v96, v92, v93
    v_cvt_pk_bf16_f32 v97, v94, v95
    v_cndmask_b32 v52, 0, v48, s[56:57]
    v_cndmask_b32 v53, 0, v49, s[56:57]
    v_cndmask_b32 v54, v48, 0, s[56:57]
    v_cndmask_b32 v55, v49, 0, s[56:57]
    v_cndmask_b32 v100, 0, v96, s[56:57]
    v_cndmask_b32 v101, 0, v97, s[56:57]
    v_cndmask_b32 v102, v96, 0, s[56:57]
    v_cndmask_b32 v103, v97, 0, s[56:57]
    s_waitcnt lgkmcnt(0)
    s_nop 0
    v_mfma_f32_16x16x32_bf16 v[56:59], v[36:39], v[52:55], 0
    v_mfma_f32_16x16x32_bf16 v[60:63], v[40:43], v[52:55], 0
    v_mfma_f32_16x16x32_bf16 v[104:107], v[84:87], v[100:103], 0
    v_mfma_f32_16x16x32_bf16 v[108:111], v[88:91], v[100:103], 0
    s_nop 7
    v_cvt_pk_bf16_f32 v64, v56, v57
    v_cvt_pk_bf16_f32 v65, v58, v59
    v_cvt_pk_bf16_f32 v66, v60, v61
    v_cvt_pk_bf16_f32 v67, v62, v63
    buffer_store_dwordx4 v[64:67], v225, s[16:19], 0 offen offset:0 sc1
    v_cvt_pk_bf16_f32 v112, v104, v105
    v_cvt_pk_bf16_f32 v113, v106, v107
    v_cvt_pk_bf16_f32 v114, v108, v109
    v_cvt_pk_bf16_f32 v115, v110, v111
    buffer_store_dwordx4 v[112:115], v225, s[16:19], 0 offen offset:2048 sc1
    s_add_u32 s40, s25, 0
    s_lshl_b32 s40, s40, 8
    s_add_u32 s84, s4, 0x300000
    s_addc_u32 s85, s5, 0
    s_mov_b32 s86, 0x4000
    s_mov_b32 s87, 0x20000
    v_mov_b32 v3, s40
    v_mov_b32 v4, 1
    s_waitcnt vmcnt(0)
    s_barrier
    s_cmp_lg_u32 s28, 0
    s_cbranch_scc1 g1_cin
    s_mov_b64 exec, 1
    buffer_atomic_add v4, v3, s[84:87], 0 offen sc1
    s_mov_b64 exec, -1
g1_cin:
    s_branch g2_in
g1_done:
    s_endpgm
.p2align 6
g2_in:
    s_cmp_ge_u32 s2, 256
    s_cbranch_scc1 g2_done
    s_load_dwordx2 s[4:5], s[0:1], 80
    s_load_dwordx2 s[6:7], s[0:1], 0
    s_load_dwordx2 s[30:31], s[0:1], 16
    v_lshrrev_b32 v1, 6, v0
    v_and_b32 v2, 63, v0
    s_and_b32 s40, s2, 3
    s_lshl_b32 s40, s40, 2
    s_bfe_u32 s41, s2, 0x20003
    s_add_u32 s25, s40, s41
    s_bfe_u32 s40, s2, 0x10002
    s_lshl_b32 s40, s40, 3
    s_lshr_b32 s42, s2, 5
    s_add_u32 s24, s40, s42
    s_add_u32 s27, s41, s42
    s_mov_b32 s26, 0
    v_readfirstlane_b32 s28, v1
    s_nop 0
    s_cmp_lt_u32 s28, 4
    s_cbranch_scc1 g2_compute
    s_sub_u32 s28, s28, 4
    s_mov_b32 s40, 2048
    v_lshrrev_b32 v3, 3, v2
    v_mul_lo_u32 v3, v3, s40
    v_bfe_u32 v4, v2, 4, 1
    v_lshlrev_b32 v4, 1, v4
    v_xor_b32 v4, v4, v2
    v_and_b32 v4, 7, v4
    v_lshl_add_u32 v3, v4, 4, v3
    s_mul_i32 s41, s24, 128
    s_mul_i32 s42, s28, 32768
    s_add_u32 s41, s41, s42
    v_xor_b32 v4, 64, v3
    s_add_u32 s42, s41, 0
    v_add_u32 v10, s42, v3
    s_add_u32 s42, s41, 16384
    v_add_u32 v11, s42, v4
    s_mov_b32 s40, 2048
    v_lshrrev_b32 v3, 3, v2
    v_mul_lo_u32 v3, v3, s40
    v_lshrrev_b32 v4, 4, v2
    v_xor_b32 v4, v4, v2
    v_and_b32 v4, 7, v4
    v_lshl_add_u32 v3, v4, 4, v3
    s_mul_i32 s41, s25, 262144
    s_mul_i32 s42, s28, 65536
    s_add_u32 s41, s41, s42
    v_xor_b32 v4, 64, v3
    s_add_u32 s42, s41, 0
    v_add_u32 v12, s42, v3
    s_add_u32 s42, s41, 16384
    v_add_u32 v13, s42, v4
    s_add_u32 s42, s41, 32768
    v_add_u32 v14, s42, v3
    s_add_u32 s42, s41, 49152
    v_add_u32 v15, s42, v4
    s_mul_i32 s36, s28, 2048
    s_mul_i32 s37, s28, 4096
    s_add_u32 s37, s37, 8192
    s_waitcnt lgkmcnt(0)
    s_add_u32 s4, s4, s97
    s_addc_u32 s5, s5, 0
    s_mov_b32 s8, s30
    s_mov_b32 s9, s31
    s_mov_b32 s10, 0x200000
    s_mov_b32 s11, 0x20000
    s_add_u32 s12, s4, 0x400000
    s_addc_u32 s13, s5, 0
    s_mov_b32 s14, 0x400000
    s_mov_b32 s15, 0x20000
    s_mov_b32 s32, 0
    s_mov_b32 s33, 0
g2_ld_pW:
    s_add_u32 s40, s32, s27
    s_and_b32 s40, s40, 1
    s_andn2_b32 s41, s32, 1
    s_or_b32 s40, s40, s41
    s_add_u32 s40, s40, s26
    s_mul_i32 s34, s40, 131072
    s_mul_i32 s35, s40, 128
    s_add_u32 s38, s33, s36
    s_add_u32 s39, s33, s37
    s_add_u32 m0, s38, 0
    s_nop 0
    buffer_load_dwordx4 v10, s[8:11], s34 offen lds
    s_add_u32 m0, s38, 1024
    s_nop 0
    buffer_load_dwordx4 v11, s[8:11], s34 offen lds
    s_add_u32 s33, s33, 24576
    s_add_u32 s32, s32, 1
    s_cmp_lt_u32 s32, 3
    s_cbranch_scc1 g2_ld_pW
    s_lshr_b32 s40, s25, 0
    s_add_u32 s40, s40, 0
    s_lshl_b32 s40, s40, 8
    s_mov_b32 s42, s40
    s_lshl_b32 s43, s96, 2
    s_add_u32 s43, s43, 2
    s_mov_b32 s41, 0x80000
    v_mov_b32 v24, 131072
    s_cmp_lg_u32 s28, 0
    s_cbranch_scc1 g2_dep_lds
    s_mov_b32 s41, 0x8000
    s_add_u32 s84, s4, 0x300000
    s_addc_u32 s85, s5, 0
    s_mov_b32 s86, 0x4000
    s_mov_b32 s87, 0x20000
    v_cmp_eq_u32 vcc, 1, v2
    v_mov_b32 v21, s40
    v_mov_b32 v23, s42
    v_cndmask_b32 v21, v21, v23, vcc
    v_mov_b32 v22, 16
    v_mov_b32 v23, 16
    v_cndmask_b32 v22, v22, v23, vcc
g2_dep:
    buffer_load_dword v23, v21, s[84:87], 0 offen sc1
    s_sub_u32 s41, s41, 1
    s_waitcnt vmcnt(0)
    v_cmp_lt_u32 vcc, v23, v22
    s_cmp_eq_u32 s41, 0
    s_cbranch_scc1 g2_dep_seen
    s_cbranch_vccz g2_dep_seen
    s_sleep 2
    s_branch g2_dep
g2_dep_seen:
    v_mov_b32 v23, s43
    ds_write_b32 v24, v23
    s_branch g2_dep_ok
g2_dep_lds:
    ds_read_b32 v23, v24
    s_sub_u32 s41, s41, 1
    s_waitcnt lgkmcnt(0)
    v_readfirstlane_b32 s40, v23
    s_cmp_eq_u32 s41, 0
    s_cbranch_scc1 g2_dep_ok
    s_cmp_eq_u32 s40, s43
    s_cbranch_scc1 g2_dep_ok
    s_sleep 1
    s_branch g2_dep_lds
g2_dep_ok:
    s_mov_b32 s32, 0
    s_mov_b32 s33, 0
g2_ld_pA:
    s_add_u32 s40, s32, s27
    s_and_b32 s40, s40, 1
    s_andn2_b32 s41, s32, 1
    s_or_b32 s40, s40, s41
    s_add_u32 s40, s40, s26
    s_mul_i32 s34, s40, 131072
    s_mul_i32 s35, s40, 128
    s_add_u32 s38, s33, s36
    s_add_u32 s39, s33, s37
    s_add_u32 m0, s39, 0
    s_nop 0
    buffer_load_dwordx4 v12, s[12:15], s35 offen sc1 lds
    s_add_u32 m0, s39, 1024
    s_nop 0
    buffer_load_dwordx4 v13, s[12:15], s35 offen sc1 lds
    s_add_u32 m0, s39, 2048
    s_nop 0
    buffer_load_dwordx4 v14, s[12:15], s35 offen sc1 lds
    s_add_u32 m0, s39, 3072
    s_nop 0
    buffer_load_dwordx4 v15, s[12:15], s35 offen sc1 lds
    s_add_u32 s33, s33, 24576
    s_add_u32 s32, s32, 1
    s_cmp_lt_u32 s32, 3
    s_cbranch_scc1 g2_ld_pA
    s_waitcnt vmcnt(8)
    s_branch g2_ld_bar
g2_ld_loop:
    s_cmp_eq_u32 s32, 4
    s_cbranch_scc1 g2_ld_s4
    s_waitcnt vmcnt(12)
g2_ld_bar:
    s_barrier
    s_add_u32 s40, s32, s27
    s_and_b32 s40, s40, 1
    s_andn2_b32 s41, s32, 1
    s_or_b32 s40, s40, s41
    s_add_u32 s40, s40, s26
    s_mul_i32 s34, s40, 131072
    s_mul_i32 s35, s40, 128
    s_add_u32 s38, s33, s36
    s_add_u32 s39, s33, s37
    s_add_u32 m0, s38, 0
    s_nop 0
    buffer_load_dwordx4 v10, s[8:11], s34 offen lds
    s_add_u32 m0, s38, 1024
    s_nop 0
    buffer_load_dwordx4 v11, s[8:11], s34 offen lds
    s_add_u32 m0, s39, 0
    s_nop 0
    buffer_load_dwordx4 v12, s[12:15], s35 offen sc1 lds
    s_add_u32 m0, s39, 1024
    s_nop 0
    buffer_load_dwordx4 v13, s[12:15], s35 offen sc1 lds
    s_add_u32 m0, s39, 2048
    s_nop 0
    buffer_load_dwordx4 v14, s[12:15], s35 offen sc1 lds
    s_add_u32 m0, s39, 3072
    s_nop 0
    buffer_load_dwordx4 v15, s[12:15], s35 offen sc1 lds
    s_add_u32 s33, s33, 24576
    s_add_u32 s32, s32, 1
    s_cmp_eq_u32 s33, 98304
    s_cselect_b32 s33, 0, s33
    s_cmp_lt_u32 s32, 16
    s_cbranch_scc1 g2_ld_loop
    s_waitcnt vmcnt(12)
    s_barrier
    s_waitcnt vmcnt(6)
    s_barrier
    s_waitcnt vmcnt(0)
    s_barrier
    s_branch g2_ld_end
g2_ld_s4:
    s_waitcnt vmcnt(10)
    s_branch g2_ld_bar
g2_ld_end:
    s_barrier
    s_branch g3_in
g2_done:
    s_endpgm
g2_compute:
    v_lshrrev_b32 v5, 4, v2
    v_bfe_u32 v6, v2, 2, 2
    v_and_b32 v7, 3, v2
    v_and_b32 v8, 15, v2
    s_and_b32 s44, s28, 0
    s_lshr_b32 s45, s28, 0
    s_mul_i32 s40, s25, 128
    s_mul_i32 s41, s45, 32
    s_add_u32 s40, s40, s41
    v_add_u32 v20, s40, v8
    s_mov_b32 s41, 2048
    v_mul_lo_u32 v9, v20, s41
    s_mul_i32 s40, s24, 128
    s_mul_i32 s41, s44, 128
    s_add_u32 s46, s40, s41
    v_and_b32 v3, 1, v5
    v_lshlrev_b32 v3, 5, v3
    v_lshrrev_b32 v4, 1, v5
    v_lshl_add_u32 v3, v4, 4, v3
    v_add3_u32 v9, v9, v3, s46
    s_mov_b32 s52, 0
    s_mov_b32 s53, 32768
    s_waitcnt lgkmcnt(0)
    s_add_u32 s4, s4, s97
    s_addc_u32 s5, s5, 0
    s_add_u32 s20, s4, 0x1900000
    s_addc_u32 s21, s5, 0
    s_cmp_eq_u32 s96, 1
    s_cselect_b32 s20, s20, s6
    s_cselect_b32 s21, s21, s7
    s_mov_b32 s22, 0x400000
    s_mov_b32 s23, 0x20000
    s_add_u32 s16, s4, 0x800000
    s_addc_u32 s17, s5, 0
    s_mov_b32 s18, 0x400000
    s_mov_b32 s19, 0x20000
    s_add_u32 s56, s4, 0xc00000
    s_addc_u32 s57, s5, 0
    s_mov_b32 s58, 0x480000
    s_mov_b32 s59, 0x20000
    s_add_u32 s60, s4, 0x200000
    s_addc_u32 s61, s5, 0
    s_mov_b32 s62, 0x40000
    s_mov_b32 s63, 0x20000
    s_mul_i32 s42, s44, 4
    s_mov_b32 s43, 0
    v_and_b32 v3, 1, v5
    v_lshlrev_b32 v3, 1, v3
    v_lshrrev_b32 v4, 1, v6
    v_or_b32 v3, v3, v4
    s_add_u32 s40, s42, 0
    v_xor_b32 v3, s40, v3
    v_lshlrev_b32 v3, 5, v3
    v_lshl_add_u32 v3, v7, 3, v3
    v_lshl_add_u32 v4, v5, 3, v6
    v_lshl_add_u32 v3, v4, 7, v3
    v_add_u32 v10, s43, v3
    v_and_b32 v3, 1, v5
    v_lshlrev_b32 v3, 1, v3
    v_lshrrev_b32 v4, 1, v6
    v_or_b32 v3, v3, v4
    s_add_u32 s40, s42, 1
    v_xor_b32 v3, s40, v3
    v_lshlrev_b32 v3, 5, v3
    v_lshl_add_u32 v3, v7, 3, v3
    v_lshl_add_u32 v4, v5, 3, v6
    v_lshl_add_u32 v3, v4, 7, v3
    v_add_u32 v11, s43, v3
    v_and_b32 v3, 1, v5
    v_lshlrev_b32 v3, 1, v3
    v_lshrrev_b32 v4, 1, v6
    v_or_b32 v3, v3, v4
    s_add_u32 s40, s42, 2
    v_xor_b32 v3, s40, v3
    v_lshlrev_b32 v3, 5, v3
    v_lshl_add_u32 v3, v7, 3, v3
    v_lshl_add_u32 v4, v5, 3, v6
    v_lshl_add_u32 v3, v4, 7, v3
    v_add_u32 v12, s43, v3
    v_and_b32 v3, 1, v5
    v_lshlrev_b32 v3, 1, v3
    v_lshrrev_b32 v4, 1, v6
    v_or_b32 v3, v3, v4
    s_add_u32 s40, s42, 3
    v_xor_b32 v3, s40, v3
    v_lshlrev_b32 v3, 5, v3
    v_lshl_add_u32 v3, v7, 3, v3
    v_lshl_add_u32 v4, v5, 3, v6
    v_lshl_add_u32 v3, v4, 7, v3
    v_add_u32 v13, s43, v3
    s_mul_i32 s42, s45, 32
    v_lshrrev_b32 v3, 1, v8
    v_xor_b32 v3, v3, v5
    v_lshlrev_b32 v3, 4, v3
    v_lshl_add_u32 v3, v8, 7, v3
    s_lshl_b32 s40, s42, 7
    s_add_u32 s40, s40, 8192
    v_add_u32 v14, s40, v3
    v_xor_b32 v15, 64, v14
    v_mov_b32 v84, 0
    v_mov_b32 v85, 0
    v_mov_b32 v86, 0
    v_mov_b32 v87, 0
    v_mov_b32 v88, 0
    v_mov_b32 v89, 0
    v_mov_b32 v90, 0
    v_mov_b32 v91, 0
    v_mov_b32 v92, 0
    v_mov_b32 v93, 0
    v_mov_b32 v94, 0
    v_mov_b32 v95, 0
    v_mov_b32 v96, 0
    v_mov_b32 v97, 0
    v_mov_b32 v98, 0
    v_mov_b32 v99, 0
    v_mov_b32 v100, 0
    v_mov_b32 v101, 0
    v_mov_b32 v102, 0
    v_mov_b32 v103, 0
    v_mov_b32 v104, 0
    v_mov_b32 v105, 0
    v_mov_b32 v106, 0
    v_mov_b32 v107, 0
    s_mov_b32 s48, 16
    s_mov_b32 s50, 0
    s_mov_b32 s51, 24576
    s_mov_b32 s29, 0xfffee000
    v_mov_b32 v28, 0
    v_mov_b32 v29, 0
    v_mov_b32 v30, 0
    v_mov_b32 v31, 0
    v_mov_b32 v32, 0
    v_mov_b32 v33, 0
    v_mov_b32 v34, 0
    v_mov_b32 v35, 0
    v_mov_b32 v36, 0
    v_mov_b32 v37, 0
    v_mov_b32 v38, 0
    v_mov_b32 v39, 0
    v_mov_b32 v40, 0
    v_mov_b32 v41, 0
    v_mov_b32 v42, 0
    v_mov_b32 v43, 0
    v_mov_b32 v44, 0
    v_mov_b32 v45, 0
    v_mov_b32 v46, 0
    v_mov_b32 v47, 0
    v_mov_b32 v48, 0
    v_mov_b32 v49, 0
    v_mov_b32 v50, 0
    v_mov_b32 v51, 0
    v_mov_b32 v52, 0
    v_mov_b32 v53, 0
    v_mov_b32 v54, 0
    v_mov_b32 v55, 0
    v_mov_b32 v56, 0
    v_mov_b32 v57, 0
    v_mov_b32 v58, 0
    v_mov_b32 v59, 0
    s_barrier
    buffer_load_dwordx4 v[124:127], v9, s[20:23], s52 offen offset:0 sc1
    buffer_load_dwordx4 v[128:131], v9, s[20:23], s52 offen offset:64 sc1
    buffer_load_dwordx4 v[132:135], v9, s[20:23], s53 offen offset:0 sc1
    buffer_load_dwordx4 v[136:139], v9, s[20:23], s53 offen offset:64 sc1
    s_branch g2_cloop2
g2_mid:
    s_waitcnt vmcnt(0)
    s_nop 7
    v_permlane16_swap_b32 v124, v126
    v_permlane16_swap_b32 v125, v127
    v_permlane16_swap_b32 v128, v130
    v_permlane16_swap_b32 v129, v131
    v_permlane16_swap_b32 v132, v134
    v_permlane16_swap_b32 v133, v135
    v_permlane16_swap_b32 v136, v138
    v_permlane16_swap_b32 v137, v139
    v_lshlrev_b32 v140, 16, v124
    v_and_b32 v141, 0xffff0000, v124
    v_lshlrev_b32 v142, 16, v125
    v_and_b32 v143, 0xffff0000, v125
    v_lshlrev_b32 v144, 16, v126
    v_and_b32 v145, 0xffff0000, v126
    v_lshlrev_b32 v146, 16, v127
    v_and_b32 v147, 0xffff0000, v127
    v_pk_add_f32 v[28:29], v[28:29], v[140:141]
    v_pk_add_f32 v[30:31], v[30:31], v[142:143]
    v_pk_add_f32 v[36:37], v[36:37], v[144:145]
    v_pk_add_f32 v[38:39], v[38:39], v[146:147]
    v_lshlrev_b32 v140, 16, v128
    v_and_b32 v141, 0xffff0000, v128
    v_lshlrev_b32 v142, 16, v129
    v_and_b32 v143, 0xffff0000, v129
    v_lshlrev_b32 v144, 16, v130
    v_and_b32 v145, 0xffff0000, v130
    v_lshlrev_b32 v146, 16, v131
    v_and_b32 v147, 0xffff0000, v131
    v_pk_add_f32 v[44:45], v[44:45], v[140:141]
    v_pk_add_f32 v[46:47], v[46:47], v[142:143]
    v_pk_add_f32 v[52:53], v[52:53], v[144:145]
    v_pk_add_f32 v[54:55], v[54:55], v[146:147]
    v_lshlrev_b32 v140, 16, v132
    v_and_b32 v141, 0xffff0000, v132
    v_lshlrev_b32 v142, 16, v133
    v_and_b32 v143, 0xffff0000, v133
    v_lshlrev_b32 v144, 16, v134
    v_and_b32 v145, 0xffff0000, v134
    v_lshlrev_b32 v146, 16, v135
    v_and_b32 v147, 0xffff0000, v135
    v_pk_add_f32 v[32:33], v[32:33], v[140:141]
    v_pk_add_f32 v[34:35], v[34:35], v[142:143]
    v_pk_add_f32 v[40:41], v[40:41], v[144:145]
    v_pk_add_f32 v[42:43], v[42:43], v[146:147]
    v_lshlrev_b32 v140, 16, v136
    v_and_b32 v141, 0xffff0000, v136
    v_lshlrev_b32 v142, 16, v137
    v_and_b32 v143, 0xffff0000, v137
    v_lshlrev_b32 v144, 16, v138
    v_and_b32 v145, 0xffff0000, v138
    v_lshlrev_b32 v146, 16, v139
    v_and_b32 v147, 0xffff0000, v139
    v_pk_add_f32 v[48:49], v[48:49], v[140:141]
    v_pk_add_f32 v[50:51], v[50:51], v[142:143]
    v_pk_add_f32 v[56:57], v[56:57], v[144:145]
    v_pk_add_f32 v[58:59], v[58:59], v[146:147]
    s_nop 1
    s_branch g2_cloop2
.p2align 3
g2_cloop:
    s_barrier
    s_cmp_eq_u32 s48, 8
    s_cbranch_scc1 g2_mid
g2_cloop2:
    v_mfma_f32_16x16x32_bf16 v[28:31], v[84:87], v[100:103], v[28:31]
    ds_read_b64_tr_b16 v[60:61], v10 offset:0
    ds_read_b64_tr_b16 v[62:63], v10 offset:512
    v_mfma_f32_16x16x32_bf16 v[32:35], v[84:87], v[104:107], v[32:35]
    ds_read_b128 v[76:79], v14 offset:0
    v_mfma_f32_16x16x32_bf16 v[40:43], v[88:91], v[104:107], v[40:43]
    ds_read_b128 v[80:83], v14 offset:2048
    v_mfma_f32_16x16x32_bf16 v[36:39], v[88:91], v[100:103], v[36:39]
    ds_read_b64_tr_b16 v[64:65], v11 offset:0
    ds_read_b64_tr_b16 v[66:67], v11 offset:512
    v_mfma_f32_16x16x32_bf16 v[44:47], v[92:95], v[100:103], v[44:47]
    ds_read_b64_tr_b16 v[68:69], v12 offset:0
    ds_read_b64_tr_b16 v[70:71], v12 offset:512
    v_mfma_f32_16x16x32_bf16 v[48:51], v[92:95], v[104:107], v[48:51]
    ds_read_b64_tr_b16 v[72:73], v13 offset:0
    ds_read_b64_tr_b16 v[74:75], v13 offset:512
    v_mfma_f32_16x16x32_bf16 v[56:59], v[96:99], v[104:107], v[56:59]
    v_mfma_f32_16x16x32_bf16 v[52:55], v[96:99], v[100:103], v[52:55]
    s_waitcnt lgkmcnt(0)
    v_mfma_f32_16x16x32_bf16 v[28:31], v[60:63], v[76:79], v[28:31]
    ds_read_b64_tr_b16 v[84:85], v10 offset:4096
    ds_read_b64_tr_b16 v[86:87], v10 offset:4608
    v_mfma_f32_16x16x32_bf16 v[32:35], v[60:63], v[80:83], v[32:35]
    ds_read_b128 v[100:103], v15 offset:0
    v_mfma_f32_16x16x32_bf16 v[40:43], v[64:67], v[80:83], v[40:43]
    ds_read_b128 v[104:107], v15 offset:2048
    v_mfma_f32_16x16x32_bf16 v[36:39], v[64:67], v[76:79], v[36:39]
    ds_read_b64_tr_b16 v[88:89], v11 offset:4096
    ds_read_b64_tr_b16 v[90:91], v11 offset:4608
    v_mfma_f32_16x16x32_bf16 v[44:47], v[68:71], v[76:79], v[44:47]
    ds_read_b64_tr_b16 v[92:93], v12 offset:4096
    ds_read_b64_tr_b16 v[94:95], v12 offset:4608
    v_mfma_f32_16x16x32_bf16 v[48:51], v[68:71], v[80:83], v[48:51]
    ds_read_b64_tr_b16 v[96:97], v13 offset:4096
    ds_read_b64_tr_b16 v[98:99], v13 offset:4608
    v_mfma_f32_16x16x32_bf16 v[56:59], v[72:75], v[80:83], v[56:59]
    s_add_u32 s50, s50, 1
    s_cmp_eq_u32 s50, 4
    v_mfma_f32_16x16x32_bf16 v[52:55], v[72:75], v[76:79], v[52:55]
    s_cselect_b32 s49, s29, s51
    s_cselect_b32 s50, 0, s50
    v_add_u32 v10, s49, v10
    v_add_u32 v11, s49, v11
    v_add_u32 v12, s49, v12
    v_add_u32 v13, s49, v13
    v_add_u32 v14, s49, v14
    v_add_u32 v15, s49, v15
    s_sub_u32 s48, s48, 1
    s_cmp_lg_u32 s48, 0
    s_waitcnt lgkmcnt(0)
    s_cbranch_scc1 g2_cloop
    v_mfma_f32_16x16x32_bf16 v[28:31], v[84:87], v[100:103], v[28:31]
    v_mfma_f32_16x16x32_bf16 v[32:35], v[84:87], v[104:107], v[32:35]
    v_mfma_f32_16x16x32_bf16 v[40:43], v[88:91], v[104:107], v[40:43]
    v_mfma_f32_16x16x32_bf16 v[36:39], v[88:91], v[100:103], v[36:39]
    v_mfma_f32_16x16x32_bf16 v[44:47], v[92:95], v[100:103], v[44:47]
    v_mfma_f32_16x16x32_bf16 v[48:51], v[92:95], v[104:107], v[48:51]
    v_mfma_f32_16x16x32_bf16 v[56:59], v[96:99], v[104:107], v[56:59]
    v_mfma_f32_16x16x32_bf16 v[52:55], v[96:99], v[100:103], v[52:55]
    s_nop 7
    v_pk_add_f32 v[76:77], v[28:29], v[30:31]
    v_pk_mul_f32 v[78:79], v[28:29], v[28:29]
    v_pk_fma_f32 v[78:79], v[30:31], v[30:31], v[78:79]
    v_pk_add_f32 v[76:77], v[76:77], v[36:37]
    v_pk_fma_f32 v[78:79], v[36:37], v[36:37], v[78:79]
    v_pk_add_f32 v[76:77], v[76:77], v[38:39]
    v_pk_fma_f32 v[78:79], v[38:39], v[38:39], v[78:79]
    v_pk_add_f32 v[76:77], v[76:77], v[44:45]
    v_pk_fma_f32 v[78:79], v[44:45], v[44:45], v[78:79]
    v_pk_add_f32 v[76:77], v[76:77], v[46:47]
    v_pk_fma_f32 v[78:79], v[46:47], v[46:47], v[78:79]
    v_pk_add_f32 v[76:77], v[76:77], v[52:53]
    v_pk_fma_f32 v[78:79], v[52:53], v[52:53], v[78:79]
    v_pk_add_f32 v[76:77], v[76:77], v[54:55]
    v_pk_fma_f32 v[78:79], v[54:55], v[54:55], v[78:79]
    v_pk_add_f32 v[80:81], v[32:33], v[34:35]
    v_pk_mul_f32 v[82:83], v[32:33], v[32:33]
    v_pk_fma_f32 v[82:83], v[34:35], v[34:35], v[82:83]
    v_pk_add_f32 v[80:81], v[80:81], v[40:41]
    v_pk_fma_f32 v[82:83], v[40:41], v[40:41], v[82:83]
    v_pk_add_f32 v[80:81], v[80:81], v[42:43]
    v_pk_fma_f32 v[82:83], v[42:43], v[42:43], v[82:83]
    v_pk_add_f32 v[80:81], v[80:81], v[48:49]
    v_pk_fma_f32 v[82:83], v[48:49], v[48:49], v[82:83]
    v_pk_add_f32 v[80:81], v[80:81], v[50:51]
    v_pk_fma_f32 v[82:83], v[50:51], v[50:51], v[82:83]
    v_pk_add_f32 v[80:81], v[80:81], v[56:57]
    v_pk_fma_f32 v[82:83], v[56:57], v[56:57], v[82:83]
    v_pk_add_f32 v[80:81], v[80:81], v[58:59]
    v_pk_fma_f32 v[82:83], v[58:59], v[58:59], v[82:83]
    v_add_f32 v76, v76, v77
    v_add_f32 v77, v78, v79
    v_add_f32 v80, v80, v81
    v_add_f32 v81, v82, v83
    s_nop 1
    v_permlane16_swap_b32 v76, v80
    v_permlane16_swap_b32 v77, v81
    v_pk_add_f32 v[76:77], v[76:77], v[80:81]
    v_mov_b32 v84, v76
    v_mov_b32 v85, v77
    v_and_b32 v3, 16, v2
    v_add_u32 v3, v3, v20
    v_permlane32_swap_b32 v76, v84
    v_permlane32_swap_b32 v77, v85
    v_pk_add_f32 v[76:77], v[76:77], v[84:85]
    v_lshlrev_b32 v3, 3, v3
    s_mul_i32 s40, s24, 1
    s_add_u32 s40, s40, s44
    s_lshl_b32 s40, s40, 14
    s_mov_b32 exec_hi, 0
    buffer_store_dwordx2 v[76:77], v3, s[60:63], s40 offen sc1
    s_mov_b32 exec_hi, -1
    v_lshrrev_b32 v4, 5, v2
    v_lshl_add_u32 v21, v4, 17, v3
    v_cvt_pk_bf16_f32 v60, v28, v29
    v_cvt_pk_bf16_f32 v61, v30, v31
    v_cvt_pk_bf16_f32 v62, v36, v37
    v_cvt_pk_bf16_f32 v63, v38, v39
    v_lshlrev_b32 v28, 16, v60
    v_and_b32 v29, 0xffff0000, v60
    v_lshlrev_b32 v30, 16, v61
    v_and_b32 v31, 0xffff0000, v61
    v_lshlrev_b32 v36, 16, v62
    v_and_b32 v37, 0xffff0000, v62
    v_lshlrev_b32 v38, 16, v63
    v_and_b32 v39, 0xffff0000, v63
    v_permlane16_swap_b32 v60, v62
    v_permlane16_swap_b32 v61, v63
    buffer_store_dwordx4 v[60:63], v9, s[16:19], s52 offen offset:0 sc1
    v_cvt_pk_bf16_f32 v64, v44, v45
    v_cvt_pk_bf16_f32 v65, v46, v47
    v_cvt_pk_bf16_f32 v66, v52, v53
    v_cvt_pk_bf16_f32 v67, v54, v55
    v_lshlrev_b32 v44, 16, v64
    v_and_b32 v45, 0xffff0000, v64
    v_lshlrev_b32 v46, 16, v65
    v_and_b32 v47, 0xffff0000, v65
    v_lshlrev_b32 v52, 16, v66
    v_and_b32 v53, 0xffff0000, v66
    v_lshlrev_b32 v54, 16, v67
    v_and_b32 v55, 0xffff0000, v67
    v_permlane16_swap_b32 v64, v66
    v_permlane16_swap_b32 v65, v67
    buffer_store_dwordx4 v[64:67], v9, s[16:19], s52 offen offset:64 sc1
    v_cvt_pk_bf16_f32 v68, v32, v33
    v_cvt_pk_bf16_f32 v69, v34, v35
    v_cvt_pk_bf16_f32 v70, v40, v41
    v_cvt_pk_bf16_f32 v71, v42, v43
    v_lshlrev_b32 v32, 16, v68
    v_and_b32 v33, 0xffff0000, v68
    v_lshlrev_b32 v34, 16, v69
    v_and_b32 v35, 0xffff0000, v69
    v_lshlrev_b32 v40, 16, v70
    v_and_b32 v41, 0xffff0000, v70
    v_lshlrev_b32 v42, 16, v71
    v_and_b32 v43, 0xffff0000, v71
    v_permlane16_swap_b32 v68, v70
    v_permlane16_swap_b32 v69, v71
    buffer_store_dwordx4 v[68:71], v9, s[16:19], s53 offen offset:0 sc1
    v_cvt_pk_bf16_f32 v72, v48, v49
    v_cvt_pk_bf16_f32 v73, v50, v51
    v_cvt_pk_bf16_f32 v74, v56, v57
    v_cvt_pk_bf16_f32 v75, v58, v59
    v_lshlrev_b32 v48, 16, v72
    v_and_b32 v49, 0xffff0000, v72
    v_lshlrev_b32 v50, 16, v73
    v_and_b32 v51, 0xffff0000, v73
    v_lshlrev_b32 v56, 16, v74
    v_and_b32 v57, 0xffff0000, v74
    v_lshlrev_b32 v58, 16, v75
    v_and_b32 v59, 0xffff0000, v75
    v_permlane16_swap_b32 v72, v74
    v_permlane16_swap_b32 v73, v75
    buffer_store_dwordx4 v[72:75], v9, s[16:19], s53 offen offset:64 sc1
    s_mov_b32 s48, 0x2000
    v_mul_u32_u24 v19, 256, v20
    v_add_u32 v19, v19, v9
    s_mov_b32 s54, 0
    s_mov_b32 s55, 36864
    s_mov_b32 s40, 0
    buffer_load_dwordx2 v[108:109], v21, s[60:63], s40 offen sc1
    s_mov_b32 s41, 16384
    buffer_load_dwordx2 v[110:111], v21, s[60:63], s41 offen sc1
    s_mov_b32 s40, 32768
    buffer_load_dwordx2 v[112:113], v21, s[60:63], s40 offen sc1
    s_mov_b32 s41, 49152
    buffer_load_dwordx2 v[114:115], v21, s[60:63], s41 offen sc1
    s_mov_b32 s40, 65536
    buffer_load_dwordx2 v[116:117], v21, s[60:63], s40 offen sc1
    s_mov_b32 s41, 81920
    buffer_load_dwordx2 v[118:119], v21, s[60:63], s41 offen sc1
    s_mov_b32 s40, 98304
    buffer_load_dwordx2 v[120:121], v21, s[60:63], s40 offen sc1
    s_mov_b32 s41, 114688
    buffer_load_dwordx2 v[122:123], v21, s[60:63], s41 offen sc1
    s_waitcnt vmcnt(0)
g2_ex:
    v_max3_u32 v4, v108, v109, v110
    v_max3_u32 v4, v4, v111, v112
    v_max3_u32 v4, v4, v113, v114
    v_max3_u32 v4, v4, v115, v116
    v_max3_u32 v4, v4, v117, v118
    v_max3_u32 v4, v4, v119, v120
    v_max3_u32 v4, v4, v121, v122
    v_max_u32 v4, v4, v123
    v_cmp_eq_u32 vcc, -1, v4
    s_sub_u32 s48, s48, 1
    s_cmp_eq_u32 s48, 0
    s_cbranch_scc1 g2_exd
    s_cbranch_vccz g2_exd
    s_sleep 2
    s_mov_b32 s40, 0
    buffer_load_dwordx2 v[108:109], v21, s[60:63], s40 offen sc1
    s_mov_b32 s41, 16384
    buffer_load_dwordx2 v[110:111], v21, s[60:63], s41 offen sc1
    s_mov_b32 s40, 32768
    buffer_load_dwordx2 v[112:113], v21, s[60:63], s40 offen sc1
    s_mov_b32 s41, 49152
    buffer_load_dwordx2 v[114:115], v21, s[60:63], s41 offen sc1
    s_mov_b32 s40, 65536
    buffer_load_dwordx2 v[116:117], v21, s[60:63], s40 offen sc1
    s_mov_b32 s41, 81920
    buffer_load_dwordx2 v[118:119], v21, s[60:63], s41 offen sc1
    s_mov_b32 s40, 98304
    buffer_load_dwordx2 v[120:121], v21, s[60:63], s40 offen sc1
    s_mov_b32 s41, 114688
    buffer_load_dwordx2 v[122:123], v21, s[60:63], s41 offen sc1
    s_waitcnt vmcnt(0)
    s_branch g2_ex
g2_exd:
    v_pk_add_f32 v[108:109], v[108:109], v[116:117]
    v_pk_add_f32 v[110:111], v[110:111], v[118:119]
    v_pk_add_f32 v[112:113], v[112:113], v[120:121]
    v_pk_add_f32 v[114:115], v[114:115], v[122:123]
    v_pk_add_f32 v[108:109], v[108:109], v[112:113]
    v_pk_add_f32 v[110:111], v[110:111], v[114:115]
    v_pk_add_f32 v[108:109], v[108:109], v[110:111]
    v_mov_b32 v110, v108
    v_mov_b32 v111, v109
    s_nop 1
    v_permlane32_swap_b32 v108, v110
    v_permlane32_swap_b32 v109, v111
    v_pk_add_f32 v[108:109], v[108:109], v[110:111]
    v_mul_f32 v108, 0x3a800000, v108
    v_mul_f32 v109, 0x3a800000, v109
    v_fma_f32 v109, -v108, v108, v109
    v_max_f32 v109, 0, v109
    v_mov_b32 v110, v108
    v_mov_b32 v111, v109
    v_cvt_pk_bf16_f32 v110, v110, v110
    v_lshlrev_b32 v110, 16, v110
    v_cvt_pk_bf16_f32 v111, v111, v111
    v_lshlrev_b32 v111, 16, v111
    v_add_f32 v111, 0x3727c5ac, v111
    v_cvt_pk_bf16_f32 v111, v111, v111
    v_lshlrev_b32 v111, 16, v111
    v_sqrt_f32 v111, v111
    s_nop 0
    v_cvt_pk_bf16_f32 v111, v111, v111
    v_lshlrev_b32 v111, 16, v111
    v_rcp_f32 v111, v111
    v_sub_f32 v112, v108, v110
    v_mul_f32 v113, v109, v111
    v_mul_f32 v112, v112, v111
    v_mul_f32 v113, v113, v111
    v_cvt_pk_bf16_f32 v112, v112, v112
    v_lshlrev_b32 v112, 16, v112
    v_cvt_pk_bf16_f32 v113, v113, v113
    v_lshlrev_b32 v113, 16, v113
    v_add_f32 v113, 0x3727c5ac, v113
    v_cvt_pk_bf16_f32 v113, v113, v113
    v_lshlrev_b32 v113, 16, v113
    v_sqrt_f32 v113, v113
    s_nop 0
    v_cvt_pk_bf16_f32 v113, v113, v113
    v_lshlrev_b32 v113, 16, v113
    v_rcp_f32 v113, v113
    v_fma_f32 v112, v110, v111, v112
    v_mul_f32 v114, v111, v113
    v_mul_f32 v115, -v112, v113
    v_mov_b32 v116, v114
    v_mov_b32 v117, v115
    s_nop 1
    v_permlane16_swap_b32 v114, v116
    v_permlane16_swap_b32 v115, v117
    v_pk_fma_f32 v[28:29], v[28:29], v[114:115], v[114:115] op_sel:[0,0,1] op_sel_hi:[1,0,1]
    v_pk_fma_f32 v[30:31], v[30:31], v[114:115], v[114:115] op_sel:[0,0,1] op_sel_hi:[1,0,1]
    v_pk_fma_f32 v[36:37], v[36:37], v[114:115], v[114:115] op_sel:[0,0,1] op_sel_hi:[1,0,1]
    v_pk_fma_f32 v[38:39], v[38:39], v[114:115], v[114:115] op_sel:[0,0,1] op_sel_hi:[1,0,1]
    v_cvt_pk_bf16_f32 v124, v28, v29
    v_cvt_pk_bf16_f32 v125, v30, v31
    v_cvt_pk_bf16_f32 v126, v36, v37
    v_cvt_pk_bf16_f32 v127, v38, v39
    s_nop 1
    v_permlane16_swap_b32 v124, v126
    v_permlane16_swap_b32 v125, v127
    buffer_store_dwordx4 v[124:127], v19, s[56:59], s54 offen offset:0 sc1
    v_pk_fma_f32 v[44:45], v[44:45], v[114:115], v[114:115] op_sel:[0,0,1] op_sel_hi:[1,0,1]
    v_pk_fma_f32 v[46:47], v[46:47], v[114:115], v[114:115] op_sel:[0,0,1] op_sel_hi:[1,0,1]
    v_pk_fma_f32 v[52:53], v[52:53], v[114:115], v[114:115] op_sel:[0,0,1] op_sel_hi:[1,0,1]
    v_pk_fma_f32 v[54:55], v[54:55], v[114:115], v[114:115] op_sel:[0,0,1] op_sel_hi:[1,0,1]
    v_cvt_pk_bf16_f32 v128, v44, v45
    v_cvt_pk_bf16_f32 v129, v46, v47
    v_cvt_pk_bf16_f32 v130, v52, v53
    v_cvt_pk_bf16_f32 v131, v54, v55
    s_nop 1
    v_permlane16_swap_b32 v128, v130
    v_permlane16_swap_b32 v129, v131
    buffer_store_dwordx4 v[128:131], v19, s[56:59], s54 offen offset:64 sc1
    v_pk_fma_f32 v[32:33], v[32:33], v[116:117], v[116:117] op_sel:[0,0,1] op_sel_hi:[1,0,1]
    v_pk_fma_f32 v[34:35], v[34:35], v[116:117], v[116:117] op_sel:[0,0,1] op_sel_hi:[1,0,1]
    v_pk_fma_f32 v[40:41], v[40:41], v[116:117], v[116:117] op_sel:[0,0,1] op_sel_hi:[1,0,1]
    v_pk_fma_f32 v[42:43], v[42:43], v[116:117], v[116:117] op_sel:[0,0,1] op_sel_hi:[1,0,1]
    v_cvt_pk_bf16_f32 v132, v32, v33
    v_cvt_pk_bf16_f32 v133, v34, v35
    v_cvt_pk_bf16_f32 v134, v40, v41
    v_cvt_pk_bf16_f32 v135, v42, v43
    s_nop 1
    v_permlane16_swap_b32 v132, v134
    v_permlane16_swap_b32 v133, v135
    buffer_store_dwordx4 v[132:135], v19, s[56:59], s55 offen offset:0 sc1
    v_pk_fma_f32 v[48:49], v[48:49], v[116:117], v[116:117] op_sel:[0,0,1] op_sel_hi:[1,0,1]
    v_pk_fma_f32 v[50:51], v[50:51], v[116:117], v[116:117] op_sel:[0,0,1] op_sel_hi:[1,0,1]
    v_pk_fma_f32 v[56:57], v[56:57], v[116:117], v[116:117] op_sel:[0,0,1] op_sel_hi:[1,0,1]
    v_pk_fma_f32 v[58:59], v[58:59], v[116:117], v[116:117] op_sel:[0,0,1] op_sel_hi:[1,0,1]
    v_cvt_pk_bf16_f32 v136, v48, v49
    v_cvt_pk_bf16_f32 v137, v50, v51
    v_cvt_pk_bf16_f32 v138, v56, v57
    v_cvt_pk_bf16_f32 v139, v58, v59
    s_nop 1
    v_permlane16_swap_b32 v136, v138
    v_permlane16_swap_b32 v137, v139
    buffer_store_dwordx4 v[136:139], v19, s[56:59], s55 offen offset:64 sc1
    s_lshr_b32 s40, s24, 1
    s_add_u32 s40, s40, 16
    s_lshl_b32 s40, s40, 8
    s_mov_b32 s42, s40
    s_add_u32 s84, s4, 0x300000
    s_addc_u32 s85, s5, 0
    s_mov_b32 s86, 0x4000
    s_mov_b32 s87, 0x20000
    v_mov_b32 v3, s40
    v_mov_b32 v4, 1
    s_waitcnt vmcnt(0)
    s_barrier
    s_cmp_lg_u32 s28, 0
    s_cbranch_scc1 g2_cin
    s_mov_b64 exec, 1
    buffer_atomic_add v4, v3, s[84:87], 0 offen sc1
    s_mov_b64 exec, -1
g2_cin:
    s_branch g3_in
.p2align 6
g3_in:
    s_cmp_ge_u32 s2, 224
    s_cbranch_scc1 g3_spare
    s_load_dwordx2 s[4:5], s[0:1], 80
    s_load_dwordx2 s[30:31], s[0:1], 32
    s_load_dwordx2 s[6:7], s[0:1], 40
    v_lshrrev_b32 v1, 6, v0
    v_and_b32 v2, 63, v0
    s_and_b32 s40, s2, 1
    s_lshl_b32 s40, s40, 2
    s_bfe_u32 s41, s2, 0x20003
    s_add_u32 s25, s40, s41
    s_bfe_u32 s40, s2, 0x20001
    s_mul_i32 s40, s40, 7
    s_lshr_b32 s42, s2, 5
    s_add_u32 s24, s40, s42
    s_add_u32 s27, s41, s42
    s_mov_b32 s26, 0
    s_cmp_eq_u32 s96, 0
    s_cselect_b32 s95, 3, 1
    v_readfirstlane_b32 s28, v1
    s_nop 0
    s_cmp_lt_u32 s28, 4
    s_cbranch_scc1 g3_compute
    s_sub_u32 s28, s28, 4
    s_mov_b32 s40, 7168
    v_lshrrev_b32 v4, 4, v2
    v_mul_lo_u32 v3, v4, s40
    v_lshlrev_b32 v4, 1, v4
    v_xor_b32 v4, v4, v2
    v_and_b32 v4, 15, v4
    v_lshl_add_u32 v3, v4, 4, v3
    s_mul_i32 s41, s24, 256
    s_mul_i32 s42, s28, 114688
    s_add_u32 s41, s41, s42
    v_xor_b32 v4, 128, v3
    s_add_u32 s42, s41, 0
    v_add_u32 v10, s42, v3
    s_add_u32 s42, s41, 28672
    v_add_u32 v11, s42, v3
    s_add_u32 s42, s41, 57344
    v_add_u32 v12, s42, v4
    s_add_u32 s42, s41, 86016
    v_add_u32 v13, s42, v4
    s_mov_b32 s40, 2304
    v_lshrrev_b32 v4, 4, v2
    v_mul_lo_u32 v3, v4, s40
    v_lshlrev_b32 v4, 1, v4
    v_xor_b32 v4, v4, v2
    v_and_b32 v4, 15, v4
    v_lshl_add_u32 v3, v4, 4, v3
    s_mul_i32 s41, s25, 256
    s_mul_i32 s42, s28, 36864
    s_add_u32 s41, s41, s42
    v_xor_b32 v4, 128, v3
    s_add_u32 s42, s41, 0
    v_add_u32 v14, s42, v3
    s_add_u32 s42, s41, 9216
    v_add_u32 v15, s42, v3
    s_add_u32 s42, s41, 18432
    v_add_u32 v16, s42, v4
    s_add_u32 s42, s41, 27648
    v_add_u32 v17, s42, v4
    s_mul_i32 s36, s28, 4096
    s_mul_i32 s37, s28, 4096
    s_add_u32 s37, s37, 16384
    s_waitcnt lgkmcnt(0)
    s_add_u32 s4, s4, s97
    s_addc_u32 s5, s5, 0
    s_mov_b32 s8, s30
    s_mov_b32 s9, s31
    s_mov_b32 s10, 0xe00000
    s_mov_b32 s11, 0x20000
    s_add_u32 s12, s4, 0xc00000
    s_addc_u32 s13, s5, 0
    s_mov_b32 s14, 0x480000
    s_mov_b32 s15, 0x20000
    s_mov_b32 s32, 0
    s_mov_b32 s33, 0
g3_ld_pW:
    s_add_u32 s40, s32, s27
    s_and_b32 s40, s40, s95
    s_andn2_b32 s41, s32, s95
    s_or_b32 s40, s40, s41
    s_add_u32 s40, s40, s26
    s_mul_i32 s34, s40, 458752
    s_mul_i32 s35, s40, 147456
    s_add_u32 s38, s33, s36
    s_add_u32 s39, s33, s37
    s_add_u32 m0, s38, 0
    s_nop 0
    buffer_load_dwordx4 v10, s[8:11], s34 offen lds
    s_add_u32 m0, s38, 1024
    s_nop 0
    buffer_load_dwordx4 v11, s[8:11], s34 offen lds
    s_add_u32 m0, s38, 2048
    s_nop 0
    buffer_load_dwordx4 v12, s[8:11], s34 offen lds
    s_add_u32 m0, s38, 3072
    s_nop 0
    buffer_load_dwordx4 v13, s[8:11], s34 offen lds
    s_add_u32 s33, s33, 32768
    s_add_u32 s32, s32, 1
    s_cmp_lt_u32 s32, 3
    s_cbranch_scc1 g3_ld_pW
    s_lshr_b32 s40, s25, 0
    s_add_u32 s40, s40, 16
    s_lshl_b32 s40, s40, 8
    s_mov_b32 s42, s40
    s_lshl_b32 s43, s96, 2
    s_add_u32 s43, s43, 3
    s_mov_b32 s41, 0x80000
    v_mov_b32 v24, 131072
    s_cmp_lg_u32 s28, 0
    s_cbranch_scc1 g3_dep_lds
    s_mov_b32 s41, 0x8000
    s_add_u32 s84, s4, 0x300000
    s_addc_u32 s85, s5, 0
    s_mov_b32 s86, 0x4000
    s_mov_b32 s87, 0x20000
    v_cmp_eq_u32 vcc, 1, v2
    v_mov_b32 v21, s40
    v_mov_b32 v23, s42
    v_cndmask_b32 v21, v21, v23, vcc
    v_mov_b32 v22, 32
    v_mov_b32 v23, 32
    v_cndmask_b32 v22, v22, v23, vcc
g3_dep:
    buffer_load_dword v23, v21, s[84:87], 0 offen sc1
    s_sub_u32 s41, s41, 1
    s_waitcnt vmcnt(0)
    v_cmp_lt_u32 vcc, v23, v22
    s_cmp_eq_u32 s41, 0
    s_cbranch_scc1 g3_dep_seen
    s_cbranch_vccz g3_dep_seen
    s_sleep 2
    s_branch g3_dep
g3_dep_seen:
    v_mov_b32 v23, s43
    ds_write_b32 v24, v23
    s_branch g3_dep_ok
g3_dep_lds:
    ds_read_b32 v23, v24
    s_sub_u32 s41, s41, 1
    s_waitcnt lgkmcnt(0)
    v_readfirstlane_b32 s40, v23
    s_cmp_eq_u32 s41, 0
    s_cbranch_scc1 g3_dep_ok
    s_cmp_eq_u32 s40, s43
    s_cbranch_scc1 g3_dep_ok
    s_sleep 1
    s_branch g3_dep_lds
g3_dep_ok:
    s_mov_b32 s32, 0
    s_mov_b32 s33, 0
g3_ld_pA:
    s_add_u32 s40, s32, s27
    s_and_b32 s40, s40, s95
    s_andn2_b32 s41, s32, s95
    s_or_b32 s40, s40, s41
    s_add_u32 s40, s40, s26
    s_mul_i32 s34, s40, 458752
    s_mul_i32 s35, s40, 147456
    s_add_u32 s38, s33, s36
    s_add_u32 s39, s33, s37
    s_add_u32 m0, s39, 0
    s_nop 0
    buffer_load_dwordx4 v14, s[12:15], s35 offen sc1 lds
    s_add_u32 m0, s39, 1024
    s_nop 0
    buffer_load_dwordx4 v15, s[12:15], s35 offen sc1 lds
    s_add_u32 m0, s39, 2048
    s_nop 0
    buffer_load_dwordx4 v16, s[12:15], s35 offen sc1 lds
    s_add_u32 m0, s39, 3072
    s_nop 0
    buffer_load_dwordx4 v17, s[12:15], s35 offen sc1 lds
    s_add_u32 s33, s33, 32768
    s_add_u32 s32, s32, 1
    s_cmp_lt_u32 s32, 3
    s_cbranch_scc1 g3_ld_pA
    s_waitcnt vmcnt(8)
    s_branch g3_ld_bar
g3_ld_loop:
    s_cmp_eq_u32 s32, 4
    s_cbranch_scc1 g3_ld_s4
    s_waitcnt vmcnt(16)
g3_ld_bar:
    s_barrier
    s_add_u32 s40, s32, s27
    s_and_b32 s40, s40, s95
    s_andn2_b32 s41, s32, s95
    s_or_b32 s40, s40, s41
    s_add_u32 s40, s40, s26
    s_mul_i32 s34, s40, 458752
    s_mul_i32 s35, s40, 147456
    s_add_u32 s38, s33, s36
    s_add_u32 s39, s33, s37
    s_add_u32 m0, s38, 0
    s_nop 0
    buffer_load_dwordx4 v10, s[8:11], s34 offen lds
    s_add_u32 m0, s38, 1024
    s_nop 0
    buffer_load_dwordx4 v11, s[8:11], s34 offen lds
    s_add_u32 m0, s38, 2048
    s_nop 0
    buffer_load_dwordx4 v12, s[8:11], s34 offen lds
    s_add_u32 m0, s38, 3072
    s_nop 0
    buffer_load_dwordx4 v13, s[8:11], s34 offen lds
    s_add_u32 m0, s39, 0
    s_nop 0
    buffer_load_dwordx4 v14, s[12:15], s35 offen sc1 lds
    s_add_u32 m0, s39, 1024
    s_nop 0
    buffer_load_dwordx4 v15, s[12:15], s35 offen sc1 lds
    s_add_u32 m0, s39, 2048
    s_nop 0
    buffer_load_dwordx4 v16, s[12:15], s35 offen sc1 lds
    s_add_u32 m0, s39, 3072
    s_nop 0
    buffer_load_dwordx4 v17, s[12:15], s35 offen sc1 lds
    s_add_u32 s33, s33, 32768
    s_add_u32 s32, s32, 1
    s_cmp_eq_u32 s33, 131072
    s_cselect_b32 s33, 0, s33
    s_cmp_lt_u32 s32, 32
    s_cbranch_scc1 g3_ld_loop
    s_waitcnt vmcnt(16)
    s_barrier
    s_waitcnt vmcnt(8)
    s_barrier
    s_waitcnt vmcnt(0)
    s_barrier
    s_branch g3_ld_end
g3_ld_s4:
    s_waitcnt vmcnt(12)
    s_branch g3_ld_bar
g3_ld_end:
    s_barrier
    s_branch g4_in
g3_done:
    s_endpgm
g3_compute:
    v_lshrrev_b32 v5, 4, v2
    v_bfe_u32 v6, v2, 2, 2
    v_and_b32 v7, 3, v2
    v_and_b32 v8, 15, v2
    s_and_b32 s44, s28, 1
    s_lshr_b32 s45, s28, 1
    s_mul_i32 s40, s25, 128
    s_mul_i32 s41, s45, 64
    s_add_u32 s40, s40, s41
    v_add_u32 v20, s40, v8
    s_mov_b32 s41, 8192
    v_mul_lo_u32 v9, v20, s41
    s_mul_i32 s40, s24, 256
    s_mul_i32 s41, s44, 128
    s_add_u32 s46, s40, s41
    v_and_b32 v3, 1, v5
    v_lshlrev_b32 v3, 5, v3
    v_lshrrev_b32 v4, 1, v5
    v_lshl_add_u32 v3, v4, 4, v3
    v_add3_u32 v9, v9, v3, s46
    s_mov_b32 s52, 0
    s_mov_b32 s53, 131072
    s_mov_b32 s54, 262144
    s_mov_b32 s55, 393216
    s_waitcnt lgkmcnt(0)
    s_add_u32 s4, s4, s97
    s_addc_u32 s5, s5, 0
    s_mov_b32 s20, s6
    s_mov_b32 s21, s7
    s_mov_b32 s22, 0x1c00
    s_mov_b32 s23, 0x20000
    s_add_u32 s16, s4, 0x1100000
    s_addc_u32 s17, s5, 0
    s_mov_b32 s18, 0x800000
    s_mov_b32 s19, 0x20000
    v_lshl_add_u32 v3, v5, 3, s46
    buffer_load_dwordx2 v[92:93], v3, s[20:23], 0 offen offset:0
    buffer_load_dwordx2 v[94:95], v3, s[20:23], 0 offen offset:32
    buffer_load_dwordx2 v[96:97], v3, s[20:23], 0 offen offset:64
    buffer_load_dwordx2 v[98:99], v3, s[20:23], 0 offen offset:96
    s_mul_i32 s42, s44, 4
    s_mov_b32 s43, 0
    v_and_b32 v3, 1, v5
    v_lshl_or_b32 v3, v3, 2, v6
    s_add_u32 s40, s42, 0
    v_xor_b32 v3, s40, v3
    v_lshlrev_b32 v3, 5, v3
    v_lshl_add_u32 v3, v7, 3, v3
    v_lshl_add_u32 v4, v5, 3, v6
    v_lshl_add_u32 v3, v4, 8, v3
    v_add_u32 v10, s43, v3
    v_and_b32 v3, 1, v5
    v_lshl_or_b32 v3, v3, 2, v6
    s_add_u32 s40, s42, 1
    v_xor_b32 v3, s40, v3
    v_lshlrev_b32 v3, 5, v3
    v_lshl_add_u32 v3, v7, 3, v3
    v_lshl_add_u32 v4, v5, 3, v6
    v_lshl_add_u32 v3, v4, 8, v3
    v_add_u32 v11, s43, v3
    v_and_b32 v3, 1, v5
    v_lshl_or_b32 v3, v3, 2, v6
    s_add_u32 s40, s42, 2
    v_xor_b32 v3, s40, v3
    v_lshlrev_b32 v3, 5, v3
    v_lshl_add_u32 v3, v7, 3, v3
    v_lshl_add_u32 v4, v5, 3, v6
    v_lshl_add_u32 v3, v4, 8, v3
    v_add_u32 v12, s43, v3
    v_and_b32 v3, 1, v5
    v_lshl_or_b32 v3, v3, 2, v6
    s_add_u32 s40, s42, 3
    v_xor_b32 v3, s40, v3
    v_lshlrev_b32 v3, 5, v3
    v_lshl_add_u32 v3, v7, 3, v3
    v_lshl_add_u32 v4, v5, 3, v6
    v_lshl_add_u32 v3, v4, 8, v3
    v_add_u32 v13, s43, v3
    s_mul_i32 s42, s45, 4
    s_mov_b32 s43, 16384
    v_and_b32 v3, 1, v5
    v_lshl_or_b32 v3, v3, 2, v6
    s_add_u32 s40, s42, 0
    v_xor_b32 v3, s40, v3
    v_lshlrev_b32 v3, 5, v3
    v_lshl_add_u32 v3, v7, 3, v3
    v_lshl_add_u32 v4, v5, 3, v6
    v_lshl_add_u32 v3, v4, 8, v3
    v_add_u32 v14, s43, v3
    v_and_b32 v3, 1, v5
    v_lshl_or_b32 v3, v3, 2, v6
    s_add_u32 s40, s42, 1
    v_xor_b32 v3, s40, v3
    v_lshlrev_b32 v3, 5, v3
    v_lshl_add_u32 v3, v7, 3, v3
    v_lshl_add_u32 v4, v5, 3, v6
    v_lshl_add_u32 v3, v4, 8, v3
    v_add_u32 v15, s43, v3
    v_and_b32 v3, 1, v5
    v_lshl_or_b32 v3, v3, 2, v6
    s_add_u32 s40, s42, 2
    v_xor_b32 v3, s40, v3
    v_lshlrev_b32 v3, 5, v3
    v_lshl_add_u32 v3, v7, 3, v3
    v_lshl_add_u32 v4, v5, 3, v6
    v_lshl_add_u32 v3, v4, 8, v3
    v_add_u32 v16, s43, v3
    v_and_b32 v3, 1, v5
    v_lshl_or_b32 v3, v3, 2, v6
    s_add_u32 s40, s42, 3
    v_xor_b32 v3, s40, v3
    v_lshlrev_b32 v3, 5, v3
    v_lshl_add_u32 v3, v7, 3, v3
    v_lshl_add_u32 v4, v5, 3, v6
    v_lshl_add_u32 v3, v4, 8, v3
    v_add_u32 v17, s43, v3
    v_mov_b32 v124, 0
    v_mov_b32 v125, 0
    v_mov_b32 v126, 0
    v_mov_b32 v127, 0
    v_mov_b32 v128, 0
    v_mov_b32 v129, 0
    v_mov_b32 v130, 0
    v_mov_b32 v131, 0
    v_mov_b32 v132, 0
    v_mov_b32 v133, 0
    v_mov_b32 v134, 0
    v_mov_b32 v135, 0
    v_mov_b32 v136, 0
    v_mov_b32 v137, 0
    v_mov_b32 v138, 0
    v_mov_b32 v139, 0
    v_mov_b32 v140, 0
    v_mov_b32 v141, 0
    v_mov_b32 v142, 0
    v_mov_b32 v143, 0
    v_mov_b32 v144, 0
    v_mov_b32 v145, 0
    v_mov_b32 v146, 0
    v_mov_b32 v147, 0
    v_mov_b32 v148, 0
    v_mov_b32 v149, 0
    v_mov_b32 v150, 0
    v_mov_b32 v151, 0
    v_mov_b32 v152, 0
    v_mov_b32 v153, 0
    v_mov_b32 v154, 0
    v_mov_b32 v155, 0
    s_mov_b32 s48, 32
    s_mov_b32 s50, 0
    s_mov_b32 s51, 32768
    s_mov_b32 s29, 0xfffe8000
    s_waitcnt vmcnt(0)
    v_lshlrev_b32 v28, 16, v92
    v_and_b32 v29, 0xffff0000, v92
    v_lshlrev_b32 v30, 16, v93
    v_and_b32 v31, 0xffff0000, v93
    v_lshlrev_b32 v32, 16, v92
    v_and_b32 v33, 0xffff0000, v92
    v_lshlrev_b32 v34, 16, v93
    v_and_b32 v35, 0xffff0000, v93
    v_lshlrev_b32 v36, 16, v92
    v_and_b32 v37, 0xffff0000, v92
    v_lshlrev_b32 v38, 16, v93
    v_and_b32 v39, 0xffff0000, v93
    v_lshlrev_b32 v40, 16, v92
    v_and_b32 v41, 0xffff0000, v92
    v_lshlrev_b32 v42, 16, v93
    v_and_b32 v43, 0xffff0000, v93
    v_lshlrev_b32 v44, 16, v94
    v_and_b32 v45, 0xffff0000, v94
    v_lshlrev_b32 v46, 16, v95
    v_and_b32 v47, 0xffff0000, v95
    v_lshlrev_b32 v48, 16, v94
    v_and_b32 v49, 0xffff0000, v94
    v_lshlrev_b32 v50, 16, v95
    v_and_b32 v51, 0xffff0000, v95
    v_lshlrev_b32 v52, 16, v94
    v_and_b32 v53, 0xffff0000, v94
    v_lshlrev_b32 v54, 16, v95
    v_and_b32 v55, 0xffff0000, v95
    v_lshlrev_b32 v56, 16, v94
    v_and_b32 v57, 0xffff0000, v94
    v_lshlrev_b32 v58, 16, v95
    v_and_b32 v59, 0xffff0000, v95
    v_lshlrev_b32 v60, 16, v96
    v_and_b32 v61, 0xffff0000, v96
    v_lshlrev_b32 v62, 16, v97
    v_and_b32 v63, 0xffff0000, v97
    v_lshlrev_b32 v64, 16, v96
    v_and_b32 v65, 0xffff0000, v96
    v_lshlrev_b32 v66, 16, v97
    v_and_b32 v67, 0xffff0000, v97
    v_lshlrev_b32 v68, 16, v96
    v_and_b32 v69, 0xffff0000, v96
    v_lshlrev_b32 v70, 16, v97
    v_and_b32 v71, 0xffff0000, v97
    v_lshlrev_b32 v72, 16, v96
    v_and_b32 v73, 0xffff0000, v96
    v_lshlrev_b32 v74, 16, v97
    v_and_b32 v75, 0xffff0000, v97
    v_lshlrev_b32 v76, 16, v98
    v_and_b32 v77, 0xffff0000, v98
    v_lshlrev_b32 v78, 16, v99
    v_and_b32 v79, 0xffff0000, v99
    v_lshlrev_b32 v80, 16, v98
    v_and_b32 v81, 0xffff0000, v98
    v_lshlrev_b32 v82, 16, v99
    v_and_b32 v83, 0xffff0000, v99
    v_lshlrev_b32 v84, 16, v98
    v_and_b32 v85, 0xffff0000, v98
    v_lshlrev_b32 v86, 16, v99
    v_and_b32 v87, 0xffff0000, v99
    v_lshlrev_b32 v88, 16, v98
    v_and_b32 v89, 0xffff0000, v98
    v_lshlrev_b32 v90, 16, v99
    v_and_b32 v91, 0xffff0000, v99
    v_mov_b32 v156, 0xbdd2d3e8
    v_mov_b32 v157, 0xbdd2d3e8
    v_mov_b32 v158, 0xc0135761
    v_mov_b32 v159, 0xc0135761
    v_mov_b32 v160, 0x3f800000
    v_mov_b32 v161, 0x3f800000
.p2align 3
g3_cloop:
    s_barrier
g3_cloop2:
    v_mfma_f32_16x16x32_bf16 v[28:31], v[124:127], v[140:143], v[28:31]
    ds_read_b64_tr_b16 v[92:93], v10 offset:0
    ds_read_b64_tr_b16 v[94:95], v10 offset:1024
    v_mfma_f32_16x16x32_bf16 v[32:35], v[124:127], v[144:147], v[32:35]
    ds_read_b64_tr_b16 v[108:109], v14 offset:0
    ds_read_b64_tr_b16 v[110:111], v14 offset:1024
    v_mfma_f32_16x16x32_bf16 v[36:39], v[124:127], v[148:151], v[36:39]
    ds_read_b64_tr_b16 v[112:113], v15 offset:0
    ds_read_b64_tr_b16 v[114:115], v15 offset:1024
    v_mfma_f32_16x16x32_bf16 v[40:43], v[124:127], v[152:155], v[40:43]
    ds_read_b64_tr_b16 v[116:117], v16 offset:0
    ds_read_b64_tr_b16 v[118:119], v16 offset:1024
    v_mfma_f32_16x16x32_bf16 v[56:59], v[128:131], v[152:155], v[56:59]
    ds_read_b64_tr_b16 v[120:121], v17 offset:0
    ds_read_b64_tr_b16 v[122:123], v17 offset:1024
    v_mfma_f32_16x16x32_bf16 v[52:55], v[128:131], v[148:151], v[52:55]
    ds_read_b64_tr_b16 v[96:97], v11 offset:0
    ds_read_b64_tr_b16 v[98:99], v11 offset:1024
    v_mfma_f32_16x16x32_bf16 v[48:51], v[128:131], v[144:147], v[48:51]
    ds_read_b64_tr_b16 v[100:101], v12 offset:0
    ds_read_b64_tr_b16 v[102:103], v12 offset:1024
    v_mfma_f32_16x16x32_bf16 v[44:47], v[128:131], v[140:143], v[44:47]
    ds_read_b64_tr_b16 v[104:105], v13 offset:0
    ds_read_b64_tr_b16 v[106:107], v13 offset:1024
    v_mfma_f32_16x16x32_bf16 v[60:63], v[132:135], v[140:143], v[60:63]
    v_mfma_f32_16x16x32_bf16 v[64:67], v[132:135], v[144:147], v[64:67]
    v_mfma_f32_16x16x32_bf16 v[68:71], v[132:135], v[148:151], v[68:71]
    v_mfma_f32_16x16x32_bf16 v[72:75], v[132:135], v[152:155], v[72:75]
    v_mfma_f32_16x16x32_bf16 v[88:91], v[136:139], v[152:155], v[88:91]
    v_mfma_f32_16x16x32_bf16 v[84:87], v[136:139], v[148:151], v[84:87]
    v_mfma_f32_16x16x32_bf16 v[80:83], v[136:139], v[144:147], v[80:83]
    v_mfma_f32_16x16x32_bf16 v[76:79], v[136:139], v[140:143], v[76:79]
    s_waitcnt lgkmcnt(0)
    v_mfma_f32_16x16x32_bf16 v[28:31], v[92:95], v[108:111], v[28:31]
    ds_read_b64_tr_b16 v[124:125], v10 offset:8192
    ds_read_b64_tr_b16 v[126:127], v10 offset:9216
    v_mfma_f32_16x16x32_bf16 v[32:35], v[92:95], v[112:115], v[32:35]
    ds_read_b64_tr_b16 v[140:141], v14 offset:8192
    ds_read_b64_tr_b16 v[142:143], v14 offset:9216
    v_mfma_f32_16x16x32_bf16 v[36:39], v[92:95], v[116:119], v[36:39]
    ds_read_b64_tr_b16 v[144:145], v15 offset:8192
    ds_read_b64_tr_b16 v[146:147], v15 offset:9216
    v_mfma_f32_16x16x32_bf16 v[40:43], v[92:95], v[120:123], v[40:43]
    ds_read_b64_tr_b16 v[148:149], v16 offset:8192
    ds_read_b64_tr_b16 v[150:151], v16 offset:9216
    v_mfma_f32_16x16x32_bf16 v[56:59], v[96:99], v[120:123], v[56:59]
    ds_read_b64_tr_b16 v[152:153], v17 offset:8192
    ds_read_b64_tr_b16 v[154:155], v17 offset:9216
    v_mfma_f32_16x16x32_bf16 v[52:55], v[96:99], v[116:119], v[52:55]
    ds_read_b64_tr_b16 v[128:129], v11 offset:8192
    ds_read_b64_tr_b16 v[130:131], v11 offset:9216
    v_mfma_f32_16x16x32_bf16 v[48:51], v[96:99], v[112:115], v[48:51]
    ds_read_b64_tr_b16 v[132:133], v12 offset:8192
    ds_read_b64_tr_b16 v[134:135], v12 offset:9216
    v_mfma_f32_16x16x32_bf16 v[44:47], v[96:99], v[108:111], v[44:47]
    ds_read_b64_tr_b16 v[136:137], v13 offset:8192
    ds_read_b64_tr_b16 v[138:139], v13 offset:9216
    v_mfma_f32_16x16x32_bf16 v[60:63], v[100:103], v[108:111], v[60:63]
    s_add_u32 s50, s50, 1
    s_cmp_eq_u32 s50, 4
    v_mfma_f32_16x16x32_bf16 v[64:67], v[100:103], v[112:115], v[64:67]
    s_cselect_b32 s49, s29, s51
    s_cselect_b32 s50, 0, s50
    v_mfma_f32_16x16x32_bf16 v[68:71], v[100:103], v[116:119], v[68:71]
    v_add_u32 v10, s49, v10
    v_add_u32 v11, s49, v11
    v_mfma_f32_16x16x32_bf16 v[72:75], v[100:103], v[120:123], v[72:75]
    v_add_u32 v12, s49, v12
    v_add_u32 v13, s49, v13
    v_mfma_f32_16x16x32_bf16 v[88:91], v[104:107], v[120:123], v[88:91]
    v_add_u32 v14, s49, v14
    v_add_u32 v15, s49, v15
    v_mfma_f32_16x16x32_bf16 v[84:87], v[104:107], v[116:119], v[84:87]
    v_add_u32 v16, s49, v16
    v_add_u32 v17, s49, v17
    v_mfma_f32_16x16x32_bf16 v[80:83], v[104:107], v[112:115], v[80:83]
    s_sub_u32 s48, s48, 1
    s_cmp_lg_u32 s48, 0
    v_mfma_f32_16x16x32_bf16 v[76:79], v[104:107], v[108:111], v[76:79]
    s_waitcnt lgkmcnt(0)
    s_cbranch_scc1 g3_cloop
    v_mfma_f32_16x16x32_bf16 v[28:31], v[124:127], v[140:143], v[28:31]
    v_mfma_f32_16x16x32_bf16 v[44:47], v[128:131], v[140:143], v[44:47]
    v_mfma_f32_16x16x32_bf16 v[60:63], v[132:135], v[140:143], v[60:63]
    v_mfma_f32_16x16x32_bf16 v[76:79], v[136:139], v[140:143], v[76:79]
    v_mfma_f32_16x16x32_bf16 v[32:35], v[124:127], v[144:147], v[32:35]
    v_mfma_f32_16x16x32_bf16 v[48:51], v[128:131], v[144:147], v[48:51]
    v_mfma_f32_16x16x32_bf16 v[64:67], v[132:135], v[144:147], v[64:67]
    v_mfma_f32_16x16x32_bf16 v[80:83], v[136:139], v[144:147], v[80:83]
    s_nop 1
    v_mfma_f32_16x16x32_bf16 v[36:39], v[124:127], v[148:151], v[36:39]
    v_pk_mul_f32 v[108:109], v[28:29], v[28:29]
    v_pk_mul_f32 v[110:111], v[30:31], v[30:31]
    v_pk_mul_f32 v[112:113], v[44:45], v[44:45]
    v_pk_mul_f32 v[114:115], v[46:47], v[46:47]
    v_pk_fma_f32 v[108:109], v[108:109], v[156:157], v[158:159]
    v_pk_fma_f32 v[110:111], v[110:111], v[156:157], v[158:159]
    v_pk_fma_f32 v[112:113], v[112:113], v[156:157], v[158:159]
    v_pk_fma_f32 v[114:115], v[114:115], v[156:157], v[158:159]
    v_pk_mul_f32 v[108:109], v[108:109], v[28:29]
    v_pk_mul_f32 v[110:111], v[110:111], v[30:31]
    v_pk_mul_f32 v[112:113], v[112:113], v[44:45]
    v_pk_mul_f32 v[114:115], v[114:115], v[46:47]
    v_exp_f32 v108, v108
    v_exp_f32 v109, v109
    v_exp_f32 v110, v110
    v_exp_f32 v111, v111
    v_exp_f32 v112, v112
    v_exp_f32 v113, v113
    v_exp_f32 v114, v114
    v_exp_f32 v115, v115
    v_pk_add_f32 v[108:109], v[108:109], v[160:161]
    v_pk_add_f32 v[110:111], v[110:111], v[160:161]
    v_mfma_f32_16x16x32_bf16 v[52:55], v[128:131], v[148:151], v[52:55]
    v_pk_add_f32 v[112:113], v[112:113], v[160:161]
    v_pk_add_f32 v[114:115], v[114:115], v[160:161]
    v_rcp_f32 v108, v108
    v_rcp_f32 v109, v109
    v_rcp_f32 v110, v110
    v_rcp_f32 v111, v111
    v_rcp_f32 v112, v112
    v_rcp_f32 v113, v113
    v_rcp_f32 v114, v114
    v_rcp_f32 v115, v115
    v_pk_mul_f32 v[28:29], v[28:29], v[108:109]
    v_pk_mul_f32 v[30:31], v[30:31], v[110:111]
    v_pk_mul_f32 v[44:45], v[44:45], v[112:113]
    v_pk_mul_f32 v[46:47], v[46:47], v[114:115]
    v_cvt_pk_bf16_f32 v92, v28, v29
    v_cvt_pk_bf16_f32 v93, v30, v31
    v_cvt_pk_bf16_f32 v94, v44, v45
    v_cvt_pk_bf16_f32 v95, v46, v47
    s_nop 1
    v_permlane16_swap_b32 v92, v94
    v_permlane16_swap_b32 v93, v95
    buffer_store_dwordx4 v[92:95], v9, s[16:19], s52 offen offset:0 sc1
    v_mfma_f32_16x16x32_bf16 v[68:71], v[132:135], v[148:151], v[68:71]
    v_pk_mul_f32 v[108:109], v[60:61], v[60:61]
    v_pk_mul_f32 v[110:111], v[62:63], v[62:63]
    v_pk_mul_f32 v[112:113], v[76:77], v[76:77]
    v_pk_mul_f32 v[114:115], v[78:79], v[78:79]
    v_pk_fma_f32 v[108:109], v[108:109], v[156:157], v[158:159]
    v_pk_fma_f32 v[110:111], v[110:111], v[156:157], v[158:159]
    v_pk_fma_f32 v[112:113], v[112:113], v[156:157], v[158:159]
    v_pk_fma_f32 v[114:115], v[114:115], v[156:157], v[158:159]
    v_pk_mul_f32 v[108:109], v[108:109], v[60:61]
    v_pk_mul_f32 v[110:111], v[110:111], v[62:63]
    v_pk_mul_f32 v[112:113], v[112:113], v[76:77]
    v_pk_mul_f32 v[114:115], v[114:115], v[78:79]
    v_exp_f32 v108, v108
    v_exp_f32 v109, v109
    v_exp_f32 v110, v110
    v_exp_f32 v111, v111
    v_exp_f32 v112, v112
    v_exp_f32 v113, v113
    v_exp_f32 v114, v114
    v_exp_f32 v115, v115
    v_pk_add_f32 v[108:109], v[108:109], v[160:161]
    v_pk_add_f32 v[110:111], v[110:111], v[160:161]
    v_mfma_f32_16x16x32_bf16 v[84:87], v[136:139], v[148:151], v[84:87]
    v_pk_add_f32 v[112:113], v[112:113], v[160:161]
    v_pk_add_f32 v[114:115], v[114:115], v[160:161]
    v_rcp_f32 v108, v108
    v_rcp_f32 v109, v109
    v_rcp_f32 v110, v110
    v_rcp_f32 v111, v111
    v_rcp_f32 v112, v112
    v_rcp_f32 v113, v113
    v_rcp_f32 v114, v114
    v_rcp_f32 v115, v115
    v_pk_mul_f32 v[60:61], v[60:61], v[108:109]
    v_pk_mul_f32 v[62:63], v[62:63], v[110:111]
    v_pk_mul_f32 v[76:77], v[76:77], v[112:113]
    v_pk_mul_f32 v[78:79], v[78:79], v[114:115]
    v_cvt_pk_bf16_f32 v96, v60, v61
    v_cvt_pk_bf16_f32 v97, v62, v63
    v_cvt_pk_bf16_f32 v98, v76, v77
    v_cvt_pk_bf16_f32 v99, v78, v79
    s_nop 1
    v_permlane16_swap_b32 v96, v98
    v_permlane16_swap_b32 v97, v99
    buffer_store_dwordx4 v[96:99], v9, s[16:19], s52 offen offset:64 sc1
    v_mfma_f32_16x16x32_bf16 v[40:43], v[124:127], v[152:155], v[40:43]
    v_pk_mul_f32 v[108:109], v[32:33], v[32:33]
    v_pk_mul_f32 v[110:111], v[34:35], v[34:35]
    v_pk_mul_f32 v[112:113], v[48:49], v[48:49]
    v_pk_mul_f32 v[114:115], v[50:51], v[50:51]
    v_pk_fma_f32 v[108:109], v[108:109], v[156:157], v[158:159]
    v_pk_fma_f32 v[110:111], v[110:111], v[156:157], v[158:159]
    v_pk_fma_f32 v[112:113], v[112:113], v[156:157], v[158:159]
    v_pk_fma_f32 v[114:115], v[114:115], v[156:157], v[158:159]
    v_pk_mul_f32 v[108:109], v[108:109], v[32:33]
    v_pk_mul_f32 v[110:111], v[110:111], v[34:35]
    v_pk_mul_f32 v[112:113], v[112:113], v[48:49]
    v_pk_mul_f32 v[114:115], v[114:115], v[50:51]
    v_exp_f32 v108, v108
    v_exp_f32 v109, v109
    v_exp_f32 v110, v110
    v_exp_f32 v111, v111
    v_exp_f32 v112, v112
    v_exp_f32 v113, v113
    v_exp_f32 v114, v114
    v_exp_f32 v115, v115
    v_pk_add_f32 v[108:109], v[108:109], v[160:161]
    v_pk_add_f32 v[110:111], v[110:111], v[160:161]
    v_mfma_f32_16x16x32_bf16 v[56:59], v[128:131], v[152:155], v[56:59]
    v_pk_add_f32 v[112:113], v[112:113], v[160:161]
    v_pk_add_f32 v[114:115], v[114:115], v[160:161]
    v_rcp_f32 v108, v108
    v_rcp_f32 v109, v109
    v_rcp_f32 v110, v110
    v_rcp_f32 v111, v111
    v_rcp_f32 v112, v112
    v_rcp_f32 v113, v113
    v_rcp_f32 v114, v114
    v_rcp_f32 v115, v115
    v_pk_mul_f32 v[32:33], v[32:33], v[108:109]
    v_pk_mul_f32 v[34:35], v[34:35], v[110:111]
    v_pk_mul_f32 v[48:49], v[48:49], v[112:113]
    v_pk_mul_f32 v[50:51], v[50:51], v[114:115]
    v_cvt_pk_bf16_f32 v100, v32, v33
    v_cvt_pk_bf16_f32 v101, v34, v35
    v_cvt_pk_bf16_f32 v102, v48, v49
    v_cvt_pk_bf16_f32 v103, v50, v51
    s_nop 1
    v_permlane16_swap_b32 v100, v102
    v_permlane16_swap_b32 v101, v103
    buffer_store_dwordx4 v[100:103], v9, s[16:19], s53 offen offset:0 sc1
    v_mfma_f32_16x16x32_bf16 v[72:75], v[132:135], v[152:155], v[72:75]
    v_pk_mul_f32 v[108:109], v[64:65], v[64:65]
    v_pk_mul_f32 v[110:111], v[66:67], v[66:67]
    v_pk_mul_f32 v[112:113], v[80:81], v[80:81]
    v_pk_mul_f32 v[114:115], v[82:83], v[82:83]
    v_pk_fma_f32 v[108:109], v[108:109], v[156:157], v[158:159]
    v_pk_fma_f32 v[110:111], v[110:111], v[156:157], v[158:159]
    v_pk_fma_f32 v[112:113], v[112:113], v[156:157], v[158:159]
    v_pk_fma_f32 v[114:115], v[114:115], v[156:157], v[158:159]
    v_pk_mul_f32 v[108:109], v[108:109], v[64:65]
    v_pk_mul_f32 v[110:111], v[110:111], v[66:67]
    v_pk_mul_f32 v[112:113], v[112:113], v[80:81]
    v_pk_mul_f32 v[114:115], v[114:115], v[82:83]
    v_exp_f32 v108, v108
    v_exp_f32 v109, v109
    v_exp_f32 v110, v110
    v_exp_f32 v111, v111
    v_exp_f32 v112, v112
    v_exp_f32 v113, v113
    v_exp_f32 v114, v114
    v_exp_f32 v115, v115
    v_pk_add_f32 v[108:109], v[108:109], v[160:161]
    v_pk_add_f32 v[110:111], v[110:111], v[160:161]
    v_mfma_f32_16x16x32_bf16 v[88:91], v[136:139], v[152:155], v[88:91]
    v_pk_add_f32 v[112:113], v[112:113], v[160:161]
    v_pk_add_f32 v[114:115], v[114:115], v[160:161]
    v_rcp_f32 v108, v108
    v_rcp_f32 v109, v109
    v_rcp_f32 v110, v110
    v_rcp_f32 v111, v111
    v_rcp_f32 v112, v112
    v_rcp_f32 v113, v113
    v_rcp_f32 v114, v114
    v_rcp_f32 v115, v115
    v_pk_mul_f32 v[64:65], v[64:65], v[108:109]
    v_pk_mul_f32 v[66:67], v[66:67], v[110:111]
    v_pk_mul_f32 v[80:81], v[80:81], v[112:113]
    v_pk_mul_f32 v[82:83], v[82:83], v[114:115]
    v_cvt_pk_bf16_f32 v104, v64, v65
    v_cvt_pk_bf16_f32 v105, v66, v67
    v_cvt_pk_bf16_f32 v106, v80, v81
    v_cvt_pk_bf16_f32 v107, v82, v83
    s_nop 1
    v_permlane16_swap_b32 v104, v106
    v_permlane16_swap_b32 v105, v107
    buffer_store_dwordx4 v[104:107], v9, s[16:19], s53 offen offset:64 sc1
    v_pk_mul_f32 v[108:109], v[36:37], v[36:37]
    v_pk_mul_f32 v[110:111], v[38:39], v[38:39]
    v_pk_mul_f32 v[112:113], v[52:53], v[52:53]
    v_pk_mul_f32 v[114:115], v[54:55], v[54:55]
    v_pk_fma_f32 v[108:109], v[108:109], v[156:157], v[158:159]
    v_pk_fma_f32 v[110:111], v[110:111], v[156:157], v[158:159]
    v_pk_fma_f32 v[112:113], v[112:113], v[156:157], v[158:159]
    v_pk_fma_f32 v[114:115], v[114:115], v[156:157], v[158:159]
    v_pk_mul_f32 v[108:109], v[108:109], v[36:37]
    v_pk_mul_f32 v[110:111], v[110:111], v[38:39]
    v_pk_mul_f32 v[112:113], v[112:113], v[52:53]
    v_pk_mul_f32 v[114:115], v[114:115], v[54:55]
    v_exp_f32 v108, v108
    v_exp_f32 v109, v109
    v_exp_f32 v110, v110
    v_exp_f32 v111, v111
    v_exp_f32 v112, v112
    v_exp_f32 v113, v113
    v_exp_f32 v114, v114
    v_exp_f32 v115, v115
    v_pk_add_f32 v[108:109], v[108:109], v[160:161]
    v_pk_add_f32 v[110:111], v[110:111], v[160:161]
    v_pk_add_f32 v[112:113], v[112:113], v[160:161]
    v_pk_add_f32 v[114:115], v[114:115], v[160:161]
    v_rcp_f32 v108, v108
    v_rcp_f32 v109, v109
    v_rcp_f32 v110, v110
    v_rcp_f32 v111, v111
    v_rcp_f32 v112, v112
    v_rcp_f32 v113, v113
    v_rcp_f32 v114, v114
    v_rcp_f32 v115, v115
    v_pk_mul_f32 v[36:37], v[36:37], v[108:109]
    v_pk_mul_f32 v[38:39], v[38:39], v[110:111]
    v_pk_mul_f32 v[52:53], v[52:53], v[112:113]
    v_pk_mul_f32 v[54:55], v[54:55], v[114:115]
    v_cvt_pk_bf16_f32 v92, v36, v37
    v_cvt_pk_bf16_f32 v93, v38, v39
    v_cvt_pk_bf16_f32 v94, v52, v53
    v_cvt_pk_bf16_f32 v95, v54, v55
    s_nop 1
    v_permlane16_swap_b32 v92, v94
    v_permlane16_swap_b32 v93, v95
    buffer_store_dwordx4 v[92:95], v9, s[16:19], s54 offen offset:0 sc1
    v_pk_mul_f32 v[108:109], v[68:69], v[68:69]
    v_pk_mul_f32 v[110:111], v[70:71], v[70:71]
    v_pk_mul_f32 v[112:113], v[84:85], v[84:85]
    v_pk_mul_f32 v[114:115], v[86:87], v[86:87]
    v_pk_fma_f32 v[108:109], v[108:109], v[156:157], v[158:159]
    v_pk_fma_f32 v[110:111], v[110:111], v[156:157], v[158:159]
    v_pk_fma_f32 v[112:113], v[112:113], v[156:157], v[158:159]
    v_pk_fma_f32 v[114:115], v[114:115], v[156:157], v[158:159]
    v_pk_mul_f32 v[108:109], v[108:109], v[68:69]
    v_pk_mul_f32 v[110:111], v[110:111], v[70:71]
    v_pk_mul_f32 v[112:113], v[112:113], v[84:85]
    v_pk_mul_f32 v[114:115], v[114:115], v[86:87]
    v_exp_f32 v108, v108
    v_exp_f32 v109, v109
    v_exp_f32 v110, v110
    v_exp_f32 v111, v111
    v_exp_f32 v112, v112
    v_exp_f32 v113, v113
    v_exp_f32 v114, v114
    v_exp_f32 v115, v115
    v_pk_add_f32 v[108:109], v[108:109], v[160:161]
    v_pk_add_f32 v[110:111], v[110:111], v[160:161]
    v_pk_add_f32 v[112:113], v[112:113], v[160:161]
    v_pk_add_f32 v[114:115], v[114:115], v[160:161]
    v_rcp_f32 v108, v108
    v_rcp_f32 v109, v109
    v_rcp_f32 v110, v110
    v_rcp_f32 v111, v111
    v_rcp_f32 v112, v112
    v_rcp_f32 v113, v113
    v_rcp_f32 v114, v114
    v_rcp_f32 v115, v115
    v_pk_mul_f32 v[68:69], v[68:69], v[108:109]
    v_pk_mul_f32 v[70:71], v[70:71], v[110:111]
    v_pk_mul_f32 v[84:85], v[84:85], v[112:113]
    v_pk_mul_f32 v[86:87], v[86:87], v[114:115]
    v_cvt_pk_bf16_f32 v96, v68, v69
    v_cvt_pk_bf16_f32 v97, v70, v71
    v_cvt_pk_bf16_f32 v98, v84, v85
    v_cvt_pk_bf16_f32 v99, v86, v87
    s_nop 1
    v_permlane16_swap_b32 v96, v98
    v_permlane16_swap_b32 v97, v99
    buffer_store_dwordx4 v[96:99], v9, s[16:19], s54 offen offset:64 sc1
    v_pk_mul_f32 v[108:109], v[40:41], v[40:41]
    v_pk_mul_f32 v[110:111], v[42:43], v[42:43]
    v_pk_mul_f32 v[112:113], v[56:57], v[56:57]
    v_pk_mul_f32 v[114:115], v[58:59], v[58:59]
    v_pk_fma_f32 v[108:109], v[108:109], v[156:157], v[158:159]
    v_pk_fma_f32 v[110:111], v[110:111], v[156:157], v[158:159]
    v_pk_fma_f32 v[112:113], v[112:113], v[156:157], v[158:159]
    v_pk_fma_f32 v[114:115], v[114:115], v[156:157], v[158:159]
    v_pk_mul_f32 v[108:109], v[108:109], v[40:41]
    v_pk_mul_f32 v[110:111], v[110:111], v[42:43]
    v_pk_mul_f32 v[112:113], v[112:113], v[56:57]
    v_pk_mul_f32 v[114:115], v[114:115], v[58:59]
    v_exp_f32 v108, v108
    v_exp_f32 v109, v109
    v_exp_f32 v110, v110
    v_exp_f32 v111, v111
    v_exp_f32 v112, v112
    v_exp_f32 v113, v113
    v_exp_f32 v114, v114
    v_exp_f32 v115, v115
    v_pk_add_f32 v[108:109], v[108:109], v[160:161]
    v_pk_add_f32 v[110:111], v[110:111], v[160:161]
    v_pk_add_f32 v[112:113], v[112:113], v[160:161]
    v_pk_add_f32 v[114:115], v[114:115], v[160:161]
    v_rcp_f32 v108, v108
    v_rcp_f32 v109, v109
    v_rcp_f32 v110, v110
    v_rcp_f32 v111, v111
    v_rcp_f32 v112, v112
    v_rcp_f32 v113, v113
    v_rcp_f32 v114, v114
    v_rcp_f32 v115, v115
    v_pk_mul_f32 v[40:41], v[40:41], v[108:109]
    v_pk_mul_f32 v[42:43], v[42:43], v[110:111]
    v_pk_mul_f32 v[56:57], v[56:57], v[112:113]
    v_pk_mul_f32 v[58:59], v[58:59], v[114:115]
    v_cvt_pk_bf16_f32 v100, v40, v41
    v_cvt_pk_bf16_f32 v101, v42, v43
    v_cvt_pk_bf16_f32 v102, v56, v57
    v_cvt_pk_bf16_f32 v103, v58, v59
    s_nop 1
    v_permlane16_swap_b32 v100, v102
    v_permlane16_swap_b32 v101, v103
    buffer_store_dwordx4 v[100:103], v9, s[16:19], s55 offen offset:0 sc1
    v_pk_mul_f32 v[108:109], v[72:73], v[72:73]
    v_pk_mul_f32 v[110:111], v[74:75], v[74:75]
    v_pk_mul_f32 v[112:113], v[88:89], v[88:89]
    v_pk_mul_f32 v[114:115], v[90:91], v[90:91]
    v_pk_fma_f32 v[108:109], v[108:109], v[156:157], v[158:159]
    v_pk_fma_f32 v[110:111], v[110:111], v[156:157], v[158:159]
    v_pk_fma_f32 v[112:113], v[112:113], v[156:157], v[158:159]
    v_pk_fma_f32 v[114:115], v[114:115], v[156:157], v[158:159]
    v_pk_mul_f32 v[108:109], v[108:109], v[72:73]
    v_pk_mul_f32 v[110:111], v[110:111], v[74:75]
    v_pk_mul_f32 v[112:113], v[112:113], v[88:89]
    v_pk_mul_f32 v[114:115], v[114:115], v[90:91]
    v_exp_f32 v108, v108
    v_exp_f32 v109, v109
    v_exp_f32 v110, v110
    v_exp_f32 v111, v111
    v_exp_f32 v112, v112
    v_exp_f32 v113, v113
    v_exp_f32 v114, v114
    v_exp_f32 v115, v115
    v_pk_add_f32 v[108:109], v[108:109], v[160:161]
    v_pk_add_f32 v[110:111], v[110:111], v[160:161]
    v_pk_add_f32 v[112:113], v[112:113], v[160:161]
    v_pk_add_f32 v[114:115], v[114:115], v[160:161]
    v_rcp_f32 v108, v108
    v_rcp_f32 v109, v109
    v_rcp_f32 v110, v110
    v_rcp_f32 v111, v111
    v_rcp_f32 v112, v112
    v_rcp_f32 v113, v113
    v_rcp_f32 v114, v114
    v_rcp_f32 v115, v115
    v_pk_mul_f32 v[72:73], v[72:73], v[108:109]
    v_pk_mul_f32 v[74:75], v[74:75], v[110:111]
    v_pk_mul_f32 v[88:89], v[88:89], v[112:113]
    v_pk_mul_f32 v[90:91], v[90:91], v[114:115]
    v_cvt_pk_bf16_f32 v104, v72, v73
    v_cvt_pk_bf16_f32 v105, v74, v75
    v_cvt_pk_bf16_f32 v106, v88, v89
    v_cvt_pk_bf16_f32 v107, v90, v91
    s_nop 1
    v_permlane16_swap_b32 v104, v106
    v_permlane16_swap_b32 v105, v107
    buffer_store_dwordx4 v[104:107], v9, s[16:19], s55 offen offset:64 sc1
    s_cmp_ge_u32 s24, 14
    s_cselect_b32 s40, 25, 24
    s_lshl_b32 s41, s25, 1
    s_add_u32 s40, s40, s41
    s_lshl_b32 s40, s40, 8
    s_add_u32 s84, s4, 0x300000
    s_addc_u32 s85, s5, 0
    s_mov_b32 s86, 0x4000
    s_mov_b32 s87, 0x20000
    v_mov_b32 v3, s40
    v_mov_b32 v4, 1
    s_waitcnt vmcnt(0)
    s_barrier
    s_cmp_lg_u32 s28, 0
    s_cbranch_scc1 g3_cin
    s_mov_b64 exec, 1
    buffer_atomic_add v4, v3, s[84:87], 0 offen sc1
    s_mov_b64 exec, -1
g3_cin:
    s_branch g4_in
g3_spare:
    s_cmp_ge_u32 s2, 256
    s_cbranch_scc1 g3_done
    s_load_dwordx2 s[4:5], s[0:1], 80
    s_load_dwordx2 s[6:7], s[0:1], 48
    s_sub_u32 s3, s2, 224
    v_lshrrev_b32 v2, 6, v0
    v_lshlrev_b32 v1, 4, v0
    v_mov_b32 v8, -1
    v_mov_b32 v9, -1
    v_mov_b32 v10, -1
    v_mov_b32 v11, -1
    v_readfirstlane_b32 s28, v2
    s_lshl_b32 s13, s3, 17
    s_waitcnt lgkmcnt(0)
    s_add_u32 s4, s4, s97
    s_addc_u32 s5, s5, 0
    s_add_u32 s8, s4, 0x1d00000
    s_addc_u32 s9, s5, 0
    s_mov_b32 s10, 0x400000
    s_mov_b32 s11, 0x20000
    buffer_store_dwordx4 v[8:11], v1, s[8:11], s13 offen sc1
    s_add_u32 s13, s13, 8192
    buffer_store_dwordx4 v[8:11], v1, s[8:11], s13 offen sc1
    s_add_u32 s13, s13, 8192
    buffer_store_dwordx4 v[8:11], v1, s[8:11], s13 offen sc1
    s_add_u32 s13, s13, 8192
    buffer_store_dwordx4 v[8:11], v1, s[8:11], s13 offen sc1
    s_add_u32 s13, s13, 8192
    buffer_store_dwordx4 v[8:11], v1, s[8:11], s13 offen sc1
    s_add_u32 s13, s13, 8192
    buffer_store_dwordx4 v[8:11], v1, s[8:11], s13 offen sc1
    s_add_u32 s13, s13, 8192
    buffer_store_dwordx4 v[8:11], v1, s[8:11], s13 offen sc1
    s_add_u32 s13, s13, 8192
    buffer_store_dwordx4 v[8:11], v1, s[8:11], s13 offen sc1
    s_add_u32 s13, s13, 8192
    buffer_store_dwordx4 v[8:11], v1, s[8:11], s13 offen sc1
    s_add_u32 s13, s13, 8192
    buffer_store_dwordx4 v[8:11], v1, s[8:11], s13 offen sc1
    s_add_u32 s13, s13, 8192
    buffer_store_dwordx4 v[8:11], v1, s[8:11], s13 offen sc1
    s_add_u32 s13, s13, 8192
    buffer_store_dwordx4 v[8:11], v1, s[8:11], s13 offen sc1
    s_add_u32 s13, s13, 8192
    buffer_store_dwordx4 v[8:11], v1, s[8:11], s13 offen sc1
    s_add_u32 s13, s13, 8192
    buffer_store_dwordx4 v[8:11], v1, s[8:11], s13 offen sc1
    s_add_u32 s13, s13, 8192
    buffer_store_dwordx4 v[8:11], v1, s[8:11], s13 offen sc1
    s_add_u32 s13, s13, 8192
    buffer_store_dwordx4 v[8:11], v1, s[8:11], s13 offen sc1
    s_add_u32 s13, s13, 8192
    s_mov_b32 s40, 14336
    s_add_u32 s84, s4, 0x300000
    s_addc_u32 s85, s5, 0
    s_mov_b32 s86, 0x4000
    s_mov_b32 s87, 0x20000
    v_mov_b32 v3, s40
    v_mov_b32 v4, 1
    s_waitcnt vmcnt(0)
    s_barrier
    s_cmp_lg_u32 s28, 0
    s_cbranch_scc1 g3_spare_cin
    s_mov_b64 exec, 1
    buffer_atomic_add v4, v3, s[84:87], 0 offen sc1
    s_mov_b64 exec, -1
g3_spare_cin:
    s_cmp_lg_u32 s96, 0
    s_cbranch_scc1 g3_spare_end
g3_spare_end:
    s_branch g4_in
.p2align 6
g4_in:
    s_cmp_ge_u32 s2, 256
    s_cbranch_scc1 g4_done
    s_load_dwordx2 s[4:5], s[0:1], 80
    s_load_dwordx2 s[6:7], s[0:1], 64
    s_load_dwordx2 s[30:31], s[0:1], 48
    s_load_dwordx2 s[34:35], s[0:1], 56
    v_lshrrev_b32 v1, 6, v0
    v_and_b32 v2, 63, v0
    s_bfe_u32 s40, s2, 0x10001
    s_lshl_b32 s40, s40, 2
    s_bfe_u32 s41, s2, 0x20003
    s_add_u32 s24, s40, s41
    s_bfe_u32 s40, s2, 0x10002
    s_lshl_b32 s40, s40, 3
    s_lshr_b32 s42, s2, 5
    s_add_u32 s25, s40, s42
    s_and_b32 s91, s2, 1
    s_add_u32 s27, s41, s42
    s_lshl_b32 s92, s24, 4
    s_add_u32 s92, s92, s25
    s_mul_i32 s26, s91, 28
    s_cmp_eq_u32 s96, 0
    s_cselect_b32 s95, 3, 1
    v_readfirstlane_b32 s28, v1
    s_nop 0
    s_cmp_lt_u32 s28, 4
    s_cbranch_scc1 g4_compute
    s_sub_u32 s28, s28, 4
    s_mov_b32 s40, 8192
    v_lshrrev_b32 v3, 3, v2
    v_mul_lo_u32 v3, v3, s40
    v_lshrrev_b32 v4, 4, v2
    v_xor_b32 v4, v4, v2
    v_and_b32 v4, 7, v4
    v_lshl_add_u32 v3, v4, 4, v3
    s_mul_i32 s41, s24, 1048576
    s_mul_i32 s42, s28, 262144
    s_add_u32 s41, s41, s42
    v_xor_b32 v4, 64, v3
    s_add_u32 s42, s41, 0
    v_add_u32 v10, s42, v3
    s_add_u32 s42, s41, 65536
    v_add_u32 v11, s42, v4
    s_add_u32 s42, s41, 131072
    v_add_u32 v12, s42, v3
    s_add_u32 s42, s41, 196608
    v_add_u32 v13, s42, v4
    s_mov_b32 s40, 4096
    v_lshrrev_b32 v4, 4, v2
    v_mul_lo_u32 v3, v4, s40
    v_lshlrev_b32 v4, 1, v4
    v_xor_b32 v4, v4, v2
    v_and_b32 v4, 15, v4
    v_lshl_add_u32 v3, v4, 4, v3
    s_mul_i32 s41, s25, 256
    s_mul_i32 s42, s28, 65536
    s_add_u32 s41, s41, s42
    v_xor_b32 v4, 128, v3
    s_add_u32 s42, s41, 0
    v_add_u32 v14, s42, v3
    s_add_u32 s42, s41, 16384
    v_add_u32 v15, s42, v3
    s_add_u32 s42, s41, 32768
    v_add_u32 v16, s42, v4
    s_add_u32 s42, s41, 49152
    v_add_u32 v17, s42, v4
    s_mul_i32 s36, s28, 4096
    s_mul_i32 s37, s28, 4096
    s_add_u32 s37, s37, 16384
    s_waitcnt lgkmcnt(0)
    s_add_u32 s4, s4, s97
    s_addc_u32 s5, s5, 0
    s_add_u32 s8, s4, 0x1100000
    s_addc_u32 s9, s5, 0
    s_mov_b32 s10, 0x800000
    s_mov_b32 s11, 0x20000
    s_mov_b32 s12, s30
    s_mov_b32 s13, s31
    s_mov_b32 s14, 0xe00000
    s_mov_b32 s15, 0x20000
    s_mov_b32 s32, 0
    s_mov_b32 s33, 0
g4_ld_pW:
    s_add_u32 s40, s32, s27
    s_and_b32 s40, s40, s95
    s_andn2_b32 s41, s32, s95
    s_or_b32 s40, s40, s41
    s_add_u32 s40, s40, s26
    s_mul_i32 s34, s40, 128
    s_mul_i32 s35, s40, 262144
    s_add_u32 s38, s33, s36
    s_add_u32 s39, s33, s37
    s_add_u32 m0, s39, 0
    s_nop 0
    buffer_load_dwordx4 v14, s[12:15], s35 offen lds
    s_add_u32 m0, s39, 1024
    s_nop 0
    buffer_load_dwordx4 v15, s[12:15], s35 offen lds
    s_add_u32 m0, s39, 2048
    s_nop 0
    buffer_load_dwordx4 v16, s[12:15], s35 offen lds
    s_add_u32 m0, s39, 3072
    s_nop 0
    buffer_load_dwordx4 v17, s[12:15], s35 offen lds
    s_add_u32 s33, s33, 32768
    s_add_u32 s32, s32, 1
    s_cmp_lt_u32 s32, 3
    s_cbranch_scc1 g4_ld_pW
    s_lshl_b32 s40, s24, 1
    s_add_u32 s40, s40, s91
    s_add_u32 s40, s40, 24
    s_lshl_b32 s40, s40, 8
    s_mov_b32 s42, 14336
    s_lshl_b32 s43, s96, 2
    s_add_u32 s43, s43, 4
    s_mov_b32 s41, 0x80000
    v_mov_b32 v24, 131072
    s_cmp_lg_u32 s28, 0
    s_cbranch_scc1 g4_dep_lds
    s_mov_b32 s41, 0x8000
    s_add_u32 s84, s4, 0x300000
    s_addc_u32 s85, s5, 0
    s_mov_b32 s86, 0x4000
    s_mov_b32 s87, 0x20000
    v_cmp_eq_u32 vcc, 1, v2
    v_mov_b32 v21, s40
    v_mov_b32 v23, s42
    v_cndmask_b32 v21, v21, v23, vcc
    v_mov_b32 v22, 14
    v_mov_b32 v23, 32
    v_cndmask_b32 v22, v22, v23, vcc
g4_dep:
    buffer_load_dword v23, v21, s[84:87], 0 offen sc1
    s_sub_u32 s41, s41, 1
    s_waitcnt vmcnt(0)
    v_cmp_lt_u32 vcc, v23, v22
    s_cmp_eq_u32 s41, 0
    s_cbranch_scc1 g4_dep_seen
    s_cbranch_vccz g4_dep_seen
    s_sleep 2
    s_branch g4_dep
g4_dep_seen:
    v_mov_b32 v23, s43
    ds_write_b32 v24, v23
    s_branch g4_dep_ok
g4_dep_lds:
    ds_read_b32 v23, v24
    s_sub_u32 s41, s41, 1
    s_waitcnt lgkmcnt(0)
    v_readfirstlane_b32 s40, v23
    s_cmp_eq_u32 s41, 0
    s_cbranch_scc1 g4_dep_ok
    s_cmp_eq_u32 s40, s43
    s_cbranch_scc1 g4_dep_ok
    s_sleep 1
    s_branch g4_dep_lds
g4_dep_ok:
    s_mov_b32 s32, 0
    s_mov_b32 s33, 0
g4_ld_pA:
    s_add_u32 s40, s32, s27
    s_and_b32 s40, s40, s95
    s_andn2_b32 s41, s32, s95
    s_or_b32 s40, s40, s41
    s_add_u32 s40, s40, s26
    s_mul_i32 s34, s40, 128
    s_mul_i32 s35, s40, 262144
    s_add_u32 s38, s33, s36
    s_add_u32 s39, s33, s37
    s_add_u32 m0, s38, 0
    s_nop 0
    buffer_load_dwordx4 v10, s[8:11], s34 offen sc1 lds
    s_add_u32 m0, s38, 1024
    s_nop 0
    buffer_load_dwordx4 v11, s[8:11], s34 offen sc1 lds
    s_add_u32 m0, s38, 2048
    s_nop 0
    buffer_load_dwordx4 v12, s[8:11], s34 offen sc1 lds
    s_add_u32 m0, s38, 3072
    s_nop 0
    buffer_load_dwordx4 v13, s[8:11], s34 offen sc1 lds
    s_add_u32 s33, s33, 32768
    s_add_u32 s32, s32, 1
    s_cmp_lt_u32 s32, 3
    s_cbranch_scc1 g4_ld_pA
    s_waitcnt vmcnt(8)
    s_branch g4_ld_bar
g4_ld_loop:
    s_cmp_eq_u32 s32, 4
    s_cbranch_scc1 g4_ld_s4
    s_waitcnt vmcnt(16)
g4_ld_bar:
    s_barrier
    s_add_u32 s40, s32, s27
    s_and_b32 s40, s40, s95
    s_andn2_b32 s41, s32, s95
    s_or_b32 s40, s40, s41
    s_add_u32 s40, s40, s26
    s_mul_i32 s34, s40, 128
    s_mul_i32 s35, s40, 262144
    s_add_u32 s38, s33, s36
    s_add_u32 s39, s33, s37
    s_add_u32 m0, s38, 0
    s_nop 0
    buffer_load_dwordx4 v10, s[8:11], s34 offen sc1 lds
    s_add_u32 m0, s38, 1024
    s_nop 0
    buffer_load_dwordx4 v11, s[8:11], s34 offen sc1 lds
    s_add_u32 m0, s38, 2048
    s_nop 0
    buffer_load_dwordx4 v12, s[8:11], s34 offen sc1 lds
    s_add_u32 m0, s38, 3072
    s_nop 0
    buffer_load_dwordx4 v13, s[8:11], s34 offen sc1 lds
    s_add_u32 m0, s39, 0
    s_nop 0
    buffer_load_dwordx4 v14, s[12:15], s35 offen lds
    s_add_u32 m0, s39, 1024
    s_nop 0
    buffer_load_dwordx4 v15, s[12:15], s35 offen lds
    s_add_u32 m0, s39, 2048
    s_nop 0
    buffer_load_dwordx4 v16, s[12:15], s35 offen lds
    s_add_u32 m0, s39, 3072
    s_nop 0
    buffer_load_dwordx4 v17, s[12:15], s35 offen lds
    s_add_u32 s33, s33, 32768
    s_add_u32 s32, s32, 1
    s_cmp_eq_u32 s33, 131072
    s_cselect_b32 s33, 0, s33
    s_cmp_lt_u32 s32, 28
    s_cbranch_scc1 g4_ld_loop
    s_waitcnt vmcnt(16)
    s_barrier
    s_waitcnt vmcnt(8)
    s_barrier
    s_waitcnt vmcnt(0)
    s_barrier
    s_branch g4_ld_end
g4_ld_s4:
    s_waitcnt vmcnt(12)
    s_branch g4_ld_bar
g4_ld_end:
    s_cmp_lg_u32 s96, 0
    s_cbranch_scc1 g4_done
    s_barrier
    s_mov_b32 s96, 1
    s_mov_b32 s97, 0x2800000
    s_branch g1_in
g4_done:
    s_endpgm
g4_compute:
    v_lshrrev_b32 v5, 4, v2
    v_bfe_u32 v6, v2, 2, 2
    v_and_b32 v7, 3, v2
    v_and_b32 v8, 15, v2
    s_and_b32 s44, s28, 1
    s_lshr_b32 s45, s28, 1
    s_mul_i32 s40, s25, 128
    s_mul_i32 s41, s45, 64
    s_add_u32 s40, s40, s41
    s_lshl_b32 s41, s91, 5
    s_add_u32 s40, s40, s41
    v_add_u32 v20, s40, v8
    s_mov_b32 s41, 2048
    v_mul_lo_u32 v9, v20, s41
    s_mul_i32 s40, s24, 256
    s_mul_i32 s41, s44, 128
    s_add_u32 s46, s40, s41
    v_and_b32 v3, 1, v5
    v_lshlrev_b32 v3, 5, v3
    v_lshrrev_b32 v4, 1, v5
    v_lshl_add_u32 v3, v4, 4, v3
    v_add3_u32 v9, v9, v3, s46
    s_mov_b32 s52, 0
    s_mov_b32 s53, 32768
    s_mov_b32 s54, 65536
    s_mov_b32 s55, 98304
    s_waitcnt lgkmcnt(0)
    s_add_u32 s4, s4, s97
    s_addc_u32 s5, s5, 0
    s_add_u32 s20, s4, 0x800000
    s_addc_u32 s21, s5, 0
    s_mov_b32 s22, 0x400000
    s_mov_b32 s23, 0x20000
    s_mov_b32 s56, s34
    s_mov_b32 s57, s35
    s_mov_b32 s58, 0x1000
    s_mov_b32 s59, 0x20000
    s_add_u32 s16, s4, 0x4100000
    s_addc_u32 s17, s5, 0
    s_cmp_eq_u32 s96, 0
    s_cselect_b32 s16, s16, s6
    s_cselect_b32 s17, s17, s7
    s_mov_b32 s18, 0x400000
    s_mov_b32 s19, 0x20000
    s_add_u32 s60, s4, 0x2800000
    s_addc_u32 s61, s5, 0
    s_mov_b32 s62, 0x40000
    s_mov_b32 s63, 0x20000
    s_add_u32 s84, s4, 0x1d00000
    s_addc_u32 s85, s5, 0
    s_mov_b32 s86, 0x400000
    s_mov_b32 s87, 0x20000
    s_mul_i32 s42, s44, 64
    v_lshrrev_b32 v3, 1, v8
    v_xor_b32 v3, v3, v5
    v_lshlrev_b32 v3, 4, v3
    v_lshl_add_u32 v3, v8, 7, v3
    s_lshl_b32 s40, s42, 7
    s_add_u32 s40, s40, 0
    v_add_u32 v10, s40, v3
    v_xor_b32 v11, 64, v10
    s_lshl_b32 s90, s91, 1
    s_mul_i32 s42, s45, 4
    s_mov_b32 s43, 16384
    v_and_b32 v3, 1, v5
    v_lshl_or_b32 v3, v3, 2, v6
    s_add_u32 s40, s42, 0
    s_xor_b32 s40, s40, s90
    v_xor_b32 v3, s40, v3
    v_lshlrev_b32 v3, 5, v3
    v_lshl_add_u32 v3, v7, 3, v3
    v_lshl_add_u32 v4, v5, 3, v6
    v_lshl_add_u32 v3, v4, 8, v3
    v_add_u32 v12, s43, v3
    v_and_b32 v3, 1, v5
    v_lshl_or_b32 v3, v3, 2, v6
    s_add_u32 s40, s42, 1
    s_xor_b32 s40, s40, s90
    v_xor_b32 v3, s40, v3
    v_lshlrev_b32 v3, 5, v3
    v_lshl_add_u32 v3, v7, 3, v3
    v_lshl_add_u32 v4, v5, 3, v6
    v_lshl_add_u32 v3, v4, 8, v3
    v_add_u32 v13, s43, v3
    v_and_b32 v3, 1, v5
    v_lshl_or_b32 v3, v3, 2, v6
    s_add_u32 s40, s42, 2
    s_xor_b32 s40, s40, s90
    v_xor_b32 v3, s40, v3
    v_lshlrev_b32 v3, 5, v3
    v_lshl_add_u32 v3, v7, 3, v3
    v_lshl_add_u32 v4, v5, 3, v6
    v_lshl_add_u32 v3, v4, 8, v3
    v_add_u32 v14, s43, v3
    v_and_b32 v3, 1, v5
    v_lshl_or_b32 v3, v3, 2, v6
    s_add_u32 s40, s42, 3
    s_xor_b32 s40, s40, s90
    v_xor_b32 v3, s40, v3
    v_lshlrev_b32 v3, 5, v3
    v_lshl_add_u32 v3, v7, 3, v3
    v_lshl_add_u32 v4, v5, 3, v6
    v_lshl_add_u32 v3, v4, 8, v3
    v_add_u32 v15, s43, v3
    v_mov_b32 v124, 0
    v_mov_b32 v125, 0
    v_mov_b32 v126, 0
    v_mov_b32 v127, 0
    v_mov_b32 v128, 0
    v_mov_b32 v129, 0
    v_mov_b32 v130, 0
    v_mov_b32 v131, 0
    v_mov_b32 v132, 0
    v_mov_b32 v133, 0
    v_mov_b32 v134, 0
    v_mov_b32 v135, 0
    v_mov_b32 v136, 0
    v_mov_b32 v137, 0
    v_mov_b32 v138, 0
    v_mov_b32 v139, 0
    v_mov_b32 v140, 0
    v_mov_b32 v141, 0
    v_mov_b32 v142, 0
    v_mov_b32 v143, 0
    v_mov_b32 v144, 0
    v_mov_b32 v145, 0
    v_mov_b32 v146, 0
    v_mov_b32 v147, 0
    v_mov_b32 v148, 0
    v_mov_b32 v149, 0
    v_mov_b32 v150, 0
    v_mov_b32 v151, 0
    v_mov_b32 v152, 0
    v_mov_b32 v153, 0
    v_mov_b32 v154, 0
    v_mov_b32 v155, 0
    s_mov_b32 s48, 28
    s_mov_b32 s50, 0
    s_mov_b32 s51, 32768
    s_mov_b32 s29, 0xfffe8000
    s_lshl_b32 s40, s28, 12
    v_lshl_add_u32 v21, v2, 4, s40
    s_lshl_b32 s93, s92, 1
    s_add_u32 s93, s93, s91
    s_lshl_b32 s93, s93, 14
    s_xor_b32 s94, s93, 0x4000
    v_mov_b32 v28, 0
    v_mov_b32 v29, 0
    v_mov_b32 v30, 0
    v_mov_b32 v31, 0
    v_mov_b32 v32, 0
    v_mov_b32 v33, 0
    v_mov_b32 v34, 0
    v_mov_b32 v35, 0
    v_mov_b32 v36, 0
    v_mov_b32 v37, 0
    v_mov_b32 v38, 0
    v_mov_b32 v39, 0
    v_mov_b32 v40, 0
    v_mov_b32 v41, 0
    v_mov_b32 v42, 0
    v_mov_b32 v43, 0
    v_mov_b32 v44, 0
    v_mov_b32 v45, 0
    v_mov_b32 v46, 0
    v_mov_b32 v47, 0
    v_mov_b32 v48, 0
    v_mov_b32 v49, 0
    v_mov_b32 v50, 0
    v_mov_b32 v51, 0
    v_mov_b32 v52, 0
    v_mov_b32 v53, 0
    v_mov_b32 v54, 0
    v_mov_b32 v55, 0
    v_mov_b32 v56, 0
    v_mov_b32 v57, 0
    v_mov_b32 v58, 0
    v_mov_b32 v59, 0
    v_mov_b32 v60, 0
    v_mov_b32 v61, 0
    v_mov_b32 v62, 0
    v_mov_b32 v63, 0
    v_mov_b32 v64, 0
    v_mov_b32 v65, 0
    v_mov_b32 v66, 0
    v_mov_b32 v67, 0
    v_mov_b32 v68, 0
    v_mov_b32 v69, 0
    v_mov_b32 v70, 0
    v_mov_b32 v71, 0
    v_mov_b32 v72, 0
    v_mov_b32 v73, 0
    v_mov_b32 v74, 0
    v_mov_b32 v75, 0
    v_mov_b32 v76, 0
    v_mov_b32 v77, 0
    v_mov_b32 v78, 0
    v_mov_b32 v79, 0
    v_mov_b32 v80, 0
    v_mov_b32 v81, 0
    v_mov_b32 v82, 0
    v_mov_b32 v83, 0
    v_mov_b32 v84, 0
    v_mov_b32 v85, 0
    v_mov_b32 v86, 0
    v_mov_b32 v87, 0
    v_mov_b32 v88, 0
    v_mov_b32 v89, 0
    v_mov_b32 v90, 0
    v_mov_b32 v91, 0
    s_barrier
    buffer_load_dwordx4 v[188:191], v9, s[20:23], s52 offen offset:0 sc1
    buffer_load_dwordx4 v[192:195], v9, s[20:23], s52 offen offset:64 sc1
    buffer_load_dwordx4 v[196:199], v9, s[20:23], s53 offen offset:0 sc1
    buffer_load_dwordx4 v[200:203], v9, s[20:23], s53 offen offset:64 sc1
    v_lshlrev_b32 v3, 1, v20
    buffer_load_ushort v22, v3, s[56:59], 0 offen offset:0
    buffer_load_ushort v23, v3, s[56:59], 0 offen offset:32
    s_branch g4_cloop2
.p2align 3
g4_cloop:
    s_barrier
g4_cloop2:
    v_mfma_f32_16x16x32_bf16 v[28:31], v[124:127], v[140:143], v[28:31]
    ds_read_b128 v[92:95], v10 offset:0
    v_mfma_f32_16x16x32_bf16 v[32:35], v[124:127], v[144:147], v[32:35]
    ds_read_b64_tr_b16 v[108:109], v12 offset:0
    ds_read_b64_tr_b16 v[110:111], v12 offset:1024
    v_mfma_f32_16x16x32_bf16 v[36:39], v[124:127], v[148:151], v[36:39]
    ds_read_b64_tr_b16 v[112:113], v13 offset:0
    ds_read_b64_tr_b16 v[114:115], v13 offset:1024
    v_mfma_f32_16x16x32_bf16 v[40:43], v[124:127], v[152:155], v[40:43]
    ds_read_b64_tr_b16 v[116:117], v14 offset:0
    ds_read_b64_tr_b16 v[118:119], v14 offset:1024
    v_mfma_f32_16x16x32_bf16 v[56:59], v[128:131], v[152:155], v[56:59]
    ds_read_b64_tr_b16 v[120:121], v15 offset:0
    ds_read_b64_tr_b16 v[122:123], v15 offset:1024
    v_mfma_f32_16x16x32_bf16 v[52:55], v[128:131], v[148:151], v[52:55]
    ds_read_b128 v[96:99], v10 offset:2048
    v_mfma_f32_16x16x32_bf16 v[48:51], v[128:131], v[144:147], v[48:51]
    ds_read_b128 v[100:103], v10 offset:4096
    v_mfma_f32_16x16x32_bf16 v[44:47], v[128:131], v[140:143], v[44:47]
    ds_read_b128 v[104:107], v10 offset:6144
    v_mfma_f32_16x16x32_bf16 v[60:63], v[132:135], v[140:143], v[60:63]
    v_mfma_f32_16x16x32_bf16 v[64:67], v[132:135], v[144:147], v[64:67]
    v_mfma_f32_16x16x32_bf16 v[68:71], v[132:135], v[148:151], v[68:71]
    v_mfma_f32_16x16x32_bf16 v[72:75], v[132:135], v[152:155], v[72:75]
    v_mfma_f32_16x16x32_bf16 v[88:91], v[136:139], v[152:155], v[88:91]
    v_mfma_f32_16x16x32_bf16 v[84:87], v[136:139], v[148:151], v[84:87]
    v_mfma_f32_16x16x32_bf16 v[80:83], v[136:139], v[144:147], v[80:83]
    v_mfma_f32_16x16x32_bf16 v[76:79], v[136:139], v[140:143], v[76:79]
    s_waitcnt lgkmcnt(0)
    v_mfma_f32_16x16x32_bf16 v[28:31], v[92:95], v[108:111], v[28:31]
    ds_read_b128 v[124:127], v11 offset:0
    v_mfma_f32_16x16x32_bf16 v[32:35], v[92:95], v[112:115], v[32:35]
    ds_read_b64_tr_b16 v[140:141], v12 offset:8192
    ds_read_b64_tr_b16 v[142:143], v12 offset:9216
    v_mfma_f32_16x16x32_bf16 v[36:39], v[92:95], v[116:119], v[36:39]
    ds_read_b64_tr_b16 v[144:145], v13 offset:8192
    ds_read_b64_tr_b16 v[146:147], v13 offset:9216
    v_mfma_f32_16x16x32_bf16 v[40:43], v[92:95], v[120:123], v[40:43]
    ds_read_b64_tr_b16 v[148:149], v14 offset:8192
    ds_read_b64_tr_b16 v[150:151], v14 offset:9216
    v_mfma_f32_16x16x32_bf16 v[56:59], v[96:99], v[120:123], v[56:59]
    ds_read_b64_tr_b16 v[152:153], v15 offset:8192
    ds_read_b64_tr_b16 v[154:155], v15 offset:9216
    v_mfma_f32_16x16x32_bf16 v[52:55], v[96:99], v[116:119], v[52:55]
    ds_read_b128 v[128:131], v11 offset:2048
    v_mfma_f32_16x16x32_bf16 v[48:51], v[96:99], v[112:115], v[48:51]
    ds_read_b128 v[132:135], v11 offset:4096
    v_mfma_f32_16x16x32_bf16 v[44:47], v[96:99], v[108:111], v[44:47]
    ds_read_b128 v[136:139], v11 offset:6144
    v_mfma_f32_16x16x32_bf16 v[60:63], v[100:103], v[108:111], v[60:63]
    s_add_u32 s50, s50, 1
    s_cmp_eq_u32 s50, 4
    v_mfma_f32_16x16x32_bf16 v[64:67], v[100:103], v[112:115], v[64:67]
    s_cselect_b32 s49, s29, s51
    s_cselect_b32 s50, 0, s50
    v_mfma_f32_16x16x32_bf16 v[68:71], v[100:103], v[116:119], v[68:71]
    v_add_u32 v10, s49, v10
    v_add_u32 v11, s49, v11
    v_mfma_f32_16x16x32_bf16 v[72:75], v[100:103], v[120:123], v[72:75]
    v_add_u32 v12, s49, v12
    v_add_u32 v13, s49, v13
    v_mfma_f32_16x16x32_bf16 v[88:91], v[104:107], v[120:123], v[88:91]
    v_add_u32 v14, s49, v14
    v_add_u32 v15, s49, v15
    v_mfma_f32_16x16x32_bf16 v[84:87], v[104:107], v[116:119], v[84:87]
    s_sub_u32 s48, s48, 1
    s_cmp_lg_u32 s48, 0
    v_mfma_f32_16x16x32_bf16 v[80:83], v[104:107], v[112:115], v[80:83]
    v_mfma_f32_16x16x32_bf16 v[76:79], v[104:107], v[108:111], v[76:79]
    s_waitcnt lgkmcnt(0)
    s_cbranch_scc1 g4_cloop
    v_mfma_f32_16x16x32_bf16 v[36:39], v[124:127], v[148:151], v[36:39]
    v_mfma_f32_16x16x32_bf16 v[52:55], v[128:131], v[148:151], v[52:55]
    v_mfma_f32_16x16x32_bf16 v[68:71], v[132:135], v[148:151], v[68:71]
    v_mfma_f32_16x16x32_bf16 v[84:87], v[136:139], v[148:151], v[84:87]
    v_mfma_f32_16x16x32_bf16 v[40:43], v[124:127], v[152:155], v[40:43]
    v_mfma_f32_16x16x32_bf16 v[56:59], v[128:131], v[152:155], v[56:59]
    v_mfma_f32_16x16x32_bf16 v[72:75], v[132:135], v[152:155], v[72:75]
    v_mfma_f32_16x16x32_bf16 v[88:91], v[136:139], v[152:155], v[88:91]
    v_mfma_f32_16x16x32_bf16 v[28:31], v[124:127], v[140:143], v[28:31]
    v_cvt_pk_bf16_f32 v156, v36, v37
    v_cvt_pk_bf16_f32 v157, v38, v39
    v_mfma_f32_16x16x32_bf16 v[44:47], v[128:131], v[140:143], v[44:47]
    v_cvt_pk_bf16_f32 v158, v52, v53
    v_cvt_pk_bf16_f32 v159, v54, v55
    buffer_store_dwordx4 v[156:159], v21, s[84:87], s93 offen offset:0 sc1
    v_mfma_f32_16x16x32_bf16 v[60:63], v[132:135], v[140:143], v[60:63]
    v_cvt_pk_bf16_f32 v160, v68, v69
    v_cvt_pk_bf16_f32 v161, v70, v71
    v_mfma_f32_16x16x32_bf16 v[76:79], v[136:139], v[140:143], v[76:79]
    v_cvt_pk_bf16_f32 v162, v84, v85
    v_cvt_pk_bf16_f32 v163, v86, v87
    buffer_store_dwordx4 v[160:163], v21, s[84:87], s93 offen offset:1024 sc1
    v_mfma_f32_16x16x32_bf16 v[32:35], v[124:127], v[144:147], v[32:35]
    v_cvt_pk_bf16_f32 v164, v40, v41
    v_cvt_pk_bf16_f32 v165, v42, v43
    v_mfma_f32_16x16x32_bf16 v[48:51], v[128:131], v[144:147], v[48:51]
    v_cvt_pk_bf16_f32 v166, v56, v57
    v_cvt_pk_bf16_f32 v167, v58, v59
    buffer_store_dwordx4 v[164:167], v21, s[84:87], s93 offen offset:2048 sc1
    v_mfma_f32_16x16x32_bf16 v[64:67], v[132:135], v[144:147], v[64:67]
    v_cvt_pk_bf16_f32 v168, v72, v73
    v_cvt_pk_bf16_f32 v169, v74, v75
    v_mfma_f32_16x16x32_bf16 v[80:83], v[136:139], v[144:147], v[80:83]
    s_nop 1
    v_cvt_pk_bf16_f32 v170, v88, v89
    v_cvt_pk_bf16_f32 v171, v90, v91
    buffer_store_dwordx4 v[168:171], v21, s[84:87], s93 offen offset:3072 sc1
    s_mov_b32 s48, 0x2000
    buffer_load_dwordx4 v[172:175], v21, s[84:87], s94 offen offset:0 sc1
    buffer_load_dwordx4 v[176:179], v21, s[84:87], s94 offen offset:1024 sc1
    buffer_load_dwordx4 v[180:183], v21, s[84:87], s94 offen offset:2048 sc1
    buffer_load_dwordx4 v[184:187], v21, s[84:87], s94 offen offset:3072 sc1
    s_waitcnt vmcnt(8)
    s_nop 3
    v_permlane16_swap_b32 v188, v190
    v_permlane16_swap_b32 v189, v191
    v_permlane16_swap_b32 v192, v194
    v_permlane16_swap_b32 v193, v195
    v_permlane16_swap_b32 v196, v198
    v_permlane16_swap_b32 v197, v199
    v_permlane16_swap_b32 v200, v202
    v_permlane16_swap_b32 v201, v203
    v_lshlrev_b32 v22, 16, v22
    v_lshlrev_b32 v23, 16, v23
    v_lshlrev_b32 v204, 16, v188
    v_and_b32 v205, 0xffff0000, v188
    v_lshlrev_b32 v206, 16, v189
    v_and_b32 v207, 0xffff0000, v189
    v_lshlrev_b32 v208, 16, v190
    v_and_b32 v209, 0xffff0000, v190
    v_lshlrev_b32 v210, 16, v191
    v_and_b32 v211, 0xffff0000, v191
    v_add_f32 v204, v204, v22
    v_add_f32 v205, v205, v22
    v_add_f32 v206, v206, v22
    v_add_f32 v207, v207, v22
    v_add_f32 v208, v208, v22
    v_add_f32 v209, v209, v22
    v_add_f32 v210, v210, v22
    v_add_f32 v211, v211, v22
    v_pk_add_f32 v[28:29], v[28:29], v[204:205]
    v_pk_add_f32 v[30:31], v[30:31], v[206:207]
    v_pk_add_f32 v[44:45], v[44:45], v[208:209]
    v_pk_add_f32 v[46:47], v[46:47], v[210:211]
    v_lshlrev_b32 v204, 16, v192
    v_and_b32 v205, 0xffff0000, v192
    v_lshlrev_b32 v206, 16, v193
    v_and_b32 v207, 0xffff0000, v193
    v_lshlrev_b32 v208, 16, v194
    v_and_b32 v209, 0xffff0000, v194
    v_lshlrev_b32 v210, 16, v195
    v_and_b32 v211, 0xffff0000, v195
    v_add_f32 v204, v204, v22
    v_add_f32 v205, v205, v22
    v_add_f32 v206, v206, v22
    v_add_f32 v207, v207, v22
    v_add_f32 v208, v208, v22
    v_add_f32 v209, v209, v22
    v_add_f32 v210, v210, v22
    v_add_f32 v211, v211, v22
    v_pk_add_f32 v[60:61], v[60:61], v[204:205]
    v_pk_add_f32 v[62:63], v[62:63], v[206:207]
    v_pk_add_f32 v[76:77], v[76:77], v[208:209]
    v_pk_add_f32 v[78:79], v[78:79], v[210:211]
    v_lshlrev_b32 v204, 16, v196
    v_and_b32 v205, 0xffff0000, v196
    v_lshlrev_b32 v206, 16, v197
    v_and_b32 v207, 0xffff0000, v197
    v_lshlrev_b32 v208, 16, v198
    v_and_b32 v209, 0xffff0000, v198
    v_lshlrev_b32 v210, 16, v199
    v_and_b32 v211, 0xffff0000, v199
    v_add_f32 v204, v204, v23
    v_add_f32 v205, v205, v23
    v_add_f32 v206, v206, v23
    v_add_f32 v207, v207, v23
    v_add_f32 v208, v208, v23
    v_add_f32 v209, v209, v23
    v_add_f32 v210, v210, v23
    v_add_f32 v211, v211, v23
    v_pk_add_f32 v[32:33], v[32:33], v[204:205]
    v_pk_add_f32 v[34:35], v[34:35], v[206:207]
    v_pk_add_f32 v[48:49], v[48:49], v[208:209]
    v_pk_add_f32 v[50:51], v[50:51], v[210:211]
    v_lshlrev_b32 v204, 16, v200
    v_and_b32 v205, 0xffff0000, v200
    v_lshlrev_b32 v206, 16, v201
    v_and_b32 v207, 0xffff0000, v201
    v_lshlrev_b32 v208, 16, v202
    v_and_b32 v209, 0xffff0000, v202
    v_lshlrev_b32 v210, 16, v203
    v_and_b32 v211, 0xffff0000, v203
    v_add_f32 v204, v204, v23
    v_add_f32 v205, v205, v23
    v_add_f32 v206, v206, v23
    v_add_f32 v207, v207, v23
    v_add_f32 v208, v208, v23
    v_add_f32 v209, v209, v23
    v_add_f32 v210, v210, v23
    v_add_f32 v211, v211, v23
    v_pk_add_f32 v[64:65], v[64:65], v[204:205]
    v_pk_add_f32 v[66:67], v[66:67], v[206:207]
    v_pk_add_f32 v[80:81], v[80:81], v[208:209]
    v_pk_add_f32 v[82:83], v[82:83], v[210:211]
    s_waitcnt vmcnt(0)
g4_rcv:
    v_max3_u32 v4, v172, v173, v174
    v_max3_u32 v4, v4, v175, v176
    v_max3_u32 v4, v4, v177, v178
    v_max3_u32 v4, v4, v179, v180
    v_max3_u32 v4, v4, v181, v182
    v_max3_u32 v4, v4, v183, v184
    v_max3_u32 v4, v4, v185, v186
    v_max_u32 v4, v4, v187
    v_cmp_eq_u32 vcc, -1, v4
    s_sub_u32 s48, s48, 1
    s_cmp_eq_u32 s48, 0
    s_cbranch_scc1 g4_rcvd
    s_cbranch_vccz g4_rcvd
    s_sleep 2
    buffer_load_dwordx4 v[172:175], v21, s[84:87], s94 offen offset:0 sc1
    buffer_load_dwordx4 v[176:179], v21, s[84:87], s94 offen offset:1024 sc1
    buffer_load_dwordx4 v[180:183], v21, s[84:87], s94 offen offset:2048 sc1
    buffer_load_dwordx4 v[184:187], v21, s[84:87], s94 offen offset:3072 sc1
    s_waitcnt vmcnt(0)
    s_branch g4_rcv
g4_rcvd:
    v_lshlrev_b32 v108, 16, v172
    v_and_b32 v109, 0xffff0000, v172
    v_lshlrev_b32 v110, 16, v173
    v_and_b32 v111, 0xffff0000, v173
    v_pk_add_f32 v[28:29], v[28:29], v[108:109]
    v_pk_add_f32 v[30:31], v[30:31], v[110:111]
    v_lshlrev_b32 v112, 16, v174
    v_and_b32 v113, 0xffff0000, v174
    v_lshlrev_b32 v114, 16, v175
    v_and_b32 v115, 0xffff0000, v175
    v_pk_add_f32 v[44:45], v[44:45], v[112:113]
    v_pk_add_f32 v[46:47], v[46:47], v[114:115]
    v_lshlrev_b32 v116, 16, v176
    v_and_b32 v117, 0xffff0000, v176
    v_lshlrev_b32 v118, 16, v177
    v_and_b32 v119, 0xffff0000, v177
    v_pk_add_f32 v[60:61], v[60:61], v[116:117]
    v_pk_add_f32 v[62:63], v[62:63], v[118:119]
    v_lshlrev_b32 v120, 16, v178
    v_and_b32 v121, 0xffff0000, v178
    v_lshlrev_b32 v122, 16, v179
    v_and_b32 v123, 0xffff0000, v179
    v_pk_add_f32 v[76:77], v[76:77], v[120:121]
    v_pk_add_f32 v[78:79], v[78:79], v[122:123]
    v_lshlrev_b32 v108, 16, v180
    v_and_b32 v109, 0xffff0000, v180
    v_lshlrev_b32 v110, 16, v181
    v_and_b32 v111, 0xffff0000, v181
    v_pk_add_f32 v[32:33], v[32:33], v[108:109]
    v_pk_add_f32 v[34:35], v[34:35], v[110:111]
    v_lshlrev_b32 v112, 16, v182
    v_and_b32 v113, 0xffff0000, v182
    v_lshlrev_b32 v114, 16, v183
    v_and_b32 v115, 0xffff0000, v183
    v_pk_add_f32 v[48:49], v[48:49], v[112:113]
    v_pk_add_f32 v[50:51], v[50:51], v[114:115]
    v_lshlrev_b32 v116, 16, v184
    v_and_b32 v117, 0xffff0000, v184
    v_lshlrev_b32 v118, 16, v185
    v_and_b32 v119, 0xffff0000, v185
    v_pk_add_f32 v[64:65], v[64:65], v[116:117]
    v_pk_add_f32 v[66:67], v[66:67], v[118:119]
    v_lshlrev_b32 v120, 16, v186
    v_and_b32 v121, 0xffff0000, v186
    v_lshlrev_b32 v122, 16, v187
    v_and_b32 v123, 0xffff0000, v187
    v_pk_add_f32 v[80:81], v[80:81], v[120:121]
    v_pk_add_f32 v[82:83], v[82:83], v[122:123]
    v_cvt_pk_bf16_f32 v92, v28, v29
    v_cvt_pk_bf16_f32 v93, v30, v31
    v_cvt_pk_bf16_f32 v94, v44, v45
    v_cvt_pk_bf16_f32 v95, v46, v47
    s_nop 1
    v_permlane16_swap_b32 v92, v94
    v_permlane16_swap_b32 v93, v95
    buffer_store_dwordx4 v[92:95], v9, s[16:19], s52 offen offset:0 sc1
    v_cvt_pk_bf16_f32 v96, v60, v61
    v_cvt_pk_bf16_f32 v97, v62, v63
    v_cvt_pk_bf16_f32 v98, v76, v77
    v_cvt_pk_bf16_f32 v99, v78, v79
    s_nop 1
    v_permlane16_swap_b32 v96, v98
    v_permlane16_swap_b32 v97, v99
    buffer_store_dwordx4 v[96:99], v9, s[16:19], s52 offen offset:64 sc1
    v_cvt_pk_bf16_f32 v100, v32, v33
    v_cvt_pk_bf16_f32 v101, v34, v35
    v_cvt_pk_bf16_f32 v102, v48, v49
    v_cvt_pk_bf16_f32 v103, v50, v51
    s_nop 1
    v_permlane16_swap_b32 v100, v102
    v_permlane16_swap_b32 v101, v103
    buffer_store_dwordx4 v[100:103], v9, s[16:19], s53 offen offset:0 sc1
    v_cvt_pk_bf16_f32 v104, v64, v65
    v_cvt_pk_bf16_f32 v105, v66, v67
    v_cvt_pk_bf16_f32 v106, v80, v81
    v_cvt_pk_bf16_f32 v107, v82, v83
    s_nop 1
    v_permlane16_swap_b32 v104, v106
    v_permlane16_swap_b32 v105, v107
    buffer_store_dwordx4 v[104:107], v9, s[16:19], s53 offen offset:64 sc1
    v_pk_add_f32 v[108:109], v[28:29], v[30:31]
    v_pk_mul_f32 v[110:111], v[28:29], v[28:29]
    v_pk_fma_f32 v[110:111], v[30:31], v[30:31], v[110:111]
    v_pk_add_f32 v[108:109], v[108:109], v[44:45]
    v_pk_fma_f32 v[110:111], v[44:45], v[44:45], v[110:111]
    v_pk_add_f32 v[108:109], v[108:109], v[46:47]
    v_pk_fma_f32 v[110:111], v[46:47], v[46:47], v[110:111]
    v_pk_add_f32 v[108:109], v[108:109], v[60:61]
    v_pk_fma_f32 v[110:111], v[60:61], v[60:61], v[110:111]
    v_pk_add_f32 v[108:109], v[108:109], v[62:63]
    v_pk_fma_f32 v[110:111], v[62:63], v[62:63], v[110:111]
    v_pk_add_f32 v[108:109], v[108:109], v[76:77]
    v_pk_fma_f32 v[110:111], v[76:77], v[76:77], v[110:111]
    v_pk_add_f32 v[108:109], v[108:109], v[78:79]
    v_pk_fma_f32 v[110:111], v[78:79], v[78:79], v[110:111]
    v_pk_add_f32 v[112:113], v[32:33], v[34:35]
    v_pk_mul_f32 v[114:115], v[32:33], v[32:33]
    v_pk_fma_f32 v[114:115], v[34:35], v[34:35], v[114:115]
    v_pk_add_f32 v[112:113], v[112:113], v[48:49]
    v_pk_fma_f32 v[114:115], v[48:49], v[48:49], v[114:115]
    v_pk_add_f32 v[112:113], v[112:113], v[50:51]
    v_pk_fma_f32 v[114:115], v[50:51], v[50:51], v[114:115]
    v_pk_add_f32 v[112:113], v[112:113], v[64:65]
    v_pk_fma_f32 v[114:115], v[64:65], v[64:65], v[114:115]
    v_pk_add_f32 v[112:113], v[112:113], v[66:67]
    v_pk_fma_f32 v[114:115], v[66:67], v[66:67], v[114:115]
    v_pk_add_f32 v[112:113], v[112:113], v[80:81]
    v_pk_fma_f32 v[114:115], v[80:81], v[80:81], v[114:115]
    v_pk_add_f32 v[112:113], v[112:113], v[82:83]
    v_pk_fma_f32 v[114:115], v[82:83], v[82:83], v[114:115]
    v_add_f32 v108, v108, v109
    v_add_f32 v109, v110, v111
    v_add_f32 v112, v112, v113
    v_add_f32 v113, v114, v115
    s_nop 1
    v_permlane16_swap_b32 v108, v112
    v_permlane16_swap_b32 v109, v113
    v_pk_add_f32 v[108:109], v[108:109], v[112:113]
    v_mov_b32 v116, v108
    v_mov_b32 v117, v109
    v_and_b32 v3, 16, v2
    v_add_u32 v3, v3, v20
    v_permlane32_swap_b32 v108, v116
    v_permlane32_swap_b32 v109, v117
    v_pk_add_f32 v[108:109], v[108:109], v[116:117]
    v_lshlrev_b32 v3, 3, v3
    s_mul_i32 s40, s24, 2
    s_add_u32 s40, s40, s44
    s_lshl_b32 s40, s40, 14
    s_mov_b32 exec_hi, 0
    buffer_store_dwordx2 v[108:109], v3, s[60:63], s40 offen sc1
    s_mov_b32 exec_hi, -1
    s_cmp_lg_u32 s96, 0
    s_cbranch_scc1 g4_done
    s_lshr_b32 s40, s25, 0
    s_add_u32 s40, s40, 40
    s_lshl_b32 s40, s40, 8
    s_mov_b32 s42, s40
    s_add_u32 s84, s4, 0x2b00000
    s_addc_u32 s85, s5, 0
    s_mov_b32 s86, 0x4000
    s_mov_b32 s87, 0x20000
    v_mov_b32 v3, s40
    v_mov_b32 v4, 1
    s_waitcnt vmcnt(0)
    s_barrier
    s_cmp_lg_u32 s28, 0
    s_cbranch_scc1 g4_cin
    s_mov_b64 exec, 1
    buffer_atomic_add v4, v3, s[84:87], 0 offen sc1
    s_mov_b64 exec, -1
g4_cin:
    s_mov_b32 s96, 1
    s_mov_b32 s97, 0x2800000
    s_branch g1_in
code_end:
.section .rodata,"a"
.p2align 6
.amdhsa_kernel g1a_kernel
  .amdhsa_next_free_vgpr 248
  .amdhsa_next_free_sgpr 100
  .amdhsa_accum_offset 248
  .amdhsa_group_segment_fixed_size 0
  .amdhsa_kernarg_size 88
  .amdhsa_user_sgpr_count 2
  .amdhsa_user_sgpr_kernarg_segment_ptr 1
  .amdhsa_system_sgpr_workgroup_id_x 1
.end_amdhsa_kernel
```

```asm
; @launch kernel=g1a_kernel grid=(256,1,1) block=(512,1,1) lds=131328
.amdgcn_target "amdgcn-amd-amdhsa--gfx950"
.text
.globl g1a_kernel
.p2align 8
.type g1a_kernel,@function
g1a_kernel:
    s_mov_b32 s96, 0
    s_mov_b32 s97, 0x0
    v_mov_b32 v1, 131072
    v_mov_b32 v2, 0
    ds_write_b32 v1, v2
    s_branch g1_in
.p2align 6
g1_in:
    s_cmp_ge_u32 s2, 256
    s_cbranch_scc1 g1_done
    s_load_dwordx2 s[4:5], s[0:1], 80
    s_load_dwordx2 s[6:7], s[0:1], 0
    s_xor_b32 s53, s96, 1
    s_load_dwordx2 s[30:31], s[0:1], 8
    s_load_dwordx2 s[16:17], s[0:1], 72
    s_load_dwordx2 s[18:19], s[0:1], 16
    v_lshrrev_b32 v1, 6, v0
    v_and_b32 v2, 63, v0
    s_and_b32 s40, s2, 1
    s_lshl_b32 s40, s40, 3
    s_bfe_u32 s41, s2, 0x30003
    s_add_u32 s25, s40, s41
    s_bfe_u32 s40, s2, 0x20001
    s_lshl_b32 s40, s40, 2
    s_lshr_b32 s42, s2, 6
    s_add_u32 s24, s40, s42
    s_add_u32 s27, s41, s42
    s_add_u32 s52, s24, s25
    s_and_b32 s52, s52, 15
    s_and_b32 s26, s52, 12
    s_mul_i32 s26, s26, s53
    v_readfirstlane_b32 s28, v1
    v_lshrrev_b32 v5, 4, v2
    v_bfe_u32 v6, v2, 2, 2
    v_and_b32 v7, 3, v2
    v_and_b32 v8, 15, v2
    s_cmp_lt_u32 s28, 4
    s_cbranch_scc1 g1_compute
    s_sub_u32 s28, s28, 4
    s_mov_b32 s40, 2048
    v_lshrrev_b32 v3, 3, v2
    v_mul_lo_u32 v3, v3, s40
    v_lshrrev_b32 v4, 4, v2
    v_xor_b32 v4, v4, v2
    v_and_b32 v4, 7, v4
    v_lshl_add_u32 v3, v4, 4, v3
    s_mul_i32 s41, s25, 262144
    s_mul_i32 s42, s28, 65536
    s_add_u32 s41, s41, s42
    v_xor_b32 v4, 64, v3
    s_add_u32 s42, s41, 0
    v_add_u32 v16, s42, v3
    s_add_u32 s42, s41, 16384
    v_add_u32 v17, s42, v4
    s_add_u32 s42, s41, 32768
    v_add_u32 v18, s42, v3
    s_add_u32 s42, s41, 49152
    v_add_u32 v19, s42, v4
    s_mov_b32 s40, 6144
    v_lshrrev_b32 v3, 3, v2
    v_mul_lo_u32 v3, v3, s40
    v_bfe_u32 v4, v2, 4, 1
    v_lshlrev_b32 v4, 1, v4
    v_xor_b32 v4, v4, v2
    v_and_b32 v4, 7, v4
    v_lshl_add_u32 v3, v4, 4, v3
    s_mul_i32 s41, s24, 128
    s_mul_i32 s42, s28, 98304
    s_add_u32 s41, s41, s42
    v_xor_b32 v4, 64, v3
    s_add_u32 s42, s41, 0
    v_add_u32 v10, s42, v3
    s_add_u32 s42, s41, 49152
    v_add_u32 v11, s42, v4
    s_mov_b32 s40, 6144
    v_lshrrev_b32 v3, 3, v2
    v_mul_lo_u32 v3, v3, s40
    v_bfe_u32 v4, v2, 4, 1
    v_lshlrev_b32 v4, 1, v4
    v_xor_b32 v4, v4, v2
    v_and_b32 v4, 7, v4
    v_lshl_add_u32 v3, v4, 4, v3
    s_mul_i32 s41, s24, 128
    s_mul_i32 s42, s28, 98304
    s_add_u32 s41, s41, s42
    v_xor_b32 v4, 64, v3
    s_add_u32 s42, s41, 2048
    v_add_u32 v12, s42, v3
    s_add_u32 s42, s41, 51200
    v_add_u32 v13, s42, v4
    s_mov_b32 s40, 6144
    v_lshrrev_b32 v3, 3, v2
    v_mul_lo_u32 v3, v3, s40
    v_bfe_u32 v4, v2, 4, 1
    v_lshlrev_b32 v4, 1, v4
    v_xor_b32 v4, v4, v2
    v_and_b32 v4, 7, v4
    v_lshl_add_u32 v3, v4, 4, v3
    s_mul_i32 s41, s24, 128
    s_mul_i32 s42, s28, 98304
    s_add_u32 s41, s41, s42
    v_xor_b32 v4, 64, v3
    s_add_u32 s42, s41, 4096
    v_add_u32 v14, s42, v3
    s_add_u32 s42, s41, 53248
    v_add_u32 v15, s42, v4
    v_lshrrev_b32 v3, 3, v2
    s_lshl_b32 s40, s28, 2
    v_add_u32 v3, s40, v3
    v_lshrrev_b32 v4, 1, v3
    v_xor_b32 v4, v4, v2
    v_and_b32 v4, 7, v4
    s_lshl_b32 s40, s25, 7
    s_sub_u32 s40, s40, 16
    v_add_u32 v3, s40, v3
    v_max_i32 v3, 0, v3
    v_lshlrev_b32 v3, 11, v3
    v_lshl_add_u32 v20, v4, 4, v3
    s_mul_i32 s36, s28, 2048
    s_mul_i32 s37, s28, 4096
    s_add_u32 s37, s37, 26624
    s_mul_i32 s46, s28, 512
    s_add_u32 s46, s46, 24576
    s_waitcnt lgkmcnt(0)
    s_mov_b32 s8, s30
    s_mov_b32 s9, s31
    s_mov_b32 s10, 0x600000
    s_mov_b32 s11, 0x20000
    s_add_u32 s56, s4, 0x100000
    s_addc_u32 s57, s5, 0
    s_mov_b32 s58, 0x30000
    s_mov_b32 s59, 0x20000
    s_add_u32 s4, s4, s97
    s_addc_u32 s5, s5, 0
    s_add_u32 s12, s4, 0x1900000
    s_addc_u32 s13, s5, 0
    s_cmp_eq_u32 s96, 1
    s_cselect_b32 s12, s12, s6
    s_cselect_b32 s13, s13, s7
    s_mov_b32 s14, 0x400000
    s_mov_b32 s15, 0x20000
    s_mov_b32 s20, s4
    s_mov_b32 s21, s5
    s_mov_b32 s22, 0x40000
    s_mov_b32 s23, 0x20000
    s_mov_b32 s60, s16
    s_mov_b32 s61, s17
    s_mov_b32 s62, 0x100
    s_mov_b32 s63, 0x20000
    s_sub_u32 s40, s52, s27
    s_and_b32 s40, s40, 1
    s_and_b32 s41, s52, 2
    s_or_b32 s40, s40, s41
    s_add_u32 s54, s40, 2
    s_cmp_eq_u32 s53, 0
    s_cselect_b32 s54, 0x7fff, s54
    s_add_u32 s55, s54, 3
    s_cmp_lg_u32 s28, 0
    s_cselect_b32 s55, 0x7fff, s55
    s_cmp_lt_u32 s55, 0x7fff
    s_cselect_b32 s29, 12, 0x7fff
    s_add_u32 s50, s29, 1
    s_mov_b32 s51, 14
    s_mov_b32 s32, 0
    s_mov_b32 s33, 0
g1_ld_pW:
    s_add_u32 s40, s32, s27
    s_and_b32 s40, s40, 1
    s_andn2_b32 s41, s32, 1
    s_or_b32 s40, s40, s41
    s_add_u32 s40, s40, s26
    s_and_b32 s40, s40, 15
    s_mul_i32 s34, s40, 393216
    s_mul_i32 s35, s40, 128
    s_add_u32 s38, s33, s36
    s_add_u32 s39, s33, s37
    s_add_u32 m0, s38, 0
    s_nop 0
    buffer_load_dwordx4 v10, s[8:11], s34 offen lds
    s_add_u32 m0, s38, 1024
    s_nop 0
    buffer_load_dwordx4 v11, s[8:11], s34 offen lds
    s_add_u32 m0, s38, 8192
    s_nop 0
    buffer_load_dwordx4 v12, s[8:11], s34 offen lds
    s_add_u32 m0, s38, 9216
    s_nop 0
    buffer_load_dwordx4 v13, s[8:11], s34 offen lds
    s_add_u32 m0, s38, 16384
    s_nop 0
    buffer_load_dwordx4 v14, s[8:11], s34 offen lds
    s_add_u32 m0, s38, 17408
    s_nop 0
    buffer_load_dwordx4 v15, s[8:11], s34 offen lds
    s_add_u32 s33, s33, 43008
    s_add_u32 s32, s32, 1
    s_cmp_lt_u32 s32, 2
    s_cbranch_scc1 g1_ld_pW
    s_cmp_eq_u32 s96, 0
    s_cbranch_scc1 g1_dep_ok
    s_add_u32 s40, s25, 40
    s_lshl_b32 s40, s40, 8
    s_sub_u32 s42, s40, 256
    s_max_u32 s42, s42, 10240
    s_cmp_lg_u32 s28, 0
    s_cbranch_scc1 g1_dep_set
    s_add_u32 s84, s4, 0x300000
    s_addc_u32 s85, s5, 0
    s_mov_b32 s86, 0x4000
    s_mov_b32 s87, 0x20000
    v_cmp_eq_u32 vcc, 1, v2
    v_mov_b32 v21, s40
    v_mov_b32 v23, s42
    v_cndmask_b32 v21, v21, v23, vcc
    v_mov_b32 v22, 16
    v_mov_b32 v23, 16
    v_cndmask_b32 v22, v22, v23, vcc
    buffer_load_dword v23, v21, s[84:87], 0 offen sc1
g1_dep_set:
    s_lshl_b32 s43, s96, 2
    s_add_u32 s43, s43, 1
    s_mov_b32 s41, 0x80000
    v_mov_b32 v24, 131072
    s_cmp_lg_u32 s28, 0
    s_cbranch_scc1 g1_dep_lds
    s_mov_b32 s41, 0x8000
    s_waitcnt vmcnt(0)
g1_dep:
    v_cmp_lt_u32 vcc, v23, v22
    s_sub_u32 s41, s41, 1
    s_cmp_eq_u32 s41, 0
    s_cbranch_scc1 g1_dep_seen
    s_cbranch_vccz g1_dep_seen
    s_sleep 2
    buffer_load_dword v23, v21, s[84:87], 0 offen sc1
    s_waitcnt vmcnt(0)
    s_branch g1_dep
g1_dep_seen:
    v_mov_b32 v23, s43
    ds_write_b32 v24, v23
    s_branch g1_dep_ok
g1_dep_lds:
    ds_read_b32 v23, v24
    s_sub_u32 s41, s41, 1
    s_waitcnt lgkmcnt(0)
    v_readfirstlane_b32 s40, v23
    s_cmp_eq_u32 s41, 0
    s_cbranch_scc1 g1_dep_ok
    s_cmp_eq_u32 s40, s43
    s_cbranch_scc1 g1_dep_ok
    s_sleep 1
    s_branch g1_dep_lds
g1_dep_ok:
    s_mov_b32 s32, 0
    s_mov_b32 s33, 0
g1_ld_pA:
    s_add_u32 s40, s32, s27
    s_and_b32 s40, s40, 1
    s_andn2_b32 s41, s32, 1
    s_or_b32 s40, s40, s41
    s_add_u32 s40, s40, s26
    s_and_b32 s40, s40, 15
    s_mul_i32 s34, s40, 393216
    s_mul_i32 s35, s40, 128
    s_add_u32 s38, s33, s36
    s_add_u32 s39, s33, s37
    s_add_u32 m0, s39, 0
    s_nop 0
    buffer_load_dwordx4 v16, s[12:15], s35 offen sc1 lds
    s_add_u32 m0, s39, 1024
    s_nop 0
    buffer_load_dwordx4 v17, s[12:15], s35 offen sc1 lds
    s_add_u32 m0, s39, 2048
    s_nop 0
    buffer_load_dwordx4 v18, s[12:15], s35 offen sc1 lds
    s_add_u32 m0, s39, 3072
    s_nop 0
    buffer_load_dwordx4 v19, s[12:15], s35 offen sc1 lds
    s_add_u32 m0, s33, s46
    s_mov_b32 exec_hi, 0
    buffer_load_dwordx4 v20, s[12:15], s35 offen sc1 lds
    s_mov_b32 exec_hi, -1
    s_add_u32 s33, s33, 43008
    s_add_u32 s32, s32, 1
    s_cmp_lt_u32 s32, 2
    s_cbranch_scc1 g1_ld_pA
    s_waitcnt vmcnt(5)
    s_branch g1_ld_bar
g1_ld_loop:
    s_sub_u32 s40, s32, s54
    s_sub_u32 s40, s40, 1
    s_cmp_lt_u32 s40, 2
    s_cbranch_scc1 g1_ld_w0
    s_sub_u32 s40, s32, s55
    s_sub_u32 s40, s40, 1
    s_cmp_lt_u32 s40, 2
    s_cbranch_scc1 g1_ld_w1
    s_sub_u32 s40, s32, s29
    s_sub_u32 s40, s40, 1
    s_cmp_lt_u32 s40, 2
    s_cbranch_scc1 g1_ld_w2
    s_sub_u32 s40, s32, s51
    s_sub_u32 s40, s40, 1
    s_cmp_lt_u32 s40, 2
    s_cbranch_scc1 g1_ld_w4
    s_waitcnt vmcnt(11)
g1_ld_bar:
    s_barrier
    s_add_u32 s40, s32, s27
    s_and_b32 s40, s40, 1
    s_andn2_b32 s41, s32, 1
    s_or_b32 s40, s40, s41
    s_add_u32 s40, s40, s26
    s_and_b32 s40, s40, 15
    s_mul_i32 s34, s40, 393216
    s_mul_i32 s35, s40, 128
    s_add_u32 s38, s33, s36
    s_add_u32 s39, s33, s37
    s_add_u32 m0, s39, 0
    s_nop 0
    buffer_load_dwordx4 v16, s[12:15], s35 offen sc1 lds
    s_add_u32 m0, s39, 1024
    s_nop 0
    buffer_load_dwordx4 v17, s[12:15], s35 offen sc1 lds
    s_add_u32 m0, s39, 2048
    s_nop 0
    buffer_load_dwordx4 v18, s[12:15], s35 offen sc1 lds
    s_add_u32 m0, s39, 3072
    s_nop 0
    buffer_load_dwordx4 v19, s[12:15], s35 offen sc1 lds
    s_add_u32 m0, s38, 0
    s_nop 0
    buffer_load_dwordx4 v10, s[8:11], s34 offen lds
    s_add_u32 m0, s38, 1024
    s_nop 0
    buffer_load_dwordx4 v11, s[8:11], s34 offen lds
    s_add_u32 m0, s38, 8192
    s_nop 0
    buffer_load_dwordx4 v12, s[8:11], s34 offen lds
    s_add_u32 m0, s38, 9216
    s_nop 0
    buffer_load_dwordx4 v13, s[8:11], s34 offen lds
    s_add_u32 m0, s38, 16384
    s_nop 0
    buffer_load_dwordx4 v14, s[8:11], s34 offen lds
    s_add_u32 m0, s38, 17408
    s_nop 0
    buffer_load_dwordx4 v15, s[8:11], s34 offen lds
    s_add_u32 m0, s33, s46
    s_mov_b32 exec_hi, 0
    buffer_load_dwordx4 v20, s[12:15], s35 offen sc1 lds
    s_mov_b32 exec_hi, -1
    s_cmp_eq_u32 s32, s54
    s_cbranch_scc1 g1_ld_h0
g1_ld_c0:
    s_cmp_eq_u32 s32, s55
    s_cbranch_scc1 g1_ld_h1
g1_ld_c1:
    s_cmp_eq_u32 s32, s29
    s_cbranch_scc1 g1_ld_h2
g1_ld_c2:
    s_cmp_eq_u32 s32, s50
    s_cbranch_scc1 g1_ld_h3
g1_ld_c3:
    s_cmp_eq_u32 s32, s51
    s_cbranch_scc1 g1_ld_h4
g1_ld_c4:
    s_add_u32 s33, s33, 43008
    s_add_u32 s32, s32, 1
    s_cmp_eq_u32 s33, 129024
    s_cselect_b32 s33, 0, s33
    s_cmp_lt_u32 s32, 16
    s_cbranch_scc1 g1_ld_loop
    s_waitcnt vmcnt(43)
    s_barrier
    s_waitcnt vmcnt(0)
    v_pk_add_f32 v[24:25], v[24:25], v[40:41]
    v_add_f32 v56, v56, v64
    v_pk_add_f32 v[26:27], v[26:27], v[42:43]
    v_add_f32 v57, v57, v65
    v_pk_add_f32 v[28:29], v[28:29], v[44:45]
    v_add_f32 v58, v58, v66
    v_pk_add_f32 v[30:31], v[30:31], v[46:47]
    v_add_f32 v59, v59, v67
    v_pk_add_f32 v[32:33], v[32:33], v[48:49]
    v_add_f32 v60, v60, v68
    v_pk_add_f32 v[34:35], v[34:35], v[50:51]
    v_add_f32 v61, v61, v69
    v_pk_add_f32 v[36:37], v[36:37], v[52:53]
    v_add_f32 v62, v62, v70
    v_pk_add_f32 v[38:39], v[38:39], v[54:55]
    v_add_f32 v63, v63, v71
    v_pk_add_f32 v[24:25], v[24:25], v[32:33]
    v_add_f32 v56, v56, v60
    v_pk_add_f32 v[26:27], v[26:27], v[34:35]
    v_add_f32 v57, v57, v61
    v_pk_add_f32 v[28:29], v[28:29], v[36:37]
    v_add_f32 v58, v58, v62
    v_pk_add_f32 v[30:31], v[30:31], v[38:39]
    v_add_f32 v59, v59, v63
    v_pk_add_f32 v[24:25], v[24:25], v[28:29]
    v_add_f32 v56, v56, v58
    v_pk_add_f32 v[26:27], v[26:27], v[30:31]
    v_add_f32 v57, v57, v59
    v_pk_add_f32 v[24:25], v[24:25], v[26:27]
    v_add_f32 v56, v56, v57
    v_mul_f32 v24, 0x3a800000, v24
    v_mul_f32 v25, 0x3a800000, v25
    v_fma_f32 v25, -v24, v24, v25
    v_max_f32 v25, 0, v25
    v_cvt_pk_bf16_f32 v24, v24, v24
    v_lshlrev_b32 v24, 16, v24
    v_cvt_pk_bf16_f32 v25, v25, v25
    v_lshlrev_b32 v25, 16, v25
    v_add_f32 v25, 0x3727c5ac, v25
    v_cvt_pk_bf16_f32 v25, v25, v25
    v_lshlrev_b32 v25, 16, v25
    v_sqrt_f32 v25, v25
    s_nop 0
    v_cvt_pk_bf16_f32 v25, v25, v25
    v_lshlrev_b32 v25, 16, v25
    v_rcp_f32 v26, v25
    v_lshlrev_b32 v3, 3, v21
    v_lshlrev_b32 v4, 2, v21
    v_mul_f32 v27, -v24, v26
    v_cmp_gt_u32 vcc, 144, v21
    s_and_saveexec_b64 s[40:41], vcc
    v_add_u32 v3, 129024, v3
    ds_write_b64 v3, v[26:27]
    s_mov_b64 exec, s[40:41]
    v_cmp_gt_u32 vcc, 192, v21
    s_and_saveexec_b64 s[40:41], vcc
    v_add_u32 v4, 130304, v4
    ds_write_b32 v4, v56
    s_mov_b64 exec, s[40:41]
    s_waitcnt lgkmcnt(0)
    s_barrier
    s_add_u32 s20, s4, 0x200000
    s_addc_u32 s21, s5, 0
    s_mov_b32 s22, 0x40000
    s_mov_b32 s23, 0x20000
    s_lshl_b32 s40, s24, 4
    s_add_u32 s40, s40, s25
    s_lshl_b32 s40, s40, 10
    s_lshl_b32 s41, s28, 8
    s_add_u32 s40, s40, s41
    v_lshlrev_b32 v3, 2, v2
    v_mov_b32 v4, -1
    buffer_store_dword v4, v3, s[20:23], s40 offen sc1
    s_cmp_eq_u32 s53, 0
    s_cbranch_scc1 g1_nopf
    s_mov_b32 s20, s18
    s_mov_b32 s21, s19
    s_mov_b32 s22, 0x200000
    s_mov_b32 s23, 0x20000
    s_lshl_b32 s40, s2, 13
    s_lshl_b32 s41, s28, 11
    s_add_u32 s40, s40, s41
    v_lshlrev_b32 v3, 4, v2
    buffer_load_dwordx4 v[120:123], v3, s[20:23], s40 offen
    buffer_load_dwordx4 v[120:123], v3, s[20:23], s40 offen offset:1024
g1_nopf:
    s_branch g1_ld_end
g1_ld_w0:
    s_waitcnt vmcnt(16)
    s_branch g1_ld_bar
g1_ld_h0:
    s_add_u32 s44, s33, 43008
    s_cmp_eq_u32 s44, 129024
    s_cselect_b32 s44, 0, s44
    s_mul_i32 s42, s28, 3
    s_add_u32 s42, s42, 0
    s_lshr_b32 s43, s42, 2
    s_lshl_b32 s43, s43, 13
    s_add_u32 s43, s43, s44
    s_and_b32 s42, s42, 3
    v_and_b32 v3, 1, v5
    v_lshlrev_b32 v3, 1, v3
    v_lshrrev_b32 v4, 1, v6
    v_or_b32 v3, v3, v4
    s_add_u32 s40, s42, 0
    v_xor_b32 v3, s40, v3
    v_lshlrev_b32 v3, 5, v3
    v_lshl_add_u32 v3, v7, 3, v3
    v_lshl_add_u32 v4, v5, 3, v6
    v_lshl_add_u32 v3, v4, 7, v3
    v_add_u32 v21, s43, v3
    ds_read_b64_tr_b16 v[24:25], v21 offset:0
    ds_read_b64_tr_b16 v[26:27], v21 offset:512
    ds_read_b64_tr_b16 v[28:29], v21 offset:4096
    ds_read_b64_tr_b16 v[30:31], v21 offset:4608
    s_mul_i32 s42, s28, 3
    s_add_u32 s42, s42, 1
    s_lshr_b32 s43, s42, 2
    s_lshl_b32 s43, s43, 13
    s_add_u32 s43, s43, s44
    s_and_b32 s42, s42, 3
    v_and_b32 v3, 1, v5
    v_lshlrev_b32 v3, 1, v3
    v_lshrrev_b32 v4, 1, v6
    v_or_b32 v3, v3, v4
    s_add_u32 s40, s42, 0
    v_xor_b32 v3, s40, v3
    v_lshlrev_b32 v3, 5, v3
    v_lshl_add_u32 v3, v7, 3, v3
    v_lshl_add_u32 v4, v5, 3, v6
    v_lshl_add_u32 v3, v4, 7, v3
    v_add_u32 v21, s43, v3
    ds_read_b64_tr_b16 v[32:33], v21 offset:0
    ds_read_b64_tr_b16 v[34:35], v21 offset:512
    ds_read_b64_tr_b16 v[36:37], v21 offset:4096
    ds_read_b64_tr_b16 v[38:39], v21 offset:4608
    s_mul_i32 s42, s28, 3
    s_add_u32 s42, s42, 2
    s_lshr_b32 s43, s42, 2
    s_lshl_b32 s43, s43, 13
    s_add_u32 s43, s43, s44
    s_and_b32 s42, s42, 3
    v_and_b32 v3, 1, v5
    v_lshlrev_b32 v3, 1, v3
    v_lshrrev_b32 v4, 1, v6
    v_or_b32 v3, v3, v4
    s_add_u32 s40, s42, 0
    v_xor_b32 v3, s40, v3
    v_lshlrev_b32 v3, 5, v3
    v_lshl_add_u32 v3, v7, 3, v3
    v_lshl_add_u32 v4, v5, 3, v6
    v_lshl_add_u32 v3, v4, 7, v3
    v_add_u32 v21, s43, v3
    ds_read_b64_tr_b16 v[40:41], v21 offset:0
    ds_read_b64_tr_b16 v[42:43], v21 offset:512
    ds_read_b64_tr_b16 v[44:45], v21 offset:4096
    ds_read_b64_tr_b16 v[46:47], v21 offset:4608
    s_lshr_b32 s42, s44, 7
    s_lshl_b32 s43, s28, 5
    s_add_u32 s42, s42, s43
    s_add_u32 s42, s42, 16
    v_lshrrev_b32 v3, 1, v8
    v_xor_b32 v3, v3, v5
    v_lshlrev_b32 v3, 4, v3
    v_lshl_add_u32 v3, v8, 7, v3
    s_lshl_b32 s40, s42, 7
    s_add_u32 s40, s40, 24576
    v_add_u32 v22, s40, v3
    v_xor_b32 v23, 64, v22
    ds_read_b128 v[48:51], v22 offset:0
    ds_read_b128 v[52:55], v23 offset:0
    ds_read_b128 v[56:59], v22 offset:2048
    ds_read_b128 v[60:63], v23 offset:2048
    v_mov_b32 v64, 0x3f803f80
    v_mov_b32 v65, 0x3f803f80
    v_mov_b32 v66, 0x3f803f80
    v_mov_b32 v67, 0x3f803f80
    s_mul_i32 s42, s52, 12288
    s_lshl_b32 s43, s24, 8
    s_add_u32 s42, s42, s43
    v_lshl_add_u32 v21, v5, 4, s42
    s_lshl_b32 s42, s52, 14
    s_lshl_b32 s43, s25, 10
    s_add_u32 s42, s42, s43
    s_lshl_b32 s43, s28, 8
    s_add_u32 s42, s42, s43
    v_lshl_add_u32 v22, v8, 3, s42
    s_waitcnt lgkmcnt(0)
    v_mfma_f32_16x16x32_bf16 v[68:71], v[24:27], v[64:67], 0
    v_mfma_f32_16x16x32_bf16 v[72:75], v[32:35], v[64:67], 0
    v_mfma_f32_16x16x32_bf16 v[76:79], v[40:43], v[64:67], 0
    v_mfma_f32_16x16x32_bf16 v[80:83], v[64:67], v[48:51], 0
    v_mfma_f32_16x16x32_bf16 v[84:87], v[48:51], v[48:51], 0
    v_mfma_f32_16x16x32_bf16 v[88:91], v[64:67], v[56:59], 0
    v_mfma_f32_16x16x32_bf16 v[92:95], v[56:59], v[56:59], 0
    v_mfma_f32_16x16x32_bf16 v[68:71], v[28:31], v[64:67], v[68:71]
    v_mfma_f32_16x16x32_bf16 v[72:75], v[36:39], v[64:67], v[72:75]
    v_mfma_f32_16x16x32_bf16 v[76:79], v[44:47], v[64:67], v[76:79]
    v_mfma_f32_16x16x32_bf16 v[80:83], v[64:67], v[52:55], v[80:83]
    v_mfma_f32_16x16x32_bf16 v[84:87], v[52:55], v[52:55], v[84:87]
    v_mfma_f32_16x16x32_bf16 v[88:91], v[64:67], v[60:63], v[88:91]
    v_mfma_f32_16x16x32_bf16 v[92:95], v[60:63], v[60:63], v[92:95]
    v_cmp_eq_u32 s[40:41], 1, v7
    v_cmp_eq_u32 s[42:43], 2, v7
    v_cmp_eq_u32 vcc, 3, v7
    s_nop 7
    v_cndmask_b32 v81, v84, v85, s[40:41]
    v_cndmask_b32 v81, v81, v86, s[42:43]
    v_cndmask_b32 v81, v81, v87, vcc
    v_cndmask_b32 v89, v92, v93, s[40:41]
    v_cndmask_b32 v89, v89, v94, s[42:43]
    v_cndmask_b32 v89, v89, v95, vcc
    s_mov_b32 exec_lo, 0x00f0000f
    s_mov_b32 exec_hi, 0xf0000f00
    buffer_store_dwordx2 v[80:81], v22, s[20:23], 0 offen offset:0 sc1
    buffer_store_dwordx2 v[88:89], v22, s[20:23], 0 offen offset:128 sc1
    s_mov_b32 exec_lo, 0x00010001
    s_mov_b32 exec_hi, 0x00010001
    s_mul_i32 s42, s28, 3
    s_add_u32 s42, s42, 0
    s_lshr_b32 s43, s42, 2
    s_lshl_b32 s43, s43, 12
    s_and_b32 s42, s42, 3
    s_lshl_b32 s42, s42, 6
    s_add_u32 s42, s42, s43
    buffer_store_dwordx4 v[68:71], v21, s[56:59], s42 offen sc1
    s_mul_i32 s42, s28, 3
    s_add_u32 s42, s42, 1
    s_lshr_b32 s43, s42, 2
    s_lshl_b32 s43, s43, 12
    s_and_b32 s42, s42, 3
    s_lshl_b32 s42, s42, 6
    s_add_u32 s42, s42, s43
    buffer_store_dwordx4 v[72:75], v21, s[56:59], s42 offen sc1
    s_mul_i32 s42, s28, 3
    s_add_u32 s42, s42, 2
    s_lshr_b32 s43, s42, 2
    s_lshl_b32 s43, s43, 12
    s_and_b32 s42, s42, 3
    s_lshl_b32 s42, s42, 6
    s_add_u32 s42, s42, s43
    buffer_store_dwordx4 v[76:79], v21, s[56:59], s42 offen sc1
    s_mov_b64 exec, -1
    s_or_b32 s40, s24, s25
    s_or_b32 s40, s40, s28
    s_cmp_lg_u32 s40, 0
    s_cbranch_scc1 g1_nocr
    v_lshlrev_b32 v21, 8, v2
    v_mov_b32 v22, 0
    s_add_u32 s84, s4, 0x300000
    s_addc_u32 s85, s5, 0
    s_mov_b32 s86, 0x4000
    s_mov_b32 s87, 0x20000
    buffer_store_dword v22, v21, s[84:87], 0 offen sc1
    s_add_u32 s84, s4, 0x2b00000
    s_addc_u32 s85, s5, 0
    s_mov_b32 s86, 0x4000
    s_mov_b32 s87, 0x20000
    buffer_store_dword v22, v21, s[84:87], 0 offen sc1
g1_nocr:
    s_branch g1_ld_c0
g1_ld_w1:
    s_waitcnt vmcnt(12)
    s_branch g1_ld_bar
g1_ld_h1:
    v_mov_b32 v21, 0
    v_mov_b32 v22, 1
    s_mov_b64 exec, 1
    buffer_atomic_add v22, v21, s[60:63], 0 offen sc1
    s_mov_b64 exec, -1
    s_branch g1_ld_c1
g1_ld_w2:
    s_waitcnt vmcnt(12)
    s_branch g1_ld_bar
g1_ld_h2:
    v_mov_b32 v21, 0
    buffer_load_dword v23, v21, s[60:63], 0 offen sc1
    s_branch g1_ld_c2
g1_ld_h3:
    s_mov_b32 s41, 0x20000
    v_mov_b32 v21, 0
    s_waitcnt vmcnt(11)
g1_poll:
    v_readfirstlane_b32 s40, v23
    s_sub_u32 s41, s41, 1
    s_cmp_eq_u32 s41, 0
    s_cbranch_scc1 g1_polled
    s_cmp_ge_u32 s40, 256
    s_cbranch_scc1 g1_polled
    s_sleep 8
    buffer_load_dword v23, v21, s[60:63], 0 offen sc1
    s_waitcnt vmcnt(0)
    s_branch g1_poll
g1_polled:
    s_branch g1_ld_c3
g1_ld_w4:
    s_waitcnt vmcnt(43)
    s_branch g1_ld_bar
g1_ld_h4:
    s_lshl_b32 s40, s28, 6
    v_add_u32 v21, s40, v2
    s_lshl_b32 s41, s25, 7
    s_sub_u32 s41, s41, 16
    v_add_u32 v3, s41, v21
    v_max_i32 v3, 0, v3
    v_min_u32 v3, 2047, v3
    v_lshlrev_b32 v3, 3, v3
    s_min_u32 s40, s28, 2
    s_lshl_b32 s40, s40, 12
    s_lshl_b32 s41, s24, 8
    s_add_u32 s40, s40, s41
    v_lshl_add_u32 v4, v2, 2, s40
    s_mov_b32 s40, 0
    buffer_load_dwordx2 v[24:25], v3, s[20:23], s40 offen sc1
    s_mov_b32 s41, 0
    buffer_load_dword v56, v4, s[56:59], s41 offen sc1
    s_mov_b32 s40, 16384
    buffer_load_dwordx2 v[26:27], v3, s[20:23], s40 offen sc1
    s_mov_b32 s41, 12288
    buffer_load_dword v57, v4, s[56:59], s41 offen sc1
    s_mov_b32 s40, 32768
    buffer_load_dwordx2 v[28:29], v3, s[20:23], s40 offen sc1
    s_mov_b32 s41, 24576
    buffer_load_dword v58, v4, s[56:59], s41 offen sc1
    s_mov_b32 s40, 49152
    buffer_load_dwordx2 v[30:31], v3, s[20:23], s40 offen sc1
    s_mov_b32 s41, 36864
    buffer_load_dword v59, v4, s[56:59], s41 offen sc1
    s_mov_b32 s40, 65536
    buffer_load_dwordx2 v[32:33], v3, s[20:23], s40 offen sc1
    s_mov_b32 s41, 49152
    buffer_load_dword v60, v4, s[56:59], s41 offen sc1
    s_mov_b32 s40, 81920
    buffer_load_dwordx2 v[34:35], v3, s[20:23], s40 offen sc1
    s_mov_b32 s41, 61440
    buffer_load_dword v61, v4, s[56:59], s41 offen sc1
    s_mov_b32 s40, 98304
    buffer_load_dwordx2 v[36:37], v3, s[20:23], s40 offen sc1
    s_mov_b32 s41, 73728
    buffer_load_dword v62, v4, s[56:59], s41 offen sc1
    s_mov_b32 s40, 114688
    buffer_load_dwordx2 v[38:39], v3, s[20:23], s40 offen sc1
    s_mov_b32 s41, 86016
    buffer_load_dword v63, v4, s[56:59], s41 offen sc1
    s_mov_b32 s40, 131072
    buffer_load_dwordx2 v[40:41], v3, s[20:23], s40 offen sc1
    s_mov_b32 s41, 98304
    buffer_load_dword v64, v4, s[56:59], s41 offen sc1
    s_mov_b32 s40, 147456
    buffer_load_dwordx2 v[42:43], v3, s[20:23], s40 offen sc1
    s_mov_b32 s41, 110592
    buffer_load_dword v65, v4, s[56:59], s41 offen sc1
    s_mov_b32 s40, 163840
    buffer_load_dwordx2 v[44:45], v3, s[20:23], s40 offen sc1
    s_mov_b32 s41, 122880
    buffer_load_dword v66, v4, s[56:59], s41 offen sc1
    s_mov_b32 s40, 180224
    buffer_load_dwordx2 v[46:47], v3, s[20:23], s40 offen sc1
    s_mov_b32 s41, 135168
    buffer_load_dword v67, v4, s[56:59], s41 offen sc1
    s_mov_b32 s40, 196608
    buffer_load_dwordx2 v[48:49], v3, s[20:23], s40 offen sc1
    s_mov_b32 s41, 147456
    buffer_load_dword v68, v4, s[56:59], s41 offen sc1
    s_mov_b32 s40, 212992
    buffer_load_dwordx2 v[50:51], v3, s[20:23], s40 offen sc1
    s_mov_b32 s41, 159744
    buffer_load_dword v69, v4, s[56:59], s41 offen sc1
    s_mov_b32 s40, 229376
    buffer_load_dwordx2 v[52:53], v3, s[20:23], s40 offen sc1
    s_mov_b32 s41, 172032
    buffer_load_dword v70, v4, s[56:59], s41 offen sc1
    s_mov_b32 s40, 245760
    buffer_load_dwordx2 v[54:55], v3, s[20:23], s40 offen sc1
    s_mov_b32 s41, 184320
    buffer_load_dword v71, v4, s[56:59], s41 offen sc1
    s_branch g1_ld_c4
g1_ld_end:
    s_add_u32 s28, s28, 4
    s_add_u32 s16, s4, 0x400000
    s_addc_u32 s17, s5, 0
    s_mov_b32 s18, 0x400000
    s_mov_b32 s19, 0x20000
    s_and_b32 s44, s28, 1
    s_lshr_b32 s45, s28, 1
    s_lshl_b32 s40, s44, 2
    v_add_u32 v3, s40, v5
    v_and_b32 v4, 7, v8
    v_xor_b32 v3, v3, v4
    v_lshlrev_b32 v3, 4, v3
    v_lshl_add_u32 v3, v8, 8, v3
    s_mul_i32 s41, s45, 4096
    s_add_u32 s41, s41, 43008
    v_add_u32 v226, s41, v3
    v_lshl_add_u32 v3, v5, 2, v6
    v_and_b32 v4, 7, v3
    v_add_u32 v228, s40, v7
    v_xor_b32 v4, v4, v228
    v_lshlrev_b32 v4, 4, v4
    v_lshl_add_u32 v3, v3, 8, v4
    s_add_u32 s41, s41, 36864
    v_add_u32 v227, s41, v3
    v_and_b32 v3, 7, v8
    v_add_u32 v4, 1, v3
    s_or_b32 s40, s25, s45
    s_cmp_eq_u32 s40, 0
    s_cselect_b32 s40, 8, 0
    v_cmp_gt_u32 vcc, 8, v8
    v_mov_b32 v21, s40
    s_mov_b64 s[56:57], vcc
    v_cndmask_b32 v21, 0, v21, vcc
    v_max_u32 v4, v4, v21
    v_add_u32 v3, 8, v3
    v_sub_u32 v3, v3, v4
    v_lshlrev_b32 v21, 2, v5
    v_sub_u32 v21, v21, v4
    v_mov_b32 v22, 0xf149f2ca
    v_add_u32 v23, 0, v21
    v_cmp_ge_u32 vcc, v3, v23
    s_nop 1
    v_cndmask_b32 v228, v22, 0, vcc
    v_add_u32 v23, 1, v21
    v_cmp_ge_u32 vcc, v3, v23
    s_nop 1
    v_cndmask_b32 v229, v22, 0, vcc
    v_add_u32 v23, 2, v21
    v_cmp_ge_u32 vcc, v3, v23
    s_nop 1
    v_cndmask_b32 v230, v22, 0, vcc
    v_add_u32 v23, 3, v21
    v_cmp_ge_u32 vcc, v3, v23
    s_nop 1
    v_cndmask_b32 v231, v22, 0, vcc
    s_lshl_b32 s40, s25, 7
    s_lshl_b32 s41, s45, 5
    s_add_u32 s40, s40, s41
    s_lshl_b32 s40, s40, 11
    s_lshl_b32 s41, s24, 7
    s_add_u32 s40, s40, s41
    s_lshl_b32 s41, s44, 6
    s_add_u32 s40, s40, s41
    v_lshlrev_b32 v225, 12, v8
    v_lshl_add_u32 v225, v5, 4, v225
    v_add_u32 v225, s40, v225
    s_mov_b32 s58, 0x3e3504f3
    s_mov_b32 s59, 0x3fb8aa3b
    s_branch g1_attn
g1_compute:
    s_and_b32 s44, s28, 1
    s_lshr_b32 s45, s28, 1
    s_lshl_b32 s42, s44, 1
    s_mov_b32 s43, 0
    v_and_b32 v3, 1, v5
    v_lshlrev_b32 v3, 1, v3
    v_lshrrev_b32 v4, 1, v6
    v_or_b32 v3, v3, v4
    s_add_u32 s40, s42, 0
    v_xor_b32 v3, s40, v3
    v_lshlrev_b32 v3, 5, v3
    v_lshl_add_u32 v3, v7, 3, v3
    v_lshl_add_u32 v4, v5, 3, v6
    v_lshl_add_u32 v3, v4, 7, v3
    v_add_u32 v10, s43, v3
    v_and_b32 v3, 1, v5
    v_lshlrev_b32 v3, 1, v3
    v_lshrrev_b32 v4, 1, v6
    v_or_b32 v3, v3, v4
    s_add_u32 s40, s42, 1
    v_xor_b32 v3, s40, v3
    v_lshlrev_b32 v3, 5, v3
    v_lshl_add_u32 v3, v7, 3, v3
    v_lshl_add_u32 v4, v5, 3, v6
    v_lshl_add_u32 v3, v4, 7, v3
    v_add_u32 v11, s43, v3
    s_xor_b32 s43, s45, 1
    s_add_u32 s43, s43, 1
    s_mul_i32 s43, s43, 8192
    v_and_b32 v3, 1, v5
    v_lshlrev_b32 v3, 1, v3
    v_lshrrev_b32 v4, 1, v6
    v_or_b32 v3, v3, v4
    s_add_u32 s40, s42, 0
    v_xor_b32 v3, s40, v3
    v_lshlrev_b32 v3, 5, v3
    v_lshl_add_u32 v3, v7, 3, v3
    v_lshl_add_u32 v4, v5, 3, v6
    v_lshl_add_u32 v3, v4, 7, v3
    v_add_u32 v12, s43, v3
    v_and_b32 v3, 1, v5
    v_lshlrev_b32 v3, 1, v3
    v_lshrrev_b32 v4, 1, v6
    v_or_b32 v3, v3, v4
    s_add_u32 s40, s42, 1
    v_xor_b32 v3, s40, v3
    v_lshlrev_b32 v3, 5, v3
    v_lshl_add_u32 v3, v7, 3, v3
    v_lshl_add_u32 v4, v5, 3, v6
    v_lshl_add_u32 v3, v4, 7, v3
    v_add_u32 v13, s43, v3
    s_xor_b32 s43, s45, 0
    s_add_u32 s43, s43, 1
    s_mul_i32 s43, s43, 8192
    v_and_b32 v3, 1, v5
    v_lshlrev_b32 v3, 1, v3
    v_lshrrev_b32 v4, 1, v6
    v_or_b32 v3, v3, v4
    s_add_u32 s40, s42, 0
    v_xor_b32 v3, s40, v3
    v_lshlrev_b32 v3, 5, v3
    v_lshl_add_u32 v3, v7, 3, v3
    v_lshl_add_u32 v4, v5, 3, v6
    v_lshl_add_u32 v3, v4, 7, v3
    v_add_u32 v14, s43, v3
    v_and_b32 v3, 1, v5
    v_lshlrev_b32 v3, 1, v3
    v_lshrrev_b32 v4, 1, v6
    v_or_b32 v3, v3, v4
    s_add_u32 s40, s42, 1
    v_xor_b32 v3, s40, v3
    v_lshlrev_b32 v3, 5, v3
    v_lshl_add_u32 v3, v7, 3, v3
    v_lshl_add_u32 v4, v5, 3, v6
    v_lshl_add_u32 v3, v4, 7, v3
    v_add_u32 v15, s43, v3
    s_mul_i32 s42, s45, 64
    s_add_u32 s42, s42, 16
    v_lshrrev_b32 v3, 1, v8
    v_xor_b32 v3, v3, v5
    v_lshlrev_b32 v3, 4, v3
    v_lshl_add_u32 v3, v8, 7, v3
    s_lshl_b32 s40, s42, 7
    s_add_u32 s40, s40, 24576
    v_add_u32 v16, s40, v3
    v_xor_b32 v17, 64, v16
    v_lshrrev_b32 v3, 1, v8
    v_xor_b32 v3, v3, v5
    v_lshlrev_b32 v3, 4, v3
    v_lshl_add_u32 v3, v8, 7, v3
    v_add_u32 v18, 24576, v3
    v_xor_b32 v19, 64, v18
    v_mov_b32 v24, 0
    v_mov_b32 v25, 0
    v_mov_b32 v26, 0
    v_mov_b32 v27, 0
    v_mov_b32 v28, 0
    v_mov_b32 v29, 0
    v_mov_b32 v30, 0
    v_mov_b32 v31, 0
    v_mov_b32 v32, 0
    v_mov_b32 v33, 0
    v_mov_b32 v34, 0
    v_mov_b32 v35, 0
    v_mov_b32 v36, 0
    v_mov_b32 v37, 0
    v_mov_b32 v38, 0
    v_mov_b32 v39, 0
    v_mov_b32 v40, 0
    v_mov_b32 v41, 0
    v_mov_b32 v42, 0
    v_mov_b32 v43, 0
    v_mov_b32 v44, 0
    v_mov_b32 v45, 0
    v_mov_b32 v46, 0
    v_mov_b32 v47, 0
    v_mov_b32 v48, 0
    v_mov_b32 v49, 0
    v_mov_b32 v50, 0
    v_mov_b32 v51, 0
    v_mov_b32 v52, 0
    v_mov_b32 v53, 0
    v_mov_b32 v54, 0
    v_mov_b32 v55, 0
    v_mov_b32 v56, 0
    v_mov_b32 v57, 0
    v_mov_b32 v58, 0
    v_mov_b32 v59, 0
    v_mov_b32 v60, 0
    v_mov_b32 v61, 0
    v_mov_b32 v62, 0
    v_mov_b32 v63, 0
    v_mov_b32 v64, 0
    v_mov_b32 v65, 0
    v_mov_b32 v66, 0
    v_mov_b32 v67, 0
    v_mov_b32 v68, 0
    v_mov_b32 v69, 0
    v_mov_b32 v70, 0
    v_mov_b32 v71, 0
    v_mov_b32 v72, 0
    v_mov_b32 v73, 0
    v_mov_b32 v74, 0
    v_mov_b32 v75, 0
    v_mov_b32 v76, 0
    v_mov_b32 v77, 0
    v_mov_b32 v78, 0
    v_mov_b32 v79, 0
    v_mov_b32 v80, 0
    v_mov_b32 v81, 0
    v_mov_b32 v82, 0
    v_mov_b32 v83, 0
    v_mov_b32 v84, 0
    v_mov_b32 v85, 0
    v_mov_b32 v86, 0
    v_mov_b32 v87, 0
    v_mov_b32 v88, 0
    v_mov_b32 v89, 0
    v_mov_b32 v90, 0
    v_mov_b32 v91, 0
    v_mov_b32 v92, 0
    v_mov_b32 v93, 0
    v_mov_b32 v94, 0
    v_mov_b32 v95, 0
    v_mov_b32 v96, 0
    v_mov_b32 v97, 0
    v_mov_b32 v98, 0
    v_mov_b32 v99, 0
    v_mov_b32 v100, 0
    v_mov_b32 v101, 0
    v_mov_b32 v102, 0
    v_mov_b32 v103, 0
    v_mov_b32 v104, 0
    v_mov_b32 v105, 0
    v_mov_b32 v106, 0
    v_mov_b32 v107, 0
    v_mov_b32 v108, 0
    v_mov_b32 v109, 0
    v_mov_b32 v110, 0
    v_mov_b32 v111, 0
    v_mov_b32 v112, 0
    v_mov_b32 v113, 0
    v_mov_b32 v114, 0
    v_mov_b32 v115, 0
    v_mov_b32 v116, 0
    v_mov_b32 v117, 0
    v_mov_b32 v118, 0
    v_mov_b32 v119, 0
    v_mov_b32 v120, 0
    v_mov_b32 v121, 0
    v_mov_b32 v122, 0
    v_mov_b32 v123, 0
    v_mov_b32 v124, 0
    v_mov_b32 v125, 0
    v_mov_b32 v126, 0
    v_mov_b32 v127, 0
    v_mov_b32 v172, 0
    v_mov_b32 v173, 0
    v_mov_b32 v174, 0
    v_mov_b32 v175, 0
    v_mov_b32 v176, 0
    v_mov_b32 v177, 0
    v_mov_b32 v178, 0
    v_mov_b32 v179, 0
    v_mov_b32 v180, 0
    v_mov_b32 v181, 0
    v_mov_b32 v182, 0
    v_mov_b32 v183, 0
    v_mov_b32 v184, 0
    v_mov_b32 v185, 0
    v_mov_b32 v186, 0
    v_mov_b32 v187, 0
    v_mov_b32 v188, 0
    v_mov_b32 v189, 0
    v_mov_b32 v190, 0
    v_mov_b32 v191, 0
    v_mov_b32 v192, 0
    v_mov_b32 v193, 0
    v_mov_b32 v194, 0
    v_mov_b32 v195, 0
    v_mov_b32 v196, 0
    v_mov_b32 v197, 0
    v_mov_b32 v198, 0
    v_mov_b32 v199, 0
    v_mov_b32 v200, 0
    v_mov_b32 v201, 0
    v_mov_b32 v202, 0
    v_mov_b32 v203, 0
    v_mov_b32 v204, 0
    v_mov_b32 v205, 0
    v_mov_b32 v206, 0
    v_mov_b32 v207, 0
    v_mov_b32 v208, 0
    v_mov_b32 v209, 0
    v_mov_b32 v210, 0
    v_mov_b32 v211, 0
    v_mov_b32 v212, 0
    v_mov_b32 v213, 0
    v_mov_b32 v214, 0
    v_mov_b32 v215, 0
    s_mov_b32 s48, 16
    s_mov_b32 s50, 0
    s_mov_b32 s51, 43008
    s_mov_b32 s29, 0xfffeb000
    s_waitcnt lgkmcnt(0)
    s_add_u32 s4, s4, s97
    s_addc_u32 s5, s5, 0
    v_lshlrev_b32 v3, 3, v8
    v_add_u32 v217, 129024, v3
    s_mul_i32 s40, s45, 512
    s_add_u32 s40, s40, 129152
    v_add_u32 v216, s40, v3
    s_lshl_b32 s40, s44, 7
    s_add_u32 s40, s40, 130304
    v_lshl_add_u32 v3, v5, 4, s40
    s_mov_b32 s43, 0
    v_add_u32 v218, s43, v3
    s_xor_b32 s43, s45, 1
    s_add_u32 s43, s43, 1
    s_mul_i32 s43, s43, 256
    v_add_u32 v219, s43, v3
    s_xor_b32 s43, s45, 0
    s_add_u32 s43, s43, 1
    s_mul_i32 s43, s43, 256
    v_add_u32 v220, s43, v3
    v_and_b32 v3, 1, v5
    v_lshlrev_b32 v3, 1, v3
    v_lshrrev_b32 v4, 1, v5
    v_add_u32 v3, v3, v4
    s_lshl_b32 s40, s44, 2
    v_add_u32 v3, s40, v3
    v_lshrrev_b32 v4, 1, v8
    v_xor_b32 v3, v3, v4
    v_lshlrev_b32 v3, 4, v3
    v_lshl_add_u32 v3, v8, 7, v3
    s_mul_i32 s42, s45, 8192
    s_add_u32 s42, s42, 45056
    s_mov_b32 s43, 0
    s_add_u32 s40, s42, s43
    v_add_u32 v221, s40, v3
    s_xor_b32 s43, s45, 1
    s_add_u32 s43, s43, 1
    s_mul_i32 s43, s43, 18432
    s_add_u32 s40, s42, s43
    v_add_u32 v222, s40, v3
    s_xor_b32 s43, s45, 0
    s_add_u32 s43, s43, 1
    s_mul_i32 s43, s43, 18432
    s_add_u32 s40, s42, s43
    v_add_u32 v223, s40, v3
    s_add_u32 s40, s43, 43008
    v_add_u32 v224, s40, v3
    s_add_u32 s16, s4, 0x400000
    s_addc_u32 s17, s5, 0
    s_mov_b32 s18, 0x400000
    s_mov_b32 s19, 0x20000
    s_and_b32 s44, s28, 1
    s_lshr_b32 s45, s28, 1
    s_lshl_b32 s40, s44, 2
    v_add_u32 v3, s40, v5
    v_and_b32 v4, 7, v8
    v_xor_b32 v3, v3, v4
    v_lshlrev_b32 v3, 4, v3
    v_lshl_add_u32 v3, v8, 8, v3
    s_mul_i32 s41, s45, 4096
    s_add_u32 s41, s41, 43008
    v_add_u32 v226, s41, v3
    v_lshl_add_u32 v3, v5, 2, v6
    v_and_b32 v4, 7, v3
    v_add_u32 v228, s40, v7
    v_xor_b32 v4, v4, v228
    v_lshlrev_b32 v4, 4, v4
    v_lshl_add_u32 v3, v3, 8, v4
    s_add_u32 s41, s41, 36864
    v_add_u32 v227, s41, v3
    v_and_b32 v3, 7, v8
    v_add_u32 v4, 1, v3
    s_or_b32 s40, s25, s45
    s_cmp_eq_u32 s40, 0
    s_cselect_b32 s40, 8, 0
    v_cmp_gt_u32 vcc, 8, v8
    v_mov_b32 v21, s40
    s_mov_b64 s[56:57], vcc
    v_cndmask_b32 v21, 0, v21, vcc
    v_max_u32 v4, v4, v21
    v_add_u32 v3, 8, v3
    v_sub_u32 v3, v3, v4
    v_lshlrev_b32 v21, 2, v5
    v_sub_u32 v21, v21, v4
    v_mov_b32 v22, 0xf149f2ca
    v_add_u32 v23, 0, v21
    v_cmp_ge_u32 vcc, v3, v23
    s_nop 1
    v_cndmask_b32 v228, v22, 0, vcc
    v_add_u32 v23, 1, v21
    v_cmp_ge_u32 vcc, v3, v23
    s_nop 1
    v_cndmask_b32 v229, v22, 0, vcc
    v_add_u32 v23, 2, v21
    v_cmp_ge_u32 vcc, v3, v23
    s_nop 1
    v_cndmask_b32 v230, v22, 0, vcc
    v_add_u32 v23, 3, v21
    v_cmp_ge_u32 vcc, v3, v23
    s_nop 1
    v_cndmask_b32 v231, v22, 0, vcc
    s_lshl_b32 s40, s25, 7
    s_lshl_b32 s41, s45, 5
    s_add_u32 s40, s40, s41
    s_lshl_b32 s40, s40, 11
    s_lshl_b32 s41, s24, 7
    s_add_u32 s40, s40, s41
    s_lshl_b32 s41, s44, 6
    s_add_u32 s40, s40, s41
    v_lshlrev_b32 v225, 12, v8
    v_lshl_add_u32 v225, v5, 4, v225
    v_add_u32 v225, s40, v225
    s_mov_b32 s58, 0x3e3504f3
    s_mov_b32 s59, 0x3fb8aa3b
.p2align 3
g1_cloop:
    s_barrier
g1_cloop2:
    v_mfma_f32_16x16x32_bf16 v[24:27], v[172:175], v[196:199], v[24:27]
    ds_read_b64_tr_b16 v[128:129], v10 offset:0
    ds_read_b64_tr_b16 v[130:131], v10 offset:512
    v_mfma_f32_16x16x32_bf16 v[28:31], v[172:175], v[200:203], v[28:31]
    ds_read_b128 v[152:155], v16 offset:0
    v_mfma_f32_16x16x32_bf16 v[32:35], v[172:175], v[204:207], v[32:35]
    ds_read_b128 v[156:159], v16 offset:2048
    v_mfma_f32_16x16x32_bf16 v[36:39], v[172:175], v[208:211], v[36:39]
    ds_read_b128 v[160:163], v16 offset:4096
    v_mfma_f32_16x16x32_bf16 v[52:55], v[176:179], v[208:211], v[52:55]
    ds_read_b128 v[164:167], v16 offset:6144
    v_mfma_f32_16x16x32_bf16 v[48:51], v[176:179], v[204:207], v[48:51]
    ds_read_b64_tr_b16 v[132:133], v11 offset:0
    ds_read_b64_tr_b16 v[134:135], v11 offset:512
    v_mfma_f32_16x16x32_bf16 v[44:47], v[176:179], v[200:203], v[44:47]
    ds_read_b64_tr_b16 v[136:137], v12 offset:0
    ds_read_b64_tr_b16 v[138:139], v12 offset:512
    v_mfma_f32_16x16x32_bf16 v[40:43], v[176:179], v[196:199], v[40:43]
    ds_read_b64_tr_b16 v[140:141], v13 offset:0
    ds_read_b64_tr_b16 v[142:143], v13 offset:512
    v_mfma_f32_16x16x32_bf16 v[56:59], v[180:183], v[196:199], v[56:59]
    ds_read_b64_tr_b16 v[144:145], v14 offset:0
    ds_read_b64_tr_b16 v[146:147], v14 offset:512
    v_mfma_f32_16x16x32_bf16 v[60:63], v[180:183], v[200:203], v[60:63]
    ds_read_b64_tr_b16 v[148:149], v15 offset:0
    ds_read_b64_tr_b16 v[150:151], v15 offset:512
    v_mfma_f32_16x16x32_bf16 v[64:67], v[180:183], v[204:207], v[64:67]
    ds_read_b128 v[168:171], v18 offset:0
    v_mfma_f32_16x16x32_bf16 v[68:71], v[180:183], v[208:211], v[68:71]
    v_mfma_f32_16x16x32_bf16 v[84:87], v[184:187], v[208:211], v[84:87]
    v_mfma_f32_16x16x32_bf16 v[80:83], v[184:187], v[204:207], v[80:83]
    v_mfma_f32_16x16x32_bf16 v[76:79], v[184:187], v[200:203], v[76:79]
    v_mfma_f32_16x16x32_bf16 v[72:75], v[184:187], v[196:199], v[72:75]
    v_mfma_f32_16x16x32_bf16 v[88:91], v[188:191], v[196:199], v[88:91]
    v_mfma_f32_16x16x32_bf16 v[92:95], v[188:191], v[200:203], v[92:95]
    v_mfma_f32_16x16x32_bf16 v[96:99], v[188:191], v[204:207], v[96:99]
    v_mfma_f32_16x16x32_bf16 v[100:103], v[188:191], v[208:211], v[100:103]
    v_mfma_f32_16x16x32_bf16 v[120:123], v[188:191], v[212:215], v[120:123]
    v_mfma_f32_16x16x32_bf16 v[124:127], v[192:195], v[212:215], v[124:127]
    v_mfma_f32_16x16x32_bf16 v[116:119], v[192:195], v[208:211], v[116:119]
    v_mfma_f32_16x16x32_bf16 v[112:115], v[192:195], v[204:207], v[112:115]
    v_mfma_f32_16x16x32_bf16 v[108:111], v[192:195], v[200:203], v[108:111]
    v_mfma_f32_16x16x32_bf16 v[104:107], v[192:195], v[196:199], v[104:107]
    s_waitcnt lgkmcnt(0)
    v_mfma_f32_16x16x32_bf16 v[24:27], v[128:131], v[152:155], v[24:27]
    ds_read_b64_tr_b16 v[172:173], v10 offset:4096
    ds_read_b64_tr_b16 v[174:175], v10 offset:4608
    v_mfma_f32_16x16x32_bf16 v[28:31], v[128:131], v[156:159], v[28:31]
    ds_read_b128 v[196:199], v17 offset:0
    v_mfma_f32_16x16x32_bf16 v[32:35], v[128:131], v[160:163], v[32:35]
    ds_read_b128 v[200:203], v17 offset:2048
    v_mfma_f32_16x16x32_bf16 v[36:39], v[128:131], v[164:167], v[36:39]
    ds_read_b128 v[204:207], v17 offset:4096
    v_mfma_f32_16x16x32_bf16 v[52:55], v[132:135], v[164:167], v[52:55]
    ds_read_b128 v[208:211], v17 offset:6144
    v_mfma_f32_16x16x32_bf16 v[48:51], v[132:135], v[160:163], v[48:51]
    ds_read_b64_tr_b16 v[176:177], v11 offset:4096
    ds_read_b64_tr_b16 v[178:179], v11 offset:4608
    v_mfma_f32_16x16x32_bf16 v[44:47], v[132:135], v[156:159], v[44:47]
    ds_read_b64_tr_b16 v[180:181], v12 offset:4096
    ds_read_b64_tr_b16 v[182:183], v12 offset:4608
    v_mfma_f32_16x16x32_bf16 v[40:43], v[132:135], v[152:155], v[40:43]
    ds_read_b64_tr_b16 v[184:185], v13 offset:4096
    ds_read_b64_tr_b16 v[186:187], v13 offset:4608
    v_mfma_f32_16x16x32_bf16 v[56:59], v[136:139], v[152:155], v[56:59]
    ds_read_b64_tr_b16 v[188:189], v14 offset:4096
    ds_read_b64_tr_b16 v[190:191], v14 offset:4608
    v_mfma_f32_16x16x32_bf16 v[60:63], v[136:139], v[156:159], v[60:63]
    ds_read_b64_tr_b16 v[192:193], v15 offset:4096
    ds_read_b64_tr_b16 v[194:195], v15 offset:4608
    v_mfma_f32_16x16x32_bf16 v[64:67], v[136:139], v[160:163], v[64:67]
    ds_read_b128 v[212:215], v19 offset:0
    v_mfma_f32_16x16x32_bf16 v[68:71], v[136:139], v[164:167], v[68:71]
    s_add_u32 s50, s50, 1
    s_cmp_eq_u32 s50, 3
    v_mfma_f32_16x16x32_bf16 v[84:87], v[140:143], v[164:167], v[84:87]
    s_cselect_b32 s49, s29, s51
    s_cselect_b32 s50, 0, s50
    v_mfma_f32_16x16x32_bf16 v[80:83], v[140:143], v[160:163], v[80:83]
    v_add_u32 v10, s49, v10
    v_add_u32 v11, s49, v11
    v_mfma_f32_16x16x32_bf16 v[76:79], v[140:143], v[156:159], v[76:79]
    v_add_u32 v12, s49, v12
    v_add_u32 v13, s49, v13
    v_mfma_f32_16x16x32_bf16 v[72:75], v[140:143], v[152:155], v[72:75]
    v_add_u32 v14, s49, v14
    v_add_u32 v15, s49, v15
    v_mfma_f32_16x16x32_bf16 v[88:91], v[144:147], v[152:155], v[88:91]
    v_add_u32 v16, s49, v16
    v_add_u32 v17, s49, v17
    v_mfma_f32_16x16x32_bf16 v[92:95], v[144:147], v[156:159], v[92:95]
    v_add_u32 v18, s49, v18
    v_add_u32 v19, s49, v19
    v_mfma_f32_16x16x32_bf16 v[96:99], v[144:147], v[160:163], v[96:99]
    s_sub_u32 s48, s48, 1
    s_cmp_lg_u32 s48, 0
    v_mfma_f32_16x16x32_bf16 v[100:103], v[144:147], v[164:167], v[100:103]
    v_mfma_f32_16x16x32_bf16 v[120:123], v[144:147], v[168:171], v[120:123]
    v_mfma_f32_16x16x32_bf16 v[124:127], v[148:151], v[168:171], v[124:127]
    v_mfma_f32_16x16x32_bf16 v[116:119], v[148:151], v[164:167], v[116:119]
    v_mfma_f32_16x16x32_bf16 v[112:115], v[148:151], v[160:163], v[112:115]
    v_mfma_f32_16x16x32_bf16 v[108:111], v[148:151], v[156:159], v[108:111]
    v_mfma_f32_16x16x32_bf16 v[104:107], v[148:151], v[152:155], v[104:107]
    s_waitcnt lgkmcnt(0)
    s_cbranch_scc1 g1_cloop
    ds_read_b64 v[128:129], v216 offset:0
    ds_read_b64 v[130:131], v216 offset:128
    ds_read_b64 v[132:133], v216 offset:256
    ds_read_b64 v[134:135], v216 offset:384
    ds_read_b64 v[136:137], v217
    ds_read_b128 v[140:143], v218 offset:0
    ds_read_b128 v[144:147], v218 offset:64
    ds_read_b128 v[148:151], v219 offset:0
    ds_read_b128 v[152:155], v219 offset:64
    ds_read_b128 v[156:159], v220 offset:0
    ds_read_b128 v[160:163], v220 offset:64
    v_mfma_f32_16x16x32_bf16 v[24:27], v[172:175], v[196:199], v[24:27]
    v_mfma_f32_16x16x32_bf16 v[40:43], v[176:179], v[196:199], v[40:43]
    v_mfma_f32_16x16x32_bf16 v[28:31], v[172:175], v[200:203], v[28:31]
    v_mfma_f32_16x16x32_bf16 v[44:47], v[176:179], v[200:203], v[44:47]
    v_mfma_f32_16x16x32_bf16 v[32:35], v[172:175], v[204:207], v[32:35]
    v_mfma_f32_16x16x32_bf16 v[48:51], v[176:179], v[204:207], v[48:51]
    s_waitcnt lgkmcnt(0)
    v_mfma_f32_16x16x32_bf16 v[36:39], v[172:175], v[208:211], v[36:39]
    v_pk_mul_f32 v[164:165], v[140:141], v[128:129] op_sel:[0,1] op_sel_hi:[1,1]
    v_pk_mul_f32 v[166:167], v[142:143], v[128:129] op_sel:[0,1] op_sel_hi:[1,1]
    v_pk_mul_f32 v[168:169], v[144:145], v[128:129] op_sel:[0,1] op_sel_hi:[1,1]
    v_pk_mul_f32 v[170:171], v[146:147], v[128:129] op_sel:[0,1] op_sel_hi:[1,1]
    v_pk_fma_f32 v[24:25], v[24:25], v[128:129], v[164:165] op_sel:[0,0,0] op_sel_hi:[1,0,1]
    v_pk_fma_f32 v[26:27], v[26:27], v[128:129], v[166:167] op_sel:[0,0,0] op_sel_hi:[1,0,1]
    v_pk_fma_f32 v[40:41], v[40:41], v[128:129], v[168:169] op_sel:[0,0,0] op_sel_hi:[1,0,1]
    v_pk_fma_f32 v[42:43], v[42:43], v[128:129], v[170:171] op_sel:[0,0,0] op_sel_hi:[1,0,1]
    v_mfma_f32_16x16x32_bf16 v[52:55], v[176:179], v[208:211], v[52:55]
    v_cvt_pk_bf16_f32 v232, v24, v25
    v_cvt_pk_bf16_f32 v233, v26, v27
    v_cvt_pk_bf16_f32 v234, v40, v41
    v_cvt_pk_bf16_f32 v235, v42, v43
    s_nop 1
    v_permlane16_swap_b32 v232, v234
    v_permlane16_swap_b32 v233, v235
    ds_write_b128 v221, v[232:235] offset:0
    v_mfma_f32_16x16x32_bf16 v[56:59], v[180:183], v[196:199], v[56:59]
    v_pk_mul_f32 v[164:165], v[140:141], v[130:131] op_sel:[0,1] op_sel_hi:[1,1]
    v_pk_mul_f32 v[166:167], v[142:143], v[130:131] op_sel:[0,1] op_sel_hi:[1,1]
    v_pk_mul_f32 v[168:169], v[144:145], v[130:131] op_sel:[0,1] op_sel_hi:[1,1]
    v_pk_mul_f32 v[170:171], v[146:147], v[130:131] op_sel:[0,1] op_sel_hi:[1,1]
    v_pk_fma_f32 v[28:29], v[28:29], v[130:131], v[164:165] op_sel:[0,0,0] op_sel_hi:[1,0,1]
    v_pk_fma_f32 v[30:31], v[30:31], v[130:131], v[166:167] op_sel:[0,0,0] op_sel_hi:[1,0,1]
    v_pk_fma_f32 v[44:45], v[44:45], v[130:131], v[168:169] op_sel:[0,0,0] op_sel_hi:[1,0,1]
    v_pk_fma_f32 v[46:47], v[46:47], v[130:131], v[170:171] op_sel:[0,0,0] op_sel_hi:[1,0,1]
    v_mfma_f32_16x16x32_bf16 v[72:75], v[184:187], v[196:199], v[72:75]
    v_cvt_pk_bf16_f32 v236, v28, v29
    v_cvt_pk_bf16_f32 v237, v30, v31
    v_cvt_pk_bf16_f32 v238, v44, v45
    v_cvt_pk_bf16_f32 v239, v46, v47
    s_nop 1
    v_permlane16_swap_b32 v236, v238
    v_permlane16_swap_b32 v237, v239
    ds_write_b128 v221, v[236:239] offset:2048
    v_mfma_f32_16x16x32_bf16 v[60:63], v[180:183], v[200:203], v[60:63]
    v_pk_mul_f32 v[164:165], v[140:141], v[132:133] op_sel:[0,1] op_sel_hi:[1,1]
    v_pk_mul_f32 v[166:167], v[142:143], v[132:133] op_sel:[0,1] op_sel_hi:[1,1]
    v_pk_mul_f32 v[168:169], v[144:145], v[132:133] op_sel:[0,1] op_sel_hi:[1,1]
    v_pk_mul_f32 v[170:171], v[146:147], v[132:133] op_sel:[0,1] op_sel_hi:[1,1]
    v_pk_fma_f32 v[32:33], v[32:33], v[132:133], v[164:165] op_sel:[0,0,0] op_sel_hi:[1,0,1]
    v_pk_fma_f32 v[34:35], v[34:35], v[132:133], v[166:167] op_sel:[0,0,0] op_sel_hi:[1,0,1]
    v_pk_fma_f32 v[48:49], v[48:49], v[132:133], v[168:169] op_sel:[0,0,0] op_sel_hi:[1,0,1]
    v_pk_fma_f32 v[50:51], v[50:51], v[132:133], v[170:171] op_sel:[0,0,0] op_sel_hi:[1,0,1]
    v_mfma_f32_16x16x32_bf16 v[76:79], v[184:187], v[200:203], v[76:79]
    v_cvt_pk_bf16_f32 v240, v32, v33
    v_cvt_pk_bf16_f32 v241, v34, v35
    v_cvt_pk_bf16_f32 v242, v48, v49
    v_cvt_pk_bf16_f32 v243, v50, v51
    s_nop 1
    v_permlane16_swap_b32 v240, v242
    v_permlane16_swap_b32 v241, v243
    ds_write_b128 v221, v[240:243] offset:4096
    v_mfma_f32_16x16x32_bf16 v[64:67], v[180:183], v[204:207], v[64:67]
    v_pk_mul_f32 v[164:165], v[140:141], v[134:135] op_sel:[0,1] op_sel_hi:[1,1]
    v_pk_mul_f32 v[166:167], v[142:143], v[134:135] op_sel:[0,1] op_sel_hi:[1,1]
    v_pk_mul_f32 v[168:169], v[144:145], v[134:135] op_sel:[0,1] op_sel_hi:[1,1]
    v_pk_mul_f32 v[170:171], v[146:147], v[134:135] op_sel:[0,1] op_sel_hi:[1,1]
    v_pk_fma_f32 v[36:37], v[36:37], v[134:135], v[164:165] op_sel:[0,0,0] op_sel_hi:[1,0,1]
    v_pk_fma_f32 v[38:39], v[38:39], v[134:135], v[166:167] op_sel:[0,0,0] op_sel_hi:[1,0,1]
    v_pk_fma_f32 v[52:53], v[52:53], v[134:135], v[168:169] op_sel:[0,0,0] op_sel_hi:[1,0,1]
    v_pk_fma_f32 v[54:55], v[54:55], v[134:135], v[170:171] op_sel:[0,0,0] op_sel_hi:[1,0,1]
    v_mfma_f32_16x16x32_bf16 v[80:83], v[184:187], v[204:207], v[80:83]
    v_cvt_pk_bf16_f32 v244, v36, v37
    v_cvt_pk_bf16_f32 v245, v38, v39
    v_cvt_pk_bf16_f32 v246, v52, v53
    v_cvt_pk_bf16_f32 v247, v54, v55
    s_nop 1
    v_permlane16_swap_b32 v244, v246
    v_permlane16_swap_b32 v245, v247
    ds_write_b128 v221, v[244:247] offset:6144
    v_mfma_f32_16x16x32_bf16 v[68:71], v[180:183], v[208:211], v[68:71]
    v_pk_mul_f32 v[164:165], v[148:149], v[128:129] op_sel:[0,1] op_sel_hi:[1,1]
    v_pk_mul_f32 v[166:167], v[150:151], v[128:129] op_sel:[0,1] op_sel_hi:[1,1]
    v_pk_mul_f32 v[168:169], v[152:153], v[128:129] op_sel:[0,1] op_sel_hi:[1,1]
    v_pk_mul_f32 v[170:171], v[154:155], v[128:129] op_sel:[0,1] op_sel_hi:[1,1]
    v_pk_fma_f32 v[56:57], v[56:57], v[128:129], v[164:165] op_sel:[0,0,0] op_sel_hi:[1,0,1]
    v_pk_fma_f32 v[58:59], v[58:59], v[128:129], v[166:167] op_sel:[0,0,0] op_sel_hi:[1,0,1]
    v_pk_fma_f32 v[72:73], v[72:73], v[128:129], v[168:169] op_sel:[0,0,0] op_sel_hi:[1,0,1]
    v_pk_fma_f32 v[74:75], v[74:75], v[128:129], v[170:171] op_sel:[0,0,0] op_sel_hi:[1,0,1]
    v_mfma_f32_16x16x32_bf16 v[84:87], v[184:187], v[208:211], v[84:87]
    v_cvt_pk_bf16_f32 v232, v56, v57
    v_cvt_pk_bf16_f32 v233, v58, v59
    v_cvt_pk_bf16_f32 v234, v72, v73
    v_cvt_pk_bf16_f32 v235, v74, v75
    s_nop 1
    v_permlane16_swap_b32 v232, v234
    v_permlane16_swap_b32 v233, v235
    ds_write_b128 v222, v[232:235] offset:0
    v_mfma_f32_16x16x32_bf16 v[88:91], v[188:191], v[196:199], v[88:91]
    v_pk_mul_f32 v[164:165], v[148:149], v[130:131] op_sel:[0,1] op_sel_hi:[1,1]
    v_pk_mul_f32 v[166:167], v[150:151], v[130:131] op_sel:[0,1] op_sel_hi:[1,1]
    v_pk_mul_f32 v[168:169], v[152:153], v[130:131] op_sel:[0,1] op_sel_hi:[1,1]
    v_pk_mul_f32 v[170:171], v[154:155], v[130:131] op_sel:[0,1] op_sel_hi:[1,1]
    v_pk_fma_f32 v[60:61], v[60:61], v[130:131], v[164:165] op_sel:[0,0,0] op_sel_hi:[1,0,1]
    v_pk_fma_f32 v[62:63], v[62:63], v[130:131], v[166:167] op_sel:[0,0,0] op_sel_hi:[1,0,1]
    v_pk_fma_f32 v[76:77], v[76:77], v[130:131], v[168:169] op_sel:[0,0,0] op_sel_hi:[1,0,1]
    v_pk_fma_f32 v[78:79], v[78:79], v[130:131], v[170:171] op_sel:[0,0,0] op_sel_hi:[1,0,1]
    v_mfma_f32_16x16x32_bf16 v[104:107], v[192:195], v[196:199], v[104:107]
    v_cvt_pk_bf16_f32 v236, v60, v61
    v_cvt_pk_bf16_f32 v237, v62, v63
    v_cvt_pk_bf16_f32 v238, v76, v77
    v_cvt_pk_bf16_f32 v239, v78, v79
    s_nop 1
    v_permlane16_swap_b32 v236, v238
    v_permlane16_swap_b32 v237, v239
    ds_write_b128 v222, v[236:239] offset:2048
    v_mfma_f32_16x16x32_bf16 v[92:95], v[188:191], v[200:203], v[92:95]
    v_pk_mul_f32 v[164:165], v[148:149], v[132:133] op_sel:[0,1] op_sel_hi:[1,1]
    v_pk_mul_f32 v[166:167], v[150:151], v[132:133] op_sel:[0,1] op_sel_hi:[1,1]
    v_pk_mul_f32 v[168:169], v[152:153], v[132:133] op_sel:[0,1] op_sel_hi:[1,1]
    v_pk_mul_f32 v[170:171], v[154:155], v[132:133] op_sel:[0,1] op_sel_hi:[1,1]
    v_pk_fma_f32 v[64:65], v[64:65], v[132:133], v[164:165] op_sel:[0,0,0] op_sel_hi:[1,0,1]
    v_pk_fma_f32 v[66:67], v[66:67], v[132:133], v[166:167] op_sel:[0,0,0] op_sel_hi:[1,0,1]
    v_pk_fma_f32 v[80:81], v[80:81], v[132:133], v[168:169] op_sel:[0,0,0] op_sel_hi:[1,0,1]
    v_pk_fma_f32 v[82:83], v[82:83], v[132:133], v[170:171] op_sel:[0,0,0] op_sel_hi:[1,0,1]
    v_mfma_f32_16x16x32_bf16 v[108:111], v[192:195], v[200:203], v[108:111]
    v_cvt_pk_bf16_f32 v240, v64, v65
    v_cvt_pk_bf16_f32 v241, v66, v67
    v_cvt_pk_bf16_f32 v242, v80, v81
    v_cvt_pk_bf16_f32 v243, v82, v83
    s_nop 1
    v_permlane16_swap_b32 v240, v242
    v_permlane16_swap_b32 v241, v243
    ds_write_b128 v222, v[240:243] offset:4096
    v_mfma_f32_16x16x32_bf16 v[96:99], v[188:191], v[204:207], v[96:99]
    v_pk_mul_f32 v[164:165], v[148:149], v[134:135] op_sel:[0,1] op_sel_hi:[1,1]
    v_pk_mul_f32 v[166:167], v[150:151], v[134:135] op_sel:[0,1] op_sel_hi:[1,1]
    v_pk_mul_f32 v[168:169], v[152:153], v[134:135] op_sel:[0,1] op_sel_hi:[1,1]
    v_pk_mul_f32 v[170:171], v[154:155], v[134:135] op_sel:[0,1] op_sel_hi:[1,1]
    v_pk_fma_f32 v[68:69], v[68:69], v[134:135], v[164:165] op_sel:[0,0,0] op_sel_hi:[1,0,1]
    v_pk_fma_f32 v[70:71], v[70:71], v[134:135], v[166:167] op_sel:[0,0,0] op_sel_hi:[1,0,1]
    v_pk_fma_f32 v[84:85], v[84:85], v[134:135], v[168:169] op_sel:[0,0,0] op_sel_hi:[1,0,1]
    v_pk_fma_f32 v[86:87], v[86:87], v[134:135], v[170:171] op_sel:[0,0,0] op_sel_hi:[1,0,1]
    v_mfma_f32_16x16x32_bf16 v[112:115], v[192:195], v[204:207], v[112:115]
    v_cvt_pk_bf16_f32 v244, v68, v69
    v_cvt_pk_bf16_f32 v245, v70, v71
    v_cvt_pk_bf16_f32 v246, v84, v85
    v_cvt_pk_bf16_f32 v247, v86, v87
    s_nop 1
    v_permlane16_swap_b32 v244, v246
    v_permlane16_swap_b32 v245, v247
    ds_write_b128 v222, v[244:247] offset:6144
    v_mfma_f32_16x16x32_bf16 v[100:103], v[188:191], v[208:211], v[100:103]
    v_pk_mul_f32 v[164:165], v[156:157], v[128:129] op_sel:[0,1] op_sel_hi:[1,1]
    v_pk_mul_f32 v[166:167], v[158:159], v[128:129] op_sel:[0,1] op_sel_hi:[1,1]
    v_pk_mul_f32 v[168:169], v[160:161], v[128:129] op_sel:[0,1] op_sel_hi:[1,1]
    v_pk_mul_f32 v[170:171], v[162:163], v[128:129] op_sel:[0,1] op_sel_hi:[1,1]
    v_pk_fma_f32 v[88:89], v[88:89], v[128:129], v[164:165] op_sel:[0,0,0] op_sel_hi:[1,0,1]
    v_pk_fma_f32 v[90:91], v[90:91], v[128:129], v[166:167] op_sel:[0,0,0] op_sel_hi:[1,0,1]
    v_pk_fma_f32 v[104:105], v[104:105], v[128:129], v[168:169] op_sel:[0,0,0] op_sel_hi:[1,0,1]
    v_pk_fma_f32 v[106:107], v[106:107], v[128:129], v[170:171] op_sel:[0,0,0] op_sel_hi:[1,0,1]
    v_mfma_f32_16x16x32_bf16 v[116:119], v[192:195], v[208:211], v[116:119]
    v_cvt_pk_bf16_f32 v232, v88, v89
    v_cvt_pk_bf16_f32 v233, v90, v91
    v_cvt_pk_bf16_f32 v234, v104, v105
    v_cvt_pk_bf16_f32 v235, v106, v107
    s_nop 1
    v_permlane16_swap_b32 v232, v234
    v_permlane16_swap_b32 v233, v235
    ds_write_b128 v223, v[232:235] offset:0
    v_mfma_f32_16x16x32_bf16 v[120:123], v[188:191], v[212:215], v[120:123]
    v_pk_mul_f32 v[164:165], v[156:157], v[130:131] op_sel:[0,1] op_sel_hi:[1,1]
    v_pk_mul_f32 v[166:167], v[158:159], v[130:131] op_sel:[0,1] op_sel_hi:[1,1]
    v_pk_mul_f32 v[168:169], v[160:161], v[130:131] op_sel:[0,1] op_sel_hi:[1,1]
    v_pk_mul_f32 v[170:171], v[162:163], v[130:131] op_sel:[0,1] op_sel_hi:[1,1]
    v_pk_fma_f32 v[92:93], v[92:93], v[130:131], v[164:165] op_sel:[0,0,0] op_sel_hi:[1,0,1]
    v_pk_fma_f32 v[94:95], v[94:95], v[130:131], v[166:167] op_sel:[0,0,0] op_sel_hi:[1,0,1]
    v_pk_fma_f32 v[108:109], v[108:109], v[130:131], v[168:169] op_sel:[0,0,0] op_sel_hi:[1,0,1]
    v_pk_fma_f32 v[110:111], v[110:111], v[130:131], v[170:171] op_sel:[0,0,0] op_sel_hi:[1,0,1]
    v_mfma_f32_16x16x32_bf16 v[124:127], v[192:195], v[212:215], v[124:127]
    v_cvt_pk_bf16_f32 v236, v92, v93
    v_cvt_pk_bf16_f32 v237, v94, v95
    v_cvt_pk_bf16_f32 v238, v108, v109
    v_cvt_pk_bf16_f32 v239, v110, v111
    s_nop 1
    v_permlane16_swap_b32 v236, v238
    v_permlane16_swap_b32 v237, v239
    ds_write_b128 v223, v[236:239] offset:2048
    v_pk_mul_f32 v[164:165], v[156:157], v[132:133] op_sel:[0,1] op_sel_hi:[1,1]
    v_pk_mul_f32 v[166:167], v[158:159], v[132:133] op_sel:[0,1] op_sel_hi:[1,1]
    v_pk_mul_f32 v[168:169], v[160:161], v[132:133] op_sel:[0,1] op_sel_hi:[1,1]
    v_pk_mul_f32 v[170:171], v[162:163], v[132:133] op_sel:[0,1] op_sel_hi:[1,1]
    v_pk_fma_f32 v[96:97], v[96:97], v[132:133], v[164:165] op_sel:[0,0,0] op_sel_hi:[1,0,1]
    v_pk_fma_f32 v[98:99], v[98:99], v[132:133], v[166:167] op_sel:[0,0,0] op_sel_hi:[1,0,1]
    v_pk_fma_f32 v[112:113], v[112:113], v[132:133], v[168:169] op_sel:[0,0,0] op_sel_hi:[1,0,1]
    v_pk_fma_f32 v[114:115], v[114:115], v[132:133], v[170:171] op_sel:[0,0,0] op_sel_hi:[1,0,1]
    v_cvt_pk_bf16_f32 v240, v96, v97
    v_cvt_pk_bf16_f32 v241, v98, v99
    v_cvt_pk_bf16_f32 v242, v112, v113
    v_cvt_pk_bf16_f32 v243, v114, v115
    s_nop 1
    v_permlane16_swap_b32 v240, v242
    v_permlane16_swap_b32 v241, v243
    ds_write_b128 v223, v[240:243] offset:4096
    v_pk_mul_f32 v[164:165], v[156:157], v[134:135] op_sel:[0,1] op_sel_hi:[1,1]
    v_pk_mul_f32 v[166:167], v[158:159], v[134:135] op_sel:[0,1] op_sel_hi:[1,1]
    v_pk_mul_f32 v[168:169], v[160:161], v[134:135] op_sel:[0,1] op_sel_hi:[1,1]
    v_pk_mul_f32 v[170:171], v[162:163], v[134:135] op_sel:[0,1] op_sel_hi:[1,1]
    v_pk_fma_f32 v[100:101], v[100:101], v[134:135], v[164:165] op_sel:[0,0,0] op_sel_hi:[1,0,1]
    v_pk_fma_f32 v[102:103], v[102:103], v[134:135], v[166:167] op_sel:[0,0,0] op_sel_hi:[1,0,1]
    v_pk_fma_f32 v[116:117], v[116:117], v[134:135], v[168:169] op_sel:[0,0,0] op_sel_hi:[1,0,1]
    v_pk_fma_f32 v[118:119], v[118:119], v[134:135], v[170:171] op_sel:[0,0,0] op_sel_hi:[1,0,1]
    v_cvt_pk_bf16_f32 v244, v100, v101
    v_cvt_pk_bf16_f32 v245, v102, v103
    v_cvt_pk_bf16_f32 v246, v116, v117
    v_cvt_pk_bf16_f32 v247, v118, v119
    s_nop 1
    v_permlane16_swap_b32 v244, v246
    v_permlane16_swap_b32 v245, v247
    ds_write_b128 v223, v[244:247] offset:6144
    v_pk_mul_f32 v[164:165], v[156:157], v[136:137] op_sel:[0,1] op_sel_hi:[1,1]
    v_pk_mul_f32 v[166:167], v[158:159], v[136:137] op_sel:[0,1] op_sel_hi:[1,1]
    v_pk_mul_f32 v[168:169], v[160:161], v[136:137] op_sel:[0,1] op_sel_hi:[1,1]
    v_pk_mul_f32 v[170:171], v[162:163], v[136:137] op_sel:[0,1] op_sel_hi:[1,1]
    v_pk_fma_f32 v[120:121], v[120:121], v[136:137], v[164:165] op_sel:[0,0,0] op_sel_hi:[1,0,1]
    v_pk_fma_f32 v[122:123], v[122:123], v[136:137], v[166:167] op_sel:[0,0,0] op_sel_hi:[1,0,1]
    v_pk_fma_f32 v[124:125], v[124:125], v[136:137], v[168:169] op_sel:[0,0,0] op_sel_hi:[1,0,1]
    v_pk_fma_f32 v[126:127], v[126:127], v[136:137], v[170:171] op_sel:[0,0,0] op_sel_hi:[1,0,1]
    v_cvt_pk_bf16_f32 v232, v120, v121
    v_cvt_pk_bf16_f32 v233, v122, v123
    v_cvt_pk_bf16_f32 v234, v124, v125
    v_cvt_pk_bf16_f32 v235, v126, v127
    s_nop 1
    v_permlane16_swap_b32 v232, v234
    v_permlane16_swap_b32 v233, v235
    ds_write_b128 v224, v[232:235]
    s_waitcnt lgkmcnt(0)
g1_attn:
    s_barrier
    ds_read_b128 v[24:27], v226 offset:2048
    ds_read_b128 v[28:31], v226 offset:18432
    ds_read_b128 v[32:35], v226 offset:20480
    ds_read_b128 v[72:75], v226 offset:2176
    ds_read_b128 v[76:79], v226 offset:18560
    ds_read_b128 v[80:83], v226 offset:20608
    ds_read_b64_tr_b16 v[36:37], v227 offset:0
    ds_read_b64_tr_b16 v[38:39], v227 offset:2048
    ds_read_b64_tr_b16 v[40:41], v227 offset:8
    ds_read_b64_tr_b16 v[42:43], v227 offset:2056
    ds_read_b64_tr_b16 v[84:85], v227 offset:128
    ds_read_b64_tr_b16 v[86:87], v227 offset:2176
    ds_read_b64_tr_b16 v[88:89], v227 offset:136
    ds_read_b64_tr_b16 v[90:91], v227 offset:2184
    s_waitcnt lgkmcnt(8)
    v_mfma_f32_16x16x32_bf16 v[44:47], v[28:31], v[24:27], 0
    v_mfma_f32_16x16x32_bf16 v[48:51], v[32:35], v[24:27], 0
    v_mfma_f32_16x16x32_bf16 v[92:95], v[76:79], v[72:75], 0
    v_mfma_f32_16x16x32_bf16 v[96:99], v[80:83], v[72:75], 0
    s_nop 7
    v_cndmask_b32 v44, v48, v44, s[56:57]
    v_cndmask_b32 v45, v49, v45, s[56:57]
    v_cndmask_b32 v46, v50, v46, s[56:57]
    v_cndmask_b32 v47, v51, v47, s[56:57]
    v_cndmask_b32 v92, v96, v92, s[56:57]
    v_cndmask_b32 v93, v97, v93, s[56:57]
    v_cndmask_b32 v94, v98, v94, s[56:57]
    v_cndmask_b32 v95, v99, v95, s[56:57]
    v_cvt_pk_bf16_f32 v48, v44, v45
    v_cvt_pk_bf16_f32 v49, v46, v47
    v_cvt_pk_bf16_f32 v96, v92, v93
    v_cvt_pk_bf16_f32 v97, v94, v95
    v_lshlrev_b32 v44, 16, v48
    v_and_b32 v45, 0xffff0000, v48
    v_lshlrev_b32 v46, 16, v49
    v_and_b32 v47, 0xffff0000, v49
    v_lshlrev_b32 v92, 16, v96
    v_and_b32 v93, 0xffff0000, v96
    v_lshlrev_b32 v94, 16, v97
    v_and_b32 v95, 0xffff0000, v97
    v_mul_f32 v44, s58, v44
    v_mul_f32 v45, s58, v45
    v_mul_f32 v46, s58, v46
    v_mul_f32 v47, s58, v47
    v_mul_f32 v92, s58, v92
    v_mul_f32 v93, s58, v93
    v_mul_f32 v94, s58, v94
    v_mul_f32 v95, s58, v95
    v_cvt_pk_bf16_f32 v48, v44, v45
    v_cvt_pk_bf16_f32 v49, v46, v47
    v_cvt_pk_bf16_f32 v96, v92, v93
    v_cvt_pk_bf16_f32 v97, v94, v95
    v_lshlrev_b32 v44, 16, v48
    v_and_b32 v45, 0xffff0000, v48
    v_lshlrev_b32 v46, 16, v49
    v_and_b32 v47, 0xffff0000, v49
    v_lshlrev_b32 v92, 16, v96
    v_and_b32 v93, 0xffff0000, v96
    v_lshlrev_b32 v94, 16, v97
    v_and_b32 v95, 0xffff0000, v97
    v_fma_f32 v44, v44, s59, v228
    v_fma_f32 v45, v45, s59, v229
    v_fma_f32 v46, v46, s59, v230
    v_fma_f32 v47, v47, s59, v231
    v_fma_f32 v92, v92, s59, v228
    v_fma_f32 v93, v93, s59, v229
    v_fma_f32 v94, v94, s59, v230
    v_fma_f32 v95, v95, s59, v231
    v_max3_f32 v48, v44, v45, v46
    v_max3_f32 v96, v92, v93, v94
    v_max_f32 v48, v48, v47
    v_max_f32 v96, v96, v95
    v_mov_b32 v49, v48
    v_mov_b32 v97, v96
    s_nop 1
    v_permlane16_swap_b32 v48, v49
    v_permlane16_swap_b32 v96, v97
    s_nop 0
    v_max_f32 v48, v48, v49
    v_max_f32 v96, v96, v97
    v_mov_b32 v49, v48
    v_mov_b32 v97, v96
    s_nop 1
    v_permlane32_swap_b32 v48, v49
    v_permlane32_swap_b32 v96, v97
    s_nop 0
    v_max_f32 v48, v48, v49
    v_max_f32 v96, v96, v97
    v_sub_f32 v44, v44, v48
    v_sub_f32 v45, v45, v48
    v_sub_f32 v46, v46, v48
    v_sub_f32 v47, v47, v48
    v_sub_f32 v92, v92, v96
    v_sub_f32 v93, v93, v96
    v_sub_f32 v94, v94, v96
    v_sub_f32 v95, v95, v96
    v_exp_f32 v44, v44
    v_exp_f32 v45, v45
    v_exp_f32 v46, v46
    v_exp_f32 v47, v47
    v_exp_f32 v92, v92
    v_exp_f32 v93, v93
    v_exp_f32 v94, v94
    v_exp_f32 v95, v95
    v_add_f32 v48, v44, v45
    v_add_f32 v49, v46, v47
    v_add_f32 v96, v92, v93
    v_add_f32 v97, v94, v95
    v_add_f32 v48, v48, v49
    v_add_f32 v96, v96, v97
    v_mov_b32 v49, v48
    v_mov_b32 v97, v96
    s_nop 1
    v_permlane16_swap_b32 v48, v49
    v_permlane16_swap_b32 v96, v97
    s_nop 0
    v_add_f32 v48, v48, v49
    v_add_f32 v96, v96, v97
    v_mov_b32 v49, v48
    v_mov_b32 v97, v96
    s_nop 1
    v_permlane32_swap_b32 v48, v49
    v_permlane32_swap_b32 v96, v97
    s_nop 0
    v_add_f32 v48, v48, v49
    v_add_f32 v96, v96, v97
    v_rcp_f32 v48, v48
    v_rcp_f32 v96, v96
    s_nop 0
    v_mul_f32 v44, v44, v48
    v_mul_f32 v45, v45, v48
    v_mul_f32 v46, v46, v48
    v_mul_f32 v47, v47, v48
    v_mul_f32 v92, v92, v96
    v_mul_f32 v93, v93, v96
    v_mul_f32 v94, v94, v96
    v_mul_f32 v95, v95, v96
    v_cvt_pk_bf16_f32 v48, v44, v45
    v_cvt_pk_bf16_f32 v49, v46, v47
    v_cvt_pk_bf16_f32 v96, v92, v93
    v_cvt_pk_bf16_f32 v97, v94, v95
    v_cndmask_b32 v52, 0, v48, s[56:57]
    v_cndmask_b32 v53, 0, v49, s[56:57]
    v_cndmask_b32 v54, v48, 0, s[56:57]
    v_cndmask_b32 v55, v49, 0, s[56:57]
    v_cndmask_b32 v100, 0, v96, s[56:57]
    v_cndmask_b32 v101, 0, v97, s[56:57]
    v_cndmask_b32 v102, v96, 0, s[56:57]
    v_cndmask_b32 v103, v97, 0, s[56:57]
    s_waitcnt lgkmcnt(0)
    s_nop 0
    v_mfma_f32_16x16x32_bf16 v[56:59], v[36:39], v[52:55], 0
    v_mfma_f32_16x16x32_bf16 v[60:63], v[40:43], v[52:55], 0
    v_mfma_f32_16x16x32_bf16 v[104:107], v[84:87], v[100:103], 0
    v_mfma_f32_16x16x32_bf16 v[108:111], v[88:91], v[100:103], 0
    s_nop 7
    v_cvt_pk_bf16_f32 v64, v56, v57
    v_cvt_pk_bf16_f32 v65, v58, v59
    v_cvt_pk_bf16_f32 v66, v60, v61
    v_cvt_pk_bf16_f32 v67, v62, v63
    buffer_store_dwordx4 v[64:67], v225, s[16:19], 0 offen offset:0 sc1
    v_cvt_pk_bf16_f32 v112, v104, v105
    v_cvt_pk_bf16_f32 v113, v106, v107
    v_cvt_pk_bf16_f32 v114, v108, v109
    v_cvt_pk_bf16_f32 v115, v110, v111
    buffer_store_dwordx4 v[112:115], v225, s[16:19], 0 offen offset:2048 sc1
    s_add_u32 s40, s25, 0
    s_lshl_b32 s40, s40, 8
    s_add_u32 s84, s4, 0x300000
    s_addc_u32 s85, s5, 0
    s_mov_b32 s86, 0x4000
    s_mov_b32 s87, 0x20000
    v_mov_b32 v3, s40
    v_mov_b32 v4, 1
    s_waitcnt vmcnt(0)
    s_barrier
    s_cmp_lg_u32 s28, 0
    s_cbranch_scc1 g1_cin
    s_mov_b64 exec, 1
    buffer_atomic_add v4, v3, s[84:87], 0 offen sc1
    s_mov_b64 exec, -1
g1_cin:
    s_branch g2_in
g1_done:
    s_endpgm
.p2align 6
g2_in:
    s_cmp_ge_u32 s2, 256
    s_cbranch_scc1 g2_done
    s_load_dwordx2 s[4:5], s[0:1], 80
    s_load_dwordx2 s[6:7], s[0:1], 0
    s_load_dwordx2 s[30:31], s[0:1], 16
    v_lshrrev_b32 v1, 6, v0
    v_and_b32 v2, 63, v0
    s_and_b32 s40, s2, 3
    s_lshl_b32 s40, s40, 2
    s_bfe_u32 s41, s2, 0x20003
    s_add_u32 s25, s40, s41
    s_bfe_u32 s40, s2, 0x10002
    s_lshl_b32 s40, s40, 3
    s_lshr_b32 s42, s2, 5
    s_add_u32 s24, s40, s42
    s_add_u32 s27, s41, s42
    s_mov_b32 s26, 0
    v_readfirstlane_b32 s28, v1
    s_nop 0
    s_cmp_lt_u32 s28, 4
    s_cbranch_scc1 g2_compute
    s_sub_u32 s28, s28, 4
    s_mov_b32 s40, 2048
    v_lshrrev_b32 v3, 3, v2
    v_mul_lo_u32 v3, v3, s40
    v_bfe_u32 v4, v2, 4, 1
    v_lshlrev_b32 v4, 1, v4
    v_xor_b32 v4, v4, v2
    v_and_b32 v4, 7, v4
    v_lshl_add_u32 v3, v4, 4, v3
    s_mul_i32 s41, s24, 128
    s_mul_i32 s42, s28, 32768
    s_add_u32 s41, s41, s42
    v_xor_b32 v4, 64, v3
    s_add_u32 s42, s41, 0
    v_add_u32 v10, s42, v3
    s_add_u32 s42, s41, 16384
    v_add_u32 v11, s42, v4
    s_mov_b32 s40, 2048
    v_lshrrev_b32 v3, 3, v2
    v_mul_lo_u32 v3, v3, s40
    v_lshrrev_b32 v4, 4, v2
    v_xor_b32 v4, v4, v2
    v_and_b32 v4, 7, v4
    v_lshl_add_u32 v3, v4, 4, v3
    s_mul_i32 s41, s25, 262144
    s_mul_i32 s42, s28, 65536
    s_add_u32 s41, s41, s42
    v_xor_b32 v4, 64, v3
    s_add_u32 s42, s41, 0
    v_add_u32 v12, s42, v3
    s_add_u32 s42, s41, 16384
    v_add_u32 v13, s42, v4
    s_add_u32 s42, s41, 32768
    v_add_u32 v14, s42, v3
    s_add_u32 s42, s41, 49152
    v_add_u32 v15, s42, v4
    s_mul_i32 s36, s28, 2048
    s_mul_i32 s37, s28, 4096
    s_add_u32 s37, s37, 8192
    s_waitcnt lgkmcnt(0)
    s_add_u32 s4, s4, s97
    s_addc_u32 s5, s5, 0
    s_mov_b32 s8, s30
    s_mov_b32 s9, s31
    s_mov_b32 s10, 0x200000
    s_mov_b32 s11, 0x20000
    s_add_u32 s12, s4, 0x400000
    s_addc_u32 s13, s5, 0
    s_mov_b32 s14, 0x400000
    s_mov_b32 s15, 0x20000
    s_mov_b32 s32, 0
    s_mov_b32 s33, 0
g2_ld_pW:
    s_add_u32 s40, s32, s27
    s_and_b32 s40, s40, 1
    s_andn2_b32 s41, s32, 1
    s_or_b32 s40, s40, s41
    s_add_u32 s40, s40, s26
    s_mul_i32 s34, s40, 131072
    s_mul_i32 s35, s40, 128
    s_add_u32 s38, s33, s36
    s_add_u32 s39, s33, s37
    s_add_u32 m0, s38, 0
    s_nop 0
    buffer_load_dwordx4 v10, s[8:11], s34 offen lds
    s_add_u32 m0, s38, 1024
    s_nop 0
    buffer_load_dwordx4 v11, s[8:11], s34 offen lds
    s_add_u32 s33, s33, 24576
    s_add_u32 s32, s32, 1
    s_cmp_lt_u32 s32, 4
    s_cbranch_scc1 g2_ld_pW
    s_lshr_b32 s40, s25, 0
    s_add_u32 s40, s40, 0
    s_lshl_b32 s40, s40, 8
    s_mov_b32 s42, s40
    s_cmp_lg_u32 s28, 0
    s_cbranch_scc1 g2_dep_set
    s_add_u32 s84, s4, 0x300000
    s_addc_u32 s85, s5, 0
    s_mov_b32 s86, 0x4000
    s_mov_b32 s87, 0x20000
    v_cmp_eq_u32 vcc, 1, v2
    v_mov_b32 v21, s40
    v_mov_b32 v23, s42
    v_cndmask_b32 v21, v21, v23, vcc
    v_mov_b32 v22, 16
    v_mov_b32 v23, 16
    v_cndmask_b32 v22, v22, v23, vcc
    buffer_load_dword v23, v21, s[84:87], 0 offen sc1
g2_dep_set:
    s_lshl_b32 s43, s96, 2
    s_add_u32 s43, s43, 2
    s_mov_b32 s41, 0x80000
    v_mov_b32 v24, 131072
    s_cmp_lg_u32 s28, 0
    s_cbranch_scc1 g2_dep_lds
    s_mov_b32 s41, 0x8000
    s_waitcnt vmcnt(0)
g2_dep:
    v_cmp_lt_u32 vcc, v23, v22
    s_sub_u32 s41, s41, 1
    s_cmp_eq_u32 s41, 0
    s_cbranch_scc1 g2_dep_seen
    s_cbranch_vccz g2_dep_seen
    s_sleep 2
    buffer_load_dword v23, v21, s[84:87], 0 offen sc1
    s_waitcnt vmcnt(0)
    s_branch g2_dep
g2_dep_seen:
    v_mov_b32 v23, s43
    ds_write_b32 v24, v23
    s_branch g2_dep_ok
g2_dep_lds:
    ds_read_b32 v23, v24
    s_sub_u32 s41, s41, 1
    s_waitcnt lgkmcnt(0)
    v_readfirstlane_b32 s40, v23
    s_cmp_eq_u32 s41, 0
    s_cbranch_scc1 g2_dep_ok
    s_cmp_eq_u32 s40, s43
    s_cbranch_scc1 g2_dep_ok
    s_sleep 1
    s_branch g2_dep_lds
g2_dep_ok:
    s_mov_b32 s32, 0
    s_mov_b32 s33, 0
g2_ld_pA:
    s_add_u32 s40, s32, s27
    s_and_b32 s40, s40, 1
    s_andn2_b32 s41, s32, 1
    s_or_b32 s40, s40, s41
    s_add_u32 s40, s40, s26
    s_mul_i32 s34, s40, 131072
    s_mul_i32 s35, s40, 128
    s_add_u32 s38, s33, s36
    s_add_u32 s39, s33, s37
    s_add_u32 m0, s39, 0
    s_nop 0
    buffer_load_dwordx4 v12, s[12:15], s35 offen sc1 lds
    s_add_u32 m0, s39, 1024
    s_nop 0
    buffer_load_dwordx4 v13, s[12:15], s35 offen sc1 lds
    s_add_u32 m0, s39, 2048
    s_nop 0
    buffer_load_dwordx4 v14, s[12:15], s35 offen sc1 lds
    s_add_u32 m0, s39, 3072
    s_nop 0
    buffer_load_dwordx4 v15, s[12:15], s35 offen sc1 lds
    s_add_u32 s33, s33, 24576
    s_add_u32 s32, s32, 1
    s_cmp_lt_u32 s32, 3
    s_cbranch_scc1 g2_ld_pA
    s_waitcnt vmcnt(8)
    s_barrier
    s_add_u32 s40, s32, s27
    s_and_b32 s40, s40, 1
    s_andn2_b32 s41, s32, 1
    s_or_b32 s40, s40, s41
    s_add_u32 s40, s40, s26
    s_mul_i32 s34, s40, 131072
    s_mul_i32 s35, s40, 128
    s_add_u32 s38, s33, s36
    s_add_u32 s39, s33, s37
    s_add_u32 m0, s39, 0
    s_nop 0
    buffer_load_dwordx4 v12, s[12:15], s35 offen sc1 lds
    s_add_u32 m0, s39, 1024
    s_nop 0
    buffer_load_dwordx4 v13, s[12:15], s35 offen sc1 lds
    s_add_u32 m0, s39, 2048
    s_nop 0
    buffer_load_dwordx4 v14, s[12:15], s35 offen sc1 lds
    s_add_u32 m0, s39, 3072
    s_nop 0
    buffer_load_dwordx4 v15, s[12:15], s35 offen sc1 lds
    s_mov_b32 s33, 0
    s_add_u32 s32, s32, 1
g2_ld_loop:
    s_cmp_eq_u32 s32, 4
    s_cbranch_scc1 g2_ld_s4
    s_cmp_eq_u32 s32, 5
    s_cbranch_scc1 g2_ld_s5
    s_waitcnt vmcnt(12)
g2_ld_bar:
    s_barrier
    s_add_u32 s40, s32, s27
    s_and_b32 s40, s40, 1
    s_andn2_b32 s41, s32, 1
    s_or_b32 s40, s40, s41
    s_add_u32 s40, s40, s26
    s_mul_i32 s34, s40, 131072
    s_mul_i32 s35, s40, 128
    s_add_u32 s38, s33, s36
    s_add_u32 s39, s33, s37
    s_add_u32 m0, s38, 0
    s_nop 0
    buffer_load_dwordx4 v10, s[8:11], s34 offen lds
    s_add_u32 m0, s38, 1024
    s_nop 0
    buffer_load_dwordx4 v11, s[8:11], s34 offen lds
    s_add_u32 m0, s39, 0
    s_nop 0
    buffer_load_dwordx4 v12, s[12:15], s35 offen sc1 lds
    s_add_u32 m0, s39, 1024
    s_nop 0
    buffer_load_dwordx4 v13, s[12:15], s35 offen sc1 lds
    s_add_u32 m0, s39, 2048
    s_nop 0
    buffer_load_dwordx4 v14, s[12:15], s35 offen sc1 lds
    s_add_u32 m0, s39, 3072
    s_nop 0
    buffer_load_dwordx4 v15, s[12:15], s35 offen sc1 lds
    s_add_u32 s33, s33, 24576
    s_add_u32 s32, s32, 1
    s_cmp_eq_u32 s33, 98304
    s_cselect_b32 s33, 0, s33
    s_cmp_lt_u32 s32, 16
    s_cbranch_scc1 g2_ld_loop
    s_waitcnt vmcnt(12)
    s_barrier
    s_waitcnt vmcnt(6)
    s_barrier
    s_waitcnt vmcnt(0)
    s_barrier
    s_branch g2_ld_end
g2_ld_s4:
    s_waitcnt vmcnt(8)
    s_branch g2_ld_bar
g2_ld_s5:
    s_waitcnt vmcnt(10)
    s_branch g2_ld_bar
g2_ld_end:
    s_barrier
    s_branch g3_in
g2_done:
    s_endpgm
g2_compute:
    v_lshrrev_b32 v5, 4, v2
    v_bfe_u32 v6, v2, 2, 2
    v_and_b32 v7, 3, v2
    v_and_b32 v8, 15, v2
    s_and_b32 s44, s28, 0
    s_lshr_b32 s45, s28, 0
    s_mul_i32 s40, s25, 128
    s_mul_i32 s41, s45, 32
    s_add_u32 s40, s40, s41
    v_add_u32 v20, s40, v8
    s_mov_b32 s41, 2048
    v_mul_lo_u32 v9, v20, s41
    s_mul_i32 s40, s24, 128
    s_mul_i32 s41, s44, 128
    s_add_u32 s46, s40, s41
    v_and_b32 v3, 1, v5
    v_lshlrev_b32 v3, 5, v3
    v_lshrrev_b32 v4, 1, v5
    v_lshl_add_u32 v3, v4, 4, v3
    v_add3_u32 v9, v9, v3, s46
    s_mov_b32 s52, 0
    s_mov_b32 s53, 32768
    s_waitcnt lgkmcnt(0)
    s_add_u32 s4, s4, s97
    s_addc_u32 s5, s5, 0
    s_add_u32 s20, s4, 0x1900000
    s_addc_u32 s21, s5, 0
    s_cmp_eq_u32 s96, 1
    s_cselect_b32 s20, s20, s6
    s_cselect_b32 s21, s21, s7
    s_mov_b32 s22, 0x400000
    s_mov_b32 s23, 0x20000
    s_add_u32 s16, s4, 0x800000
    s_addc_u32 s17, s5, 0
    s_mov_b32 s18, 0x400000
    s_mov_b32 s19, 0x20000
    s_add_u32 s56, s4, 0xc00000
    s_addc_u32 s57, s5, 0
    s_mov_b32 s58, 0x480000
    s_mov_b32 s59, 0x20000
    s_add_u32 s60, s4, 0x200000
    s_addc_u32 s61, s5, 0
    s_mov_b32 s62, 0x40000
    s_mov_b32 s63, 0x20000
    s_mul_i32 s42, s44, 4
    s_mov_b32 s43, 0
    v_and_b32 v3, 1, v5
    v_lshlrev_b32 v3, 1, v3
    v_lshrrev_b32 v4, 1, v6
    v_or_b32 v3, v3, v4
    s_add_u32 s40, s42, 0
    v_xor_b32 v3, s40, v3
    v_lshlrev_b32 v3, 5, v3
    v_lshl_add_u32 v3, v7, 3, v3
    v_lshl_add_u32 v4, v5, 3, v6
    v_lshl_add_u32 v3, v4, 7, v3
    v_add_u32 v10, s43, v3
    v_and_b32 v3, 1, v5
    v_lshlrev_b32 v3, 1, v3
    v_lshrrev_b32 v4, 1, v6
    v_or_b32 v3, v3, v4
    s_add_u32 s40, s42, 1
    v_xor_b32 v3, s40, v3
    v_lshlrev_b32 v3, 5, v3
    v_lshl_add_u32 v3, v7, 3, v3
    v_lshl_add_u32 v4, v5, 3, v6
    v_lshl_add_u32 v3, v4, 7, v3
    v_add_u32 v11, s43, v3
    v_and_b32 v3, 1, v5
    v_lshlrev_b32 v3, 1, v3
    v_lshrrev_b32 v4, 1, v6
    v_or_b32 v3, v3, v4
    s_add_u32 s40, s42, 2
    v_xor_b32 v3, s40, v3
    v_lshlrev_b32 v3, 5, v3
    v_lshl_add_u32 v3, v7, 3, v3
    v_lshl_add_u32 v4, v5, 3, v6
    v_lshl_add_u32 v3, v4, 7, v3
    v_add_u32 v12, s43, v3
    v_and_b32 v3, 1, v5
    v_lshlrev_b32 v3, 1, v3
    v_lshrrev_b32 v4, 1, v6
    v_or_b32 v3, v3, v4
    s_add_u32 s40, s42, 3
    v_xor_b32 v3, s40, v3
    v_lshlrev_b32 v3, 5, v3
    v_lshl_add_u32 v3, v7, 3, v3
    v_lshl_add_u32 v4, v5, 3, v6
    v_lshl_add_u32 v3, v4, 7, v3
    v_add_u32 v13, s43, v3
    s_mul_i32 s42, s45, 32
    v_lshrrev_b32 v3, 1, v8
    v_xor_b32 v3, v3, v5
    v_lshlrev_b32 v3, 4, v3
    v_lshl_add_u32 v3, v8, 7, v3
    s_lshl_b32 s40, s42, 7
    s_add_u32 s40, s40, 8192
    v_add_u32 v14, s40, v3
    v_xor_b32 v15, 64, v14
    v_mov_b32 v84, 0
    v_mov_b32 v85, 0
    v_mov_b32 v86, 0
    v_mov_b32 v87, 0
    v_mov_b32 v88, 0
    v_mov_b32 v89, 0
    v_mov_b32 v90, 0
    v_mov_b32 v91, 0
    v_mov_b32 v92, 0
    v_mov_b32 v93, 0
    v_mov_b32 v94, 0
    v_mov_b32 v95, 0
    v_mov_b32 v96, 0
    v_mov_b32 v97, 0
    v_mov_b32 v98, 0
    v_mov_b32 v99, 0
    v_mov_b32 v100, 0
    v_mov_b32 v101, 0
    v_mov_b32 v102, 0
    v_mov_b32 v103, 0
    v_mov_b32 v104, 0
    v_mov_b32 v105, 0
    v_mov_b32 v106, 0
    v_mov_b32 v107, 0
    s_mov_b32 s48, 16
    s_mov_b32 s50, 0
    s_mov_b32 s51, 24576
    s_mov_b32 s29, 0xfffee000
    v_mov_b32 v28, 0
    v_mov_b32 v29, 0
    v_mov_b32 v30, 0
    v_mov_b32 v31, 0
    v_mov_b32 v32, 0
    v_mov_b32 v33, 0
    v_mov_b32 v34, 0
    v_mov_b32 v35, 0
    v_mov_b32 v36, 0
    v_mov_b32 v37, 0
    v_mov_b32 v38, 0
    v_mov_b32 v39, 0
    v_mov_b32 v40, 0
    v_mov_b32 v41, 0
    v_mov_b32 v42, 0
    v_mov_b32 v43, 0
    v_mov_b32 v44, 0
    v_mov_b32 v45, 0
    v_mov_b32 v46, 0
    v_mov_b32 v47, 0
    v_mov_b32 v48, 0
    v_mov_b32 v49, 0
    v_mov_b32 v50, 0
    v_mov_b32 v51, 0
    v_mov_b32 v52, 0
    v_mov_b32 v53, 0
    v_mov_b32 v54, 0
    v_mov_b32 v55, 0
    v_mov_b32 v56, 0
    v_mov_b32 v57, 0
    v_mov_b32 v58, 0
    v_mov_b32 v59, 0
    s_barrier
    buffer_load_dwordx4 v[124:127], v9, s[20:23], s52 offen offset:0 sc1
    buffer_load_dwordx4 v[128:131], v9, s[20:23], s52 offen offset:64 sc1
    buffer_load_dwordx4 v[132:135], v9, s[20:23], s53 offen offset:0 sc1
    buffer_load_dwordx4 v[136:139], v9, s[20:23], s53 offen offset:64 sc1
    s_branch g2_cloop2
g2_mid:
    s_waitcnt vmcnt(0)
    s_nop 7
    v_permlane16_swap_b32 v124, v126
    v_permlane16_swap_b32 v125, v127
    v_permlane16_swap_b32 v128, v130
    v_permlane16_swap_b32 v129, v131
    v_permlane16_swap_b32 v132, v134
    v_permlane16_swap_b32 v133, v135
    v_permlane16_swap_b32 v136, v138
    v_permlane16_swap_b32 v137, v139
    v_lshlrev_b32 v140, 16, v124
    v_and_b32 v141, 0xffff0000, v124
    v_lshlrev_b32 v142, 16, v125
    v_and_b32 v143, 0xffff0000, v125
    v_lshlrev_b32 v144, 16, v126
    v_and_b32 v145, 0xffff0000, v126
    v_lshlrev_b32 v146, 16, v127
    v_and_b32 v147, 0xffff0000, v127
    v_pk_add_f32 v[28:29], v[28:29], v[140:141]
    v_pk_add_f32 v[30:31], v[30:31], v[142:143]
    v_pk_add_f32 v[36:37], v[36:37], v[144:145]
    v_pk_add_f32 v[38:39], v[38:39], v[146:147]
    v_lshlrev_b32 v140, 16, v128
    v_and_b32 v141, 0xffff0000, v128
    v_lshlrev_b32 v142, 16, v129
    v_and_b32 v143, 0xffff0000, v129
    v_lshlrev_b32 v144, 16, v130
    v_and_b32 v145, 0xffff0000, v130
    v_lshlrev_b32 v146, 16, v131
    v_and_b32 v147, 0xffff0000, v131
    v_pk_add_f32 v[44:45], v[44:45], v[140:141]
    v_pk_add_f32 v[46:47], v[46:47], v[142:143]
    v_pk_add_f32 v[52:53], v[52:53], v[144:145]
    v_pk_add_f32 v[54:55], v[54:55], v[146:147]
    v_lshlrev_b32 v140, 16, v132
    v_and_b32 v141, 0xffff0000, v132
    v_lshlrev_b32 v142, 16, v133
    v_and_b32 v143, 0xffff0000, v133
    v_lshlrev_b32 v144, 16, v134
    v_and_b32 v145, 0xffff0000, v134
    v_lshlrev_b32 v146, 16, v135
    v_and_b32 v147, 0xffff0000, v135
    v_pk_add_f32 v[32:33], v[32:33], v[140:141]
    v_pk_add_f32 v[34:35], v[34:35], v[142:143]
    v_pk_add_f32 v[40:41], v[40:41], v[144:145]
    v_pk_add_f32 v[42:43], v[42:43], v[146:147]
    v_lshlrev_b32 v140, 16, v136
    v_and_b32 v141, 0xffff0000, v136
    v_lshlrev_b32 v142, 16, v137
    v_and_b32 v143, 0xffff0000, v137
    v_lshlrev_b32 v144, 16, v138
    v_and_b32 v145, 0xffff0000, v138
    v_lshlrev_b32 v146, 16, v139
    v_and_b32 v147, 0xffff0000, v139
    v_pk_add_f32 v[48:49], v[48:49], v[140:141]
    v_pk_add_f32 v[50:51], v[50:51], v[142:143]
    v_pk_add_f32 v[56:57], v[56:57], v[144:145]
    v_pk_add_f32 v[58:59], v[58:59], v[146:147]
    s_nop 1
    s_branch g2_cloop2
.p2align 3
g2_cloop:
    s_barrier
    s_cmp_eq_u32 s48, 8
    s_cbranch_scc1 g2_mid
g2_cloop2:
    v_mfma_f32_16x16x32_bf16 v[28:31], v[84:87], v[100:103], v[28:31]
    ds_read_b64_tr_b16 v[60:61], v10 offset:0
    ds_read_b64_tr_b16 v[62:63], v10 offset:512
    v_mfma_f32_16x16x32_bf16 v[32:35], v[84:87], v[104:107], v[32:35]
    ds_read_b128 v[76:79], v14 offset:0
    v_mfma_f32_16x16x32_bf16 v[40:43], v[88:91], v[104:107], v[40:43]
    ds_read_b128 v[80:83], v14 offset:2048
    v_mfma_f32_16x16x32_bf16 v[36:39], v[88:91], v[100:103], v[36:39]
    ds_read_b64_tr_b16 v[64:65], v11 offset:0
    ds_read_b64_tr_b16 v[66:67], v11 offset:512
    v_mfma_f32_16x16x32_bf16 v[44:47], v[92:95], v[100:103], v[44:47]
    ds_read_b64_tr_b16 v[68:69], v12 offset:0
    ds_read_b64_tr_b16 v[70:71], v12 offset:512
    v_mfma_f32_16x16x32_bf16 v[48:51], v[92:95], v[104:107], v[48:51]
    ds_read_b64_tr_b16 v[72:73], v13 offset:0
    ds_read_b64_tr_b16 v[74:75], v13 offset:512
    v_mfma_f32_16x16x32_bf16 v[56:59], v[96:99], v[104:107], v[56:59]
    v_mfma_f32_16x16x32_bf16 v[52:55], v[96:99], v[100:103], v[52:55]
    s_waitcnt lgkmcnt(0)
    v_mfma_f32_16x16x32_bf16 v[28:31], v[60:63], v[76:79], v[28:31]
    ds_read_b64_tr_b16 v[84:85], v10 offset:4096
    ds_read_b64_tr_b16 v[86:87], v10 offset:4608
    v_mfma_f32_16x16x32_bf16 v[32:35], v[60:63], v[80:83], v[32:35]
    ds_read_b128 v[100:103], v15 offset:0
    v_mfma_f32_16x16x32_bf16 v[40:43], v[64:67], v[80:83], v[40:43]
    ds_read_b128 v[104:107], v15 offset:2048
    v_mfma_f32_16x16x32_bf16 v[36:39], v[64:67], v[76:79], v[36:39]
    ds_read_b64_tr_b16 v[88:89], v11 offset:4096
    ds_read_b64_tr_b16 v[90:91], v11 offset:4608
    v_mfma_f32_16x16x32_bf16 v[44:47], v[68:71], v[76:79], v[44:47]
    ds_read_b64_tr_b16 v[92:93], v12 offset:4096
    ds_read_b64_tr_b16 v[94:95], v12 offset:4608
    v_mfma_f32_16x16x32_bf16 v[48:51], v[68:71], v[80:83], v[48:51]
    ds_read_b64_tr_b16 v[96:97], v13 offset:4096
    ds_read_b64_tr_b16 v[98:99], v13 offset:4608
    v_mfma_f32_16x16x32_bf16 v[56:59], v[72:75], v[80:83], v[56:59]
    s_add_u32 s50, s50, 1
    s_cmp_eq_u32 s50, 4
    v_mfma_f32_16x16x32_bf16 v[52:55], v[72:75], v[76:79], v[52:55]
    s_cselect_b32 s49, s29, s51
    s_cselect_b32 s50, 0, s50
    v_add_u32 v10, s49, v10
    v_add_u32 v11, s49, v11
    v_add_u32 v12, s49, v12
    v_add_u32 v13, s49, v13
    v_add_u32 v14, s49, v14
    v_add_u32 v15, s49, v15
    s_sub_u32 s48, s48, 1
    s_cmp_lg_u32 s48, 0
    s_waitcnt lgkmcnt(0)
    s_cbranch_scc1 g2_cloop
    v_mfma_f32_16x16x32_bf16 v[28:31], v[84:87], v[100:103], v[28:31]
    v_mfma_f32_16x16x32_bf16 v[32:35], v[84:87], v[104:107], v[32:35]
    v_mfma_f32_16x16x32_bf16 v[40:43], v[88:91], v[104:107], v[40:43]
    v_mfma_f32_16x16x32_bf16 v[36:39], v[88:91], v[100:103], v[36:39]
    v_mfma_f32_16x16x32_bf16 v[44:47], v[92:95], v[100:103], v[44:47]
    v_mfma_f32_16x16x32_bf16 v[48:51], v[92:95], v[104:107], v[48:51]
    v_mfma_f32_16x16x32_bf16 v[56:59], v[96:99], v[104:107], v[56:59]
    v_mfma_f32_16x16x32_bf16 v[52:55], v[96:99], v[100:103], v[52:55]
    s_nop 7
    v_pk_add_f32 v[76:77], v[28:29], v[30:31]
    v_pk_mul_f32 v[78:79], v[28:29], v[28:29]
    v_pk_fma_f32 v[78:79], v[30:31], v[30:31], v[78:79]
    v_pk_add_f32 v[76:77], v[76:77], v[36:37]
    v_pk_fma_f32 v[78:79], v[36:37], v[36:37], v[78:79]
    v_pk_add_f32 v[76:77], v[76:77], v[38:39]
    v_pk_fma_f32 v[78:79], v[38:39], v[38:39], v[78:79]
    v_pk_add_f32 v[76:77], v[76:77], v[44:45]
    v_pk_fma_f32 v[78:79], v[44:45], v[44:45], v[78:79]
    v_pk_add_f32 v[76:77], v[76:77], v[46:47]
    v_pk_fma_f32 v[78:79], v[46:47], v[46:47], v[78:79]
    v_pk_add_f32 v[76:77], v[76:77], v[52:53]
    v_pk_fma_f32 v[78:79], v[52:53], v[52:53], v[78:79]
    v_pk_add_f32 v[76:77], v[76:77], v[54:55]
    v_pk_fma_f32 v[78:79], v[54:55], v[54:55], v[78:79]
    v_pk_add_f32 v[80:81], v[32:33], v[34:35]
    v_pk_mul_f32 v[82:83], v[32:33], v[32:33]
    v_pk_fma_f32 v[82:83], v[34:35], v[34:35], v[82:83]
    v_pk_add_f32 v[80:81], v[80:81], v[40:41]
    v_pk_fma_f32 v[82:83], v[40:41], v[40:41], v[82:83]
    v_pk_add_f32 v[80:81], v[80:81], v[42:43]
    v_pk_fma_f32 v[82:83], v[42:43], v[42:43], v[82:83]
    v_pk_add_f32 v[80:81], v[80:81], v[48:49]
    v_pk_fma_f32 v[82:83], v[48:49], v[48:49], v[82:83]
    v_pk_add_f32 v[80:81], v[80:81], v[50:51]
    v_pk_fma_f32 v[82:83], v[50:51], v[50:51], v[82:83]
    v_pk_add_f32 v[80:81], v[80:81], v[56:57]
    v_pk_fma_f32 v[82:83], v[56:57], v[56:57], v[82:83]
    v_pk_add_f32 v[80:81], v[80:81], v[58:59]
    v_pk_fma_f32 v[82:83], v[58:59], v[58:59], v[82:83]
    v_add_f32 v76, v76, v77
    v_add_f32 v77, v78, v79
    v_add_f32 v80, v80, v81
    v_add_f32 v81, v82, v83
    s_nop 1
    v_permlane16_swap_b32 v76, v80
    v_permlane16_swap_b32 v77, v81
    v_pk_add_f32 v[76:77], v[76:77], v[80:81]
    v_mov_b32 v84, v76
    v_mov_b32 v85, v77
    v_and_b32 v3, 16, v2
    v_add_u32 v3, v3, v20
    v_permlane32_swap_b32 v76, v84
    v_permlane32_swap_b32 v77, v85
    v_pk_add_f32 v[76:77], v[76:77], v[84:85]
    v_lshlrev_b32 v3, 3, v3
    s_mul_i32 s40, s24, 1
    s_add_u32 s40, s40, s44
    s_lshl_b32 s40, s40, 14
    s_mov_b32 exec_hi, 0
    buffer_store_dwordx2 v[76:77], v3, s[60:63], s40 offen sc1
    s_mov_b32 exec_hi, -1
    v_lshrrev_b32 v4, 5, v2
    v_lshl_add_u32 v21, v4, 17, v3
    v_cvt_pk_bf16_f32 v60, v28, v29
    v_cvt_pk_bf16_f32 v61, v30, v31
    v_cvt_pk_bf16_f32 v62, v36, v37
    v_cvt_pk_bf16_f32 v63, v38, v39
    v_lshlrev_b32 v28, 16, v60
    v_and_b32 v29, 0xffff0000, v60
    v_lshlrev_b32 v30, 16, v61
    v_and_b32 v31, 0xffff0000, v61
    v_lshlrev_b32 v36, 16, v62
    v_and_b32 v37, 0xffff0000, v62
    v_lshlrev_b32 v38, 16, v63
    v_and_b32 v39, 0xffff0000, v63
    v_permlane16_swap_b32 v60, v62
    v_permlane16_swap_b32 v61, v63
    buffer_store_dwordx4 v[60:63], v9, s[16:19], s52 offen offset:0 sc1
    v_cvt_pk_bf16_f32 v64, v44, v45
    v_cvt_pk_bf16_f32 v65, v46, v47
    v_cvt_pk_bf16_f32 v66, v52, v53
    v_cvt_pk_bf16_f32 v67, v54, v55
    v_lshlrev_b32 v44, 16, v64
    v_and_b32 v45, 0xffff0000, v64
    v_lshlrev_b32 v46, 16, v65
    v_and_b32 v47, 0xffff0000, v65
    v_lshlrev_b32 v52, 16, v66
    v_and_b32 v53, 0xffff0000, v66
    v_lshlrev_b32 v54, 16, v67
    v_and_b32 v55, 0xffff0000, v67
    v_permlane16_swap_b32 v64, v66
    v_permlane16_swap_b32 v65, v67
    buffer_store_dwordx4 v[64:67], v9, s[16:19], s52 offen offset:64 sc1
    v_cvt_pk_bf16_f32 v68, v32, v33
    v_cvt_pk_bf16_f32 v69, v34, v35
    v_cvt_pk_bf16_f32 v70, v40, v41
    v_cvt_pk_bf16_f32 v71, v42, v43
    v_lshlrev_b32 v32, 16, v68
    v_and_b32 v33, 0xffff0000, v68
    v_lshlrev_b32 v34, 16, v69
    v_and_b32 v35, 0xffff0000, v69
    v_lshlrev_b32 v40, 16, v70
    v_and_b32 v41, 0xffff0000, v70
    v_lshlrev_b32 v42, 16, v71
    v_and_b32 v43, 0xffff0000, v71
    v_permlane16_swap_b32 v68, v70
    v_permlane16_swap_b32 v69, v71
    buffer_store_dwordx4 v[68:71], v9, s[16:19], s53 offen offset:0 sc1
    v_cvt_pk_bf16_f32 v72, v48, v49
    v_cvt_pk_bf16_f32 v73, v50, v51
    v_cvt_pk_bf16_f32 v74, v56, v57
    v_cvt_pk_bf16_f32 v75, v58, v59
    v_lshlrev_b32 v48, 16, v72
    v_and_b32 v49, 0xffff0000, v72
    v_lshlrev_b32 v50, 16, v73
    v_and_b32 v51, 0xffff0000, v73
    v_lshlrev_b32 v56, 16, v74
    v_and_b32 v57, 0xffff0000, v74
    v_lshlrev_b32 v58, 16, v75
    v_and_b32 v59, 0xffff0000, v75
    v_permlane16_swap_b32 v72, v74
    v_permlane16_swap_b32 v73, v75
    buffer_store_dwordx4 v[72:75], v9, s[16:19], s53 offen offset:64 sc1
    s_mov_b32 s48, 0x2000
    v_mul_u32_u24 v19, 256, v20
    v_add_u32 v19, v19, v9
    s_mov_b32 s54, 0
    s_mov_b32 s55, 36864
    s_mov_b32 s40, 0
    buffer_load_dwordx2 v[108:109], v21, s[60:63], s40 offen sc1
    s_mov_b32 s41, 16384
    buffer_load_dwordx2 v[110:111], v21, s[60:63], s41 offen sc1
    s_mov_b32 s40, 32768
    buffer_load_dwordx2 v[112:113], v21, s[60:63], s40 offen sc1
    s_mov_b32 s41, 49152
    buffer_load_dwordx2 v[114:115], v21, s[60:63], s41 offen sc1
    s_mov_b32 s40, 65536
    buffer_load_dwordx2 v[116:117], v21, s[60:63], s40 offen sc1
    s_mov_b32 s41, 81920
    buffer_load_dwordx2 v[118:119], v21, s[60:63], s41 offen sc1
    s_mov_b32 s40, 98304
    buffer_load_dwordx2 v[120:121], v21, s[60:63], s40 offen sc1
    s_mov_b32 s41, 114688
    buffer_load_dwordx2 v[122:123], v21, s[60:63], s41 offen sc1
    s_waitcnt vmcnt(0)
g2_ex:
    v_max3_u32 v4, v108, v109, v110
    v_max3_u32 v4, v4, v111, v112
    v_max3_u32 v4, v4, v113, v114
    v_max3_u32 v4, v4, v115, v116
    v_max3_u32 v4, v4, v117, v118
    v_max3_u32 v4, v4, v119, v120
    v_max3_u32 v4, v4, v121, v122
    v_max_u32 v4, v4, v123
    v_cmp_eq_u32 vcc, -1, v4
    s_sub_u32 s48, s48, 1
    s_cmp_eq_u32 s48, 0
    s_cbranch_scc1 g2_exd
    s_cbranch_vccz g2_exd
    s_sleep 2
    s_mov_b32 s40, 0
    buffer_load_dwordx2 v[108:109], v21, s[60:63], s40 offen sc1
    s_mov_b32 s41, 16384
    buffer_load_dwordx2 v[110:111], v21, s[60:63], s41 offen sc1
    s_mov_b32 s40, 32768
    buffer_load_dwordx2 v[112:113], v21, s[60:63], s40 offen sc1
    s_mov_b32 s41, 49152
    buffer_load_dwordx2 v[114:115], v21, s[60:63], s41 offen sc1
    s_mov_b32 s40, 65536
    buffer_load_dwordx2 v[116:117], v21, s[60:63], s40 offen sc1
    s_mov_b32 s41, 81920
    buffer_load_dwordx2 v[118:119], v21, s[60:63], s41 offen sc1
    s_mov_b32 s40, 98304
    buffer_load_dwordx2 v[120:121], v21, s[60:63], s40 offen sc1
    s_mov_b32 s41, 114688
    buffer_load_dwordx2 v[122:123], v21, s[60:63], s41 offen sc1
    s_waitcnt vmcnt(0)
    s_branch g2_ex
g2_exd:
    v_pk_add_f32 v[108:109], v[108:109], v[116:117]
    v_pk_add_f32 v[110:111], v[110:111], v[118:119]
    v_pk_add_f32 v[112:113], v[112:113], v[120:121]
    v_pk_add_f32 v[114:115], v[114:115], v[122:123]
    v_pk_add_f32 v[108:109], v[108:109], v[112:113]
    v_pk_add_f32 v[110:111], v[110:111], v[114:115]
    v_pk_add_f32 v[108:109], v[108:109], v[110:111]
    v_mov_b32 v110, v108
    v_mov_b32 v111, v109
    s_nop 1
    v_permlane32_swap_b32 v108, v110
    v_permlane32_swap_b32 v109, v111
    v_pk_add_f32 v[108:109], v[108:109], v[110:111]
    v_mul_f32 v108, 0x3a800000, v108
    v_mul_f32 v109, 0x3a800000, v109
    v_fma_f32 v109, -v108, v108, v109
    v_max_f32 v109, 0, v109
    v_mov_b32 v110, v108
    v_mov_b32 v111, v109
    v_cvt_pk_bf16_f32 v110, v110, v110
    v_lshlrev_b32 v110, 16, v110
    v_cvt_pk_bf16_f32 v111, v111, v111
    v_lshlrev_b32 v111, 16, v111
    v_add_f32 v111, 0x3727c5ac, v111
    v_cvt_pk_bf16_f32 v111, v111, v111
    v_lshlrev_b32 v111, 16, v111
    v_sqrt_f32 v111, v111
    s_nop 0
    v_cvt_pk_bf16_f32 v111, v111, v111
    v_lshlrev_b32 v111, 16, v111
    v_rcp_f32 v111, v111
    v_sub_f32 v112, v108, v110
    v_mul_f32 v113, v109, v111
    v_mul_f32 v112, v112, v111
    v_mul_f32 v113, v113, v111
    v_cvt_pk_bf16_f32 v112, v112, v112
    v_lshlrev_b32 v112, 16, v112
    v_cvt_pk_bf16_f32 v113, v113, v113
    v_lshlrev_b32 v113, 16, v113
    v_add_f32 v113, 0x3727c5ac, v113
    v_cvt_pk_bf16_f32 v113, v113, v113
    v_lshlrev_b32 v113, 16, v113
    v_sqrt_f32 v113, v113
    s_nop 0
    v_cvt_pk_bf16_f32 v113, v113, v113
    v_lshlrev_b32 v113, 16, v113
    v_rcp_f32 v113, v113
    v_fma_f32 v112, v110, v111, v112
    v_mul_f32 v114, v111, v113
    v_mul_f32 v115, -v112, v113
    v_mov_b32 v116, v114
    v_mov_b32 v117, v115
    s_nop 1
    v_permlane16_swap_b32 v114, v116
    v_permlane16_swap_b32 v115, v117
    v_pk_fma_f32 v[28:29], v[28:29], v[114:115], v[114:115] op_sel:[0,0,1] op_sel_hi:[1,0,1]
    v_pk_fma_f32 v[30:31], v[30:31], v[114:115], v[114:115] op_sel:[0,0,1] op_sel_hi:[1,0,1]
    v_pk_fma_f32 v[36:37], v[36:37], v[114:115], v[114:115] op_sel:[0,0,1] op_sel_hi:[1,0,1]
    v_pk_fma_f32 v[38:39], v[38:39], v[114:115], v[114:115] op_sel:[0,0,1] op_sel_hi:[1,0,1]
    v_cvt_pk_bf16_f32 v124, v28, v29
    v_cvt_pk_bf16_f32 v125, v30, v31
    v_cvt_pk_bf16_f32 v126, v36, v37
    v_cvt_pk_bf16_f32 v127, v38, v39
    s_nop 1
    v_permlane16_swap_b32 v124, v126
    v_permlane16_swap_b32 v125, v127
    buffer_store_dwordx4 v[124:127], v19, s[56:59], s54 offen offset:0 sc1
    v_pk_fma_f32 v[44:45], v[44:45], v[114:115], v[114:115] op_sel:[0,0,1] op_sel_hi:[1,0,1]
    v_pk_fma_f32 v[46:47], v[46:47], v[114:115], v[114:115] op_sel:[0,0,1] op_sel_hi:[1,0,1]
    v_pk_fma_f32 v[52:53], v[52:53], v[114:115], v[114:115] op_sel:[0,0,1] op_sel_hi:[1,0,1]
    v_pk_fma_f32 v[54:55], v[54:55], v[114:115], v[114:115] op_sel:[0,0,1] op_sel_hi:[1,0,1]
    v_cvt_pk_bf16_f32 v128, v44, v45
    v_cvt_pk_bf16_f32 v129, v46, v47
    v_cvt_pk_bf16_f32 v130, v52, v53
    v_cvt_pk_bf16_f32 v131, v54, v55
    s_nop 1
    v_permlane16_swap_b32 v128, v130
    v_permlane16_swap_b32 v129, v131
    buffer_store_dwordx4 v[128:131], v19, s[56:59], s54 offen offset:64 sc1
    v_pk_fma_f32 v[32:33], v[32:33], v[116:117], v[116:117] op_sel:[0,0,1] op_sel_hi:[1,0,1]
    v_pk_fma_f32 v[34:35], v[34:35], v[116:117], v[116:117] op_sel:[0,0,1] op_sel_hi:[1,0,1]
    v_pk_fma_f32 v[40:41], v[40:41], v[116:117], v[116:117] op_sel:[0,0,1] op_sel_hi:[1,0,1]
    v_pk_fma_f32 v[42:43], v[42:43], v[116:117], v[116:117] op_sel:[0,0,1] op_sel_hi:[1,0,1]
    v_cvt_pk_bf16_f32 v132, v32, v33
    v_cvt_pk_bf16_f32 v133, v34, v35
    v_cvt_pk_bf16_f32 v134, v40, v41
    v_cvt_pk_bf16_f32 v135, v42, v43
    s_nop 1
    v_permlane16_swap_b32 v132, v134
    v_permlane16_swap_b32 v133, v135
    buffer_store_dwordx4 v[132:135], v19, s[56:59], s55 offen offset:0 sc1
    v_pk_fma_f32 v[48:49], v[48:49], v[116:117], v[116:117] op_sel:[0,0,1] op_sel_hi:[1,0,1]
    v_pk_fma_f32 v[50:51], v[50:51], v[116:117], v[116:117] op_sel:[0,0,1] op_sel_hi:[1,0,1]
    v_pk_fma_f32 v[56:57], v[56:57], v[116:117], v[116:117] op_sel:[0,0,1] op_sel_hi:[1,0,1]
    v_pk_fma_f32 v[58:59], v[58:59], v[116:117], v[116:117] op_sel:[0,0,1] op_sel_hi:[1,0,1]
    v_cvt_pk_bf16_f32 v136, v48, v49
    v_cvt_pk_bf16_f32 v137, v50, v51
    v_cvt_pk_bf16_f32 v138, v56, v57
    v_cvt_pk_bf16_f32 v139, v58, v59
    s_nop 1
    v_permlane16_swap_b32 v136, v138
    v_permlane16_swap_b32 v137, v139
    buffer_store_dwordx4 v[136:139], v19, s[56:59], s55 offen offset:64 sc1
    s_lshr_b32 s40, s24, 1
    s_add_u32 s40, s40, 16
    s_lshl_b32 s40, s40, 8
    s_mov_b32 s42, s40
    s_add_u32 s84, s4, 0x300000
    s_addc_u32 s85, s5, 0
    s_mov_b32 s86, 0x4000
    s_mov_b32 s87, 0x20000
    v_mov_b32 v3, s40
    v_mov_b32 v4, 1
    s_waitcnt vmcnt(0)
    s_barrier
    s_cmp_lg_u32 s28, 0
    s_cbranch_scc1 g2_cin
    s_mov_b64 exec, 1
    buffer_atomic_add v4, v3, s[84:87], 0 offen sc1
    s_mov_b64 exec, -1
g2_cin:
    s_branch g3_in
.p2align 6
g3_in:
    s_cmp_ge_u32 s2, 224
    s_cbranch_scc1 g3_spare
    s_load_dwordx2 s[4:5], s[0:1], 80
    s_load_dwordx2 s[30:31], s[0:1], 32
    s_load_dwordx2 s[6:7], s[0:1], 40
    v_lshrrev_b32 v1, 6, v0
    v_and_b32 v2, 63, v0
    s_and_b32 s40, s2, 1
    s_lshl_b32 s40, s40, 2
    s_bfe_u32 s41, s2, 0x20003
    s_add_u32 s25, s40, s41
    s_bfe_u32 s40, s2, 0x20001
    s_mul_i32 s40, s40, 7
    s_lshr_b32 s42, s2, 5
    s_add_u32 s24, s40, s42
    s_add_u32 s27, s41, s42
    s_mov_b32 s26, 0
    s_cmp_eq_u32 s96, 0
    s_cselect_b32 s95, 3, 1
    v_readfirstlane_b32 s28, v1
    s_nop 0
    s_cmp_lt_u32 s28, 4
    s_cbranch_scc1 g3_compute
    s_sub_u32 s28, s28, 4
    s_mov_b32 s40, 7168
    v_lshrrev_b32 v4, 4, v2
    v_mul_lo_u32 v3, v4, s40
    v_lshlrev_b32 v4, 1, v4
    v_xor_b32 v4, v4, v2
    v_and_b32 v4, 15, v4
    v_lshl_add_u32 v3, v4, 4, v3
    s_mul_i32 s41, s24, 256
    s_mul_i32 s42, s28, 114688
    s_add_u32 s41, s41, s42
    v_xor_b32 v4, 128, v3
    s_add_u32 s42, s41, 0
    v_add_u32 v10, s42, v3
    s_add_u32 s42, s41, 28672
    v_add_u32 v11, s42, v3
    s_add_u32 s42, s41, 57344
    v_add_u32 v12, s42, v4
    s_add_u32 s42, s41, 86016
    v_add_u32 v13, s42, v4
    s_mov_b32 s40, 2304
    v_lshrrev_b32 v4, 4, v2
    v_mul_lo_u32 v3, v4, s40
    v_lshlrev_b32 v4, 1, v4
    v_xor_b32 v4, v4, v2
    v_and_b32 v4, 15, v4
    v_lshl_add_u32 v3, v4, 4, v3
    s_mul_i32 s41, s25, 256
    s_mul_i32 s42, s28, 36864
    s_add_u32 s41, s41, s42
    v_xor_b32 v4, 128, v3
    s_add_u32 s42, s41, 0
    v_add_u32 v14, s42, v3
    s_add_u32 s42, s41, 9216
    v_add_u32 v15, s42, v3
    s_add_u32 s42, s41, 18432
    v_add_u32 v16, s42, v4
    s_add_u32 s42, s41, 27648
    v_add_u32 v17, s42, v4
    s_mul_i32 s36, s28, 4096
    s_mul_i32 s37, s28, 4096
    s_add_u32 s37, s37, 16384
    s_waitcnt lgkmcnt(0)
    s_add_u32 s4, s4, s97
    s_addc_u32 s5, s5, 0
    s_mov_b32 s8, s30
    s_mov_b32 s9, s31
    s_mov_b32 s10, 0xe00000
    s_mov_b32 s11, 0x20000
    s_add_u32 s12, s4, 0xc00000
    s_addc_u32 s13, s5, 0
    s_mov_b32 s14, 0x480000
    s_mov_b32 s15, 0x20000
    s_mov_b32 s32, 0
    s_mov_b32 s33, 0
g3_ld_pW:
    s_add_u32 s40, s32, s27
    s_and_b32 s40, s40, s95
    s_andn2_b32 s41, s32, s95
    s_or_b32 s40, s40, s41
    s_add_u32 s40, s40, s26
    s_mul_i32 s34, s40, 458752
    s_mul_i32 s35, s40, 147456
    s_add_u32 s38, s33, s36
    s_add_u32 s39, s33, s37
    s_add_u32 m0, s38, 0
    s_nop 0
    buffer_load_dwordx4 v10, s[8:11], s34 offen lds
    s_add_u32 m0, s38, 1024
    s_nop 0
    buffer_load_dwordx4 v11, s[8:11], s34 offen lds
    s_add_u32 m0, s38, 2048
    s_nop 0
    buffer_load_dwordx4 v12, s[8:11], s34 offen lds
    s_add_u32 m0, s38, 3072
    s_nop 0
    buffer_load_dwordx4 v13, s[8:11], s34 offen lds
    s_add_u32 s33, s33, 32768
    s_add_u32 s32, s32, 1
    s_cmp_lt_u32 s32, 4
    s_cbranch_scc1 g3_ld_pW
    s_lshr_b32 s40, s25, 0
    s_add_u32 s40, s40, 16
    s_lshl_b32 s40, s40, 8
    s_mov_b32 s42, s40
    s_cmp_lg_u32 s28, 0
    s_cbranch_scc1 g3_dep_set
    s_add_u32 s84, s4, 0x300000
    s_addc_u32 s85, s5, 0
    s_mov_b32 s86, 0x4000
    s_mov_b32 s87, 0x20000
    v_cmp_eq_u32 vcc, 1, v2
    v_mov_b32 v21, s40
    v_mov_b32 v23, s42
    v_cndmask_b32 v21, v21, v23, vcc
    v_mov_b32 v22, 32
    v_mov_b32 v23, 32
    v_cndmask_b32 v22, v22, v23, vcc
    buffer_load_dword v23, v21, s[84:87], 0 offen sc1
g3_dep_set:
    s_lshl_b32 s43, s96, 2
    s_add_u32 s43, s43, 3
    s_mov_b32 s41, 0x80000
    v_mov_b32 v24, 131072
    s_cmp_lg_u32 s28, 0
    s_cbranch_scc1 g3_dep_lds
    s_mov_b32 s41, 0x8000
    s_waitcnt vmcnt(0)
g3_dep:
    v_cmp_lt_u32 vcc, v23, v22
    s_sub_u32 s41, s41, 1
    s_cmp_eq_u32 s41, 0
    s_cbranch_scc1 g3_dep_seen
    s_cbranch_vccz g3_dep_seen
    s_sleep 2
    buffer_load_dword v23, v21, s[84:87], 0 offen sc1
    s_waitcnt vmcnt(0)
    s_branch g3_dep
g3_dep_seen:
    v_mov_b32 v23, s43
    ds_write_b32 v24, v23
    s_branch g3_dep_ok
g3_dep_lds:
    ds_read_b32 v23, v24
    s_sub_u32 s41, s41, 1
    s_waitcnt lgkmcnt(0)
    v_readfirstlane_b32 s40, v23
    s_cmp_eq_u32 s41, 0
    s_cbranch_scc1 g3_dep_ok
    s_cmp_eq_u32 s40, s43
    s_cbranch_scc1 g3_dep_ok
    s_sleep 1
    s_branch g3_dep_lds
g3_dep_ok:
    s_mov_b32 s32, 0
    s_mov_b32 s33, 0
g3_ld_pA:
    s_add_u32 s40, s32, s27
    s_and_b32 s40, s40, s95
    s_andn2_b32 s41, s32, s95
    s_or_b32 s40, s40, s41
    s_add_u32 s40, s40, s26
    s_mul_i32 s34, s40, 458752
    s_mul_i32 s35, s40, 147456
    s_add_u32 s38, s33, s36
    s_add_u32 s39, s33, s37
    s_add_u32 m0, s39, 0
    s_nop 0
    buffer_load_dwordx4 v14, s[12:15], s35 offen sc1 lds
    s_add_u32 m0, s39, 1024
    s_nop 0
    buffer_load_dwordx4 v15, s[12:15], s35 offen sc1 lds
    s_add_u32 m0, s39, 2048
    s_nop 0
    buffer_load_dwordx4 v16, s[12:15], s35 offen sc1 lds
    s_add_u32 m0, s39, 3072
    s_nop 0
    buffer_load_dwordx4 v17, s[12:15], s35 offen sc1 lds
    s_add_u32 s33, s33, 32768
    s_add_u32 s32, s32, 1
    s_cmp_lt_u32 s32, 3
    s_cbranch_scc1 g3_ld_pA
    s_waitcnt vmcnt(8)
    s_barrier
    s_add_u32 s40, s32, s27
    s_and_b32 s40, s40, s95
    s_andn2_b32 s41, s32, s95
    s_or_b32 s40, s40, s41
    s_add_u32 s40, s40, s26
    s_mul_i32 s34, s40, 458752
    s_mul_i32 s35, s40, 147456
    s_add_u32 s38, s33, s36
    s_add_u32 s39, s33, s37
    s_add_u32 m0, s39, 0
    s_nop 0
    buffer_load_dwordx4 v14, s[12:15], s35 offen sc1 lds
    s_add_u32 m0, s39, 1024
    s_nop 0
    buffer_load_dwordx4 v15, s[12:15], s35 offen sc1 lds
    s_add_u32 m0, s39, 2048
    s_nop 0
    buffer_load_dwordx4 v16, s[12:15], s35 offen sc1 lds
    s_add_u32 m0, s39, 3072
    s_nop 0
    buffer_load_dwordx4 v17, s[12:15], s35 offen sc1 lds
    s_mov_b32 s33, 0
    s_add_u32 s32, s32, 1
g3_ld_loop:
    s_cmp_eq_u32 s32, 4
    s_cbranch_scc1 g3_ld_s4
    s_cmp_eq_u32 s32, 5
    s_cbranch_scc1 g3_ld_s5
    s_waitcnt vmcnt(16)
g3_ld_bar:
    s_barrier
    s_add_u32 s40, s32, s27
    s_and_b32 s40, s40, s95
    s_andn2_b32 s41, s32, s95
    s_or_b32 s40, s40, s41
    s_add_u32 s40, s40, s26
    s_mul_i32 s34, s40, 458752
    s_mul_i32 s35, s40, 147456
    s_add_u32 s38, s33, s36
    s_add_u32 s39, s33, s37
    s_add_u32 m0, s38, 0
    s_nop 0
    buffer_load_dwordx4 v10, s[8:11], s34 offen lds
    s_add_u32 m0, s38, 1024
    s_nop 0
    buffer_load_dwordx4 v11, s[8:11], s34 offen lds
    s_add_u32 m0, s38, 2048
    s_nop 0
    buffer_load_dwordx4 v12, s[8:11], s34 offen lds
    s_add_u32 m0, s38, 3072
    s_nop 0
    buffer_load_dwordx4 v13, s[8:11], s34 offen lds
    s_add_u32 m0, s39, 0
    s_nop 0
    buffer_load_dwordx4 v14, s[12:15], s35 offen sc1 lds
    s_add_u32 m0, s39, 1024
    s_nop 0
    buffer_load_dwordx4 v15, s[12:15], s35 offen sc1 lds
    s_add_u32 m0, s39, 2048
    s_nop 0
    buffer_load_dwordx4 v16, s[12:15], s35 offen sc1 lds
    s_add_u32 m0, s39, 3072
    s_nop 0
    buffer_load_dwordx4 v17, s[12:15], s35 offen sc1 lds
    s_add_u32 s33, s33, 32768
    s_add_u32 s32, s32, 1
    s_cmp_eq_u32 s33, 131072
    s_cselect_b32 s33, 0, s33
    s_cmp_lt_u32 s32, 32
    s_cbranch_scc1 g3_ld_loop
    s_waitcnt vmcnt(16)
    s_barrier
    s_waitcnt vmcnt(8)
    s_barrier
    s_waitcnt vmcnt(0)
    s_barrier
    s_branch g3_ld_end
g3_ld_s4:
    s_waitcnt vmcnt(8)
    s_branch g3_ld_bar
g3_ld_s5:
    s_waitcnt vmcnt(12)
    s_branch g3_ld_bar
g3_ld_end:
    s_barrier
    s_branch g4_in
g3_done:
    s_endpgm
g3_compute:
    v_lshrrev_b32 v5, 4, v2
    v_bfe_u32 v6, v2, 2, 2
    v_and_b32 v7, 3, v2
    v_and_b32 v8, 15, v2
    s_and_b32 s44, s28, 1
    s_lshr_b32 s45, s28, 1
    s_mul_i32 s40, s25, 128
    s_mul_i32 s41, s45, 64
    s_add_u32 s40, s40, s41
    v_add_u32 v20, s40, v8
    s_mov_b32 s41, 8192
    v_mul_lo_u32 v9, v20, s41
    s_mul_i32 s40, s24, 256
    s_mul_i32 s41, s44, 128
    s_add_u32 s46, s40, s41
    v_and_b32 v3, 1, v5
    v_lshlrev_b32 v3, 5, v3
    v_lshrrev_b32 v4, 1, v5
    v_lshl_add_u32 v3, v4, 4, v3
    v_add3_u32 v9, v9, v3, s46
    s_mov_b32 s52, 0
    s_mov_b32 s53, 131072
    s_mov_b32 s54, 262144
    s_mov_b32 s55, 393216
    s_waitcnt lgkmcnt(0)
    s_add_u32 s4, s4, s97
    s_addc_u32 s5, s5, 0
    s_mov_b32 s20, s6
    s_mov_b32 s21, s7
    s_mov_b32 s22, 0x1c00
    s_mov_b32 s23, 0x20000
    s_add_u32 s16, s4, 0x1100000
    s_addc_u32 s17, s5, 0
    s_mov_b32 s18, 0x800000
    s_mov_b32 s19, 0x20000
    v_lshl_add_u32 v3, v5, 3, s46
    buffer_load_dwordx2 v[92:93], v3, s[20:23], 0 offen offset:0
    buffer_load_dwordx2 v[94:95], v3, s[20:23], 0 offen offset:32
    buffer_load_dwordx2 v[96:97], v3, s[20:23], 0 offen offset:64
    buffer_load_dwordx2 v[98:99], v3, s[20:23], 0 offen offset:96
    s_mul_i32 s42, s44, 4
    s_mov_b32 s43, 0
    v_and_b32 v3, 1, v5
    v_lshl_or_b32 v3, v3, 2, v6
    s_add_u32 s40, s42, 0
    v_xor_b32 v3, s40, v3
    v_lshlrev_b32 v3, 5, v3
    v_lshl_add_u32 v3, v7, 3, v3
    v_lshl_add_u32 v4, v5, 3, v6
    v_lshl_add_u32 v3, v4, 8, v3
    v_add_u32 v10, s43, v3
    v_and_b32 v3, 1, v5
    v_lshl_or_b32 v3, v3, 2, v6
    s_add_u32 s40, s42, 1
    v_xor_b32 v3, s40, v3
    v_lshlrev_b32 v3, 5, v3
    v_lshl_add_u32 v3, v7, 3, v3
    v_lshl_add_u32 v4, v5, 3, v6
    v_lshl_add_u32 v3, v4, 8, v3
    v_add_u32 v11, s43, v3
    v_and_b32 v3, 1, v5
    v_lshl_or_b32 v3, v3, 2, v6
    s_add_u32 s40, s42, 2
    v_xor_b32 v3, s40, v3
    v_lshlrev_b32 v3, 5, v3
    v_lshl_add_u32 v3, v7, 3, v3
    v_lshl_add_u32 v4, v5, 3, v6
    v_lshl_add_u32 v3, v4, 8, v3
    v_add_u32 v12, s43, v3
    v_and_b32 v3, 1, v5
    v_lshl_or_b32 v3, v3, 2, v6
    s_add_u32 s40, s42, 3
    v_xor_b32 v3, s40, v3
    v_lshlrev_b32 v3, 5, v3
    v_lshl_add_u32 v3, v7, 3, v3
    v_lshl_add_u32 v4, v5, 3, v6
    v_lshl_add_u32 v3, v4, 8, v3
    v_add_u32 v13, s43, v3
    s_mul_i32 s42, s45, 4
    s_mov_b32 s43, 16384
    v_and_b32 v3, 1, v5
    v_lshl_or_b32 v3, v3, 2, v6
    s_add_u32 s40, s42, 0
    v_xor_b32 v3, s40, v3
    v_lshlrev_b32 v3, 5, v3
    v_lshl_add_u32 v3, v7, 3, v3
    v_lshl_add_u32 v4, v5, 3, v6
    v_lshl_add_u32 v3, v4, 8, v3
    v_add_u32 v14, s43, v3
    v_and_b32 v3, 1, v5
    v_lshl_or_b32 v3, v3, 2, v6
    s_add_u32 s40, s42, 1
    v_xor_b32 v3, s40, v3
    v_lshlrev_b32 v3, 5, v3
    v_lshl_add_u32 v3, v7, 3, v3
    v_lshl_add_u32 v4, v5, 3, v6
    v_lshl_add_u32 v3, v4, 8, v3
    v_add_u32 v15, s43, v3
    v_and_b32 v3, 1, v5
    v_lshl_or_b32 v3, v3, 2, v6
    s_add_u32 s40, s42, 2
    v_xor_b32 v3, s40, v3
    v_lshlrev_b32 v3, 5, v3
    v_lshl_add_u32 v3, v7, 3, v3
    v_lshl_add_u32 v4, v5, 3, v6
    v_lshl_add_u32 v3, v4, 8, v3
    v_add_u32 v16, s43, v3
    v_and_b32 v3, 1, v5
    v_lshl_or_b32 v3, v3, 2, v6
    s_add_u32 s40, s42, 3
    v_xor_b32 v3, s40, v3
    v_lshlrev_b32 v3, 5, v3
    v_lshl_add_u32 v3, v7, 3, v3
    v_lshl_add_u32 v4, v5, 3, v6
    v_lshl_add_u32 v3, v4, 8, v3
    v_add_u32 v17, s43, v3
    v_mov_b32 v124, 0
    v_mov_b32 v125, 0
    v_mov_b32 v126, 0
    v_mov_b32 v127, 0
    v_mov_b32 v128, 0
    v_mov_b32 v129, 0
    v_mov_b32 v130, 0
    v_mov_b32 v131, 0
    v_mov_b32 v132, 0
    v_mov_b32 v133, 0
    v_mov_b32 v134, 0
    v_mov_b32 v135, 0
    v_mov_b32 v136, 0
    v_mov_b32 v137, 0
    v_mov_b32 v138, 0
    v_mov_b32 v139, 0
    v_mov_b32 v140, 0
    v_mov_b32 v141, 0
    v_mov_b32 v142, 0
    v_mov_b32 v143, 0
    v_mov_b32 v144, 0
    v_mov_b32 v145, 0
    v_mov_b32 v146, 0
    v_mov_b32 v147, 0
    v_mov_b32 v148, 0
    v_mov_b32 v149, 0
    v_mov_b32 v150, 0
    v_mov_b32 v151, 0
    v_mov_b32 v152, 0
    v_mov_b32 v153, 0
    v_mov_b32 v154, 0
    v_mov_b32 v155, 0
    s_mov_b32 s48, 32
    s_mov_b32 s50, 0
    s_mov_b32 s51, 32768
    s_mov_b32 s29, 0xfffe8000
    s_waitcnt vmcnt(0)
    v_lshlrev_b32 v28, 16, v92
    v_and_b32 v29, 0xffff0000, v92
    v_lshlrev_b32 v30, 16, v93
    v_and_b32 v31, 0xffff0000, v93
    v_lshlrev_b32 v32, 16, v92
    v_and_b32 v33, 0xffff0000, v92
    v_lshlrev_b32 v34, 16, v93
    v_and_b32 v35, 0xffff0000, v93
    v_lshlrev_b32 v36, 16, v92
    v_and_b32 v37, 0xffff0000, v92
    v_lshlrev_b32 v38, 16, v93
    v_and_b32 v39, 0xffff0000, v93
    v_lshlrev_b32 v40, 16, v92
    v_and_b32 v41, 0xffff0000, v92
    v_lshlrev_b32 v42, 16, v93
    v_and_b32 v43, 0xffff0000, v93
    v_lshlrev_b32 v44, 16, v94
    v_and_b32 v45, 0xffff0000, v94
    v_lshlrev_b32 v46, 16, v95
    v_and_b32 v47, 0xffff0000, v95
    v_lshlrev_b32 v48, 16, v94
    v_and_b32 v49, 0xffff0000, v94
    v_lshlrev_b32 v50, 16, v95
    v_and_b32 v51, 0xffff0000, v95
    v_lshlrev_b32 v52, 16, v94
    v_and_b32 v53, 0xffff0000, v94
    v_lshlrev_b32 v54, 16, v95
    v_and_b32 v55, 0xffff0000, v95
    v_lshlrev_b32 v56, 16, v94
    v_and_b32 v57, 0xffff0000, v94
    v_lshlrev_b32 v58, 16, v95
    v_and_b32 v59, 0xffff0000, v95
    v_lshlrev_b32 v60, 16, v96
    v_and_b32 v61, 0xffff0000, v96
    v_lshlrev_b32 v62, 16, v97
    v_and_b32 v63, 0xffff0000, v97
    v_lshlrev_b32 v64, 16, v96
    v_and_b32 v65, 0xffff0000, v96
    v_lshlrev_b32 v66, 16, v97
    v_and_b32 v67, 0xffff0000, v97
    v_lshlrev_b32 v68, 16, v96
    v_and_b32 v69, 0xffff0000, v96
    v_lshlrev_b32 v70, 16, v97
    v_and_b32 v71, 0xffff0000, v97
    v_lshlrev_b32 v72, 16, v96
    v_and_b32 v73, 0xffff0000, v96
    v_lshlrev_b32 v74, 16, v97
    v_and_b32 v75, 0xffff0000, v97
    v_lshlrev_b32 v76, 16, v98
    v_and_b32 v77, 0xffff0000, v98
    v_lshlrev_b32 v78, 16, v99
    v_and_b32 v79, 0xffff0000, v99
    v_lshlrev_b32 v80, 16, v98
    v_and_b32 v81, 0xffff0000, v98
    v_lshlrev_b32 v82, 16, v99
    v_and_b32 v83, 0xffff0000, v99
    v_lshlrev_b32 v84, 16, v98
    v_and_b32 v85, 0xffff0000, v98
    v_lshlrev_b32 v86, 16, v99
    v_and_b32 v87, 0xffff0000, v99
    v_lshlrev_b32 v88, 16, v98
    v_and_b32 v89, 0xffff0000, v98
    v_lshlrev_b32 v90, 16, v99
    v_and_b32 v91, 0xffff0000, v99
    v_mov_b32 v156, 0xbdd2d3e8
    v_mov_b32 v157, 0xbdd2d3e8
    v_mov_b32 v158, 0xc0135761
    v_mov_b32 v159, 0xc0135761
    v_mov_b32 v160, 0x3f800000
    v_mov_b32 v161, 0x3f800000
.p2align 3
g3_cloop:
    s_barrier
g3_cloop2:
    v_mfma_f32_16x16x32_bf16 v[28:31], v[124:127], v[140:143], v[28:31]
    ds_read_b64_tr_b16 v[92:93], v10 offset:0
    ds_read_b64_tr_b16 v[94:95], v10 offset:1024
    v_mfma_f32_16x16x32_bf16 v[32:35], v[124:127], v[144:147], v[32:35]
    ds_read_b64_tr_b16 v[108:109], v14 offset:0
    ds_read_b64_tr_b16 v[110:111], v14 offset:1024
    v_mfma_f32_16x16x32_bf16 v[36:39], v[124:127], v[148:151], v[36:39]
    ds_read_b64_tr_b16 v[112:113], v15 offset:0
    ds_read_b64_tr_b16 v[114:115], v15 offset:1024
    v_mfma_f32_16x16x32_bf16 v[40:43], v[124:127], v[152:155], v[40:43]
    ds_read_b64_tr_b16 v[116:117], v16 offset:0
    ds_read_b64_tr_b16 v[118:119], v16 offset:1024
    v_mfma_f32_16x16x32_bf16 v[56:59], v[128:131], v[152:155], v[56:59]
    ds_read_b64_tr_b16 v[120:121], v17 offset:0
    ds_read_b64_tr_b16 v[122:123], v17 offset:1024
    v_mfma_f32_16x16x32_bf16 v[52:55], v[128:131], v[148:151], v[52:55]
    ds_read_b64_tr_b16 v[96:97], v11 offset:0
    ds_read_b64_tr_b16 v[98:99], v11 offset:1024
    v_mfma_f32_16x16x32_bf16 v[48:51], v[128:131], v[144:147], v[48:51]
    ds_read_b64_tr_b16 v[100:101], v12 offset:0
    ds_read_b64_tr_b16 v[102:103], v12 offset:1024
    v_mfma_f32_16x16x32_bf16 v[44:47], v[128:131], v[140:143], v[44:47]
    ds_read_b64_tr_b16 v[104:105], v13 offset:0
    ds_read_b64_tr_b16 v[106:107], v13 offset:1024
    v_mfma_f32_16x16x32_bf16 v[60:63], v[132:135], v[140:143], v[60:63]
    v_mfma_f32_16x16x32_bf16 v[64:67], v[132:135], v[144:147], v[64:67]
    v_mfma_f32_16x16x32_bf16 v[68:71], v[132:135], v[148:151], v[68:71]
    v_mfma_f32_16x16x32_bf16 v[72:75], v[132:135], v[152:155], v[72:75]
    v_mfma_f32_16x16x32_bf16 v[88:91], v[136:139], v[152:155], v[88:91]
    v_mfma_f32_16x16x32_bf16 v[84:87], v[136:139], v[148:151], v[84:87]
    v_mfma_f32_16x16x32_bf16 v[80:83], v[136:139], v[144:147], v[80:83]
    v_mfma_f32_16x16x32_bf16 v[76:79], v[136:139], v[140:143], v[76:79]
    s_waitcnt lgkmcnt(0)
    v_mfma_f32_16x16x32_bf16 v[28:31], v[92:95], v[108:111], v[28:31]
    ds_read_b64_tr_b16 v[124:125], v10 offset:8192
    ds_read_b64_tr_b16 v[126:127], v10 offset:9216
    v_mfma_f32_16x16x32_bf16 v[32:35], v[92:95], v[112:115], v[32:35]
    ds_read_b64_tr_b16 v[140:141], v14 offset:8192
    ds_read_b64_tr_b16 v[142:143], v14 offset:9216
    v_mfma_f32_16x16x32_bf16 v[36:39], v[92:95], v[116:119], v[36:39]
    ds_read_b64_tr_b16 v[144:145], v15 offset:8192
    ds_read_b64_tr_b16 v[146:147], v15 offset:9216
    v_mfma_f32_16x16x32_bf16 v[40:43], v[92:95], v[120:123], v[40:43]
    ds_read_b64_tr_b16 v[148:149], v16 offset:8192
    ds_read_b64_tr_b16 v[150:151], v16 offset:9216
    v_mfma_f32_16x16x32_bf16 v[56:59], v[96:99], v[120:123], v[56:59]
    ds_read_b64_tr_b16 v[152:153], v17 offset:8192
    ds_read_b64_tr_b16 v[154:155], v17 offset:9216
    v_mfma_f32_16x16x32_bf16 v[52:55], v[96:99], v[116:119], v[52:55]
    ds_read_b64_tr_b16 v[128:129], v11 offset:8192
    ds_read_b64_tr_b16 v[130:131], v11 offset:9216
    v_mfma_f32_16x16x32_bf16 v[48:51], v[96:99], v[112:115], v[48:51]
    ds_read_b64_tr_b16 v[132:133], v12 offset:8192
    ds_read_b64_tr_b16 v[134:135], v12 offset:9216
    v_mfma_f32_16x16x32_bf16 v[44:47], v[96:99], v[108:111], v[44:47]
    ds_read_b64_tr_b16 v[136:137], v13 offset:8192
    ds_read_b64_tr_b16 v[138:139], v13 offset:9216
    v_mfma_f32_16x16x32_bf16 v[60:63], v[100:103], v[108:111], v[60:63]
    s_add_u32 s50, s50, 1
    s_cmp_eq_u32 s50, 4
    v_mfma_f32_16x16x32_bf16 v[64:67], v[100:103], v[112:115], v[64:67]
    s_cselect_b32 s49, s29, s51
    s_cselect_b32 s50, 0, s50
    v_mfma_f32_16x16x32_bf16 v[68:71], v[100:103], v[116:119], v[68:71]
    v_add_u32 v10, s49, v10
    v_add_u32 v11, s49, v11
    v_mfma_f32_16x16x32_bf16 v[72:75], v[100:103], v[120:123], v[72:75]
    v_add_u32 v12, s49, v12
    v_add_u32 v13, s49, v13
    v_mfma_f32_16x16x32_bf16 v[88:91], v[104:107], v[120:123], v[88:91]
    v_add_u32 v14, s49, v14
    v_add_u32 v15, s49, v15
    v_mfma_f32_16x16x32_bf16 v[84:87], v[104:107], v[116:119], v[84:87]
    v_add_u32 v16, s49, v16
    v_add_u32 v17, s49, v17
    v_mfma_f32_16x16x32_bf16 v[80:83], v[104:107], v[112:115], v[80:83]
    s_sub_u32 s48, s48, 1
    s_cmp_lg_u32 s48, 0
    v_mfma_f32_16x16x32_bf16 v[76:79], v[104:107], v[108:111], v[76:79]
    s_waitcnt lgkmcnt(0)
    s_cbranch_scc1 g3_cloop
    v_mfma_f32_16x16x32_bf16 v[28:31], v[124:127], v[140:143], v[28:31]
    v_mfma_f32_16x16x32_bf16 v[44:47], v[128:131], v[140:143], v[44:47]
    v_mfma_f32_16x16x32_bf16 v[60:63], v[132:135], v[140:143], v[60:63]
    v_mfma_f32_16x16x32_bf16 v[76:79], v[136:139], v[140:143], v[76:79]
    v_mfma_f32_16x16x32_bf16 v[32:35], v[124:127], v[144:147], v[32:35]
    v_mfma_f32_16x16x32_bf16 v[48:51], v[128:131], v[144:147], v[48:51]
    v_mfma_f32_16x16x32_bf16 v[64:67], v[132:135], v[144:147], v[64:67]
    v_mfma_f32_16x16x32_bf16 v[80:83], v[136:139], v[144:147], v[80:83]
    s_nop 1
    v_mfma_f32_16x16x32_bf16 v[36:39], v[124:127], v[148:151], v[36:39]
    v_pk_mul_f32 v[108:109], v[28:29], v[28:29]
    v_pk_mul_f32 v[110:111], v[30:31], v[30:31]
    v_pk_mul_f32 v[112:113], v[44:45], v[44:45]
    v_pk_mul_f32 v[114:115], v[46:47], v[46:47]
    v_pk_fma_f32 v[108:109], v[108:109], v[156:157], v[158:159]
    v_pk_fma_f32 v[110:111], v[110:111], v[156:157], v[158:159]
    v_pk_fma_f32 v[112:113], v[112:113], v[156:157], v[158:159]
    v_pk_fma_f32 v[114:115], v[114:115], v[156:157], v[158:159]
    v_pk_mul_f32 v[108:109], v[108:109], v[28:29]
    v_pk_mul_f32 v[110:111], v[110:111], v[30:31]
    v_pk_mul_f32 v[112:113], v[112:113], v[44:45]
    v_pk_mul_f32 v[114:115], v[114:115], v[46:47]
    v_exp_f32 v108, v108
    v_exp_f32 v109, v109
    v_exp_f32 v110, v110
    v_exp_f32 v111, v111
    v_exp_f32 v112, v112
    v_exp_f32 v113, v113
    v_exp_f32 v114, v114
    v_exp_f32 v115, v115
    v_pk_add_f32 v[108:109], v[108:109], v[160:161]
    v_pk_add_f32 v[110:111], v[110:111], v[160:161]
    v_mfma_f32_16x16x32_bf16 v[52:55], v[128:131], v[148:151], v[52:55]
    v_pk_add_f32 v[112:113], v[112:113], v[160:161]
    v_pk_add_f32 v[114:115], v[114:115], v[160:161]
    v_rcp_f32 v108, v108
    v_rcp_f32 v109, v109
    v_rcp_f32 v110, v110
    v_rcp_f32 v111, v111
    v_rcp_f32 v112, v112
    v_rcp_f32 v113, v113
    v_rcp_f32 v114, v114
    v_rcp_f32 v115, v115
    v_pk_mul_f32 v[28:29], v[28:29], v[108:109]
    v_pk_mul_f32 v[30:31], v[30:31], v[110:111]
    v_pk_mul_f32 v[44:45], v[44:45], v[112:113]
    v_pk_mul_f32 v[46:47], v[46:47], v[114:115]
    v_cvt_pk_bf16_f32 v92, v28, v29
    v_cvt_pk_bf16_f32 v93, v30, v31
    v_cvt_pk_bf16_f32 v94, v44, v45
    v_cvt_pk_bf16_f32 v95, v46, v47
    s_nop 1
    v_permlane16_swap_b32 v92, v94
    v_permlane16_swap_b32 v93, v95
    buffer_store_dwordx4 v[92:95], v9, s[16:19], s52 offen offset:0 sc1
    v_mfma_f32_16x16x32_bf16 v[68:71], v[132:135], v[148:151], v[68:71]
    v_pk_mul_f32 v[108:109], v[60:61], v[60:61]
    v_pk_mul_f32 v[110:111], v[62:63], v[62:63]
    v_pk_mul_f32 v[112:113], v[76:77], v[76:77]
    v_pk_mul_f32 v[114:115], v[78:79], v[78:79]
    v_pk_fma_f32 v[108:109], v[108:109], v[156:157], v[158:159]
    v_pk_fma_f32 v[110:111], v[110:111], v[156:157], v[158:159]
    v_pk_fma_f32 v[112:113], v[112:113], v[156:157], v[158:159]
    v_pk_fma_f32 v[114:115], v[114:115], v[156:157], v[158:159]
    v_pk_mul_f32 v[108:109], v[108:109], v[60:61]
    v_pk_mul_f32 v[110:111], v[110:111], v[62:63]
    v_pk_mul_f32 v[112:113], v[112:113], v[76:77]
    v_pk_mul_f32 v[114:115], v[114:115], v[78:79]
    v_exp_f32 v108, v108
    v_exp_f32 v109, v109
    v_exp_f32 v110, v110
    v_exp_f32 v111, v111
    v_exp_f32 v112, v112
    v_exp_f32 v113, v113
    v_exp_f32 v114, v114
    v_exp_f32 v115, v115
    v_pk_add_f32 v[108:109], v[108:109], v[160:161]
    v_pk_add_f32 v[110:111], v[110:111], v[160:161]
    v_mfma_f32_16x16x32_bf16 v[84:87], v[136:139], v[148:151], v[84:87]
    v_pk_add_f32 v[112:113], v[112:113], v[160:161]
    v_pk_add_f32 v[114:115], v[114:115], v[160:161]
    v_rcp_f32 v108, v108
    v_rcp_f32 v109, v109
    v_rcp_f32 v110, v110
    v_rcp_f32 v111, v111
    v_rcp_f32 v112, v112
    v_rcp_f32 v113, v113
    v_rcp_f32 v114, v114
    v_rcp_f32 v115, v115
    v_pk_mul_f32 v[60:61], v[60:61], v[108:109]
    v_pk_mul_f32 v[62:63], v[62:63], v[110:111]
    v_pk_mul_f32 v[76:77], v[76:77], v[112:113]
    v_pk_mul_f32 v[78:79], v[78:79], v[114:115]
    v_cvt_pk_bf16_f32 v96, v60, v61
    v_cvt_pk_bf16_f32 v97, v62, v63
    v_cvt_pk_bf16_f32 v98, v76, v77
    v_cvt_pk_bf16_f32 v99, v78, v79
    s_nop 1
    v_permlane16_swap_b32 v96, v98
    v_permlane16_swap_b32 v97, v99
    buffer_store_dwordx4 v[96:99], v9, s[16:19], s52 offen offset:64 sc1
    v_mfma_f32_16x16x32_bf16 v[40:43], v[124:127], v[152:155], v[40:43]
    v_pk_mul_f32 v[108:109], v[32:33], v[32:33]
    v_pk_mul_f32 v[110:111], v[34:35], v[34:35]
    v_pk_mul_f32 v[112:113], v[48:49], v[48:49]
    v_pk_mul_f32 v[114:115], v[50:51], v[50:51]
    v_pk_fma_f32 v[108:109], v[108:109], v[156:157], v[158:159]
    v_pk_fma_f32 v[110:111], v[110:111], v[156:157], v[158:159]
    v_pk_fma_f32 v[112:113], v[112:113], v[156:157], v[158:159]
    v_pk_fma_f32 v[114:115], v[114:115], v[156:157], v[158:159]
    v_pk_mul_f32 v[108:109], v[108:109], v[32:33]
    v_pk_mul_f32 v[110:111], v[110:111], v[34:35]
    v_pk_mul_f32 v[112:113], v[112:113], v[48:49]
    v_pk_mul_f32 v[114:115], v[114:115], v[50:51]
    v_exp_f32 v108, v108
    v_exp_f32 v109, v109
    v_exp_f32 v110, v110
    v_exp_f32 v111, v111
    v_exp_f32 v112, v112
    v_exp_f32 v113, v113
    v_exp_f32 v114, v114
    v_exp_f32 v115, v115
    v_pk_add_f32 v[108:109], v[108:109], v[160:161]
    v_pk_add_f32 v[110:111], v[110:111], v[160:161]
    v_mfma_f32_16x16x32_bf16 v[56:59], v[128:131], v[152:155], v[56:59]
    v_pk_add_f32 v[112:113], v[112:113], v[160:161]
    v_pk_add_f32 v[114:115], v[114:115], v[160:161]
    v_rcp_f32 v108, v108
    v_rcp_f32 v109, v109
    v_rcp_f32 v110, v110
    v_rcp_f32 v111, v111
    v_rcp_f32 v112, v112
    v_rcp_f32 v113, v113
    v_rcp_f32 v114, v114
    v_rcp_f32 v115, v115
    v_pk_mul_f32 v[32:33], v[32:33], v[108:109]
    v_pk_mul_f32 v[34:35], v[34:35], v[110:111]
    v_pk_mul_f32 v[48:49], v[48:49], v[112:113]
    v_pk_mul_f32 v[50:51], v[50:51], v[114:115]
    v_cvt_pk_bf16_f32 v100, v32, v33
    v_cvt_pk_bf16_f32 v101, v34, v35
    v_cvt_pk_bf16_f32 v102, v48, v49
    v_cvt_pk_bf16_f32 v103, v50, v51
    s_nop 1
    v_permlane16_swap_b32 v100, v102
    v_permlane16_swap_b32 v101, v103
    buffer_store_dwordx4 v[100:103], v9, s[16:19], s53 offen offset:0 sc1
    v_mfma_f32_16x16x32_bf16 v[72:75], v[132:135], v[152:155], v[72:75]
    v_pk_mul_f32 v[108:109], v[64:65], v[64:65]
    v_pk_mul_f32 v[110:111], v[66:67], v[66:67]
    v_pk_mul_f32 v[112:113], v[80:81], v[80:81]
    v_pk_mul_f32 v[114:115], v[82:83], v[82:83]
    v_pk_fma_f32 v[108:109], v[108:109], v[156:157], v[158:159]
    v_pk_fma_f32 v[110:111], v[110:111], v[156:157], v[158:159]
    v_pk_fma_f32 v[112:113], v[112:113], v[156:157], v[158:159]
    v_pk_fma_f32 v[114:115], v[114:115], v[156:157], v[158:159]
    v_pk_mul_f32 v[108:109], v[108:109], v[64:65]
    v_pk_mul_f32 v[110:111], v[110:111], v[66:67]
    v_pk_mul_f32 v[112:113], v[112:113], v[80:81]
    v_pk_mul_f32 v[114:115], v[114:115], v[82:83]
    v_exp_f32 v108, v108
    v_exp_f32 v109, v109
    v_exp_f32 v110, v110
    v_exp_f32 v111, v111
    v_exp_f32 v112, v112
    v_exp_f32 v113, v113
    v_exp_f32 v114, v114
    v_exp_f32 v115, v115
    v_pk_add_f32 v[108:109], v[108:109], v[160:161]
    v_pk_add_f32 v[110:111], v[110:111], v[160:161]
    v_mfma_f32_16x16x32_bf16 v[88:91], v[136:139], v[152:155], v[88:91]
    v_pk_add_f32 v[112:113], v[112:113], v[160:161]
    v_pk_add_f32 v[114:115], v[114:115], v[160:161]
    v_rcp_f32 v108, v108
    v_rcp_f32 v109, v109
    v_rcp_f32 v110, v110
    v_rcp_f32 v111, v111
    v_rcp_f32 v112, v112
    v_rcp_f32 v113, v113
    v_rcp_f32 v114, v114
    v_rcp_f32 v115, v115
    v_pk_mul_f32 v[64:65], v[64:65], v[108:109]
    v_pk_mul_f32 v[66:67], v[66:67], v[110:111]
    v_pk_mul_f32 v[80:81], v[80:81], v[112:113]
    v_pk_mul_f32 v[82:83], v[82:83], v[114:115]
    v_cvt_pk_bf16_f32 v104, v64, v65
    v_cvt_pk_bf16_f32 v105, v66, v67
    v_cvt_pk_bf16_f32 v106, v80, v81
    v_cvt_pk_bf16_f32 v107, v82, v83
    s_nop 1
    v_permlane16_swap_b32 v104, v106
    v_permlane16_swap_b32 v105, v107
    buffer_store_dwordx4 v[104:107], v9, s[16:19], s53 offen offset:64 sc1
    v_pk_mul_f32 v[108:109], v[36:37], v[36:37]
    v_pk_mul_f32 v[110:111], v[38:39], v[38:39]
    v_pk_mul_f32 v[112:113], v[52:53], v[52:53]
    v_pk_mul_f32 v[114:115], v[54:55], v[54:55]
    v_pk_fma_f32 v[108:109], v[108:109], v[156:157], v[158:159]
    v_pk_fma_f32 v[110:111], v[110:111], v[156:157], v[158:159]
    v_pk_fma_f32 v[112:113], v[112:113], v[156:157], v[158:159]
    v_pk_fma_f32 v[114:115], v[114:115], v[156:157], v[158:159]
    v_pk_mul_f32 v[108:109], v[108:109], v[36:37]
    v_pk_mul_f32 v[110:111], v[110:111], v[38:39]
    v_pk_mul_f32 v[112:113], v[112:113], v[52:53]
    v_pk_mul_f32 v[114:115], v[114:115], v[54:55]
    v_exp_f32 v108, v108
    v_exp_f32 v109, v109
    v_exp_f32 v110, v110
    v_exp_f32 v111, v111
    v_exp_f32 v112, v112
    v_exp_f32 v113, v113
    v_exp_f32 v114, v114
    v_exp_f32 v115, v115
    v_pk_add_f32 v[108:109], v[108:109], v[160:161]
    v_pk_add_f32 v[110:111], v[110:111], v[160:161]
    v_pk_add_f32 v[112:113], v[112:113], v[160:161]
    v_pk_add_f32 v[114:115], v[114:115], v[160:161]
    v_rcp_f32 v108, v108
    v_rcp_f32 v109, v109
    v_rcp_f32 v110, v110
    v_rcp_f32 v111, v111
    v_rcp_f32 v112, v112
    v_rcp_f32 v113, v113
    v_rcp_f32 v114, v114
    v_rcp_f32 v115, v115
    v_pk_mul_f32 v[36:37], v[36:37], v[108:109]
    v_pk_mul_f32 v[38:39], v[38:39], v[110:111]
    v_pk_mul_f32 v[52:53], v[52:53], v[112:113]
    v_pk_mul_f32 v[54:55], v[54:55], v[114:115]
    v_cvt_pk_bf16_f32 v92, v36, v37
    v_cvt_pk_bf16_f32 v93, v38, v39
    v_cvt_pk_bf16_f32 v94, v52, v53
    v_cvt_pk_bf16_f32 v95, v54, v55
    s_nop 1
    v_permlane16_swap_b32 v92, v94
    v_permlane16_swap_b32 v93, v95
    buffer_store_dwordx4 v[92:95], v9, s[16:19], s54 offen offset:0 sc1
    v_pk_mul_f32 v[108:109], v[68:69], v[68:69]
    v_pk_mul_f32 v[110:111], v[70:71], v[70:71]
    v_pk_mul_f32 v[112:113], v[84:85], v[84:85]
    v_pk_mul_f32 v[114:115], v[86:87], v[86:87]
    v_pk_fma_f32 v[108:109], v[108:109], v[156:157], v[158:159]
    v_pk_fma_f32 v[110:111], v[110:111], v[156:157], v[158:159]
    v_pk_fma_f32 v[112:113], v[112:113], v[156:157], v[158:159]
    v_pk_fma_f32 v[114:115], v[114:115], v[156:157], v[158:159]
    v_pk_mul_f32 v[108:109], v[108:109], v[68:69]
    v_pk_mul_f32 v[110:111], v[110:111], v[70:71]
    v_pk_mul_f32 v[112:113], v[112:113], v[84:85]
    v_pk_mul_f32 v[114:115], v[114:115], v[86:87]
    v_exp_f32 v108, v108
    v_exp_f32 v109, v109
    v_exp_f32 v110, v110
    v_exp_f32 v111, v111
    v_exp_f32 v112, v112
    v_exp_f32 v113, v113
    v_exp_f32 v114, v114
    v_exp_f32 v115, v115
    v_pk_add_f32 v[108:109], v[108:109], v[160:161]
    v_pk_add_f32 v[110:111], v[110:111], v[160:161]
    v_pk_add_f32 v[112:113], v[112:113], v[160:161]
    v_pk_add_f32 v[114:115], v[114:115], v[160:161]
    v_rcp_f32 v108, v108
    v_rcp_f32 v109, v109
    v_rcp_f32 v110, v110
    v_rcp_f32 v111, v111
    v_rcp_f32 v112, v112
    v_rcp_f32 v113, v113
    v_rcp_f32 v114, v114
    v_rcp_f32 v115, v115
    v_pk_mul_f32 v[68:69], v[68:69], v[108:109]
    v_pk_mul_f32 v[70:71], v[70:71], v[110:111]
    v_pk_mul_f32 v[84:85], v[84:85], v[112:113]
    v_pk_mul_f32 v[86:87], v[86:87], v[114:115]
    v_cvt_pk_bf16_f32 v96, v68, v69
    v_cvt_pk_bf16_f32 v97, v70, v71
    v_cvt_pk_bf16_f32 v98, v84, v85
    v_cvt_pk_bf16_f32 v99, v86, v87
    s_nop 1
    v_permlane16_swap_b32 v96, v98
    v_permlane16_swap_b32 v97, v99
    buffer_store_dwordx4 v[96:99], v9, s[16:19], s54 offen offset:64 sc1
    v_pk_mul_f32 v[108:109], v[40:41], v[40:41]
    v_pk_mul_f32 v[110:111], v[42:43], v[42:43]
    v_pk_mul_f32 v[112:113], v[56:57], v[56:57]
    v_pk_mul_f32 v[114:115], v[58:59], v[58:59]
    v_pk_fma_f32 v[108:109], v[108:109], v[156:157], v[158:159]
    v_pk_fma_f32 v[110:111], v[110:111], v[156:157], v[158:159]
    v_pk_fma_f32 v[112:113], v[112:113], v[156:157], v[158:159]
    v_pk_fma_f32 v[114:115], v[114:115], v[156:157], v[158:159]
    v_pk_mul_f32 v[108:109], v[108:109], v[40:41]
    v_pk_mul_f32 v[110:111], v[110:111], v[42:43]
    v_pk_mul_f32 v[112:113], v[112:113], v[56:57]
    v_pk_mul_f32 v[114:115], v[114:115], v[58:59]
    v_exp_f32 v108, v108
    v_exp_f32 v109, v109
    v_exp_f32 v110, v110
    v_exp_f32 v111, v111
    v_exp_f32 v112, v112
    v_exp_f32 v113, v113
    v_exp_f32 v114, v114
    v_exp_f32 v115, v115
    v_pk_add_f32 v[108:109], v[108:109], v[160:161]
    v_pk_add_f32 v[110:111], v[110:111], v[160:161]
    v_pk_add_f32 v[112:113], v[112:113], v[160:161]
    v_pk_add_f32 v[114:115], v[114:115], v[160:161]
    v_rcp_f32 v108, v108
    v_rcp_f32 v109, v109
    v_rcp_f32 v110, v110
    v_rcp_f32 v111, v111
    v_rcp_f32 v112, v112
    v_rcp_f32 v113, v113
    v_rcp_f32 v114, v114
    v_rcp_f32 v115, v115
    v_pk_mul_f32 v[40:41], v[40:41], v[108:109]
    v_pk_mul_f32 v[42:43], v[42:43], v[110:111]
    v_pk_mul_f32 v[56:57], v[56:57], v[112:113]
    v_pk_mul_f32 v[58:59], v[58:59], v[114:115]
    v_cvt_pk_bf16_f32 v100, v40, v41
    v_cvt_pk_bf16_f32 v101, v42, v43
    v_cvt_pk_bf16_f32 v102, v56, v57
    v_cvt_pk_bf16_f32 v103, v58, v59
    s_nop 1
    v_permlane16_swap_b32 v100, v102
    v_permlane16_swap_b32 v101, v103
    buffer_store_dwordx4 v[100:103], v9, s[16:19], s55 offen offset:0 sc1
    v_pk_mul_f32 v[108:109], v[72:73], v[72:73]
    v_pk_mul_f32 v[110:111], v[74:75], v[74:75]
    v_pk_mul_f32 v[112:113], v[88:89], v[88:89]
    v_pk_mul_f32 v[114:115], v[90:91], v[90:91]
    v_pk_fma_f32 v[108:109], v[108:109], v[156:157], v[158:159]
    v_pk_fma_f32 v[110:111], v[110:111], v[156:157], v[158:159]
    v_pk_fma_f32 v[112:113], v[112:113], v[156:157], v[158:159]
    v_pk_fma_f32 v[114:115], v[114:115], v[156:157], v[158:159]
    v_pk_mul_f32 v[108:109], v[108:109], v[72:73]
    v_pk_mul_f32 v[110:111], v[110:111], v[74:75]
    v_pk_mul_f32 v[112:113], v[112:113], v[88:89]
    v_pk_mul_f32 v[114:115], v[114:115], v[90:91]
    v_exp_f32 v108, v108
    v_exp_f32 v109, v109
    v_exp_f32 v110, v110
    v_exp_f32 v111, v111
    v_exp_f32 v112, v112
    v_exp_f32 v113, v113
    v_exp_f32 v114, v114
    v_exp_f32 v115, v115
    v_pk_add_f32 v[108:109], v[108:109], v[160:161]
    v_pk_add_f32 v[110:111], v[110:111], v[160:161]
    v_pk_add_f32 v[112:113], v[112:113], v[160:161]
    v_pk_add_f32 v[114:115], v[114:115], v[160:161]
    v_rcp_f32 v108, v108
    v_rcp_f32 v109, v109
    v_rcp_f32 v110, v110
    v_rcp_f32 v111, v111
    v_rcp_f32 v112, v112
    v_rcp_f32 v113, v113
    v_rcp_f32 v114, v114
    v_rcp_f32 v115, v115
    v_pk_mul_f32 v[72:73], v[72:73], v[108:109]
    v_pk_mul_f32 v[74:75], v[74:75], v[110:111]
    v_pk_mul_f32 v[88:89], v[88:89], v[112:113]
    v_pk_mul_f32 v[90:91], v[90:91], v[114:115]
    v_cvt_pk_bf16_f32 v104, v72, v73
    v_cvt_pk_bf16_f32 v105, v74, v75
    v_cvt_pk_bf16_f32 v106, v88, v89
    v_cvt_pk_bf16_f32 v107, v90, v91
    s_nop 1
    v_permlane16_swap_b32 v104, v106
    v_permlane16_swap_b32 v105, v107
    buffer_store_dwordx4 v[104:107], v9, s[16:19], s55 offen offset:64 sc1
    s_cmp_ge_u32 s24, 14
    s_cselect_b32 s40, 25, 24
    s_lshl_b32 s41, s25, 1
    s_add_u32 s40, s40, s41
    s_lshl_b32 s40, s40, 8
    s_add_u32 s84, s4, 0x300000
    s_addc_u32 s85, s5, 0
    s_mov_b32 s86, 0x4000
    s_mov_b32 s87, 0x20000
    v_mov_b32 v3, s40
    v_mov_b32 v4, 1
    s_waitcnt vmcnt(0)
    s_barrier
    s_cmp_lg_u32 s28, 0
    s_cbranch_scc1 g3_cin
    s_mov_b64 exec, 1
    buffer_atomic_add v4, v3, s[84:87], 0 offen sc1
    s_mov_b64 exec, -1
g3_cin:
    s_branch g4_in
g3_spare:
    s_cmp_ge_u32 s2, 256
    s_cbranch_scc1 g3_done
    s_load_dwordx2 s[4:5], s[0:1], 80
    s_load_dwordx2 s[6:7], s[0:1], 48
    s_sub_u32 s3, s2, 224
    v_lshrrev_b32 v2, 6, v0
    v_lshlrev_b32 v1, 4, v0
    v_mov_b32 v8, -1
    v_mov_b32 v9, -1
    v_mov_b32 v10, -1
    v_mov_b32 v11, -1
    v_readfirstlane_b32 s28, v2
    s_lshl_b32 s13, s3, 17
    s_waitcnt lgkmcnt(0)
    s_add_u32 s4, s4, s97
    s_addc_u32 s5, s5, 0
    s_add_u32 s8, s4, 0x1d00000
    s_addc_u32 s9, s5, 0
    s_mov_b32 s10, 0x400000
    s_mov_b32 s11, 0x20000
    buffer_store_dwordx4 v[8:11], v1, s[8:11], s13 offen sc1
    s_add_u32 s13, s13, 8192
    buffer_store_dwordx4 v[8:11], v1, s[8:11], s13 offen sc1
    s_add_u32 s13, s13, 8192
    buffer_store_dwordx4 v[8:11], v1, s[8:11], s13 offen sc1
    s_add_u32 s13, s13, 8192
    buffer_store_dwordx4 v[8:11], v1, s[8:11], s13 offen sc1
    s_add_u32 s13, s13, 8192
    buffer_store_dwordx4 v[8:11], v1, s[8:11], s13 offen sc1
    s_add_u32 s13, s13, 8192
    buffer_store_dwordx4 v[8:11], v1, s[8:11], s13 offen sc1
    s_add_u32 s13, s13, 8192
    buffer_store_dwordx4 v[8:11], v1, s[8:11], s13 offen sc1
    s_add_u32 s13, s13, 8192
    buffer_store_dwordx4 v[8:11], v1, s[8:11], s13 offen sc1
    s_add_u32 s13, s13, 8192
    buffer_store_dwordx4 v[8:11], v1, s[8:11], s13 offen sc1
    s_add_u32 s13, s13, 8192
    buffer_store_dwordx4 v[8:11], v1, s[8:11], s13 offen sc1
    s_add_u32 s13, s13, 8192
    buffer_store_dwordx4 v[8:11], v1, s[8:11], s13 offen sc1
    s_add_u32 s13, s13, 8192
    buffer_store_dwordx4 v[8:11], v1, s[8:11], s13 offen sc1
    s_add_u32 s13, s13, 8192
    buffer_store_dwordx4 v[8:11], v1, s[8:11], s13 offen sc1
    s_add_u32 s13, s13, 8192
    buffer_store_dwordx4 v[8:11], v1, s[8:11], s13 offen sc1
    s_add_u32 s13, s13, 8192
    buffer_store_dwordx4 v[8:11], v1, s[8:11], s13 offen sc1
    s_add_u32 s13, s13, 8192
    buffer_store_dwordx4 v[8:11], v1, s[8:11], s13 offen sc1
    s_add_u32 s13, s13, 8192
    s_mov_b32 s40, 14336
    s_add_u32 s84, s4, 0x300000
    s_addc_u32 s85, s5, 0
    s_mov_b32 s86, 0x4000
    s_mov_b32 s87, 0x20000
    v_mov_b32 v3, s40
    v_mov_b32 v4, 1
    s_waitcnt vmcnt(0)
    s_barrier
    s_cmp_lg_u32 s28, 0
    s_cbranch_scc1 g3_spare_cin
    s_mov_b64 exec, 1
    buffer_atomic_add v4, v3, s[84:87], 0 offen sc1
    s_mov_b64 exec, -1
g3_spare_cin:
    s_cmp_lg_u32 s96, 0
    s_cbranch_scc1 g3_spare_end
g3_spare_end:
    s_branch g4_in
.p2align 6
g4_in:
    s_cmp_ge_u32 s2, 256
    s_cbranch_scc1 g4_done
    s_load_dwordx2 s[4:5], s[0:1], 80
    s_load_dwordx2 s[6:7], s[0:1], 64
    s_load_dwordx2 s[30:31], s[0:1], 48
    s_load_dwordx2 s[34:35], s[0:1], 56
    v_lshrrev_b32 v1, 6, v0
    v_and_b32 v2, 63, v0
    s_bfe_u32 s40, s2, 0x10001
    s_lshl_b32 s40, s40, 2
    s_bfe_u32 s41, s2, 0x20003
    s_add_u32 s24, s40, s41
    s_bfe_u32 s40, s2, 0x10002
    s_lshl_b32 s40, s40, 3
    s_lshr_b32 s42, s2, 5
    s_add_u32 s25, s40, s42
    s_and_b32 s91, s2, 1
    s_add_u32 s27, s41, s42
    s_lshl_b32 s92, s24, 4
    s_add_u32 s92, s92, s25
    s_mul_i32 s26, s91, 28
    s_cmp_eq_u32 s96, 0
    s_cselect_b32 s95, 3, 1
    v_readfirstlane_b32 s28, v1
    s_nop 0
    s_cmp_lt_u32 s28, 4
    s_cbranch_scc1 g4_compute
    s_sub_u32 s28, s28, 4
    s_mov_b32 s40, 8192
    v_lshrrev_b32 v3, 3, v2
    v_mul_lo_u32 v3, v3, s40
    v_lshrrev_b32 v4, 4, v2
    v_xor_b32 v4, v4, v2
    v_and_b32 v4, 7, v4
    v_lshl_add_u32 v3, v4, 4, v3
    s_mul_i32 s41, s24, 1048576
    s_mul_i32 s42, s28, 262144
    s_add_u32 s41, s41, s42
    v_xor_b32 v4, 64, v3
    s_add_u32 s42, s41, 0
    v_add_u32 v10, s42, v3
    s_add_u32 s42, s41, 65536
    v_add_u32 v11, s42, v4
    s_add_u32 s42, s41, 131072
    v_add_u32 v12, s42, v3
    s_add_u32 s42, s41, 196608
    v_add_u32 v13, s42, v4
    s_mov_b32 s40, 4096
    v_lshrrev_b32 v4, 4, v2
    v_mul_lo_u32 v3, v4, s40
    v_lshlrev_b32 v4, 1, v4
    v_xor_b32 v4, v4, v2
    v_and_b32 v4, 15, v4
    v_lshl_add_u32 v3, v4, 4, v3
    s_mul_i32 s41, s25, 256
    s_mul_i32 s42, s28, 65536
    s_add_u32 s41, s41, s42
    v_xor_b32 v4, 128, v3
    s_add_u32 s42, s41, 0
    v_add_u32 v14, s42, v3
    s_add_u32 s42, s41, 16384
    v_add_u32 v15, s42, v3
    s_add_u32 s42, s41, 32768
    v_add_u32 v16, s42, v4
    s_add_u32 s42, s41, 49152
    v_add_u32 v17, s42, v4
    s_mul_i32 s36, s28, 4096
    s_mul_i32 s37, s28, 4096
    s_add_u32 s37, s37, 16384
    s_waitcnt lgkmcnt(0)
    s_add_u32 s4, s4, s97
    s_addc_u32 s5, s5, 0
    s_add_u32 s8, s4, 0x1100000
    s_addc_u32 s9, s5, 0
    s_mov_b32 s10, 0x800000
    s_mov_b32 s11, 0x20000
    s_mov_b32 s12, s30
    s_mov_b32 s13, s31
    s_mov_b32 s14, 0xe00000
    s_mov_b32 s15, 0x20000
    s_mov_b32 s32, 0
    s_mov_b32 s33, 0
g4_ld_pW:
    s_add_u32 s40, s32, s27
    s_and_b32 s40, s40, s95
    s_andn2_b32 s41, s32, s95
    s_or_b32 s40, s40, s41
    s_add_u32 s40, s40, s26
    s_mul_i32 s34, s40, 128
    s_mul_i32 s35, s40, 262144
    s_add_u32 s38, s33, s36
    s_add_u32 s39, s33, s37
    s_add_u32 m0, s39, 0
    s_nop 0
    buffer_load_dwordx4 v14, s[12:15], s35 offen lds
    s_add_u32 m0, s39, 1024
    s_nop 0
    buffer_load_dwordx4 v15, s[12:15], s35 offen lds
    s_add_u32 m0, s39, 2048
    s_nop 0
    buffer_load_dwordx4 v16, s[12:15], s35 offen lds
    s_add_u32 m0, s39, 3072
    s_nop 0
    buffer_load_dwordx4 v17, s[12:15], s35 offen lds
    s_add_u32 s33, s33, 32768
    s_add_u32 s32, s32, 1
    s_cmp_lt_u32 s32, 4
    s_cbranch_scc1 g4_ld_pW
    s_lshl_b32 s40, s24, 1
    s_add_u32 s40, s40, s91
    s_add_u32 s40, s40, 24
    s_lshl_b32 s40, s40, 8
    s_mov_b32 s42, 14336
    s_cmp_lg_u32 s28, 0
    s_cbranch_scc1 g4_dep_set
    s_add_u32 s84, s4, 0x300000
    s_addc_u32 s85, s5, 0
    s_mov_b32 s86, 0x4000
    s_mov_b32 s87, 0x20000
    v_cmp_eq_u32 vcc, 1, v2
    v_mov_b32 v21, s40
    v_mov_b32 v23, s42
    v_cndmask_b32 v21, v21, v23, vcc
    v_mov_b32 v22, 14
    v_mov_b32 v23, 32
    v_cndmask_b32 v22, v22, v23, vcc
    buffer_load_dword v23, v21, s[84:87], 0 offen sc1
g4_dep_set:
    s_lshl_b32 s43, s96, 2
    s_add_u32 s43, s43, 4
    s_mov_b32 s41, 0x80000
    v_mov_b32 v24, 131072
    s_cmp_lg_u32 s28, 0
    s_cbranch_scc1 g4_dep_lds
    s_mov_b32 s41, 0x8000
    s_waitcnt vmcnt(0)
g4_dep:
    v_cmp_lt_u32 vcc, v23, v22
    s_sub_u32 s41, s41, 1
    s_cmp_eq_u32 s41, 0
    s_cbranch_scc1 g4_dep_seen
    s_cbranch_vccz g4_dep_seen
    s_sleep 2
    buffer_load_dword v23, v21, s[84:87], 0 offen sc1
    s_waitcnt vmcnt(0)
    s_branch g4_dep
g4_dep_seen:
    v_mov_b32 v23, s43
    ds_write_b32 v24, v23
    s_branch g4_dep_ok
g4_dep_lds:
    ds_read_b32 v23, v24
    s_sub_u32 s41, s41, 1
    s_waitcnt lgkmcnt(0)
    v_readfirstlane_b32 s40, v23
    s_cmp_eq_u32 s41, 0
    s_cbranch_scc1 g4_dep_ok
    s_cmp_eq_u32 s40, s43
    s_cbranch_scc1 g4_dep_ok
    s_sleep 1
    s_branch g4_dep_lds
g4_dep_ok:
    s_mov_b32 s32, 0
    s_mov_b32 s33, 0
g4_ld_pA:
    s_add_u32 s40, s32, s27
    s_and_b32 s40, s40, s95
    s_andn2_b32 s41, s32, s95
    s_or_b32 s40, s40, s41
    s_add_u32 s40, s40, s26
    s_mul_i32 s34, s40, 128
    s_mul_i32 s35, s40, 262144
    s_add_u32 s38, s33, s36
    s_add_u32 s39, s33, s37
    s_add_u32 m0, s38, 0
    s_nop 0
    buffer_load_dwordx4 v10, s[8:11], s34 offen sc1 lds
    s_add_u32 m0, s38, 1024
    s_nop 0
    buffer_load_dwordx4 v11, s[8:11], s34 offen sc1 lds
    s_add_u32 m0, s38, 2048
    s_nop 0
    buffer_load_dwordx4 v12, s[8:11], s34 offen sc1 lds
    s_add_u32 m0, s38, 3072
    s_nop 0
    buffer_load_dwordx4 v13, s[8:11], s34 offen sc1 lds
    s_add_u32 s33, s33, 32768
    s_add_u32 s32, s32, 1
    s_cmp_lt_u32 s32, 3
    s_cbranch_scc1 g4_ld_pA
    s_waitcnt vmcnt(8)
    s_barrier
    s_add_u32 s40, s32, s27
    s_and_b32 s40, s40, s95
    s_andn2_b32 s41, s32, s95
    s_or_b32 s40, s40, s41
    s_add_u32 s40, s40, s26
    s_mul_i32 s34, s40, 128
    s_mul_i32 s35, s40, 262144
    s_add_u32 s38, s33, s36
    s_add_u32 s39, s33, s37
    s_add_u32 m0, s38, 0
    s_nop 0
    buffer_load_dwordx4 v10, s[8:11], s34 offen sc1 lds
    s_add_u32 m0, s38, 1024
    s_nop 0
    buffer_load_dwordx4 v11, s[8:11], s34 offen sc1 lds
    s_add_u32 m0, s38, 2048
    s_nop 0
    buffer_load_dwordx4 v12, s[8:11], s34 offen sc1 lds
    s_add_u32 m0, s38, 3072
    s_nop 0
    buffer_load_dwordx4 v13, s[8:11], s34 offen sc1 lds
    s_mov_b32 s33, 0
    s_add_u32 s32, s32, 1
g4_ld_loop:
    s_cmp_eq_u32 s32, 4
    s_cbranch_scc1 g4_ld_s4
    s_cmp_eq_u32 s32, 5
    s_cbranch_scc1 g4_ld_s5
    s_waitcnt vmcnt(16)
g4_ld_bar:
    s_barrier
    s_add_u32 s40, s32, s27
    s_and_b32 s40, s40, s95
    s_andn2_b32 s41, s32, s95
    s_or_b32 s40, s40, s41
    s_add_u32 s40, s40, s26
    s_mul_i32 s34, s40, 128
    s_mul_i32 s35, s40, 262144
    s_add_u32 s38, s33, s36
    s_add_u32 s39, s33, s37
    s_add_u32 m0, s38, 0
    s_nop 0
    buffer_load_dwordx4 v10, s[8:11], s34 offen sc1 lds
    s_add_u32 m0, s38, 1024
    s_nop 0
    buffer_load_dwordx4 v11, s[8:11], s34 offen sc1 lds
    s_add_u32 m0, s38, 2048
    s_nop 0
    buffer_load_dwordx4 v12, s[8:11], s34 offen sc1 lds
    s_add_u32 m0, s38, 3072
    s_nop 0
    buffer_load_dwordx4 v13, s[8:11], s34 offen sc1 lds
    s_add_u32 m0, s39, 0
    s_nop 0
    buffer_load_dwordx4 v14, s[12:15], s35 offen lds
    s_add_u32 m0, s39, 1024
    s_nop 0
    buffer_load_dwordx4 v15, s[12:15], s35 offen lds
    s_add_u32 m0, s39, 2048
    s_nop 0
    buffer_load_dwordx4 v16, s[12:15], s35 offen lds
    s_add_u32 m0, s39, 3072
    s_nop 0
    buffer_load_dwordx4 v17, s[12:15], s35 offen lds
    s_add_u32 s33, s33, 32768
    s_add_u32 s32, s32, 1
    s_cmp_eq_u32 s33, 131072
    s_cselect_b32 s33, 0, s33
    s_cmp_lt_u32 s32, 28
    s_cbranch_scc1 g4_ld_loop
    s_waitcnt vmcnt(16)
    s_barrier
    s_waitcnt vmcnt(8)
    s_barrier
    s_waitcnt vmcnt(0)
    s_barrier
    s_branch g4_ld_end
g4_ld_s4:
    s_waitcnt vmcnt(8)
    s_branch g4_ld_bar
g4_ld_s5:
    s_waitcnt vmcnt(12)
    s_branch g4_ld_bar
g4_ld_end:
    s_cmp_lg_u32 s96, 0
    s_cbranch_scc1 g4_done
    s_barrier
    s_mov_b32 s96, 1
    s_mov_b32 s97, 0x2800000
    s_branch g1_in
g4_done:
    s_endpgm
g4_compute:
    v_lshrrev_b32 v5, 4, v2
    v_bfe_u32 v6, v2, 2, 2
    v_and_b32 v7, 3, v2
    v_and_b32 v8, 15, v2
    s_and_b32 s44, s28, 1
    s_lshr_b32 s45, s28, 1
    s_mul_i32 s40, s25, 128
    s_mul_i32 s41, s45, 64
    s_add_u32 s40, s40, s41
    s_lshl_b32 s41, s91, 5
    s_add_u32 s40, s40, s41
    v_add_u32 v20, s40, v8
    s_mov_b32 s41, 2048
    v_mul_lo_u32 v9, v20, s41
    s_mul_i32 s40, s24, 256
    s_mul_i32 s41, s44, 128
    s_add_u32 s46, s40, s41
    v_and_b32 v3, 1, v5
    v_lshlrev_b32 v3, 5, v3
    v_lshrrev_b32 v4, 1, v5
    v_lshl_add_u32 v3, v4, 4, v3
    v_add3_u32 v9, v9, v3, s46
    s_mov_b32 s52, 0
    s_mov_b32 s53, 32768
    s_mov_b32 s54, 65536
    s_mov_b32 s55, 98304
    s_waitcnt lgkmcnt(0)
    s_add_u32 s4, s4, s97
    s_addc_u32 s5, s5, 0
    s_add_u32 s20, s4, 0x800000
    s_addc_u32 s21, s5, 0
    s_mov_b32 s22, 0x400000
    s_mov_b32 s23, 0x20000
    s_mov_b32 s56, s34
    s_mov_b32 s57, s35
    s_mov_b32 s58, 0x1000
    s_mov_b32 s59, 0x20000
    s_add_u32 s16, s4, 0x4100000
    s_addc_u32 s17, s5, 0
    s_cmp_eq_u32 s96, 0
    s_cselect_b32 s16, s16, s6
    s_cselect_b32 s17, s17, s7
    s_mov_b32 s18, 0x400000
    s_mov_b32 s19, 0x20000
    s_add_u32 s60, s4, 0x2800000
    s_addc_u32 s61, s5, 0
    s_mov_b32 s62, 0x40000
    s_mov_b32 s63, 0x20000
    s_add_u32 s84, s4, 0x1d00000
    s_addc_u32 s85, s5, 0
    s_mov_b32 s86, 0x400000
    s_mov_b32 s87, 0x20000
    s_mul_i32 s42, s44, 64
    v_lshrrev_b32 v3, 1, v8
    v_xor_b32 v3, v3, v5
    v_lshlrev_b32 v3, 4, v3
    v_lshl_add_u32 v3, v8, 7, v3
    s_lshl_b32 s40, s42, 7
    s_add_u32 s40, s40, 0
    v_add_u32 v10, s40, v3
    v_xor_b32 v11, 64, v10
    s_lshl_b32 s90, s91, 1
    s_mul_i32 s42, s45, 4
    s_mov_b32 s43, 16384
    v_and_b32 v3, 1, v5
    v_lshl_or_b32 v3, v3, 2, v6
    s_add_u32 s40, s42, 0
    s_xor_b32 s40, s40, s90
    v_xor_b32 v3, s40, v3
    v_lshlrev_b32 v3, 5, v3
    v_lshl_add_u32 v3, v7, 3, v3
    v_lshl_add_u32 v4, v5, 3, v6
    v_lshl_add_u32 v3, v4, 8, v3
    v_add_u32 v12, s43, v3
    v_and_b32 v3, 1, v5
    v_lshl_or_b32 v3, v3, 2, v6
    s_add_u32 s40, s42, 1
    s_xor_b32 s40, s40, s90
    v_xor_b32 v3, s40, v3
    v_lshlrev_b32 v3, 5, v3
    v_lshl_add_u32 v3, v7, 3, v3
    v_lshl_add_u32 v4, v5, 3, v6
    v_lshl_add_u32 v3, v4, 8, v3
    v_add_u32 v13, s43, v3
    v_and_b32 v3, 1, v5
    v_lshl_or_b32 v3, v3, 2, v6
    s_add_u32 s40, s42, 2
    s_xor_b32 s40, s40, s90
    v_xor_b32 v3, s40, v3
    v_lshlrev_b32 v3, 5, v3
    v_lshl_add_u32 v3, v7, 3, v3
    v_lshl_add_u32 v4, v5, 3, v6
    v_lshl_add_u32 v3, v4, 8, v3
    v_add_u32 v14, s43, v3
    v_and_b32 v3, 1, v5
    v_lshl_or_b32 v3, v3, 2, v6
    s_add_u32 s40, s42, 3
    s_xor_b32 s40, s40, s90
    v_xor_b32 v3, s40, v3
    v_lshlrev_b32 v3, 5, v3
    v_lshl_add_u32 v3, v7, 3, v3
    v_lshl_add_u32 v4, v5, 3, v6
    v_lshl_add_u32 v3, v4, 8, v3
    v_add_u32 v15, s43, v3
    v_mov_b32 v124, 0
    v_mov_b32 v125, 0
    v_mov_b32 v126, 0
    v_mov_b32 v127, 0
    v_mov_b32 v128, 0
    v_mov_b32 v129, 0
    v_mov_b32 v130, 0
    v_mov_b32 v131, 0
    v_mov_b32 v132, 0
    v_mov_b32 v133, 0
    v_mov_b32 v134, 0
    v_mov_b32 v135, 0
    v_mov_b32 v136, 0
    v_mov_b32 v137, 0
    v_mov_b32 v138, 0
    v_mov_b32 v139, 0
    v_mov_b32 v140, 0
    v_mov_b32 v141, 0
    v_mov_b32 v142, 0
    v_mov_b32 v143, 0
    v_mov_b32 v144, 0
    v_mov_b32 v145, 0
    v_mov_b32 v146, 0
    v_mov_b32 v147, 0
    v_mov_b32 v148, 0
    v_mov_b32 v149, 0
    v_mov_b32 v150, 0
    v_mov_b32 v151, 0
    v_mov_b32 v152, 0
    v_mov_b32 v153, 0
    v_mov_b32 v154, 0
    v_mov_b32 v155, 0
    s_mov_b32 s48, 28
    s_mov_b32 s50, 0
    s_mov_b32 s51, 32768
    s_mov_b32 s29, 0xfffe8000
    s_lshl_b32 s40, s28, 12
    v_lshl_add_u32 v21, v2, 4, s40
    s_lshl_b32 s93, s92, 1
    s_add_u32 s93, s93, s91
    s_lshl_b32 s93, s93, 14
    s_xor_b32 s94, s93, 0x4000
    v_mov_b32 v28, 0
    v_mov_b32 v29, 0
    v_mov_b32 v30, 0
    v_mov_b32 v31, 0
    v_mov_b32 v32, 0
    v_mov_b32 v33, 0
    v_mov_b32 v34, 0
    v_mov_b32 v35, 0
    v_mov_b32 v36, 0
    v_mov_b32 v37, 0
    v_mov_b32 v38, 0
    v_mov_b32 v39, 0
    v_mov_b32 v40, 0
    v_mov_b32 v41, 0
    v_mov_b32 v42, 0
    v_mov_b32 v43, 0
    v_mov_b32 v44, 0
    v_mov_b32 v45, 0
    v_mov_b32 v46, 0
    v_mov_b32 v47, 0
    v_mov_b32 v48, 0
    v_mov_b32 v49, 0
    v_mov_b32 v50, 0
    v_mov_b32 v51, 0
    v_mov_b32 v52, 0
    v_mov_b32 v53, 0
    v_mov_b32 v54, 0
    v_mov_b32 v55, 0
    v_mov_b32 v56, 0
    v_mov_b32 v57, 0
    v_mov_b32 v58, 0
    v_mov_b32 v59, 0
    v_mov_b32 v60, 0
    v_mov_b32 v61, 0
    v_mov_b32 v62, 0
    v_mov_b32 v63, 0
    v_mov_b32 v64, 0
    v_mov_b32 v65, 0
    v_mov_b32 v66, 0
    v_mov_b32 v67, 0
    v_mov_b32 v68, 0
    v_mov_b32 v69, 0
    v_mov_b32 v70, 0
    v_mov_b32 v71, 0
    v_mov_b32 v72, 0
    v_mov_b32 v73, 0
    v_mov_b32 v74, 0
    v_mov_b32 v75, 0
    v_mov_b32 v76, 0
    v_mov_b32 v77, 0
    v_mov_b32 v78, 0
    v_mov_b32 v79, 0
    v_mov_b32 v80, 0
    v_mov_b32 v81, 0
    v_mov_b32 v82, 0
    v_mov_b32 v83, 0
    v_mov_b32 v84, 0
    v_mov_b32 v85, 0
    v_mov_b32 v86, 0
    v_mov_b32 v87, 0
    v_mov_b32 v88, 0
    v_mov_b32 v89, 0
    v_mov_b32 v90, 0
    v_mov_b32 v91, 0
    s_barrier
    buffer_load_dwordx4 v[188:191], v9, s[20:23], s52 offen offset:0 sc1
    buffer_load_dwordx4 v[192:195], v9, s[20:23], s52 offen offset:64 sc1
    buffer_load_dwordx4 v[196:199], v9, s[20:23], s53 offen offset:0 sc1
    buffer_load_dwordx4 v[200:203], v9, s[20:23], s53 offen offset:64 sc1
    v_lshlrev_b32 v3, 1, v20
    buffer_load_ushort v22, v3, s[56:59], 0 offen offset:0
    buffer_load_ushort v23, v3, s[56:59], 0 offen offset:32
    s_branch g4_cloop2
.p2align 3
g4_cloop:
    s_barrier
g4_cloop2:
    v_mfma_f32_16x16x32_bf16 v[28:31], v[124:127], v[140:143], v[28:31]
    ds_read_b128 v[92:95], v10 offset:0
    v_mfma_f32_16x16x32_bf16 v[32:35], v[124:127], v[144:147], v[32:35]
    ds_read_b64_tr_b16 v[108:109], v12 offset:0
    ds_read_b64_tr_b16 v[110:111], v12 offset:1024
    v_mfma_f32_16x16x32_bf16 v[36:39], v[124:127], v[148:151], v[36:39]
    ds_read_b64_tr_b16 v[112:113], v13 offset:0
    ds_read_b64_tr_b16 v[114:115], v13 offset:1024
    v_mfma_f32_16x16x32_bf16 v[40:43], v[124:127], v[152:155], v[40:43]
    ds_read_b64_tr_b16 v[116:117], v14 offset:0
    ds_read_b64_tr_b16 v[118:119], v14 offset:1024
    v_mfma_f32_16x16x32_bf16 v[56:59], v[128:131], v[152:155], v[56:59]
    ds_read_b64_tr_b16 v[120:121], v15 offset:0
    ds_read_b64_tr_b16 v[122:123], v15 offset:1024
    v_mfma_f32_16x16x32_bf16 v[52:55], v[128:131], v[148:151], v[52:55]
    ds_read_b128 v[96:99], v10 offset:2048
    v_mfma_f32_16x16x32_bf16 v[48:51], v[128:131], v[144:147], v[48:51]
    ds_read_b128 v[100:103], v10 offset:4096
    v_mfma_f32_16x16x32_bf16 v[44:47], v[128:131], v[140:143], v[44:47]
    ds_read_b128 v[104:107], v10 offset:6144
    v_mfma_f32_16x16x32_bf16 v[60:63], v[132:135], v[140:143], v[60:63]
    v_mfma_f32_16x16x32_bf16 v[64:67], v[132:135], v[144:147], v[64:67]
    v_mfma_f32_16x16x32_bf16 v[68:71], v[132:135], v[148:151], v[68:71]
    v_mfma_f32_16x16x32_bf16 v[72:75], v[132:135], v[152:155], v[72:75]
    v_mfma_f32_16x16x32_bf16 v[88:91], v[136:139], v[152:155], v[88:91]
    v_mfma_f32_16x16x32_bf16 v[84:87], v[136:139], v[148:151], v[84:87]
    v_mfma_f32_16x16x32_bf16 v[80:83], v[136:139], v[144:147], v[80:83]
    v_mfma_f32_16x16x32_bf16 v[76:79], v[136:139], v[140:143], v[76:79]
    s_waitcnt lgkmcnt(0)
    v_mfma_f32_16x16x32_bf16 v[28:31], v[92:95], v[108:111], v[28:31]
    ds_read_b128 v[124:127], v11 offset:0
    v_mfma_f32_16x16x32_bf16 v[32:35], v[92:95], v[112:115], v[32:35]
    ds_read_b64_tr_b16 v[140:141], v12 offset:8192
    ds_read_b64_tr_b16 v[142:143], v12 offset:9216
    v_mfma_f32_16x16x32_bf16 v[36:39], v[92:95], v[116:119], v[36:39]
    ds_read_b64_tr_b16 v[144:145], v13 offset:8192
    ds_read_b64_tr_b16 v[146:147], v13 offset:9216
    v_mfma_f32_16x16x32_bf16 v[40:43], v[92:95], v[120:123], v[40:43]
    ds_read_b64_tr_b16 v[148:149], v14 offset:8192
    ds_read_b64_tr_b16 v[150:151], v14 offset:9216
    v_mfma_f32_16x16x32_bf16 v[56:59], v[96:99], v[120:123], v[56:59]
    ds_read_b64_tr_b16 v[152:153], v15 offset:8192
    ds_read_b64_tr_b16 v[154:155], v15 offset:9216
    v_mfma_f32_16x16x32_bf16 v[52:55], v[96:99], v[116:119], v[52:55]
    ds_read_b128 v[128:131], v11 offset:2048
    v_mfma_f32_16x16x32_bf16 v[48:51], v[96:99], v[112:115], v[48:51]
    ds_read_b128 v[132:135], v11 offset:4096
    v_mfma_f32_16x16x32_bf16 v[44:47], v[96:99], v[108:111], v[44:47]
    ds_read_b128 v[136:139], v11 offset:6144
    v_mfma_f32_16x16x32_bf16 v[60:63], v[100:103], v[108:111], v[60:63]
    s_add_u32 s50, s50, 1
    s_cmp_eq_u32 s50, 4
    v_mfma_f32_16x16x32_bf16 v[64:67], v[100:103], v[112:115], v[64:67]
    s_cselect_b32 s49, s29, s51
    s_cselect_b32 s50, 0, s50
    v_mfma_f32_16x16x32_bf16 v[68:71], v[100:103], v[116:119], v[68:71]
    v_add_u32 v10, s49, v10
    v_add_u32 v11, s49, v11
    v_mfma_f32_16x16x32_bf16 v[72:75], v[100:103], v[120:123], v[72:75]
    v_add_u32 v12, s49, v12
    v_add_u32 v13, s49, v13
    v_mfma_f32_16x16x32_bf16 v[88:91], v[104:107], v[120:123], v[88:91]
    v_add_u32 v14, s49, v14
    v_add_u32 v15, s49, v15
    v_mfma_f32_16x16x32_bf16 v[84:87], v[104:107], v[116:119], v[84:87]
    s_sub_u32 s48, s48, 1
    s_cmp_lg_u32 s48, 0
    v_mfma_f32_16x16x32_bf16 v[80:83], v[104:107], v[112:115], v[80:83]
    v_mfma_f32_16x16x32_bf16 v[76:79], v[104:107], v[108:111], v[76:79]
    s_waitcnt lgkmcnt(0)
    s_cbranch_scc1 g4_cloop
    v_mfma_f32_16x16x32_bf16 v[36:39], v[124:127], v[148:151], v[36:39]
    v_mfma_f32_16x16x32_bf16 v[52:55], v[128:131], v[148:151], v[52:55]
    v_mfma_f32_16x16x32_bf16 v[68:71], v[132:135], v[148:151], v[68:71]
    v_mfma_f32_16x16x32_bf16 v[84:87], v[136:139], v[148:151], v[84:87]
    v_mfma_f32_16x16x32_bf16 v[40:43], v[124:127], v[152:155], v[40:43]
    v_mfma_f32_16x16x32_bf16 v[56:59], v[128:131], v[152:155], v[56:59]
    v_mfma_f32_16x16x32_bf16 v[72:75], v[132:135], v[152:155], v[72:75]
    v_mfma_f32_16x16x32_bf16 v[88:91], v[136:139], v[152:155], v[88:91]
    v_mfma_f32_16x16x32_bf16 v[28:31], v[124:127], v[140:143], v[28:31]
    v_cvt_pk_bf16_f32 v156, v36, v37
    v_cvt_pk_bf16_f32 v157, v38, v39
    v_mfma_f32_16x16x32_bf16 v[44:47], v[128:131], v[140:143], v[44:47]
    v_cvt_pk_bf16_f32 v158, v52, v53
    v_cvt_pk_bf16_f32 v159, v54, v55
    buffer_store_dwordx4 v[156:159], v21, s[84:87], s93 offen offset:0 sc1
    v_mfma_f32_16x16x32_bf16 v[60:63], v[132:135], v[140:143], v[60:63]
    v_cvt_pk_bf16_f32 v160, v68, v69
    v_cvt_pk_bf16_f32 v161, v70, v71
    v_mfma_f32_16x16x32_bf16 v[76:79], v[136:139], v[140:143], v[76:79]
    v_cvt_pk_bf16_f32 v162, v84, v85
    v_cvt_pk_bf16_f32 v163, v86, v87
    buffer_store_dwordx4 v[160:163], v21, s[84:87], s93 offen offset:1024 sc1
    v_mfma_f32_16x16x32_bf16 v[32:35], v[124:127], v[144:147], v[32:35]
    v_cvt_pk_bf16_f32 v164, v40, v41
    v_cvt_pk_bf16_f32 v165, v42, v43
    v_mfma_f32_16x16x32_bf16 v[48:51], v[128:131], v[144:147], v[48:51]
    v_cvt_pk_bf16_f32 v166, v56, v57
    v_cvt_pk_bf16_f32 v167, v58, v59
    buffer_store_dwordx4 v[164:167], v21, s[84:87], s93 offen offset:2048 sc1
    v_mfma_f32_16x16x32_bf16 v[64:67], v[132:135], v[144:147], v[64:67]
    v_cvt_pk_bf16_f32 v168, v72, v73
    v_cvt_pk_bf16_f32 v169, v74, v75
    v_mfma_f32_16x16x32_bf16 v[80:83], v[136:139], v[144:147], v[80:83]
    s_nop 1
    v_cvt_pk_bf16_f32 v170, v88, v89
    v_cvt_pk_bf16_f32 v171, v90, v91
    buffer_store_dwordx4 v[168:171], v21, s[84:87], s93 offen offset:3072 sc1
    s_mov_b32 s48, 0x2000
    buffer_load_dwordx4 v[172:175], v21, s[84:87], s94 offen offset:0 sc1
    buffer_load_dwordx4 v[176:179], v21, s[84:87], s94 offen offset:1024 sc1
    buffer_load_dwordx4 v[180:183], v21, s[84:87], s94 offen offset:2048 sc1
    buffer_load_dwordx4 v[184:187], v21, s[84:87], s94 offen offset:3072 sc1
    s_waitcnt vmcnt(8)
    s_nop 3
    v_permlane16_swap_b32 v188, v190
    v_permlane16_swap_b32 v189, v191
    v_permlane16_swap_b32 v192, v194
    v_permlane16_swap_b32 v193, v195
    v_permlane16_swap_b32 v196, v198
    v_permlane16_swap_b32 v197, v199
    v_permlane16_swap_b32 v200, v202
    v_permlane16_swap_b32 v201, v203
    v_lshlrev_b32 v22, 16, v22
    v_lshlrev_b32 v23, 16, v23
    v_lshlrev_b32 v204, 16, v188
    v_and_b32 v205, 0xffff0000, v188
    v_lshlrev_b32 v206, 16, v189
    v_and_b32 v207, 0xffff0000, v189
    v_lshlrev_b32 v208, 16, v190
    v_and_b32 v209, 0xffff0000, v190
    v_lshlrev_b32 v210, 16, v191
    v_and_b32 v211, 0xffff0000, v191
    v_add_f32 v204, v204, v22
    v_add_f32 v205, v205, v22
    v_add_f32 v206, v206, v22
    v_add_f32 v207, v207, v22
    v_add_f32 v208, v208, v22
    v_add_f32 v209, v209, v22
    v_add_f32 v210, v210, v22
    v_add_f32 v211, v211, v22
    v_pk_add_f32 v[28:29], v[28:29], v[204:205]
    v_pk_add_f32 v[30:31], v[30:31], v[206:207]
    v_pk_add_f32 v[44:45], v[44:45], v[208:209]
    v_pk_add_f32 v[46:47], v[46:47], v[210:211]
    v_lshlrev_b32 v204, 16, v192
    v_and_b32 v205, 0xffff0000, v192
    v_lshlrev_b32 v206, 16, v193
    v_and_b32 v207, 0xffff0000, v193
    v_lshlrev_b32 v208, 16, v194
    v_and_b32 v209, 0xffff0000, v194
    v_lshlrev_b32 v210, 16, v195
    v_and_b32 v211, 0xffff0000, v195
    v_add_f32 v204, v204, v22
    v_add_f32 v205, v205, v22
    v_add_f32 v206, v206, v22
    v_add_f32 v207, v207, v22
    v_add_f32 v208, v208, v22
    v_add_f32 v209, v209, v22
    v_add_f32 v210, v210, v22
    v_add_f32 v211, v211, v22
    v_pk_add_f32 v[60:61], v[60:61], v[204:205]
    v_pk_add_f32 v[62:63], v[62:63], v[206:207]
    v_pk_add_f32 v[76:77], v[76:77], v[208:209]
    v_pk_add_f32 v[78:79], v[78:79], v[210:211]
    v_lshlrev_b32 v204, 16, v196
    v_and_b32 v205, 0xffff0000, v196
    v_lshlrev_b32 v206, 16, v197
    v_and_b32 v207, 0xffff0000, v197
    v_lshlrev_b32 v208, 16, v198
    v_and_b32 v209, 0xffff0000, v198
    v_lshlrev_b32 v210, 16, v199
    v_and_b32 v211, 0xffff0000, v199
    v_add_f32 v204, v204, v23
    v_add_f32 v205, v205, v23
    v_add_f32 v206, v206, v23
    v_add_f32 v207, v207, v23
    v_add_f32 v208, v208, v23
    v_add_f32 v209, v209, v23
    v_add_f32 v210, v210, v23
    v_add_f32 v211, v211, v23
    v_pk_add_f32 v[32:33], v[32:33], v[204:205]
    v_pk_add_f32 v[34:35], v[34:35], v[206:207]
    v_pk_add_f32 v[48:49], v[48:49], v[208:209]
    v_pk_add_f32 v[50:51], v[50:51], v[210:211]
    v_lshlrev_b32 v204, 16, v200
    v_and_b32 v205, 0xffff0000, v200
    v_lshlrev_b32 v206, 16, v201
    v_and_b32 v207, 0xffff0000, v201
    v_lshlrev_b32 v208, 16, v202
    v_and_b32 v209, 0xffff0000, v202
    v_lshlrev_b32 v210, 16, v203
    v_and_b32 v211, 0xffff0000, v203
    v_add_f32 v204, v204, v23
    v_add_f32 v205, v205, v23
    v_add_f32 v206, v206, v23
    v_add_f32 v207, v207, v23
    v_add_f32 v208, v208, v23
    v_add_f32 v209, v209, v23
    v_add_f32 v210, v210, v23
    v_add_f32 v211, v211, v23
    v_pk_add_f32 v[64:65], v[64:65], v[204:205]
    v_pk_add_f32 v[66:67], v[66:67], v[206:207]
    v_pk_add_f32 v[80:81], v[80:81], v[208:209]
    v_pk_add_f32 v[82:83], v[82:83], v[210:211]
    s_waitcnt vmcnt(0)
g4_rcv:
    v_max3_u32 v4, v172, v173, v174
    v_max3_u32 v4, v4, v175, v176
    v_max3_u32 v4, v4, v177, v178
    v_max3_u32 v4, v4, v179, v180
    v_max3_u32 v4, v4, v181, v182
    v_max3_u32 v4, v4, v183, v184
    v_max3_u32 v4, v4, v185, v186
    v_max_u32 v4, v4, v187
    v_cmp_eq_u32 vcc, -1, v4
    s_sub_u32 s48, s48, 1
    s_cmp_eq_u32 s48, 0
    s_cbranch_scc1 g4_rcvd
    s_cbranch_vccz g4_rcvd
    s_sleep 2
    buffer_load_dwordx4 v[172:175], v21, s[84:87], s94 offen offset:0 sc1
    buffer_load_dwordx4 v[176:179], v21, s[84:87], s94 offen offset:1024 sc1
    buffer_load_dwordx4 v[180:183], v21, s[84:87], s94 offen offset:2048 sc1
    buffer_load_dwordx4 v[184:187], v21, s[84:87], s94 offen offset:3072 sc1
    s_waitcnt vmcnt(0)
    s_branch g4_rcv
g4_rcvd:
    v_lshlrev_b32 v108, 16, v172
    v_and_b32 v109, 0xffff0000, v172
    v_lshlrev_b32 v110, 16, v173
    v_and_b32 v111, 0xffff0000, v173
    v_pk_add_f32 v[28:29], v[28:29], v[108:109]
    v_pk_add_f32 v[30:31], v[30:31], v[110:111]
    v_lshlrev_b32 v112, 16, v174
    v_and_b32 v113, 0xffff0000, v174
    v_lshlrev_b32 v114, 16, v175
    v_and_b32 v115, 0xffff0000, v175
    v_pk_add_f32 v[44:45], v[44:45], v[112:113]
    v_pk_add_f32 v[46:47], v[46:47], v[114:115]
    v_lshlrev_b32 v116, 16, v176
    v_and_b32 v117, 0xffff0000, v176
    v_lshlrev_b32 v118, 16, v177
    v_and_b32 v119, 0xffff0000, v177
    v_pk_add_f32 v[60:61], v[60:61], v[116:117]
    v_pk_add_f32 v[62:63], v[62:63], v[118:119]
    v_lshlrev_b32 v120, 16, v178
    v_and_b32 v121, 0xffff0000, v178
    v_lshlrev_b32 v122, 16, v179
    v_and_b32 v123, 0xffff0000, v179
    v_pk_add_f32 v[76:77], v[76:77], v[120:121]
    v_pk_add_f32 v[78:79], v[78:79], v[122:123]
    v_lshlrev_b32 v108, 16, v180
    v_and_b32 v109, 0xffff0000, v180
    v_lshlrev_b32 v110, 16, v181
    v_and_b32 v111, 0xffff0000, v181
    v_pk_add_f32 v[32:33], v[32:33], v[108:109]
    v_pk_add_f32 v[34:35], v[34:35], v[110:111]
    v_lshlrev_b32 v112, 16, v182
    v_and_b32 v113, 0xffff0000, v182
    v_lshlrev_b32 v114, 16, v183
    v_and_b32 v115, 0xffff0000, v183
    v_pk_add_f32 v[48:49], v[48:49], v[112:113]
    v_pk_add_f32 v[50:51], v[50:51], v[114:115]
    v_lshlrev_b32 v116, 16, v184
    v_and_b32 v117, 0xffff0000, v184
    v_lshlrev_b32 v118, 16, v185
    v_and_b32 v119, 0xffff0000, v185
    v_pk_add_f32 v[64:65], v[64:65], v[116:117]
    v_pk_add_f32 v[66:67], v[66:67], v[118:119]
    v_lshlrev_b32 v120, 16, v186
    v_and_b32 v121, 0xffff0000, v186
    v_lshlrev_b32 v122, 16, v187
    v_and_b32 v123, 0xffff0000, v187
    v_pk_add_f32 v[80:81], v[80:81], v[120:121]
    v_pk_add_f32 v[82:83], v[82:83], v[122:123]
    v_cvt_pk_bf16_f32 v92, v28, v29
    v_cvt_pk_bf16_f32 v93, v30, v31
    v_cvt_pk_bf16_f32 v94, v44, v45
    v_cvt_pk_bf16_f32 v95, v46, v47
    s_nop 1
    v_permlane16_swap_b32 v92, v94
    v_permlane16_swap_b32 v93, v95
    buffer_store_dwordx4 v[92:95], v9, s[16:19], s52 offen offset:0 sc1
    v_cvt_pk_bf16_f32 v96, v60, v61
    v_cvt_pk_bf16_f32 v97, v62, v63
    v_cvt_pk_bf16_f32 v98, v76, v77
    v_cvt_pk_bf16_f32 v99, v78, v79
    s_nop 1
    v_permlane16_swap_b32 v96, v98
    v_permlane16_swap_b32 v97, v99
    buffer_store_dwordx4 v[96:99], v9, s[16:19], s52 offen offset:64 sc1
    v_cvt_pk_bf16_f32 v100, v32, v33
    v_cvt_pk_bf16_f32 v101, v34, v35
    v_cvt_pk_bf16_f32 v102, v48, v49
    v_cvt_pk_bf16_f32 v103, v50, v51
    s_nop 1
    v_permlane16_swap_b32 v100, v102
    v_permlane16_swap_b32 v101, v103
    buffer_store_dwordx4 v[100:103], v9, s[16:19], s53 offen offset:0 sc1
    v_cvt_pk_bf16_f32 v104, v64, v65
    v_cvt_pk_bf16_f32 v105, v66, v67
    v_cvt_pk_bf16_f32 v106, v80, v81
    v_cvt_pk_bf16_f32 v107, v82, v83
    s_nop 1
    v_permlane16_swap_b32 v104, v106
    v_permlane16_swap_b32 v105, v107
    buffer_store_dwordx4 v[104:107], v9, s[16:19], s53 offen offset:64 sc1
    v_pk_add_f32 v[108:109], v[28:29], v[30:31]
    v_pk_mul_f32 v[110:111], v[28:29], v[28:29]
    v_pk_fma_f32 v[110:111], v[30:31], v[30:31], v[110:111]
    v_pk_add_f32 v[108:109], v[108:109], v[44:45]
    v_pk_fma_f32 v[110:111], v[44:45], v[44:45], v[110:111]
    v_pk_add_f32 v[108:109], v[108:109], v[46:47]
    v_pk_fma_f32 v[110:111], v[46:47], v[46:47], v[110:111]
    v_pk_add_f32 v[108:109], v[108:109], v[60:61]
    v_pk_fma_f32 v[110:111], v[60:61], v[60:61], v[110:111]
    v_pk_add_f32 v[108:109], v[108:109], v[62:63]
    v_pk_fma_f32 v[110:111], v[62:63], v[62:63], v[110:111]
    v_pk_add_f32 v[108:109], v[108:109], v[76:77]
    v_pk_fma_f32 v[110:111], v[76:77], v[76:77], v[110:111]
    v_pk_add_f32 v[108:109], v[108:109], v[78:79]
    v_pk_fma_f32 v[110:111], v[78:79], v[78:79], v[110:111]
    v_pk_add_f32 v[112:113], v[32:33], v[34:35]
    v_pk_mul_f32 v[114:115], v[32:33], v[32:33]
    v_pk_fma_f32 v[114:115], v[34:35], v[34:35], v[114:115]
    v_pk_add_f32 v[112:113], v[112:113], v[48:49]
    v_pk_fma_f32 v[114:115], v[48:49], v[48:49], v[114:115]
    v_pk_add_f32 v[112:113], v[112:113], v[50:51]
    v_pk_fma_f32 v[114:115], v[50:51], v[50:51], v[114:115]
    v_pk_add_f32 v[112:113], v[112:113], v[64:65]
    v_pk_fma_f32 v[114:115], v[64:65], v[64:65], v[114:115]
    v_pk_add_f32 v[112:113], v[112:113], v[66:67]
    v_pk_fma_f32 v[114:115], v[66:67], v[66:67], v[114:115]
    v_pk_add_f32 v[112:113], v[112:113], v[80:81]
    v_pk_fma_f32 v[114:115], v[80:81], v[80:81], v[114:115]
    v_pk_add_f32 v[112:113], v[112:113], v[82:83]
    v_pk_fma_f32 v[114:115], v[82:83], v[82:83], v[114:115]
    v_add_f32 v108, v108, v109
    v_add_f32 v109, v110, v111
    v_add_f32 v112, v112, v113
    v_add_f32 v113, v114, v115
    s_nop 1
    v_permlane16_swap_b32 v108, v112
    v_permlane16_swap_b32 v109, v113
    v_pk_add_f32 v[108:109], v[108:109], v[112:113]
    v_mov_b32 v116, v108
    v_mov_b32 v117, v109
    v_and_b32 v3, 16, v2
    v_add_u32 v3, v3, v20
    v_permlane32_swap_b32 v108, v116
    v_permlane32_swap_b32 v109, v117
    v_pk_add_f32 v[108:109], v[108:109], v[116:117]
    v_lshlrev_b32 v3, 3, v3
    s_mul_i32 s40, s24, 2
    s_add_u32 s40, s40, s44
    s_lshl_b32 s40, s40, 14
    s_mov_b32 exec_hi, 0
    buffer_store_dwordx2 v[108:109], v3, s[60:63], s40 offen sc1
    s_mov_b32 exec_hi, -1
    s_cmp_lg_u32 s96, 0
    s_cbranch_scc1 g4_done
    s_lshr_b32 s40, s25, 0
    s_add_u32 s40, s40, 40
    s_lshl_b32 s40, s40, 8
    s_mov_b32 s42, s40
    s_add_u32 s84, s4, 0x2b00000
    s_addc_u32 s85, s5, 0
    s_mov_b32 s86, 0x4000
    s_mov_b32 s87, 0x20000
    v_mov_b32 v3, s40
    v_mov_b32 v4, 1
    s_waitcnt vmcnt(0)
    s_barrier
    s_cmp_lg_u32 s28, 0
    s_cbranch_scc1 g4_cin
    s_mov_b64 exec, 1
    buffer_atomic_add v4, v3, s[84:87], 0 offen sc1
    s_mov_b64 exec, -1
g4_cin:
    s_mov_b32 s96, 1
    s_mov_b32 s97, 0x2800000
    s_branch g1_in
code_end:
.section .rodata,"a"
.p2align 6
.amdhsa_kernel g1a_kernel
  .amdhsa_next_free_vgpr 248
  .amdhsa_next_free_sgpr 100
  .amdhsa_accum_offset 248
  .amdhsa_group_segment_fixed_size 0
  .amdhsa_kernarg_size 88
  .amdhsa_user_sgpr_count 2
  .amdhsa_user_sgpr_kernarg_segment_ptr 1
  .amdhsa_system_sgpr_workgroup_id_x 1
.end_amdhsa_kernel
```

```asm
; @launch kernel=g1a_kernel grid=(256,1,1) block=(512,1,1) lds=131328
.amdgcn_target "amdgcn-amd-amdhsa--gfx950"
.text
.globl g1a_kernel
.p2align 8
.type g1a_kernel,@function
g1a_kernel:
    s_mov_b32 s96, 0
    s_mov_b32 s97, 0x0
    v_mov_b32 v1, 131072
    v_mov_b32 v2, 0
    ds_write_b32 v1, v2
    s_branch g1_in
.p2align 6
g1_in:
    s_cmp_ge_u32 s2, 256
    s_cbranch_scc1 g1_done
    s_load_dwordx2 s[4:5], s[0:1], 80
    s_load_dwordx2 s[6:7], s[0:1], 0
    s_xor_b32 s53, s96, 1
    s_load_dwordx2 s[30:31], s[0:1], 8
    s_load_dwordx2 s[16:17], s[0:1], 72
    s_load_dwordx2 s[18:19], s[0:1], 16
    v_lshrrev_b32 v1, 6, v0
    v_and_b32 v2, 63, v0
    s_and_b32 s40, s2, 1
    s_lshl_b32 s40, s40, 3
    s_bfe_u32 s41, s2, 0x30003
    s_add_u32 s25, s40, s41
    s_bfe_u32 s40, s2, 0x20001
    s_lshl_b32 s40, s40, 2
    s_lshr_b32 s42, s2, 6
    s_add_u32 s24, s40, s42
    s_add_u32 s27, s41, s42
    s_add_u32 s52, s24, s25
    s_and_b32 s52, s52, 15
    s_and_b32 s26, s52, 12
    s_mul_i32 s26, s26, s53
    v_readfirstlane_b32 s28, v1
    v_lshrrev_b32 v5, 4, v2
    v_bfe_u32 v6, v2, 2, 2
    v_and_b32 v7, 3, v2
    v_and_b32 v8, 15, v2
    s_cmp_lt_u32 s28, 4
    s_cbranch_scc1 g1_compute
    s_sub_u32 s28, s28, 4
    s_mov_b32 s40, 2048
    v_lshrrev_b32 v3, 3, v2
    v_mul_lo_u32 v3, v3, s40
    v_lshrrev_b32 v4, 4, v2
    v_xor_b32 v4, v4, v2
    v_and_b32 v4, 7, v4
    v_lshl_add_u32 v3, v4, 4, v3
    s_mul_i32 s41, s25, 262144
    s_mul_i32 s42, s28, 65536
    s_add_u32 s41, s41, s42
    v_xor_b32 v4, 64, v3
    s_add_u32 s42, s41, 0
    v_add_u32 v16, s42, v3
    s_add_u32 s42, s41, 16384
    v_add_u32 v17, s42, v4
    s_add_u32 s42, s41, 32768
    v_add_u32 v18, s42, v3
    s_add_u32 s42, s41, 49152
    v_add_u32 v19, s42, v4
    s_mov_b32 s40, 6144
    v_lshrrev_b32 v3, 3, v2
    v_mul_lo_u32 v3, v3, s40
    v_bfe_u32 v4, v2, 4, 1
    v_lshlrev_b32 v4, 1, v4
    v_xor_b32 v4, v4, v2
    v_and_b32 v4, 7, v4
    v_lshl_add_u32 v3, v4, 4, v3
    s_mul_i32 s41, s24, 128
    s_mul_i32 s42, s28, 98304
    s_add_u32 s41, s41, s42
    v_xor_b32 v4, 64, v3
    s_add_u32 s42, s41, 0
    v_add_u32 v10, s42, v3
    s_add_u32 s42, s41, 49152
    v_add_u32 v11, s42, v4
    s_mov_b32 s40, 6144
    v_lshrrev_b32 v3, 3, v2
    v_mul_lo_u32 v3, v3, s40
    v_bfe_u32 v4, v2, 4, 1
    v_lshlrev_b32 v4, 1, v4
    v_xor_b32 v4, v4, v2
    v_and_b32 v4, 7, v4
    v_lshl_add_u32 v3, v4, 4, v3
    s_mul_i32 s41, s24, 128
    s_mul_i32 s42, s28, 98304
    s_add_u32 s41, s41, s42
    v_xor_b32 v4, 64, v3
    s_add_u32 s42, s41, 2048
    v_add_u32 v12, s42, v3
    s_add_u32 s42, s41, 51200
    v_add_u32 v13, s42, v4
    s_mov_b32 s40, 6144
    v_lshrrev_b32 v3, 3, v2
    v_mul_lo_u32 v3, v3, s40
    v_bfe_u32 v4, v2, 4, 1
    v_lshlrev_b32 v4, 1, v4
    v_xor_b32 v4, v4, v2
    v_and_b32 v4, 7, v4
    v_lshl_add_u32 v3, v4, 4, v3
    s_mul_i32 s41, s24, 128
    s_mul_i32 s42, s28, 98304
    s_add_u32 s41, s41, s42
    v_xor_b32 v4, 64, v3
    s_add_u32 s42, s41, 4096
    v_add_u32 v14, s42, v3
    s_add_u32 s42, s41, 53248
    v_add_u32 v15, s42, v4
    v_lshrrev_b32 v3, 3, v2
    s_lshl_b32 s40, s28, 2
    v_add_u32 v3, s40, v3
    v_lshrrev_b32 v4, 1, v3
    v_xor_b32 v4, v4, v2
    v_and_b32 v4, 7, v4
    s_lshl_b32 s40, s25, 7
    s_sub_u32 s40, s40, 16
    v_add_u32 v3, s40, v3
    v_max_i32 v3, 0, v3
    v_lshlrev_b32 v3, 11, v3
    v_lshl_add_u32 v20, v4, 4, v3
    s_mul_i32 s36, s28, 2048
    s_mul_i32 s37, s28, 4096
    s_add_u32 s37, s37, 26624
    s_mul_i32 s46, s28, 512
    s_add_u32 s46, s46, 24576
    s_waitcnt lgkmcnt(0)
    s_mov_b32 s8, s30
    s_mov_b32 s9, s31
    s_mov_b32 s10, 0x600000
    s_mov_b32 s11, 0x20000
    s_add_u32 s56, s4, 0x100000
    s_addc_u32 s57, s5, 0
    s_mov_b32 s58, 0x30000
    s_mov_b32 s59, 0x20000
    s_add_u32 s4, s4, s97
    s_addc_u32 s5, s5, 0
    s_add_u32 s12, s4, 0x1900000
    s_addc_u32 s13, s5, 0
    s_cmp_eq_u32 s96, 1
    s_cselect_b32 s12, s12, s6
    s_cselect_b32 s13, s13, s7
    s_mov_b32 s14, 0x400000
    s_mov_b32 s15, 0x20000
    s_mov_b32 s20, s4
    s_mov_b32 s21, s5
    s_mov_b32 s22, 0x40000
    s_mov_b32 s23, 0x20000
    s_mov_b32 s60, s16
    s_mov_b32 s61, s17
    s_mov_b32 s62, 0x100
    s_mov_b32 s63, 0x20000
    s_sub_u32 s40, s52, s27
    s_and_b32 s40, s40, 1
    s_and_b32 s41, s52, 2
    s_or_b32 s40, s40, s41
    s_add_u32 s54, s40, 2
    s_cmp_eq_u32 s53, 0
    s_cselect_b32 s54, 0x7fff, s54
    s_add_u32 s55, s54, 3
    s_cmp_lg_u32 s28, 0
    s_cselect_b32 s55, 0x7fff, s55
    s_cmp_lt_u32 s55, 0x7fff
    s_cselect_b32 s29, 12, 0x7fff
    s_add_u32 s50, s29, 1
    s_mov_b32 s51, 14
    s_mov_b32 s32, 0
    s_mov_b32 s33, 0
g1_ld_pW:
    s_add_u32 s40, s32, s27
    s_and_b32 s40, s40, 1
    s_andn2_b32 s41, s32, 1
    s_or_b32 s40, s40, s41
    s_add_u32 s40, s40, s26
    s_and_b32 s40, s40, 15
    s_mul_i32 s34, s40, 393216
    s_mul_i32 s35, s40, 128
    s_add_u32 s38, s33, s36
    s_add_u32 s39, s33, s37
    s_add_u32 m0, s38, 0
    s_nop 0
    buffer_load_dwordx4 v10, s[8:11], s34 offen lds
    s_add_u32 m0, s38, 1024
    s_nop 0
    buffer_load_dwordx4 v11, s[8:11], s34 offen lds
    s_add_u32 m0, s38, 8192
    s_nop 0
    buffer_load_dwordx4 v12, s[8:11], s34 offen lds
    s_add_u32 m0, s38, 9216
    s_nop 0
    buffer_load_dwordx4 v13, s[8:11], s34 offen lds
    s_add_u32 m0, s38, 16384
    s_nop 0
    buffer_load_dwordx4 v14, s[8:11], s34 offen lds
    s_add_u32 m0, s38, 17408
    s_nop 0
    buffer_load_dwordx4 v15, s[8:11], s34 offen lds
    s_add_u32 s33, s33, 43008
    s_add_u32 s32, s32, 1
    s_cmp_lt_u32 s32, 2
    s_cbranch_scc1 g1_ld_pW
    s_cmp_eq_u32 s96, 0
    s_cbranch_scc1 g1_dep_ok
    s_add_u32 s40, s25, 40
    s_lshl_b32 s40, s40, 8
    s_sub_u32 s42, s40, 256
    s_max_u32 s42, s42, 10240
    s_cmp_lg_u32 s28, 0
    s_cbranch_scc1 g1_dep_set
    s_add_u32 s84, s4, 0x300000
    s_addc_u32 s85, s5, 0
    s_mov_b32 s86, 0x4000
    s_mov_b32 s87, 0x20000
    v_cmp_eq_u32 vcc, 1, v2
    v_mov_b32 v21, s40
    v_mov_b32 v23, s42
    v_cndmask_b32 v21, v21, v23, vcc
    v_mov_b32 v22, 16
    v_mov_b32 v23, 16
    v_cndmask_b32 v22, v22, v23, vcc
    buffer_load_dword v23, v21, s[84:87], 0 offen sc1
g1_dep_set:
    s_lshl_b32 s43, s96, 2
    s_add_u32 s43, s43, 1
    s_mov_b32 s41, 0x800000
    v_mov_b32 v24, 131072
    s_cmp_lg_u32 s28, 0
    s_cbranch_scc1 g1_dep_lds
    s_mov_b32 s41, 0x40000
    s_waitcnt vmcnt(0)
g1_dep:
    v_cmp_lt_u32 vcc, v23, v22
    s_sub_u32 s41, s41, 1
    s_cmp_eq_u32 s41, 0
    s_cbranch_scc1 g1_dep_seen
    s_cbranch_vccz g1_dep_seen
    s_sleep 2
    buffer_load_dword v23, v21, s[84:87], 0 offen sc1
    s_waitcnt vmcnt(0)
    s_branch g1_dep
g1_dep_seen:
    v_mov_b32 v23, s43
    ds_write_b32 v24, v23
    s_branch g1_dep_ok
g1_dep_lds:
    ds_read_b32 v23, v24
    s_sub_u32 s41, s41, 1
    s_waitcnt lgkmcnt(0)
    v_readfirstlane_b32 s40, v23
    s_cmp_eq_u32 s41, 0
    s_cbranch_scc1 g1_dep_ok
    s_cmp_eq_u32 s40, s43
    s_cbranch_scc1 g1_dep_ok
    s_sleep 1
    s_branch g1_dep_lds
g1_dep_ok:
    s_mov_b32 s32, 0
    s_mov_b32 s33, 0
g1_ld_pA:
    s_add_u32 s40, s32, s27
    s_and_b32 s40, s40, 1
    s_andn2_b32 s41, s32, 1
    s_or_b32 s40, s40, s41
    s_add_u32 s40, s40, s26
    s_and_b32 s40, s40, 15
    s_mul_i32 s34, s40, 393216
    s_mul_i32 s35, s40, 128
    s_add_u32 s38, s33, s36
    s_add_u32 s39, s33, s37
    s_add_u32 m0, s39, 0
    s_nop 0
    buffer_load_dwordx4 v16, s[12:15], s35 offen sc1 lds
    s_add_u32 m0, s39, 1024
    s_nop 0
    buffer_load_dwordx4 v17, s[12:15], s35 offen sc1 lds
    s_add_u32 m0, s39, 2048
    s_nop 0
    buffer_load_dwordx4 v18, s[12:15], s35 offen sc1 lds
    s_add_u32 m0, s39, 3072
    s_nop 0
    buffer_load_dwordx4 v19, s[12:15], s35 offen sc1 lds
    s_add_u32 m0, s33, s46
    s_mov_b32 exec_hi, 0
    buffer_load_dwordx4 v20, s[12:15], s35 offen sc1 lds
    s_mov_b32 exec_hi, -1
    s_add_u32 s33, s33, 43008
    s_add_u32 s32, s32, 1
    s_cmp_lt_u32 s32, 2
    s_cbranch_scc1 g1_ld_pA
    s_waitcnt vmcnt(5)
    s_branch g1_ld_bar
g1_ld_loop:
    s_sub_u32 s40, s32, s54
    s_sub_u32 s40, s40, 1
    s_cmp_lt_u32 s40, 2
    s_cbranch_scc1 g1_ld_w0
    s_sub_u32 s40, s32, s55
    s_sub_u32 s40, s40, 1
    s_cmp_lt_u32 s40, 2
    s_cbranch_scc1 g1_ld_w1
    s_sub_u32 s40, s32, s29
    s_sub_u32 s40, s40, 1
    s_cmp_lt_u32 s40, 2
    s_cbranch_scc1 g1_ld_w2
    s_sub_u32 s40, s32, s51
    s_sub_u32 s40, s40, 1
    s_cmp_lt_u32 s40, 2
    s_cbranch_scc1 g1_ld_w4
    s_waitcnt vmcnt(11)
g1_ld_bar:
    s_barrier
    s_add_u32 s40, s32, s27
    s_and_b32 s40, s40, 1
    s_andn2_b32 s41, s32, 1
    s_or_b32 s40, s40, s41
    s_add_u32 s40, s40, s26
    s_and_b32 s40, s40, 15
    s_mul_i32 s34, s40, 393216
    s_mul_i32 s35, s40, 128
    s_add_u32 s38, s33, s36
    s_add_u32 s39, s33, s37
    s_add_u32 m0, s39, 0
    s_nop 0
    buffer_load_dwordx4 v16, s[12:15], s35 offen sc1 lds
    s_add_u32 m0, s39, 1024
    s_nop 0
    buffer_load_dwordx4 v17, s[12:15], s35 offen sc1 lds
    s_add_u32 m0, s39, 2048
    s_nop 0
    buffer_load_dwordx4 v18, s[12:15], s35 offen sc1 lds
    s_add_u32 m0, s39, 3072
    s_nop 0
    buffer_load_dwordx4 v19, s[12:15], s35 offen sc1 lds
    s_add_u32 m0, s38, 0
    s_nop 0
    buffer_load_dwordx4 v10, s[8:11], s34 offen lds
    s_add_u32 m0, s38, 1024
    s_nop 0
    buffer_load_dwordx4 v11, s[8:11], s34 offen lds
    s_add_u32 m0, s38, 8192
    s_nop 0
    buffer_load_dwordx4 v12, s[8:11], s34 offen lds
    s_add_u32 m0, s38, 9216
    s_nop 0
    buffer_load_dwordx4 v13, s[8:11], s34 offen lds
    s_add_u32 m0, s38, 16384
    s_nop 0
    buffer_load_dwordx4 v14, s[8:11], s34 offen lds
    s_add_u32 m0, s38, 17408
    s_nop 0
    buffer_load_dwordx4 v15, s[8:11], s34 offen lds
    s_add_u32 m0, s33, s46
    s_mov_b32 exec_hi, 0
    buffer_load_dwordx4 v20, s[12:15], s35 offen sc1 lds
    s_mov_b32 exec_hi, -1
    s_cmp_eq_u32 s32, s54
    s_cbranch_scc1 g1_ld_h0
g1_ld_c0:
    s_cmp_eq_u32 s32, s55
    s_cbranch_scc1 g1_ld_h1
g1_ld_c1:
    s_cmp_eq_u32 s32, s29
    s_cbranch_scc1 g1_ld_h2
g1_ld_c2:
    s_cmp_eq_u32 s32, s50
    s_cbranch_scc1 g1_ld_h3
g1_ld_c3:
    s_cmp_eq_u32 s32, s51
    s_cbranch_scc1 g1_ld_h4
g1_ld_c4:
    s_add_u32 s33, s33, 43008
    s_add_u32 s32, s32, 1
    s_cmp_eq_u32 s33, 129024
    s_cselect_b32 s33, 0, s33
    s_cmp_lt_u32 s32, 16
    s_cbranch_scc1 g1_ld_loop
    s_waitcnt vmcnt(43)
    s_barrier
    s_waitcnt vmcnt(0)
    v_pk_add_f32 v[24:25], v[24:25], v[40:41]
    v_add_f32 v56, v56, v64
    v_pk_add_f32 v[26:27], v[26:27], v[42:43]
    v_add_f32 v57, v57, v65
    v_pk_add_f32 v[28:29], v[28:29], v[44:45]
    v_add_f32 v58, v58, v66
    v_pk_add_f32 v[30:31], v[30:31], v[46:47]
    v_add_f32 v59, v59, v67
    v_pk_add_f32 v[32:33], v[32:33], v[48:49]
    v_add_f32 v60, v60, v68
    v_pk_add_f32 v[34:35], v[34:35], v[50:51]
    v_add_f32 v61, v61, v69
    v_pk_add_f32 v[36:37], v[36:37], v[52:53]
    v_add_f32 v62, v62, v70
    v_pk_add_f32 v[38:39], v[38:39], v[54:55]
    v_add_f32 v63, v63, v71
    v_pk_add_f32 v[24:25], v[24:25], v[32:33]
    v_add_f32 v56, v56, v60
    v_pk_add_f32 v[26:27], v[26:27], v[34:35]
    v_add_f32 v57, v57, v61
    v_pk_add_f32 v[28:29], v[28:29], v[36:37]
    v_add_f32 v58, v58, v62
    v_pk_add_f32 v[30:31], v[30:31], v[38:39]
    v_add_f32 v59, v59, v63
    v_pk_add_f32 v[24:25], v[24:25], v[28:29]
    v_add_f32 v56, v56, v58
    v_pk_add_f32 v[26:27], v[26:27], v[30:31]
    v_add_f32 v57, v57, v59
    v_pk_add_f32 v[24:25], v[24:25], v[26:27]
    v_add_f32 v56, v56, v57
    v_mul_f32 v24, 0x3a800000, v24
    v_mul_f32 v25, 0x3a800000, v25
    v_fma_f32 v25, -v24, v24, v25
    v_max_f32 v25, 0, v25
    v_cvt_pk_bf16_f32 v24, v24, v24
    v_lshlrev_b32 v24, 16, v24
    v_cvt_pk_bf16_f32 v25, v25, v25
    v_lshlrev_b32 v25, 16, v25
    v_add_f32 v25, 0x3727c5ac, v25
    v_cvt_pk_bf16_f32 v25, v25, v25
    v_lshlrev_b32 v25, 16, v25
    v_sqrt_f32 v25, v25
    s_nop 0
    v_cvt_pk_bf16_f32 v25, v25, v25
    v_lshlrev_b32 v25, 16, v25
    v_rcp_f32 v26, v25
    v_lshlrev_b32 v3, 3, v21
    v_lshlrev_b32 v4, 2, v21
    v_mul_f32 v27, -v24, v26
    v_cmp_gt_u32 vcc, 144, v21
    s_and_saveexec_b64 s[40:41], vcc
    v_add_u32 v3, 129024, v3
    ds_write_b64 v3, v[26:27]
    s_mov_b64 exec, s[40:41]
    v_cmp_gt_u32 vcc, 192, v21
    s_and_saveexec_b64 s[40:41], vcc
    v_add_u32 v4, 130304, v4
    ds_write_b32 v4, v56
    s_mov_b64 exec, s[40:41]
    s_waitcnt lgkmcnt(0)
    s_barrier
    s_add_u32 s20, s4, 0x200000
    s_addc_u32 s21, s5, 0
    s_mov_b32 s22, 0x40000
    s_mov_b32 s23, 0x20000
    s_lshl_b32 s40, s24, 4
    s_add_u32 s40, s40, s25
    s_lshl_b32 s40, s40, 10
    s_lshl_b32 s41, s28, 8
    s_add_u32 s40, s40, s41
    v_lshlrev_b32 v3, 2, v2
    v_mov_b32 v4, -1
    buffer_store_dword v4, v3, s[20:23], s40 offen sc1
    s_cmp_eq_u32 s53, 0
    s_cbranch_scc1 g1_nopf
    s_mov_b32 s20, s18
    s_mov_b32 s21, s19
    s_mov_b32 s22, 0x200000
    s_mov_b32 s23, 0x20000
    s_lshl_b32 s40, s2, 13
    s_lshl_b32 s41, s28, 11
    s_add_u32 s40, s40, s41
    v_lshlrev_b32 v3, 4, v2
    buffer_load_dwordx4 v[120:123], v3, s[20:23], s40 offen
    buffer_load_dwordx4 v[120:123], v3, s[20:23], s40 offen offset:1024
g1_nopf:
    s_branch g1_ld_end
g1_ld_w0:
    s_waitcnt vmcnt(16)
    s_branch g1_ld_bar
g1_ld_h0:
    s_add_u32 s44, s33, 43008
    s_cmp_eq_u32 s44, 129024
    s_cselect_b32 s44, 0, s44
    s_mul_i32 s42, s28, 3
    s_add_u32 s42, s42, 0
    s_lshr_b32 s43, s42, 2
    s_lshl_b32 s43, s43, 13
    s_add_u32 s43, s43, s44
    s_and_b32 s42, s42, 3
    v_and_b32 v3, 1, v5
    v_lshlrev_b32 v3, 1, v3
    v_lshrrev_b32 v4, 1, v6
    v_or_b32 v3, v3, v4
    s_add_u32 s40, s42, 0
    v_xor_b32 v3, s40, v3
    v_lshlrev_b32 v3, 5, v3
    v_lshl_add_u32 v3, v7, 3, v3
    v_lshl_add_u32 v4, v5, 3, v6
    v_lshl_add_u32 v3, v4, 7, v3
    v_add_u32 v21, s43, v3
    ds_read_b64_tr_b16 v[24:25], v21 offset:0
    ds_read_b64_tr_b16 v[26:27], v21 offset:512
    ds_read_b64_tr_b16 v[28:29], v21 offset:4096
    ds_read_b64_tr_b16 v[30:31], v21 offset:4608
    s_mul_i32 s42, s28, 3
    s_add_u32 s42, s42, 1
    s_lshr_b32 s43, s42, 2
    s_lshl_b32 s43, s43, 13
    s_add_u32 s43, s43, s44
    s_and_b32 s42, s42, 3
    v_and_b32 v3, 1, v5
    v_lshlrev_b32 v3, 1, v3
    v_lshrrev_b32 v4, 1, v6
    v_or_b32 v3, v3, v4
    s_add_u32 s40, s42, 0
    v_xor_b32 v3, s40, v3
    v_lshlrev_b32 v3, 5, v3
    v_lshl_add_u32 v3, v7, 3, v3
    v_lshl_add_u32 v4, v5, 3, v6
    v_lshl_add_u32 v3, v4, 7, v3
    v_add_u32 v21, s43, v3
    ds_read_b64_tr_b16 v[32:33], v21 offset:0
    ds_read_b64_tr_b16 v[34:35], v21 offset:512
    ds_read_b64_tr_b16 v[36:37], v21 offset:4096
    ds_read_b64_tr_b16 v[38:39], v21 offset:4608
    s_mul_i32 s42, s28, 3
    s_add_u32 s42, s42, 2
    s_lshr_b32 s43, s42, 2
    s_lshl_b32 s43, s43, 13
    s_add_u32 s43, s43, s44
    s_and_b32 s42, s42, 3
    v_and_b32 v3, 1, v5
    v_lshlrev_b32 v3, 1, v3
    v_lshrrev_b32 v4, 1, v6
    v_or_b32 v3, v3, v4
    s_add_u32 s40, s42, 0
    v_xor_b32 v3, s40, v3
    v_lshlrev_b32 v3, 5, v3
    v_lshl_add_u32 v3, v7, 3, v3
    v_lshl_add_u32 v4, v5, 3, v6
    v_lshl_add_u32 v3, v4, 7, v3
    v_add_u32 v21, s43, v3
    ds_read_b64_tr_b16 v[40:41], v21 offset:0
    ds_read_b64_tr_b16 v[42:43], v21 offset:512
    ds_read_b64_tr_b16 v[44:45], v21 offset:4096
    ds_read_b64_tr_b16 v[46:47], v21 offset:4608
    s_lshr_b32 s42, s44, 7
    s_lshl_b32 s43, s28, 5
    s_add_u32 s42, s42, s43
    s_add_u32 s42, s42, 16
    v_lshrrev_b32 v3, 1, v8
    v_xor_b32 v3, v3, v5
    v_lshlrev_b32 v3, 4, v3
    v_lshl_add_u32 v3, v8, 7, v3
    s_lshl_b32 s40, s42, 7
    s_add_u32 s40, s40, 24576
    v_add_u32 v22, s40, v3
    v_xor_b32 v23, 64, v22
    ds_read_b128 v[48:51], v22 offset:0
    ds_read_b128 v[52:55], v23 offset:0
    ds_read_b128 v[56:59], v22 offset:2048
    ds_read_b128 v[60:63], v23 offset:2048
    v_mov_b32 v64, 0x3f803f80
    v_mov_b32 v65, 0x3f803f80
    v_mov_b32 v66, 0x3f803f80
    v_mov_b32 v67, 0x3f803f80
    s_mul_i32 s42, s52, 12288
    s_lshl_b32 s43, s24, 8
    s_add_u32 s42, s42, s43
    v_lshl_add_u32 v21, v5, 4, s42
    s_lshl_b32 s42, s52, 14
    s_lshl_b32 s43, s25, 10
    s_add_u32 s42, s42, s43
    s_lshl_b32 s43, s28, 8
    s_add_u32 s42, s42, s43
    v_lshl_add_u32 v22, v8, 3, s42
    s_waitcnt lgkmcnt(0)
    v_mfma_f32_16x16x32_bf16 v[68:71], v[24:27], v[64:67], 0
    v_mfma_f32_16x16x32_bf16 v[72:75], v[32:35], v[64:67], 0
    v_mfma_f32_16x16x32_bf16 v[76:79], v[40:43], v[64:67], 0
    v_mfma_f32_16x16x32_bf16 v[80:83], v[64:67], v[48:51], 0
    v_mfma_f32_16x16x32_bf16 v[84:87], v[48:51], v[48:51], 0
    v_mfma_f32_16x16x32_bf16 v[88:91], v[64:67], v[56:59], 0
    v_mfma_f32_16x16x32_bf16 v[92:95], v[56:59], v[56:59], 0
    v_mfma_f32_16x16x32_bf16 v[68:71], v[28:31], v[64:67], v[68:71]
    v_mfma_f32_16x16x32_bf16 v[72:75], v[36:39], v[64:67], v[72:75]
    v_mfma_f32_16x16x32_bf16 v[76:79], v[44:47], v[64:67], v[76:79]
    v_mfma_f32_16x16x32_bf16 v[80:83], v[64:67], v[52:55], v[80:83]
    v_mfma_f32_16x16x32_bf16 v[84:87], v[52:55], v[52:55], v[84:87]
    v_mfma_f32_16x16x32_bf16 v[88:91], v[64:67], v[60:63], v[88:91]
    v_mfma_f32_16x16x32_bf16 v[92:95], v[60:63], v[60:63], v[92:95]
    v_cmp_eq_u32 s[40:41], 1, v7
    v_cmp_eq_u32 s[42:43], 2, v7
    v_cmp_eq_u32 vcc, 3, v7
    s_nop 7
    v_cndmask_b32 v81, v84, v85, s[40:41]
    v_cndmask_b32 v81, v81, v86, s[42:43]
    v_cndmask_b32 v81, v81, v87, vcc
    v_cndmask_b32 v89, v92, v93, s[40:41]
    v_cndmask_b32 v89, v89, v94, s[42:43]
    v_cndmask_b32 v89, v89, v95, vcc
    s_mov_b32 exec_lo, 0x00f0000f
    s_mov_b32 exec_hi, 0xf0000f00
    buffer_store_dwordx2 v[80:81], v22, s[20:23], 0 offen offset:0 sc1
    buffer_store_dwordx2 v[88:89], v22, s[20:23], 0 offen offset:128 sc1
    s_mov_b32 exec_lo, 0x00010001
    s_mov_b32 exec_hi, 0x00010001
    s_mul_i32 s42, s28, 3
    s_add_u32 s42, s42, 0
    s_lshr_b32 s43, s42, 2
    s_lshl_b32 s43, s43, 12
    s_and_b32 s42, s42, 3
    s_lshl_b32 s42, s42, 6
    s_add_u32 s42, s42, s43
    buffer_store_dwordx4 v[68:71], v21, s[56:59], s42 offen sc1
    s_mul_i32 s42, s28, 3
    s_add_u32 s42, s42, 1
    s_lshr_b32 s43, s42, 2
    s_lshl_b32 s43, s43, 12
    s_and_b32 s42, s42, 3
    s_lshl_b32 s42, s42, 6
    s_add_u32 s42, s42, s43
    buffer_store_dwordx4 v[72:75], v21, s[56:59], s42 offen sc1
    s_mul_i32 s42, s28, 3
    s_add_u32 s42, s42, 2
    s_lshr_b32 s43, s42, 2
    s_lshl_b32 s43, s43, 12
    s_and_b32 s42, s42, 3
    s_lshl_b32 s42, s42, 6
    s_add_u32 s42, s42, s43
    buffer_store_dwordx4 v[76:79], v21, s[56:59], s42 offen sc1
    s_mov_b64 exec, -1
    s_or_b32 s40, s24, s25
    s_or_b32 s40, s40, s28
    s_cmp_lg_u32 s40, 0
    s_cbranch_scc1 g1_nocr
    v_lshlrev_b32 v21, 8, v2
    v_mov_b32 v22, 0
    s_add_u32 s84, s4, 0x300000
    s_addc_u32 s85, s5, 0
    s_mov_b32 s86, 0x4000
    s_mov_b32 s87, 0x20000
    buffer_store_dword v22, v21, s[84:87], 0 offen sc1
    s_add_u32 s84, s4, 0x2b00000
    s_addc_u32 s85, s5, 0
    s_mov_b32 s86, 0x4000
    s_mov_b32 s87, 0x20000
    buffer_store_dword v22, v21, s[84:87], 0 offen sc1
g1_nocr:
    s_branch g1_ld_c0
g1_ld_w1:
    s_waitcnt vmcnt(12)
    s_branch g1_ld_bar
g1_ld_h1:
    v_mov_b32 v21, 0
    v_mov_b32 v22, 1
    s_mov_b64 exec, 1
    buffer_atomic_add v22, v21, s[60:63], 0 offen sc1
    s_mov_b64 exec, -1
    s_branch g1_ld_c1
g1_ld_w2:
    s_waitcnt vmcnt(12)
    s_branch g1_ld_bar
g1_ld_h2:
    v_mov_b32 v21, 0
    buffer_load_dword v23, v21, s[60:63], 0 offen sc1
    s_branch g1_ld_c2
g1_ld_h3:
    s_mov_b32 s41, 0x40000
    v_mov_b32 v21, 0
    s_waitcnt vmcnt(11)
g1_poll:
    v_readfirstlane_b32 s40, v23
    s_sub_u32 s41, s41, 1
    s_cmp_eq_u32 s41, 0
    s_cbranch_scc1 g1_polled
    s_cmp_ge_u32 s40, 256
    s_cbranch_scc1 g1_polled
    s_sleep 8
    buffer_load_dword v23, v21, s[60:63], 0 offen sc1
    s_waitcnt vmcnt(0)
    s_branch g1_poll
g1_polled:
    s_branch g1_ld_c3
g1_ld_w4:
    s_waitcnt vmcnt(43)
    s_branch g1_ld_bar
g1_ld_h4:
    s_lshl_b32 s40, s28, 6
    v_add_u32 v21, s40, v2
    s_lshl_b32 s41, s25, 7
    s_sub_u32 s41, s41, 16
    v_add_u32 v3, s41, v21
    v_max_i32 v3, 0, v3
    v_min_u32 v3, 2047, v3
    v_lshlrev_b32 v3, 3, v3
    s_min_u32 s40, s28, 2
    s_lshl_b32 s40, s40, 12
    s_lshl_b32 s41, s24, 8
    s_add_u32 s40, s40, s41
    v_lshl_add_u32 v4, v2, 2, s40
    s_mov_b32 s40, 0
    buffer_load_dwordx2 v[24:25], v3, s[20:23], s40 offen sc1
    s_mov_b32 s41, 0
    buffer_load_dword v56, v4, s[56:59], s41 offen sc1
    s_mov_b32 s40, 16384
    buffer_load_dwordx2 v[26:27], v3, s[20:23], s40 offen sc1
    s_mov_b32 s41, 12288
    buffer_load_dword v57, v4, s[56:59], s41 offen sc1
    s_mov_b32 s40, 32768
    buffer_load_dwordx2 v[28:29], v3, s[20:23], s40 offen sc1
    s_mov_b32 s41, 24576
    buffer_load_dword v58, v4, s[56:59], s41 offen sc1
    s_mov_b32 s40, 49152
    buffer_load_dwordx2 v[30:31], v3, s[20:23], s40 offen sc1
    s_mov_b32 s41, 36864
    buffer_load_dword v59, v4, s[56:59], s41 offen sc1
    s_mov_b32 s40, 65536
    buffer_load_dwordx2 v[32:33], v3, s[20:23], s40 offen sc1
    s_mov_b32 s41, 49152
    buffer_load_dword v60, v4, s[56:59], s41 offen sc1
    s_mov_b32 s40, 81920
    buffer_load_dwordx2 v[34:35], v3, s[20:23], s40 offen sc1
    s_mov_b32 s41, 61440
    buffer_load_dword v61, v4, s[56:59], s41 offen sc1
    s_mov_b32 s40, 98304
    buffer_load_dwordx2 v[36:37], v3, s[20:23], s40 offen sc1
    s_mov_b32 s41, 73728
    buffer_load_dword v62, v4, s[56:59], s41 offen sc1
    s_mov_b32 s40, 114688
    buffer_load_dwordx2 v[38:39], v3, s[20:23], s40 offen sc1
    s_mov_b32 s41, 86016
    buffer_load_dword v63, v4, s[56:59], s41 offen sc1
    s_mov_b32 s40, 131072
    buffer_load_dwordx2 v[40:41], v3, s[20:23], s40 offen sc1
    s_mov_b32 s41, 98304
    buffer_load_dword v64, v4, s[56:59], s41 offen sc1
    s_mov_b32 s40, 147456
    buffer_load_dwordx2 v[42:43], v3, s[20:23], s40 offen sc1
    s_mov_b32 s41, 110592
    buffer_load_dword v65, v4, s[56:59], s41 offen sc1
    s_mov_b32 s40, 163840
    buffer_load_dwordx2 v[44:45], v3, s[20:23], s40 offen sc1
    s_mov_b32 s41, 122880
    buffer_load_dword v66, v4, s[56:59], s41 offen sc1
    s_mov_b32 s40, 180224
    buffer_load_dwordx2 v[46:47], v3, s[20:23], s40 offen sc1
    s_mov_b32 s41, 135168
    buffer_load_dword v67, v4, s[56:59], s41 offen sc1
    s_mov_b32 s40, 196608
    buffer_load_dwordx2 v[48:49], v3, s[20:23], s40 offen sc1
    s_mov_b32 s41, 147456
    buffer_load_dword v68, v4, s[56:59], s41 offen sc1
    s_mov_b32 s40, 212992
    buffer_load_dwordx2 v[50:51], v3, s[20:23], s40 offen sc1
    s_mov_b32 s41, 159744
    buffer_load_dword v69, v4, s[56:59], s41 offen sc1
    s_mov_b32 s40, 229376
    buffer_load_dwordx2 v[52:53], v3, s[20:23], s40 offen sc1
    s_mov_b32 s41, 172032
    buffer_load_dword v70, v4, s[56:59], s41 offen sc1
    s_mov_b32 s40, 245760
    buffer_load_dwordx2 v[54:55], v3, s[20:23], s40 offen sc1
    s_mov_b32 s41, 184320
    buffer_load_dword v71, v4, s[56:59], s41 offen sc1
    s_branch g1_ld_c4
g1_ld_end:
    s_add_u32 s28, s28, 4
    s_add_u32 s16, s4, 0x400000
    s_addc_u32 s17, s5, 0
    s_mov_b32 s18, 0x400000
    s_mov_b32 s19, 0x20000
    s_and_b32 s44, s28, 1
    s_lshr_b32 s45, s28, 1
    s_lshl_b32 s40, s44, 2
    v_add_u32 v3, s40, v5
    v_and_b32 v4, 7, v8
    v_xor_b32 v3, v3, v4
    v_lshlrev_b32 v3, 4, v3
    v_lshl_add_u32 v3, v8, 8, v3
    s_mul_i32 s41, s45, 4096
    s_add_u32 s41, s41, 43008
    v_add_u32 v226, s41, v3
    v_lshl_add_u32 v3, v5, 2, v6
    v_and_b32 v4, 7, v3
    v_add_u32 v228, s40, v7
    v_xor_b32 v4, v4, v228
    v_lshlrev_b32 v4, 4, v4
    v_lshl_add_u32 v3, v3, 8, v4
    s_add_u32 s41, s41, 36864
    v_add_u32 v227, s41, v3
    v_and_b32 v3, 7, v8
    v_add_u32 v4, 1, v3
    s_or_b32 s40, s25, s45
    s_cmp_eq_u32 s40, 0
    s_cselect_b32 s40, 8, 0
    v_cmp_gt_u32 vcc, 8, v8
    v_mov_b32 v21, s40
    s_mov_b64 s[56:57], vcc
    v_cndmask_b32 v21, 0, v21, vcc
    v_max_u32 v4, v4, v21
    v_add_u32 v3, 8, v3
    v_sub_u32 v3, v3, v4
    v_lshlrev_b32 v21, 2, v5
    v_sub_u32 v21, v21, v4
    v_mov_b32 v22, 0xf149f2ca
    v_add_u32 v23, 0, v21
    v_cmp_ge_u32 vcc, v3, v23
    s_nop 1
    v_cndmask_b32 v228, v22, 0, vcc
    v_add_u32 v23, 1, v21
    v_cmp_ge_u32 vcc, v3, v23
    s_nop 1
    v_cndmask_b32 v229, v22, 0, vcc
    v_add_u32 v23, 2, v21
    v_cmp_ge_u32 vcc, v3, v23
    s_nop 1
    v_cndmask_b32 v230, v22, 0, vcc
    v_add_u32 v23, 3, v21
    v_cmp_ge_u32 vcc, v3, v23
    s_nop 1
    v_cndmask_b32 v231, v22, 0, vcc
    s_lshl_b32 s40, s25, 7
    s_lshl_b32 s41, s45, 5
    s_add_u32 s40, s40, s41
    s_lshl_b32 s40, s40, 11
    s_lshl_b32 s41, s24, 7
    s_add_u32 s40, s40, s41
    s_lshl_b32 s41, s44, 6
    s_add_u32 s40, s40, s41
    v_lshlrev_b32 v225, 12, v8
    v_lshl_add_u32 v225, v5, 4, v225
    v_add_u32 v225, s40, v225
    s_mov_b32 s58, 0x3e3504f3
    s_mov_b32 s59, 0x3fb8aa3b
    s_branch g1_attn
g1_compute:
    s_and_b32 s44, s28, 1
    s_lshr_b32 s45, s28, 1
    s_lshl_b32 s42, s44, 1
    s_mov_b32 s43, 0
    v_and_b32 v3, 1, v5
    v_lshlrev_b32 v3, 1, v3
    v_lshrrev_b32 v4, 1, v6
    v_or_b32 v3, v3, v4
    s_add_u32 s40, s42, 0
    v_xor_b32 v3, s40, v3
    v_lshlrev_b32 v3, 5, v3
    v_lshl_add_u32 v3, v7, 3, v3
    v_lshl_add_u32 v4, v5, 3, v6
    v_lshl_add_u32 v3, v4, 7, v3
    v_add_u32 v10, s43, v3
    v_and_b32 v3, 1, v5
    v_lshlrev_b32 v3, 1, v3
    v_lshrrev_b32 v4, 1, v6
    v_or_b32 v3, v3, v4
    s_add_u32 s40, s42, 1
    v_xor_b32 v3, s40, v3
    v_lshlrev_b32 v3, 5, v3
    v_lshl_add_u32 v3, v7, 3, v3
    v_lshl_add_u32 v4, v5, 3, v6
    v_lshl_add_u32 v3, v4, 7, v3
    v_add_u32 v11, s43, v3
    s_xor_b32 s43, s45, 1
    s_add_u32 s43, s43, 1
    s_mul_i32 s43, s43, 8192
    v_and_b32 v3, 1, v5
    v_lshlrev_b32 v3, 1, v3
    v_lshrrev_b32 v4, 1, v6
    v_or_b32 v3, v3, v4
    s_add_u32 s40, s42, 0
    v_xor_b32 v3, s40, v3
    v_lshlrev_b32 v3, 5, v3
    v_lshl_add_u32 v3, v7, 3, v3
    v_lshl_add_u32 v4, v5, 3, v6
    v_lshl_add_u32 v3, v4, 7, v3
    v_add_u32 v12, s43, v3
    v_and_b32 v3, 1, v5
    v_lshlrev_b32 v3, 1, v3
    v_lshrrev_b32 v4, 1, v6
    v_or_b32 v3, v3, v4
    s_add_u32 s40, s42, 1
    v_xor_b32 v3, s40, v3
    v_lshlrev_b32 v3, 5, v3
    v_lshl_add_u32 v3, v7, 3, v3
    v_lshl_add_u32 v4, v5, 3, v6
    v_lshl_add_u32 v3, v4, 7, v3
    v_add_u32 v13, s43, v3
    s_xor_b32 s43, s45, 0
    s_add_u32 s43, s43, 1
    s_mul_i32 s43, s43, 8192
    v_and_b32 v3, 1, v5
    v_lshlrev_b32 v3, 1, v3
    v_lshrrev_b32 v4, 1, v6
    v_or_b32 v3, v3, v4
    s_add_u32 s40, s42, 0
    v_xor_b32 v3, s40, v3
    v_lshlrev_b32 v3, 5, v3
    v_lshl_add_u32 v3, v7, 3, v3
    v_lshl_add_u32 v4, v5, 3, v6
    v_lshl_add_u32 v3, v4, 7, v3
    v_add_u32 v14, s43, v3
    v_and_b32 v3, 1, v5
    v_lshlrev_b32 v3, 1, v3
    v_lshrrev_b32 v4, 1, v6
    v_or_b32 v3, v3, v4
    s_add_u32 s40, s42, 1
    v_xor_b32 v3, s40, v3
    v_lshlrev_b32 v3, 5, v3
    v_lshl_add_u32 v3, v7, 3, v3
    v_lshl_add_u32 v4, v5, 3, v6
    v_lshl_add_u32 v3, v4, 7, v3
    v_add_u32 v15, s43, v3
    s_mul_i32 s42, s45, 64
    s_add_u32 s42, s42, 16
    v_lshrrev_b32 v3, 1, v8
    v_xor_b32 v3, v3, v5
    v_lshlrev_b32 v3, 4, v3
    v_lshl_add_u32 v3, v8, 7, v3
    s_lshl_b32 s40, s42, 7
    s_add_u32 s40, s40, 24576
    v_add_u32 v16, s40, v3
    v_xor_b32 v17, 64, v16
    v_lshrrev_b32 v3, 1, v8
    v_xor_b32 v3, v3, v5
    v_lshlrev_b32 v3, 4, v3
    v_lshl_add_u32 v3, v8, 7, v3
    v_add_u32 v18, 24576, v3
    v_xor_b32 v19, 64, v18
    v_mov_b32 v24, 0
    v_mov_b32 v25, 0
    v_mov_b32 v26, 0
    v_mov_b32 v27, 0
    v_mov_b32 v28, 0
    v_mov_b32 v29, 0
    v_mov_b32 v30, 0
    v_mov_b32 v31, 0
    v_mov_b32 v32, 0
    v_mov_b32 v33, 0
    v_mov_b32 v34, 0
    v_mov_b32 v35, 0
    v_mov_b32 v36, 0
    v_mov_b32 v37, 0
    v_mov_b32 v38, 0
    v_mov_b32 v39, 0
    v_mov_b32 v40, 0
    v_mov_b32 v41, 0
    v_mov_b32 v42, 0
    v_mov_b32 v43, 0
    v_mov_b32 v44, 0
    v_mov_b32 v45, 0
    v_mov_b32 v46, 0
    v_mov_b32 v47, 0
    v_mov_b32 v48, 0
    v_mov_b32 v49, 0
    v_mov_b32 v50, 0
    v_mov_b32 v51, 0
    v_mov_b32 v52, 0
    v_mov_b32 v53, 0
    v_mov_b32 v54, 0
    v_mov_b32 v55, 0
    v_mov_b32 v56, 0
    v_mov_b32 v57, 0
    v_mov_b32 v58, 0
    v_mov_b32 v59, 0
    v_mov_b32 v60, 0
    v_mov_b32 v61, 0
    v_mov_b32 v62, 0
    v_mov_b32 v63, 0
    v_mov_b32 v64, 0
    v_mov_b32 v65, 0
    v_mov_b32 v66, 0
    v_mov_b32 v67, 0
    v_mov_b32 v68, 0
    v_mov_b32 v69, 0
    v_mov_b32 v70, 0
    v_mov_b32 v71, 0
    v_mov_b32 v72, 0
    v_mov_b32 v73, 0
    v_mov_b32 v74, 0
    v_mov_b32 v75, 0
    v_mov_b32 v76, 0
    v_mov_b32 v77, 0
    v_mov_b32 v78, 0
    v_mov_b32 v79, 0
    v_mov_b32 v80, 0
    v_mov_b32 v81, 0
    v_mov_b32 v82, 0
    v_mov_b32 v83, 0
    v_mov_b32 v84, 0
    v_mov_b32 v85, 0
    v_mov_b32 v86, 0
    v_mov_b32 v87, 0
    v_mov_b32 v88, 0
    v_mov_b32 v89, 0
    v_mov_b32 v90, 0
    v_mov_b32 v91, 0
    v_mov_b32 v92, 0
    v_mov_b32 v93, 0
    v_mov_b32 v94, 0
    v_mov_b32 v95, 0
    v_mov_b32 v96, 0
    v_mov_b32 v97, 0
    v_mov_b32 v98, 0
    v_mov_b32 v99, 0
    v_mov_b32 v100, 0
    v_mov_b32 v101, 0
    v_mov_b32 v102, 0
    v_mov_b32 v103, 0
    v_mov_b32 v104, 0
    v_mov_b32 v105, 0
    v_mov_b32 v106, 0
    v_mov_b32 v107, 0
    v_mov_b32 v108, 0
    v_mov_b32 v109, 0
    v_mov_b32 v110, 0
    v_mov_b32 v111, 0
    v_mov_b32 v112, 0
    v_mov_b32 v113, 0
    v_mov_b32 v114, 0
    v_mov_b32 v115, 0
    v_mov_b32 v116, 0
    v_mov_b32 v117, 0
    v_mov_b32 v118, 0
    v_mov_b32 v119, 0
    v_mov_b32 v120, 0
    v_mov_b32 v121, 0
    v_mov_b32 v122, 0
    v_mov_b32 v123, 0
    v_mov_b32 v124, 0
    v_mov_b32 v125, 0
    v_mov_b32 v126, 0
    v_mov_b32 v127, 0
    v_mov_b32 v172, 0
    v_mov_b32 v173, 0
    v_mov_b32 v174, 0
    v_mov_b32 v175, 0
    v_mov_b32 v176, 0
    v_mov_b32 v177, 0
    v_mov_b32 v178, 0
    v_mov_b32 v179, 0
    v_mov_b32 v180, 0
    v_mov_b32 v181, 0
    v_mov_b32 v182, 0
    v_mov_b32 v183, 0
    v_mov_b32 v184, 0
    v_mov_b32 v185, 0
    v_mov_b32 v186, 0
    v_mov_b32 v187, 0
    v_mov_b32 v188, 0
    v_mov_b32 v189, 0
    v_mov_b32 v190, 0
    v_mov_b32 v191, 0
    v_mov_b32 v192, 0
    v_mov_b32 v193, 0
    v_mov_b32 v194, 0
    v_mov_b32 v195, 0
    v_mov_b32 v196, 0
    v_mov_b32 v197, 0
    v_mov_b32 v198, 0
    v_mov_b32 v199, 0
    v_mov_b32 v200, 0
    v_mov_b32 v201, 0
    v_mov_b32 v202, 0
    v_mov_b32 v203, 0
    v_mov_b32 v204, 0
    v_mov_b32 v205, 0
    v_mov_b32 v206, 0
    v_mov_b32 v207, 0
    v_mov_b32 v208, 0
    v_mov_b32 v209, 0
    v_mov_b32 v210, 0
    v_mov_b32 v211, 0
    v_mov_b32 v212, 0
    v_mov_b32 v213, 0
    v_mov_b32 v214, 0
    v_mov_b32 v215, 0
    s_mov_b32 s48, 16
    s_mov_b32 s50, 0
    s_mov_b32 s51, 43008
    s_mov_b32 s29, 0xfffeb000
    s_waitcnt lgkmcnt(0)
    s_add_u32 s4, s4, s97
    s_addc_u32 s5, s5, 0
    v_lshlrev_b32 v3, 3, v8
    v_add_u32 v217, 129024, v3
    s_mul_i32 s40, s45, 512
    s_add_u32 s40, s40, 129152
    v_add_u32 v216, s40, v3
    s_lshl_b32 s40, s44, 7
    s_add_u32 s40, s40, 130304
    v_lshl_add_u32 v3, v5, 4, s40
    s_mov_b32 s43, 0
    v_add_u32 v218, s43, v3
    s_xor_b32 s43, s45, 1
    s_add_u32 s43, s43, 1
    s_mul_i32 s43, s43, 256
    v_add_u32 v219, s43, v3
    s_xor_b32 s43, s45, 0
    s_add_u32 s43, s43, 1
    s_mul_i32 s43, s43, 256
    v_add_u32 v220, s43, v3
    v_and_b32 v3, 1, v5
    v_lshlrev_b32 v3, 1, v3
    v_lshrrev_b32 v4, 1, v5
    v_add_u32 v3, v3, v4
    s_lshl_b32 s40, s44, 2
    v_add_u32 v3, s40, v3
    v_lshrrev_b32 v4, 1, v8
    v_xor_b32 v3, v3, v4
    v_lshlrev_b32 v3, 4, v3
    v_lshl_add_u32 v3, v8, 7, v3
    s_mul_i32 s42, s45, 8192
    s_add_u32 s42, s42, 45056
    s_mov_b32 s43, 0
    s_add_u32 s40, s42, s43
    v_add_u32 v221, s40, v3
    s_xor_b32 s43, s45, 1
    s_add_u32 s43, s43, 1
    s_mul_i32 s43, s43, 18432
    s_add_u32 s40, s42, s43
    v_add_u32 v222, s40, v3
    s_xor_b32 s43, s45, 0
    s_add_u32 s43, s43, 1
    s_mul_i32 s43, s43, 18432
    s_add_u32 s40, s42, s43
    v_add_u32 v223, s40, v3
    s_add_u32 s40, s43, 43008
    v_add_u32 v224, s40, v3
    s_add_u32 s16, s4, 0x400000
    s_addc_u32 s17, s5, 0
    s_mov_b32 s18, 0x400000
    s_mov_b32 s19, 0x20000
    s_and_b32 s44, s28, 1
    s_lshr_b32 s45, s28, 1
    s_lshl_b32 s40, s44, 2
    v_add_u32 v3, s40, v5
    v_and_b32 v4, 7, v8
    v_xor_b32 v3, v3, v4
    v_lshlrev_b32 v3, 4, v3
    v_lshl_add_u32 v3, v8, 8, v3
    s_mul_i32 s41, s45, 4096
    s_add_u32 s41, s41, 43008
    v_add_u32 v226, s41, v3
    v_lshl_add_u32 v3, v5, 2, v6
    v_and_b32 v4, 7, v3
    v_add_u32 v228, s40, v7
    v_xor_b32 v4, v4, v228
    v_lshlrev_b32 v4, 4, v4
    v_lshl_add_u32 v3, v3, 8, v4
    s_add_u32 s41, s41, 36864
    v_add_u32 v227, s41, v3
    v_and_b32 v3, 7, v8
    v_add_u32 v4, 1, v3
    s_or_b32 s40, s25, s45
    s_cmp_eq_u32 s40, 0
    s_cselect_b32 s40, 8, 0
    v_cmp_gt_u32 vcc, 8, v8
    v_mov_b32 v21, s40
    s_mov_b64 s[56:57], vcc
    v_cndmask_b32 v21, 0, v21, vcc
    v_max_u32 v4, v4, v21
    v_add_u32 v3, 8, v3
    v_sub_u32 v3, v3, v4
    v_lshlrev_b32 v21, 2, v5
    v_sub_u32 v21, v21, v4
    v_mov_b32 v22, 0xf149f2ca
    v_add_u32 v23, 0, v21
    v_cmp_ge_u32 vcc, v3, v23
    s_nop 1
    v_cndmask_b32 v228, v22, 0, vcc
    v_add_u32 v23, 1, v21
    v_cmp_ge_u32 vcc, v3, v23
    s_nop 1
    v_cndmask_b32 v229, v22, 0, vcc
    v_add_u32 v23, 2, v21
    v_cmp_ge_u32 vcc, v3, v23
    s_nop 1
    v_cndmask_b32 v230, v22, 0, vcc
    v_add_u32 v23, 3, v21
    v_cmp_ge_u32 vcc, v3, v23
    s_nop 1
    v_cndmask_b32 v231, v22, 0, vcc
    s_lshl_b32 s40, s25, 7
    s_lshl_b32 s41, s45, 5
    s_add_u32 s40, s40, s41
    s_lshl_b32 s40, s40, 11
    s_lshl_b32 s41, s24, 7
    s_add_u32 s40, s40, s41
    s_lshl_b32 s41, s44, 6
    s_add_u32 s40, s40, s41
    v_lshlrev_b32 v225, 12, v8
    v_lshl_add_u32 v225, v5, 4, v225
    v_add_u32 v225, s40, v225
    s_mov_b32 s58, 0x3e3504f3
    s_mov_b32 s59, 0x3fb8aa3b
.p2align 3
g1_cloop:
    s_barrier
g1_cloop2:
    v_mfma_f32_16x16x32_bf16 v[24:27], v[172:175], v[196:199], v[24:27]
    ds_read_b64_tr_b16 v[128:129], v10 offset:0
    ds_read_b64_tr_b16 v[130:131], v10 offset:512
    v_mfma_f32_16x16x32_bf16 v[28:31], v[172:175], v[200:203], v[28:31]
    ds_read_b128 v[152:155], v16 offset:0
    v_mfma_f32_16x16x32_bf16 v[32:35], v[172:175], v[204:207], v[32:35]
    ds_read_b128 v[156:159], v16 offset:2048
    v_mfma_f32_16x16x32_bf16 v[36:39], v[172:175], v[208:211], v[36:39]
    ds_read_b128 v[160:163], v16 offset:4096
    v_mfma_f32_16x16x32_bf16 v[52:55], v[176:179], v[208:211], v[52:55]
    ds_read_b128 v[164:167], v16 offset:6144
    v_mfma_f32_16x16x32_bf16 v[48:51], v[176:179], v[204:207], v[48:51]
    ds_read_b64_tr_b16 v[132:133], v11 offset:0
    ds_read_b64_tr_b16 v[134:135], v11 offset:512
    v_mfma_f32_16x16x32_bf16 v[44:47], v[176:179], v[200:203], v[44:47]
    ds_read_b64_tr_b16 v[136:137], v12 offset:0
    ds_read_b64_tr_b16 v[138:139], v12 offset:512
    v_mfma_f32_16x16x32_bf16 v[40:43], v[176:179], v[196:199], v[40:43]
    ds_read_b64_tr_b16 v[140:141], v13 offset:0
    ds_read_b64_tr_b16 v[142:143], v13 offset:512
    v_mfma_f32_16x16x32_bf16 v[56:59], v[180:183], v[196:199], v[56:59]
    ds_read_b64_tr_b16 v[144:145], v14 offset:0
    ds_read_b64_tr_b16 v[146:147], v14 offset:512
    v_mfma_f32_16x16x32_bf16 v[60:63], v[180:183], v[200:203], v[60:63]
    ds_read_b64_tr_b16 v[148:149], v15 offset:0
    ds_read_b64_tr_b16 v[150:151], v15 offset:512
    v_mfma_f32_16x16x32_bf16 v[64:67], v[180:183], v[204:207], v[64:67]
    ds_read_b128 v[168:171], v18 offset:0
    v_mfma_f32_16x16x32_bf16 v[68:71], v[180:183], v[208:211], v[68:71]
    v_mfma_f32_16x16x32_bf16 v[84:87], v[184:187], v[208:211], v[84:87]
    v_mfma_f32_16x16x32_bf16 v[80:83], v[184:187], v[204:207], v[80:83]
    v_mfma_f32_16x16x32_bf16 v[76:79], v[184:187], v[200:203], v[76:79]
    v_mfma_f32_16x16x32_bf16 v[72:75], v[184:187], v[196:199], v[72:75]
    v_mfma_f32_16x16x32_bf16 v[88:91], v[188:191], v[196:199], v[88:91]
    v_mfma_f32_16x16x32_bf16 v[92:95], v[188:191], v[200:203], v[92:95]
    v_mfma_f32_16x16x32_bf16 v[96:99], v[188:191], v[204:207], v[96:99]
    v_mfma_f32_16x16x32_bf16 v[100:103], v[188:191], v[208:211], v[100:103]
    v_mfma_f32_16x16x32_bf16 v[120:123], v[188:191], v[212:215], v[120:123]
    v_mfma_f32_16x16x32_bf16 v[124:127], v[192:195], v[212:215], v[124:127]
    v_mfma_f32_16x16x32_bf16 v[116:119], v[192:195], v[208:211], v[116:119]
    v_mfma_f32_16x16x32_bf16 v[112:115], v[192:195], v[204:207], v[112:115]
    v_mfma_f32_16x16x32_bf16 v[108:111], v[192:195], v[200:203], v[108:111]
    v_mfma_f32_16x16x32_bf16 v[104:107], v[192:195], v[196:199], v[104:107]
    s_waitcnt lgkmcnt(0)
    v_mfma_f32_16x16x32_bf16 v[24:27], v[128:131], v[152:155], v[24:27]
    ds_read_b64_tr_b16 v[172:173], v10 offset:4096
    ds_read_b64_tr_b16 v[174:175], v10 offset:4608
    v_mfma_f32_16x16x32_bf16 v[28:31], v[128:131], v[156:159], v[28:31]
    ds_read_b128 v[196:199], v17 offset:0
    v_mfma_f32_16x16x32_bf16 v[32:35], v[128:131], v[160:163], v[32:35]
    ds_read_b128 v[200:203], v17 offset:2048
    v_mfma_f32_16x16x32_bf16 v[36:39], v[128:131], v[164:167], v[36:39]
    ds_read_b128 v[204:207], v17 offset:4096
    v_mfma_f32_16x16x32_bf16 v[52:55], v[132:135], v[164:167], v[52:55]
    ds_read_b128 v[208:211], v17 offset:6144
    v_mfma_f32_16x16x32_bf16 v[48:51], v[132:135], v[160:163], v[48:51]
    ds_read_b64_tr_b16 v[176:177], v11 offset:4096
    ds_read_b64_tr_b16 v[178:179], v11 offset:4608
    v_mfma_f32_16x16x32_bf16 v[44:47], v[132:135], v[156:159], v[44:47]
    ds_read_b64_tr_b16 v[180:181], v12 offset:4096
    ds_read_b64_tr_b16 v[182:183], v12 offset:4608
    v_mfma_f32_16x16x32_bf16 v[40:43], v[132:135], v[152:155], v[40:43]
    ds_read_b64_tr_b16 v[184:185], v13 offset:4096
    ds_read_b64_tr_b16 v[186:187], v13 offset:4608
    v_mfma_f32_16x16x32_bf16 v[56:59], v[136:139], v[152:155], v[56:59]
    ds_read_b64_tr_b16 v[188:189], v14 offset:4096
    ds_read_b64_tr_b16 v[190:191], v14 offset:4608
    v_mfma_f32_16x16x32_bf16 v[60:63], v[136:139], v[156:159], v[60:63]
    ds_read_b64_tr_b16 v[192:193], v15 offset:4096
    ds_read_b64_tr_b16 v[194:195], v15 offset:4608
    v_mfma_f32_16x16x32_bf16 v[64:67], v[136:139], v[160:163], v[64:67]
    ds_read_b128 v[212:215], v19 offset:0
    v_mfma_f32_16x16x32_bf16 v[68:71], v[136:139], v[164:167], v[68:71]
    s_add_u32 s50, s50, 1
    s_cmp_eq_u32 s50, 3
    v_mfma_f32_16x16x32_bf16 v[84:87], v[140:143], v[164:167], v[84:87]
    s_cselect_b32 s49, s29, s51
    s_cselect_b32 s50, 0, s50
    v_mfma_f32_16x16x32_bf16 v[80:83], v[140:143], v[160:163], v[80:83]
    v_add_u32 v10, s49, v10
    v_add_u32 v11, s49, v11
    v_mfma_f32_16x16x32_bf16 v[76:79], v[140:143], v[156:159], v[76:79]
    v_add_u32 v12, s49, v12
    v_add_u32 v13, s49, v13
    v_mfma_f32_16x16x32_bf16 v[72:75], v[140:143], v[152:155], v[72:75]
    v_add_u32 v14, s49, v14
    v_add_u32 v15, s49, v15
    v_mfma_f32_16x16x32_bf16 v[88:91], v[144:147], v[152:155], v[88:91]
    v_add_u32 v16, s49, v16
    v_add_u32 v17, s49, v17
    v_mfma_f32_16x16x32_bf16 v[92:95], v[144:147], v[156:159], v[92:95]
    v_add_u32 v18, s49, v18
    v_add_u32 v19, s49, v19
    v_mfma_f32_16x16x32_bf16 v[96:99], v[144:147], v[160:163], v[96:99]
    s_sub_u32 s48, s48, 1
    s_cmp_lg_u32 s48, 0
    v_mfma_f32_16x16x32_bf16 v[100:103], v[144:147], v[164:167], v[100:103]
    v_mfma_f32_16x16x32_bf16 v[120:123], v[144:147], v[168:171], v[120:123]
    v_mfma_f32_16x16x32_bf16 v[124:127], v[148:151], v[168:171], v[124:127]
    v_mfma_f32_16x16x32_bf16 v[116:119], v[148:151], v[164:167], v[116:119]
    v_mfma_f32_16x16x32_bf16 v[112:115], v[148:151], v[160:163], v[112:115]
    v_mfma_f32_16x16x32_bf16 v[108:111], v[148:151], v[156:159], v[108:111]
    v_mfma_f32_16x16x32_bf16 v[104:107], v[148:151], v[152:155], v[104:107]
    s_waitcnt lgkmcnt(0)
    s_cbranch_scc1 g1_cloop
    ds_read_b64 v[128:129], v216 offset:0
    ds_read_b64 v[130:131], v216 offset:128
    ds_read_b64 v[132:133], v216 offset:256
    ds_read_b64 v[134:135], v216 offset:384
    ds_read_b64 v[136:137], v217
    ds_read_b128 v[140:143], v218 offset:0
    ds_read_b128 v[144:147], v218 offset:64
    ds_read_b128 v[148:151], v219 offset:0
    ds_read_b128 v[152:155], v219 offset:64
    ds_read_b128 v[156:159], v220 offset:0
    ds_read_b128 v[160:163], v220 offset:64
    v_mfma_f32_16x16x32_bf16 v[24:27], v[172:175], v[196:199], v[24:27]
    v_mfma_f32_16x16x32_bf16 v[40:43], v[176:179], v[196:199], v[40:43]
    v_mfma_f32_16x16x32_bf16 v[28:31], v[172:175], v[200:203], v[28:31]
    v_mfma_f32_16x16x32_bf16 v[44:47], v[176:179], v[200:203], v[44:47]
    v_mfma_f32_16x16x32_bf16 v[32:35], v[172:175], v[204:207], v[32:35]
    v_mfma_f32_16x16x32_bf16 v[48:51], v[176:179], v[204:207], v[48:51]
    s_waitcnt lgkmcnt(0)
    v_mfma_f32_16x16x32_bf16 v[36:39], v[172:175], v[208:211], v[36:39]
    v_pk_mul_f32 v[164:165], v[140:141], v[128:129] op_sel:[0,1] op_sel_hi:[1,1]
    v_pk_mul_f32 v[166:167], v[142:143], v[128:129] op_sel:[0,1] op_sel_hi:[1,1]
    v_pk_mul_f32 v[168:169], v[144:145], v[128:129] op_sel:[0,1] op_sel_hi:[1,1]
    v_pk_mul_f32 v[170:171], v[146:147], v[128:129] op_sel:[0,1] op_sel_hi:[1,1]
    v_pk_fma_f32 v[24:25], v[24:25], v[128:129], v[164:165] op_sel:[0,0,0] op_sel_hi:[1,0,1]
    v_pk_fma_f32 v[26:27], v[26:27], v[128:129], v[166:167] op_sel:[0,0,0] op_sel_hi:[1,0,1]
    v_pk_fma_f32 v[40:41], v[40:41], v[128:129], v[168:169] op_sel:[0,0,0] op_sel_hi:[1,0,1]
    v_pk_fma_f32 v[42:43], v[42:43], v[128:129], v[170:171] op_sel:[0,0,0] op_sel_hi:[1,0,1]
    v_mfma_f32_16x16x32_bf16 v[52:55], v[176:179], v[208:211], v[52:55]
    v_cvt_pk_bf16_f32 v232, v24, v25
    v_cvt_pk_bf16_f32 v233, v26, v27
    v_cvt_pk_bf16_f32 v234, v40, v41
    v_cvt_pk_bf16_f32 v235, v42, v43
    s_nop 1
    v_permlane16_swap_b32 v232, v234
    v_permlane16_swap_b32 v233, v235
    ds_write_b128 v221, v[232:235] offset:0
    v_mfma_f32_16x16x32_bf16 v[56:59], v[180:183], v[196:199], v[56:59]
    v_pk_mul_f32 v[164:165], v[140:141], v[130:131] op_sel:[0,1] op_sel_hi:[1,1]
    v_pk_mul_f32 v[166:167], v[142:143], v[130:131] op_sel:[0,1] op_sel_hi:[1,1]
    v_pk_mul_f32 v[168:169], v[144:145], v[130:131] op_sel:[0,1] op_sel_hi:[1,1]
    v_pk_mul_f32 v[170:171], v[146:147], v[130:131] op_sel:[0,1] op_sel_hi:[1,1]
    v_pk_fma_f32 v[28:29], v[28:29], v[130:131], v[164:165] op_sel:[0,0,0] op_sel_hi:[1,0,1]
    v_pk_fma_f32 v[30:31], v[30:31], v[130:131], v[166:167] op_sel:[0,0,0] op_sel_hi:[1,0,1]
    v_pk_fma_f32 v[44:45], v[44:45], v[130:131], v[168:169] op_sel:[0,0,0] op_sel_hi:[1,0,1]
    v_pk_fma_f32 v[46:47], v[46:47], v[130:131], v[170:171] op_sel:[0,0,0] op_sel_hi:[1,0,1]
    v_mfma_f32_16x16x32_bf16 v[72:75], v[184:187], v[196:199], v[72:75]
    v_cvt_pk_bf16_f32 v236, v28, v29
    v_cvt_pk_bf16_f32 v237, v30, v31
    v_cvt_pk_bf16_f32 v238, v44, v45
    v_cvt_pk_bf16_f32 v239, v46, v47
    s_nop 1
    v_permlane16_swap_b32 v236, v238
    v_permlane16_swap_b32 v237, v239
    ds_write_b128 v221, v[236:239] offset:2048
    v_mfma_f32_16x16x32_bf16 v[60:63], v[180:183], v[200:203], v[60:63]
    v_pk_mul_f32 v[164:165], v[140:141], v[132:133] op_sel:[0,1] op_sel_hi:[1,1]
    v_pk_mul_f32 v[166:167], v[142:143], v[132:133] op_sel:[0,1] op_sel_hi:[1,1]
    v_pk_mul_f32 v[168:169], v[144:145], v[132:133] op_sel:[0,1] op_sel_hi:[1,1]
    v_pk_mul_f32 v[170:171], v[146:147], v[132:133] op_sel:[0,1] op_sel_hi:[1,1]
    v_pk_fma_f32 v[32:33], v[32:33], v[132:133], v[164:165] op_sel:[0,0,0] op_sel_hi:[1,0,1]
    v_pk_fma_f32 v[34:35], v[34:35], v[132:133], v[166:167] op_sel:[0,0,0] op_sel_hi:[1,0,1]
    v_pk_fma_f32 v[48:49], v[48:49], v[132:133], v[168:169] op_sel:[0,0,0] op_sel_hi:[1,0,1]
    v_pk_fma_f32 v[50:51], v[50:51], v[132:133], v[170:171] op_sel:[0,0,0] op_sel_hi:[1,0,1]
    v_mfma_f32_16x16x32_bf16 v[76:79], v[184:187], v[200:203], v[76:79]
    v_cvt_pk_bf16_f32 v240, v32, v33
    v_cvt_pk_bf16_f32 v241, v34, v35
    v_cvt_pk_bf16_f32 v242, v48, v49
    v_cvt_pk_bf16_f32 v243, v50, v51
    s_nop 1
    v_permlane16_swap_b32 v240, v242
    v_permlane16_swap_b32 v241, v243
    ds_write_b128 v221, v[240:243] offset:4096
    v_mfma_f32_16x16x32_bf16 v[64:67], v[180:183], v[204:207], v[64:67]
    v_pk_mul_f32 v[164:165], v[140:141], v[134:135] op_sel:[0,1] op_sel_hi:[1,1]
    v_pk_mul_f32 v[166:167], v[142:143], v[134:135] op_sel:[0,1] op_sel_hi:[1,1]
    v_pk_mul_f32 v[168:169], v[144:145], v[134:135] op_sel:[0,1] op_sel_hi:[1,1]
    v_pk_mul_f32 v[170:171], v[146:147], v[134:135] op_sel:[0,1] op_sel_hi:[1,1]
    v_pk_fma_f32 v[36:37], v[36:37], v[134:135], v[164:165] op_sel:[0,0,0] op_sel_hi:[1,0,1]
    v_pk_fma_f32 v[38:39], v[38:39], v[134:135], v[166:167] op_sel:[0,0,0] op_sel_hi:[1,0,1]
    v_pk_fma_f32 v[52:53], v[52:53], v[134:135], v[168:169] op_sel:[0,0,0] op_sel_hi:[1,0,1]
    v_pk_fma_f32 v[54:55], v[54:55], v[134:135], v[170:171] op_sel:[0,0,0] op_sel_hi:[1,0,1]
    v_mfma_f32_16x16x32_bf16 v[80:83], v[184:187], v[204:207], v[80:83]
    v_cvt_pk_bf16_f32 v244, v36, v37
    v_cvt_pk_bf16_f32 v245, v38, v39
    v_cvt_pk_bf16_f32 v246, v52, v53
    v_cvt_pk_bf16_f32 v247, v54, v55
    s_nop 1
    v_permlane16_swap_b32 v244, v246
    v_permlane16_swap_b32 v245, v247
    ds_write_b128 v221, v[244:247] offset:6144
    v_mfma_f32_16x16x32_bf16 v[68:71], v[180:183], v[208:211], v[68:71]
    v_pk_mul_f32 v[164:165], v[148:149], v[128:129] op_sel:[0,1] op_sel_hi:[1,1]
    v_pk_mul_f32 v[166:167], v[150:151], v[128:129] op_sel:[0,1] op_sel_hi:[1,1]
    v_pk_mul_f32 v[168:169], v[152:153], v[128:129] op_sel:[0,1] op_sel_hi:[1,1]
    v_pk_mul_f32 v[170:171], v[154:155], v[128:129] op_sel:[0,1] op_sel_hi:[1,1]
    v_pk_fma_f32 v[56:57], v[56:57], v[128:129], v[164:165] op_sel:[0,0,0] op_sel_hi:[1,0,1]
    v_pk_fma_f32 v[58:59], v[58:59], v[128:129], v[166:167] op_sel:[0,0,0] op_sel_hi:[1,0,1]
    v_pk_fma_f32 v[72:73], v[72:73], v[128:129], v[168:169] op_sel:[0,0,0] op_sel_hi:[1,0,1]
    v_pk_fma_f32 v[74:75], v[74:75], v[128:129], v[170:171] op_sel:[0,0,0] op_sel_hi:[1,0,1]
    v_mfma_f32_16x16x32_bf16 v[84:87], v[184:187], v[208:211], v[84:87]
    v_cvt_pk_bf16_f32 v232, v56, v57
    v_cvt_pk_bf16_f32 v233, v58, v59
    v_cvt_pk_bf16_f32 v234, v72, v73
    v_cvt_pk_bf16_f32 v235, v74, v75
    s_nop 1
    v_permlane16_swap_b32 v232, v234
    v_permlane16_swap_b32 v233, v235
    ds_write_b128 v222, v[232:235] offset:0
    v_mfma_f32_16x16x32_bf16 v[88:91], v[188:191], v[196:199], v[88:91]
    v_pk_mul_f32 v[164:165], v[148:149], v[130:131] op_sel:[0,1] op_sel_hi:[1,1]
    v_pk_mul_f32 v[166:167], v[150:151], v[130:131] op_sel:[0,1] op_sel_hi:[1,1]
    v_pk_mul_f32 v[168:169], v[152:153], v[130:131] op_sel:[0,1] op_sel_hi:[1,1]
    v_pk_mul_f32 v[170:171], v[154:155], v[130:131] op_sel:[0,1] op_sel_hi:[1,1]
    v_pk_fma_f32 v[60:61], v[60:61], v[130:131], v[164:165] op_sel:[0,0,0] op_sel_hi:[1,0,1]
    v_pk_fma_f32 v[62:63], v[62:63], v[130:131], v[166:167] op_sel:[0,0,0] op_sel_hi:[1,0,1]
    v_pk_fma_f32 v[76:77], v[76:77], v[130:131], v[168:169] op_sel:[0,0,0] op_sel_hi:[1,0,1]
    v_pk_fma_f32 v[78:79], v[78:79], v[130:131], v[170:171] op_sel:[0,0,0] op_sel_hi:[1,0,1]
    v_mfma_f32_16x16x32_bf16 v[104:107], v[192:195], v[196:199], v[104:107]
    v_cvt_pk_bf16_f32 v236, v60, v61
    v_cvt_pk_bf16_f32 v237, v62, v63
    v_cvt_pk_bf16_f32 v238, v76, v77
    v_cvt_pk_bf16_f32 v239, v78, v79
    s_nop 1
    v_permlane16_swap_b32 v236, v238
    v_permlane16_swap_b32 v237, v239
    ds_write_b128 v222, v[236:239] offset:2048
    v_mfma_f32_16x16x32_bf16 v[92:95], v[188:191], v[200:203], v[92:95]
    v_pk_mul_f32 v[164:165], v[148:149], v[132:133] op_sel:[0,1] op_sel_hi:[1,1]
    v_pk_mul_f32 v[166:167], v[150:151], v[132:133] op_sel:[0,1] op_sel_hi:[1,1]
    v_pk_mul_f32 v[168:169], v[152:153], v[132:133] op_sel:[0,1] op_sel_hi:[1,1]
    v_pk_mul_f32 v[170:171], v[154:155], v[132:133] op_sel:[0,1] op_sel_hi:[1,1]
    v_pk_fma_f32 v[64:65], v[64:65], v[132:133], v[164:165] op_sel:[0,0,0] op_sel_hi:[1,0,1]
    v_pk_fma_f32 v[66:67], v[66:67], v[132:133], v[166:167] op_sel:[0,0,0] op_sel_hi:[1,0,1]
    v_pk_fma_f32 v[80:81], v[80:81], v[132:133], v[168:169] op_sel:[0,0,0] op_sel_hi:[1,0,1]
    v_pk_fma_f32 v[82:83], v[82:83], v[132:133], v[170:171] op_sel:[0,0,0] op_sel_hi:[1,0,1]
    v_mfma_f32_16x16x32_bf16 v[108:111], v[192:195], v[200:203], v[108:111]
    v_cvt_pk_bf16_f32 v240, v64, v65
    v_cvt_pk_bf16_f32 v241, v66, v67
    v_cvt_pk_bf16_f32 v242, v80, v81
    v_cvt_pk_bf16_f32 v243, v82, v83
    s_nop 1
    v_permlane16_swap_b32 v240, v242
    v_permlane16_swap_b32 v241, v243
    ds_write_b128 v222, v[240:243] offset:4096
    v_mfma_f32_16x16x32_bf16 v[96:99], v[188:191], v[204:207], v[96:99]
    v_pk_mul_f32 v[164:165], v[148:149], v[134:135] op_sel:[0,1] op_sel_hi:[1,1]
    v_pk_mul_f32 v[166:167], v[150:151], v[134:135] op_sel:[0,1] op_sel_hi:[1,1]
    v_pk_mul_f32 v[168:169], v[152:153], v[134:135] op_sel:[0,1] op_sel_hi:[1,1]
    v_pk_mul_f32 v[170:171], v[154:155], v[134:135] op_sel:[0,1] op_sel_hi:[1,1]
    v_pk_fma_f32 v[68:69], v[68:69], v[134:135], v[164:165] op_sel:[0,0,0] op_sel_hi:[1,0,1]
    v_pk_fma_f32 v[70:71], v[70:71], v[134:135], v[166:167] op_sel:[0,0,0] op_sel_hi:[1,0,1]
    v_pk_fma_f32 v[84:85], v[84:85], v[134:135], v[168:169] op_sel:[0,0,0] op_sel_hi:[1,0,1]
    v_pk_fma_f32 v[86:87], v[86:87], v[134:135], v[170:171] op_sel:[0,0,0] op_sel_hi:[1,0,1]
    v_mfma_f32_16x16x32_bf16 v[112:115], v[192:195], v[204:207], v[112:115]
    v_cvt_pk_bf16_f32 v244, v68, v69
    v_cvt_pk_bf16_f32 v245, v70, v71
    v_cvt_pk_bf16_f32 v246, v84, v85
    v_cvt_pk_bf16_f32 v247, v86, v87
    s_nop 1
    v_permlane16_swap_b32 v244, v246
    v_permlane16_swap_b32 v245, v247
    ds_write_b128 v222, v[244:247] offset:6144
    v_mfma_f32_16x16x32_bf16 v[100:103], v[188:191], v[208:211], v[100:103]
    v_pk_mul_f32 v[164:165], v[156:157], v[128:129] op_sel:[0,1] op_sel_hi:[1,1]
    v_pk_mul_f32 v[166:167], v[158:159], v[128:129] op_sel:[0,1] op_sel_hi:[1,1]
    v_pk_mul_f32 v[168:169], v[160:161], v[128:129] op_sel:[0,1] op_sel_hi:[1,1]
    v_pk_mul_f32 v[170:171], v[162:163], v[128:129] op_sel:[0,1] op_sel_hi:[1,1]
    v_pk_fma_f32 v[88:89], v[88:89], v[128:129], v[164:165] op_sel:[0,0,0] op_sel_hi:[1,0,1]
    v_pk_fma_f32 v[90:91], v[90:91], v[128:129], v[166:167] op_sel:[0,0,0] op_sel_hi:[1,0,1]
    v_pk_fma_f32 v[104:105], v[104:105], v[128:129], v[168:169] op_sel:[0,0,0] op_sel_hi:[1,0,1]
    v_pk_fma_f32 v[106:107], v[106:107], v[128:129], v[170:171] op_sel:[0,0,0] op_sel_hi:[1,0,1]
    v_mfma_f32_16x16x32_bf16 v[116:119], v[192:195], v[208:211], v[116:119]
    v_cvt_pk_bf16_f32 v232, v88, v89
    v_cvt_pk_bf16_f32 v233, v90, v91
    v_cvt_pk_bf16_f32 v234, v104, v105
    v_cvt_pk_bf16_f32 v235, v106, v107
    s_nop 1
    v_permlane16_swap_b32 v232, v234
    v_permlane16_swap_b32 v233, v235
    ds_write_b128 v223, v[232:235] offset:0
    v_mfma_f32_16x16x32_bf16 v[120:123], v[188:191], v[212:215], v[120:123]
    v_pk_mul_f32 v[164:165], v[156:157], v[130:131] op_sel:[0,1] op_sel_hi:[1,1]
    v_pk_mul_f32 v[166:167], v[158:159], v[130:131] op_sel:[0,1] op_sel_hi:[1,1]
    v_pk_mul_f32 v[168:169], v[160:161], v[130:131] op_sel:[0,1] op_sel_hi:[1,1]
    v_pk_mul_f32 v[170:171], v[162:163], v[130:131] op_sel:[0,1] op_sel_hi:[1,1]
    v_pk_fma_f32 v[92:93], v[92:93], v[130:131], v[164:165] op_sel:[0,0,0] op_sel_hi:[1,0,1]
    v_pk_fma_f32 v[94:95], v[94:95], v[130:131], v[166:167] op_sel:[0,0,0] op_sel_hi:[1,0,1]
    v_pk_fma_f32 v[108:109], v[108:109], v[130:131], v[168:169] op_sel:[0,0,0] op_sel_hi:[1,0,1]
    v_pk_fma_f32 v[110:111], v[110:111], v[130:131], v[170:171] op_sel:[0,0,0] op_sel_hi:[1,0,1]
    v_mfma_f32_16x16x32_bf16 v[124:127], v[192:195], v[212:215], v[124:127]
    v_cvt_pk_bf16_f32 v236, v92, v93
    v_cvt_pk_bf16_f32 v237, v94, v95
    v_cvt_pk_bf16_f32 v238, v108, v109
    v_cvt_pk_bf16_f32 v239, v110, v111
    s_nop 1
    v_permlane16_swap_b32 v236, v238
    v_permlane16_swap_b32 v237, v239
    ds_write_b128 v223, v[236:239] offset:2048
    v_pk_mul_f32 v[164:165], v[156:157], v[132:133] op_sel:[0,1] op_sel_hi:[1,1]
    v_pk_mul_f32 v[166:167], v[158:159], v[132:133] op_sel:[0,1] op_sel_hi:[1,1]
    v_pk_mul_f32 v[168:169], v[160:161], v[132:133] op_sel:[0,1] op_sel_hi:[1,1]
    v_pk_mul_f32 v[170:171], v[162:163], v[132:133] op_sel:[0,1] op_sel_hi:[1,1]
    v_pk_fma_f32 v[96:97], v[96:97], v[132:133], v[164:165] op_sel:[0,0,0] op_sel_hi:[1,0,1]
    v_pk_fma_f32 v[98:99], v[98:99], v[132:133], v[166:167] op_sel:[0,0,0] op_sel_hi:[1,0,1]
    v_pk_fma_f32 v[112:113], v[112:113], v[132:133], v[168:169] op_sel:[0,0,0] op_sel_hi:[1,0,1]
    v_pk_fma_f32 v[114:115], v[114:115], v[132:133], v[170:171] op_sel:[0,0,0] op_sel_hi:[1,0,1]
    v_cvt_pk_bf16_f32 v240, v96, v97
    v_cvt_pk_bf16_f32 v241, v98, v99
    v_cvt_pk_bf16_f32 v242, v112, v113
    v_cvt_pk_bf16_f32 v243, v114, v115
    s_nop 1
    v_permlane16_swap_b32 v240, v242
    v_permlane16_swap_b32 v241, v243
    ds_write_b128 v223, v[240:243] offset:4096
    v_pk_mul_f32 v[164:165], v[156:157], v[134:135] op_sel:[0,1] op_sel_hi:[1,1]
    v_pk_mul_f32 v[166:167], v[158:159], v[134:135] op_sel:[0,1] op_sel_hi:[1,1]
    v_pk_mul_f32 v[168:169], v[160:161], v[134:135] op_sel:[0,1] op_sel_hi:[1,1]
    v_pk_mul_f32 v[170:171], v[162:163], v[134:135] op_sel:[0,1] op_sel_hi:[1,1]
    v_pk_fma_f32 v[100:101], v[100:101], v[134:135], v[164:165] op_sel:[0,0,0] op_sel_hi:[1,0,1]
    v_pk_fma_f32 v[102:103], v[102:103], v[134:135], v[166:167] op_sel:[0,0,0] op_sel_hi:[1,0,1]
    v_pk_fma_f32 v[116:117], v[116:117], v[134:135], v[168:169] op_sel:[0,0,0] op_sel_hi:[1,0,1]
    v_pk_fma_f32 v[118:119], v[118:119], v[134:135], v[170:171] op_sel:[0,0,0] op_sel_hi:[1,0,1]
    v_cvt_pk_bf16_f32 v244, v100, v101
    v_cvt_pk_bf16_f32 v245, v102, v103
    v_cvt_pk_bf16_f32 v246, v116, v117
    v_cvt_pk_bf16_f32 v247, v118, v119
    s_nop 1
    v_permlane16_swap_b32 v244, v246
    v_permlane16_swap_b32 v245, v247
    ds_write_b128 v223, v[244:247] offset:6144
    v_pk_mul_f32 v[164:165], v[156:157], v[136:137] op_sel:[0,1] op_sel_hi:[1,1]
    v_pk_mul_f32 v[166:167], v[158:159], v[136:137] op_sel:[0,1] op_sel_hi:[1,1]
    v_pk_mul_f32 v[168:169], v[160:161], v[136:137] op_sel:[0,1] op_sel_hi:[1,1]
    v_pk_mul_f32 v[170:171], v[162:163], v[136:137] op_sel:[0,1] op_sel_hi:[1,1]
    v_pk_fma_f32 v[120:121], v[120:121], v[136:137], v[164:165] op_sel:[0,0,0] op_sel_hi:[1,0,1]
    v_pk_fma_f32 v[122:123], v[122:123], v[136:137], v[166:167] op_sel:[0,0,0] op_sel_hi:[1,0,1]
    v_pk_fma_f32 v[124:125], v[124:125], v[136:137], v[168:169] op_sel:[0,0,0] op_sel_hi:[1,0,1]
    v_pk_fma_f32 v[126:127], v[126:127], v[136:137], v[170:171] op_sel:[0,0,0] op_sel_hi:[1,0,1]
    v_cvt_pk_bf16_f32 v232, v120, v121
    v_cvt_pk_bf16_f32 v233, v122, v123
    v_cvt_pk_bf16_f32 v234, v124, v125
    v_cvt_pk_bf16_f32 v235, v126, v127
    s_nop 1
    v_permlane16_swap_b32 v232, v234
    v_permlane16_swap_b32 v233, v235
    ds_write_b128 v224, v[232:235]
    s_waitcnt lgkmcnt(0)
g1_attn:
    s_barrier
    ds_read_b128 v[24:27], v226 offset:2048
    ds_read_b128 v[28:31], v226 offset:18432
    ds_read_b128 v[32:35], v226 offset:20480
    ds_read_b128 v[72:75], v226 offset:2176
    ds_read_b128 v[76:79], v226 offset:18560
    ds_read_b128 v[80:83], v226 offset:20608
    ds_read_b64_tr_b16 v[36:37], v227 offset:0
    ds_read_b64_tr_b16 v[38:39], v227 offset:2048
    ds_read_b64_tr_b16 v[40:41], v227 offset:8
    ds_read_b64_tr_b16 v[42:43], v227 offset:2056
    ds_read_b64_tr_b16 v[84:85], v227 offset:128
    ds_read_b64_tr_b16 v[86:87], v227 offset:2176
    ds_read_b64_tr_b16 v[88:89], v227 offset:136
    ds_read_b64_tr_b16 v[90:91], v227 offset:2184
    s_waitcnt lgkmcnt(8)
    v_mfma_f32_16x16x32_bf16 v[44:47], v[28:31], v[24:27], 0
    v_mfma_f32_16x16x32_bf16 v[48:51], v[32:35], v[24:27], 0
    v_mfma_f32_16x16x32_bf16 v[92:95], v[76:79], v[72:75], 0
    v_mfma_f32_16x16x32_bf16 v[96:99], v[80:83], v[72:75], 0
    s_nop 7
    v_cndmask_b32 v44, v48, v44, s[56:57]
    v_cndmask_b32 v45, v49, v45, s[56:57]
    v_cndmask_b32 v46, v50, v46, s[56:57]
    v_cndmask_b32 v47, v51, v47, s[56:57]
    v_cndmask_b32 v92, v96, v92, s[56:57]
    v_cndmask_b32 v93, v97, v93, s[56:57]
    v_cndmask_b32 v94, v98, v94, s[56:57]
    v_cndmask_b32 v95, v99, v95, s[56:57]
    v_cvt_pk_bf16_f32 v48, v44, v45
    v_cvt_pk_bf16_f32 v49, v46, v47
    v_cvt_pk_bf16_f32 v96, v92, v93
    v_cvt_pk_bf16_f32 v97, v94, v95
    v_lshlrev_b32 v44, 16, v48
    v_and_b32 v45, 0xffff0000, v48
    v_lshlrev_b32 v46, 16, v49
    v_and_b32 v47, 0xffff0000, v49
    v_lshlrev_b32 v92, 16, v96
    v_and_b32 v93, 0xffff0000, v96
    v_lshlrev_b32 v94, 16, v97
    v_and_b32 v95, 0xffff0000, v97
    v_mul_f32 v44, s58, v44
    v_mul_f32 v45, s58, v45
    v_mul_f32 v46, s58, v46
    v_mul_f32 v47, s58, v47
    v_mul_f32 v92, s58, v92
    v_mul_f32 v93, s58, v93
    v_mul_f32 v94, s58, v94
    v_mul_f32 v95, s58, v95
    v_cvt_pk_bf16_f32 v48, v44, v45
    v_cvt_pk_bf16_f32 v49, v46, v47
    v_cvt_pk_bf16_f32 v96, v92, v93
    v_cvt_pk_bf16_f32 v97, v94, v95
    v_lshlrev_b32 v44, 16, v48
    v_and_b32 v45, 0xffff0000, v48
    v_lshlrev_b32 v46, 16, v49
    v_and_b32 v47, 0xffff0000, v49
    v_lshlrev_b32 v92, 16, v96
    v_and_b32 v93, 0xffff0000, v96
    v_lshlrev_b32 v94, 16, v97
    v_and_b32 v95, 0xffff0000, v97
    v_fma_f32 v44, v44, s59, v228
    v_fma_f32 v45, v45, s59, v229
    v_fma_f32 v46, v46, s59, v230
    v_fma_f32 v47, v47, s59, v231
    v_fma_f32 v92, v92, s59, v228
    v_fma_f32 v93, v93, s59, v229
    v_fma_f32 v94, v94, s59, v230
    v_fma_f32 v95, v95, s59, v231
    v_max3_f32 v48, v44, v45, v46
    v_max3_f32 v96, v92, v93, v94
    v_max_f32 v48, v48, v47
    v_max_f32 v96, v96, v95
    v_mov_b32 v49, v48
    v_mov_b32 v97, v96
    s_nop 1
    v_permlane16_swap_b32 v48, v49
    v_permlane16_swap_b32 v96, v97
    s_nop 0
    v_max_f32 v48, v48, v49
    v_max_f32 v96, v96, v97
    v_mov_b32 v49, v48
    v_mov_b32 v97, v96
    s_nop 1
    v_permlane32_swap_b32 v48, v49
    v_permlane32_swap_b32 v96, v97
    s_nop 0
    v_max_f32 v48, v48, v49
    v_max_f32 v96, v96, v97
    v_sub_f32 v44, v44, v48
    v_sub_f32 v45, v45, v48
    v_sub_f32 v46, v46, v48
    v_sub_f32 v47, v47, v48
    v_sub_f32 v92, v92, v96
    v_sub_f32 v93, v93, v96
    v_sub_f32 v94, v94, v96
    v_sub_f32 v95, v95, v96
    v_exp_f32 v44, v44
    v_exp_f32 v45, v45
    v_exp_f32 v46, v46
    v_exp_f32 v47, v47
    v_exp_f32 v92, v92
    v_exp_f32 v93, v93
    v_exp_f32 v94, v94
    v_exp_f32 v95, v95
    v_add_f32 v48, v44, v45
    v_add_f32 v49, v46, v47
    v_add_f32 v96, v92, v93
    v_add_f32 v97, v94, v95
    v_add_f32 v48, v48, v49
    v_add_f32 v96, v96, v97
    v_mov_b32 v49, v48
    v_mov_b32 v97, v96
    s_nop 1
    v_permlane16_swap_b32 v48, v49
    v_permlane16_swap_b32 v96, v97
    s_nop 0
    v_add_f32 v48, v48, v49
    v_add_f32 v96, v96, v97
    v_mov_b32 v49, v48
    v_mov_b32 v97, v96
    s_nop 1
    v_permlane32_swap_b32 v48, v49
    v_permlane32_swap_b32 v96, v97
    s_nop 0
    v_add_f32 v48, v48, v49
    v_add_f32 v96, v96, v97
    v_rcp_f32 v48, v48
    v_rcp_f32 v96, v96
    s_nop 0
    v_mul_f32 v44, v44, v48
    v_mul_f32 v45, v45, v48
    v_mul_f32 v46, v46, v48
    v_mul_f32 v47, v47, v48
    v_mul_f32 v92, v92, v96
    v_mul_f32 v93, v93, v96
    v_mul_f32 v94, v94, v96
    v_mul_f32 v95, v95, v96
    v_cvt_pk_bf16_f32 v48, v44, v45
    v_cvt_pk_bf16_f32 v49, v46, v47
    v_cvt_pk_bf16_f32 v96, v92, v93
    v_cvt_pk_bf16_f32 v97, v94, v95
    v_cndmask_b32 v52, 0, v48, s[56:57]
    v_cndmask_b32 v53, 0, v49, s[56:57]
    v_cndmask_b32 v54, v48, 0, s[56:57]
    v_cndmask_b32 v55, v49, 0, s[56:57]
    v_cndmask_b32 v100, 0, v96, s[56:57]
    v_cndmask_b32 v101, 0, v97, s[56:57]
    v_cndmask_b32 v102, v96, 0, s[56:57]
    v_cndmask_b32 v103, v97, 0, s[56:57]
    s_waitcnt lgkmcnt(0)
    s_nop 0
    v_mfma_f32_16x16x32_bf16 v[56:59], v[36:39], v[52:55], 0
    v_mfma_f32_16x16x32_bf16 v[60:63], v[40:43], v[52:55], 0
    v_mfma_f32_16x16x32_bf16 v[104:107], v[84:87], v[100:103], 0
    v_mfma_f32_16x16x32_bf16 v[108:111], v[88:91], v[100:103], 0
    s_nop 7
    v_cvt_pk_bf16_f32 v64, v56, v57
    v_cvt_pk_bf16_f32 v65, v58, v59
    v_cvt_pk_bf16_f32 v66, v60, v61
    v_cvt_pk_bf16_f32 v67, v62, v63
    buffer_store_dwordx4 v[64:67], v225, s[16:19], 0 offen offset:0 sc1
    v_cvt_pk_bf16_f32 v112, v104, v105
    v_cvt_pk_bf16_f32 v113, v106, v107
    v_cvt_pk_bf16_f32 v114, v108, v109
    v_cvt_pk_bf16_f32 v115, v110, v111
    buffer_store_dwordx4 v[112:115], v225, s[16:19], 0 offen offset:2048 sc1
    s_add_u32 s40, s25, 0
    s_lshl_b32 s40, s40, 8
    s_add_u32 s84, s4, 0x300000
    s_addc_u32 s85, s5, 0
    s_mov_b32 s86, 0x4000
    s_mov_b32 s87, 0x20000
    v_mov_b32 v3, s40
    v_mov_b32 v4, 1
    s_waitcnt vmcnt(0)
    s_barrier
    s_cmp_lg_u32 s28, 0
    s_cbranch_scc1 g1_cin
    s_mov_b64 exec, 1
    buffer_atomic_add v4, v3, s[84:87], 0 offen sc1
    s_mov_b64 exec, -1
g1_cin:
    s_branch g2_in
g1_done:
    s_endpgm
.p2align 6
g2_in:
    s_cmp_ge_u32 s2, 256
    s_cbranch_scc1 g2_done
    s_load_dwordx2 s[4:5], s[0:1], 80
    s_load_dwordx2 s[6:7], s[0:1], 0
    s_load_dwordx2 s[30:31], s[0:1], 16
    v_lshrrev_b32 v1, 6, v0
    v_and_b32 v2, 63, v0
    s_and_b32 s40, s2, 3
    s_lshl_b32 s40, s40, 2
    s_bfe_u32 s41, s2, 0x20003
    s_add_u32 s25, s40, s41
    s_bfe_u32 s40, s2, 0x10002
    s_lshl_b32 s40, s40, 3
    s_lshr_b32 s42, s2, 5
    s_add_u32 s24, s40, s42
    s_add_u32 s27, s41, s42
    s_mov_b32 s26, 0
    v_readfirstlane_b32 s28, v1
    s_nop 0
    s_cmp_lt_u32 s28, 4
    s_cbranch_scc1 g2_compute
    s_sub_u32 s28, s28, 4
    s_mov_b32 s40, 2048
    v_lshrrev_b32 v3, 3, v2
    v_mul_lo_u32 v3, v3, s40
    v_bfe_u32 v4, v2, 4, 1
    v_lshlrev_b32 v4, 1, v4
    v_xor_b32 v4, v4, v2
    v_and_b32 v4, 7, v4
    v_lshl_add_u32 v3, v4, 4, v3
    s_mul_i32 s41, s24, 128
    s_mul_i32 s42, s28, 32768
    s_add_u32 s41, s41, s42
    v_xor_b32 v4, 64, v3
    s_add_u32 s42, s41, 0
    v_add_u32 v10, s42, v3
    s_add_u32 s42, s41, 16384
    v_add_u32 v11, s42, v4
    s_mov_b32 s40, 2048
    v_lshrrev_b32 v3, 3, v2
    v_mul_lo_u32 v3, v3, s40
    v_lshrrev_b32 v4, 4, v2
    v_xor_b32 v4, v4, v2
    v_and_b32 v4, 7, v4
    v_lshl_add_u32 v3, v4, 4, v3
    s_mul_i32 s41, s25, 262144
    s_mul_i32 s42, s28, 65536
    s_add_u32 s41, s41, s42
    v_xor_b32 v4, 64, v3
    s_add_u32 s42, s41, 0
    v_add_u32 v12, s42, v3
    s_add_u32 s42, s41, 16384
    v_add_u32 v13, s42, v4
    s_add_u32 s42, s41, 32768
    v_add_u32 v14, s42, v3
    s_add_u32 s42, s41, 49152
    v_add_u32 v15, s42, v4
    s_mul_i32 s36, s28, 2048
    s_mul_i32 s37, s28, 4096
    s_add_u32 s37, s37, 8192
    s_waitcnt lgkmcnt(0)
    s_add_u32 s4, s4, s97
    s_addc_u32 s5, s5, 0
    s_mov_b32 s8, s30
    s_mov_b32 s9, s31
    s_mov_b32 s10, 0x200000
    s_mov_b32 s11, 0x20000
    s_add_u32 s12, s4, 0x400000
    s_addc_u32 s13, s5, 0
    s_mov_b32 s14, 0x400000
    s_mov_b32 s15, 0x20000
    s_mov_b32 s32, 0
    s_mov_b32 s33, 0
g2_ld_pW:
    s_add_u32 s40, s32, s27
    s_and_b32 s40, s40, 1
    s_andn2_b32 s41, s32, 1
    s_or_b32 s40, s40, s41
    s_add_u32 s40, s40, s26
    s_mul_i32 s34, s40, 131072
    s_mul_i32 s35, s40, 128
    s_add_u32 s38, s33, s36
    s_add_u32 s39, s33, s37
    s_add_u32 m0, s38, 0
    s_nop 0
    buffer_load_dwordx4 v10, s[8:11], s34 offen lds
    s_add_u32 m0, s38, 1024
    s_nop 0
    buffer_load_dwordx4 v11, s[8:11], s34 offen lds
    s_add_u32 s33, s33, 24576
    s_add_u32 s32, s32, 1
    s_cmp_lt_u32 s32, 4
    s_cbranch_scc1 g2_ld_pW
    s_lshr_b32 s40, s25, 0
    s_add_u32 s40, s40, 0
    s_lshl_b32 s40, s40, 8
    s_mov_b32 s42, s40
    s_cmp_lg_u32 s28, 0
    s_cbranch_scc1 g2_dep_set
    s_add_u32 s84, s4, 0x300000
    s_addc_u32 s85, s5, 0
    s_mov_b32 s86, 0x4000
    s_mov_b32 s87, 0x20000
    v_cmp_eq_u32 vcc, 1, v2
    v_mov_b32 v21, s40
    v_mov_b32 v23, s42
    v_cndmask_b32 v21, v21, v23, vcc
    v_mov_b32 v22, 16
    v_mov_b32 v23, 16
    v_cndmask_b32 v22, v22, v23, vcc
    buffer_load_dword v23, v21, s[84:87], 0 offen sc1
g2_dep_set:
    s_lshl_b32 s43, s96, 2
    s_add_u32 s43, s43, 2
    s_mov_b32 s41, 0x800000
    v_mov_b32 v24, 131072
    s_cmp_lg_u32 s28, 0
    s_cbranch_scc1 g2_dep_lds
    s_mov_b32 s41, 0x40000
    s_waitcnt vmcnt(0)
g2_dep:
    v_cmp_lt_u32 vcc, v23, v22
    s_sub_u32 s41, s41, 1
    s_cmp_eq_u32 s41, 0
    s_cbranch_scc1 g2_dep_seen
    s_cbranch_vccz g2_dep_seen
    s_sleep 2
    buffer_load_dword v23, v21, s[84:87], 0 offen sc1
    s_waitcnt vmcnt(0)
    s_branch g2_dep
g2_dep_seen:
    v_mov_b32 v23, s43
    ds_write_b32 v24, v23
    s_branch g2_dep_ok
g2_dep_lds:
    ds_read_b32 v23, v24
    s_sub_u32 s41, s41, 1
    s_waitcnt lgkmcnt(0)
    v_readfirstlane_b32 s40, v23
    s_cmp_eq_u32 s41, 0
    s_cbranch_scc1 g2_dep_ok
    s_cmp_eq_u32 s40, s43
    s_cbranch_scc1 g2_dep_ok
    s_sleep 1
    s_branch g2_dep_lds
g2_dep_ok:
    s_mov_b32 s32, 0
    s_mov_b32 s33, 0
g2_ld_pA:
    s_add_u32 s40, s32, s27
    s_and_b32 s40, s40, 1
    s_andn2_b32 s41, s32, 1
    s_or_b32 s40, s40, s41
    s_add_u32 s40, s40, s26
    s_mul_i32 s34, s40, 131072
    s_mul_i32 s35, s40, 128
    s_add_u32 s38, s33, s36
    s_add_u32 s39, s33, s37
    s_add_u32 m0, s39, 0
    s_nop 0
    buffer_load_dwordx4 v12, s[12:15], s35 offen sc1 lds
    s_add_u32 m0, s39, 1024
    s_nop 0
    buffer_load_dwordx4 v13, s[12:15], s35 offen sc1 lds
    s_add_u32 m0, s39, 2048
    s_nop 0
    buffer_load_dwordx4 v14, s[12:15], s35 offen sc1 lds
    s_add_u32 m0, s39, 3072
    s_nop 0
    buffer_load_dwordx4 v15, s[12:15], s35 offen sc1 lds
    s_add_u32 s33, s33, 24576
    s_add_u32 s32, s32, 1
    s_cmp_lt_u32 s32, 3
    s_cbranch_scc1 g2_ld_pA
    s_waitcnt vmcnt(8)
    s_barrier
    s_add_u32 s40, s32, s27
    s_and_b32 s40, s40, 1
    s_andn2_b32 s41, s32, 1
    s_or_b32 s40, s40, s41
    s_add_u32 s40, s40, s26
    s_mul_i32 s34, s40, 131072
    s_mul_i32 s35, s40, 128
    s_add_u32 s38, s33, s36
    s_add_u32 s39, s33, s37
    s_add_u32 m0, s39, 0
    s_nop 0
    buffer_load_dwordx4 v12, s[12:15], s35 offen sc1 lds
    s_add_u32 m0, s39, 1024
    s_nop 0
    buffer_load_dwordx4 v13, s[12:15], s35 offen sc1 lds
    s_add_u32 m0, s39, 2048
    s_nop 0
    buffer_load_dwordx4 v14, s[12:15], s35 offen sc1 lds
    s_add_u32 m0, s39, 3072
    s_nop 0
    buffer_load_dwordx4 v15, s[12:15], s35 offen sc1 lds
    s_mov_b32 s33, 0
    s_add_u32 s32, s32, 1
g2_ld_loop:
    s_cmp_eq_u32 s32, 4
    s_cbranch_scc1 g2_ld_s4
    s_cmp_eq_u32 s32, 5
    s_cbranch_scc1 g2_ld_s5
    s_waitcnt vmcnt(12)
g2_ld_bar:
    s_barrier
    s_add_u32 s40, s32, s27
    s_and_b32 s40, s40, 1
    s_andn2_b32 s41, s32, 1
    s_or_b32 s40, s40, s41
    s_add_u32 s40, s40, s26
    s_mul_i32 s34, s40, 131072
    s_mul_i32 s35, s40, 128
    s_add_u32 s38, s33, s36
    s_add_u32 s39, s33, s37
    s_add_u32 m0, s38, 0
    s_nop 0
    buffer_load_dwordx4 v10, s[8:11], s34 offen lds
    s_add_u32 m0, s38, 1024
    s_nop 0
    buffer_load_dwordx4 v11, s[8:11], s34 offen lds
    s_add_u32 m0, s39, 0
    s_nop 0
    buffer_load_dwordx4 v12, s[12:15], s35 offen sc1 lds
    s_add_u32 m0, s39, 1024
    s_nop 0
    buffer_load_dwordx4 v13, s[12:15], s35 offen sc1 lds
    s_add_u32 m0, s39, 2048
    s_nop 0
    buffer_load_dwordx4 v14, s[12:15], s35 offen sc1 lds
    s_add_u32 m0, s39, 3072
    s_nop 0
    buffer_load_dwordx4 v15, s[12:15], s35 offen sc1 lds
    s_add_u32 s33, s33, 24576
    s_add_u32 s32, s32, 1
    s_cmp_eq_u32 s33, 98304
    s_cselect_b32 s33, 0, s33
    s_cmp_lt_u32 s32, 16
    s_cbranch_scc1 g2_ld_loop
    s_waitcnt vmcnt(12)
    s_barrier
    s_waitcnt vmcnt(6)
    s_barrier
    s_waitcnt vmcnt(0)
    s_barrier
    s_branch g2_ld_end
g2_ld_s4:
    s_waitcnt vmcnt(8)
    s_branch g2_ld_bar
g2_ld_s5:
    s_waitcnt vmcnt(10)
    s_branch g2_ld_bar
g2_ld_end:
    s_barrier
    s_branch g3_in
g2_done:
    s_endpgm
g2_compute:
    v_lshrrev_b32 v5, 4, v2
    v_bfe_u32 v6, v2, 2, 2
    v_and_b32 v7, 3, v2
    v_and_b32 v8, 15, v2
    s_and_b32 s44, s28, 0
    s_lshr_b32 s45, s28, 0
    s_mul_i32 s40, s25, 128
    s_mul_i32 s41, s45, 32
    s_add_u32 s40, s40, s41
    v_add_u32 v20, s40, v8
    s_mov_b32 s41, 2048
    v_mul_lo_u32 v9, v20, s41
    s_mul_i32 s40, s24, 128
    s_mul_i32 s41, s44, 128
    s_add_u32 s46, s40, s41
    v_and_b32 v3, 1, v5
    v_lshlrev_b32 v3, 5, v3
    v_lshrrev_b32 v4, 1, v5
    v_lshl_add_u32 v3, v4, 4, v3
    v_add3_u32 v9, v9, v3, s46
    s_mov_b32 s52, 0
    s_mov_b32 s53, 32768
    s_waitcnt lgkmcnt(0)
    s_add_u32 s4, s4, s97
    s_addc_u32 s5, s5, 0
    s_add_u32 s20, s4, 0x1900000
    s_addc_u32 s21, s5, 0
    s_cmp_eq_u32 s96, 1
    s_cselect_b32 s20, s20, s6
    s_cselect_b32 s21, s21, s7
    s_mov_b32 s22, 0x400000
    s_mov_b32 s23, 0x20000
    s_add_u32 s16, s4, 0x800000
    s_addc_u32 s17, s5, 0
    s_mov_b32 s18, 0x400000
    s_mov_b32 s19, 0x20000
    s_add_u32 s56, s4, 0xc00000
    s_addc_u32 s57, s5, 0
    s_mov_b32 s58, 0x480000
    s_mov_b32 s59, 0x20000
    s_add_u32 s60, s4, 0x200000
    s_addc_u32 s61, s5, 0
    s_mov_b32 s62, 0x40000
    s_mov_b32 s63, 0x20000
    s_mul_i32 s42, s44, 4
    s_mov_b32 s43, 0
    v_and_b32 v3, 1, v5
    v_lshlrev_b32 v3, 1, v3
    v_lshrrev_b32 v4, 1, v6
    v_or_b32 v3, v3, v4
    s_add_u32 s40, s42, 0
    v_xor_b32 v3, s40, v3
    v_lshlrev_b32 v3, 5, v3
    v_lshl_add_u32 v3, v7, 3, v3
    v_lshl_add_u32 v4, v5, 3, v6
    v_lshl_add_u32 v3, v4, 7, v3
    v_add_u32 v10, s43, v3
    v_and_b32 v3, 1, v5
    v_lshlrev_b32 v3, 1, v3
    v_lshrrev_b32 v4, 1, v6
    v_or_b32 v3, v3, v4
    s_add_u32 s40, s42, 1
    v_xor_b32 v3, s40, v3
    v_lshlrev_b32 v3, 5, v3
    v_lshl_add_u32 v3, v7, 3, v3
    v_lshl_add_u32 v4, v5, 3, v6
    v_lshl_add_u32 v3, v4, 7, v3
    v_add_u32 v11, s43, v3
    v_and_b32 v3, 1, v5
    v_lshlrev_b32 v3, 1, v3
    v_lshrrev_b32 v4, 1, v6
    v_or_b32 v3, v3, v4
    s_add_u32 s40, s42, 2
    v_xor_b32 v3, s40, v3
    v_lshlrev_b32 v3, 5, v3
    v_lshl_add_u32 v3, v7, 3, v3
    v_lshl_add_u32 v4, v5, 3, v6
    v_lshl_add_u32 v3, v4, 7, v3
    v_add_u32 v12, s43, v3
    v_and_b32 v3, 1, v5
    v_lshlrev_b32 v3, 1, v3
    v_lshrrev_b32 v4, 1, v6
    v_or_b32 v3, v3, v4
    s_add_u32 s40, s42, 3
    v_xor_b32 v3, s40, v3
    v_lshlrev_b32 v3, 5, v3
    v_lshl_add_u32 v3, v7, 3, v3
    v_lshl_add_u32 v4, v5, 3, v6
    v_lshl_add_u32 v3, v4, 7, v3
    v_add_u32 v13, s43, v3
    s_mul_i32 s42, s45, 32
    v_lshrrev_b32 v3, 1, v8
    v_xor_b32 v3, v3, v5
    v_lshlrev_b32 v3, 4, v3
    v_lshl_add_u32 v3, v8, 7, v3
    s_lshl_b32 s40, s42, 7
    s_add_u32 s40, s40, 8192
    v_add_u32 v14, s40, v3
    v_xor_b32 v15, 64, v14
    v_mov_b32 v84, 0
    v_mov_b32 v85, 0
    v_mov_b32 v86, 0
    v_mov_b32 v87, 0
    v_mov_b32 v88, 0
    v_mov_b32 v89, 0
    v_mov_b32 v90, 0
    v_mov_b32 v91, 0
    v_mov_b32 v92, 0
    v_mov_b32 v93, 0
    v_mov_b32 v94, 0
    v_mov_b32 v95, 0
    v_mov_b32 v96, 0
    v_mov_b32 v97, 0
    v_mov_b32 v98, 0
    v_mov_b32 v99, 0
    v_mov_b32 v100, 0
    v_mov_b32 v101, 0
    v_mov_b32 v102, 0
    v_mov_b32 v103, 0
    v_mov_b32 v104, 0
    v_mov_b32 v105, 0
    v_mov_b32 v106, 0
    v_mov_b32 v107, 0
    s_mov_b32 s48, 16
    s_mov_b32 s50, 0
    s_mov_b32 s51, 24576
    s_mov_b32 s29, 0xfffee000
    v_mov_b32 v28, 0
    v_mov_b32 v29, 0
    v_mov_b32 v30, 0
    v_mov_b32 v31, 0
    v_mov_b32 v32, 0
    v_mov_b32 v33, 0
    v_mov_b32 v34, 0
    v_mov_b32 v35, 0
    v_mov_b32 v36, 0
    v_mov_b32 v37, 0
    v_mov_b32 v38, 0
    v_mov_b32 v39, 0
    v_mov_b32 v40, 0
    v_mov_b32 v41, 0
    v_mov_b32 v42, 0
    v_mov_b32 v43, 0
    v_mov_b32 v44, 0
    v_mov_b32 v45, 0
    v_mov_b32 v46, 0
    v_mov_b32 v47, 0
    v_mov_b32 v48, 0
    v_mov_b32 v49, 0
    v_mov_b32 v50, 0
    v_mov_b32 v51, 0
    v_mov_b32 v52, 0
    v_mov_b32 v53, 0
    v_mov_b32 v54, 0
    v_mov_b32 v55, 0
    v_mov_b32 v56, 0
    v_mov_b32 v57, 0
    v_mov_b32 v58, 0
    v_mov_b32 v59, 0
    s_barrier
    buffer_load_dwordx4 v[124:127], v9, s[20:23], s52 offen offset:0 sc1
    buffer_load_dwordx4 v[128:131], v9, s[20:23], s52 offen offset:64 sc1
    buffer_load_dwordx4 v[132:135], v9, s[20:23], s53 offen offset:0 sc1
    buffer_load_dwordx4 v[136:139], v9, s[20:23], s53 offen offset:64 sc1
    s_branch g2_cloop2
g2_mid:
    s_waitcnt vmcnt(0)
    s_nop 7
    v_permlane16_swap_b32 v124, v126
    v_permlane16_swap_b32 v125, v127
    v_permlane16_swap_b32 v128, v130
    v_permlane16_swap_b32 v129, v131
    v_permlane16_swap_b32 v132, v134
    v_permlane16_swap_b32 v133, v135
    v_permlane16_swap_b32 v136, v138
    v_permlane16_swap_b32 v137, v139
    v_lshlrev_b32 v140, 16, v124
    v_and_b32 v141, 0xffff0000, v124
    v_lshlrev_b32 v142, 16, v125
    v_and_b32 v143, 0xffff0000, v125
    v_lshlrev_b32 v144, 16, v126
    v_and_b32 v145, 0xffff0000, v126
    v_lshlrev_b32 v146, 16, v127
    v_and_b32 v147, 0xffff0000, v127
    v_pk_add_f32 v[28:29], v[28:29], v[140:141]
    v_pk_add_f32 v[30:31], v[30:31], v[142:143]
    v_pk_add_f32 v[36:37], v[36:37], v[144:145]
    v_pk_add_f32 v[38:39], v[38:39], v[146:147]
    v_lshlrev_b32 v140, 16, v128
    v_and_b32 v141, 0xffff0000, v128
    v_lshlrev_b32 v142, 16, v129
    v_and_b32 v143, 0xffff0000, v129
    v_lshlrev_b32 v144, 16, v130
    v_and_b32 v145, 0xffff0000, v130
    v_lshlrev_b32 v146, 16, v131
    v_and_b32 v147, 0xffff0000, v131
    v_pk_add_f32 v[44:45], v[44:45], v[140:141]
    v_pk_add_f32 v[46:47], v[46:47], v[142:143]
    v_pk_add_f32 v[52:53], v[52:53], v[144:145]
    v_pk_add_f32 v[54:55], v[54:55], v[146:147]
    v_lshlrev_b32 v140, 16, v132
    v_and_b32 v141, 0xffff0000, v132
    v_lshlrev_b32 v142, 16, v133
    v_and_b32 v143, 0xffff0000, v133
    v_lshlrev_b32 v144, 16, v134
    v_and_b32 v145, 0xffff0000, v134
    v_lshlrev_b32 v146, 16, v135
    v_and_b32 v147, 0xffff0000, v135
    v_pk_add_f32 v[32:33], v[32:33], v[140:141]
    v_pk_add_f32 v[34:35], v[34:35], v[142:143]
    v_pk_add_f32 v[40:41], v[40:41], v[144:145]
    v_pk_add_f32 v[42:43], v[42:43], v[146:147]
    v_lshlrev_b32 v140, 16, v136
    v_and_b32 v141, 0xffff0000, v136
    v_lshlrev_b32 v142, 16, v137
    v_and_b32 v143, 0xffff0000, v137
    v_lshlrev_b32 v144, 16, v138
    v_and_b32 v145, 0xffff0000, v138
    v_lshlrev_b32 v146, 16, v139
    v_and_b32 v147, 0xffff0000, v139
    v_pk_add_f32 v[48:49], v[48:49], v[140:141]
    v_pk_add_f32 v[50:51], v[50:51], v[142:143]
    v_pk_add_f32 v[56:57], v[56:57], v[144:145]
    v_pk_add_f32 v[58:59], v[58:59], v[146:147]
    s_nop 1
    s_branch g2_cloop2
.p2align 3
g2_cloop:
    s_barrier
    s_cmp_eq_u32 s48, 8
    s_cbranch_scc1 g2_mid
g2_cloop2:
    v_mfma_f32_16x16x32_bf16 v[28:31], v[84:87], v[100:103], v[28:31]
    ds_read_b64_tr_b16 v[60:61], v10 offset:0
    ds_read_b64_tr_b16 v[62:63], v10 offset:512
    v_mfma_f32_16x16x32_bf16 v[32:35], v[84:87], v[104:107], v[32:35]
    ds_read_b128 v[76:79], v14 offset:0
    v_mfma_f32_16x16x32_bf16 v[40:43], v[88:91], v[104:107], v[40:43]
    ds_read_b128 v[80:83], v14 offset:2048
    v_mfma_f32_16x16x32_bf16 v[36:39], v[88:91], v[100:103], v[36:39]
    ds_read_b64_tr_b16 v[64:65], v11 offset:0
    ds_read_b64_tr_b16 v[66:67], v11 offset:512
    v_mfma_f32_16x16x32_bf16 v[44:47], v[92:95], v[100:103], v[44:47]
    ds_read_b64_tr_b16 v[68:69], v12 offset:0
    ds_read_b64_tr_b16 v[70:71], v12 offset:512
    v_mfma_f32_16x16x32_bf16 v[48:51], v[92:95], v[104:107], v[48:51]
    ds_read_b64_tr_b16 v[72:73], v13 offset:0
    ds_read_b64_tr_b16 v[74:75], v13 offset:512
    v_mfma_f32_16x16x32_bf16 v[56:59], v[96:99], v[104:107], v[56:59]
    v_mfma_f32_16x16x32_bf16 v[52:55], v[96:99], v[100:103], v[52:55]
    s_waitcnt lgkmcnt(0)
    v_mfma_f32_16x16x32_bf16 v[28:31], v[60:63], v[76:79], v[28:31]
    ds_read_b64_tr_b16 v[84:85], v10 offset:4096
    ds_read_b64_tr_b16 v[86:87], v10 offset:4608
    v_mfma_f32_16x16x32_bf16 v[32:35], v[60:63], v[80:83], v[32:35]
    ds_read_b128 v[100:103], v15 offset:0
    v_mfma_f32_16x16x32_bf16 v[40:43], v[64:67], v[80:83], v[40:43]
    ds_read_b128 v[104:107], v15 offset:2048
    v_mfma_f32_16x16x32_bf16 v[36:39], v[64:67], v[76:79], v[36:39]
    ds_read_b64_tr_b16 v[88:89], v11 offset:4096
    ds_read_b64_tr_b16 v[90:91], v11 offset:4608
    v_mfma_f32_16x16x32_bf16 v[44:47], v[68:71], v[76:79], v[44:47]
    ds_read_b64_tr_b16 v[92:93], v12 offset:4096
    ds_read_b64_tr_b16 v[94:95], v12 offset:4608
    v_mfma_f32_16x16x32_bf16 v[48:51], v[68:71], v[80:83], v[48:51]
    ds_read_b64_tr_b16 v[96:97], v13 offset:4096
    ds_read_b64_tr_b16 v[98:99], v13 offset:4608
    v_mfma_f32_16x16x32_bf16 v[56:59], v[72:75], v[80:83], v[56:59]
    s_add_u32 s50, s50, 1
    s_cmp_eq_u32 s50, 4
    v_mfma_f32_16x16x32_bf16 v[52:55], v[72:75], v[76:79], v[52:55]
    s_cselect_b32 s49, s29, s51
    s_cselect_b32 s50, 0, s50
    v_add_u32 v10, s49, v10
    v_add_u32 v11, s49, v11
    v_add_u32 v12, s49, v12
    v_add_u32 v13, s49, v13
    v_add_u32 v14, s49, v14
    v_add_u32 v15, s49, v15
    s_sub_u32 s48, s48, 1
    s_cmp_lg_u32 s48, 0
    s_waitcnt lgkmcnt(0)
    s_cbranch_scc1 g2_cloop
    v_mfma_f32_16x16x32_bf16 v[28:31], v[84:87], v[100:103], v[28:31]
    v_mfma_f32_16x16x32_bf16 v[32:35], v[84:87], v[104:107], v[32:35]
    v_mfma_f32_16x16x32_bf16 v[40:43], v[88:91], v[104:107], v[40:43]
    v_mfma_f32_16x16x32_bf16 v[36:39], v[88:91], v[100:103], v[36:39]
    v_mfma_f32_16x16x32_bf16 v[44:47], v[92:95], v[100:103], v[44:47]
    v_mfma_f32_16x16x32_bf16 v[48:51], v[92:95], v[104:107], v[48:51]
    v_mfma_f32_16x16x32_bf16 v[56:59], v[96:99], v[104:107], v[56:59]
    v_mfma_f32_16x16x32_bf16 v[52:55], v[96:99], v[100:103], v[52:55]
    s_nop 7
    v_pk_add_f32 v[76:77], v[28:29], v[30:31]
    v_pk_mul_f32 v[78:79], v[28:29], v[28:29]
    v_pk_fma_f32 v[78:79], v[30:31], v[30:31], v[78:79]
    v_pk_add_f32 v[76:77], v[76:77], v[36:37]
    v_pk_fma_f32 v[78:79], v[36:37], v[36:37], v[78:79]
    v_pk_add_f32 v[76:77], v[76:77], v[38:39]
    v_pk_fma_f32 v[78:79], v[38:39], v[38:39], v[78:79]
    v_pk_add_f32 v[76:77], v[76:77], v[44:45]
    v_pk_fma_f32 v[78:79], v[44:45], v[44:45], v[78:79]
    v_pk_add_f32 v[76:77], v[76:77], v[46:47]
    v_pk_fma_f32 v[78:79], v[46:47], v[46:47], v[78:79]
    v_pk_add_f32 v[76:77], v[76:77], v[52:53]
    v_pk_fma_f32 v[78:79], v[52:53], v[52:53], v[78:79]
    v_pk_add_f32 v[76:77], v[76:77], v[54:55]
    v_pk_fma_f32 v[78:79], v[54:55], v[54:55], v[78:79]
    v_pk_add_f32 v[80:81], v[32:33], v[34:35]
    v_pk_mul_f32 v[82:83], v[32:33], v[32:33]
    v_pk_fma_f32 v[82:83], v[34:35], v[34:35], v[82:83]
    v_pk_add_f32 v[80:81], v[80:81], v[40:41]
    v_pk_fma_f32 v[82:83], v[40:41], v[40:41], v[82:83]
    v_pk_add_f32 v[80:81], v[80:81], v[42:43]
    v_pk_fma_f32 v[82:83], v[42:43], v[42:43], v[82:83]
    v_pk_add_f32 v[80:81], v[80:81], v[48:49]
    v_pk_fma_f32 v[82:83], v[48:49], v[48:49], v[82:83]
    v_pk_add_f32 v[80:81], v[80:81], v[50:51]
    v_pk_fma_f32 v[82:83], v[50:51], v[50:51], v[82:83]
    v_pk_add_f32 v[80:81], v[80:81], v[56:57]
    v_pk_fma_f32 v[82:83], v[56:57], v[56:57], v[82:83]
    v_pk_add_f32 v[80:81], v[80:81], v[58:59]
    v_pk_fma_f32 v[82:83], v[58:59], v[58:59], v[82:83]
    v_add_f32 v76, v76, v77
    v_add_f32 v77, v78, v79
    v_add_f32 v80, v80, v81
    v_add_f32 v81, v82, v83
    s_nop 1
    v_permlane16_swap_b32 v76, v80
    v_permlane16_swap_b32 v77, v81
    v_pk_add_f32 v[76:77], v[76:77], v[80:81]
    v_mov_b32 v84, v76
    v_mov_b32 v85, v77
    v_and_b32 v3, 16, v2
    v_add_u32 v3, v3, v20
    v_permlane32_swap_b32 v76, v84
    v_permlane32_swap_b32 v77, v85
    v_pk_add_f32 v[76:77], v[76:77], v[84:85]
    v_lshlrev_b32 v3, 3, v3
    s_mul_i32 s40, s24, 1
    s_add_u32 s40, s40, s44
    s_lshl_b32 s40, s40, 14
    s_mov_b32 exec_hi, 0
    buffer_store_dwordx2 v[76:77], v3, s[60:63], s40 offen sc1
    s_mov_b32 exec_hi, -1
    v_lshrrev_b32 v4, 5, v2
    v_lshl_add_u32 v21, v4, 17, v3
    v_cvt_pk_bf16_f32 v60, v28, v29
    v_cvt_pk_bf16_f32 v61, v30, v31
    v_cvt_pk_bf16_f32 v62, v36, v37
    v_cvt_pk_bf16_f32 v63, v38, v39
    v_lshlrev_b32 v28, 16, v60
    v_and_b32 v29, 0xffff0000, v60
    v_lshlrev_b32 v30, 16, v61
    v_and_b32 v31, 0xffff0000, v61
    v_lshlrev_b32 v36, 16, v62
    v_and_b32 v37, 0xffff0000, v62
    v_lshlrev_b32 v38, 16, v63
    v_and_b32 v39, 0xffff0000, v63
    v_permlane16_swap_b32 v60, v62
    v_permlane16_swap_b32 v61, v63
    buffer_store_dwordx4 v[60:63], v9, s[16:19], s52 offen offset:0 sc1
    v_cvt_pk_bf16_f32 v64, v44, v45
    v_cvt_pk_bf16_f32 v65, v46, v47
    v_cvt_pk_bf16_f32 v66, v52, v53
    v_cvt_pk_bf16_f32 v67, v54, v55
    v_lshlrev_b32 v44, 16, v64
    v_and_b32 v45, 0xffff0000, v64
    v_lshlrev_b32 v46, 16, v65
    v_and_b32 v47, 0xffff0000, v65
    v_lshlrev_b32 v52, 16, v66
    v_and_b32 v53, 0xffff0000, v66
    v_lshlrev_b32 v54, 16, v67
    v_and_b32 v55, 0xffff0000, v67
    v_permlane16_swap_b32 v64, v66
    v_permlane16_swap_b32 v65, v67
    buffer_store_dwordx4 v[64:67], v9, s[16:19], s52 offen offset:64 sc1
    v_cvt_pk_bf16_f32 v68, v32, v33
    v_cvt_pk_bf16_f32 v69, v34, v35
    v_cvt_pk_bf16_f32 v70, v40, v41
    v_cvt_pk_bf16_f32 v71, v42, v43
    v_lshlrev_b32 v32, 16, v68
    v_and_b32 v33, 0xffff0000, v68
    v_lshlrev_b32 v34, 16, v69
    v_and_b32 v35, 0xffff0000, v69
    v_lshlrev_b32 v40, 16, v70
    v_and_b32 v41, 0xffff0000, v70
    v_lshlrev_b32 v42, 16, v71
    v_and_b32 v43, 0xffff0000, v71
    v_permlane16_swap_b32 v68, v70
    v_permlane16_swap_b32 v69, v71
    buffer_store_dwordx4 v[68:71], v9, s[16:19], s53 offen offset:0 sc1
    v_cvt_pk_bf16_f32 v72, v48, v49
    v_cvt_pk_bf16_f32 v73, v50, v51
    v_cvt_pk_bf16_f32 v74, v56, v57
    v_cvt_pk_bf16_f32 v75, v58, v59
    v_lshlrev_b32 v48, 16, v72
    v_and_b32 v49, 0xffff0000, v72
    v_lshlrev_b32 v50, 16, v73
    v_and_b32 v51, 0xffff0000, v73
    v_lshlrev_b32 v56, 16, v74
    v_and_b32 v57, 0xffff0000, v74
    v_lshlrev_b32 v58, 16, v75
    v_and_b32 v59, 0xffff0000, v75
    v_permlane16_swap_b32 v72, v74
    v_permlane16_swap_b32 v73, v75
    buffer_store_dwordx4 v[72:75], v9, s[16:19], s53 offen offset:64 sc1
    s_mov_b32 s48, 0x40000
    v_mul_u32_u24 v19, 256, v20
    v_add_u32 v19, v19, v9
    s_mov_b32 s54, 0
    s_mov_b32 s55, 36864
    s_mov_b32 s40, 0
    buffer_load_dwordx2 v[108:109], v21, s[60:63], s40 offen sc1
    s_mov_b32 s41, 16384
    buffer_load_dwordx2 v[110:111], v21, s[60:63], s41 offen sc1
    s_mov_b32 s40, 32768
    buffer_load_dwordx2 v[112:113], v21, s[60:63], s40 offen sc1
    s_mov_b32 s41, 49152
    buffer_load_dwordx2 v[114:115], v21, s[60:63], s41 offen sc1
    s_mov_b32 s40, 65536
    buffer_load_dwordx2 v[116:117], v21, s[60:63], s40 offen sc1
    s_mov_b32 s41, 81920
    buffer_load_dwordx2 v[118:119], v21, s[60:63], s41 offen sc1
    s_mov_b32 s40, 98304
    buffer_load_dwordx2 v[120:121], v21, s[60:63], s40 offen sc1
    s_mov_b32 s41, 114688
    buffer_load_dwordx2 v[122:123], v21, s[60:63], s41 offen sc1
    s_waitcnt vmcnt(0)
g2_ex:
    v_max3_u32 v4, v108, v109, v110
    v_max3_u32 v4, v4, v111, v112
    v_max3_u32 v4, v4, v113, v114
    v_max3_u32 v4, v4, v115, v116
    v_max3_u32 v4, v4, v117, v118
    v_max3_u32 v4, v4, v119, v120
    v_max3_u32 v4, v4, v121, v122
    v_max_u32 v4, v4, v123
    v_cmp_eq_u32 vcc, -1, v4
    s_sub_u32 s48, s48, 1
    s_cmp_eq_u32 s48, 0
    s_cbranch_scc1 g2_exd
    s_cbranch_vccz g2_exd
    s_sleep 2
    s_mov_b32 s40, 0
    buffer_load_dwordx2 v[108:109], v21, s[60:63], s40 offen sc1
    s_mov_b32 s41, 16384
    buffer_load_dwordx2 v[110:111], v21, s[60:63], s41 offen sc1
    s_mov_b32 s40, 32768
    buffer_load_dwordx2 v[112:113], v21, s[60:63], s40 offen sc1
    s_mov_b32 s41, 49152
    buffer_load_dwordx2 v[114:115], v21, s[60:63], s41 offen sc1
    s_mov_b32 s40, 65536
    buffer_load_dwordx2 v[116:117], v21, s[60:63], s40 offen sc1
    s_mov_b32 s41, 81920
    buffer_load_dwordx2 v[118:119], v21, s[60:63], s41 offen sc1
    s_mov_b32 s40, 98304
    buffer_load_dwordx2 v[120:121], v21, s[60:63], s40 offen sc1
    s_mov_b32 s41, 114688
    buffer_load_dwordx2 v[122:123], v21, s[60:63], s41 offen sc1
    s_waitcnt vmcnt(0)
    s_branch g2_ex
g2_exd:
    v_pk_add_f32 v[108:109], v[108:109], v[116:117]
    v_pk_add_f32 v[110:111], v[110:111], v[118:119]
    v_pk_add_f32 v[112:113], v[112:113], v[120:121]
    v_pk_add_f32 v[114:115], v[114:115], v[122:123]
    v_pk_add_f32 v[108:109], v[108:109], v[112:113]
    v_pk_add_f32 v[110:111], v[110:111], v[114:115]
    v_pk_add_f32 v[108:109], v[108:109], v[110:111]
    v_mov_b32 v110, v108
    v_mov_b32 v111, v109
    s_nop 1
    v_permlane32_swap_b32 v108, v110
    v_permlane32_swap_b32 v109, v111
    v_pk_add_f32 v[108:109], v[108:109], v[110:111]
    v_mul_f32 v108, 0x3a800000, v108
    v_mul_f32 v109, 0x3a800000, v109
    v_fma_f32 v109, -v108, v108, v109
    v_max_f32 v109, 0, v109
    v_mov_b32 v110, v108
    v_mov_b32 v111, v109
    v_cvt_pk_bf16_f32 v110, v110, v110
    v_lshlrev_b32 v110, 16, v110
    v_cvt_pk_bf16_f32 v111, v111, v111
    v_lshlrev_b32 v111, 16, v111
    v_add_f32 v111, 0x3727c5ac, v111
    v_cvt_pk_bf16_f32 v111, v111, v111
    v_lshlrev_b32 v111, 16, v111
    v_sqrt_f32 v111, v111
    s_nop 0
    v_cvt_pk_bf16_f32 v111, v111, v111
    v_lshlrev_b32 v111, 16, v111
    v_rcp_f32 v111, v111
    v_sub_f32 v112, v108, v110
    v_mul_f32 v113, v109, v111
    v_mul_f32 v112, v112, v111
    v_mul_f32 v113, v113, v111
    v_cvt_pk_bf16_f32 v112, v112, v112
    v_lshlrev_b32 v112, 16, v112
    v_cvt_pk_bf16_f32 v113, v113, v113
    v_lshlrev_b32 v113, 16, v113
    v_add_f32 v113, 0x3727c5ac, v113
    v_cvt_pk_bf16_f32 v113, v113, v113
    v_lshlrev_b32 v113, 16, v113
    v_sqrt_f32 v113, v113
    s_nop 0
    v_cvt_pk_bf16_f32 v113, v113, v113
    v_lshlrev_b32 v113, 16, v113
    v_rcp_f32 v113, v113
    v_fma_f32 v112, v110, v111, v112
    v_mul_f32 v114, v111, v113
    v_mul_f32 v115, -v112, v113
    v_mov_b32 v116, v114
    v_mov_b32 v117, v115
    s_nop 1
    v_permlane16_swap_b32 v114, v116
    v_permlane16_swap_b32 v115, v117
    v_pk_fma_f32 v[28:29], v[28:29], v[114:115], v[114:115] op_sel:[0,0,1] op_sel_hi:[1,0,1]
    v_pk_fma_f32 v[30:31], v[30:31], v[114:115], v[114:115] op_sel:[0,0,1] op_sel_hi:[1,0,1]
    v_pk_fma_f32 v[36:37], v[36:37], v[114:115], v[114:115] op_sel:[0,0,1] op_sel_hi:[1,0,1]
    v_pk_fma_f32 v[38:39], v[38:39], v[114:115], v[114:115] op_sel:[0,0,1] op_sel_hi:[1,0,1]
    v_cvt_pk_bf16_f32 v124, v28, v29
    v_cvt_pk_bf16_f32 v125, v30, v31
    v_cvt_pk_bf16_f32 v126, v36, v37
    v_cvt_pk_bf16_f32 v127, v38, v39
    s_nop 1
    v_permlane16_swap_b32 v124, v126
    v_permlane16_swap_b32 v125, v127
    buffer_store_dwordx4 v[124:127], v19, s[56:59], s54 offen offset:0 sc1
    v_pk_fma_f32 v[44:45], v[44:45], v[114:115], v[114:115] op_sel:[0,0,1] op_sel_hi:[1,0,1]
    v_pk_fma_f32 v[46:47], v[46:47], v[114:115], v[114:115] op_sel:[0,0,1] op_sel_hi:[1,0,1]
    v_pk_fma_f32 v[52:53], v[52:53], v[114:115], v[114:115] op_sel:[0,0,1] op_sel_hi:[1,0,1]
    v_pk_fma_f32 v[54:55], v[54:55], v[114:115], v[114:115] op_sel:[0,0,1] op_sel_hi:[1,0,1]
    v_cvt_pk_bf16_f32 v128, v44, v45
    v_cvt_pk_bf16_f32 v129, v46, v47
    v_cvt_pk_bf16_f32 v130, v52, v53
    v_cvt_pk_bf16_f32 v131, v54, v55
    s_nop 1
    v_permlane16_swap_b32 v128, v130
    v_permlane16_swap_b32 v129, v131
    buffer_store_dwordx4 v[128:131], v19, s[56:59], s54 offen offset:64 sc1
    v_pk_fma_f32 v[32:33], v[32:33], v[116:117], v[116:117] op_sel:[0,0,1] op_sel_hi:[1,0,1]
    v_pk_fma_f32 v[34:35], v[34:35], v[116:117], v[116:117] op_sel:[0,0,1] op_sel_hi:[1,0,1]
    v_pk_fma_f32 v[40:41], v[40:41], v[116:117], v[116:117] op_sel:[0,0,1] op_sel_hi:[1,0,1]
    v_pk_fma_f32 v[42:43], v[42:43], v[116:117], v[116:117] op_sel:[0,0,1] op_sel_hi:[1,0,1]
    v_cvt_pk_bf16_f32 v132, v32, v33
    v_cvt_pk_bf16_f32 v133, v34, v35
    v_cvt_pk_bf16_f32 v134, v40, v41
    v_cvt_pk_bf16_f32 v135, v42, v43
    s_nop 1
    v_permlane16_swap_b32 v132, v134
    v_permlane16_swap_b32 v133, v135
    buffer_store_dwordx4 v[132:135], v19, s[56:59], s55 offen offset:0 sc1
    v_pk_fma_f32 v[48:49], v[48:49], v[116:117], v[116:117] op_sel:[0,0,1] op_sel_hi:[1,0,1]
    v_pk_fma_f32 v[50:51], v[50:51], v[116:117], v[116:117] op_sel:[0,0,1] op_sel_hi:[1,0,1]
    v_pk_fma_f32 v[56:57], v[56:57], v[116:117], v[116:117] op_sel:[0,0,1] op_sel_hi:[1,0,1]
    v_pk_fma_f32 v[58:59], v[58:59], v[116:117], v[116:117] op_sel:[0,0,1] op_sel_hi:[1,0,1]
    v_cvt_pk_bf16_f32 v136, v48, v49
    v_cvt_pk_bf16_f32 v137, v50, v51
    v_cvt_pk_bf16_f32 v138, v56, v57
    v_cvt_pk_bf16_f32 v139, v58, v59
    s_nop 1
    v_permlane16_swap_b32 v136, v138
    v_permlane16_swap_b32 v137, v139
    buffer_store_dwordx4 v[136:139], v19, s[56:59], s55 offen offset:64 sc1
    s_lshr_b32 s40, s24, 1
    s_add_u32 s40, s40, 16
    s_lshl_b32 s40, s40, 8
    s_mov_b32 s42, s40
    s_add_u32 s84, s4, 0x300000
    s_addc_u32 s85, s5, 0
    s_mov_b32 s86, 0x4000
    s_mov_b32 s87, 0x20000
    v_mov_b32 v3, s40
    v_mov_b32 v4, 1
    s_waitcnt vmcnt(0)
    s_barrier
    s_cmp_lg_u32 s28, 0
    s_cbranch_scc1 g2_cin
    s_mov_b64 exec, 1
    buffer_atomic_add v4, v3, s[84:87], 0 offen sc1
    s_mov_b64 exec, -1
g2_cin:
    s_branch g3_in
.p2align 6
g3_in:
    s_cmp_ge_u32 s2, 224
    s_cbranch_scc1 g3_spare
    s_load_dwordx2 s[4:5], s[0:1], 80
    s_load_dwordx2 s[30:31], s[0:1], 32
    s_load_dwordx2 s[6:7], s[0:1], 40
    v_lshrrev_b32 v1, 6, v0
    v_and_b32 v2, 63, v0
    s_and_b32 s40, s2, 1
    s_lshl_b32 s40, s40, 2
    s_bfe_u32 s41, s2, 0x20003
    s_add_u32 s25, s40, s41
    s_bfe_u32 s40, s2, 0x20001
    s_mul_i32 s40, s40, 7
    s_lshr_b32 s42, s2, 5
    s_add_u32 s24, s40, s42
    s_add_u32 s27, s41, s42
    s_mov_b32 s26, 0
    s_cmp_eq_u32 s96, 0
    s_cselect_b32 s95, 3, 1
    v_readfirstlane_b32 s28, v1
    s_nop 0
    s_cmp_lt_u32 s28, 4
    s_cbranch_scc1 g3_compute
    s_sub_u32 s28, s28, 4
    s_mov_b32 s40, 7168
    v_lshrrev_b32 v4, 4, v2
    v_mul_lo_u32 v3, v4, s40
    v_lshlrev_b32 v4, 1, v4
    v_xor_b32 v4, v4, v2
    v_and_b32 v4, 15, v4
    v_lshl_add_u32 v3, v4, 4, v3
    s_mul_i32 s41, s24, 256
    s_mul_i32 s42, s28, 114688
    s_add_u32 s41, s41, s42
    v_xor_b32 v4, 128, v3
    s_add_u32 s42, s41, 0
    v_add_u32 v10, s42, v3
    s_add_u32 s42, s41, 28672
    v_add_u32 v11, s42, v3
    s_add_u32 s42, s41, 57344
    v_add_u32 v12, s42, v4
    s_add_u32 s42, s41, 86016
    v_add_u32 v13, s42, v4
    s_mov_b32 s40, 2304
    v_lshrrev_b32 v4, 4, v2
    v_mul_lo_u32 v3, v4, s40
    v_lshlrev_b32 v4, 1, v4
    v_xor_b32 v4, v4, v2
    v_and_b32 v4, 15, v4
    v_lshl_add_u32 v3, v4, 4, v3
    s_mul_i32 s41, s25, 256
    s_mul_i32 s42, s28, 36864
    s_add_u32 s41, s41, s42
    v_xor_b32 v4, 128, v3
    s_add_u32 s42, s41, 0
    v_add_u32 v14, s42, v3
    s_add_u32 s42, s41, 9216
    v_add_u32 v15, s42, v3
    s_add_u32 s42, s41, 18432
    v_add_u32 v16, s42, v4
    s_add_u32 s42, s41, 27648
    v_add_u32 v17, s42, v4
    s_mul_i32 s36, s28, 4096
    s_mul_i32 s37, s28, 4096
    s_add_u32 s37, s37, 16384
    s_waitcnt lgkmcnt(0)
    s_add_u32 s4, s4, s97
    s_addc_u32 s5, s5, 0
    s_mov_b32 s8, s30
    s_mov_b32 s9, s31
    s_mov_b32 s10, 0xe00000
    s_mov_b32 s11, 0x20000
    s_add_u32 s12, s4, 0xc00000
    s_addc_u32 s13, s5, 0
    s_mov_b32 s14, 0x480000
    s_mov_b32 s15, 0x20000
    s_mov_b32 s32, 0
    s_mov_b32 s33, 0
g3_ld_pW:
    s_add_u32 s40, s32, s27
    s_and_b32 s40, s40, s95
    s_andn2_b32 s41, s32, s95
    s_or_b32 s40, s40, s41
    s_add_u32 s40, s40, s26
    s_mul_i32 s34, s40, 458752
    s_mul_i32 s35, s40, 147456
    s_add_u32 s38, s33, s36
    s_add_u32 s39, s33, s37
    s_add_u32 m0, s38, 0
    s_nop 0
    buffer_load_dwordx4 v10, s[8:11], s34 offen lds
    s_add_u32 m0, s38, 1024
    s_nop 0
    buffer_load_dwordx4 v11, s[8:11], s34 offen lds
    s_add_u32 m0, s38, 2048
    s_nop 0
    buffer_load_dwordx4 v12, s[8:11], s34 offen lds
    s_add_u32 m0, s38, 3072
    s_nop 0
    buffer_load_dwordx4 v13, s[8:11], s34 offen lds
    s_add_u32 s33, s33, 32768
    s_add_u32 s32, s32, 1
    s_cmp_lt_u32 s32, 4
    s_cbranch_scc1 g3_ld_pW
    s_lshr_b32 s40, s25, 0
    s_add_u32 s40, s40, 16
    s_lshl_b32 s40, s40, 8
    s_mov_b32 s42, s40
    s_cmp_lg_u32 s28, 0
    s_cbranch_scc1 g3_dep_set
    s_add_u32 s84, s4, 0x300000
    s_addc_u32 s85, s5, 0
    s_mov_b32 s86, 0x4000
    s_mov_b32 s87, 0x20000
    v_cmp_eq_u32 vcc, 1, v2
    v_mov_b32 v21, s40
    v_mov_b32 v23, s42
    v_cndmask_b32 v21, v21, v23, vcc
    v_mov_b32 v22, 32
    v_mov_b32 v23, 32
    v_cndmask_b32 v22, v22, v23, vcc
    buffer_load_dword v23, v21, s[84:87], 0 offen sc1
g3_dep_set:
    s_lshl_b32 s43, s96, 2
    s_add_u32 s43, s43, 3
    s_mov_b32 s41, 0x800000
    v_mov_b32 v24, 131072
    s_cmp_lg_u32 s28, 0
    s_cbranch_scc1 g3_dep_lds
    s_mov_b32 s41, 0x40000
    s_waitcnt vmcnt(0)
g3_dep:
    v_cmp_lt_u32 vcc, v23, v22
    s_sub_u32 s41, s41, 1
    s_cmp_eq_u32 s41, 0
    s_cbranch_scc1 g3_dep_seen
    s_cbranch_vccz g3_dep_seen
    s_sleep 2
    buffer_load_dword v23, v21, s[84:87], 0 offen sc1
    s_waitcnt vmcnt(0)
    s_branch g3_dep
g3_dep_seen:
    v_mov_b32 v23, s43
    ds_write_b32 v24, v23
    s_branch g3_dep_ok
g3_dep_lds:
    ds_read_b32 v23, v24
    s_sub_u32 s41, s41, 1
    s_waitcnt lgkmcnt(0)
    v_readfirstlane_b32 s40, v23
    s_cmp_eq_u32 s41, 0
    s_cbranch_scc1 g3_dep_ok
    s_cmp_eq_u32 s40, s43
    s_cbranch_scc1 g3_dep_ok
    s_sleep 1
    s_branch g3_dep_lds
g3_dep_ok:
    s_mov_b32 s32, 0
    s_mov_b32 s33, 0
g3_ld_pA:
    s_add_u32 s40, s32, s27
    s_and_b32 s40, s40, s95
    s_andn2_b32 s41, s32, s95
    s_or_b32 s40, s40, s41
    s_add_u32 s40, s40, s26
    s_mul_i32 s34, s40, 458752
    s_mul_i32 s35, s40, 147456
    s_add_u32 s38, s33, s36
    s_add_u32 s39, s33, s37
    s_add_u32 m0, s39, 0
    s_nop 0
    buffer_load_dwordx4 v14, s[12:15], s35 offen sc1 lds
    s_add_u32 m0, s39, 1024
    s_nop 0
    buffer_load_dwordx4 v15, s[12:15], s35 offen sc1 lds
    s_add_u32 m0, s39, 2048
    s_nop 0
    buffer_load_dwordx4 v16, s[12:15], s35 offen sc1 lds
    s_add_u32 m0, s39, 3072
    s_nop 0
    buffer_load_dwordx4 v17, s[12:15], s35 offen sc1 lds
    s_add_u32 s33, s33, 32768
    s_add_u32 s32, s32, 1
    s_cmp_lt_u32 s32, 3
    s_cbranch_scc1 g3_ld_pA
    s_waitcnt vmcnt(8)
    s_barrier
    s_add_u32 s40, s32, s27
    s_and_b32 s40, s40, s95
    s_andn2_b32 s41, s32, s95
    s_or_b32 s40, s40, s41
    s_add_u32 s40, s40, s26
    s_mul_i32 s34, s40, 458752
    s_mul_i32 s35, s40, 147456
    s_add_u32 s38, s33, s36
    s_add_u32 s39, s33, s37
    s_add_u32 m0, s39, 0
    s_nop 0
    buffer_load_dwordx4 v14, s[12:15], s35 offen sc1 lds
    s_add_u32 m0, s39, 1024
    s_nop 0
    buffer_load_dwordx4 v15, s[12:15], s35 offen sc1 lds
    s_add_u32 m0, s39, 2048
    s_nop 0
    buffer_load_dwordx4 v16, s[12:15], s35 offen sc1 lds
    s_add_u32 m0, s39, 3072
    s_nop 0
    buffer_load_dwordx4 v17, s[12:15], s35 offen sc1 lds
    s_mov_b32 s33, 0
    s_add_u32 s32, s32, 1
g3_ld_loop:
    s_cmp_eq_u32 s32, 4
    s_cbranch_scc1 g3_ld_s4
    s_cmp_eq_u32 s32, 5
    s_cbranch_scc1 g3_ld_s5
    s_waitcnt vmcnt(16)
g3_ld_bar:
    s_barrier
    s_add_u32 s40, s32, s27
    s_and_b32 s40, s40, s95
    s_andn2_b32 s41, s32, s95
    s_or_b32 s40, s40, s41
    s_add_u32 s40, s40, s26
    s_mul_i32 s34, s40, 458752
    s_mul_i32 s35, s40, 147456
    s_add_u32 s38, s33, s36
    s_add_u32 s39, s33, s37
    s_add_u32 m0, s38, 0
    s_nop 0
    buffer_load_dwordx4 v10, s[8:11], s34 offen lds
    s_add_u32 m0, s38, 1024
    s_nop 0
    buffer_load_dwordx4 v11, s[8:11], s34 offen lds
    s_add_u32 m0, s38, 2048
    s_nop 0
    buffer_load_dwordx4 v12, s[8:11], s34 offen lds
    s_add_u32 m0, s38, 3072
    s_nop 0
    buffer_load_dwordx4 v13, s[8:11], s34 offen lds
    s_add_u32 m0, s39, 0
    s_nop 0
    buffer_load_dwordx4 v14, s[12:15], s35 offen sc1 lds
    s_add_u32 m0, s39, 1024
    s_nop 0
    buffer_load_dwordx4 v15, s[12:15], s35 offen sc1 lds
    s_add_u32 m0, s39, 2048
    s_nop 0
    buffer_load_dwordx4 v16, s[12:15], s35 offen sc1 lds
    s_add_u32 m0, s39, 3072
    s_nop 0
    buffer_load_dwordx4 v17, s[12:15], s35 offen sc1 lds
    s_add_u32 s33, s33, 32768
    s_add_u32 s32, s32, 1
    s_cmp_eq_u32 s33, 131072
    s_cselect_b32 s33, 0, s33
    s_cmp_lt_u32 s32, 32
    s_cbranch_scc1 g3_ld_loop
    s_waitcnt vmcnt(16)
    s_barrier
    s_waitcnt vmcnt(8)
    s_barrier
    s_waitcnt vmcnt(0)
    s_barrier
    s_branch g3_ld_end
g3_ld_s4:
    s_waitcnt vmcnt(8)
    s_branch g3_ld_bar
g3_ld_s5:
    s_waitcnt vmcnt(12)
    s_branch g3_ld_bar
g3_ld_end:
    s_barrier
    s_branch g4_in
g3_done:
    s_endpgm
g3_compute:
    v_lshrrev_b32 v5, 4, v2
    v_bfe_u32 v6, v2, 2, 2
    v_and_b32 v7, 3, v2
    v_and_b32 v8, 15, v2
    s_and_b32 s44, s28, 1
    s_lshr_b32 s45, s28, 1
    s_mul_i32 s40, s25, 128
    s_mul_i32 s41, s45, 64
    s_add_u32 s40, s40, s41
    v_add_u32 v20, s40, v8
    s_mov_b32 s41, 8192
    v_mul_lo_u32 v9, v20, s41
    s_mul_i32 s40, s24, 256
    s_mul_i32 s41, s44, 128
    s_add_u32 s46, s40, s41
    v_and_b32 v3, 1, v5
    v_lshlrev_b32 v3, 5, v3
    v_lshrrev_b32 v4, 1, v5
    v_lshl_add_u32 v3, v4, 4, v3
    v_add3_u32 v9, v9, v3, s46
    s_mov_b32 s52, 0
    s_mov_b32 s53, 131072
    s_mov_b32 s54, 262144
    s_mov_b32 s55, 393216
    s_waitcnt lgkmcnt(0)
    s_add_u32 s4, s4, s97
    s_addc_u32 s5, s5, 0
    s_mov_b32 s20, s6
    s_mov_b32 s21, s7
    s_mov_b32 s22, 0x1c00
    s_mov_b32 s23, 0x20000
    s_add_u32 s16, s4, 0x1100000
    s_addc_u32 s17, s5, 0
    s_mov_b32 s18, 0x800000
    s_mov_b32 s19, 0x20000
    v_lshl_add_u32 v3, v5, 3, s46
    buffer_load_dwordx2 v[92:93], v3, s[20:23], 0 offen offset:0
    buffer_load_dwordx2 v[94:95], v3, s[20:23], 0 offen offset:32
    buffer_load_dwordx2 v[96:97], v3, s[20:23], 0 offen offset:64
    buffer_load_dwordx2 v[98:99], v3, s[20:23], 0 offen offset:96
    s_mul_i32 s42, s44, 4
    s_mov_b32 s43, 0
    v_and_b32 v3, 1, v5
    v_lshl_or_b32 v3, v3, 2, v6
    s_add_u32 s40, s42, 0
    v_xor_b32 v3, s40, v3
    v_lshlrev_b32 v3, 5, v3
    v_lshl_add_u32 v3, v7, 3, v3
    v_lshl_add_u32 v4, v5, 3, v6
    v_lshl_add_u32 v3, v4, 8, v3
    v_add_u32 v10, s43, v3
    v_and_b32 v3, 1, v5
    v_lshl_or_b32 v3, v3, 2, v6
    s_add_u32 s40, s42, 1
    v_xor_b32 v3, s40, v3
    v_lshlrev_b32 v3, 5, v3
    v_lshl_add_u32 v3, v7, 3, v3
    v_lshl_add_u32 v4, v5, 3, v6
    v_lshl_add_u32 v3, v4, 8, v3
    v_add_u32 v11, s43, v3
    v_and_b32 v3, 1, v5
    v_lshl_or_b32 v3, v3, 2, v6
    s_add_u32 s40, s42, 2
    v_xor_b32 v3, s40, v3
    v_lshlrev_b32 v3, 5, v3
    v_lshl_add_u32 v3, v7, 3, v3
    v_lshl_add_u32 v4, v5, 3, v6
    v_lshl_add_u32 v3, v4, 8, v3
    v_add_u32 v12, s43, v3
    v_and_b32 v3, 1, v5
    v_lshl_or_b32 v3, v3, 2, v6
    s_add_u32 s40, s42, 3
    v_xor_b32 v3, s40, v3
    v_lshlrev_b32 v3, 5, v3
    v_lshl_add_u32 v3, v7, 3, v3
    v_lshl_add_u32 v4, v5, 3, v6
    v_lshl_add_u32 v3, v4, 8, v3
    v_add_u32 v13, s43, v3
    s_mul_i32 s42, s45, 4
    s_mov_b32 s43, 16384
    v_and_b32 v3, 1, v5
    v_lshl_or_b32 v3, v3, 2, v6
    s_add_u32 s40, s42, 0
    v_xor_b32 v3, s40, v3
    v_lshlrev_b32 v3, 5, v3
    v_lshl_add_u32 v3, v7, 3, v3
    v_lshl_add_u32 v4, v5, 3, v6
    v_lshl_add_u32 v3, v4, 8, v3
    v_add_u32 v14, s43, v3
    v_and_b32 v3, 1, v5
    v_lshl_or_b32 v3, v3, 2, v6
    s_add_u32 s40, s42, 1
    v_xor_b32 v3, s40, v3
    v_lshlrev_b32 v3, 5, v3
    v_lshl_add_u32 v3, v7, 3, v3
    v_lshl_add_u32 v4, v5, 3, v6
    v_lshl_add_u32 v3, v4, 8, v3
    v_add_u32 v15, s43, v3
    v_and_b32 v3, 1, v5
    v_lshl_or_b32 v3, v3, 2, v6
    s_add_u32 s40, s42, 2
    v_xor_b32 v3, s40, v3
    v_lshlrev_b32 v3, 5, v3
    v_lshl_add_u32 v3, v7, 3, v3
    v_lshl_add_u32 v4, v5, 3, v6
    v_lshl_add_u32 v3, v4, 8, v3
    v_add_u32 v16, s43, v3
    v_and_b32 v3, 1, v5
    v_lshl_or_b32 v3, v3, 2, v6
    s_add_u32 s40, s42, 3
    v_xor_b32 v3, s40, v3
    v_lshlrev_b32 v3, 5, v3
    v_lshl_add_u32 v3, v7, 3, v3
    v_lshl_add_u32 v4, v5, 3, v6
    v_lshl_add_u32 v3, v4, 8, v3
    v_add_u32 v17, s43, v3
    v_mov_b32 v124, 0
    v_mov_b32 v125, 0
    v_mov_b32 v126, 0
    v_mov_b32 v127, 0
    v_mov_b32 v128, 0
    v_mov_b32 v129, 0
    v_mov_b32 v130, 0
    v_mov_b32 v131, 0
    v_mov_b32 v132, 0
    v_mov_b32 v133, 0
    v_mov_b32 v134, 0
    v_mov_b32 v135, 0
    v_mov_b32 v136, 0
    v_mov_b32 v137, 0
    v_mov_b32 v138, 0
    v_mov_b32 v139, 0
    v_mov_b32 v140, 0
    v_mov_b32 v141, 0
    v_mov_b32 v142, 0
    v_mov_b32 v143, 0
    v_mov_b32 v144, 0
    v_mov_b32 v145, 0
    v_mov_b32 v146, 0
    v_mov_b32 v147, 0
    v_mov_b32 v148, 0
    v_mov_b32 v149, 0
    v_mov_b32 v150, 0
    v_mov_b32 v151, 0
    v_mov_b32 v152, 0
    v_mov_b32 v153, 0
    v_mov_b32 v154, 0
    v_mov_b32 v155, 0
    s_mov_b32 s48, 32
    s_mov_b32 s50, 0
    s_mov_b32 s51, 32768
    s_mov_b32 s29, 0xfffe8000
    s_waitcnt vmcnt(0)
    v_lshlrev_b32 v28, 16, v92
    v_and_b32 v29, 0xffff0000, v92
    v_lshlrev_b32 v30, 16, v93
    v_and_b32 v31, 0xffff0000, v93
    v_lshlrev_b32 v32, 16, v92
    v_and_b32 v33, 0xffff0000, v92
    v_lshlrev_b32 v34, 16, v93
    v_and_b32 v35, 0xffff0000, v93
    v_lshlrev_b32 v36, 16, v92
    v_and_b32 v37, 0xffff0000, v92
    v_lshlrev_b32 v38, 16, v93
    v_and_b32 v39, 0xffff0000, v93
    v_lshlrev_b32 v40, 16, v92
    v_and_b32 v41, 0xffff0000, v92
    v_lshlrev_b32 v42, 16, v93
    v_and_b32 v43, 0xffff0000, v93
    v_lshlrev_b32 v44, 16, v94
    v_and_b32 v45, 0xffff0000, v94
    v_lshlrev_b32 v46, 16, v95
    v_and_b32 v47, 0xffff0000, v95
    v_lshlrev_b32 v48, 16, v94
    v_and_b32 v49, 0xffff0000, v94
    v_lshlrev_b32 v50, 16, v95
    v_and_b32 v51, 0xffff0000, v95
    v_lshlrev_b32 v52, 16, v94
    v_and_b32 v53, 0xffff0000, v94
    v_lshlrev_b32 v54, 16, v95
    v_and_b32 v55, 0xffff0000, v95
    v_lshlrev_b32 v56, 16, v94
    v_and_b32 v57, 0xffff0000, v94
    v_lshlrev_b32 v58, 16, v95
    v_and_b32 v59, 0xffff0000, v95
    v_lshlrev_b32 v60, 16, v96
    v_and_b32 v61, 0xffff0000, v96
    v_lshlrev_b32 v62, 16, v97
    v_and_b32 v63, 0xffff0000, v97
    v_lshlrev_b32 v64, 16, v96
    v_and_b32 v65, 0xffff0000, v96
    v_lshlrev_b32 v66, 16, v97
    v_and_b32 v67, 0xffff0000, v97
    v_lshlrev_b32 v68, 16, v96
    v_and_b32 v69, 0xffff0000, v96
    v_lshlrev_b32 v70, 16, v97
    v_and_b32 v71, 0xffff0000, v97
    v_lshlrev_b32 v72, 16, v96
    v_and_b32 v73, 0xffff0000, v96
    v_lshlrev_b32 v74, 16, v97
    v_and_b32 v75, 0xffff0000, v97
    v_lshlrev_b32 v76, 16, v98
    v_and_b32 v77, 0xffff0000, v98
    v_lshlrev_b32 v78, 16, v99
    v_and_b32 v79, 0xffff0000, v99
    v_lshlrev_b32 v80, 16, v98
    v_and_b32 v81, 0xffff0000, v98
    v_lshlrev_b32 v82, 16, v99
    v_and_b32 v83, 0xffff0000, v99
    v_lshlrev_b32 v84, 16, v98
    v_and_b32 v85, 0xffff0000, v98
    v_lshlrev_b32 v86, 16, v99
    v_and_b32 v87, 0xffff0000, v99
    v_lshlrev_b32 v88, 16, v98
    v_and_b32 v89, 0xffff0000, v98
    v_lshlrev_b32 v90, 16, v99
    v_and_b32 v91, 0xffff0000, v99
    v_mov_b32 v156, 0xbdd2d3e8
    v_mov_b32 v157, 0xbdd2d3e8
    v_mov_b32 v158, 0xc0135761
    v_mov_b32 v159, 0xc0135761
    v_mov_b32 v160, 0x3f800000
    v_mov_b32 v161, 0x3f800000
.p2align 3
g3_cloop:
    s_barrier
g3_cloop2:
    v_mfma_f32_16x16x32_bf16 v[28:31], v[124:127], v[140:143], v[28:31]
    ds_read_b64_tr_b16 v[92:93], v10 offset:0
    ds_read_b64_tr_b16 v[94:95], v10 offset:1024
    v_mfma_f32_16x16x32_bf16 v[32:35], v[124:127], v[144:147], v[32:35]
    ds_read_b64_tr_b16 v[108:109], v14 offset:0
    ds_read_b64_tr_b16 v[110:111], v14 offset:1024
    v_mfma_f32_16x16x32_bf16 v[36:39], v[124:127], v[148:151], v[36:39]
    ds_read_b64_tr_b16 v[112:113], v15 offset:0
    ds_read_b64_tr_b16 v[114:115], v15 offset:1024
    v_mfma_f32_16x16x32_bf16 v[40:43], v[124:127], v[152:155], v[40:43]
    ds_read_b64_tr_b16 v[116:117], v16 offset:0
    ds_read_b64_tr_b16 v[118:119], v16 offset:1024
    v_mfma_f32_16x16x32_bf16 v[56:59], v[128:131], v[152:155], v[56:59]
    ds_read_b64_tr_b16 v[120:121], v17 offset:0
    ds_read_b64_tr_b16 v[122:123], v17 offset:1024
    v_mfma_f32_16x16x32_bf16 v[52:55], v[128:131], v[148:151], v[52:55]
    ds_read_b64_tr_b16 v[96:97], v11 offset:0
    ds_read_b64_tr_b16 v[98:99], v11 offset:1024
    v_mfma_f32_16x16x32_bf16 v[48:51], v[128:131], v[144:147], v[48:51]
    ds_read_b64_tr_b16 v[100:101], v12 offset:0
    ds_read_b64_tr_b16 v[102:103], v12 offset:1024
    v_mfma_f32_16x16x32_bf16 v[44:47], v[128:131], v[140:143], v[44:47]
    ds_read_b64_tr_b16 v[104:105], v13 offset:0
    ds_read_b64_tr_b16 v[106:107], v13 offset:1024
    v_mfma_f32_16x16x32_bf16 v[60:63], v[132:135], v[140:143], v[60:63]
    v_mfma_f32_16x16x32_bf16 v[64:67], v[132:135], v[144:147], v[64:67]
    v_mfma_f32_16x16x32_bf16 v[68:71], v[132:135], v[148:151], v[68:71]
    v_mfma_f32_16x16x32_bf16 v[72:75], v[132:135], v[152:155], v[72:75]
    v_mfma_f32_16x16x32_bf16 v[88:91], v[136:139], v[152:155], v[88:91]
    v_mfma_f32_16x16x32_bf16 v[84:87], v[136:139], v[148:151], v[84:87]
    v_mfma_f32_16x16x32_bf16 v[80:83], v[136:139], v[144:147], v[80:83]
    v_mfma_f32_16x16x32_bf16 v[76:79], v[136:139], v[140:143], v[76:79]
    s_waitcnt lgkmcnt(0)
    v_mfma_f32_16x16x32_bf16 v[28:31], v[92:95], v[108:111], v[28:31]
    ds_read_b64_tr_b16 v[124:125], v10 offset:8192
    ds_read_b64_tr_b16 v[126:127], v10 offset:9216
    v_mfma_f32_16x16x32_bf16 v[32:35], v[92:95], v[112:115], v[32:35]
    ds_read_b64_tr_b16 v[140:141], v14 offset:8192
    ds_read_b64_tr_b16 v[142:143], v14 offset:9216
    v_mfma_f32_16x16x32_bf16 v[36:39], v[92:95], v[116:119], v[36:39]
    ds_read_b64_tr_b16 v[144:145], v15 offset:8192
    ds_read_b64_tr_b16 v[146:147], v15 offset:9216
    v_mfma_f32_16x16x32_bf16 v[40:43], v[92:95], v[120:123], v[40:43]
    ds_read_b64_tr_b16 v[148:149], v16 offset:8192
    ds_read_b64_tr_b16 v[150:151], v16 offset:9216
    v_mfma_f32_16x16x32_bf16 v[56:59], v[96:99], v[120:123], v[56:59]
    ds_read_b64_tr_b16 v[152:153], v17 offset:8192
    ds_read_b64_tr_b16 v[154:155], v17 offset:9216
    v_mfma_f32_16x16x32_bf16 v[52:55], v[96:99], v[116:119], v[52:55]
    ds_read_b64_tr_b16 v[128:129], v11 offset:8192
    ds_read_b64_tr_b16 v[130:131], v11 offset:9216
    v_mfma_f32_16x16x32_bf16 v[48:51], v[96:99], v[112:115], v[48:51]
    ds_read_b64_tr_b16 v[132:133], v12 offset:8192
    ds_read_b64_tr_b16 v[134:135], v12 offset:9216
    v_mfma_f32_16x16x32_bf16 v[44:47], v[96:99], v[108:111], v[44:47]
    ds_read_b64_tr_b16 v[136:137], v13 offset:8192
    ds_read_b64_tr_b16 v[138:139], v13 offset:9216
    v_mfma_f32_16x16x32_bf16 v[60:63], v[100:103], v[108:111], v[60:63]
    s_add_u32 s50, s50, 1
    s_cmp_eq_u32 s50, 4
    v_mfma_f32_16x16x32_bf16 v[64:67], v[100:103], v[112:115], v[64:67]
    s_cselect_b32 s49, s29, s51
    s_cselect_b32 s50, 0, s50
    v_mfma_f32_16x16x32_bf16 v[68:71], v[100:103], v[116:119], v[68:71]
    v_add_u32 v10, s49, v10
    v_add_u32 v11, s49, v11
    v_mfma_f32_16x16x32_bf16 v[72:75], v[100:103], v[120:123], v[72:75]
    v_add_u32 v12, s49, v12
    v_add_u32 v13, s49, v13
    v_mfma_f32_16x16x32_bf16 v[88:91], v[104:107], v[120:123], v[88:91]
    v_add_u32 v14, s49, v14
    v_add_u32 v15, s49, v15
    v_mfma_f32_16x16x32_bf16 v[84:87], v[104:107], v[116:119], v[84:87]
    v_add_u32 v16, s49, v16
    v_add_u32 v17, s49, v17
    v_mfma_f32_16x16x32_bf16 v[80:83], v[104:107], v[112:115], v[80:83]
    s_sub_u32 s48, s48, 1
    s_cmp_lg_u32 s48, 0
    v_mfma_f32_16x16x32_bf16 v[76:79], v[104:107], v[108:111], v[76:79]
    s_waitcnt lgkmcnt(0)
    s_cbranch_scc1 g3_cloop
    v_mfma_f32_16x16x32_bf16 v[28:31], v[124:127], v[140:143], v[28:31]
    v_mfma_f32_16x16x32_bf16 v[44:47], v[128:131], v[140:143], v[44:47]
    v_mfma_f32_16x16x32_bf16 v[60:63], v[132:135], v[140:143], v[60:63]
    v_mfma_f32_16x16x32_bf16 v[76:79], v[136:139], v[140:143], v[76:79]
    v_mfma_f32_16x16x32_bf16 v[32:35], v[124:127], v[144:147], v[32:35]
    v_mfma_f32_16x16x32_bf16 v[48:51], v[128:131], v[144:147], v[48:51]
    v_mfma_f32_16x16x32_bf16 v[64:67], v[132:135], v[144:147], v[64:67]
    v_mfma_f32_16x16x32_bf16 v[80:83], v[136:139], v[144:147], v[80:83]
    s_nop 1
    v_mfma_f32_16x16x32_bf16 v[36:39], v[124:127], v[148:151], v[36:39]
    v_pk_mul_f32 v[108:109], v[28:29], v[28:29]
    v_pk_mul_f32 v[110:111], v[30:31], v[30:31]
    v_pk_mul_f32 v[112:113], v[44:45], v[44:45]
    v_pk_mul_f32 v[114:115], v[46:47], v[46:47]
    v_pk_fma_f32 v[108:109], v[108:109], v[156:157], v[158:159]
    v_pk_fma_f32 v[110:111], v[110:111], v[156:157], v[158:159]
    v_pk_fma_f32 v[112:113], v[112:113], v[156:157], v[158:159]
    v_pk_fma_f32 v[114:115], v[114:115], v[156:157], v[158:159]
    v_pk_mul_f32 v[108:109], v[108:109], v[28:29]
    v_pk_mul_f32 v[110:111], v[110:111], v[30:31]
    v_pk_mul_f32 v[112:113], v[112:113], v[44:45]
    v_pk_mul_f32 v[114:115], v[114:115], v[46:47]
    v_exp_f32 v108, v108
    v_exp_f32 v109, v109
    v_exp_f32 v110, v110
    v_exp_f32 v111, v111
    v_exp_f32 v112, v112
    v_exp_f32 v113, v113
    v_exp_f32 v114, v114
    v_exp_f32 v115, v115
    v_pk_add_f32 v[108:109], v[108:109], v[160:161]
    v_pk_add_f32 v[110:111], v[110:111], v[160:161]
    v_mfma_f32_16x16x32_bf16 v[52:55], v[128:131], v[148:151], v[52:55]
    v_pk_add_f32 v[112:113], v[112:113], v[160:161]
    v_pk_add_f32 v[114:115], v[114:115], v[160:161]
    v_rcp_f32 v108, v108
    v_rcp_f32 v109, v109
    v_rcp_f32 v110, v110
    v_rcp_f32 v111, v111
    v_rcp_f32 v112, v112
    v_rcp_f32 v113, v113
    v_rcp_f32 v114, v114
    v_rcp_f32 v115, v115
    v_pk_mul_f32 v[28:29], v[28:29], v[108:109]
    v_pk_mul_f32 v[30:31], v[30:31], v[110:111]
    v_pk_mul_f32 v[44:45], v[44:45], v[112:113]
    v_pk_mul_f32 v[46:47], v[46:47], v[114:115]
    v_cvt_pk_bf16_f32 v92, v28, v29
    v_cvt_pk_bf16_f32 v93, v30, v31
    v_cvt_pk_bf16_f32 v94, v44, v45
    v_cvt_pk_bf16_f32 v95, v46, v47
    s_nop 1
    v_permlane16_swap_b32 v92, v94
    v_permlane16_swap_b32 v93, v95
    buffer_store_dwordx4 v[92:95], v9, s[16:19], s52 offen offset:0 sc1
    v_mfma_f32_16x16x32_bf16 v[68:71], v[132:135], v[148:151], v[68:71]
    v_pk_mul_f32 v[108:109], v[60:61], v[60:61]
    v_pk_mul_f32 v[110:111], v[62:63], v[62:63]
    v_pk_mul_f32 v[112:113], v[76:77], v[76:77]
    v_pk_mul_f32 v[114:115], v[78:79], v[78:79]
    v_pk_fma_f32 v[108:109], v[108:109], v[156:157], v[158:159]
    v_pk_fma_f32 v[110:111], v[110:111], v[156:157], v[158:159]
    v_pk_fma_f32 v[112:113], v[112:113], v[156:157], v[158:159]
    v_pk_fma_f32 v[114:115], v[114:115], v[156:157], v[158:159]
    v_pk_mul_f32 v[108:109], v[108:109], v[60:61]
    v_pk_mul_f32 v[110:111], v[110:111], v[62:63]
    v_pk_mul_f32 v[112:113], v[112:113], v[76:77]
    v_pk_mul_f32 v[114:115], v[114:115], v[78:79]
    v_exp_f32 v108, v108
    v_exp_f32 v109, v109
    v_exp_f32 v110, v110
    v_exp_f32 v111, v111
    v_exp_f32 v112, v112
    v_exp_f32 v113, v113
    v_exp_f32 v114, v114
    v_exp_f32 v115, v115
    v_pk_add_f32 v[108:109], v[108:109], v[160:161]
    v_pk_add_f32 v[110:111], v[110:111], v[160:161]
    v_mfma_f32_16x16x32_bf16 v[84:87], v[136:139], v[148:151], v[84:87]
    v_pk_add_f32 v[112:113], v[112:113], v[160:161]
    v_pk_add_f32 v[114:115], v[114:115], v[160:161]
    v_rcp_f32 v108, v108
    v_rcp_f32 v109, v109
    v_rcp_f32 v110, v110
    v_rcp_f32 v111, v111
    v_rcp_f32 v112, v112
    v_rcp_f32 v113, v113
    v_rcp_f32 v114, v114
    v_rcp_f32 v115, v115
    v_pk_mul_f32 v[60:61], v[60:61], v[108:109]
    v_pk_mul_f32 v[62:63], v[62:63], v[110:111]
    v_pk_mul_f32 v[76:77], v[76:77], v[112:113]
    v_pk_mul_f32 v[78:79], v[78:79], v[114:115]
    v_cvt_pk_bf16_f32 v96, v60, v61
    v_cvt_pk_bf16_f32 v97, v62, v63
    v_cvt_pk_bf16_f32 v98, v76, v77
    v_cvt_pk_bf16_f32 v99, v78, v79
    s_nop 1
    v_permlane16_swap_b32 v96, v98
    v_permlane16_swap_b32 v97, v99
    buffer_store_dwordx4 v[96:99], v9, s[16:19], s52 offen offset:64 sc1
    v_mfma_f32_16x16x32_bf16 v[40:43], v[124:127], v[152:155], v[40:43]
    v_pk_mul_f32 v[108:109], v[32:33], v[32:33]
    v_pk_mul_f32 v[110:111], v[34:35], v[34:35]
    v_pk_mul_f32 v[112:113], v[48:49], v[48:49]
    v_pk_mul_f32 v[114:115], v[50:51], v[50:51]
    v_pk_fma_f32 v[108:109], v[108:109], v[156:157], v[158:159]
    v_pk_fma_f32 v[110:111], v[110:111], v[156:157], v[158:159]
    v_pk_fma_f32 v[112:113], v[112:113], v[156:157], v[158:159]
    v_pk_fma_f32 v[114:115], v[114:115], v[156:157], v[158:159]
    v_pk_mul_f32 v[108:109], v[108:109], v[32:33]
    v_pk_mul_f32 v[110:111], v[110:111], v[34:35]
    v_pk_mul_f32 v[112:113], v[112:113], v[48:49]
    v_pk_mul_f32 v[114:115], v[114:115], v[50:51]
    v_exp_f32 v108, v108
    v_exp_f32 v109, v109
    v_exp_f32 v110, v110
    v_exp_f32 v111, v111
    v_exp_f32 v112, v112
    v_exp_f32 v113, v113
    v_exp_f32 v114, v114
    v_exp_f32 v115, v115
    v_pk_add_f32 v[108:109], v[108:109], v[160:161]
    v_pk_add_f32 v[110:111], v[110:111], v[160:161]
    v_mfma_f32_16x16x32_bf16 v[56:59], v[128:131], v[152:155], v[56:59]
    v_pk_add_f32 v[112:113], v[112:113], v[160:161]
    v_pk_add_f32 v[114:115], v[114:115], v[160:161]
    v_rcp_f32 v108, v108
    v_rcp_f32 v109, v109
    v_rcp_f32 v110, v110
    v_rcp_f32 v111, v111
    v_rcp_f32 v112, v112
    v_rcp_f32 v113, v113
    v_rcp_f32 v114, v114
    v_rcp_f32 v115, v115
    v_pk_mul_f32 v[32:33], v[32:33], v[108:109]
    v_pk_mul_f32 v[34:35], v[34:35], v[110:111]
    v_pk_mul_f32 v[48:49], v[48:49], v[112:113]
    v_pk_mul_f32 v[50:51], v[50:51], v[114:115]
    v_cvt_pk_bf16_f32 v100, v32, v33
    v_cvt_pk_bf16_f32 v101, v34, v35
    v_cvt_pk_bf16_f32 v102, v48, v49
    v_cvt_pk_bf16_f32 v103, v50, v51
    s_nop 1
    v_permlane16_swap_b32 v100, v102
    v_permlane16_swap_b32 v101, v103
    buffer_store_dwordx4 v[100:103], v9, s[16:19], s53 offen offset:0 sc1
    v_mfma_f32_16x16x32_bf16 v[72:75], v[132:135], v[152:155], v[72:75]
    v_pk_mul_f32 v[108:109], v[64:65], v[64:65]
    v_pk_mul_f32 v[110:111], v[66:67], v[66:67]
    v_pk_mul_f32 v[112:113], v[80:81], v[80:81]
    v_pk_mul_f32 v[114:115], v[82:83], v[82:83]
    v_pk_fma_f32 v[108:109], v[108:109], v[156:157], v[158:159]
    v_pk_fma_f32 v[110:111], v[110:111], v[156:157], v[158:159]
    v_pk_fma_f32 v[112:113], v[112:113], v[156:157], v[158:159]
    v_pk_fma_f32 v[114:115], v[114:115], v[156:157], v[158:159]
    v_pk_mul_f32 v[108:109], v[108:109], v[64:65]
    v_pk_mul_f32 v[110:111], v[110:111], v[66:67]
    v_pk_mul_f32 v[112:113], v[112:113], v[80:81]
    v_pk_mul_f32 v[114:115], v[114:115], v[82:83]
    v_exp_f32 v108, v108
    v_exp_f32 v109, v109
    v_exp_f32 v110, v110
    v_exp_f32 v111, v111
    v_exp_f32 v112, v112
    v_exp_f32 v113, v113
    v_exp_f32 v114, v114
    v_exp_f32 v115, v115
    v_pk_add_f32 v[108:109], v[108:109], v[160:161]
    v_pk_add_f32 v[110:111], v[110:111], v[160:161]
    v_mfma_f32_16x16x32_bf16 v[88:91], v[136:139], v[152:155], v[88:91]
    v_pk_add_f32 v[112:113], v[112:113], v[160:161]
    v_pk_add_f32 v[114:115], v[114:115], v[160:161]
    v_rcp_f32 v108, v108
    v_rcp_f32 v109, v109
    v_rcp_f32 v110, v110
    v_rcp_f32 v111, v111
    v_rcp_f32 v112, v112
    v_rcp_f32 v113, v113
    v_rcp_f32 v114, v114
    v_rcp_f32 v115, v115
    v_pk_mul_f32 v[64:65], v[64:65], v[108:109]
    v_pk_mul_f32 v[66:67], v[66:67], v[110:111]
    v_pk_mul_f32 v[80:81], v[80:81], v[112:113]
    v_pk_mul_f32 v[82:83], v[82:83], v[114:115]
    v_cvt_pk_bf16_f32 v104, v64, v65
    v_cvt_pk_bf16_f32 v105, v66, v67
    v_cvt_pk_bf16_f32 v106, v80, v81
    v_cvt_pk_bf16_f32 v107, v82, v83
    s_nop 1
    v_permlane16_swap_b32 v104, v106
    v_permlane16_swap_b32 v105, v107
    buffer_store_dwordx4 v[104:107], v9, s[16:19], s53 offen offset:64 sc1
    v_pk_mul_f32 v[108:109], v[36:37], v[36:37]
    v_pk_mul_f32 v[110:111], v[38:39], v[38:39]
    v_pk_mul_f32 v[112:113], v[52:53], v[52:53]
    v_pk_mul_f32 v[114:115], v[54:55], v[54:55]
    v_pk_fma_f32 v[108:109], v[108:109], v[156:157], v[158:159]
    v_pk_fma_f32 v[110:111], v[110:111], v[156:157], v[158:159]
    v_pk_fma_f32 v[112:113], v[112:113], v[156:157], v[158:159]
    v_pk_fma_f32 v[114:115], v[114:115], v[156:157], v[158:159]
    v_pk_mul_f32 v[108:109], v[108:109], v[36:37]
    v_pk_mul_f32 v[110:111], v[110:111], v[38:39]
    v_pk_mul_f32 v[112:113], v[112:113], v[52:53]
    v_pk_mul_f32 v[114:115], v[114:115], v[54:55]
    v_exp_f32 v108, v108
    v_exp_f32 v109, v109
    v_exp_f32 v110, v110
    v_exp_f32 v111, v111
    v_exp_f32 v112, v112
    v_exp_f32 v113, v113
    v_exp_f32 v114, v114
    v_exp_f32 v115, v115
    v_pk_add_f32 v[108:109], v[108:109], v[160:161]
    v_pk_add_f32 v[110:111], v[110:111], v[160:161]
    v_pk_add_f32 v[112:113], v[112:113], v[160:161]
    v_pk_add_f32 v[114:115], v[114:115], v[160:161]
    v_rcp_f32 v108, v108
    v_rcp_f32 v109, v109
    v_rcp_f32 v110, v110
    v_rcp_f32 v111, v111
    v_rcp_f32 v112, v112
    v_rcp_f32 v113, v113
    v_rcp_f32 v114, v114
    v_rcp_f32 v115, v115
    v_pk_mul_f32 v[36:37], v[36:37], v[108:109]
    v_pk_mul_f32 v[38:39], v[38:39], v[110:111]
    v_pk_mul_f32 v[52:53], v[52:53], v[112:113]
    v_pk_mul_f32 v[54:55], v[54:55], v[114:115]
    v_cvt_pk_bf16_f32 v92, v36, v37
    v_cvt_pk_bf16_f32 v93, v38, v39
    v_cvt_pk_bf16_f32 v94, v52, v53
    v_cvt_pk_bf16_f32 v95, v54, v55
    s_nop 1
    v_permlane16_swap_b32 v92, v94
    v_permlane16_swap_b32 v93, v95
    buffer_store_dwordx4 v[92:95], v9, s[16:19], s54 offen offset:0 sc1
    v_pk_mul_f32 v[108:109], v[68:69], v[68:69]
    v_pk_mul_f32 v[110:111], v[70:71], v[70:71]
    v_pk_mul_f32 v[112:113], v[84:85], v[84:85]
    v_pk_mul_f32 v[114:115], v[86:87], v[86:87]
    v_pk_fma_f32 v[108:109], v[108:109], v[156:157], v[158:159]
    v_pk_fma_f32 v[110:111], v[110:111], v[156:157], v[158:159]
    v_pk_fma_f32 v[112:113], v[112:113], v[156:157], v[158:159]
    v_pk_fma_f32 v[114:115], v[114:115], v[156:157], v[158:159]
    v_pk_mul_f32 v[108:109], v[108:109], v[68:69]
    v_pk_mul_f32 v[110:111], v[110:111], v[70:71]
    v_pk_mul_f32 v[112:113], v[112:113], v[84:85]
    v_pk_mul_f32 v[114:115], v[114:115], v[86:87]
    v_exp_f32 v108, v108
    v_exp_f32 v109, v109
    v_exp_f32 v110, v110
    v_exp_f32 v111, v111
    v_exp_f32 v112, v112
    v_exp_f32 v113, v113
    v_exp_f32 v114, v114
    v_exp_f32 v115, v115
    v_pk_add_f32 v[108:109], v[108:109], v[160:161]
    v_pk_add_f32 v[110:111], v[110:111], v[160:161]
    v_pk_add_f32 v[112:113], v[112:113], v[160:161]
    v_pk_add_f32 v[114:115], v[114:115], v[160:161]
    v_rcp_f32 v108, v108
    v_rcp_f32 v109, v109
    v_rcp_f32 v110, v110
    v_rcp_f32 v111, v111
    v_rcp_f32 v112, v112
    v_rcp_f32 v113, v113
    v_rcp_f32 v114, v114
    v_rcp_f32 v115, v115
    v_pk_mul_f32 v[68:69], v[68:69], v[108:109]
    v_pk_mul_f32 v[70:71], v[70:71], v[110:111]
    v_pk_mul_f32 v[84:85], v[84:85], v[112:113]
    v_pk_mul_f32 v[86:87], v[86:87], v[114:115]
    v_cvt_pk_bf16_f32 v96, v68, v69
    v_cvt_pk_bf16_f32 v97, v70, v71
    v_cvt_pk_bf16_f32 v98, v84, v85
    v_cvt_pk_bf16_f32 v99, v86, v87
    s_nop 1
    v_permlane16_swap_b32 v96, v98
    v_permlane16_swap_b32 v97, v99
    buffer_store_dwordx4 v[96:99], v9, s[16:19], s54 offen offset:64 sc1
    v_pk_mul_f32 v[108:109], v[40:41], v[40:41]
    v_pk_mul_f32 v[110:111], v[42:43], v[42:43]
    v_pk_mul_f32 v[112:113], v[56:57], v[56:57]
    v_pk_mul_f32 v[114:115], v[58:59], v[58:59]
    v_pk_fma_f32 v[108:109], v[108:109], v[156:157], v[158:159]
    v_pk_fma_f32 v[110:111], v[110:111], v[156:157], v[158:159]
    v_pk_fma_f32 v[112:113], v[112:113], v[156:157], v[158:159]
    v_pk_fma_f32 v[114:115], v[114:115], v[156:157], v[158:159]
    v_pk_mul_f32 v[108:109], v[108:109], v[40:41]
    v_pk_mul_f32 v[110:111], v[110:111], v[42:43]
    v_pk_mul_f32 v[112:113], v[112:113], v[56:57]
    v_pk_mul_f32 v[114:115], v[114:115], v[58:59]
    v_exp_f32 v108, v108
    v_exp_f32 v109, v109
    v_exp_f32 v110, v110
    v_exp_f32 v111, v111
    v_exp_f32 v112, v112
    v_exp_f32 v113, v113
    v_exp_f32 v114, v114
    v_exp_f32 v115, v115
    v_pk_add_f32 v[108:109], v[108:109], v[160:161]
    v_pk_add_f32 v[110:111], v[110:111], v[160:161]
    v_pk_add_f32 v[112:113], v[112:113], v[160:161]
    v_pk_add_f32 v[114:115], v[114:115], v[160:161]
    v_rcp_f32 v108, v108
    v_rcp_f32 v109, v109
    v_rcp_f32 v110, v110
    v_rcp_f32 v111, v111
    v_rcp_f32 v112, v112
    v_rcp_f32 v113, v113
    v_rcp_f32 v114, v114
    v_rcp_f32 v115, v115
    v_pk_mul_f32 v[40:41], v[40:41], v[108:109]
    v_pk_mul_f32 v[42:43], v[42:43], v[110:111]
    v_pk_mul_f32 v[56:57], v[56:57], v[112:113]
    v_pk_mul_f32 v[58:59], v[58:59], v[114:115]
    v_cvt_pk_bf16_f32 v100, v40, v41
    v_cvt_pk_bf16_f32 v101, v42, v43
    v_cvt_pk_bf16_f32 v102, v56, v57
    v_cvt_pk_bf16_f32 v103, v58, v59
    s_nop 1
    v_permlane16_swap_b32 v100, v102
    v_permlane16_swap_b32 v101, v103
    buffer_store_dwordx4 v[100:103], v9, s[16:19], s55 offen offset:0 sc1
    v_pk_mul_f32 v[108:109], v[72:73], v[72:73]
    v_pk_mul_f32 v[110:111], v[74:75], v[74:75]
    v_pk_mul_f32 v[112:113], v[88:89], v[88:89]
    v_pk_mul_f32 v[114:115], v[90:91], v[90:91]
    v_pk_fma_f32 v[108:109], v[108:109], v[156:157], v[158:159]
    v_pk_fma_f32 v[110:111], v[110:111], v[156:157], v[158:159]
    v_pk_fma_f32 v[112:113], v[112:113], v[156:157], v[158:159]
    v_pk_fma_f32 v[114:115], v[114:115], v[156:157], v[158:159]
    v_pk_mul_f32 v[108:109], v[108:109], v[72:73]
    v_pk_mul_f32 v[110:111], v[110:111], v[74:75]
    v_pk_mul_f32 v[112:113], v[112:113], v[88:89]
    v_pk_mul_f32 v[114:115], v[114:115], v[90:91]
    v_exp_f32 v108, v108
    v_exp_f32 v109, v109
    v_exp_f32 v110, v110
    v_exp_f32 v111, v111
    v_exp_f32 v112, v112
    v_exp_f32 v113, v113
    v_exp_f32 v114, v114
    v_exp_f32 v115, v115
    v_pk_add_f32 v[108:109], v[108:109], v[160:161]
    v_pk_add_f32 v[110:111], v[110:111], v[160:161]
    v_pk_add_f32 v[112:113], v[112:113], v[160:161]
    v_pk_add_f32 v[114:115], v[114:115], v[160:161]
    v_rcp_f32 v108, v108
    v_rcp_f32 v109, v109
    v_rcp_f32 v110, v110
    v_rcp_f32 v111, v111
    v_rcp_f32 v112, v112
    v_rcp_f32 v113, v113
    v_rcp_f32 v114, v114
    v_rcp_f32 v115, v115
    v_pk_mul_f32 v[72:73], v[72:73], v[108:109]
    v_pk_mul_f32 v[74:75], v[74:75], v[110:111]
    v_pk_mul_f32 v[88:89], v[88:89], v[112:113]
    v_pk_mul_f32 v[90:91], v[90:91], v[114:115]
    v_cvt_pk_bf16_f32 v104, v72, v73
    v_cvt_pk_bf16_f32 v105, v74, v75
    v_cvt_pk_bf16_f32 v106, v88, v89
    v_cvt_pk_bf16_f32 v107, v90, v91
    s_nop 1
    v_permlane16_swap_b32 v104, v106
    v_permlane16_swap_b32 v105, v107
    buffer_store_dwordx4 v[104:107], v9, s[16:19], s55 offen offset:64 sc1
    s_cmp_ge_u32 s24, 14
    s_cselect_b32 s40, 25, 24
    s_lshl_b32 s41, s25, 1
    s_add_u32 s40, s40, s41
    s_lshl_b32 s40, s40, 8
    s_add_u32 s84, s4, 0x300000
    s_addc_u32 s85, s5, 0
    s_mov_b32 s86, 0x4000
    s_mov_b32 s87, 0x20000
    v_mov_b32 v3, s40
    v_mov_b32 v4, 1
    s_waitcnt vmcnt(0)
    s_barrier
    s_cmp_lg_u32 s28, 0
    s_cbranch_scc1 g3_cin
    s_mov_b64 exec, 1
    buffer_atomic_add v4, v3, s[84:87], 0 offen sc1
    s_mov_b64 exec, -1
g3_cin:
    s_branch g4_in
g3_spare:
    s_cmp_ge_u32 s2, 256
    s_cbranch_scc1 g3_done
    s_load_dwordx2 s[4:5], s[0:1], 80
    s_load_dwordx2 s[6:7], s[0:1], 48
    s_sub_u32 s3, s2, 224
    v_lshrrev_b32 v2, 6, v0
    v_lshlrev_b32 v1, 4, v0
    v_mov_b32 v8, -1
    v_mov_b32 v9, -1
    v_mov_b32 v10, -1
    v_mov_b32 v11, -1
    v_readfirstlane_b32 s28, v2
    s_lshl_b32 s13, s3, 17
    s_waitcnt lgkmcnt(0)
    s_add_u32 s4, s4, s97
    s_addc_u32 s5, s5, 0
    s_add_u32 s8, s4, 0x1d00000
    s_addc_u32 s9, s5, 0
    s_mov_b32 s10, 0x400000
    s_mov_b32 s11, 0x20000
    buffer_store_dwordx4 v[8:11], v1, s[8:11], s13 offen sc1
    s_add_u32 s13, s13, 8192
    buffer_store_dwordx4 v[8:11], v1, s[8:11], s13 offen sc1
    s_add_u32 s13, s13, 8192
    buffer_store_dwordx4 v[8:11], v1, s[8:11], s13 offen sc1
    s_add_u32 s13, s13, 8192
    buffer_store_dwordx4 v[8:11], v1, s[8:11], s13 offen sc1
    s_add_u32 s13, s13, 8192
    buffer_store_dwordx4 v[8:11], v1, s[8:11], s13 offen sc1
    s_add_u32 s13, s13, 8192
    buffer_store_dwordx4 v[8:11], v1, s[8:11], s13 offen sc1
    s_add_u32 s13, s13, 8192
    buffer_store_dwordx4 v[8:11], v1, s[8:11], s13 offen sc1
    s_add_u32 s13, s13, 8192
    buffer_store_dwordx4 v[8:11], v1, s[8:11], s13 offen sc1
    s_add_u32 s13, s13, 8192
    buffer_store_dwordx4 v[8:11], v1, s[8:11], s13 offen sc1
    s_add_u32 s13, s13, 8192
    buffer_store_dwordx4 v[8:11], v1, s[8:11], s13 offen sc1
    s_add_u32 s13, s13, 8192
    buffer_store_dwordx4 v[8:11], v1, s[8:11], s13 offen sc1
    s_add_u32 s13, s13, 8192
    buffer_store_dwordx4 v[8:11], v1, s[8:11], s13 offen sc1
    s_add_u32 s13, s13, 8192
    buffer_store_dwordx4 v[8:11], v1, s[8:11], s13 offen sc1
    s_add_u32 s13, s13, 8192
    buffer_store_dwordx4 v[8:11], v1, s[8:11], s13 offen sc1
    s_add_u32 s13, s13, 8192
    buffer_store_dwordx4 v[8:11], v1, s[8:11], s13 offen sc1
    s_add_u32 s13, s13, 8192
    buffer_store_dwordx4 v[8:11], v1, s[8:11], s13 offen sc1
    s_add_u32 s13, s13, 8192
    s_mov_b32 s40, 14336
    s_add_u32 s84, s4, 0x300000
    s_addc_u32 s85, s5, 0
    s_mov_b32 s86, 0x4000
    s_mov_b32 s87, 0x20000
    v_mov_b32 v3, s40
    v_mov_b32 v4, 1
    s_waitcnt vmcnt(0)
    s_barrier
    s_cmp_lg_u32 s28, 0
    s_cbranch_scc1 g3_spare_cin
    s_mov_b64 exec, 1
    buffer_atomic_add v4, v3, s[84:87], 0 offen sc1
    s_mov_b64 exec, -1
g3_spare_cin:
    s_cmp_lg_u32 s96, 0
    s_cbranch_scc1 g3_spare_end
g3_spare_end:
    s_branch g4_in
.p2align 6
g4_in:
    s_cmp_ge_u32 s2, 256
    s_cbranch_scc1 g4_done
    s_load_dwordx2 s[4:5], s[0:1], 80
    s_load_dwordx2 s[6:7], s[0:1], 64
    s_load_dwordx2 s[30:31], s[0:1], 48
    s_load_dwordx2 s[34:35], s[0:1], 56
    v_lshrrev_b32 v1, 6, v0
    v_and_b32 v2, 63, v0
    s_bfe_u32 s40, s2, 0x10001
    s_lshl_b32 s40, s40, 2
    s_bfe_u32 s41, s2, 0x20003
    s_add_u32 s24, s40, s41
    s_bfe_u32 s40, s2, 0x10002
    s_lshl_b32 s40, s40, 3
    s_lshr_b32 s42, s2, 5
    s_add_u32 s25, s40, s42
    s_and_b32 s91, s2, 1
    s_add_u32 s27, s41, s42
    s_lshl_b32 s92, s24, 4
    s_add_u32 s92, s92, s25
    s_mul_i32 s26, s91, 28
    s_cmp_eq_u32 s96, 0
    s_cselect_b32 s95, 3, 1
    v_readfirstlane_b32 s28, v1
    s_nop 0
    s_cmp_lt_u32 s28, 4
    s_cbranch_scc1 g4_compute
    s_sub_u32 s28, s28, 4
    s_mov_b32 s40, 8192
    v_lshrrev_b32 v3, 3, v2
    v_mul_lo_u32 v3, v3, s40
    v_lshrrev_b32 v4, 4, v2
    v_xor_b32 v4, v4, v2
    v_and_b32 v4, 7, v4
    v_lshl_add_u32 v3, v4, 4, v3
    s_mul_i32 s41, s24, 1048576
    s_mul_i32 s42, s28, 262144
    s_add_u32 s41, s41, s42
    v_xor_b32 v4, 64, v3
    s_add_u32 s42, s41, 0
    v_add_u32 v10, s42, v3
    s_add_u32 s42, s41, 65536
    v_add_u32 v11, s42, v4
    s_add_u32 s42, s41, 131072
    v_add_u32 v12, s42, v3
    s_add_u32 s42, s41, 196608
    v_add_u32 v13, s42, v4
    s_mov_b32 s40, 4096
    v_lshrrev_b32 v4, 4, v2
    v_mul_lo_u32 v3, v4, s40
    v_lshlrev_b32 v4, 1, v4
    v_xor_b32 v4, v4, v2
    v_and_b32 v4, 15, v4
    v_lshl_add_u32 v3, v4, 4, v3
    s_mul_i32 s41, s25, 256
    s_mul_i32 s42, s28, 65536
    s_add_u32 s41, s41, s42
    v_xor_b32 v4, 128, v3
    s_add_u32 s42, s41, 0
    v_add_u32 v14, s42, v3
    s_add_u32 s42, s41, 16384
    v_add_u32 v15, s42, v3
    s_add_u32 s42, s41, 32768
    v_add_u32 v16, s42, v4
    s_add_u32 s42, s41, 49152
    v_add_u32 v17, s42, v4
    s_mul_i32 s36, s28, 4096
    s_mul_i32 s37, s28, 4096
    s_add_u32 s37, s37, 16384
    s_waitcnt lgkmcnt(0)
    s_add_u32 s4, s4, s97
    s_addc_u32 s5, s5, 0
    s_add_u32 s8, s4, 0x1100000
    s_addc_u32 s9, s5, 0
    s_mov_b32 s10, 0x800000
    s_mov_b32 s11, 0x20000
    s_mov_b32 s12, s30
    s_mov_b32 s13, s31
    s_mov_b32 s14, 0xe00000
    s_mov_b32 s15, 0x20000
    s_mov_b32 s32, 0
    s_mov_b32 s33, 0
g4_ld_pW:
    s_add_u32 s40, s32, s27
    s_and_b32 s40, s40, s95
    s_andn2_b32 s41, s32, s95
    s_or_b32 s40, s40, s41
    s_add_u32 s40, s40, s26
    s_mul_i32 s34, s40, 128
    s_mul_i32 s35, s40, 262144
    s_add_u32 s38, s33, s36
    s_add_u32 s39, s33, s37
    s_add_u32 m0, s39, 0
    s_nop 0
    buffer_load_dwordx4 v14, s[12:15], s35 offen lds
    s_add_u32 m0, s39, 1024
    s_nop 0
    buffer_load_dwordx4 v15, s[12:15], s35 offen lds
    s_add_u32 m0, s39, 2048
    s_nop 0
    buffer_load_dwordx4 v16, s[12:15], s35 offen lds
    s_add_u32 m0, s39, 3072
    s_nop 0
    buffer_load_dwordx4 v17, s[12:15], s35 offen lds
    s_add_u32 s33, s33, 32768
    s_add_u32 s32, s32, 1
    s_cmp_lt_u32 s32, 4
    s_cbranch_scc1 g4_ld_pW
    s_lshl_b32 s40, s24, 1
    s_add_u32 s40, s40, s91
    s_add_u32 s40, s40, 24
    s_lshl_b32 s40, s40, 8
    s_mov_b32 s42, 14336
    s_cmp_lg_u32 s28, 0
    s_cbranch_scc1 g4_dep_set
    s_add_u32 s84, s4, 0x300000
    s_addc_u32 s85, s5, 0
    s_mov_b32 s86, 0x4000
    s_mov_b32 s87, 0x20000
    v_cmp_eq_u32 vcc, 1, v2
    v_mov_b32 v21, s40
    v_mov_b32 v23, s42
    v_cndmask_b32 v21, v21, v23, vcc
    v_mov_b32 v22, 14
    v_mov_b32 v23, 32
    v_cndmask_b32 v22, v22, v23, vcc
    buffer_load_dword v23, v21, s[84:87], 0 offen sc1
g4_dep_set:
    s_lshl_b32 s43, s96, 2
    s_add_u32 s43, s43, 4
    s_mov_b32 s41, 0x800000
    v_mov_b32 v24, 131072
    s_cmp_lg_u32 s28, 0
    s_cbranch_scc1 g4_dep_lds
    s_mov_b32 s41, 0x40000
    s_waitcnt vmcnt(0)
g4_dep:
    v_cmp_lt_u32 vcc, v23, v22
    s_sub_u32 s41, s41, 1
    s_cmp_eq_u32 s41, 0
    s_cbranch_scc1 g4_dep_seen
    s_cbranch_vccz g4_dep_seen
    s_sleep 2
    buffer_load_dword v23, v21, s[84:87], 0 offen sc1
    s_waitcnt vmcnt(0)
    s_branch g4_dep
g4_dep_seen:
    v_mov_b32 v23, s43
    ds_write_b32 v24, v23
    s_branch g4_dep_ok
g4_dep_lds:
    ds_read_b32 v23, v24
    s_sub_u32 s41, s41, 1
    s_waitcnt lgkmcnt(0)
    v_readfirstlane_b32 s40, v23
    s_cmp_eq_u32 s41, 0
    s_cbranch_scc1 g4_dep_ok
    s_cmp_eq_u32 s40, s43
    s_cbranch_scc1 g4_dep_ok
    s_sleep 1
    s_branch g4_dep_lds
g4_dep_ok:
    s_mov_b32 s32, 0
    s_mov_b32 s33, 0
g4_ld_pA:
    s_add_u32 s40, s32, s27
    s_and_b32 s40, s40, s95
    s_andn2_b32 s41, s32, s95
    s_or_b32 s40, s40, s41
    s_add_u32 s40, s40, s26
    s_mul_i32 s34, s40, 128
    s_mul_i32 s35, s40, 262144
    s_add_u32 s38, s33, s36
    s_add_u32 s39, s33, s37
    s_add_u32 m0, s38, 0
    s_nop 0
    buffer_load_dwordx4 v10, s[8:11], s34 offen sc1 lds
    s_add_u32 m0, s38, 1024
    s_nop 0
    buffer_load_dwordx4 v11, s[8:11], s34 offen sc1 lds
    s_add_u32 m0, s38, 2048
    s_nop 0
    buffer_load_dwordx4 v12, s[8:11], s34 offen sc1 lds
    s_add_u32 m0, s38, 3072
    s_nop 0
    buffer_load_dwordx4 v13, s[8:11], s34 offen sc1 lds
    s_add_u32 s33, s33, 32768
    s_add_u32 s32, s32, 1
    s_cmp_lt_u32 s32, 3
    s_cbranch_scc1 g4_ld_pA
    s_waitcnt vmcnt(8)
    s_barrier
    s_add_u32 s40, s32, s27
    s_and_b32 s40, s40, s95
    s_andn2_b32 s41, s32, s95
    s_or_b32 s40, s40, s41
    s_add_u32 s40, s40, s26
    s_mul_i32 s34, s40, 128
    s_mul_i32 s35, s40, 262144
    s_add_u32 s38, s33, s36
    s_add_u32 s39, s33, s37
    s_add_u32 m0, s38, 0
    s_nop 0
    buffer_load_dwordx4 v10, s[8:11], s34 offen sc1 lds
    s_add_u32 m0, s38, 1024
    s_nop 0
    buffer_load_dwordx4 v11, s[8:11], s34 offen sc1 lds
    s_add_u32 m0, s38, 2048
    s_nop 0
    buffer_load_dwordx4 v12, s[8:11], s34 offen sc1 lds
    s_add_u32 m0, s38, 3072
    s_nop 0
    buffer_load_dwordx4 v13, s[8:11], s34 offen sc1 lds
    s_mov_b32 s33, 0
    s_add_u32 s32, s32, 1
g4_ld_loop:
    s_cmp_eq_u32 s32, 4
    s_cbranch_scc1 g4_ld_s4
    s_cmp_eq_u32 s32, 5
    s_cbranch_scc1 g4_ld_s5
    s_waitcnt vmcnt(16)
g4_ld_bar:
    s_barrier
    s_add_u32 s40, s32, s27
    s_and_b32 s40, s40, s95
    s_andn2_b32 s41, s32, s95
    s_or_b32 s40, s40, s41
    s_add_u32 s40, s40, s26
    s_mul_i32 s34, s40, 128
    s_mul_i32 s35, s40, 262144
    s_add_u32 s38, s33, s36
    s_add_u32 s39, s33, s37
    s_add_u32 m0, s38, 0
    s_nop 0
    buffer_load_dwordx4 v10, s[8:11], s34 offen sc1 lds
    s_add_u32 m0, s38, 1024
    s_nop 0
    buffer_load_dwordx4 v11, s[8:11], s34 offen sc1 lds
    s_add_u32 m0, s38, 2048
    s_nop 0
    buffer_load_dwordx4 v12, s[8:11], s34 offen sc1 lds
    s_add_u32 m0, s38, 3072
    s_nop 0
    buffer_load_dwordx4 v13, s[8:11], s34 offen sc1 lds
    s_add_u32 m0, s39, 0
    s_nop 0
    buffer_load_dwordx4 v14, s[12:15], s35 offen lds
    s_add_u32 m0, s39, 1024
    s_nop 0
    buffer_load_dwordx4 v15, s[12:15], s35 offen lds
    s_add_u32 m0, s39, 2048
    s_nop 0
    buffer_load_dwordx4 v16, s[12:15], s35 offen lds
    s_add_u32 m0, s39, 3072
    s_nop 0
    buffer_load_dwordx4 v17, s[12:15], s35 offen lds
    s_add_u32 s33, s33, 32768
    s_add_u32 s32, s32, 1
    s_cmp_eq_u32 s33, 131072
    s_cselect_b32 s33, 0, s33
    s_cmp_lt_u32 s32, 28
    s_cbranch_scc1 g4_ld_loop
    s_waitcnt vmcnt(16)
    s_barrier
    s_waitcnt vmcnt(8)
    s_barrier
    s_waitcnt vmcnt(0)
    s_barrier
    s_branch g4_ld_end
g4_ld_s4:
    s_waitcnt vmcnt(8)
    s_branch g4_ld_bar
g4_ld_s5:
    s_waitcnt vmcnt(12)
    s_branch g4_ld_bar
g4_ld_end:
    s_cmp_lg_u32 s96, 0
    s_cbranch_scc1 g4_done
    s_barrier
    s_mov_b32 s96, 1
    s_mov_b32 s97, 0x2800000
    s_branch g1_in
g4_done:
    s_endpgm
g4_compute:
    v_lshrrev_b32 v5, 4, v2
    v_bfe_u32 v6, v2, 2, 2
    v_and_b32 v7, 3, v2
    v_and_b32 v8, 15, v2
    s_and_b32 s44, s28, 1
    s_lshr_b32 s45, s28, 1
    s_mul_i32 s40, s25, 128
    s_mul_i32 s41, s45, 64
    s_add_u32 s40, s40, s41
    s_lshl_b32 s41, s91, 5
    s_add_u32 s40, s40, s41
    v_add_u32 v20, s40, v8
    s_mov_b32 s41, 2048
    v_mul_lo_u32 v9, v20, s41
    s_mul_i32 s40, s24, 256
    s_mul_i32 s41, s44, 128
    s_add_u32 s46, s40, s41
    v_and_b32 v3, 1, v5
    v_lshlrev_b32 v3, 5, v3
    v_lshrrev_b32 v4, 1, v5
    v_lshl_add_u32 v3, v4, 4, v3
    v_add3_u32 v9, v9, v3, s46
    s_mov_b32 s52, 0
    s_mov_b32 s53, 32768
    s_mov_b32 s54, 65536
    s_mov_b32 s55, 98304
    s_waitcnt lgkmcnt(0)
    s_add_u32 s4, s4, s97
    s_addc_u32 s5, s5, 0
    s_add_u32 s20, s4, 0x800000
    s_addc_u32 s21, s5, 0
    s_mov_b32 s22, 0x400000
    s_mov_b32 s23, 0x20000
    s_mov_b32 s56, s34
    s_mov_b32 s57, s35
    s_mov_b32 s58, 0x1000
    s_mov_b32 s59, 0x20000
    s_add_u32 s16, s4, 0x4100000
    s_addc_u32 s17, s5, 0
    s_cmp_eq_u32 s96, 0
    s_cselect_b32 s16, s16, s6
    s_cselect_b32 s17, s17, s7
    s_mov_b32 s18, 0x400000
    s_mov_b32 s19, 0x20000
    s_add_u32 s60, s4, 0x2800000
    s_addc_u32 s61, s5, 0
    s_mov_b32 s62, 0x40000
    s_mov_b32 s63, 0x20000
    s_add_u32 s84, s4, 0x1d00000
    s_addc_u32 s85, s5, 0
    s_mov_b32 s86, 0x400000
    s_mov_b32 s87, 0x20000
    s_mul_i32 s42, s44, 64
    v_lshrrev_b32 v3, 1, v8
    v_xor_b32 v3, v3, v5
    v_lshlrev_b32 v3, 4, v3
    v_lshl_add_u32 v3, v8, 7, v3
    s_lshl_b32 s40, s42, 7
    s_add_u32 s40, s40, 0
    v_add_u32 v10, s40, v3
    v_xor_b32 v11, 64, v10
    s_lshl_b32 s90, s91, 1
    s_mul_i32 s42, s45, 4
    s_mov_b32 s43, 16384
    v_and_b32 v3, 1, v5
    v_lshl_or_b32 v3, v3, 2, v6
    s_add_u32 s40, s42, 0
    s_xor_b32 s40, s40, s90
    v_xor_b32 v3, s40, v3
    v_lshlrev_b32 v3, 5, v3
    v_lshl_add_u32 v3, v7, 3, v3
    v_lshl_add_u32 v4, v5, 3, v6
    v_lshl_add_u32 v3, v4, 8, v3
    v_add_u32 v12, s43, v3
    v_and_b32 v3, 1, v5
    v_lshl_or_b32 v3, v3, 2, v6
    s_add_u32 s40, s42, 1
    s_xor_b32 s40, s40, s90
    v_xor_b32 v3, s40, v3
    v_lshlrev_b32 v3, 5, v3
    v_lshl_add_u32 v3, v7, 3, v3
    v_lshl_add_u32 v4, v5, 3, v6
    v_lshl_add_u32 v3, v4, 8, v3
    v_add_u32 v13, s43, v3
    v_and_b32 v3, 1, v5
    v_lshl_or_b32 v3, v3, 2, v6
    s_add_u32 s40, s42, 2
    s_xor_b32 s40, s40, s90
    v_xor_b32 v3, s40, v3
    v_lshlrev_b32 v3, 5, v3
    v_lshl_add_u32 v3, v7, 3, v3
    v_lshl_add_u32 v4, v5, 3, v6
    v_lshl_add_u32 v3, v4, 8, v3
    v_add_u32 v14, s43, v3
    v_and_b32 v3, 1, v5
    v_lshl_or_b32 v3, v3, 2, v6
    s_add_u32 s40, s42, 3
    s_xor_b32 s40, s40, s90
    v_xor_b32 v3, s40, v3
    v_lshlrev_b32 v3, 5, v3
    v_lshl_add_u32 v3, v7, 3, v3
    v_lshl_add_u32 v4, v5, 3, v6
    v_lshl_add_u32 v3, v4, 8, v3
    v_add_u32 v15, s43, v3
    v_mov_b32 v124, 0
    v_mov_b32 v125, 0
    v_mov_b32 v126, 0
    v_mov_b32 v127, 0
    v_mov_b32 v128, 0
    v_mov_b32 v129, 0
    v_mov_b32 v130, 0
    v_mov_b32 v131, 0
    v_mov_b32 v132, 0
    v_mov_b32 v133, 0
    v_mov_b32 v134, 0
    v_mov_b32 v135, 0
    v_mov_b32 v136, 0
    v_mov_b32 v137, 0
    v_mov_b32 v138, 0
    v_mov_b32 v139, 0
    v_mov_b32 v140, 0
    v_mov_b32 v141, 0
    v_mov_b32 v142, 0
    v_mov_b32 v143, 0
    v_mov_b32 v144, 0
    v_mov_b32 v145, 0
    v_mov_b32 v146, 0
    v_mov_b32 v147, 0
    v_mov_b32 v148, 0
    v_mov_b32 v149, 0
    v_mov_b32 v150, 0
    v_mov_b32 v151, 0
    v_mov_b32 v152, 0
    v_mov_b32 v153, 0
    v_mov_b32 v154, 0
    v_mov_b32 v155, 0
    s_mov_b32 s48, 28
    s_mov_b32 s50, 0
    s_mov_b32 s51, 32768
    s_mov_b32 s29, 0xfffe8000
    s_lshl_b32 s40, s28, 12
    v_lshl_add_u32 v21, v2, 4, s40
    s_lshl_b32 s93, s92, 1
    s_add_u32 s93, s93, s91
    s_lshl_b32 s93, s93, 14
    s_xor_b32 s94, s93, 0x4000
    v_mov_b32 v28, 0
    v_mov_b32 v29, 0
    v_mov_b32 v30, 0
    v_mov_b32 v31, 0
    v_mov_b32 v32, 0
    v_mov_b32 v33, 0
    v_mov_b32 v34, 0
    v_mov_b32 v35, 0
    v_mov_b32 v36, 0
    v_mov_b32 v37, 0
    v_mov_b32 v38, 0
    v_mov_b32 v39, 0
    v_mov_b32 v40, 0
    v_mov_b32 v41, 0
    v_mov_b32 v42, 0
    v_mov_b32 v43, 0
    v_mov_b32 v44, 0
    v_mov_b32 v45, 0
    v_mov_b32 v46, 0
    v_mov_b32 v47, 0
    v_mov_b32 v48, 0
    v_mov_b32 v49, 0
    v_mov_b32 v50, 0
    v_mov_b32 v51, 0
    v_mov_b32 v52, 0
    v_mov_b32 v53, 0
    v_mov_b32 v54, 0
    v_mov_b32 v55, 0
    v_mov_b32 v56, 0
    v_mov_b32 v57, 0
    v_mov_b32 v58, 0
    v_mov_b32 v59, 0
    v_mov_b32 v60, 0
    v_mov_b32 v61, 0
    v_mov_b32 v62, 0
    v_mov_b32 v63, 0
    v_mov_b32 v64, 0
    v_mov_b32 v65, 0
    v_mov_b32 v66, 0
    v_mov_b32 v67, 0
    v_mov_b32 v68, 0
    v_mov_b32 v69, 0
    v_mov_b32 v70, 0
    v_mov_b32 v71, 0
    v_mov_b32 v72, 0
    v_mov_b32 v73, 0
    v_mov_b32 v74, 0
    v_mov_b32 v75, 0
    v_mov_b32 v76, 0
    v_mov_b32 v77, 0
    v_mov_b32 v78, 0
    v_mov_b32 v79, 0
    v_mov_b32 v80, 0
    v_mov_b32 v81, 0
    v_mov_b32 v82, 0
    v_mov_b32 v83, 0
    v_mov_b32 v84, 0
    v_mov_b32 v85, 0
    v_mov_b32 v86, 0
    v_mov_b32 v87, 0
    v_mov_b32 v88, 0
    v_mov_b32 v89, 0
    v_mov_b32 v90, 0
    v_mov_b32 v91, 0
    s_barrier
    buffer_load_dwordx4 v[188:191], v9, s[20:23], s52 offen offset:0 sc1
    buffer_load_dwordx4 v[192:195], v9, s[20:23], s52 offen offset:64 sc1
    buffer_load_dwordx4 v[196:199], v9, s[20:23], s53 offen offset:0 sc1
    buffer_load_dwordx4 v[200:203], v9, s[20:23], s53 offen offset:64 sc1
    v_lshlrev_b32 v3, 1, v20
    buffer_load_ushort v22, v3, s[56:59], 0 offen offset:0
    buffer_load_ushort v23, v3, s[56:59], 0 offen offset:32
    s_branch g4_cloop2
.p2align 3
g4_cloop:
    s_barrier
g4_cloop2:
    v_mfma_f32_16x16x32_bf16 v[28:31], v[124:127], v[140:143], v[28:31]
    ds_read_b128 v[92:95], v10 offset:0
    v_mfma_f32_16x16x32_bf16 v[32:35], v[124:127], v[144:147], v[32:35]
    ds_read_b64_tr_b16 v[108:109], v12 offset:0
    ds_read_b64_tr_b16 v[110:111], v12 offset:1024
    v_mfma_f32_16x16x32_bf16 v[36:39], v[124:127], v[148:151], v[36:39]
    ds_read_b64_tr_b16 v[112:113], v13 offset:0
    ds_read_b64_tr_b16 v[114:115], v13 offset:1024
    v_mfma_f32_16x16x32_bf16 v[40:43], v[124:127], v[152:155], v[40:43]
    ds_read_b64_tr_b16 v[116:117], v14 offset:0
    ds_read_b64_tr_b16 v[118:119], v14 offset:1024
    v_mfma_f32_16x16x32_bf16 v[56:59], v[128:131], v[152:155], v[56:59]
    ds_read_b64_tr_b16 v[120:121], v15 offset:0
    ds_read_b64_tr_b16 v[122:123], v15 offset:1024
    v_mfma_f32_16x16x32_bf16 v[52:55], v[128:131], v[148:151], v[52:55]
    ds_read_b128 v[96:99], v10 offset:2048
    v_mfma_f32_16x16x32_bf16 v[48:51], v[128:131], v[144:147], v[48:51]
    ds_read_b128 v[100:103], v10 offset:4096
    v_mfma_f32_16x16x32_bf16 v[44:47], v[128:131], v[140:143], v[44:47]
    ds_read_b128 v[104:107], v10 offset:6144
    v_mfma_f32_16x16x32_bf16 v[60:63], v[132:135], v[140:143], v[60:63]
    v_mfma_f32_16x16x32_bf16 v[64:67], v[132:135], v[144:147], v[64:67]
    v_mfma_f32_16x16x32_bf16 v[68:71], v[132:135], v[148:151], v[68:71]
    v_mfma_f32_16x16x32_bf16 v[72:75], v[132:135], v[152:155], v[72:75]
    v_mfma_f32_16x16x32_bf16 v[88:91], v[136:139], v[152:155], v[88:91]
    v_mfma_f32_16x16x32_bf16 v[84:87], v[136:139], v[148:151], v[84:87]
    v_mfma_f32_16x16x32_bf16 v[80:83], v[136:139], v[144:147], v[80:83]
    v_mfma_f32_16x16x32_bf16 v[76:79], v[136:139], v[140:143], v[76:79]
    s_waitcnt lgkmcnt(0)
    v_mfma_f32_16x16x32_bf16 v[28:31], v[92:95], v[108:111], v[28:31]
    ds_read_b128 v[124:127], v11 offset:0
    v_mfma_f32_16x16x32_bf16 v[32:35], v[92:95], v[112:115], v[32:35]
    ds_read_b64_tr_b16 v[140:141], v12 offset:8192
    ds_read_b64_tr_b16 v[142:143], v12 offset:9216
    v_mfma_f32_16x16x32_bf16 v[36:39], v[92:95], v[116:119], v[36:39]
    ds_read_b64_tr_b16 v[144:145], v13 offset:8192
    ds_read_b64_tr_b16 v[146:147], v13 offset:9216
    v_mfma_f32_16x16x32_bf16 v[40:43], v[92:95], v[120:123], v[40:43]
    ds_read_b64_tr_b16 v[148:149], v14 offset:8192
    ds_read_b64_tr_b16 v[150:151], v14 offset:9216
    v_mfma_f32_16x16x32_bf16 v[56:59], v[96:99], v[120:123], v[56:59]
    ds_read_b64_tr_b16 v[152:153], v15 offset:8192
    ds_read_b64_tr_b16 v[154:155], v15 offset:9216
    v_mfma_f32_16x16x32_bf16 v[52:55], v[96:99], v[116:119], v[52:55]
    ds_read_b128 v[128:131], v11 offset:2048
    v_mfma_f32_16x16x32_bf16 v[48:51], v[96:99], v[112:115], v[48:51]
    ds_read_b128 v[132:135], v11 offset:4096
    v_mfma_f32_16x16x32_bf16 v[44:47], v[96:99], v[108:111], v[44:47]
    ds_read_b128 v[136:139], v11 offset:6144
    v_mfma_f32_16x16x32_bf16 v[60:63], v[100:103], v[108:111], v[60:63]
    s_add_u32 s50, s50, 1
    s_cmp_eq_u32 s50, 4
    v_mfma_f32_16x16x32_bf16 v[64:67], v[100:103], v[112:115], v[64:67]
    s_cselect_b32 s49, s29, s51
    s_cselect_b32 s50, 0, s50
    v_mfma_f32_16x16x32_bf16 v[68:71], v[100:103], v[116:119], v[68:71]
    v_add_u32 v10, s49, v10
    v_add_u32 v11, s49, v11
    v_mfma_f32_16x16x32_bf16 v[72:75], v[100:103], v[120:123], v[72:75]
    v_add_u32 v12, s49, v12
    v_add_u32 v13, s49, v13
    v_mfma_f32_16x16x32_bf16 v[88:91], v[104:107], v[120:123], v[88:91]
    v_add_u32 v14, s49, v14
    v_add_u32 v15, s49, v15
    v_mfma_f32_16x16x32_bf16 v[84:87], v[104:107], v[116:119], v[84:87]
    s_sub_u32 s48, s48, 1
    s_cmp_lg_u32 s48, 0
    v_mfma_f32_16x16x32_bf16 v[80:83], v[104:107], v[112:115], v[80:83]
    v_mfma_f32_16x16x32_bf16 v[76:79], v[104:107], v[108:111], v[76:79]
    s_waitcnt lgkmcnt(0)
    s_cbranch_scc1 g4_cloop
    v_mfma_f32_16x16x32_bf16 v[36:39], v[124:127], v[148:151], v[36:39]
    v_mfma_f32_16x16x32_bf16 v[52:55], v[128:131], v[148:151], v[52:55]
    v_mfma_f32_16x16x32_bf16 v[68:71], v[132:135], v[148:151], v[68:71]
    v_mfma_f32_16x16x32_bf16 v[84:87], v[136:139], v[148:151], v[84:87]
    v_mfma_f32_16x16x32_bf16 v[40:43], v[124:127], v[152:155], v[40:43]
    v_mfma_f32_16x16x32_bf16 v[56:59], v[128:131], v[152:155], v[56:59]
    v_mfma_f32_16x16x32_bf16 v[72:75], v[132:135], v[152:155], v[72:75]
    v_mfma_f32_16x16x32_bf16 v[88:91], v[136:139], v[152:155], v[88:91]
    v_mfma_f32_16x16x32_bf16 v[28:31], v[124:127], v[140:143], v[28:31]
    v_cvt_pk_bf16_f32 v156, v36, v37
    v_cvt_pk_bf16_f32 v157, v38, v39
    v_mfma_f32_16x16x32_bf16 v[44:47], v[128:131], v[140:143], v[44:47]
    v_cvt_pk_bf16_f32 v158, v52, v53
    v_cvt_pk_bf16_f32 v159, v54, v55
    buffer_store_dwordx4 v[156:159], v21, s[84:87], s93 offen offset:0 sc1
    v_mfma_f32_16x16x32_bf16 v[60:63], v[132:135], v[140:143], v[60:63]
    v_cvt_pk_bf16_f32 v160, v68, v69
    v_cvt_pk_bf16_f32 v161, v70, v71
    v_mfma_f32_16x16x32_bf16 v[76:79], v[136:139], v[140:143], v[76:79]
    v_cvt_pk_bf16_f32 v162, v84, v85
    v_cvt_pk_bf16_f32 v163, v86, v87
    buffer_store_dwordx4 v[160:163], v21, s[84:87], s93 offen offset:1024 sc1
    v_mfma_f32_16x16x32_bf16 v[32:35], v[124:127], v[144:147], v[32:35]
    v_cvt_pk_bf16_f32 v164, v40, v41
    v_cvt_pk_bf16_f32 v165, v42, v43
    v_mfma_f32_16x16x32_bf16 v[48:51], v[128:131], v[144:147], v[48:51]
    v_cvt_pk_bf16_f32 v166, v56, v57
    v_cvt_pk_bf16_f32 v167, v58, v59
    buffer_store_dwordx4 v[164:167], v21, s[84:87], s93 offen offset:2048 sc1
    v_mfma_f32_16x16x32_bf16 v[64:67], v[132:135], v[144:147], v[64:67]
    v_cvt_pk_bf16_f32 v168, v72, v73
    v_cvt_pk_bf16_f32 v169, v74, v75
    v_mfma_f32_16x16x32_bf16 v[80:83], v[136:139], v[144:147], v[80:83]
    s_nop 1
    v_cvt_pk_bf16_f32 v170, v88, v89
    v_cvt_pk_bf16_f32 v171, v90, v91
    buffer_store_dwordx4 v[168:171], v21, s[84:87], s93 offen offset:3072 sc1
    s_mov_b32 s48, 0x40000
    buffer_load_dwordx4 v[172:175], v21, s[84:87], s94 offen offset:0 sc1
    buffer_load_dwordx4 v[176:179], v21, s[84:87], s94 offen offset:1024 sc1
    buffer_load_dwordx4 v[180:183], v21, s[84:87], s94 offen offset:2048 sc1
    buffer_load_dwordx4 v[184:187], v21, s[84:87], s94 offen offset:3072 sc1
    s_waitcnt vmcnt(8)
    s_nop 3
    v_permlane16_swap_b32 v188, v190
    v_permlane16_swap_b32 v189, v191
    v_permlane16_swap_b32 v192, v194
    v_permlane16_swap_b32 v193, v195
    v_permlane16_swap_b32 v196, v198
    v_permlane16_swap_b32 v197, v199
    v_permlane16_swap_b32 v200, v202
    v_permlane16_swap_b32 v201, v203
    v_lshlrev_b32 v22, 16, v22
    v_lshlrev_b32 v23, 16, v23
    v_lshlrev_b32 v204, 16, v188
    v_and_b32 v205, 0xffff0000, v188
    v_lshlrev_b32 v206, 16, v189
    v_and_b32 v207, 0xffff0000, v189
    v_lshlrev_b32 v208, 16, v190
    v_and_b32 v209, 0xffff0000, v190
    v_lshlrev_b32 v210, 16, v191
    v_and_b32 v211, 0xffff0000, v191
    v_add_f32 v204, v204, v22
    v_add_f32 v205, v205, v22
    v_add_f32 v206, v206, v22
    v_add_f32 v207, v207, v22
    v_add_f32 v208, v208, v22
    v_add_f32 v209, v209, v22
    v_add_f32 v210, v210, v22
    v_add_f32 v211, v211, v22
    v_pk_add_f32 v[28:29], v[28:29], v[204:205]
    v_pk_add_f32 v[30:31], v[30:31], v[206:207]
    v_pk_add_f32 v[44:45], v[44:45], v[208:209]
    v_pk_add_f32 v[46:47], v[46:47], v[210:211]
    v_lshlrev_b32 v204, 16, v192
    v_and_b32 v205, 0xffff0000, v192
    v_lshlrev_b32 v206, 16, v193
    v_and_b32 v207, 0xffff0000, v193
    v_lshlrev_b32 v208, 16, v194
    v_and_b32 v209, 0xffff0000, v194
    v_lshlrev_b32 v210, 16, v195
    v_and_b32 v211, 0xffff0000, v195
    v_add_f32 v204, v204, v22
    v_add_f32 v205, v205, v22
    v_add_f32 v206, v206, v22
    v_add_f32 v207, v207, v22
    v_add_f32 v208, v208, v22
    v_add_f32 v209, v209, v22
    v_add_f32 v210, v210, v22
    v_add_f32 v211, v211, v22
    v_pk_add_f32 v[60:61], v[60:61], v[204:205]
    v_pk_add_f32 v[62:63], v[62:63], v[206:207]
    v_pk_add_f32 v[76:77], v[76:77], v[208:209]
    v_pk_add_f32 v[78:79], v[78:79], v[210:211]
    v_lshlrev_b32 v204, 16, v196
    v_and_b32 v205, 0xffff0000, v196
    v_lshlrev_b32 v206, 16, v197
    v_and_b32 v207, 0xffff0000, v197
    v_lshlrev_b32 v208, 16, v198
    v_and_b32 v209, 0xffff0000, v198
    v_lshlrev_b32 v210, 16, v199
    v_and_b32 v211, 0xffff0000, v199
    v_add_f32 v204, v204, v23
    v_add_f32 v205, v205, v23
    v_add_f32 v206, v206, v23
    v_add_f32 v207, v207, v23
    v_add_f32 v208, v208, v23
    v_add_f32 v209, v209, v23
    v_add_f32 v210, v210, v23
    v_add_f32 v211, v211, v23
    v_pk_add_f32 v[32:33], v[32:33], v[204:205]
    v_pk_add_f32 v[34:35], v[34:35], v[206:207]
    v_pk_add_f32 v[48:49], v[48:49], v[208:209]
    v_pk_add_f32 v[50:51], v[50:51], v[210:211]
    v_lshlrev_b32 v204, 16, v200
    v_and_b32 v205, 0xffff0000, v200
    v_lshlrev_b32 v206, 16, v201
    v_and_b32 v207, 0xffff0000, v201
    v_lshlrev_b32 v208, 16, v202
    v_and_b32 v209, 0xffff0000, v202
    v_lshlrev_b32 v210, 16, v203
    v_and_b32 v211, 0xffff0000, v203
    v_add_f32 v204, v204, v23
    v_add_f32 v205, v205, v23
    v_add_f32 v206, v206, v23
    v_add_f32 v207, v207, v23
    v_add_f32 v208, v208, v23
    v_add_f32 v209, v209, v23
    v_add_f32 v210, v210, v23
    v_add_f32 v211, v211, v23
    v_pk_add_f32 v[64:65], v[64:65], v[204:205]
    v_pk_add_f32 v[66:67], v[66:67], v[206:207]
    v_pk_add_f32 v[80:81], v[80:81], v[208:209]
    v_pk_add_f32 v[82:83], v[82:83], v[210:211]
    s_waitcnt vmcnt(0)
g4_rcv:
    v_max3_u32 v4, v172, v173, v174
    v_max3_u32 v4, v4, v175, v176
    v_max3_u32 v4, v4, v177, v178
    v_max3_u32 v4, v4, v179, v180
    v_max3_u32 v4, v4, v181, v182
    v_max3_u32 v4, v4, v183, v184
    v_max3_u32 v4, v4, v185, v186
    v_max_u32 v4, v4, v187
    v_cmp_eq_u32 vcc, -1, v4
    s_sub_u32 s48, s48, 1
    s_cmp_eq_u32 s48, 0
    s_cbranch_scc1 g4_rcvd
    s_cbranch_vccz g4_rcvd
    s_sleep 2
    buffer_load_dwordx4 v[172:175], v21, s[84:87], s94 offen offset:0 sc1
    buffer_load_dwordx4 v[176:179], v21, s[84:87], s94 offen offset:1024 sc1
    buffer_load_dwordx4 v[180:183], v21, s[84:87], s94 offen offset:2048 sc1
    buffer_load_dwordx4 v[184:187], v21, s[84:87], s94 offen offset:3072 sc1
    s_waitcnt vmcnt(0)
    s_branch g4_rcv
g4_rcvd:
    v_lshlrev_b32 v108, 16, v172
    v_and_b32 v109, 0xffff0000, v172
    v_lshlrev_b32 v110, 16, v173
    v_and_b32 v111, 0xffff0000, v173
    v_pk_add_f32 v[28:29], v[28:29], v[108:109]
    v_pk_add_f32 v[30:31], v[30:31], v[110:111]
    v_lshlrev_b32 v112, 16, v174
    v_and_b32 v113, 0xffff0000, v174
    v_lshlrev_b32 v114, 16, v175
    v_and_b32 v115, 0xffff0000, v175
    v_pk_add_f32 v[44:45], v[44:45], v[112:113]
    v_pk_add_f32 v[46:47], v[46:47], v[114:115]
    v_lshlrev_b32 v116, 16, v176
    v_and_b32 v117, 0xffff0000, v176
    v_lshlrev_b32 v118, 16, v177
    v_and_b32 v119, 0xffff0000, v177
    v_pk_add_f32 v[60:61], v[60:61], v[116:117]
    v_pk_add_f32 v[62:63], v[62:63], v[118:119]
    v_lshlrev_b32 v120, 16, v178
    v_and_b32 v121, 0xffff0000, v178
    v_lshlrev_b32 v122, 16, v179
    v_and_b32 v123, 0xffff0000, v179
    v_pk_add_f32 v[76:77], v[76:77], v[120:121]
    v_pk_add_f32 v[78:79], v[78:79], v[122:123]
    v_lshlrev_b32 v108, 16, v180
    v_and_b32 v109, 0xffff0000, v180
    v_lshlrev_b32 v110, 16, v181
    v_and_b32 v111, 0xffff0000, v181
    v_pk_add_f32 v[32:33], v[32:33], v[108:109]
    v_pk_add_f32 v[34:35], v[34:35], v[110:111]
    v_lshlrev_b32 v112, 16, v182
    v_and_b32 v113, 0xffff0000, v182
    v_lshlrev_b32 v114, 16, v183
    v_and_b32 v115, 0xffff0000, v183
    v_pk_add_f32 v[48:49], v[48:49], v[112:113]
    v_pk_add_f32 v[50:51], v[50:51], v[114:115]
    v_lshlrev_b32 v116, 16, v184
    v_and_b32 v117, 0xffff0000, v184
    v_lshlrev_b32 v118, 16, v185
    v_and_b32 v119, 0xffff0000, v185
    v_pk_add_f32 v[64:65], v[64:65], v[116:117]
    v_pk_add_f32 v[66:67], v[66:67], v[118:119]
    v_lshlrev_b32 v120, 16, v186
    v_and_b32 v121, 0xffff0000, v186
    v_lshlrev_b32 v122, 16, v187
    v_and_b32 v123, 0xffff0000, v187
    v_pk_add_f32 v[80:81], v[80:81], v[120:121]
    v_pk_add_f32 v[82:83], v[82:83], v[122:123]
    v_cvt_pk_bf16_f32 v92, v28, v29
    v_cvt_pk_bf16_f32 v93, v30, v31
    v_cvt_pk_bf16_f32 v94, v44, v45
    v_cvt_pk_bf16_f32 v95, v46, v47
    s_nop 1
    v_permlane16_swap_b32 v92, v94
    v_permlane16_swap_b32 v93, v95
    buffer_store_dwordx4 v[92:95], v9, s[16:19], s52 offen offset:0 sc1
    v_cvt_pk_bf16_f32 v96, v60, v61
    v_cvt_pk_bf16_f32 v97, v62, v63
    v_cvt_pk_bf16_f32 v98, v76, v77
    v_cvt_pk_bf16_f32 v99, v78, v79
    s_nop 1
    v_permlane16_swap_b32 v96, v98
    v_permlane16_swap_b32 v97, v99
    buffer_store_dwordx4 v[96:99], v9, s[16:19], s52 offen offset:64 sc1
    v_cvt_pk_bf16_f32 v100, v32, v33
    v_cvt_pk_bf16_f32 v101, v34, v35
    v_cvt_pk_bf16_f32 v102, v48, v49
    v_cvt_pk_bf16_f32 v103, v50, v51
    s_nop 1
    v_permlane16_swap_b32 v100, v102
    v_permlane16_swap_b32 v101, v103
    buffer_store_dwordx4 v[100:103], v9, s[16:19], s53 offen offset:0 sc1
    v_cvt_pk_bf16_f32 v104, v64, v65
    v_cvt_pk_bf16_f32 v105, v66, v67
    v_cvt_pk_bf16_f32 v106, v80, v81
    v_cvt_pk_bf16_f32 v107, v82, v83
    s_nop 1
    v_permlane16_swap_b32 v104, v106
    v_permlane16_swap_b32 v105, v107
    buffer_store_dwordx4 v[104:107], v9, s[16:19], s53 offen offset:64 sc1
    v_pk_add_f32 v[108:109], v[28:29], v[30:31]
    v_pk_mul_f32 v[110:111], v[28:29], v[28:29]
    v_pk_fma_f32 v[110:111], v[30:31], v[30:31], v[110:111]
    v_pk_add_f32 v[108:109], v[108:109], v[44:45]
    v_pk_fma_f32 v[110:111], v[44:45], v[44:45], v[110:111]
    v_pk_add_f32 v[108:109], v[108:109], v[46:47]
    v_pk_fma_f32 v[110:111], v[46:47], v[46:47], v[110:111]
    v_pk_add_f32 v[108:109], v[108:109], v[60:61]
    v_pk_fma_f32 v[110:111], v[60:61], v[60:61], v[110:111]
    v_pk_add_f32 v[108:109], v[108:109], v[62:63]
    v_pk_fma_f32 v[110:111], v[62:63], v[62:63], v[110:111]
    v_pk_add_f32 v[108:109], v[108:109], v[76:77]
    v_pk_fma_f32 v[110:111], v[76:77], v[76:77], v[110:111]
    v_pk_add_f32 v[108:109], v[108:109], v[78:79]
    v_pk_fma_f32 v[110:111], v[78:79], v[78:79], v[110:111]
    v_pk_add_f32 v[112:113], v[32:33], v[34:35]
    v_pk_mul_f32 v[114:115], v[32:33], v[32:33]
    v_pk_fma_f32 v[114:115], v[34:35], v[34:35], v[114:115]
    v_pk_add_f32 v[112:113], v[112:113], v[48:49]
    v_pk_fma_f32 v[114:115], v[48:49], v[48:49], v[114:115]
    v_pk_add_f32 v[112:113], v[112:113], v[50:51]
    v_pk_fma_f32 v[114:115], v[50:51], v[50:51], v[114:115]
    v_pk_add_f32 v[112:113], v[112:113], v[64:65]
    v_pk_fma_f32 v[114:115], v[64:65], v[64:65], v[114:115]
    v_pk_add_f32 v[112:113], v[112:113], v[66:67]
    v_pk_fma_f32 v[114:115], v[66:67], v[66:67], v[114:115]
    v_pk_add_f32 v[112:113], v[112:113], v[80:81]
    v_pk_fma_f32 v[114:115], v[80:81], v[80:81], v[114:115]
    v_pk_add_f32 v[112:113], v[112:113], v[82:83]
    v_pk_fma_f32 v[114:115], v[82:83], v[82:83], v[114:115]
    v_add_f32 v108, v108, v109
    v_add_f32 v109, v110, v111
    v_add_f32 v112, v112, v113
    v_add_f32 v113, v114, v115
    s_nop 1
    v_permlane16_swap_b32 v108, v112
    v_permlane16_swap_b32 v109, v113
    v_pk_add_f32 v[108:109], v[108:109], v[112:113]
    v_mov_b32 v116, v108
    v_mov_b32 v117, v109
    v_and_b32 v3, 16, v2
    v_add_u32 v3, v3, v20
    v_permlane32_swap_b32 v108, v116
    v_permlane32_swap_b32 v109, v117
    v_pk_add_f32 v[108:109], v[108:109], v[116:117]
    v_lshlrev_b32 v3, 3, v3
    s_mul_i32 s40, s24, 2
    s_add_u32 s40, s40, s44
    s_lshl_b32 s40, s40, 14
    s_mov_b32 exec_hi, 0
    buffer_store_dwordx2 v[108:109], v3, s[60:63], s40 offen sc1
    s_mov_b32 exec_hi, -1
    s_cmp_lg_u32 s96, 0
    s_cbranch_scc1 g4_done
    s_lshr_b32 s40, s25, 0
    s_add_u32 s40, s40, 40
    s_lshl_b32 s40, s40, 8
    s_mov_b32 s42, s40
    s_add_u32 s84, s4, 0x2b00000
    s_addc_u32 s85, s5, 0
    s_mov_b32 s86, 0x4000
    s_mov_b32 s87, 0x20000
    v_mov_b32 v3, s40
    v_mov_b32 v4, 1
    s_waitcnt vmcnt(0)
    s_barrier
    s_cmp_lg_u32 s28, 0
    s_cbranch_scc1 g4_cin
    s_mov_b64 exec, 1
    buffer_atomic_add v4, v3, s[84:87], 0 offen sc1
    s_mov_b64 exec, -1
g4_cin:
    s_mov_b32 s96, 1
    s_mov_b32 s97, 0x2800000
    s_branch g1_in
code_end:
.section .rodata,"a"
.p2align 6
.amdhsa_kernel g1a_kernel
  .amdhsa_next_free_vgpr 248
  .amdhsa_next_free_sgpr 100
  .amdhsa_accum_offset 248
  .amdhsa_group_segment_fixed_size 0
  .amdhsa_kernarg_size 88
  .amdhsa_user_sgpr_count 2
  .amdhsa_user_sgpr_kernarg_segment_ptr 1
  .amdhsa_system_sgpr_workgroup_id_x 1
.end_amdhsa_kernel
```

```asm
; @launch kernel=g1a_kernel grid=(256,1,1) block=(512,1,1) lds=131328
.amdgcn_target "amdgcn-amd-amdhsa--gfx950"
.text
.globl g1a_kernel
.p2align 8
.type g1a_kernel,@function
g1a_kernel:
    s_mov_b32 s96, 0
    s_mov_b32 s97, 0x0
    v_mov_b32 v1, 131072
    v_mov_b32 v2, 0
    ds_write_b32 v1, v2
    s_branch g1_in
.p2align 6
g1_in:
    s_cmp_ge_u32 s2, 256
    s_cbranch_scc1 g1_done
    s_load_dwordx2 s[4:5], s[0:1], 80
    s_load_dwordx2 s[6:7], s[0:1], 0
    s_xor_b32 s53, s96, 1
    s_load_dwordx2 s[30:31], s[0:1], 8
    s_load_dwordx2 s[16:17], s[0:1], 72
    s_load_dwordx2 s[18:19], s[0:1], 16
    v_lshrrev_b32 v1, 6, v0
    v_and_b32 v2, 63, v0
    s_and_b32 s40, s2, 1
    s_lshl_b32 s40, s40, 3
    s_bfe_u32 s41, s2, 0x30003
    s_add_u32 s25, s40, s41
    s_bfe_u32 s40, s2, 0x20001
    s_lshl_b32 s40, s40, 2
    s_lshr_b32 s42, s2, 6
    s_add_u32 s24, s40, s42
    s_add_u32 s27, s41, s42
    s_add_u32 s52, s24, s25
    s_and_b32 s52, s52, 15
    s_and_b32 s26, s52, 12
    s_mul_i32 s26, s26, s53
    v_readfirstlane_b32 s28, v1
    v_lshrrev_b32 v5, 4, v2
    v_bfe_u32 v6, v2, 2, 2
    v_and_b32 v7, 3, v2
    v_and_b32 v8, 15, v2
    s_cmp_lt_u32 s28, 4
    s_cbranch_scc1 g1_compute
    s_sub_u32 s28, s28, 4
    s_mov_b32 s40, 2048
    v_lshrrev_b32 v3, 3, v2
    v_mul_lo_u32 v3, v3, s40
    v_lshrrev_b32 v4, 4, v2
    v_xor_b32 v4, v4, v2
    v_and_b32 v4, 7, v4
    v_lshl_add_u32 v3, v4, 4, v3
    s_mul_i32 s41, s25, 262144
    s_mul_i32 s42, s28, 65536
    s_add_u32 s41, s41, s42
    v_xor_b32 v4, 64, v3
    s_add_u32 s42, s41, 0
    v_add_u32 v16, s42, v3
    s_add_u32 s42, s41, 16384
    v_add_u32 v17, s42, v4
    s_add_u32 s42, s41, 32768
    v_add_u32 v18, s42, v3
    s_add_u32 s42, s41, 49152
    v_add_u32 v19, s42, v4
    s_mov_b32 s40, 6144
    v_lshrrev_b32 v3, 3, v2
    v_mul_lo_u32 v3, v3, s40
    v_bfe_u32 v4, v2, 4, 1
    v_lshlrev_b32 v4, 1, v4
    v_xor_b32 v4, v4, v2
    v_and_b32 v4, 7, v4
    v_lshl_add_u32 v3, v4, 4, v3
    s_mul_i32 s41, s24, 128
    s_mul_i32 s42, s28, 98304
    s_add_u32 s41, s41, s42
    v_xor_b32 v4, 64, v3
    s_add_u32 s42, s41, 0
    v_add_u32 v10, s42, v3
    s_add_u32 s42, s41, 49152
    v_add_u32 v11, s42, v4
    s_mov_b32 s40, 6144
    v_lshrrev_b32 v3, 3, v2
    v_mul_lo_u32 v3, v3, s40
    v_bfe_u32 v4, v2, 4, 1
    v_lshlrev_b32 v4, 1, v4
    v_xor_b32 v4, v4, v2
    v_and_b32 v4, 7, v4
    v_lshl_add_u32 v3, v4, 4, v3
    s_mul_i32 s41, s24, 128
    s_mul_i32 s42, s28, 98304
    s_add_u32 s41, s41, s42
    v_xor_b32 v4, 64, v3
    s_add_u32 s42, s41, 2048
    v_add_u32 v12, s42, v3
    s_add_u32 s42, s41, 51200
    v_add_u32 v13, s42, v4
    s_mov_b32 s40, 6144
    v_lshrrev_b32 v3, 3, v2
    v_mul_lo_u32 v3, v3, s40
    v_bfe_u32 v4, v2, 4, 1
    v_lshlrev_b32 v4, 1, v4
    v_xor_b32 v4, v4, v2
    v_and_b32 v4, 7, v4
    v_lshl_add_u32 v3, v4, 4, v3
    s_mul_i32 s41, s24, 128
    s_mul_i32 s42, s28, 98304
    s_add_u32 s41, s41, s42
    v_xor_b32 v4, 64, v3
    s_add_u32 s42, s41, 4096
    v_add_u32 v14, s42, v3
    s_add_u32 s42, s41, 53248
    v_add_u32 v15, s42, v4
    v_lshrrev_b32 v3, 3, v2
    s_lshl_b32 s40, s28, 2
    v_add_u32 v3, s40, v3
    v_lshrrev_b32 v4, 1, v3
    v_xor_b32 v4, v4, v2
    v_and_b32 v4, 7, v4
    s_lshl_b32 s40, s25, 7
    s_sub_u32 s40, s40, 16
    v_add_u32 v3, s40, v3
    v_max_i32 v3, 0, v3
    v_lshlrev_b32 v3, 11, v3
    v_lshl_add_u32 v20, v4, 4, v3
    s_mul_i32 s36, s28, 2048
    s_mul_i32 s37, s28, 4096
    s_add_u32 s37, s37, 26624
    s_mul_i32 s46, s28, 512
    s_add_u32 s46, s46, 24576
    s_waitcnt lgkmcnt(0)
    s_mov_b32 s8, s30
    s_mov_b32 s9, s31
    s_mov_b32 s10, 0x600000
    s_mov_b32 s11, 0x20000
    s_add_u32 s56, s4, 0x100000
    s_addc_u32 s57, s5, 0
    s_mov_b32 s58, 0x30000
    s_mov_b32 s59, 0x20000
    s_add_u32 s4, s4, s97
    s_addc_u32 s5, s5, 0
    s_add_u32 s12, s4, 0x1900000
    s_addc_u32 s13, s5, 0
    s_cmp_eq_u32 s96, 1
    s_cselect_b32 s12, s12, s6
    s_cselect_b32 s13, s13, s7
    s_mov_b32 s14, 0x400000
    s_mov_b32 s15, 0x20000
    s_mov_b32 s20, s4
    s_mov_b32 s21, s5
    s_mov_b32 s22, 0x40000
    s_mov_b32 s23, 0x20000
    s_mov_b32 s60, s16
    s_mov_b32 s61, s17
    s_mov_b32 s62, 0x100
    s_mov_b32 s63, 0x20000
    s_sub_u32 s40, s52, s27
    s_and_b32 s40, s40, 1
    s_and_b32 s41, s52, 2
    s_or_b32 s40, s40, s41
    s_add_u32 s54, s40, 2
    s_cmp_eq_u32 s53, 0
    s_cselect_b32 s54, 0x7fff, s54
    s_add_u32 s55, s54, 3
    s_cmp_lg_u32 s28, 0
    s_cselect_b32 s55, 0x7fff, s55
    s_cmp_lt_u32 s55, 0x7fff
    s_cselect_b32 s29, 12, 0x7fff
    s_add_u32 s50, s29, 1
    s_mov_b32 s51, 14
    s_mov_b32 s32, 0
    s_mov_b32 s33, 0
g1_ld_pW:
    s_add_u32 s40, s32, s27
    s_and_b32 s40, s40, 1
    s_andn2_b32 s41, s32, 1
    s_or_b32 s40, s40, s41
    s_add_u32 s40, s40, s26
    s_and_b32 s40, s40, 15
    s_mul_i32 s34, s40, 393216
    s_mul_i32 s35, s40, 128
    s_add_u32 s38, s33, s36
    s_add_u32 s39, s33, s37
    s_add_u32 m0, s38, 0
    s_nop 0
    buffer_load_dwordx4 v10, s[8:11], s34 offen lds
    s_add_u32 m0, s38, 1024
    s_nop 0
    buffer_load_dwordx4 v11, s[8:11], s34 offen lds
    s_add_u32 m0, s38, 8192
    s_nop 0
    buffer_load_dwordx4 v12, s[8:11], s34 offen lds
    s_add_u32 m0, s38, 9216
    s_nop 0
    buffer_load_dwordx4 v13, s[8:11], s34 offen lds
    s_add_u32 m0, s38, 16384
    s_nop 0
    buffer_load_dwordx4 v14, s[8:11], s34 offen lds
    s_add_u32 m0, s38, 17408
    s_nop 0
    buffer_load_dwordx4 v15, s[8:11], s34 offen lds
    s_add_u32 s33, s33, 43008
    s_add_u32 s32, s32, 1
    s_cmp_lt_u32 s32, 2
    s_cbranch_scc1 g1_ld_pW
    s_cmp_eq_u32 s96, 0
    s_cbranch_scc1 g1_dep_ok
    s_add_u32 s40, s25, 40
    s_lshl_b32 s40, s40, 8
    s_sub_u32 s42, s40, 256
    s_max_u32 s42, s42, 10240
    s_cmp_lg_u32 s28, 0
    s_cbranch_scc1 g1_dep_set
    s_add_u32 s84, s4, 0x300000
    s_addc_u32 s85, s5, 0
    s_mov_b32 s86, 0x4000
    s_mov_b32 s87, 0x20000
    v_cmp_eq_u32 vcc, 1, v2
    v_mov_b32 v21, s40
    v_mov_b32 v23, s42
    v_cndmask_b32 v21, v21, v23, vcc
    v_mov_b32 v22, 16
    v_mov_b32 v23, 16
    v_cndmask_b32 v22, v22, v23, vcc
    buffer_load_dword v23, v21, s[84:87], 0 offen sc1
g1_dep_set:
    s_lshl_b32 s43, s96, 2
    s_add_u32 s43, s43, 1
    s_mov_b32 s41, 0x800000
    v_mov_b32 v24, 131072
    s_cmp_lg_u32 s28, 0
    s_cbranch_scc1 g1_dep_lds
    s_mov_b32 s41, 0x40000
    s_waitcnt vmcnt(0)
g1_dep:
    v_cmp_lt_u32 vcc, v23, v22
    s_sub_u32 s41, s41, 1
    s_cmp_eq_u32 s41, 0
    s_cbranch_scc1 g1_dep_seen
    s_cbranch_vccz g1_dep_seen
    s_sleep 2
    buffer_load_dword v23, v21, s[84:87], 0 offen sc1
    s_waitcnt vmcnt(0)
    s_branch g1_dep
g1_dep_seen:
    v_mov_b32 v23, s43
    ds_write_b32 v24, v23
    s_branch g1_dep_ok
g1_dep_lds:
    ds_read_b32 v23, v24
    s_sub_u32 s41, s41, 1
    s_waitcnt lgkmcnt(0)
    v_readfirstlane_b32 s40, v23
    s_cmp_eq_u32 s41, 0
    s_cbranch_scc1 g1_dep_ok
    s_cmp_eq_u32 s40, s43
    s_cbranch_scc1 g1_dep_ok
    s_sleep 1
    s_branch g1_dep_lds
g1_dep_ok:
    s_mov_b32 s32, 0
    s_mov_b32 s33, 0
g1_ld_pA:
    s_add_u32 s40, s32, s27
    s_and_b32 s40, s40, 1
    s_andn2_b32 s41, s32, 1
    s_or_b32 s40, s40, s41
    s_add_u32 s40, s40, s26
    s_and_b32 s40, s40, 15
    s_mul_i32 s34, s40, 393216
    s_mul_i32 s35, s40, 128
    s_add_u32 s38, s33, s36
    s_add_u32 s39, s33, s37
    s_add_u32 m0, s39, 0
    s_nop 0
    buffer_load_dwordx4 v16, s[12:15], s35 offen sc1 lds
    s_add_u32 m0, s39, 1024
    s_nop 0
    buffer_load_dwordx4 v17, s[12:15], s35 offen sc1 lds
    s_add_u32 m0, s39, 2048
    s_nop 0
    buffer_load_dwordx4 v18, s[12:15], s35 offen sc1 lds
    s_add_u32 m0, s39, 3072
    s_nop 0
    buffer_load_dwordx4 v19, s[12:15], s35 offen sc1 lds
    s_add_u32 m0, s33, s46
    s_mov_b32 exec_hi, 0
    buffer_load_dwordx4 v20, s[12:15], s35 offen sc1 lds
    s_mov_b32 exec_hi, -1
    s_add_u32 s33, s33, 43008
    s_add_u32 s32, s32, 1
    s_cmp_lt_u32 s32, 2
    s_cbranch_scc1 g1_ld_pA
    s_waitcnt vmcnt(5)
    s_branch g1_ld_bar
g1_ld_loop:
    s_sub_u32 s40, s32, s54
    s_sub_u32 s40, s40, 1
    s_cmp_lt_u32 s40, 2
    s_cbranch_scc1 g1_ld_w0
    s_sub_u32 s40, s32, s55
    s_sub_u32 s40, s40, 1
    s_cmp_lt_u32 s40, 2
    s_cbranch_scc1 g1_ld_w1
    s_sub_u32 s40, s32, s29
    s_sub_u32 s40, s40, 1
    s_cmp_lt_u32 s40, 2
    s_cbranch_scc1 g1_ld_w2
    s_sub_u32 s40, s32, s51
    s_sub_u32 s40, s40, 1
    s_cmp_lt_u32 s40, 2
    s_cbranch_scc1 g1_ld_w4
    s_waitcnt vmcnt(11)
g1_ld_bar:
    s_barrier
    s_add_u32 s40, s32, s27
    s_and_b32 s40, s40, 1
    s_andn2_b32 s41, s32, 1
    s_or_b32 s40, s40, s41
    s_add_u32 s40, s40, s26
    s_and_b32 s40, s40, 15
    s_mul_i32 s34, s40, 393216
    s_mul_i32 s35, s40, 128
    s_add_u32 s38, s33, s36
    s_add_u32 s39, s33, s37
    s_add_u32 m0, s39, 0
    s_nop 0
    buffer_load_dwordx4 v16, s[12:15], s35 offen sc1 lds
    s_add_u32 m0, s39, 1024
    s_nop 0
    buffer_load_dwordx4 v17, s[12:15], s35 offen sc1 lds
    s_add_u32 m0, s39, 2048
    s_nop 0
    buffer_load_dwordx4 v18, s[12:15], s35 offen sc1 lds
    s_add_u32 m0, s39, 3072
    s_nop 0
    buffer_load_dwordx4 v19, s[12:15], s35 offen sc1 lds
    s_add_u32 m0, s38, 0
    s_nop 0
    buffer_load_dwordx4 v10, s[8:11], s34 offen lds
    s_add_u32 m0, s38, 1024
    s_nop 0
    buffer_load_dwordx4 v11, s[8:11], s34 offen lds
    s_add_u32 m0, s38, 8192
    s_nop 0
    buffer_load_dwordx4 v12, s[8:11], s34 offen lds
    s_add_u32 m0, s38, 9216
    s_nop 0
    buffer_load_dwordx4 v13, s[8:11], s34 offen lds
    s_add_u32 m0, s38, 16384
    s_nop 0
    buffer_load_dwordx4 v14, s[8:11], s34 offen lds
    s_add_u32 m0, s38, 17408
    s_nop 0
    buffer_load_dwordx4 v15, s[8:11], s34 offen lds
    s_add_u32 m0, s33, s46
    s_mov_b32 exec_hi, 0
    buffer_load_dwordx4 v20, s[12:15], s35 offen sc1 lds
    s_mov_b32 exec_hi, -1
    s_cmp_eq_u32 s32, s54
    s_cbranch_scc1 g1_ld_h0
g1_ld_c0:
    s_cmp_eq_u32 s32, s55
    s_cbranch_scc1 g1_ld_h1
g1_ld_c1:
    s_cmp_eq_u32 s32, s29
    s_cbranch_scc1 g1_ld_h2
g1_ld_c2:
    s_cmp_eq_u32 s32, s50
    s_cbranch_scc1 g1_ld_h3
g1_ld_c3:
    s_cmp_eq_u32 s32, s51
    s_cbranch_scc1 g1_ld_h4
g1_ld_c4:
    s_add_u32 s33, s33, 43008
    s_add_u32 s32, s32, 1
    s_cmp_eq_u32 s33, 129024
    s_cselect_b32 s33, 0, s33
    s_cmp_lt_u32 s32, 16
    s_cbranch_scc1 g1_ld_loop
    s_waitcnt vmcnt(43)
    s_barrier
    s_waitcnt vmcnt(0)
    v_pk_add_f32 v[24:25], v[24:25], v[40:41]
    v_add_f32 v56, v56, v64
    v_pk_add_f32 v[26:27], v[26:27], v[42:43]
    v_add_f32 v57, v57, v65
    v_pk_add_f32 v[28:29], v[28:29], v[44:45]
    v_add_f32 v58, v58, v66
    v_pk_add_f32 v[30:31], v[30:31], v[46:47]
    v_add_f32 v59, v59, v67
    v_pk_add_f32 v[32:33], v[32:33], v[48:49]
    v_add_f32 v60, v60, v68
    v_pk_add_f32 v[34:35], v[34:35], v[50:51]
    v_add_f32 v61, v61, v69
    v_pk_add_f32 v[36:37], v[36:37], v[52:53]
    v_add_f32 v62, v62, v70
    v_pk_add_f32 v[38:39], v[38:39], v[54:55]
    v_add_f32 v63, v63, v71
    v_pk_add_f32 v[24:25], v[24:25], v[32:33]
    v_add_f32 v56, v56, v60
    v_pk_add_f32 v[26:27], v[26:27], v[34:35]
    v_add_f32 v57, v57, v61
    v_pk_add_f32 v[28:29], v[28:29], v[36:37]
    v_add_f32 v58, v58, v62
    v_pk_add_f32 v[30:31], v[30:31], v[38:39]
    v_add_f32 v59, v59, v63
    v_pk_add_f32 v[24:25], v[24:25], v[28:29]
    v_add_f32 v56, v56, v58
    v_pk_add_f32 v[26:27], v[26:27], v[30:31]
    v_add_f32 v57, v57, v59
    v_pk_add_f32 v[24:25], v[24:25], v[26:27]
    v_add_f32 v56, v56, v57
    v_mul_f32 v24, 0x3a800000, v24
    v_mul_f32 v25, 0x3a800000, v25
    v_fma_f32 v25, -v24, v24, v25
    v_max_f32 v25, 0, v25
    v_cvt_pk_bf16_f32 v24, v24, v24
    v_lshlrev_b32 v24, 16, v24
    v_cvt_pk_bf16_f32 v25, v25, v25
    v_lshlrev_b32 v25, 16, v25
    v_add_f32 v25, 0x3727c5ac, v25
    v_cvt_pk_bf16_f32 v25, v25, v25
    v_lshlrev_b32 v25, 16, v25
    v_sqrt_f32 v25, v25
    s_nop 0
    v_cvt_pk_bf16_f32 v25, v25, v25
    v_lshlrev_b32 v25, 16, v25
    v_rcp_f32 v26, v25
    v_lshlrev_b32 v3, 3, v21
    v_lshlrev_b32 v4, 2, v21
    v_mul_f32 v27, -v24, v26
    v_cmp_gt_u32 vcc, 144, v21
    s_and_saveexec_b64 s[40:41], vcc
    v_add_u32 v3, 129024, v3
    ds_write_b64 v3, v[26:27]
    s_mov_b64 exec, s[40:41]
    v_cmp_gt_u32 vcc, 192, v21
    s_and_saveexec_b64 s[40:41], vcc
    v_add_u32 v4, 130304, v4
    ds_write_b32 v4, v56
    s_mov_b64 exec, s[40:41]
    s_waitcnt lgkmcnt(0)
    s_barrier
    s_add_u32 s20, s4, 0x200000
    s_addc_u32 s21, s5, 0
    s_mov_b32 s22, 0x40000
    s_mov_b32 s23, 0x20000
    s_lshl_b32 s40, s24, 4
    s_add_u32 s40, s40, s25
    s_lshl_b32 s40, s40, 10
    s_lshl_b32 s41, s28, 8
    s_add_u32 s40, s40, s41
    v_lshlrev_b32 v3, 2, v2
    v_mov_b32 v4, -1
    buffer_store_dword v4, v3, s[20:23], s40 offen sc1
    s_cmp_eq_u32 s53, 0
    s_cbranch_scc1 g1_nopf
    s_mov_b32 s20, s18
    s_mov_b32 s21, s19
    s_mov_b32 s22, 0x200000
    s_mov_b32 s23, 0x20000
    s_lshl_b32 s40, s2, 13
    s_lshl_b32 s41, s28, 11
    s_add_u32 s40, s40, s41
    v_lshlrev_b32 v3, 4, v2
    buffer_load_dwordx4 v[120:123], v3, s[20:23], s40 offen
    buffer_load_dwordx4 v[120:123], v3, s[20:23], s40 offen offset:1024
g1_nopf:
    s_branch g1_ld_end
g1_ld_w0:
    s_waitcnt vmcnt(16)
    s_branch g1_ld_bar
g1_ld_h0:
    s_add_u32 s44, s33, 43008
    s_cmp_eq_u32 s44, 129024
    s_cselect_b32 s44, 0, s44
    s_mul_i32 s42, s28, 3
    s_add_u32 s42, s42, 0
    s_lshr_b32 s43, s42, 2
    s_lshl_b32 s43, s43, 13
    s_add_u32 s43, s43, s44
    s_and_b32 s42, s42, 3
    v_and_b32 v3, 1, v5
    v_lshlrev_b32 v3, 1, v3
    v_lshrrev_b32 v4, 1, v6
    v_or_b32 v3, v3, v4
    s_add_u32 s40, s42, 0
    v_xor_b32 v3, s40, v3
    v_lshlrev_b32 v3, 5, v3
    v_lshl_add_u32 v3, v7, 3, v3
    v_lshl_add_u32 v4, v5, 3, v6
    v_lshl_add_u32 v3, v4, 7, v3
    v_add_u32 v21, s43, v3
    ds_read_b64_tr_b16 v[24:25], v21 offset:0
    ds_read_b64_tr_b16 v[26:27], v21 offset:512
    ds_read_b64_tr_b16 v[28:29], v21 offset:4096
    ds_read_b64_tr_b16 v[30:31], v21 offset:4608
    s_mul_i32 s42, s28, 3
    s_add_u32 s42, s42, 1
    s_lshr_b32 s43, s42, 2
    s_lshl_b32 s43, s43, 13
    s_add_u32 s43, s43, s44
    s_and_b32 s42, s42, 3
    v_and_b32 v3, 1, v5
    v_lshlrev_b32 v3, 1, v3
    v_lshrrev_b32 v4, 1, v6
    v_or_b32 v3, v3, v4
    s_add_u32 s40, s42, 0
    v_xor_b32 v3, s40, v3
    v_lshlrev_b32 v3, 5, v3
    v_lshl_add_u32 v3, v7, 3, v3
    v_lshl_add_u32 v4, v5, 3, v6
    v_lshl_add_u32 v3, v4, 7, v3
    v_add_u32 v21, s43, v3
    ds_read_b64_tr_b16 v[32:33], v21 offset:0
    ds_read_b64_tr_b16 v[34:35], v21 offset:512
    ds_read_b64_tr_b16 v[36:37], v21 offset:4096
    ds_read_b64_tr_b16 v[38:39], v21 offset:4608
    s_mul_i32 s42, s28, 3
    s_add_u32 s42, s42, 2
    s_lshr_b32 s43, s42, 2
    s_lshl_b32 s43, s43, 13
    s_add_u32 s43, s43, s44
    s_and_b32 s42, s42, 3
    v_and_b32 v3, 1, v5
    v_lshlrev_b32 v3, 1, v3
    v_lshrrev_b32 v4, 1, v6
    v_or_b32 v3, v3, v4
    s_add_u32 s40, s42, 0
    v_xor_b32 v3, s40, v3
    v_lshlrev_b32 v3, 5, v3
    v_lshl_add_u32 v3, v7, 3, v3
    v_lshl_add_u32 v4, v5, 3, v6
    v_lshl_add_u32 v3, v4, 7, v3
    v_add_u32 v21, s43, v3
    ds_read_b64_tr_b16 v[40:41], v21 offset:0
    ds_read_b64_tr_b16 v[42:43], v21 offset:512
    ds_read_b64_tr_b16 v[44:45], v21 offset:4096
    ds_read_b64_tr_b16 v[46:47], v21 offset:4608
    s_lshr_b32 s42, s44, 7
    s_lshl_b32 s43, s28, 5
    s_add_u32 s42, s42, s43
    s_add_u32 s42, s42, 16
    v_lshrrev_b32 v3, 1, v8
    v_xor_b32 v3, v3, v5
    v_lshlrev_b32 v3, 4, v3
    v_lshl_add_u32 v3, v8, 7, v3
    s_lshl_b32 s40, s42, 7
    s_add_u32 s40, s40, 24576
    v_add_u32 v22, s40, v3
    v_xor_b32 v23, 64, v22
    ds_read_b128 v[48:51], v22 offset:0
    ds_read_b128 v[52:55], v23 offset:0
    ds_read_b128 v[56:59], v22 offset:2048
    ds_read_b128 v[60:63], v23 offset:2048
    v_mov_b32 v64, 0x3f803f80
    v_mov_b32 v65, 0x3f803f80
    v_mov_b32 v66, 0x3f803f80
    v_mov_b32 v67, 0x3f803f80
    s_mul_i32 s42, s52, 12288
    s_lshl_b32 s43, s24, 8
    s_add_u32 s42, s42, s43
    v_lshl_add_u32 v21, v5, 4, s42
    s_lshl_b32 s42, s52, 14
    s_lshl_b32 s43, s25, 10
    s_add_u32 s42, s42, s43
    s_lshl_b32 s43, s28, 8
    s_add_u32 s42, s42, s43
    v_lshl_add_u32 v22, v8, 3, s42
    s_waitcnt lgkmcnt(0)
    v_mfma_f32_16x16x32_bf16 v[68:71], v[24:27], v[64:67], 0
    v_mfma_f32_16x16x32_bf16 v[72:75], v[32:35], v[64:67], 0
    v_mfma_f32_16x16x32_bf16 v[76:79], v[40:43], v[64:67], 0
    v_mfma_f32_16x16x32_bf16 v[80:83], v[64:67], v[48:51], 0
    v_mfma_f32_16x16x32_bf16 v[84:87], v[48:51], v[48:51], 0
    v_mfma_f32_16x16x32_bf16 v[88:91], v[64:67], v[56:59], 0
    v_mfma_f32_16x16x32_bf16 v[92:95], v[56:59], v[56:59], 0
    v_mfma_f32_16x16x32_bf16 v[68:71], v[28:31], v[64:67], v[68:71]
    v_mfma_f32_16x16x32_bf16 v[72:75], v[36:39], v[64:67], v[72:75]
    v_mfma_f32_16x16x32_bf16 v[76:79], v[44:47], v[64:67], v[76:79]
    v_mfma_f32_16x16x32_bf16 v[80:83], v[64:67], v[52:55], v[80:83]
    v_mfma_f32_16x16x32_bf16 v[84:87], v[52:55], v[52:55], v[84:87]
    v_mfma_f32_16x16x32_bf16 v[88:91], v[64:67], v[60:63], v[88:91]
    v_mfma_f32_16x16x32_bf16 v[92:95], v[60:63], v[60:63], v[92:95]
    v_cmp_eq_u32 s[40:41], 1, v7
    v_cmp_eq_u32 s[42:43], 2, v7
    v_cmp_eq_u32 vcc, 3, v7
    s_nop 7
    v_cndmask_b32 v81, v84, v85, s[40:41]
    v_cndmask_b32 v81, v81, v86, s[42:43]
    v_cndmask_b32 v81, v81, v87, vcc
    v_cndmask_b32 v89, v92, v93, s[40:41]
    v_cndmask_b32 v89, v89, v94, s[42:43]
    v_cndmask_b32 v89, v89, v95, vcc
    s_mov_b32 exec_lo, 0x00f0000f
    s_mov_b32 exec_hi, 0xf0000f00
    buffer_store_dwordx2 v[80:81], v22, s[20:23], 0 offen offset:0 sc1
    buffer_store_dwordx2 v[88:89], v22, s[20:23], 0 offen offset:128 sc1
    s_mov_b32 exec_lo, 0x00010001
    s_mov_b32 exec_hi, 0x00010001
    s_mul_i32 s42, s28, 3
    s_add_u32 s42, s42, 0
    s_lshr_b32 s43, s42, 2
    s_lshl_b32 s43, s43, 12
    s_and_b32 s42, s42, 3
    s_lshl_b32 s42, s42, 6
    s_add_u32 s42, s42, s43
    buffer_store_dwordx4 v[68:71], v21, s[56:59], s42 offen sc1
    s_mul_i32 s42, s28, 3
    s_add_u32 s42, s42, 1
    s_lshr_b32 s43, s42, 2
    s_lshl_b32 s43, s43, 12
    s_and_b32 s42, s42, 3
    s_lshl_b32 s42, s42, 6
    s_add_u32 s42, s42, s43
    buffer_store_dwordx4 v[72:75], v21, s[56:59], s42 offen sc1
    s_mul_i32 s42, s28, 3
    s_add_u32 s42, s42, 2
    s_lshr_b32 s43, s42, 2
    s_lshl_b32 s43, s43, 12
    s_and_b32 s42, s42, 3
    s_lshl_b32 s42, s42, 6
    s_add_u32 s42, s42, s43
    buffer_store_dwordx4 v[76:79], v21, s[56:59], s42 offen sc1
    s_mov_b64 exec, -1
    s_or_b32 s40, s24, s25
    s_or_b32 s40, s40, s28
    s_cmp_lg_u32 s40, 0
    s_cbranch_scc1 g1_nocr
    v_lshlrev_b32 v21, 8, v2
    v_mov_b32 v22, 0
    s_add_u32 s84, s4, 0x300000
    s_addc_u32 s85, s5, 0
    s_mov_b32 s86, 0x4000
    s_mov_b32 s87, 0x20000
    buffer_store_dword v22, v21, s[84:87], 0 offen sc1
    s_add_u32 s84, s4, 0x2b00000
    s_addc_u32 s85, s5, 0
    s_mov_b32 s86, 0x4000
    s_mov_b32 s87, 0x20000
    buffer_store_dword v22, v21, s[84:87], 0 offen sc1
g1_nocr:
    s_branch g1_ld_c0
g1_ld_w1:
    s_waitcnt vmcnt(12)
    s_branch g1_ld_bar
g1_ld_h1:
    v_mov_b32 v21, 0
    v_mov_b32 v22, 1
    s_mov_b64 exec, 1
    buffer_atomic_add v22, v21, s[60:63], 0 offen sc1
    s_mov_b64 exec, -1
    s_branch g1_ld_c1
g1_ld_w2:
    s_waitcnt vmcnt(12)
    s_branch g1_ld_bar
g1_ld_h2:
    v_mov_b32 v21, 0
    buffer_load_dword v23, v21, s[60:63], 0 offen sc1
    s_branch g1_ld_c2
g1_ld_h3:
    s_mov_b32 s41, 0x40000
    v_mov_b32 v21, 0
    s_waitcnt vmcnt(11)
g1_poll:
    v_readfirstlane_b32 s40, v23
    s_sub_u32 s41, s41, 1
    s_cmp_eq_u32 s41, 0
    s_cbranch_scc1 g1_polled
    s_cmp_ge_u32 s40, 256
    s_cbranch_scc1 g1_polled
    s_sleep 8
    buffer_load_dword v23, v21, s[60:63], 0 offen sc1
    s_waitcnt vmcnt(0)
    s_branch g1_poll
g1_polled:
    s_branch g1_ld_c3
g1_ld_w4:
    s_waitcnt vmcnt(43)
    s_branch g1_ld_bar
g1_ld_h4:
    s_lshl_b32 s40, s28, 6
    v_add_u32 v21, s40, v2
    s_lshl_b32 s41, s25, 7
    s_sub_u32 s41, s41, 16
    v_add_u32 v3, s41, v21
    v_max_i32 v3, 0, v3
    v_min_u32 v3, 2047, v3
    v_lshlrev_b32 v3, 3, v3
    s_min_u32 s40, s28, 2
    s_lshl_b32 s40, s40, 12
    s_lshl_b32 s41, s24, 8
    s_add_u32 s40, s40, s41
    v_lshl_add_u32 v4, v2, 2, s40
    s_mov_b32 s40, 0
    buffer_load_dwordx2 v[24:25], v3, s[20:23], s40 offen sc1
    s_mov_b32 s41, 0
    buffer_load_dword v56, v4, s[56:59], s41 offen sc1
    s_mov_b32 s40, 16384
    buffer_load_dwordx2 v[26:27], v3, s[20:23], s40 offen sc1
    s_mov_b32 s41, 12288
    buffer_load_dword v57, v4, s[56:59], s41 offen sc1
    s_mov_b32 s40, 32768
    buffer_load_dwordx2 v[28:29], v3, s[20:23], s40 offen sc1
    s_mov_b32 s41, 24576
    buffer_load_dword v58, v4, s[56:59], s41 offen sc1
    s_mov_b32 s40, 49152
    buffer_load_dwordx2 v[30:31], v3, s[20:23], s40 offen sc1
    s_mov_b32 s41, 36864
    buffer_load_dword v59, v4, s[56:59], s41 offen sc1
    s_mov_b32 s40, 65536
    buffer_load_dwordx2 v[32:33], v3, s[20:23], s40 offen sc1
    s_mov_b32 s41, 49152
    buffer_load_dword v60, v4, s[56:59], s41 offen sc1
    s_mov_b32 s40, 81920
    buffer_load_dwordx2 v[34:35], v3, s[20:23], s40 offen sc1
    s_mov_b32 s41, 61440
    buffer_load_dword v61, v4, s[56:59], s41 offen sc1
    s_mov_b32 s40, 98304
    buffer_load_dwordx2 v[36:37], v3, s[20:23], s40 offen sc1
    s_mov_b32 s41, 73728
    buffer_load_dword v62, v4, s[56:59], s41 offen sc1
    s_mov_b32 s40, 114688
    buffer_load_dwordx2 v[38:39], v3, s[20:23], s40 offen sc1
    s_mov_b32 s41, 86016
    buffer_load_dword v63, v4, s[56:59], s41 offen sc1
    s_mov_b32 s40, 131072
    buffer_load_dwordx2 v[40:41], v3, s[20:23], s40 offen sc1
    s_mov_b32 s41, 98304
    buffer_load_dword v64, v4, s[56:59], s41 offen sc1
    s_mov_b32 s40, 147456
    buffer_load_dwordx2 v[42:43], v3, s[20:23], s40 offen sc1
    s_mov_b32 s41, 110592
    buffer_load_dword v65, v4, s[56:59], s41 offen sc1
    s_mov_b32 s40, 163840
    buffer_load_dwordx2 v[44:45], v3, s[20:23], s40 offen sc1
    s_mov_b32 s41, 122880
    buffer_load_dword v66, v4, s[56:59], s41 offen sc1
    s_mov_b32 s40, 180224
    buffer_load_dwordx2 v[46:47], v3, s[20:23], s40 offen sc1
    s_mov_b32 s41, 135168
    buffer_load_dword v67, v4, s[56:59], s41 offen sc1
    s_mov_b32 s40, 196608
    buffer_load_dwordx2 v[48:49], v3, s[20:23], s40 offen sc1
    s_mov_b32 s41, 147456
    buffer_load_dword v68, v4, s[56:59], s41 offen sc1
    s_mov_b32 s40, 212992
    buffer_load_dwordx2 v[50:51], v3, s[20:23], s40 offen sc1
    s_mov_b32 s41, 159744
    buffer_load_dword v69, v4, s[56:59], s41 offen sc1
    s_mov_b32 s40, 229376
    buffer_load_dwordx2 v[52:53], v3, s[20:23], s40 offen sc1
    s_mov_b32 s41, 172032
    buffer_load_dword v70, v4, s[56:59], s41 offen sc1
    s_mov_b32 s40, 245760
    buffer_load_dwordx2 v[54:55], v3, s[20:23], s40 offen sc1
    s_mov_b32 s41, 184320
    buffer_load_dword v71, v4, s[56:59], s41 offen sc1
    s_branch g1_ld_c4
g1_ld_end:
    s_add_u32 s28, s28, 4
    s_add_u32 s16, s4, 0x400000
    s_addc_u32 s17, s5, 0
    s_mov_b32 s18, 0x400000
    s_mov_b32 s19, 0x20000
    s_and_b32 s44, s28, 1
    s_lshr_b32 s45, s28, 1
    s_lshl_b32 s40, s44, 2
    v_add_u32 v3, s40, v5
    v_and_b32 v4, 7, v8
    v_xor_b32 v3, v3, v4
    v_lshlrev_b32 v3, 4, v3
    v_lshl_add_u32 v3, v8, 8, v3
    s_mul_i32 s41, s45, 4096
    s_add_u32 s41, s41, 43008
    v_add_u32 v226, s41, v3
    v_lshl_add_u32 v3, v5, 2, v6
    v_and_b32 v4, 7, v3
    v_add_u32 v228, s40, v7
    v_xor_b32 v4, v4, v228
    v_lshlrev_b32 v4, 4, v4
    v_lshl_add_u32 v3, v3, 8, v4
    s_add_u32 s41, s41, 36864
    v_add_u32 v227, s41, v3
    v_and_b32 v3, 7, v8
    v_add_u32 v4, 1, v3
    s_or_b32 s40, s25, s45
    s_cmp_eq_u32 s40, 0
    s_cselect_b32 s40, 8, 0
    v_cmp_gt_u32 vcc, 8, v8
    v_mov_b32 v21, s40
    s_mov_b64 s[56:57], vcc
    v_cndmask_b32 v21, 0, v21, vcc
    v_max_u32 v4, v4, v21
    v_add_u32 v3, 8, v3
    v_sub_u32 v3, v3, v4
    v_lshlrev_b32 v21, 2, v5
    v_sub_u32 v21, v21, v4
    v_mov_b32 v22, 0xf149f2ca
    v_add_u32 v23, 0, v21
    v_cmp_ge_u32 vcc, v3, v23
    s_nop 1
    v_cndmask_b32 v228, v22, 0, vcc
    v_add_u32 v23, 1, v21
    v_cmp_ge_u32 vcc, v3, v23
    s_nop 1
    v_cndmask_b32 v229, v22, 0, vcc
    v_add_u32 v23, 2, v21
    v_cmp_ge_u32 vcc, v3, v23
    s_nop 1
    v_cndmask_b32 v230, v22, 0, vcc
    v_add_u32 v23, 3, v21
    v_cmp_ge_u32 vcc, v3, v23
    s_nop 1
    v_cndmask_b32 v231, v22, 0, vcc
    s_lshl_b32 s40, s25, 7
    s_lshl_b32 s41, s45, 5
    s_add_u32 s40, s40, s41
    s_lshl_b32 s40, s40, 11
    s_lshl_b32 s41, s24, 7
    s_add_u32 s40, s40, s41
    s_lshl_b32 s41, s44, 6
    s_add_u32 s40, s40, s41
    v_lshlrev_b32 v225, 12, v8
    v_lshl_add_u32 v225, v5, 4, v225
    v_add_u32 v225, s40, v225
    s_mov_b32 s58, 0x3e3504f3
    s_mov_b32 s59, 0x3fb8aa3b
    s_branch g1_attn
g1_compute:
    s_and_b32 s44, s28, 1
    s_lshr_b32 s45, s28, 1
    s_lshl_b32 s42, s44, 1
    s_mov_b32 s43, 0
    v_and_b32 v3, 1, v5
    v_lshlrev_b32 v3, 1, v3
    v_lshrrev_b32 v4, 1, v6
    v_or_b32 v3, v3, v4
    s_add_u32 s40, s42, 0
    v_xor_b32 v3, s40, v3
    v_lshlrev_b32 v3, 5, v3
    v_lshl_add_u32 v3, v7, 3, v3
    v_lshl_add_u32 v4, v5, 3, v6
    v_lshl_add_u32 v3, v4, 7, v3
    v_add_u32 v10, s43, v3
    v_and_b32 v3, 1, v5
    v_lshlrev_b32 v3, 1, v3
    v_lshrrev_b32 v4, 1, v6
    v_or_b32 v3, v3, v4
    s_add_u32 s40, s42, 1
    v_xor_b32 v3, s40, v3
    v_lshlrev_b32 v3, 5, v3
    v_lshl_add_u32 v3, v7, 3, v3
    v_lshl_add_u32 v4, v5, 3, v6
    v_lshl_add_u32 v3, v4, 7, v3
    v_add_u32 v11, s43, v3
    s_xor_b32 s43, s45, 1
    s_add_u32 s43, s43, 1
    s_mul_i32 s43, s43, 8192
    v_and_b32 v3, 1, v5
    v_lshlrev_b32 v3, 1, v3
    v_lshrrev_b32 v4, 1, v6
    v_or_b32 v3, v3, v4
    s_add_u32 s40, s42, 0
    v_xor_b32 v3, s40, v3
    v_lshlrev_b32 v3, 5, v3
    v_lshl_add_u32 v3, v7, 3, v3
    v_lshl_add_u32 v4, v5, 3, v6
    v_lshl_add_u32 v3, v4, 7, v3
    v_add_u32 v12, s43, v3
    v_and_b32 v3, 1, v5
    v_lshlrev_b32 v3, 1, v3
    v_lshrrev_b32 v4, 1, v6
    v_or_b32 v3, v3, v4
    s_add_u32 s40, s42, 1
    v_xor_b32 v3, s40, v3
    v_lshlrev_b32 v3, 5, v3
    v_lshl_add_u32 v3, v7, 3, v3
    v_lshl_add_u32 v4, v5, 3, v6
    v_lshl_add_u32 v3, v4, 7, v3
    v_add_u32 v13, s43, v3
    s_xor_b32 s43, s45, 0
    s_add_u32 s43, s43, 1
    s_mul_i32 s43, s43, 8192
    v_and_b32 v3, 1, v5
    v_lshlrev_b32 v3, 1, v3
    v_lshrrev_b32 v4, 1, v6
    v_or_b32 v3, v3, v4
    s_add_u32 s40, s42, 0
    v_xor_b32 v3, s40, v3
    v_lshlrev_b32 v3, 5, v3
    v_lshl_add_u32 v3, v7, 3, v3
    v_lshl_add_u32 v4, v5, 3, v6
    v_lshl_add_u32 v3, v4, 7, v3
    v_add_u32 v14, s43, v3
    v_and_b32 v3, 1, v5
    v_lshlrev_b32 v3, 1, v3
    v_lshrrev_b32 v4, 1, v6
    v_or_b32 v3, v3, v4
    s_add_u32 s40, s42, 1
    v_xor_b32 v3, s40, v3
    v_lshlrev_b32 v3, 5, v3
    v_lshl_add_u32 v3, v7, 3, v3
    v_lshl_add_u32 v4, v5, 3, v6
    v_lshl_add_u32 v3, v4, 7, v3
    v_add_u32 v15, s43, v3
    s_mul_i32 s42, s45, 64
    s_add_u32 s42, s42, 16
    v_lshrrev_b32 v3, 1, v8
    v_xor_b32 v3, v3, v5
    v_lshlrev_b32 v3, 4, v3
    v_lshl_add_u32 v3, v8, 7, v3
    s_lshl_b32 s40, s42, 7
    s_add_u32 s40, s40, 24576
    v_add_u32 v16, s40, v3
    v_xor_b32 v17, 64, v16
    v_lshrrev_b32 v3, 1, v8
    v_xor_b32 v3, v3, v5
    v_lshlrev_b32 v3, 4, v3
    v_lshl_add_u32 v3, v8, 7, v3
    v_add_u32 v18, 24576, v3
    v_xor_b32 v19, 64, v18
    v_mov_b32 v24, 0
    v_mov_b32 v25, 0
    v_mov_b32 v26, 0
    v_mov_b32 v27, 0
    v_mov_b32 v28, 0
    v_mov_b32 v29, 0
    v_mov_b32 v30, 0
    v_mov_b32 v31, 0
    v_mov_b32 v32, 0
    v_mov_b32 v33, 0
    v_mov_b32 v34, 0
    v_mov_b32 v35, 0
    v_mov_b32 v36, 0
    v_mov_b32 v37, 0
    v_mov_b32 v38, 0
    v_mov_b32 v39, 0
    v_mov_b32 v40, 0
    v_mov_b32 v41, 0
    v_mov_b32 v42, 0
    v_mov_b32 v43, 0
    v_mov_b32 v44, 0
    v_mov_b32 v45, 0
    v_mov_b32 v46, 0
    v_mov_b32 v47, 0
    v_mov_b32 v48, 0
    v_mov_b32 v49, 0
    v_mov_b32 v50, 0
    v_mov_b32 v51, 0
    v_mov_b32 v52, 0
    v_mov_b32 v53, 0
    v_mov_b32 v54, 0
    v_mov_b32 v55, 0
    v_mov_b32 v56, 0
    v_mov_b32 v57, 0
    v_mov_b32 v58, 0
    v_mov_b32 v59, 0
    v_mov_b32 v60, 0
    v_mov_b32 v61, 0
    v_mov_b32 v62, 0
    v_mov_b32 v63, 0
    v_mov_b32 v64, 0
    v_mov_b32 v65, 0
    v_mov_b32 v66, 0
    v_mov_b32 v67, 0
    v_mov_b32 v68, 0
    v_mov_b32 v69, 0
    v_mov_b32 v70, 0
    v_mov_b32 v71, 0
    v_mov_b32 v72, 0
    v_mov_b32 v73, 0
    v_mov_b32 v74, 0
    v_mov_b32 v75, 0
    v_mov_b32 v76, 0
    v_mov_b32 v77, 0
    v_mov_b32 v78, 0
    v_mov_b32 v79, 0
    v_mov_b32 v80, 0
    v_mov_b32 v81, 0
    v_mov_b32 v82, 0
    v_mov_b32 v83, 0
    v_mov_b32 v84, 0
    v_mov_b32 v85, 0
    v_mov_b32 v86, 0
    v_mov_b32 v87, 0
    v_mov_b32 v88, 0
    v_mov_b32 v89, 0
    v_mov_b32 v90, 0
    v_mov_b32 v91, 0
    v_mov_b32 v92, 0
    v_mov_b32 v93, 0
    v_mov_b32 v94, 0
    v_mov_b32 v95, 0
    v_mov_b32 v96, 0
    v_mov_b32 v97, 0
    v_mov_b32 v98, 0
    v_mov_b32 v99, 0
    v_mov_b32 v100, 0
    v_mov_b32 v101, 0
    v_mov_b32 v102, 0
    v_mov_b32 v103, 0
    v_mov_b32 v104, 0
    v_mov_b32 v105, 0
    v_mov_b32 v106, 0
    v_mov_b32 v107, 0
    v_mov_b32 v108, 0
    v_mov_b32 v109, 0
    v_mov_b32 v110, 0
    v_mov_b32 v111, 0
    v_mov_b32 v112, 0
    v_mov_b32 v113, 0
    v_mov_b32 v114, 0
    v_mov_b32 v115, 0
    v_mov_b32 v116, 0
    v_mov_b32 v117, 0
    v_mov_b32 v118, 0
    v_mov_b32 v119, 0
    v_mov_b32 v120, 0
    v_mov_b32 v121, 0
    v_mov_b32 v122, 0
    v_mov_b32 v123, 0
    v_mov_b32 v124, 0
    v_mov_b32 v125, 0
    v_mov_b32 v126, 0
    v_mov_b32 v127, 0
    s_mov_b32 s48, 16
    s_mov_b32 s50, 0
    s_mov_b32 s51, 43008
    s_mov_b32 s29, 0xfffeb000
    s_waitcnt lgkmcnt(0)
    s_add_u32 s4, s4, s97
    s_addc_u32 s5, s5, 0
    v_lshlrev_b32 v3, 3, v8
    v_add_u32 v217, 129024, v3
    s_mul_i32 s40, s45, 512
    s_add_u32 s40, s40, 129152
    v_add_u32 v216, s40, v3
    s_lshl_b32 s40, s44, 7
    s_add_u32 s40, s40, 130304
    v_lshl_add_u32 v3, v5, 4, s40
    s_mov_b32 s43, 0
    v_add_u32 v218, s43, v3
    s_xor_b32 s43, s45, 1
    s_add_u32 s43, s43, 1
    s_mul_i32 s43, s43, 256
    v_add_u32 v219, s43, v3
    s_xor_b32 s43, s45, 0
    s_add_u32 s43, s43, 1
    s_mul_i32 s43, s43, 256
    v_add_u32 v220, s43, v3
    v_and_b32 v3, 1, v5
    v_lshlrev_b32 v3, 1, v3
    v_lshrrev_b32 v4, 1, v5
    v_add_u32 v3, v3, v4
    s_lshl_b32 s40, s44, 2
    v_add_u32 v3, s40, v3
    v_lshrrev_b32 v4, 1, v8
    v_xor_b32 v3, v3, v4
    v_lshlrev_b32 v3, 4, v3
    v_lshl_add_u32 v3, v8, 7, v3
    s_mul_i32 s42, s45, 8192
    s_add_u32 s42, s42, 45056
    s_mov_b32 s43, 0
    s_add_u32 s40, s42, s43
    v_add_u32 v221, s40, v3
    s_xor_b32 s43, s45, 1
    s_add_u32 s43, s43, 1
    s_mul_i32 s43, s43, 18432
    s_add_u32 s40, s42, s43
    v_add_u32 v222, s40, v3
    s_xor_b32 s43, s45, 0
    s_add_u32 s43, s43, 1
    s_mul_i32 s43, s43, 18432
    s_add_u32 s40, s42, s43
    v_add_u32 v223, s40, v3
    s_add_u32 s40, s43, 43008
    v_add_u32 v224, s40, v3
    s_add_u32 s16, s4, 0x400000
    s_addc_u32 s17, s5, 0
    s_mov_b32 s18, 0x400000
    s_mov_b32 s19, 0x20000
    s_and_b32 s44, s28, 1
    s_lshr_b32 s45, s28, 1
    s_lshl_b32 s40, s44, 2
    v_add_u32 v3, s40, v5
    v_and_b32 v4, 7, v8
    v_xor_b32 v3, v3, v4
    v_lshlrev_b32 v3, 4, v3
    v_lshl_add_u32 v3, v8, 8, v3
    s_mul_i32 s41, s45, 4096
    s_add_u32 s41, s41, 43008
    v_add_u32 v226, s41, v3
    v_lshl_add_u32 v3, v5, 2, v6
    v_and_b32 v4, 7, v3
    v_add_u32 v228, s40, v7
    v_xor_b32 v4, v4, v228
    v_lshlrev_b32 v4, 4, v4
    v_lshl_add_u32 v3, v3, 8, v4
    s_add_u32 s41, s41, 36864
    v_add_u32 v227, s41, v3
    v_and_b32 v3, 7, v8
    v_add_u32 v4, 1, v3
    s_or_b32 s40, s25, s45
    s_cmp_eq_u32 s40, 0
    s_cselect_b32 s40, 8, 0
    v_cmp_gt_u32 vcc, 8, v8
    v_mov_b32 v21, s40
    s_mov_b64 s[56:57], vcc
    v_cndmask_b32 v21, 0, v21, vcc
    v_max_u32 v4, v4, v21
    v_add_u32 v3, 8, v3
    v_sub_u32 v3, v3, v4
    v_lshlrev_b32 v21, 2, v5
    v_sub_u32 v21, v21, v4
    v_mov_b32 v22, 0xf149f2ca
    v_add_u32 v23, 0, v21
    v_cmp_ge_u32 vcc, v3, v23
    s_nop 1
    v_cndmask_b32 v228, v22, 0, vcc
    v_add_u32 v23, 1, v21
    v_cmp_ge_u32 vcc, v3, v23
    s_nop 1
    v_cndmask_b32 v229, v22, 0, vcc
    v_add_u32 v23, 2, v21
    v_cmp_ge_u32 vcc, v3, v23
    s_nop 1
    v_cndmask_b32 v230, v22, 0, vcc
    v_add_u32 v23, 3, v21
    v_cmp_ge_u32 vcc, v3, v23
    s_nop 1
    v_cndmask_b32 v231, v22, 0, vcc
    s_lshl_b32 s40, s25, 7
    s_lshl_b32 s41, s45, 5
    s_add_u32 s40, s40, s41
    s_lshl_b32 s40, s40, 11
    s_lshl_b32 s41, s24, 7
    s_add_u32 s40, s40, s41
    s_lshl_b32 s41, s44, 6
    s_add_u32 s40, s40, s41
    v_lshlrev_b32 v225, 12, v8
    v_lshl_add_u32 v225, v5, 4, v225
    v_add_u32 v225, s40, v225
    s_mov_b32 s58, 0x3e3504f3
    s_mov_b32 s59, 0x3fb8aa3b
    s_barrier
    ds_read_b64_tr_b16 v[128:129], v10 offset:0
    ds_read_b64_tr_b16 v[130:131], v10 offset:512
    ds_read_b128 v[152:155], v16 offset:0
    ds_read_b128 v[156:159], v16 offset:2048
    ds_read_b128 v[160:163], v16 offset:4096
    ds_read_b128 v[164:167], v16 offset:6144
    ds_read_b64_tr_b16 v[132:133], v11 offset:0
    ds_read_b64_tr_b16 v[134:135], v11 offset:512
    ds_read_b64_tr_b16 v[136:137], v12 offset:0
    ds_read_b64_tr_b16 v[138:139], v12 offset:512
    ds_read_b64_tr_b16 v[140:141], v13 offset:0
    ds_read_b64_tr_b16 v[142:143], v13 offset:512
    ds_read_b64_tr_b16 v[144:145], v14 offset:0
    ds_read_b64_tr_b16 v[146:147], v14 offset:512
    ds_read_b64_tr_b16 v[148:149], v15 offset:0
    ds_read_b64_tr_b16 v[150:151], v15 offset:512
    ds_read_b128 v[168:171], v18 offset:0
    s_branch g1_cloop3
.p2align 3
g1_cloop:
    s_barrier
g1_cloop2:
    v_mfma_f32_16x16x32_bf16 v[24:27], v[172:175], v[196:199], v[24:27]
    ds_read_b64_tr_b16 v[128:129], v10 offset:0
    ds_read_b64_tr_b16 v[130:131], v10 offset:512
    v_mfma_f32_16x16x32_bf16 v[28:31], v[172:175], v[200:203], v[28:31]
    ds_read_b128 v[152:155], v16 offset:0
    v_mfma_f32_16x16x32_bf16 v[32:35], v[172:175], v[204:207], v[32:35]
    ds_read_b128 v[156:159], v16 offset:2048
    v_mfma_f32_16x16x32_bf16 v[36:39], v[172:175], v[208:211], v[36:39]
    ds_read_b128 v[160:163], v16 offset:4096
    v_mfma_f32_16x16x32_bf16 v[52:55], v[176:179], v[208:211], v[52:55]
    ds_read_b128 v[164:167], v16 offset:6144
    v_mfma_f32_16x16x32_bf16 v[48:51], v[176:179], v[204:207], v[48:51]
    ds_read_b64_tr_b16 v[132:133], v11 offset:0
    ds_read_b64_tr_b16 v[134:135], v11 offset:512
    v_mfma_f32_16x16x32_bf16 v[44:47], v[176:179], v[200:203], v[44:47]
    ds_read_b64_tr_b16 v[136:137], v12 offset:0
    ds_read_b64_tr_b16 v[138:139], v12 offset:512
    v_mfma_f32_16x16x32_bf16 v[40:43], v[176:179], v[196:199], v[40:43]
    ds_read_b64_tr_b16 v[140:141], v13 offset:0
    ds_read_b64_tr_b16 v[142:143], v13 offset:512
    v_mfma_f32_16x16x32_bf16 v[56:59], v[180:183], v[196:199], v[56:59]
    ds_read_b64_tr_b16 v[144:145], v14 offset:0
    ds_read_b64_tr_b16 v[146:147], v14 offset:512
    v_mfma_f32_16x16x32_bf16 v[60:63], v[180:183], v[200:203], v[60:63]
    ds_read_b64_tr_b16 v[148:149], v15 offset:0
    ds_read_b64_tr_b16 v[150:151], v15 offset:512
    v_mfma_f32_16x16x32_bf16 v[64:67], v[180:183], v[204:207], v[64:67]
    ds_read_b128 v[168:171], v18 offset:0
    v_mfma_f32_16x16x32_bf16 v[68:71], v[180:183], v[208:211], v[68:71]
    v_mfma_f32_16x16x32_bf16 v[84:87], v[184:187], v[208:211], v[84:87]
    v_mfma_f32_16x16x32_bf16 v[80:83], v[184:187], v[204:207], v[80:83]
    v_mfma_f32_16x16x32_bf16 v[76:79], v[184:187], v[200:203], v[76:79]
    v_mfma_f32_16x16x32_bf16 v[72:75], v[184:187], v[196:199], v[72:75]
    v_mfma_f32_16x16x32_bf16 v[88:91], v[188:191], v[196:199], v[88:91]
    v_mfma_f32_16x16x32_bf16 v[92:95], v[188:191], v[200:203], v[92:95]
    v_mfma_f32_16x16x32_bf16 v[96:99], v[188:191], v[204:207], v[96:99]
    v_mfma_f32_16x16x32_bf16 v[100:103], v[188:191], v[208:211], v[100:103]
    v_mfma_f32_16x16x32_bf16 v[120:123], v[188:191], v[212:215], v[120:123]
    v_mfma_f32_16x16x32_bf16 v[124:127], v[192:195], v[212:215], v[124:127]
    v_mfma_f32_16x16x32_bf16 v[116:119], v[192:195], v[208:211], v[116:119]
    v_mfma_f32_16x16x32_bf16 v[112:115], v[192:195], v[204:207], v[112:115]
    v_mfma_f32_16x16x32_bf16 v[108:111], v[192:195], v[200:203], v[108:111]
    v_mfma_f32_16x16x32_bf16 v[104:107], v[192:195], v[196:199], v[104:107]
g1_cloop3:
    s_waitcnt lgkmcnt(0)
    v_mfma_f32_16x16x32_bf16 v[24:27], v[128:131], v[152:155], v[24:27]
    ds_read_b64_tr_b16 v[172:173], v10 offset:4096
    ds_read_b64_tr_b16 v[174:175], v10 offset:4608
    v_mfma_f32_16x16x32_bf16 v[28:31], v[128:131], v[156:159], v[28:31]
    ds_read_b128 v[196:199], v17 offset:0
    v_mfma_f32_16x16x32_bf16 v[32:35], v[128:131], v[160:163], v[32:35]
    ds_read_b128 v[200:203], v17 offset:2048
    v_mfma_f32_16x16x32_bf16 v[36:39], v[128:131], v[164:167], v[36:39]
    ds_read_b128 v[204:207], v17 offset:4096
    v_mfma_f32_16x16x32_bf16 v[52:55], v[132:135], v[164:167], v[52:55]
    ds_read_b128 v[208:211], v17 offset:6144
    v_mfma_f32_16x16x32_bf16 v[48:51], v[132:135], v[160:163], v[48:51]
    ds_read_b64_tr_b16 v[176:177], v11 offset:4096
    ds_read_b64_tr_b16 v[178:179], v11 offset:4608
    v_mfma_f32_16x16x32_bf16 v[44:47], v[132:135], v[156:159], v[44:47]
    ds_read_b64_tr_b16 v[180:181], v12 offset:4096
    ds_read_b64_tr_b16 v[182:183], v12 offset:4608
    v_mfma_f32_16x16x32_bf16 v[40:43], v[132:135], v[152:155], v[40:43]
    ds_read_b64_tr_b16 v[184:185], v13 offset:4096
    ds_read_b64_tr_b16 v[186:187], v13 offset:4608
    v_mfma_f32_16x16x32_bf16 v[56:59], v[136:139], v[152:155], v[56:59]
    ds_read_b64_tr_b16 v[188:189], v14 offset:4096
    ds_read_b64_tr_b16 v[190:191], v14 offset:4608
    v_mfma_f32_16x16x32_bf16 v[60:63], v[136:139], v[156:159], v[60:63]
    ds_read_b64_tr_b16 v[192:193], v15 offset:4096
    ds_read_b64_tr_b16 v[194:195], v15 offset:4608
    v_mfma_f32_16x16x32_bf16 v[64:67], v[136:139], v[160:163], v[64:67]
    ds_read_b128 v[212:215], v19 offset:0
    v_mfma_f32_16x16x32_bf16 v[68:71], v[136:139], v[164:167], v[68:71]
    s_add_u32 s50, s50, 1
    s_cmp_eq_u32 s50, 3
    v_mfma_f32_16x16x32_bf16 v[84:87], v[140:143], v[164:167], v[84:87]
    s_cselect_b32 s49, s29, s51
    s_cselect_b32 s50, 0, s50
    v_mfma_f32_16x16x32_bf16 v[80:83], v[140:143], v[160:163], v[80:83]
    v_add_u32 v10, s49, v10
    v_add_u32 v11, s49, v11
    v_mfma_f32_16x16x32_bf16 v[76:79], v[140:143], v[156:159], v[76:79]
    v_add_u32 v12, s49, v12
    v_add_u32 v13, s49, v13
    v_mfma_f32_16x16x32_bf16 v[72:75], v[140:143], v[152:155], v[72:75]
    v_add_u32 v14, s49, v14
    v_add_u32 v15, s49, v15
    v_mfma_f32_16x16x32_bf16 v[88:91], v[144:147], v[152:155], v[88:91]
    v_add_u32 v16, s49, v16
    v_add_u32 v17, s49, v17
    v_mfma_f32_16x16x32_bf16 v[92:95], v[144:147], v[156:159], v[92:95]
    v_add_u32 v18, s49, v18
    v_add_u32 v19, s49, v19
    v_mfma_f32_16x16x32_bf16 v[96:99], v[144:147], v[160:163], v[96:99]
    s_sub_u32 s48, s48, 1
    s_cmp_lg_u32 s48, 0
    v_mfma_f32_16x16x32_bf16 v[100:103], v[144:147], v[164:167], v[100:103]
    v_mfma_f32_16x16x32_bf16 v[120:123], v[144:147], v[168:171], v[120:123]
    v_mfma_f32_16x16x32_bf16 v[124:127], v[148:151], v[168:171], v[124:127]
    v_mfma_f32_16x16x32_bf16 v[116:119], v[148:151], v[164:167], v[116:119]
    v_mfma_f32_16x16x32_bf16 v[112:115], v[148:151], v[160:163], v[112:115]
    v_mfma_f32_16x16x32_bf16 v[108:111], v[148:151], v[156:159], v[108:111]
    v_mfma_f32_16x16x32_bf16 v[104:107], v[148:151], v[152:155], v[104:107]
    s_waitcnt lgkmcnt(0)
    s_cbranch_scc1 g1_cloop
    ds_read_b64 v[128:129], v216 offset:0
    ds_read_b64 v[130:131], v216 offset:128
    ds_read_b64 v[132:133], v216 offset:256
    ds_read_b64 v[134:135], v216 offset:384
    ds_read_b64 v[136:137], v217
    ds_read_b128 v[140:143], v218 offset:0
    ds_read_b128 v[144:147], v218 offset:64
    ds_read_b128 v[148:151], v219 offset:0
    ds_read_b128 v[152:155], v219 offset:64
    ds_read_b128 v[156:159], v220 offset:0
    ds_read_b128 v[160:163], v220 offset:64
    v_mfma_f32_16x16x32_bf16 v[24:27], v[172:175], v[196:199], v[24:27]
    v_mfma_f32_16x16x32_bf16 v[40:43], v[176:179], v[196:199], v[40:43]
    v_mfma_f32_16x16x32_bf16 v[28:31], v[172:175], v[200:203], v[28:31]
    v_mfma_f32_16x16x32_bf16 v[44:47], v[176:179], v[200:203], v[44:47]
    v_mfma_f32_16x16x32_bf16 v[32:35], v[172:175], v[204:207], v[32:35]
    v_mfma_f32_16x16x32_bf16 v[48:51], v[176:179], v[204:207], v[48:51]
    s_waitcnt lgkmcnt(0)
    v_mfma_f32_16x16x32_bf16 v[36:39], v[172:175], v[208:211], v[36:39]
    v_pk_mul_f32 v[164:165], v[140:141], v[128:129] op_sel:[0,1] op_sel_hi:[1,1]
    v_pk_mul_f32 v[166:167], v[142:143], v[128:129] op_sel:[0,1] op_sel_hi:[1,1]
    v_pk_mul_f32 v[168:169], v[144:145], v[128:129] op_sel:[0,1] op_sel_hi:[1,1]
    v_pk_mul_f32 v[170:171], v[146:147], v[128:129] op_sel:[0,1] op_sel_hi:[1,1]
    v_pk_fma_f32 v[24:25], v[24:25], v[128:129], v[164:165] op_sel:[0,0,0] op_sel_hi:[1,0,1]
    v_pk_fma_f32 v[26:27], v[26:27], v[128:129], v[166:167] op_sel:[0,0,0] op_sel_hi:[1,0,1]
    v_pk_fma_f32 v[40:41], v[40:41], v[128:129], v[168:169] op_sel:[0,0,0] op_sel_hi:[1,0,1]
    v_pk_fma_f32 v[42:43], v[42:43], v[128:129], v[170:171] op_sel:[0,0,0] op_sel_hi:[1,0,1]
    v_mfma_f32_16x16x32_bf16 v[52:55], v[176:179], v[208:211], v[52:55]
    v_cvt_pk_bf16_f32 v232, v24, v25
    v_cvt_pk_bf16_f32 v233, v26, v27
    v_cvt_pk_bf16_f32 v234, v40, v41
    v_cvt_pk_bf16_f32 v235, v42, v43
    s_nop 1
    v_permlane16_swap_b32 v232, v234
    v_permlane16_swap_b32 v233, v235
    ds_write_b128 v221, v[232:235] offset:0
    v_mfma_f32_16x16x32_bf16 v[56:59], v[180:183], v[196:199], v[56:59]
    v_pk_mul_f32 v[164:165], v[140:141], v[130:131] op_sel:[0,1] op_sel_hi:[1,1]
    v_pk_mul_f32 v[166:167], v[142:143], v[130:131] op_sel:[0,1] op_sel_hi:[1,1]
    v_pk_mul_f32 v[168:169], v[144:145], v[130:131] op_sel:[0,1] op_sel_hi:[1,1]
    v_pk_mul_f32 v[170:171], v[146:147], v[130:131] op_sel:[0,1] op_sel_hi:[1,1]
    v_pk_fma_f32 v[28:29], v[28:29], v[130:131], v[164:165] op_sel:[0,0,0] op_sel_hi:[1,0,1]
    v_pk_fma_f32 v[30:31], v[30:31], v[130:131], v[166:167] op_sel:[0,0,0] op_sel_hi:[1,0,1]
    v_pk_fma_f32 v[44:45], v[44:45], v[130:131], v[168:169] op_sel:[0,0,0] op_sel_hi:[1,0,1]
    v_pk_fma_f32 v[46:47], v[46:47], v[130:131], v[170:171] op_sel:[0,0,0] op_sel_hi:[1,0,1]
    v_mfma_f32_16x16x32_bf16 v[72:75], v[184:187], v[196:199], v[72:75]
    v_cvt_pk_bf16_f32 v236, v28, v29
    v_cvt_pk_bf16_f32 v237, v30, v31
    v_cvt_pk_bf16_f32 v238, v44, v45
    v_cvt_pk_bf16_f32 v239, v46, v47
    s_nop 1
    v_permlane16_swap_b32 v236, v238
    v_permlane16_swap_b32 v237, v239
    ds_write_b128 v221, v[236:239] offset:2048
    v_mfma_f32_16x16x32_bf16 v[60:63], v[180:183], v[200:203], v[60:63]
    v_pk_mul_f32 v[164:165], v[140:141], v[132:133] op_sel:[0,1] op_sel_hi:[1,1]
    v_pk_mul_f32 v[166:167], v[142:143], v[132:133] op_sel:[0,1] op_sel_hi:[1,1]
    v_pk_mul_f32 v[168:169], v[144:145], v[132:133] op_sel:[0,1] op_sel_hi:[1,1]
    v_pk_mul_f32 v[170:171], v[146:147], v[132:133] op_sel:[0,1] op_sel_hi:[1,1]
    v_pk_fma_f32 v[32:33], v[32:33], v[132:133], v[164:165] op_sel:[0,0,0] op_sel_hi:[1,0,1]
    v_pk_fma_f32 v[34:35], v[34:35], v[132:133], v[166:167] op_sel:[0,0,0] op_sel_hi:[1,0,1]
    v_pk_fma_f32 v[48:49], v[48:49], v[132:133], v[168:169] op_sel:[0,0,0] op_sel_hi:[1,0,1]
    v_pk_fma_f32 v[50:51], v[50:51], v[132:133], v[170:171] op_sel:[0,0,0] op_sel_hi:[1,0,1]
    v_mfma_f32_16x16x32_bf16 v[76:79], v[184:187], v[200:203], v[76:79]
    v_cvt_pk_bf16_f32 v240, v32, v33
    v_cvt_pk_bf16_f32 v241, v34, v35
    v_cvt_pk_bf16_f32 v242, v48, v49
    v_cvt_pk_bf16_f32 v243, v50, v51
    s_nop 1
    v_permlane16_swap_b32 v240, v242
    v_permlane16_swap_b32 v241, v243
    ds_write_b128 v221, v[240:243] offset:4096
    v_mfma_f32_16x16x32_bf16 v[64:67], v[180:183], v[204:207], v[64:67]
    v_pk_mul_f32 v[164:165], v[140:141], v[134:135] op_sel:[0,1] op_sel_hi:[1,1]
    v_pk_mul_f32 v[166:167], v[142:143], v[134:135] op_sel:[0,1] op_sel_hi:[1,1]
    v_pk_mul_f32 v[168:169], v[144:145], v[134:135] op_sel:[0,1] op_sel_hi:[1,1]
    v_pk_mul_f32 v[170:171], v[146:147], v[134:135] op_sel:[0,1] op_sel_hi:[1,1]
    v_pk_fma_f32 v[36:37], v[36:37], v[134:135], v[164:165] op_sel:[0,0,0] op_sel_hi:[1,0,1]
    v_pk_fma_f32 v[38:39], v[38:39], v[134:135], v[166:167] op_sel:[0,0,0] op_sel_hi:[1,0,1]
    v_pk_fma_f32 v[52:53], v[52:53], v[134:135], v[168:169] op_sel:[0,0,0] op_sel_hi:[1,0,1]
    v_pk_fma_f32 v[54:55], v[54:55], v[134:135], v[170:171] op_sel:[0,0,0] op_sel_hi:[1,0,1]
    v_mfma_f32_16x16x32_bf16 v[80:83], v[184:187], v[204:207], v[80:83]
    v_cvt_pk_bf16_f32 v244, v36, v37
    v_cvt_pk_bf16_f32 v245, v38, v39
    v_cvt_pk_bf16_f32 v246, v52, v53
    v_cvt_pk_bf16_f32 v247, v54, v55
    s_nop 1
    v_permlane16_swap_b32 v244, v246
    v_permlane16_swap_b32 v245, v247
    ds_write_b128 v221, v[244:247] offset:6144
    v_mfma_f32_16x16x32_bf16 v[68:71], v[180:183], v[208:211], v[68:71]
    v_pk_mul_f32 v[164:165], v[148:149], v[128:129] op_sel:[0,1] op_sel_hi:[1,1]
    v_pk_mul_f32 v[166:167], v[150:151], v[128:129] op_sel:[0,1] op_sel_hi:[1,1]
    v_pk_mul_f32 v[168:169], v[152:153], v[128:129] op_sel:[0,1] op_sel_hi:[1,1]
    v_pk_mul_f32 v[170:171], v[154:155], v[128:129] op_sel:[0,1] op_sel_hi:[1,1]
    v_pk_fma_f32 v[56:57], v[56:57], v[128:129], v[164:165] op_sel:[0,0,0] op_sel_hi:[1,0,1]
    v_pk_fma_f32 v[58:59], v[58:59], v[128:129], v[166:167] op_sel:[0,0,0] op_sel_hi:[1,0,1]
    v_pk_fma_f32 v[72:73], v[72:73], v[128:129], v[168:169] op_sel:[0,0,0] op_sel_hi:[1,0,1]
    v_pk_fma_f32 v[74:75], v[74:75], v[128:129], v[170:171] op_sel:[0,0,0] op_sel_hi:[1,0,1]
    v_mfma_f32_16x16x32_bf16 v[84:87], v[184:187], v[208:211], v[84:87]
    v_cvt_pk_bf16_f32 v232, v56, v57
    v_cvt_pk_bf16_f32 v233, v58, v59
    v_cvt_pk_bf16_f32 v234, v72, v73
    v_cvt_pk_bf16_f32 v235, v74, v75
    s_nop 1
    v_permlane16_swap_b32 v232, v234
    v_permlane16_swap_b32 v233, v235
    ds_write_b128 v222, v[232:235] offset:0
    v_mfma_f32_16x16x32_bf16 v[88:91], v[188:191], v[196:199], v[88:91]
    v_pk_mul_f32 v[164:165], v[148:149], v[130:131] op_sel:[0,1] op_sel_hi:[1,1]
    v_pk_mul_f32 v[166:167], v[150:151], v[130:131] op_sel:[0,1] op_sel_hi:[1,1]
    v_pk_mul_f32 v[168:169], v[152:153], v[130:131] op_sel:[0,1] op_sel_hi:[1,1]
    v_pk_mul_f32 v[170:171], v[154:155], v[130:131] op_sel:[0,1] op_sel_hi:[1,1]
    v_pk_fma_f32 v[60:61], v[60:61], v[130:131], v[164:165] op_sel:[0,0,0] op_sel_hi:[1,0,1]
    v_pk_fma_f32 v[62:63], v[62:63], v[130:131], v[166:167] op_sel:[0,0,0] op_sel_hi:[1,0,1]
    v_pk_fma_f32 v[76:77], v[76:77], v[130:131], v[168:169] op_sel:[0,0,0] op_sel_hi:[1,0,1]
    v_pk_fma_f32 v[78:79], v[78:79], v[130:131], v[170:171] op_sel:[0,0,0] op_sel_hi:[1,0,1]
    v_mfma_f32_16x16x32_bf16 v[104:107], v[192:195], v[196:199], v[104:107]
    v_cvt_pk_bf16_f32 v236, v60, v61
    v_cvt_pk_bf16_f32 v237, v62, v63
    v_cvt_pk_bf16_f32 v238, v76, v77
    v_cvt_pk_bf16_f32 v239, v78, v79
    s_nop 1
    v_permlane16_swap_b32 v236, v238
    v_permlane16_swap_b32 v237, v239
    ds_write_b128 v222, v[236:239] offset:2048
    v_mfma_f32_16x16x32_bf16 v[92:95], v[188:191], v[200:203], v[92:95]
    v_pk_mul_f32 v[164:165], v[148:149], v[132:133] op_sel:[0,1] op_sel_hi:[1,1]
    v_pk_mul_f32 v[166:167], v[150:151], v[132:133] op_sel:[0,1] op_sel_hi:[1,1]
    v_pk_mul_f32 v[168:169], v[152:153], v[132:133] op_sel:[0,1] op_sel_hi:[1,1]
    v_pk_mul_f32 v[170:171], v[154:155], v[132:133] op_sel:[0,1] op_sel_hi:[1,1]
    v_pk_fma_f32 v[64:65], v[64:65], v[132:133], v[164:165] op_sel:[0,0,0] op_sel_hi:[1,0,1]
    v_pk_fma_f32 v[66:67], v[66:67], v[132:133], v[166:167] op_sel:[0,0,0] op_sel_hi:[1,0,1]
    v_pk_fma_f32 v[80:81], v[80:81], v[132:133], v[168:169] op_sel:[0,0,0] op_sel_hi:[1,0,1]
    v_pk_fma_f32 v[82:83], v[82:83], v[132:133], v[170:171] op_sel:[0,0,0] op_sel_hi:[1,0,1]
    v_mfma_f32_16x16x32_bf16 v[108:111], v[192:195], v[200:203], v[108:111]
    v_cvt_pk_bf16_f32 v240, v64, v65
    v_cvt_pk_bf16_f32 v241, v66, v67
    v_cvt_pk_bf16_f32 v242, v80, v81
    v_cvt_pk_bf16_f32 v243, v82, v83
    s_nop 1
    v_permlane16_swap_b32 v240, v242
    v_permlane16_swap_b32 v241, v243
    ds_write_b128 v222, v[240:243] offset:4096
    v_mfma_f32_16x16x32_bf16 v[96:99], v[188:191], v[204:207], v[96:99]
    v_pk_mul_f32 v[164:165], v[148:149], v[134:135] op_sel:[0,1] op_sel_hi:[1,1]
    v_pk_mul_f32 v[166:167], v[150:151], v[134:135] op_sel:[0,1] op_sel_hi:[1,1]
    v_pk_mul_f32 v[168:169], v[152:153], v[134:135] op_sel:[0,1] op_sel_hi:[1,1]
    v_pk_mul_f32 v[170:171], v[154:155], v[134:135] op_sel:[0,1] op_sel_hi:[1,1]
    v_pk_fma_f32 v[68:69], v[68:69], v[134:135], v[164:165] op_sel:[0,0,0] op_sel_hi:[1,0,1]
    v_pk_fma_f32 v[70:71], v[70:71], v[134:135], v[166:167] op_sel:[0,0,0] op_sel_hi:[1,0,1]
    v_pk_fma_f32 v[84:85], v[84:85], v[134:135], v[168:169] op_sel:[0,0,0] op_sel_hi:[1,0,1]
    v_pk_fma_f32 v[86:87], v[86:87], v[134:135], v[170:171] op_sel:[0,0,0] op_sel_hi:[1,0,1]
    v_mfma_f32_16x16x32_bf16 v[112:115], v[192:195], v[204:207], v[112:115]
    v_cvt_pk_bf16_f32 v244, v68, v69
    v_cvt_pk_bf16_f32 v245, v70, v71
    v_cvt_pk_bf16_f32 v246, v84, v85
    v_cvt_pk_bf16_f32 v247, v86, v87
    s_nop 1
    v_permlane16_swap_b32 v244, v246
    v_permlane16_swap_b32 v245, v247
    ds_write_b128 v222, v[244:247] offset:6144
    v_mfma_f32_16x16x32_bf16 v[100:103], v[188:191], v[208:211], v[100:103]
    v_pk_mul_f32 v[164:165], v[156:157], v[128:129] op_sel:[0,1] op_sel_hi:[1,1]
    v_pk_mul_f32 v[166:167], v[158:159], v[128:129] op_sel:[0,1] op_sel_hi:[1,1]
    v_pk_mul_f32 v[168:169], v[160:161], v[128:129] op_sel:[0,1] op_sel_hi:[1,1]
    v_pk_mul_f32 v[170:171], v[162:163], v[128:129] op_sel:[0,1] op_sel_hi:[1,1]
    v_pk_fma_f32 v[88:89], v[88:89], v[128:129], v[164:165] op_sel:[0,0,0] op_sel_hi:[1,0,1]
    v_pk_fma_f32 v[90:91], v[90:91], v[128:129], v[166:167] op_sel:[0,0,0] op_sel_hi:[1,0,1]
    v_pk_fma_f32 v[104:105], v[104:105], v[128:129], v[168:169] op_sel:[0,0,0] op_sel_hi:[1,0,1]
    v_pk_fma_f32 v[106:107], v[106:107], v[128:129], v[170:171] op_sel:[0,0,0] op_sel_hi:[1,0,1]
    v_mfma_f32_16x16x32_bf16 v[116:119], v[192:195], v[208:211], v[116:119]
    v_cvt_pk_bf16_f32 v232, v88, v89
    v_cvt_pk_bf16_f32 v233, v90, v91
    v_cvt_pk_bf16_f32 v234, v104, v105
    v_cvt_pk_bf16_f32 v235, v106, v107
    s_nop 1
    v_permlane16_swap_b32 v232, v234
    v_permlane16_swap_b32 v233, v235
    ds_write_b128 v223, v[232:235] offset:0
    v_mfma_f32_16x16x32_bf16 v[120:123], v[188:191], v[212:215], v[120:123]
    v_pk_mul_f32 v[164:165], v[156:157], v[130:131] op_sel:[0,1] op_sel_hi:[1,1]
    v_pk_mul_f32 v[166:167], v[158:159], v[130:131] op_sel:[0,1] op_sel_hi:[1,1]
    v_pk_mul_f32 v[168:169], v[160:161], v[130:131] op_sel:[0,1] op_sel_hi:[1,1]
    v_pk_mul_f32 v[170:171], v[162:163], v[130:131] op_sel:[0,1] op_sel_hi:[1,1]
    v_pk_fma_f32 v[92:93], v[92:93], v[130:131], v[164:165] op_sel:[0,0,0] op_sel_hi:[1,0,1]
    v_pk_fma_f32 v[94:95], v[94:95], v[130:131], v[166:167] op_sel:[0,0,0] op_sel_hi:[1,0,1]
    v_pk_fma_f32 v[108:109], v[108:109], v[130:131], v[168:169] op_sel:[0,0,0] op_sel_hi:[1,0,1]
    v_pk_fma_f32 v[110:111], v[110:111], v[130:131], v[170:171] op_sel:[0,0,0] op_sel_hi:[1,0,1]
    v_mfma_f32_16x16x32_bf16 v[124:127], v[192:195], v[212:215], v[124:127]
    v_cvt_pk_bf16_f32 v236, v92, v93
    v_cvt_pk_bf16_f32 v237, v94, v95
    v_cvt_pk_bf16_f32 v238, v108, v109
    v_cvt_pk_bf16_f32 v239, v110, v111
    s_nop 1
    v_permlane16_swap_b32 v236, v238
    v_permlane16_swap_b32 v237, v239
    ds_write_b128 v223, v[236:239] offset:2048
    v_pk_mul_f32 v[164:165], v[156:157], v[132:133] op_sel:[0,1] op_sel_hi:[1,1]
    v_pk_mul_f32 v[166:167], v[158:159], v[132:133] op_sel:[0,1] op_sel_hi:[1,1]
    v_pk_mul_f32 v[168:169], v[160:161], v[132:133] op_sel:[0,1] op_sel_hi:[1,1]
    v_pk_mul_f32 v[170:171], v[162:163], v[132:133] op_sel:[0,1] op_sel_hi:[1,1]
    v_pk_fma_f32 v[96:97], v[96:97], v[132:133], v[164:165] op_sel:[0,0,0] op_sel_hi:[1,0,1]
    v_pk_fma_f32 v[98:99], v[98:99], v[132:133], v[166:167] op_sel:[0,0,0] op_sel_hi:[1,0,1]
    v_pk_fma_f32 v[112:113], v[112:113], v[132:133], v[168:169] op_sel:[0,0,0] op_sel_hi:[1,0,1]
    v_pk_fma_f32 v[114:115], v[114:115], v[132:133], v[170:171] op_sel:[0,0,0] op_sel_hi:[1,0,1]
    v_cvt_pk_bf16_f32 v240, v96, v97
    v_cvt_pk_bf16_f32 v241, v98, v99
    v_cvt_pk_bf16_f32 v242, v112, v113
    v_cvt_pk_bf16_f32 v243, v114, v115
    s_nop 1
    v_permlane16_swap_b32 v240, v242
    v_permlane16_swap_b32 v241, v243
    ds_write_b128 v223, v[240:243] offset:4096
    v_pk_mul_f32 v[164:165], v[156:157], v[134:135] op_sel:[0,1] op_sel_hi:[1,1]
    v_pk_mul_f32 v[166:167], v[158:159], v[134:135] op_sel:[0,1] op_sel_hi:[1,1]
    v_pk_mul_f32 v[168:169], v[160:161], v[134:135] op_sel:[0,1] op_sel_hi:[1,1]
    v_pk_mul_f32 v[170:171], v[162:163], v[134:135] op_sel:[0,1] op_sel_hi:[1,1]
    v_pk_fma_f32 v[100:101], v[100:101], v[134:135], v[164:165] op_sel:[0,0,0] op_sel_hi:[1,0,1]
    v_pk_fma_f32 v[102:103], v[102:103], v[134:135], v[166:167] op_sel:[0,0,0] op_sel_hi:[1,0,1]
    v_pk_fma_f32 v[116:117], v[116:117], v[134:135], v[168:169] op_sel:[0,0,0] op_sel_hi:[1,0,1]
    v_pk_fma_f32 v[118:119], v[118:119], v[134:135], v[170:171] op_sel:[0,0,0] op_sel_hi:[1,0,1]
    v_cvt_pk_bf16_f32 v244, v100, v101
    v_cvt_pk_bf16_f32 v245, v102, v103
    v_cvt_pk_bf16_f32 v246, v116, v117
    v_cvt_pk_bf16_f32 v247, v118, v119
    s_nop 1
    v_permlane16_swap_b32 v244, v246
    v_permlane16_swap_b32 v245, v247
    ds_write_b128 v223, v[244:247] offset:6144
    v_pk_mul_f32 v[164:165], v[156:157], v[136:137] op_sel:[0,1] op_sel_hi:[1,1]
    v_pk_mul_f32 v[166:167], v[158:159], v[136:137] op_sel:[0,1] op_sel_hi:[1,1]
    v_pk_mul_f32 v[168:169], v[160:161], v[136:137] op_sel:[0,1] op_sel_hi:[1,1]
    v_pk_mul_f32 v[170:171], v[162:163], v[136:137] op_sel:[0,1] op_sel_hi:[1,1]
    v_pk_fma_f32 v[120:121], v[120:121], v[136:137], v[164:165] op_sel:[0,0,0] op_sel_hi:[1,0,1]
    v_pk_fma_f32 v[122:123], v[122:123], v[136:137], v[166:167] op_sel:[0,0,0] op_sel_hi:[1,0,1]
    v_pk_fma_f32 v[124:125], v[124:125], v[136:137], v[168:169] op_sel:[0,0,0] op_sel_hi:[1,0,1]
    v_pk_fma_f32 v[126:127], v[126:127], v[136:137], v[170:171] op_sel:[0,0,0] op_sel_hi:[1,0,1]
    v_cvt_pk_bf16_f32 v232, v120, v121
    v_cvt_pk_bf16_f32 v233, v122, v123
    v_cvt_pk_bf16_f32 v234, v124, v125
    v_cvt_pk_bf16_f32 v235, v126, v127
    s_nop 1
    v_permlane16_swap_b32 v232, v234
    v_permlane16_swap_b32 v233, v235
    ds_write_b128 v224, v[232:235]
    s_waitcnt lgkmcnt(0)
g1_attn:
    s_barrier
    ds_read_b128 v[24:27], v226 offset:2048
    ds_read_b128 v[28:31], v226 offset:18432
    ds_read_b128 v[32:35], v226 offset:20480
    ds_read_b128 v[72:75], v226 offset:2176
    ds_read_b128 v[76:79], v226 offset:18560
    ds_read_b128 v[80:83], v226 offset:20608
    ds_read_b64_tr_b16 v[36:37], v227 offset:0
    ds_read_b64_tr_b16 v[38:39], v227 offset:2048
    ds_read_b64_tr_b16 v[40:41], v227 offset:8
    ds_read_b64_tr_b16 v[42:43], v227 offset:2056
    ds_read_b64_tr_b16 v[84:85], v227 offset:128
    ds_read_b64_tr_b16 v[86:87], v227 offset:2176
    ds_read_b64_tr_b16 v[88:89], v227 offset:136
    ds_read_b64_tr_b16 v[90:91], v227 offset:2184
    s_waitcnt lgkmcnt(8)
    v_mfma_f32_16x16x32_bf16 v[44:47], v[28:31], v[24:27], 0
    v_mfma_f32_16x16x32_bf16 v[48:51], v[32:35], v[24:27], 0
    v_mfma_f32_16x16x32_bf16 v[92:95], v[76:79], v[72:75], 0
    v_mfma_f32_16x16x32_bf16 v[96:99], v[80:83], v[72:75], 0
    s_nop 7
    v_cndmask_b32 v44, v48, v44, s[56:57]
    v_cndmask_b32 v45, v49, v45, s[56:57]
    v_cndmask_b32 v46, v50, v46, s[56:57]
    v_cndmask_b32 v47, v51, v47, s[56:57]
    v_cndmask_b32 v92, v96, v92, s[56:57]
    v_cndmask_b32 v93, v97, v93, s[56:57]
    v_cndmask_b32 v94, v98, v94, s[56:57]
    v_cndmask_b32 v95, v99, v95, s[56:57]
    v_cvt_pk_bf16_f32 v48, v44, v45
    v_cvt_pk_bf16_f32 v49, v46, v47
    v_cvt_pk_bf16_f32 v96, v92, v93
    v_cvt_pk_bf16_f32 v97, v94, v95
    v_lshlrev_b32 v44, 16, v48
    v_and_b32 v45, 0xffff0000, v48
    v_lshlrev_b32 v46, 16, v49
    v_and_b32 v47, 0xffff0000, v49
    v_lshlrev_b32 v92, 16, v96
    v_and_b32 v93, 0xffff0000, v96
    v_lshlrev_b32 v94, 16, v97
    v_and_b32 v95, 0xffff0000, v97
    v_mul_f32 v44, s58, v44
    v_mul_f32 v45, s58, v45
    v_mul_f32 v46, s58, v46
    v_mul_f32 v47, s58, v47
    v_mul_f32 v92, s58, v92
    v_mul_f32 v93, s58, v93
    v_mul_f32 v94, s58, v94
    v_mul_f32 v95, s58, v95
    v_cvt_pk_bf16_f32 v48, v44, v45
    v_cvt_pk_bf16_f32 v49, v46, v47
    v_cvt_pk_bf16_f32 v96, v92, v93
    v_cvt_pk_bf16_f32 v97, v94, v95
    v_lshlrev_b32 v44, 16, v48
    v_and_b32 v45, 0xffff0000, v48
    v_lshlrev_b32 v46, 16, v49
    v_and_b32 v47, 0xffff0000, v49
    v_lshlrev_b32 v92, 16, v96
    v_and_b32 v93, 0xffff0000, v96
    v_lshlrev_b32 v94, 16, v97
    v_and_b32 v95, 0xffff0000, v97
    v_fma_f32 v44, v44, s59, v228
    v_fma_f32 v45, v45, s59, v229
    v_fma_f32 v46, v46, s59, v230
    v_fma_f32 v47, v47, s59, v231
    v_fma_f32 v92, v92, s59, v228
    v_fma_f32 v93, v93, s59, v229
    v_fma_f32 v94, v94, s59, v230
    v_fma_f32 v95, v95, s59, v231
    v_max3_f32 v48, v44, v45, v46
    v_max3_f32 v96, v92, v93, v94
    v_max_f32 v48, v48, v47
    v_max_f32 v96, v96, v95
    v_mov_b32 v49, v48
    v_mov_b32 v97, v96
    s_nop 1
    v_permlane16_swap_b32 v48, v49
    v_permlane16_swap_b32 v96, v97
    s_nop 0
    v_max_f32 v48, v48, v49
    v_max_f32 v96, v96, v97
    v_mov_b32 v49, v48
    v_mov_b32 v97, v96
    s_nop 1
    v_permlane32_swap_b32 v48, v49
    v_permlane32_swap_b32 v96, v97
    s_nop 0
    v_max_f32 v48, v48, v49
    v_max_f32 v96, v96, v97
    v_sub_f32 v44, v44, v48
    v_sub_f32 v45, v45, v48
    v_sub_f32 v46, v46, v48
    v_sub_f32 v47, v47, v48
    v_sub_f32 v92, v92, v96
    v_sub_f32 v93, v93, v96
    v_sub_f32 v94, v94, v96
    v_sub_f32 v95, v95, v96
    v_exp_f32 v44, v44
    v_exp_f32 v45, v45
    v_exp_f32 v46, v46
    v_exp_f32 v47, v47
    v_exp_f32 v92, v92
    v_exp_f32 v93, v93
    v_exp_f32 v94, v94
    v_exp_f32 v95, v95
    v_add_f32 v48, v44, v45
    v_add_f32 v49, v46, v47
    v_add_f32 v96, v92, v93
    v_add_f32 v97, v94, v95
    v_add_f32 v48, v48, v49
    v_add_f32 v96, v96, v97
    v_mov_b32 v49, v48
    v_mov_b32 v97, v96
    s_nop 1
    v_permlane16_swap_b32 v48, v49
    v_permlane16_swap_b32 v96, v97
    s_nop 0
    v_add_f32 v48, v48, v49
    v_add_f32 v96, v96, v97
    v_mov_b32 v49, v48
    v_mov_b32 v97, v96
    s_nop 1
    v_permlane32_swap_b32 v48, v49
    v_permlane32_swap_b32 v96, v97
    s_nop 0
    v_add_f32 v48, v48, v49
    v_add_f32 v96, v96, v97
    v_rcp_f32 v48, v48
    v_rcp_f32 v96, v96
    s_nop 0
    v_mul_f32 v44, v44, v48
    v_mul_f32 v45, v45, v48
    v_mul_f32 v46, v46, v48
    v_mul_f32 v47, v47, v48
    v_mul_f32 v92, v92, v96
    v_mul_f32 v93, v93, v96
    v_mul_f32 v94, v94, v96
    v_mul_f32 v95, v95, v96
    v_cvt_pk_bf16_f32 v48, v44, v45
    v_cvt_pk_bf16_f32 v49, v46, v47
    v_cvt_pk_bf16_f32 v96, v92, v93
    v_cvt_pk_bf16_f32 v97, v94, v95
    v_cndmask_b32 v52, 0, v48, s[56:57]
    v_cndmask_b32 v53, 0, v49, s[56:57]
    v_cndmask_b32 v54, v48, 0, s[56:57]
    v_cndmask_b32 v55, v49, 0, s[56:57]
    v_cndmask_b32 v100, 0, v96, s[56:57]
    v_cndmask_b32 v101, 0, v97, s[56:57]
    v_cndmask_b32 v102, v96, 0, s[56:57]
    v_cndmask_b32 v103, v97, 0, s[56:57]
    s_waitcnt lgkmcnt(0)
    s_nop 0
    v_mfma_f32_16x16x32_bf16 v[56:59], v[36:39], v[52:55], 0
    v_mfma_f32_16x16x32_bf16 v[60:63], v[40:43], v[52:55], 0
    v_mfma_f32_16x16x32_bf16 v[104:107], v[84:87], v[100:103], 0
    v_mfma_f32_16x16x32_bf16 v[108:111], v[88:91], v[100:103], 0
    s_nop 7
    v_cvt_pk_bf16_f32 v64, v56, v57
    v_cvt_pk_bf16_f32 v65, v58, v59
    v_cvt_pk_bf16_f32 v66, v60, v61
    v_cvt_pk_bf16_f32 v67, v62, v63
    buffer_store_dwordx4 v[64:67], v225, s[16:19], 0 offen offset:0 sc1
    v_cvt_pk_bf16_f32 v112, v104, v105
    v_cvt_pk_bf16_f32 v113, v106, v107
    v_cvt_pk_bf16_f32 v114, v108, v109
    v_cvt_pk_bf16_f32 v115, v110, v111
    buffer_store_dwordx4 v[112:115], v225, s[16:19], 0 offen offset:2048 sc1
    s_add_u32 s40, s25, 0
    s_lshl_b32 s40, s40, 8
    s_add_u32 s84, s4, 0x300000
    s_addc_u32 s85, s5, 0
    s_mov_b32 s86, 0x4000
    s_mov_b32 s87, 0x20000
    v_mov_b32 v3, s40
    v_mov_b32 v4, 1
    s_waitcnt vmcnt(0)
    s_barrier
    s_cmp_lg_u32 s28, 0
    s_cbranch_scc1 g1_cin
    s_mov_b64 exec, 1
    buffer_atomic_add v4, v3, s[84:87], 0 offen sc1
    s_mov_b64 exec, -1
g1_cin:
    s_branch g2_in
g1_done:
    s_endpgm
.p2align 6
g2_in:
    s_cmp_ge_u32 s2, 256
    s_cbranch_scc1 g2_done
    s_load_dwordx2 s[4:5], s[0:1], 80
    s_load_dwordx2 s[6:7], s[0:1], 0
    s_load_dwordx2 s[30:31], s[0:1], 16
    v_lshrrev_b32 v1, 6, v0
    v_and_b32 v2, 63, v0
    s_and_b32 s40, s2, 3
    s_lshl_b32 s40, s40, 2
    s_bfe_u32 s41, s2, 0x20003
    s_add_u32 s25, s40, s41
    s_bfe_u32 s40, s2, 0x10002
    s_lshl_b32 s40, s40, 3
    s_lshr_b32 s42, s2, 5
    s_add_u32 s24, s40, s42
    s_add_u32 s27, s41, s42
    s_mov_b32 s26, 0
    v_readfirstlane_b32 s28, v1
    s_nop 0
    s_cmp_lt_u32 s28, 4
    s_cbranch_scc1 g2_compute
    s_sub_u32 s28, s28, 4
    s_mov_b32 s40, 2048
    v_lshrrev_b32 v3, 3, v2
    v_mul_lo_u32 v3, v3, s40
    v_bfe_u32 v4, v2, 4, 1
    v_lshlrev_b32 v4, 1, v4
    v_xor_b32 v4, v4, v2
    v_and_b32 v4, 7, v4
    v_lshl_add_u32 v3, v4, 4, v3
    s_mul_i32 s41, s24, 128
    s_mul_i32 s42, s28, 32768
    s_add_u32 s41, s41, s42
    v_xor_b32 v4, 64, v3
    s_add_u32 s42, s41, 0
    v_add_u32 v10, s42, v3
    s_add_u32 s42, s41, 16384
    v_add_u32 v11, s42, v4
    s_mov_b32 s40, 2048
    v_lshrrev_b32 v3, 3, v2
    v_mul_lo_u32 v3, v3, s40
    v_lshrrev_b32 v4, 4, v2
    v_xor_b32 v4, v4, v2
    v_and_b32 v4, 7, v4
    v_lshl_add_u32 v3, v4, 4, v3
    s_mul_i32 s41, s25, 262144
    s_mul_i32 s42, s28, 65536
    s_add_u32 s41, s41, s42
    v_xor_b32 v4, 64, v3
    s_add_u32 s42, s41, 0
    v_add_u32 v12, s42, v3
    s_add_u32 s42, s41, 16384
    v_add_u32 v13, s42, v4
    s_add_u32 s42, s41, 32768
    v_add_u32 v14, s42, v3
    s_add_u32 s42, s41, 49152
    v_add_u32 v15, s42, v4
    s_mul_i32 s36, s28, 2048
    s_mul_i32 s37, s28, 4096
    s_add_u32 s37, s37, 8192
    s_waitcnt lgkmcnt(0)
    s_add_u32 s4, s4, s97
    s_addc_u32 s5, s5, 0
    s_mov_b32 s8, s30
    s_mov_b32 s9, s31
    s_mov_b32 s10, 0x200000
    s_mov_b32 s11, 0x20000
    s_add_u32 s12, s4, 0x400000
    s_addc_u32 s13, s5, 0
    s_mov_b32 s14, 0x400000
    s_mov_b32 s15, 0x20000
    s_mov_b32 s32, 0
    s_mov_b32 s33, 0
g2_ld_pW:
    s_add_u32 s40, s32, s27
    s_and_b32 s40, s40, 1
    s_andn2_b32 s41, s32, 1
    s_or_b32 s40, s40, s41
    s_add_u32 s40, s40, s26
    s_mul_i32 s34, s40, 131072
    s_mul_i32 s35, s40, 128
    s_add_u32 s38, s33, s36
    s_add_u32 s39, s33, s37
    s_add_u32 m0, s38, 0
    s_nop 0
    buffer_load_dwordx4 v10, s[8:11], s34 offen lds
    s_add_u32 m0, s38, 1024
    s_nop 0
    buffer_load_dwordx4 v11, s[8:11], s34 offen lds
    s_add_u32 s33, s33, 24576
    s_add_u32 s32, s32, 1
    s_cmp_lt_u32 s32, 4
    s_cbranch_scc1 g2_ld_pW
    s_lshr_b32 s40, s25, 0
    s_add_u32 s40, s40, 0
    s_lshl_b32 s40, s40, 8
    s_mov_b32 s42, s40
    s_cmp_lg_u32 s28, 0
    s_cbranch_scc1 g2_dep_set
    s_add_u32 s84, s4, 0x300000
    s_addc_u32 s85, s5, 0
    s_mov_b32 s86, 0x4000
    s_mov_b32 s87, 0x20000
    v_cmp_eq_u32 vcc, 1, v2
    v_mov_b32 v21, s40
    v_mov_b32 v23, s42
    v_cndmask_b32 v21, v21, v23, vcc
    v_mov_b32 v22, 16
    v_mov_b32 v23, 16
    v_cndmask_b32 v22, v22, v23, vcc
    buffer_load_dword v23, v21, s[84:87], 0 offen sc1
g2_dep_set:
    s_lshl_b32 s43, s96, 2
    s_add_u32 s43, s43, 2
    s_mov_b32 s41, 0x800000
    v_mov_b32 v24, 131072
    s_cmp_lg_u32 s28, 0
    s_cbranch_scc1 g2_dep_lds
    s_mov_b32 s41, 0x40000
    s_waitcnt vmcnt(0)
g2_dep:
    v_cmp_lt_u32 vcc, v23, v22
    s_sub_u32 s41, s41, 1
    s_cmp_eq_u32 s41, 0
    s_cbranch_scc1 g2_dep_seen
    s_cbranch_vccz g2_dep_seen
    s_sleep 2
    buffer_load_dword v23, v21, s[84:87], 0 offen sc1
    s_waitcnt vmcnt(0)
    s_branch g2_dep
g2_dep_seen:
    v_mov_b32 v23, s43
    ds_write_b32 v24, v23
    s_branch g2_dep_ok
g2_dep_lds:
    ds_read_b32 v23, v24
    s_sub_u32 s41, s41, 1
    s_waitcnt lgkmcnt(0)
    v_readfirstlane_b32 s40, v23
    s_cmp_eq_u32 s41, 0
    s_cbranch_scc1 g2_dep_ok
    s_cmp_eq_u32 s40, s43
    s_cbranch_scc1 g2_dep_ok
    s_sleep 1
    s_branch g2_dep_lds
g2_dep_ok:
    s_mov_b32 s32, 0
    s_mov_b32 s33, 0
g2_ld_pA:
    s_add_u32 s40, s32, s27
    s_and_b32 s40, s40, 1
    s_andn2_b32 s41, s32, 1
    s_or_b32 s40, s40, s41
    s_add_u32 s40, s40, s26
    s_mul_i32 s34, s40, 131072
    s_mul_i32 s35, s40, 128
    s_add_u32 s38, s33, s36
    s_add_u32 s39, s33, s37
    s_add_u32 m0, s39, 0
    s_nop 0
    buffer_load_dwordx4 v12, s[12:15], s35 offen sc1 lds
    s_add_u32 m0, s39, 1024
    s_nop 0
    buffer_load_dwordx4 v13, s[12:15], s35 offen sc1 lds
    s_add_u32 m0, s39, 2048
    s_nop 0
    buffer_load_dwordx4 v14, s[12:15], s35 offen sc1 lds
    s_add_u32 m0, s39, 3072
    s_nop 0
    buffer_load_dwordx4 v15, s[12:15], s35 offen sc1 lds
    s_add_u32 s33, s33, 24576
    s_add_u32 s32, s32, 1
    s_cmp_lt_u32 s32, 3
    s_cbranch_scc1 g2_ld_pA
    s_waitcnt vmcnt(8)
    s_barrier
    s_add_u32 s40, s32, s27
    s_and_b32 s40, s40, 1
    s_andn2_b32 s41, s32, 1
    s_or_b32 s40, s40, s41
    s_add_u32 s40, s40, s26
    s_mul_i32 s34, s40, 131072
    s_mul_i32 s35, s40, 128
    s_add_u32 s38, s33, s36
    s_add_u32 s39, s33, s37
    s_add_u32 m0, s39, 0
    s_nop 0
    buffer_load_dwordx4 v12, s[12:15], s35 offen sc1 lds
    s_add_u32 m0, s39, 1024
    s_nop 0
    buffer_load_dwordx4 v13, s[12:15], s35 offen sc1 lds
    s_add_u32 m0, s39, 2048
    s_nop 0
    buffer_load_dwordx4 v14, s[12:15], s35 offen sc1 lds
    s_add_u32 m0, s39, 3072
    s_nop 0
    buffer_load_dwordx4 v15, s[12:15], s35 offen sc1 lds
    s_mov_b32 s33, 0
    s_add_u32 s32, s32, 1
g2_ld_loop:
    s_cmp_eq_u32 s32, 4
    s_cbranch_scc1 g2_ld_s4
    s_cmp_eq_u32 s32, 5
    s_cbranch_scc1 g2_ld_s5
    s_waitcnt vmcnt(12)
g2_ld_bar:
    s_barrier
    s_add_u32 s40, s32, s27
    s_and_b32 s40, s40, 1
    s_andn2_b32 s41, s32, 1
    s_or_b32 s40, s40, s41
    s_add_u32 s40, s40, s26
    s_mul_i32 s34, s40, 131072
    s_mul_i32 s35, s40, 128
    s_add_u32 s38, s33, s36
    s_add_u32 s39, s33, s37
    s_add_u32 m0, s38, 0
    s_nop 0
    buffer_load_dwordx4 v10, s[8:11], s34 offen lds
    s_add_u32 m0, s38, 1024
    s_nop 0
    buffer_load_dwordx4 v11, s[8:11], s34 offen lds
    s_add_u32 m0, s39, 0
    s_nop 0
    buffer_load_dwordx4 v12, s[12:15], s35 offen sc1 lds
    s_add_u32 m0, s39, 1024
    s_nop 0
    buffer_load_dwordx4 v13, s[12:15], s35 offen sc1 lds
    s_add_u32 m0, s39, 2048
    s_nop 0
    buffer_load_dwordx4 v14, s[12:15], s35 offen sc1 lds
    s_add_u32 m0, s39, 3072
    s_nop 0
    buffer_load_dwordx4 v15, s[12:15], s35 offen sc1 lds
    s_add_u32 s33, s33, 24576
    s_add_u32 s32, s32, 1
    s_cmp_eq_u32 s33, 98304
    s_cselect_b32 s33, 0, s33
    s_cmp_lt_u32 s32, 16
    s_cbranch_scc1 g2_ld_loop
    s_waitcnt vmcnt(12)
    s_barrier
    s_waitcnt vmcnt(6)
    s_barrier
    s_waitcnt vmcnt(0)
    s_barrier
    s_branch g2_ld_end
g2_ld_s4:
    s_waitcnt vmcnt(8)
    s_branch g2_ld_bar
g2_ld_s5:
    s_waitcnt vmcnt(10)
    s_branch g2_ld_bar
g2_ld_end:
    s_barrier
    s_branch g3_in
g2_done:
    s_endpgm
g2_compute:
    v_lshrrev_b32 v5, 4, v2
    v_bfe_u32 v6, v2, 2, 2
    v_and_b32 v7, 3, v2
    v_and_b32 v8, 15, v2
    s_and_b32 s44, s28, 0
    s_lshr_b32 s45, s28, 0
    s_mul_i32 s40, s25, 128
    s_mul_i32 s41, s45, 32
    s_add_u32 s40, s40, s41
    v_add_u32 v20, s40, v8
    s_mov_b32 s41, 2048
    v_mul_lo_u32 v9, v20, s41
    s_mul_i32 s40, s24, 128
    s_mul_i32 s41, s44, 128
    s_add_u32 s46, s40, s41
    v_and_b32 v3, 1, v5
    v_lshlrev_b32 v3, 5, v3
    v_lshrrev_b32 v4, 1, v5
    v_lshl_add_u32 v3, v4, 4, v3
    v_add3_u32 v9, v9, v3, s46
    s_mov_b32 s52, 0
    s_mov_b32 s53, 32768
    s_waitcnt lgkmcnt(0)
    s_add_u32 s4, s4, s97
    s_addc_u32 s5, s5, 0
    s_add_u32 s20, s4, 0x1900000
    s_addc_u32 s21, s5, 0
    s_cmp_eq_u32 s96, 1
    s_cselect_b32 s20, s20, s6
    s_cselect_b32 s21, s21, s7
    s_mov_b32 s22, 0x400000
    s_mov_b32 s23, 0x20000
    s_add_u32 s16, s4, 0x800000
    s_addc_u32 s17, s5, 0
    s_mov_b32 s18, 0x400000
    s_mov_b32 s19, 0x20000
    s_add_u32 s56, s4, 0xc00000
    s_addc_u32 s57, s5, 0
    s_mov_b32 s58, 0x480000
    s_mov_b32 s59, 0x20000
    s_add_u32 s60, s4, 0x200000
    s_addc_u32 s61, s5, 0
    s_mov_b32 s62, 0x40000
    s_mov_b32 s63, 0x20000
    s_mul_i32 s42, s44, 4
    s_mov_b32 s43, 0
    v_and_b32 v3, 1, v5
    v_lshlrev_b32 v3, 1, v3
    v_lshrrev_b32 v4, 1, v6
    v_or_b32 v3, v3, v4
    s_add_u32 s40, s42, 0
    v_xor_b32 v3, s40, v3
    v_lshlrev_b32 v3, 5, v3
    v_lshl_add_u32 v3, v7, 3, v3
    v_lshl_add_u32 v4, v5, 3, v6
    v_lshl_add_u32 v3, v4, 7, v3
    v_add_u32 v10, s43, v3
    v_and_b32 v3, 1, v5
    v_lshlrev_b32 v3, 1, v3
    v_lshrrev_b32 v4, 1, v6
    v_or_b32 v3, v3, v4
    s_add_u32 s40, s42, 1
    v_xor_b32 v3, s40, v3
    v_lshlrev_b32 v3, 5, v3
    v_lshl_add_u32 v3, v7, 3, v3
    v_lshl_add_u32 v4, v5, 3, v6
    v_lshl_add_u32 v3, v4, 7, v3
    v_add_u32 v11, s43, v3
    v_and_b32 v3, 1, v5
    v_lshlrev_b32 v3, 1, v3
    v_lshrrev_b32 v4, 1, v6
    v_or_b32 v3, v3, v4
    s_add_u32 s40, s42, 2
    v_xor_b32 v3, s40, v3
    v_lshlrev_b32 v3, 5, v3
    v_lshl_add_u32 v3, v7, 3, v3
    v_lshl_add_u32 v4, v5, 3, v6
    v_lshl_add_u32 v3, v4, 7, v3
    v_add_u32 v12, s43, v3
    v_and_b32 v3, 1, v5
    v_lshlrev_b32 v3, 1, v3
    v_lshrrev_b32 v4, 1, v6
    v_or_b32 v3, v3, v4
    s_add_u32 s40, s42, 3
    v_xor_b32 v3, s40, v3
    v_lshlrev_b32 v3, 5, v3
    v_lshl_add_u32 v3, v7, 3, v3
    v_lshl_add_u32 v4, v5, 3, v6
    v_lshl_add_u32 v3, v4, 7, v3
    v_add_u32 v13, s43, v3
    s_mul_i32 s42, s45, 32
    v_lshrrev_b32 v3, 1, v8
    v_xor_b32 v3, v3, v5
    v_lshlrev_b32 v3, 4, v3
    v_lshl_add_u32 v3, v8, 7, v3
    s_lshl_b32 s40, s42, 7
    s_add_u32 s40, s40, 8192
    v_add_u32 v14, s40, v3
    v_xor_b32 v15, 64, v14
    s_mov_b32 s48, 16
    s_mov_b32 s50, 0
    s_mov_b32 s51, 24576
    s_mov_b32 s29, 0xfffee000
    v_mov_b32 v28, 0
    v_mov_b32 v29, 0
    v_mov_b32 v30, 0
    v_mov_b32 v31, 0
    v_mov_b32 v32, 0
    v_mov_b32 v33, 0
    v_mov_b32 v34, 0
    v_mov_b32 v35, 0
    v_mov_b32 v36, 0
    v_mov_b32 v37, 0
    v_mov_b32 v38, 0
    v_mov_b32 v39, 0
    v_mov_b32 v40, 0
    v_mov_b32 v41, 0
    v_mov_b32 v42, 0
    v_mov_b32 v43, 0
    v_mov_b32 v44, 0
    v_mov_b32 v45, 0
    v_mov_b32 v46, 0
    v_mov_b32 v47, 0
    v_mov_b32 v48, 0
    v_mov_b32 v49, 0
    v_mov_b32 v50, 0
    v_mov_b32 v51, 0
    v_mov_b32 v52, 0
    v_mov_b32 v53, 0
    v_mov_b32 v54, 0
    v_mov_b32 v55, 0
    v_mov_b32 v56, 0
    v_mov_b32 v57, 0
    v_mov_b32 v58, 0
    v_mov_b32 v59, 0
    s_barrier
    ds_read_b64_tr_b16 v[60:61], v10 offset:0
    ds_read_b64_tr_b16 v[62:63], v10 offset:512
    ds_read_b128 v[76:79], v14 offset:0
    ds_read_b128 v[80:83], v14 offset:2048
    ds_read_b64_tr_b16 v[64:65], v11 offset:0
    ds_read_b64_tr_b16 v[66:67], v11 offset:512
    ds_read_b64_tr_b16 v[68:69], v12 offset:0
    ds_read_b64_tr_b16 v[70:71], v12 offset:512
    ds_read_b64_tr_b16 v[72:73], v13 offset:0
    ds_read_b64_tr_b16 v[74:75], v13 offset:512
    buffer_load_dwordx4 v[124:127], v9, s[20:23], s52 offen offset:0 sc1
    buffer_load_dwordx4 v[128:131], v9, s[20:23], s52 offen offset:64 sc1
    buffer_load_dwordx4 v[132:135], v9, s[20:23], s53 offen offset:0 sc1
    buffer_load_dwordx4 v[136:139], v9, s[20:23], s53 offen offset:64 sc1
    s_branch g2_cloop3
g2_mid:
    s_waitcnt vmcnt(0)
    s_nop 7
    v_permlane16_swap_b32 v124, v126
    v_permlane16_swap_b32 v125, v127
    v_permlane16_swap_b32 v128, v130
    v_permlane16_swap_b32 v129, v131
    v_permlane16_swap_b32 v132, v134
    v_permlane16_swap_b32 v133, v135
    v_permlane16_swap_b32 v136, v138
    v_permlane16_swap_b32 v137, v139
    v_lshlrev_b32 v140, 16, v124
    v_and_b32 v141, 0xffff0000, v124
    v_lshlrev_b32 v142, 16, v125
    v_and_b32 v143, 0xffff0000, v125
    v_lshlrev_b32 v144, 16, v126
    v_and_b32 v145, 0xffff0000, v126
    v_lshlrev_b32 v146, 16, v127
    v_and_b32 v147, 0xffff0000, v127
    v_pk_add_f32 v[28:29], v[28:29], v[140:141]
    v_pk_add_f32 v[30:31], v[30:31], v[142:143]
    v_pk_add_f32 v[36:37], v[36:37], v[144:145]
    v_pk_add_f32 v[38:39], v[38:39], v[146:147]
    v_lshlrev_b32 v140, 16, v128
    v_and_b32 v141, 0xffff0000, v128
    v_lshlrev_b32 v142, 16, v129
    v_and_b32 v143, 0xffff0000, v129
    v_lshlrev_b32 v144, 16, v130
    v_and_b32 v145, 0xffff0000, v130
    v_lshlrev_b32 v146, 16, v131
    v_and_b32 v147, 0xffff0000, v131
    v_pk_add_f32 v[44:45], v[44:45], v[140:141]
    v_pk_add_f32 v[46:47], v[46:47], v[142:143]
    v_pk_add_f32 v[52:53], v[52:53], v[144:145]
    v_pk_add_f32 v[54:55], v[54:55], v[146:147]
    v_lshlrev_b32 v140, 16, v132
    v_and_b32 v141, 0xffff0000, v132
    v_lshlrev_b32 v142, 16, v133
    v_and_b32 v143, 0xffff0000, v133
    v_lshlrev_b32 v144, 16, v134
    v_and_b32 v145, 0xffff0000, v134
    v_lshlrev_b32 v146, 16, v135
    v_and_b32 v147, 0xffff0000, v135
    v_pk_add_f32 v[32:33], v[32:33], v[140:141]
    v_pk_add_f32 v[34:35], v[34:35], v[142:143]
    v_pk_add_f32 v[40:41], v[40:41], v[144:145]
    v_pk_add_f32 v[42:43], v[42:43], v[146:147]
    v_lshlrev_b32 v140, 16, v136
    v_and_b32 v141, 0xffff0000, v136
    v_lshlrev_b32 v142, 16, v137
    v_and_b32 v143, 0xffff0000, v137
    v_lshlrev_b32 v144, 16, v138
    v_and_b32 v145, 0xffff0000, v138
    v_lshlrev_b32 v146, 16, v139
    v_and_b32 v147, 0xffff0000, v139
    v_pk_add_f32 v[48:49], v[48:49], v[140:141]
    v_pk_add_f32 v[50:51], v[50:51], v[142:143]
    v_pk_add_f32 v[56:57], v[56:57], v[144:145]
    v_pk_add_f32 v[58:59], v[58:59], v[146:147]
    s_nop 1
    s_branch g2_cloop2
.p2align 3
g2_cloop:
    s_barrier
    s_cmp_eq_u32 s48, 8
    s_cbranch_scc1 g2_mid
g2_cloop2:
    v_mfma_f32_16x16x32_bf16 v[28:31], v[84:87], v[100:103], v[28:31]
    ds_read_b64_tr_b16 v[60:61], v10 offset:0
    ds_read_b64_tr_b16 v[62:63], v10 offset:512
    v_mfma_f32_16x16x32_bf16 v[32:35], v[84:87], v[104:107], v[32:35]
    ds_read_b128 v[76:79], v14 offset:0
    v_mfma_f32_16x16x32_bf16 v[40:43], v[88:91], v[104:107], v[40:43]
    ds_read_b128 v[80:83], v14 offset:2048
    v_mfma_f32_16x16x32_bf16 v[36:39], v[88:91], v[100:103], v[36:39]
    ds_read_b64_tr_b16 v[64:65], v11 offset:0
    ds_read_b64_tr_b16 v[66:67], v11 offset:512
    v_mfma_f32_16x16x32_bf16 v[44:47], v[92:95], v[100:103], v[44:47]
    ds_read_b64_tr_b16 v[68:69], v12 offset:0
    ds_read_b64_tr_b16 v[70:71], v12 offset:512
    v_mfma_f32_16x16x32_bf16 v[48:51], v[92:95], v[104:107], v[48:51]
    ds_read_b64_tr_b16 v[72:73], v13 offset:0
    ds_read_b64_tr_b16 v[74:75], v13 offset:512
    v_mfma_f32_16x16x32_bf16 v[56:59], v[96:99], v[104:107], v[56:59]
    v_mfma_f32_16x16x32_bf16 v[52:55], v[96:99], v[100:103], v[52:55]
g2_cloop3:
    s_waitcnt lgkmcnt(0)
    v_mfma_f32_16x16x32_bf16 v[28:31], v[60:63], v[76:79], v[28:31]
    ds_read_b64_tr_b16 v[84:85], v10 offset:4096
    ds_read_b64_tr_b16 v[86:87], v10 offset:4608
    v_mfma_f32_16x16x32_bf16 v[32:35], v[60:63], v[80:83], v[32:35]
    ds_read_b128 v[100:103], v15 offset:0
    v_mfma_f32_16x16x32_bf16 v[40:43], v[64:67], v[80:83], v[40:43]
    ds_read_b128 v[104:107], v15 offset:2048
    v_mfma_f32_16x16x32_bf16 v[36:39], v[64:67], v[76:79], v[36:39]
    ds_read_b64_tr_b16 v[88:89], v11 offset:4096
    ds_read_b64_tr_b16 v[90:91], v11 offset:4608
    v_mfma_f32_16x16x32_bf16 v[44:47], v[68:71], v[76:79], v[44:47]
    ds_read_b64_tr_b16 v[92:93], v12 offset:4096
    ds_read_b64_tr_b16 v[94:95], v12 offset:4608
    v_mfma_f32_16x16x32_bf16 v[48:51], v[68:71], v[80:83], v[48:51]
    ds_read_b64_tr_b16 v[96:97], v13 offset:4096
    ds_read_b64_tr_b16 v[98:99], v13 offset:4608
    v_mfma_f32_16x16x32_bf16 v[56:59], v[72:75], v[80:83], v[56:59]
    s_add_u32 s50, s50, 1
    s_cmp_eq_u32 s50, 4
    v_mfma_f32_16x16x32_bf16 v[52:55], v[72:75], v[76:79], v[52:55]
    s_cselect_b32 s49, s29, s51
    s_cselect_b32 s50, 0, s50
    v_add_u32 v10, s49, v10
    v_add_u32 v11, s49, v11
    v_add_u32 v12, s49, v12
    v_add_u32 v13, s49, v13
    v_add_u32 v14, s49, v14
    v_add_u32 v15, s49, v15
    s_sub_u32 s48, s48, 1
    s_cmp_lg_u32 s48, 0
    s_waitcnt lgkmcnt(0)
    s_cbranch_scc1 g2_cloop
    v_mfma_f32_16x16x32_bf16 v[28:31], v[84:87], v[100:103], v[28:31]
    v_mfma_f32_16x16x32_bf16 v[32:35], v[84:87], v[104:107], v[32:35]
    v_mfma_f32_16x16x32_bf16 v[40:43], v[88:91], v[104:107], v[40:43]
    v_mfma_f32_16x16x32_bf16 v[36:39], v[88:91], v[100:103], v[36:39]
    v_mfma_f32_16x16x32_bf16 v[44:47], v[92:95], v[100:103], v[44:47]
    v_mfma_f32_16x16x32_bf16 v[48:51], v[92:95], v[104:107], v[48:51]
    v_mfma_f32_16x16x32_bf16 v[56:59], v[96:99], v[104:107], v[56:59]
    v_mfma_f32_16x16x32_bf16 v[52:55], v[96:99], v[100:103], v[52:55]
    s_nop 7
    v_pk_add_f32 v[76:77], v[28:29], v[30:31]
    v_pk_mul_f32 v[78:79], v[28:29], v[28:29]
    v_pk_fma_f32 v[78:79], v[30:31], v[30:31], v[78:79]
    v_pk_add_f32 v[76:77], v[76:77], v[36:37]
    v_pk_fma_f32 v[78:79], v[36:37], v[36:37], v[78:79]
    v_pk_add_f32 v[76:77], v[76:77], v[38:39]
    v_pk_fma_f32 v[78:79], v[38:39], v[38:39], v[78:79]
    v_pk_add_f32 v[76:77], v[76:77], v[44:45]
    v_pk_fma_f32 v[78:79], v[44:45], v[44:45], v[78:79]
    v_pk_add_f32 v[76:77], v[76:77], v[46:47]
    v_pk_fma_f32 v[78:79], v[46:47], v[46:47], v[78:79]
    v_pk_add_f32 v[76:77], v[76:77], v[52:53]
    v_pk_fma_f32 v[78:79], v[52:53], v[52:53], v[78:79]
    v_pk_add_f32 v[76:77], v[76:77], v[54:55]
    v_pk_fma_f32 v[78:79], v[54:55], v[54:55], v[78:79]
    v_pk_add_f32 v[80:81], v[32:33], v[34:35]
    v_pk_mul_f32 v[82:83], v[32:33], v[32:33]
    v_pk_fma_f32 v[82:83], v[34:35], v[34:35], v[82:83]
    v_pk_add_f32 v[80:81], v[80:81], v[40:41]
    v_pk_fma_f32 v[82:83], v[40:41], v[40:41], v[82:83]
    v_pk_add_f32 v[80:81], v[80:81], v[42:43]
    v_pk_fma_f32 v[82:83], v[42:43], v[42:43], v[82:83]
    v_pk_add_f32 v[80:81], v[80:81], v[48:49]
    v_pk_fma_f32 v[82:83], v[48:49], v[48:49], v[82:83]
    v_pk_add_f32 v[80:81], v[80:81], v[50:51]
    v_pk_fma_f32 v[82:83], v[50:51], v[50:51], v[82:83]
    v_pk_add_f32 v[80:81], v[80:81], v[56:57]
    v_pk_fma_f32 v[82:83], v[56:57], v[56:57], v[82:83]
    v_pk_add_f32 v[80:81], v[80:81], v[58:59]
    v_pk_fma_f32 v[82:83], v[58:59], v[58:59], v[82:83]
    v_add_f32 v76, v76, v77
    v_add_f32 v77, v78, v79
    v_add_f32 v80, v80, v81
    v_add_f32 v81, v82, v83
    s_nop 1
    v_permlane16_swap_b32 v76, v80
    v_permlane16_swap_b32 v77, v81
    v_pk_add_f32 v[76:77], v[76:77], v[80:81]
    v_mov_b32 v84, v76
    v_mov_b32 v85, v77
    v_and_b32 v3, 16, v2
    v_add_u32 v3, v3, v20
    v_permlane32_swap_b32 v76, v84
    v_permlane32_swap_b32 v77, v85
    v_pk_add_f32 v[76:77], v[76:77], v[84:85]
    v_lshlrev_b32 v3, 3, v3
    s_mul_i32 s40, s24, 1
    s_add_u32 s40, s40, s44
    s_lshl_b32 s40, s40, 14
    s_mov_b32 exec_hi, 0
    buffer_store_dwordx2 v[76:77], v3, s[60:63], s40 offen sc1
    s_mov_b32 exec_hi, -1
    v_lshrrev_b32 v4, 5, v2
    v_lshl_add_u32 v21, v4, 17, v3
    v_cvt_pk_bf16_f32 v60, v28, v29
    v_cvt_pk_bf16_f32 v61, v30, v31
    v_cvt_pk_bf16_f32 v62, v36, v37
    v_cvt_pk_bf16_f32 v63, v38, v39
    v_lshlrev_b32 v28, 16, v60
    v_and_b32 v29, 0xffff0000, v60
    v_lshlrev_b32 v30, 16, v61
    v_and_b32 v31, 0xffff0000, v61
    v_lshlrev_b32 v36, 16, v62
    v_and_b32 v37, 0xffff0000, v62
    v_lshlrev_b32 v38, 16, v63
    v_and_b32 v39, 0xffff0000, v63
    v_permlane16_swap_b32 v60, v62
    v_permlane16_swap_b32 v61, v63
    buffer_store_dwordx4 v[60:63], v9, s[16:19], s52 offen offset:0 sc1
    v_cvt_pk_bf16_f32 v64, v44, v45
    v_cvt_pk_bf16_f32 v65, v46, v47
    v_cvt_pk_bf16_f32 v66, v52, v53
    v_cvt_pk_bf16_f32 v67, v54, v55
    v_lshlrev_b32 v44, 16, v64
    v_and_b32 v45, 0xffff0000, v64
    v_lshlrev_b32 v46, 16, v65
    v_and_b32 v47, 0xffff0000, v65
    v_lshlrev_b32 v52, 16, v66
    v_and_b32 v53, 0xffff0000, v66
    v_lshlrev_b32 v54, 16, v67
    v_and_b32 v55, 0xffff0000, v67
    v_permlane16_swap_b32 v64, v66
    v_permlane16_swap_b32 v65, v67
    buffer_store_dwordx4 v[64:67], v9, s[16:19], s52 offen offset:64 sc1
    v_cvt_pk_bf16_f32 v68, v32, v33
    v_cvt_pk_bf16_f32 v69, v34, v35
    v_cvt_pk_bf16_f32 v70, v40, v41
    v_cvt_pk_bf16_f32 v71, v42, v43
    v_lshlrev_b32 v32, 16, v68
    v_and_b32 v33, 0xffff0000, v68
    v_lshlrev_b32 v34, 16, v69
    v_and_b32 v35, 0xffff0000, v69
    v_lshlrev_b32 v40, 16, v70
    v_and_b32 v41, 0xffff0000, v70
    v_lshlrev_b32 v42, 16, v71
    v_and_b32 v43, 0xffff0000, v71
    v_permlane16_swap_b32 v68, v70
    v_permlane16_swap_b32 v69, v71
    buffer_store_dwordx4 v[68:71], v9, s[16:19], s53 offen offset:0 sc1
    v_cvt_pk_bf16_f32 v72, v48, v49
    v_cvt_pk_bf16_f32 v73, v50, v51
    v_cvt_pk_bf16_f32 v74, v56, v57
    v_cvt_pk_bf16_f32 v75, v58, v59
    v_lshlrev_b32 v48, 16, v72
    v_and_b32 v49, 0xffff0000, v72
    v_lshlrev_b32 v50, 16, v73
    v_and_b32 v51, 0xffff0000, v73
    v_lshlrev_b32 v56, 16, v74
    v_and_b32 v57, 0xffff0000, v74
    v_lshlrev_b32 v58, 16, v75
    v_and_b32 v59, 0xffff0000, v75
    v_permlane16_swap_b32 v72, v74
    v_permlane16_swap_b32 v73, v75
    buffer_store_dwordx4 v[72:75], v9, s[16:19], s53 offen offset:64 sc1
    s_mov_b32 s48, 0x40000
    v_mul_u32_u24 v19, 256, v20
    v_add_u32 v19, v19, v9
    s_mov_b32 s54, 0
    s_mov_b32 s55, 36864
    s_mov_b32 s40, 0
    buffer_load_dwordx2 v[108:109], v21, s[60:63], s40 offen sc1
    s_mov_b32 s41, 16384
    buffer_load_dwordx2 v[110:111], v21, s[60:63], s41 offen sc1
    s_mov_b32 s40, 32768
    buffer_load_dwordx2 v[112:113], v21, s[60:63], s40 offen sc1
    s_mov_b32 s41, 49152
    buffer_load_dwordx2 v[114:115], v21, s[60:63], s41 offen sc1
    s_mov_b32 s40, 65536
    buffer_load_dwordx2 v[116:117], v21, s[60:63], s40 offen sc1
    s_mov_b32 s41, 81920
    buffer_load_dwordx2 v[118:119], v21, s[60:63], s41 offen sc1
    s_mov_b32 s40, 98304
    buffer_load_dwordx2 v[120:121], v21, s[60:63], s40 offen sc1
    s_mov_b32 s41, 114688
    buffer_load_dwordx2 v[122:123], v21, s[60:63], s41 offen sc1
    s_waitcnt vmcnt(0)
g2_ex:
    v_max3_u32 v4, v108, v109, v110
    v_max3_u32 v4, v4, v111, v112
    v_max3_u32 v4, v4, v113, v114
    v_max3_u32 v4, v4, v115, v116
    v_max3_u32 v4, v4, v117, v118
    v_max3_u32 v4, v4, v119, v120
    v_max3_u32 v4, v4, v121, v122
    v_max_u32 v4, v4, v123
    v_cmp_eq_u32 vcc, -1, v4
    s_sub_u32 s48, s48, 1
    s_cmp_eq_u32 s48, 0
    s_cbranch_scc1 g2_exd
    s_cbranch_vccz g2_exd
    s_sleep 2
    s_mov_b32 s40, 0
    buffer_load_dwordx2 v[108:109], v21, s[60:63], s40 offen sc1
    s_mov_b32 s41, 16384
    buffer_load_dwordx2 v[110:111], v21, s[60:63], s41 offen sc1
    s_mov_b32 s40, 32768
    buffer_load_dwordx2 v[112:113], v21, s[60:63], s40 offen sc1
    s_mov_b32 s41, 49152
    buffer_load_dwordx2 v[114:115], v21, s[60:63], s41 offen sc1
    s_mov_b32 s40, 65536
    buffer_load_dwordx2 v[116:117], v21, s[60:63], s40 offen sc1
    s_mov_b32 s41, 81920
    buffer_load_dwordx2 v[118:119], v21, s[60:63], s41 offen sc1
    s_mov_b32 s40, 98304
    buffer_load_dwordx2 v[120:121], v21, s[60:63], s40 offen sc1
    s_mov_b32 s41, 114688
    buffer_load_dwordx2 v[122:123], v21, s[60:63], s41 offen sc1
    s_waitcnt vmcnt(0)
    s_branch g2_ex
g2_exd:
    v_pk_add_f32 v[108:109], v[108:109], v[116:117]
    v_pk_add_f32 v[110:111], v[110:111], v[118:119]
    v_pk_add_f32 v[112:113], v[112:113], v[120:121]
    v_pk_add_f32 v[114:115], v[114:115], v[122:123]
    v_pk_add_f32 v[108:109], v[108:109], v[112:113]
    v_pk_add_f32 v[110:111], v[110:111], v[114:115]
    v_pk_add_f32 v[108:109], v[108:109], v[110:111]
    v_mov_b32 v110, v108
    v_mov_b32 v111, v109
    s_nop 1
    v_permlane32_swap_b32 v108, v110
    v_permlane32_swap_b32 v109, v111
    v_pk_add_f32 v[108:109], v[108:109], v[110:111]
    v_mul_f32 v108, 0x3a800000, v108
    v_mul_f32 v109, 0x3a800000, v109
    v_fma_f32 v109, -v108, v108, v109
    v_max_f32 v109, 0, v109
    v_mov_b32 v110, v108
    v_mov_b32 v111, v109
    v_cvt_pk_bf16_f32 v110, v110, v110
    v_lshlrev_b32 v110, 16, v110
    v_cvt_pk_bf16_f32 v111, v111, v111
    v_lshlrev_b32 v111, 16, v111
    v_add_f32 v111, 0x3727c5ac, v111
    v_cvt_pk_bf16_f32 v111, v111, v111
    v_lshlrev_b32 v111, 16, v111
    v_sqrt_f32 v111, v111
    s_nop 0
    v_cvt_pk_bf16_f32 v111, v111, v111
    v_lshlrev_b32 v111, 16, v111
    v_rcp_f32 v111, v111
    v_sub_f32 v112, v108, v110
    v_mul_f32 v113, v109, v111
    v_mul_f32 v112, v112, v111
    v_mul_f32 v113, v113, v111
    v_cvt_pk_bf16_f32 v112, v112, v112
    v_lshlrev_b32 v112, 16, v112
    v_cvt_pk_bf16_f32 v113, v113, v113
    v_lshlrev_b32 v113, 16, v113
    v_add_f32 v113, 0x3727c5ac, v113
    v_cvt_pk_bf16_f32 v113, v113, v113
    v_lshlrev_b32 v113, 16, v113
    v_sqrt_f32 v113, v113
    s_nop 0
    v_cvt_pk_bf16_f32 v113, v113, v113
    v_lshlrev_b32 v113, 16, v113
    v_rcp_f32 v113, v113
    v_fma_f32 v112, v110, v111, v112
    v_mul_f32 v114, v111, v113
    v_mul_f32 v115, -v112, v113
    v_mov_b32 v116, v114
    v_mov_b32 v117, v115
    s_nop 1
    v_permlane16_swap_b32 v114, v116
    v_permlane16_swap_b32 v115, v117
    v_pk_fma_f32 v[28:29], v[28:29], v[114:115], v[114:115] op_sel:[0,0,1] op_sel_hi:[1,0,1]
    v_pk_fma_f32 v[30:31], v[30:31], v[114:115], v[114:115] op_sel:[0,0,1] op_sel_hi:[1,0,1]
    v_pk_fma_f32 v[36:37], v[36:37], v[114:115], v[114:115] op_sel:[0,0,1] op_sel_hi:[1,0,1]
    v_pk_fma_f32 v[38:39], v[38:39], v[114:115], v[114:115] op_sel:[0,0,1] op_sel_hi:[1,0,1]
    v_cvt_pk_bf16_f32 v124, v28, v29
    v_cvt_pk_bf16_f32 v125, v30, v31
    v_cvt_pk_bf16_f32 v126, v36, v37
    v_cvt_pk_bf16_f32 v127, v38, v39
    s_nop 1
    v_permlane16_swap_b32 v124, v126
    v_permlane16_swap_b32 v125, v127
    buffer_store_dwordx4 v[124:127], v19, s[56:59], s54 offen offset:0 sc1
    v_pk_fma_f32 v[44:45], v[44:45], v[114:115], v[114:115] op_sel:[0,0,1] op_sel_hi:[1,0,1]
    v_pk_fma_f32 v[46:47], v[46:47], v[114:115], v[114:115] op_sel:[0,0,1] op_sel_hi:[1,0,1]
    v_pk_fma_f32 v[52:53], v[52:53], v[114:115], v[114:115] op_sel:[0,0,1] op_sel_hi:[1,0,1]
    v_pk_fma_f32 v[54:55], v[54:55], v[114:115], v[114:115] op_sel:[0,0,1] op_sel_hi:[1,0,1]
    v_cvt_pk_bf16_f32 v128, v44, v45
    v_cvt_pk_bf16_f32 v129, v46, v47
    v_cvt_pk_bf16_f32 v130, v52, v53
    v_cvt_pk_bf16_f32 v131, v54, v55
    s_nop 1
    v_permlane16_swap_b32 v128, v130
    v_permlane16_swap_b32 v129, v131
    buffer_store_dwordx4 v[128:131], v19, s[56:59], s54 offen offset:64 sc1
    v_pk_fma_f32 v[32:33], v[32:33], v[116:117], v[116:117] op_sel:[0,0,1] op_sel_hi:[1,0,1]
    v_pk_fma_f32 v[34:35], v[34:35], v[116:117], v[116:117] op_sel:[0,0,1] op_sel_hi:[1,0,1]
    v_pk_fma_f32 v[40:41], v[40:41], v[116:117], v[116:117] op_sel:[0,0,1] op_sel_hi:[1,0,1]
    v_pk_fma_f32 v[42:43], v[42:43], v[116:117], v[116:117] op_sel:[0,0,1] op_sel_hi:[1,0,1]
    v_cvt_pk_bf16_f32 v132, v32, v33
    v_cvt_pk_bf16_f32 v133, v34, v35
    v_cvt_pk_bf16_f32 v134, v40, v41
    v_cvt_pk_bf16_f32 v135, v42, v43
    s_nop 1
    v_permlane16_swap_b32 v132, v134
    v_permlane16_swap_b32 v133, v135
    buffer_store_dwordx4 v[132:135], v19, s[56:59], s55 offen offset:0 sc1
    v_pk_fma_f32 v[48:49], v[48:49], v[116:117], v[116:117] op_sel:[0,0,1] op_sel_hi:[1,0,1]
    v_pk_fma_f32 v[50:51], v[50:51], v[116:117], v[116:117] op_sel:[0,0,1] op_sel_hi:[1,0,1]
    v_pk_fma_f32 v[56:57], v[56:57], v[116:117], v[116:117] op_sel:[0,0,1] op_sel_hi:[1,0,1]
    v_pk_fma_f32 v[58:59], v[58:59], v[116:117], v[116:117] op_sel:[0,0,1] op_sel_hi:[1,0,1]
    v_cvt_pk_bf16_f32 v136, v48, v49
    v_cvt_pk_bf16_f32 v137, v50, v51
    v_cvt_pk_bf16_f32 v138, v56, v57
    v_cvt_pk_bf16_f32 v139, v58, v59
    s_nop 1
    v_permlane16_swap_b32 v136, v138
    v_permlane16_swap_b32 v137, v139
    buffer_store_dwordx4 v[136:139], v19, s[56:59], s55 offen offset:64 sc1
    s_lshr_b32 s40, s24, 1
    s_add_u32 s40, s40, 16
    s_lshl_b32 s40, s40, 8
    s_mov_b32 s42, s40
    s_add_u32 s84, s4, 0x300000
    s_addc_u32 s85, s5, 0
    s_mov_b32 s86, 0x4000
    s_mov_b32 s87, 0x20000
    v_mov_b32 v3, s40
    v_mov_b32 v4, 1
    s_waitcnt vmcnt(0)
    s_barrier
    s_cmp_lg_u32 s28, 0
    s_cbranch_scc1 g2_cin
    s_mov_b64 exec, 1
    buffer_atomic_add v4, v3, s[84:87], 0 offen sc1
    s_mov_b64 exec, -1
g2_cin:
    s_branch g3_in
.p2align 6
g3_in:
    s_cmp_ge_u32 s2, 224
    s_cbranch_scc1 g3_spare
    s_load_dwordx2 s[4:5], s[0:1], 80
    s_load_dwordx2 s[30:31], s[0:1], 32
    s_load_dwordx2 s[6:7], s[0:1], 40
    v_lshrrev_b32 v1, 6, v0
    v_and_b32 v2, 63, v0
    s_and_b32 s40, s2, 1
    s_lshl_b32 s40, s40, 2
    s_bfe_u32 s41, s2, 0x20003
    s_add_u32 s25, s40, s41
    s_bfe_u32 s40, s2, 0x20001
    s_mul_i32 s40, s40, 7
    s_lshr_b32 s42, s2, 5
    s_add_u32 s24, s40, s42
    s_add_u32 s27, s41, s42
    s_mov_b32 s26, 0
    s_cmp_eq_u32 s96, 0
    s_cselect_b32 s95, 3, 1
    v_readfirstlane_b32 s28, v1
    s_nop 0
    s_cmp_lt_u32 s28, 4
    s_cbranch_scc1 g3_compute
    s_sub_u32 s28, s28, 4
    s_mov_b32 s40, 7168
    v_lshrrev_b32 v4, 4, v2
    v_mul_lo_u32 v3, v4, s40
    v_lshlrev_b32 v4, 1, v4
    v_xor_b32 v4, v4, v2
    v_and_b32 v4, 15, v4
    v_lshl_add_u32 v3, v4, 4, v3
    s_mul_i32 s41, s24, 256
    s_mul_i32 s42, s28, 114688
    s_add_u32 s41, s41, s42
    v_xor_b32 v4, 128, v3
    s_add_u32 s42, s41, 0
    v_add_u32 v10, s42, v3
    s_add_u32 s42, s41, 28672
    v_add_u32 v11, s42, v3
    s_add_u32 s42, s41, 57344
    v_add_u32 v12, s42, v4
    s_add_u32 s42, s41, 86016
    v_add_u32 v13, s42, v4
    s_mov_b32 s40, 2304
    v_lshrrev_b32 v4, 4, v2
    v_mul_lo_u32 v3, v4, s40
    v_lshlrev_b32 v4, 1, v4
    v_xor_b32 v4, v4, v2
    v_and_b32 v4, 15, v4
    v_lshl_add_u32 v3, v4, 4, v3
    s_mul_i32 s41, s25, 256
    s_mul_i32 s42, s28, 36864
    s_add_u32 s41, s41, s42
    v_xor_b32 v4, 128, v3
    s_add_u32 s42, s41, 0
    v_add_u32 v14, s42, v3
    s_add_u32 s42, s41, 9216
    v_add_u32 v15, s42, v3
    s_add_u32 s42, s41, 18432
    v_add_u32 v16, s42, v4
    s_add_u32 s42, s41, 27648
    v_add_u32 v17, s42, v4
    s_mul_i32 s36, s28, 4096
    s_mul_i32 s37, s28, 4096
    s_add_u32 s37, s37, 16384
    s_waitcnt lgkmcnt(0)
    s_add_u32 s4, s4, s97
    s_addc_u32 s5, s5, 0
    s_mov_b32 s8, s30
    s_mov_b32 s9, s31
    s_mov_b32 s10, 0xe00000
    s_mov_b32 s11, 0x20000
    s_add_u32 s12, s4, 0xc00000
    s_addc_u32 s13, s5, 0
    s_mov_b32 s14, 0x480000
    s_mov_b32 s15, 0x20000
    s_mov_b32 s32, 0
    s_mov_b32 s33, 0
g3_ld_pW:
    s_add_u32 s40, s32, s27
    s_and_b32 s40, s40, s95
    s_andn2_b32 s41, s32, s95
    s_or_b32 s40, s40, s41
    s_add_u32 s40, s40, s26
    s_mul_i32 s34, s40, 458752
    s_mul_i32 s35, s40, 147456
    s_add_u32 s38, s33, s36
    s_add_u32 s39, s33, s37
    s_add_u32 m0, s38, 0
    s_nop 0
    buffer_load_dwordx4 v10, s[8:11], s34 offen lds
    s_add_u32 m0, s38, 1024
    s_nop 0
    buffer_load_dwordx4 v11, s[8:11], s34 offen lds
    s_add_u32 m0, s38, 2048
    s_nop 0
    buffer_load_dwordx4 v12, s[8:11], s34 offen lds
    s_add_u32 m0, s38, 3072
    s_nop 0
    buffer_load_dwordx4 v13, s[8:11], s34 offen lds
    s_add_u32 s33, s33, 32768
    s_add_u32 s32, s32, 1
    s_cmp_lt_u32 s32, 4
    s_cbranch_scc1 g3_ld_pW
    s_lshr_b32 s40, s25, 0
    s_add_u32 s40, s40, 16
    s_lshl_b32 s40, s40, 8
    s_mov_b32 s42, s40
    s_cmp_lg_u32 s28, 0
    s_cbranch_scc1 g3_dep_set
    s_add_u32 s84, s4, 0x300000
    s_addc_u32 s85, s5, 0
    s_mov_b32 s86, 0x4000
    s_mov_b32 s87, 0x20000
    v_cmp_eq_u32 vcc, 1, v2
    v_mov_b32 v21, s40
    v_mov_b32 v23, s42
    v_cndmask_b32 v21, v21, v23, vcc
    v_mov_b32 v22, 32
    v_mov_b32 v23, 32
    v_cndmask_b32 v22, v22, v23, vcc
    buffer_load_dword v23, v21, s[84:87], 0 offen sc1
g3_dep_set:
    s_lshl_b32 s43, s96, 2
    s_add_u32 s43, s43, 3
    s_mov_b32 s41, 0x800000
    v_mov_b32 v24, 131072
    s_cmp_lg_u32 s28, 0
    s_cbranch_scc1 g3_dep_lds
    s_mov_b32 s41, 0x40000
    s_waitcnt vmcnt(0)
g3_dep:
    v_cmp_lt_u32 vcc, v23, v22
    s_sub_u32 s41, s41, 1
    s_cmp_eq_u32 s41, 0
    s_cbranch_scc1 g3_dep_seen
    s_cbranch_vccz g3_dep_seen
    s_sleep 2
    buffer_load_dword v23, v21, s[84:87], 0 offen sc1
    s_waitcnt vmcnt(0)
    s_branch g3_dep
g3_dep_seen:
    v_mov_b32 v23, s43
    ds_write_b32 v24, v23
    s_branch g3_dep_ok
g3_dep_lds:
    ds_read_b32 v23, v24
    s_sub_u32 s41, s41, 1
    s_waitcnt lgkmcnt(0)
    v_readfirstlane_b32 s40, v23
    s_cmp_eq_u32 s41, 0
    s_cbranch_scc1 g3_dep_ok
    s_cmp_eq_u32 s40, s43
    s_cbranch_scc1 g3_dep_ok
    s_sleep 1
    s_branch g3_dep_lds
g3_dep_ok:
    s_mov_b32 s32, 0
    s_mov_b32 s33, 0
g3_ld_pA:
    s_add_u32 s40, s32, s27
    s_and_b32 s40, s40, s95
    s_andn2_b32 s41, s32, s95
    s_or_b32 s40, s40, s41
    s_add_u32 s40, s40, s26
    s_mul_i32 s34, s40, 458752
    s_mul_i32 s35, s40, 147456
    s_add_u32 s38, s33, s36
    s_add_u32 s39, s33, s37
    s_add_u32 m0, s39, 0
    s_nop 0
    buffer_load_dwordx4 v14, s[12:15], s35 offen sc1 lds
    s_add_u32 m0, s39, 1024
    s_nop 0
    buffer_load_dwordx4 v15, s[12:15], s35 offen sc1 lds
    s_add_u32 m0, s39, 2048
    s_nop 0
    buffer_load_dwordx4 v16, s[12:15], s35 offen sc1 lds
    s_add_u32 m0, s39, 3072
    s_nop 0
    buffer_load_dwordx4 v17, s[12:15], s35 offen sc1 lds
    s_add_u32 s33, s33, 32768
    s_add_u32 s32, s32, 1
    s_cmp_lt_u32 s32, 3
    s_cbranch_scc1 g3_ld_pA
    s_waitcnt vmcnt(8)
    s_barrier
    s_add_u32 s40, s32, s27
    s_and_b32 s40, s40, s95
    s_andn2_b32 s41, s32, s95
    s_or_b32 s40, s40, s41
    s_add_u32 s40, s40, s26
    s_mul_i32 s34, s40, 458752
    s_mul_i32 s35, s40, 147456
    s_add_u32 s38, s33, s36
    s_add_u32 s39, s33, s37
    s_add_u32 m0, s39, 0
    s_nop 0
    buffer_load_dwordx4 v14, s[12:15], s35 offen sc1 lds
    s_add_u32 m0, s39, 1024
    s_nop 0
    buffer_load_dwordx4 v15, s[12:15], s35 offen sc1 lds
    s_add_u32 m0, s39, 2048
    s_nop 0
    buffer_load_dwordx4 v16, s[12:15], s35 offen sc1 lds
    s_add_u32 m0, s39, 3072
    s_nop 0
    buffer_load_dwordx4 v17, s[12:15], s35 offen sc1 lds
    s_mov_b32 s33, 0
    s_add_u32 s32, s32, 1
g3_ld_loop:
    s_cmp_eq_u32 s32, 4
    s_cbranch_scc1 g3_ld_s4
    s_cmp_eq_u32 s32, 5
    s_cbranch_scc1 g3_ld_s5
    s_waitcnt vmcnt(16)
g3_ld_bar:
    s_barrier
    s_add_u32 s40, s32, s27
    s_and_b32 s40, s40, s95
    s_andn2_b32 s41, s32, s95
    s_or_b32 s40, s40, s41
    s_add_u32 s40, s40, s26
    s_mul_i32 s34, s40, 458752
    s_mul_i32 s35, s40, 147456
    s_add_u32 s38, s33, s36
    s_add_u32 s39, s33, s37
    s_add_u32 m0, s38, 0
    s_nop 0
    buffer_load_dwordx4 v10, s[8:11], s34 offen lds
    s_add_u32 m0, s38, 1024
    s_nop 0
    buffer_load_dwordx4 v11, s[8:11], s34 offen lds
    s_add_u32 m0, s38, 2048
    s_nop 0
    buffer_load_dwordx4 v12, s[8:11], s34 offen lds
    s_add_u32 m0, s38, 3072
    s_nop 0
    buffer_load_dwordx4 v13, s[8:11], s34 offen lds
    s_add_u32 m0, s39, 0
    s_nop 0
    buffer_load_dwordx4 v14, s[12:15], s35 offen sc1 lds
    s_add_u32 m0, s39, 1024
    s_nop 0
    buffer_load_dwordx4 v15, s[12:15], s35 offen sc1 lds
    s_add_u32 m0, s39, 2048
    s_nop 0
    buffer_load_dwordx4 v16, s[12:15], s35 offen sc1 lds
    s_add_u32 m0, s39, 3072
    s_nop 0
    buffer_load_dwordx4 v17, s[12:15], s35 offen sc1 lds
    s_add_u32 s33, s33, 32768
    s_add_u32 s32, s32, 1
    s_cmp_eq_u32 s33, 131072
    s_cselect_b32 s33, 0, s33
    s_cmp_lt_u32 s32, 32
    s_cbranch_scc1 g3_ld_loop
    s_waitcnt vmcnt(16)
    s_barrier
    s_waitcnt vmcnt(8)
    s_barrier
    s_waitcnt vmcnt(0)
    s_barrier
    s_branch g3_ld_end
g3_ld_s4:
    s_waitcnt vmcnt(8)
    s_branch g3_ld_bar
g3_ld_s5:
    s_waitcnt vmcnt(12)
    s_branch g3_ld_bar
g3_ld_end:
    s_barrier
    s_branch g4_in
g3_done:
    s_endpgm
g3_compute:
    v_lshrrev_b32 v5, 4, v2
    v_bfe_u32 v6, v2, 2, 2
    v_and_b32 v7, 3, v2
    v_and_b32 v8, 15, v2
    s_and_b32 s44, s28, 1
    s_lshr_b32 s45, s28, 1
    s_mul_i32 s40, s25, 128
    s_mul_i32 s41, s45, 64
    s_add_u32 s40, s40, s41
    v_add_u32 v20, s40, v8
    s_mov_b32 s41, 8192
    v_mul_lo_u32 v9, v20, s41
    s_mul_i32 s40, s24, 256
    s_mul_i32 s41, s44, 128
    s_add_u32 s46, s40, s41
    v_and_b32 v3, 1, v5
    v_lshlrev_b32 v3, 5, v3
    v_lshrrev_b32 v4, 1, v5
    v_lshl_add_u32 v3, v4, 4, v3
    v_add3_u32 v9, v9, v3, s46
    s_mov_b32 s52, 0
    s_mov_b32 s53, 131072
    s_mov_b32 s54, 262144
    s_mov_b32 s55, 393216
    s_waitcnt lgkmcnt(0)
    s_add_u32 s4, s4, s97
    s_addc_u32 s5, s5, 0
    s_mov_b32 s20, s6
    s_mov_b32 s21, s7
    s_mov_b32 s22, 0x1c00
    s_mov_b32 s23, 0x20000
    s_add_u32 s16, s4, 0x1100000
    s_addc_u32 s17, s5, 0
    s_mov_b32 s18, 0x800000
    s_mov_b32 s19, 0x20000
    v_lshl_add_u32 v3, v5, 3, s46
    buffer_load_dwordx2 v[92:93], v3, s[20:23], 0 offen offset:0
    buffer_load_dwordx2 v[94:95], v3, s[20:23], 0 offen offset:32
    buffer_load_dwordx2 v[96:97], v3, s[20:23], 0 offen offset:64
    buffer_load_dwordx2 v[98:99], v3, s[20:23], 0 offen offset:96
    s_mul_i32 s42, s44, 4
    s_mov_b32 s43, 0
    v_and_b32 v3, 1, v5
    v_lshl_or_b32 v3, v3, 2, v6
    s_add_u32 s40, s42, 0
    v_xor_b32 v3, s40, v3
    v_lshlrev_b32 v3, 5, v3
    v_lshl_add_u32 v3, v7, 3, v3
    v_lshl_add_u32 v4, v5, 3, v6
    v_lshl_add_u32 v3, v4, 8, v3
    v_add_u32 v10, s43, v3
    v_and_b32 v3, 1, v5
    v_lshl_or_b32 v3, v3, 2, v6
    s_add_u32 s40, s42, 1
    v_xor_b32 v3, s40, v3
    v_lshlrev_b32 v3, 5, v3
    v_lshl_add_u32 v3, v7, 3, v3
    v_lshl_add_u32 v4, v5, 3, v6
    v_lshl_add_u32 v3, v4, 8, v3
    v_add_u32 v11, s43, v3
    v_and_b32 v3, 1, v5
    v_lshl_or_b32 v3, v3, 2, v6
    s_add_u32 s40, s42, 2
    v_xor_b32 v3, s40, v3
    v_lshlrev_b32 v3, 5, v3
    v_lshl_add_u32 v3, v7, 3, v3
    v_lshl_add_u32 v4, v5, 3, v6
    v_lshl_add_u32 v3, v4, 8, v3
    v_add_u32 v12, s43, v3
    v_and_b32 v3, 1, v5
    v_lshl_or_b32 v3, v3, 2, v6
    s_add_u32 s40, s42, 3
    v_xor_b32 v3, s40, v3
    v_lshlrev_b32 v3, 5, v3
    v_lshl_add_u32 v3, v7, 3, v3
    v_lshl_add_u32 v4, v5, 3, v6
    v_lshl_add_u32 v3, v4, 8, v3
    v_add_u32 v13, s43, v3
    s_mul_i32 s42, s45, 4
    s_mov_b32 s43, 16384
    v_and_b32 v3, 1, v5
    v_lshl_or_b32 v3, v3, 2, v6
    s_add_u32 s40, s42, 0
    v_xor_b32 v3, s40, v3
    v_lshlrev_b32 v3, 5, v3
    v_lshl_add_u32 v3, v7, 3, v3
    v_lshl_add_u32 v4, v5, 3, v6
    v_lshl_add_u32 v3, v4, 8, v3
    v_add_u32 v14, s43, v3
    v_and_b32 v3, 1, v5
    v_lshl_or_b32 v3, v3, 2, v6
    s_add_u32 s40, s42, 1
    v_xor_b32 v3, s40, v3
    v_lshlrev_b32 v3, 5, v3
    v_lshl_add_u32 v3, v7, 3, v3
    v_lshl_add_u32 v4, v5, 3, v6
    v_lshl_add_u32 v3, v4, 8, v3
    v_add_u32 v15, s43, v3
    v_and_b32 v3, 1, v5
    v_lshl_or_b32 v3, v3, 2, v6
    s_add_u32 s40, s42, 2
    v_xor_b32 v3, s40, v3
    v_lshlrev_b32 v3, 5, v3
    v_lshl_add_u32 v3, v7, 3, v3
    v_lshl_add_u32 v4, v5, 3, v6
    v_lshl_add_u32 v3, v4, 8, v3
    v_add_u32 v16, s43, v3
    v_and_b32 v3, 1, v5
    v_lshl_or_b32 v3, v3, 2, v6
    s_add_u32 s40, s42, 3
    v_xor_b32 v3, s40, v3
    v_lshlrev_b32 v3, 5, v3
    v_lshl_add_u32 v3, v7, 3, v3
    v_lshl_add_u32 v4, v5, 3, v6
    v_lshl_add_u32 v3, v4, 8, v3
    v_add_u32 v17, s43, v3
    s_mov_b32 s48, 32
    s_mov_b32 s50, 0
    s_mov_b32 s51, 32768
    s_mov_b32 s29, 0xfffe8000
    s_waitcnt vmcnt(0)
    v_lshlrev_b32 v28, 16, v92
    v_and_b32 v29, 0xffff0000, v92
    v_lshlrev_b32 v30, 16, v93
    v_and_b32 v31, 0xffff0000, v93
    v_lshlrev_b32 v32, 16, v92
    v_and_b32 v33, 0xffff0000, v92
    v_lshlrev_b32 v34, 16, v93
    v_and_b32 v35, 0xffff0000, v93
    v_lshlrev_b32 v36, 16, v92
    v_and_b32 v37, 0xffff0000, v92
    v_lshlrev_b32 v38, 16, v93
    v_and_b32 v39, 0xffff0000, v93
    v_lshlrev_b32 v40, 16, v92
    v_and_b32 v41, 0xffff0000, v92
    v_lshlrev_b32 v42, 16, v93
    v_and_b32 v43, 0xffff0000, v93
    v_lshlrev_b32 v44, 16, v94
    v_and_b32 v45, 0xffff0000, v94
    v_lshlrev_b32 v46, 16, v95
    v_and_b32 v47, 0xffff0000, v95
    v_lshlrev_b32 v48, 16, v94
    v_and_b32 v49, 0xffff0000, v94
    v_lshlrev_b32 v50, 16, v95
    v_and_b32 v51, 0xffff0000, v95
    v_lshlrev_b32 v52, 16, v94
    v_and_b32 v53, 0xffff0000, v94
    v_lshlrev_b32 v54, 16, v95
    v_and_b32 v55, 0xffff0000, v95
    v_lshlrev_b32 v56, 16, v94
    v_and_b32 v57, 0xffff0000, v94
    v_lshlrev_b32 v58, 16, v95
    v_and_b32 v59, 0xffff0000, v95
    v_lshlrev_b32 v60, 16, v96
    v_and_b32 v61, 0xffff0000, v96
    v_lshlrev_b32 v62, 16, v97
    v_and_b32 v63, 0xffff0000, v97
    v_lshlrev_b32 v64, 16, v96
    v_and_b32 v65, 0xffff0000, v96
    v_lshlrev_b32 v66, 16, v97
    v_and_b32 v67, 0xffff0000, v97
    v_lshlrev_b32 v68, 16, v96
    v_and_b32 v69, 0xffff0000, v96
    v_lshlrev_b32 v70, 16, v97
    v_and_b32 v71, 0xffff0000, v97
    v_lshlrev_b32 v72, 16, v96
    v_and_b32 v73, 0xffff0000, v96
    v_lshlrev_b32 v74, 16, v97
    v_and_b32 v75, 0xffff0000, v97
    v_lshlrev_b32 v76, 16, v98
    v_and_b32 v77, 0xffff0000, v98
    v_lshlrev_b32 v78, 16, v99
    v_and_b32 v79, 0xffff0000, v99
    v_lshlrev_b32 v80, 16, v98
    v_and_b32 v81, 0xffff0000, v98
    v_lshlrev_b32 v82, 16, v99
    v_and_b32 v83, 0xffff0000, v99
    v_lshlrev_b32 v84, 16, v98
    v_and_b32 v85, 0xffff0000, v98
    v_lshlrev_b32 v86, 16, v99
    v_and_b32 v87, 0xffff0000, v99
    v_lshlrev_b32 v88, 16, v98
    v_and_b32 v89, 0xffff0000, v98
    v_lshlrev_b32 v90, 16, v99
    v_and_b32 v91, 0xffff0000, v99
    v_mov_b32 v156, 0xbdd2d3e8
    v_mov_b32 v157, 0xbdd2d3e8
    v_mov_b32 v158, 0xc0135761
    v_mov_b32 v159, 0xc0135761
    v_mov_b32 v160, 0x3f800000
    v_mov_b32 v161, 0x3f800000
    s_barrier
    ds_read_b64_tr_b16 v[92:93], v10 offset:0
    ds_read_b64_tr_b16 v[94:95], v10 offset:1024
    ds_read_b64_tr_b16 v[108:109], v14 offset:0
    ds_read_b64_tr_b16 v[110:111], v14 offset:1024
    ds_read_b64_tr_b16 v[112:113], v15 offset:0
    ds_read_b64_tr_b16 v[114:115], v15 offset:1024
    ds_read_b64_tr_b16 v[116:117], v16 offset:0
    ds_read_b64_tr_b16 v[118:119], v16 offset:1024
    ds_read_b64_tr_b16 v[120:121], v17 offset:0
    ds_read_b64_tr_b16 v[122:123], v17 offset:1024
    ds_read_b64_tr_b16 v[96:97], v11 offset:0
    ds_read_b64_tr_b16 v[98:99], v11 offset:1024
    ds_read_b64_tr_b16 v[100:101], v12 offset:0
    ds_read_b64_tr_b16 v[102:103], v12 offset:1024
    ds_read_b64_tr_b16 v[104:105], v13 offset:0
    ds_read_b64_tr_b16 v[106:107], v13 offset:1024
    s_branch g3_cloop3
.p2align 3
g3_cloop:
    s_barrier
g3_cloop2:
    v_mfma_f32_16x16x32_bf16 v[28:31], v[124:127], v[140:143], v[28:31]
    ds_read_b64_tr_b16 v[92:93], v10 offset:0
    ds_read_b64_tr_b16 v[94:95], v10 offset:1024
    v_mfma_f32_16x16x32_bf16 v[32:35], v[124:127], v[144:147], v[32:35]
    ds_read_b64_tr_b16 v[108:109], v14 offset:0
    ds_read_b64_tr_b16 v[110:111], v14 offset:1024
    v_mfma_f32_16x16x32_bf16 v[36:39], v[124:127], v[148:151], v[36:39]
    ds_read_b64_tr_b16 v[112:113], v15 offset:0
    ds_read_b64_tr_b16 v[114:115], v15 offset:1024
    v_mfma_f32_16x16x32_bf16 v[40:43], v[124:127], v[152:155], v[40:43]
    ds_read_b64_tr_b16 v[116:117], v16 offset:0
    ds_read_b64_tr_b16 v[118:119], v16 offset:1024
    v_mfma_f32_16x16x32_bf16 v[56:59], v[128:131], v[152:155], v[56:59]
    ds_read_b64_tr_b16 v[120:121], v17 offset:0
    ds_read_b64_tr_b16 v[122:123], v17 offset:1024
    v_mfma_f32_16x16x32_bf16 v[52:55], v[128:131], v[148:151], v[52:55]
    ds_read_b64_tr_b16 v[96:97], v11 offset:0
    ds_read_b64_tr_b16 v[98:99], v11 offset:1024
    v_mfma_f32_16x16x32_bf16 v[48:51], v[128:131], v[144:147], v[48:51]
    ds_read_b64_tr_b16 v[100:101], v12 offset:0
    ds_read_b64_tr_b16 v[102:103], v12 offset:1024
    v_mfma_f32_16x16x32_bf16 v[44:47], v[128:131], v[140:143], v[44:47]
    ds_read_b64_tr_b16 v[104:105], v13 offset:0
    ds_read_b64_tr_b16 v[106:107], v13 offset:1024
    v_mfma_f32_16x16x32_bf16 v[60:63], v[132:135], v[140:143], v[60:63]
    v_mfma_f32_16x16x32_bf16 v[64:67], v[132:135], v[144:147], v[64:67]
    v_mfma_f32_16x16x32_bf16 v[68:71], v[132:135], v[148:151], v[68:71]
    v_mfma_f32_16x16x32_bf16 v[72:75], v[132:135], v[152:155], v[72:75]
    v_mfma_f32_16x16x32_bf16 v[88:91], v[136:139], v[152:155], v[88:91]
    v_mfma_f32_16x16x32_bf16 v[84:87], v[136:139], v[148:151], v[84:87]
    v_mfma_f32_16x16x32_bf16 v[80:83], v[136:139], v[144:147], v[80:83]
    v_mfma_f32_16x16x32_bf16 v[76:79], v[136:139], v[140:143], v[76:79]
g3_cloop3:
    s_waitcnt lgkmcnt(0)
    v_mfma_f32_16x16x32_bf16 v[28:31], v[92:95], v[108:111], v[28:31]
    ds_read_b64_tr_b16 v[124:125], v10 offset:8192
    ds_read_b64_tr_b16 v[126:127], v10 offset:9216
    v_mfma_f32_16x16x32_bf16 v[32:35], v[92:95], v[112:115], v[32:35]
    ds_read_b64_tr_b16 v[140:141], v14 offset:8192
    ds_read_b64_tr_b16 v[142:143], v14 offset:9216
    v_mfma_f32_16x16x32_bf16 v[36:39], v[92:95], v[116:119], v[36:39]
    ds_read_b64_tr_b16 v[144:145], v15 offset:8192
    ds_read_b64_tr_b16 v[146:147], v15 offset:9216
    v_mfma_f32_16x16x32_bf16 v[40:43], v[92:95], v[120:123], v[40:43]
    ds_read_b64_tr_b16 v[148:149], v16 offset:8192
    ds_read_b64_tr_b16 v[150:151], v16 offset:9216
    v_mfma_f32_16x16x32_bf16 v[56:59], v[96:99], v[120:123], v[56:59]
    ds_read_b64_tr_b16 v[152:153], v17 offset:8192
    ds_read_b64_tr_b16 v[154:155], v17 offset:9216
    v_mfma_f32_16x16x32_bf16 v[52:55], v[96:99], v[116:119], v[52:55]
    ds_read_b64_tr_b16 v[128:129], v11 offset:8192
    ds_read_b64_tr_b16 v[130:131], v11 offset:9216
    v_mfma_f32_16x16x32_bf16 v[48:51], v[96:99], v[112:115], v[48:51]
    ds_read_b64_tr_b16 v[132:133], v12 offset:8192
    ds_read_b64_tr_b16 v[134:135], v12 offset:9216
    v_mfma_f32_16x16x32_bf16 v[44:47], v[96:99], v[108:111], v[44:47]
    ds_read_b64_tr_b16 v[136:137], v13 offset:8192
    ds_read_b64_tr_b16 v[138:139], v13 offset:9216
    v_mfma_f32_16x16x32_bf16 v[60:63], v[100:103], v[108:111], v[60:63]
    s_add_u32 s50, s50, 1
    s_cmp_eq_u32 s50, 4
    v_mfma_f32_16x16x32_bf16 v[64:67], v[100:103], v[112:115], v[64:67]
    s_cselect_b32 s49, s29, s51
    s_cselect_b32 s50, 0, s50
    v_mfma_f32_16x16x32_bf16 v[68:71], v[100:103], v[116:119], v[68:71]
    v_add_u32 v10, s49, v10
    v_add_u32 v11, s49, v11
    v_mfma_f32_16x16x32_bf16 v[72:75], v[100:103], v[120:123], v[72:75]
    v_add_u32 v12, s49, v12
    v_add_u32 v13, s49, v13
    v_mfma_f32_16x16x32_bf16 v[88:91], v[104:107], v[120:123], v[88:91]
    v_add_u32 v14, s49, v14
    v_add_u32 v15, s49, v15
    v_mfma_f32_16x16x32_bf16 v[84:87], v[104:107], v[116:119], v[84:87]
    v_add_u32 v16, s49, v16
    v_add_u32 v17, s49, v17
    v_mfma_f32_16x16x32_bf16 v[80:83], v[104:107], v[112:115], v[80:83]
    s_sub_u32 s48, s48, 1
    s_cmp_lg_u32 s48, 0
    v_mfma_f32_16x16x32_bf16 v[76:79], v[104:107], v[108:111], v[76:79]
    s_waitcnt lgkmcnt(0)
    s_cbranch_scc1 g3_cloop
    v_mfma_f32_16x16x32_bf16 v[28:31], v[124:127], v[140:143], v[28:31]
    v_mfma_f32_16x16x32_bf16 v[44:47], v[128:131], v[140:143], v[44:47]
    v_mfma_f32_16x16x32_bf16 v[60:63], v[132:135], v[140:143], v[60:63]
    v_mfma_f32_16x16x32_bf16 v[76:79], v[136:139], v[140:143], v[76:79]
    v_mfma_f32_16x16x32_bf16 v[32:35], v[124:127], v[144:147], v[32:35]
    v_mfma_f32_16x16x32_bf16 v[48:51], v[128:131], v[144:147], v[48:51]
    v_mfma_f32_16x16x32_bf16 v[64:67], v[132:135], v[144:147], v[64:67]
    v_mfma_f32_16x16x32_bf16 v[80:83], v[136:139], v[144:147], v[80:83]
    s_nop 1
    v_mfma_f32_16x16x32_bf16 v[36:39], v[124:127], v[148:151], v[36:39]
    v_pk_mul_f32 v[108:109], v[28:29], v[28:29]
    v_pk_mul_f32 v[110:111], v[30:31], v[30:31]
    v_pk_mul_f32 v[112:113], v[44:45], v[44:45]
    v_pk_mul_f32 v[114:115], v[46:47], v[46:47]
    v_pk_fma_f32 v[108:109], v[108:109], v[156:157], v[158:159]
    v_pk_fma_f32 v[110:111], v[110:111], v[156:157], v[158:159]
    v_pk_fma_f32 v[112:113], v[112:113], v[156:157], v[158:159]
    v_pk_fma_f32 v[114:115], v[114:115], v[156:157], v[158:159]
    v_pk_mul_f32 v[108:109], v[108:109], v[28:29]
    v_pk_mul_f32 v[110:111], v[110:111], v[30:31]
    v_pk_mul_f32 v[112:113], v[112:113], v[44:45]
    v_pk_mul_f32 v[114:115], v[114:115], v[46:47]
    v_exp_f32 v108, v108
    v_exp_f32 v109, v109
    v_exp_f32 v110, v110
    v_exp_f32 v111, v111
    v_exp_f32 v112, v112
    v_exp_f32 v113, v113
    v_exp_f32 v114, v114
    v_exp_f32 v115, v115
    v_pk_add_f32 v[108:109], v[108:109], v[160:161]
    v_pk_add_f32 v[110:111], v[110:111], v[160:161]
    v_mfma_f32_16x16x32_bf16 v[52:55], v[128:131], v[148:151], v[52:55]
    v_pk_add_f32 v[112:113], v[112:113], v[160:161]
    v_pk_add_f32 v[114:115], v[114:115], v[160:161]
    v_rcp_f32 v108, v108
    v_rcp_f32 v109, v109
    v_rcp_f32 v110, v110
    v_rcp_f32 v111, v111
    v_rcp_f32 v112, v112
    v_rcp_f32 v113, v113
    v_rcp_f32 v114, v114
    v_rcp_f32 v115, v115
    v_pk_mul_f32 v[28:29], v[28:29], v[108:109]
    v_pk_mul_f32 v[30:31], v[30:31], v[110:111]
    v_pk_mul_f32 v[44:45], v[44:45], v[112:113]
    v_pk_mul_f32 v[46:47], v[46:47], v[114:115]
    v_cvt_pk_bf16_f32 v92, v28, v29
    v_cvt_pk_bf16_f32 v93, v30, v31
    v_cvt_pk_bf16_f32 v94, v44, v45
    v_cvt_pk_bf16_f32 v95, v46, v47
    s_nop 1
    v_permlane16_swap_b32 v92, v94
    v_permlane16_swap_b32 v93, v95
    buffer_store_dwordx4 v[92:95], v9, s[16:19], s52 offen offset:0 sc1
    v_mfma_f32_16x16x32_bf16 v[68:71], v[132:135], v[148:151], v[68:71]
    v_pk_mul_f32 v[108:109], v[60:61], v[60:61]
    v_pk_mul_f32 v[110:111], v[62:63], v[62:63]
    v_pk_mul_f32 v[112:113], v[76:77], v[76:77]
    v_pk_mul_f32 v[114:115], v[78:79], v[78:79]
    v_pk_fma_f32 v[108:109], v[108:109], v[156:157], v[158:159]
    v_pk_fma_f32 v[110:111], v[110:111], v[156:157], v[158:159]
    v_pk_fma_f32 v[112:113], v[112:113], v[156:157], v[158:159]
    v_pk_fma_f32 v[114:115], v[114:115], v[156:157], v[158:159]
    v_pk_mul_f32 v[108:109], v[108:109], v[60:61]
    v_pk_mul_f32 v[110:111], v[110:111], v[62:63]
    v_pk_mul_f32 v[112:113], v[112:113], v[76:77]
    v_pk_mul_f32 v[114:115], v[114:115], v[78:79]
    v_exp_f32 v108, v108
    v_exp_f32 v109, v109
    v_exp_f32 v110, v110
    v_exp_f32 v111, v111
    v_exp_f32 v112, v112
    v_exp_f32 v113, v113
    v_exp_f32 v114, v114
    v_exp_f32 v115, v115
    v_pk_add_f32 v[108:109], v[108:109], v[160:161]
    v_pk_add_f32 v[110:111], v[110:111], v[160:161]
    v_mfma_f32_16x16x32_bf16 v[84:87], v[136:139], v[148:151], v[84:87]
    v_pk_add_f32 v[112:113], v[112:113], v[160:161]
    v_pk_add_f32 v[114:115], v[114:115], v[160:161]
    v_rcp_f32 v108, v108
    v_rcp_f32 v109, v109
    v_rcp_f32 v110, v110
    v_rcp_f32 v111, v111
    v_rcp_f32 v112, v112
    v_rcp_f32 v113, v113
    v_rcp_f32 v114, v114
    v_rcp_f32 v115, v115
    v_pk_mul_f32 v[60:61], v[60:61], v[108:109]
    v_pk_mul_f32 v[62:63], v[62:63], v[110:111]
    v_pk_mul_f32 v[76:77], v[76:77], v[112:113]
    v_pk_mul_f32 v[78:79], v[78:79], v[114:115]
    v_cvt_pk_bf16_f32 v96, v60, v61
    v_cvt_pk_bf16_f32 v97, v62, v63
    v_cvt_pk_bf16_f32 v98, v76, v77
    v_cvt_pk_bf16_f32 v99, v78, v79
    s_nop 1
    v_permlane16_swap_b32 v96, v98
    v_permlane16_swap_b32 v97, v99
    buffer_store_dwordx4 v[96:99], v9, s[16:19], s52 offen offset:64 sc1
    v_mfma_f32_16x16x32_bf16 v[40:43], v[124:127], v[152:155], v[40:43]
    v_pk_mul_f32 v[108:109], v[32:33], v[32:33]
    v_pk_mul_f32 v[110:111], v[34:35], v[34:35]
    v_pk_mul_f32 v[112:113], v[48:49], v[48:49]
    v_pk_mul_f32 v[114:115], v[50:51], v[50:51]
    v_pk_fma_f32 v[108:109], v[108:109], v[156:157], v[158:159]
    v_pk_fma_f32 v[110:111], v[110:111], v[156:157], v[158:159]
    v_pk_fma_f32 v[112:113], v[112:113], v[156:157], v[158:159]
    v_pk_fma_f32 v[114:115], v[114:115], v[156:157], v[158:159]
    v_pk_mul_f32 v[108:109], v[108:109], v[32:33]
    v_pk_mul_f32 v[110:111], v[110:111], v[34:35]
    v_pk_mul_f32 v[112:113], v[112:113], v[48:49]
    v_pk_mul_f32 v[114:115], v[114:115], v[50:51]
    v_exp_f32 v108, v108
    v_exp_f32 v109, v109
    v_exp_f32 v110, v110
    v_exp_f32 v111, v111
    v_exp_f32 v112, v112
    v_exp_f32 v113, v113
    v_exp_f32 v114, v114
    v_exp_f32 v115, v115
    v_pk_add_f32 v[108:109], v[108:109], v[160:161]
    v_pk_add_f32 v[110:111], v[110:111], v[160:161]
    v_mfma_f32_16x16x32_bf16 v[56:59], v[128:131], v[152:155], v[56:59]
    v_pk_add_f32 v[112:113], v[112:113], v[160:161]
    v_pk_add_f32 v[114:115], v[114:115], v[160:161]
    v_rcp_f32 v108, v108
    v_rcp_f32 v109, v109
    v_rcp_f32 v110, v110
    v_rcp_f32 v111, v111
    v_rcp_f32 v112, v112
    v_rcp_f32 v113, v113
    v_rcp_f32 v114, v114
    v_rcp_f32 v115, v115
    v_pk_mul_f32 v[32:33], v[32:33], v[108:109]
    v_pk_mul_f32 v[34:35], v[34:35], v[110:111]
    v_pk_mul_f32 v[48:49], v[48:49], v[112:113]
    v_pk_mul_f32 v[50:51], v[50:51], v[114:115]
    v_cvt_pk_bf16_f32 v100, v32, v33
    v_cvt_pk_bf16_f32 v101, v34, v35
    v_cvt_pk_bf16_f32 v102, v48, v49
    v_cvt_pk_bf16_f32 v103, v50, v51
    s_nop 1
    v_permlane16_swap_b32 v100, v102
    v_permlane16_swap_b32 v101, v103
    buffer_store_dwordx4 v[100:103], v9, s[16:19], s53 offen offset:0 sc1
    v_mfma_f32_16x16x32_bf16 v[72:75], v[132:135], v[152:155], v[72:75]
    v_pk_mul_f32 v[108:109], v[64:65], v[64:65]
    v_pk_mul_f32 v[110:111], v[66:67], v[66:67]
    v_pk_mul_f32 v[112:113], v[80:81], v[80:81]
    v_pk_mul_f32 v[114:115], v[82:83], v[82:83]
    v_pk_fma_f32 v[108:109], v[108:109], v[156:157], v[158:159]
    v_pk_fma_f32 v[110:111], v[110:111], v[156:157], v[158:159]
    v_pk_fma_f32 v[112:113], v[112:113], v[156:157], v[158:159]
    v_pk_fma_f32 v[114:115], v[114:115], v[156:157], v[158:159]
    v_pk_mul_f32 v[108:109], v[108:109], v[64:65]
    v_pk_mul_f32 v[110:111], v[110:111], v[66:67]
    v_pk_mul_f32 v[112:113], v[112:113], v[80:81]
    v_pk_mul_f32 v[114:115], v[114:115], v[82:83]
    v_exp_f32 v108, v108
    v_exp_f32 v109, v109
    v_exp_f32 v110, v110
    v_exp_f32 v111, v111
    v_exp_f32 v112, v112
    v_exp_f32 v113, v113
    v_exp_f32 v114, v114
    v_exp_f32 v115, v115
    v_pk_add_f32 v[108:109], v[108:109], v[160:161]
    v_pk_add_f32 v[110:111], v[110:111], v[160:161]
    v_mfma_f32_16x16x32_bf16 v[88:91], v[136:139], v[152:155], v[88:91]
    v_pk_add_f32 v[112:113], v[112:113], v[160:161]
    v_pk_add_f32 v[114:115], v[114:115], v[160:161]
    v_rcp_f32 v108, v108
    v_rcp_f32 v109, v109
    v_rcp_f32 v110, v110
    v_rcp_f32 v111, v111
    v_rcp_f32 v112, v112
    v_rcp_f32 v113, v113
    v_rcp_f32 v114, v114
    v_rcp_f32 v115, v115
    v_pk_mul_f32 v[64:65], v[64:65], v[108:109]
    v_pk_mul_f32 v[66:67], v[66:67], v[110:111]
    v_pk_mul_f32 v[80:81], v[80:81], v[112:113]
    v_pk_mul_f32 v[82:83], v[82:83], v[114:115]
    v_cvt_pk_bf16_f32 v104, v64, v65
    v_cvt_pk_bf16_f32 v105, v66, v67
    v_cvt_pk_bf16_f32 v106, v80, v81
    v_cvt_pk_bf16_f32 v107, v82, v83
    s_nop 1
    v_permlane16_swap_b32 v104, v106
    v_permlane16_swap_b32 v105, v107
    buffer_store_dwordx4 v[104:107], v9, s[16:19], s53 offen offset:64 sc1
    v_pk_mul_f32 v[108:109], v[36:37], v[36:37]
    v_pk_mul_f32 v[110:111], v[38:39], v[38:39]
    v_pk_mul_f32 v[112:113], v[52:53], v[52:53]
    v_pk_mul_f32 v[114:115], v[54:55], v[54:55]
    v_pk_fma_f32 v[108:109], v[108:109], v[156:157], v[158:159]
    v_pk_fma_f32 v[110:111], v[110:111], v[156:157], v[158:159]
    v_pk_fma_f32 v[112:113], v[112:113], v[156:157], v[158:159]
    v_pk_fma_f32 v[114:115], v[114:115], v[156:157], v[158:159]
    v_pk_mul_f32 v[108:109], v[108:109], v[36:37]
    v_pk_mul_f32 v[110:111], v[110:111], v[38:39]
    v_pk_mul_f32 v[112:113], v[112:113], v[52:53]
    v_pk_mul_f32 v[114:115], v[114:115], v[54:55]
    v_exp_f32 v108, v108
    v_exp_f32 v109, v109
    v_exp_f32 v110, v110
    v_exp_f32 v111, v111
    v_exp_f32 v112, v112
    v_exp_f32 v113, v113
    v_exp_f32 v114, v114
    v_exp_f32 v115, v115
    v_pk_add_f32 v[108:109], v[108:109], v[160:161]
    v_pk_add_f32 v[110:111], v[110:111], v[160:161]
    v_pk_add_f32 v[112:113], v[112:113], v[160:161]
    v_pk_add_f32 v[114:115], v[114:115], v[160:161]
    v_rcp_f32 v108, v108
    v_rcp_f32 v109, v109
    v_rcp_f32 v110, v110
    v_rcp_f32 v111, v111
    v_rcp_f32 v112, v112
    v_rcp_f32 v113, v113
    v_rcp_f32 v114, v114
    v_rcp_f32 v115, v115
    v_pk_mul_f32 v[36:37], v[36:37], v[108:109]
    v_pk_mul_f32 v[38:39], v[38:39], v[110:111]
    v_pk_mul_f32 v[52:53], v[52:53], v[112:113]
    v_pk_mul_f32 v[54:55], v[54:55], v[114:115]
    v_cvt_pk_bf16_f32 v92, v36, v37
    v_cvt_pk_bf16_f32 v93, v38, v39
    v_cvt_pk_bf16_f32 v94, v52, v53
    v_cvt_pk_bf16_f32 v95, v54, v55
    s_nop 1
    v_permlane16_swap_b32 v92, v94
    v_permlane16_swap_b32 v93, v95
    buffer_store_dwordx4 v[92:95], v9, s[16:19], s54 offen offset:0 sc1
    v_pk_mul_f32 v[108:109], v[68:69], v[68:69]
    v_pk_mul_f32 v[110:111], v[70:71], v[70:71]
    v_pk_mul_f32 v[112:113], v[84:85], v[84:85]
    v_pk_mul_f32 v[114:115], v[86:87], v[86:87]
    v_pk_fma_f32 v[108:109], v[108:109], v[156:157], v[158:159]
    v_pk_fma_f32 v[110:111], v[110:111], v[156:157], v[158:159]
    v_pk_fma_f32 v[112:113], v[112:113], v[156:157], v[158:159]
    v_pk_fma_f32 v[114:115], v[114:115], v[156:157], v[158:159]
    v_pk_mul_f32 v[108:109], v[108:109], v[68:69]
    v_pk_mul_f32 v[110:111], v[110:111], v[70:71]
    v_pk_mul_f32 v[112:113], v[112:113], v[84:85]
    v_pk_mul_f32 v[114:115], v[114:115], v[86:87]
    v_exp_f32 v108, v108
    v_exp_f32 v109, v109
    v_exp_f32 v110, v110
    v_exp_f32 v111, v111
    v_exp_f32 v112, v112
    v_exp_f32 v113, v113
    v_exp_f32 v114, v114
    v_exp_f32 v115, v115
    v_pk_add_f32 v[108:109], v[108:109], v[160:161]
    v_pk_add_f32 v[110:111], v[110:111], v[160:161]
    v_pk_add_f32 v[112:113], v[112:113], v[160:161]
    v_pk_add_f32 v[114:115], v[114:115], v[160:161]
    v_rcp_f32 v108, v108
    v_rcp_f32 v109, v109
    v_rcp_f32 v110, v110
    v_rcp_f32 v111, v111
    v_rcp_f32 v112, v112
    v_rcp_f32 v113, v113
    v_rcp_f32 v114, v114
    v_rcp_f32 v115, v115
    v_pk_mul_f32 v[68:69], v[68:69], v[108:109]
    v_pk_mul_f32 v[70:71], v[70:71], v[110:111]
    v_pk_mul_f32 v[84:85], v[84:85], v[112:113]
    v_pk_mul_f32 v[86:87], v[86:87], v[114:115]
    v_cvt_pk_bf16_f32 v96, v68, v69
    v_cvt_pk_bf16_f32 v97, v70, v71
    v_cvt_pk_bf16_f32 v98, v84, v85
    v_cvt_pk_bf16_f32 v99, v86, v87
    s_nop 1
    v_permlane16_swap_b32 v96, v98
    v_permlane16_swap_b32 v97, v99
    buffer_store_dwordx4 v[96:99], v9, s[16:19], s54 offen offset:64 sc1
    v_pk_mul_f32 v[108:109], v[40:41], v[40:41]
    v_pk_mul_f32 v[110:111], v[42:43], v[42:43]
    v_pk_mul_f32 v[112:113], v[56:57], v[56:57]
    v_pk_mul_f32 v[114:115], v[58:59], v[58:59]
    v_pk_fma_f32 v[108:109], v[108:109], v[156:157], v[158:159]
    v_pk_fma_f32 v[110:111], v[110:111], v[156:157], v[158:159]
    v_pk_fma_f32 v[112:113], v[112:113], v[156:157], v[158:159]
    v_pk_fma_f32 v[114:115], v[114:115], v[156:157], v[158:159]
    v_pk_mul_f32 v[108:109], v[108:109], v[40:41]
    v_pk_mul_f32 v[110:111], v[110:111], v[42:43]
    v_pk_mul_f32 v[112:113], v[112:113], v[56:57]
    v_pk_mul_f32 v[114:115], v[114:115], v[58:59]
    v_exp_f32 v108, v108
    v_exp_f32 v109, v109
    v_exp_f32 v110, v110
    v_exp_f32 v111, v111
    v_exp_f32 v112, v112
    v_exp_f32 v113, v113
    v_exp_f32 v114, v114
    v_exp_f32 v115, v115
    v_pk_add_f32 v[108:109], v[108:109], v[160:161]
    v_pk_add_f32 v[110:111], v[110:111], v[160:161]
    v_pk_add_f32 v[112:113], v[112:113], v[160:161]
    v_pk_add_f32 v[114:115], v[114:115], v[160:161]
    v_rcp_f32 v108, v108
    v_rcp_f32 v109, v109
    v_rcp_f32 v110, v110
    v_rcp_f32 v111, v111
    v_rcp_f32 v112, v112
    v_rcp_f32 v113, v113
    v_rcp_f32 v114, v114
    v_rcp_f32 v115, v115
    v_pk_mul_f32 v[40:41], v[40:41], v[108:109]
    v_pk_mul_f32 v[42:43], v[42:43], v[110:111]
    v_pk_mul_f32 v[56:57], v[56:57], v[112:113]
    v_pk_mul_f32 v[58:59], v[58:59], v[114:115]
    v_cvt_pk_bf16_f32 v100, v40, v41
    v_cvt_pk_bf16_f32 v101, v42, v43
    v_cvt_pk_bf16_f32 v102, v56, v57
    v_cvt_pk_bf16_f32 v103, v58, v59
    s_nop 1
    v_permlane16_swap_b32 v100, v102
    v_permlane16_swap_b32 v101, v103
    buffer_store_dwordx4 v[100:103], v9, s[16:19], s55 offen offset:0 sc1
    v_pk_mul_f32 v[108:109], v[72:73], v[72:73]
    v_pk_mul_f32 v[110:111], v[74:75], v[74:75]
    v_pk_mul_f32 v[112:113], v[88:89], v[88:89]
    v_pk_mul_f32 v[114:115], v[90:91], v[90:91]
    v_pk_fma_f32 v[108:109], v[108:109], v[156:157], v[158:159]
    v_pk_fma_f32 v[110:111], v[110:111], v[156:157], v[158:159]
    v_pk_fma_f32 v[112:113], v[112:113], v[156:157], v[158:159]
    v_pk_fma_f32 v[114:115], v[114:115], v[156:157], v[158:159]
    v_pk_mul_f32 v[108:109], v[108:109], v[72:73]
    v_pk_mul_f32 v[110:111], v[110:111], v[74:75]
    v_pk_mul_f32 v[112:113], v[112:113], v[88:89]
    v_pk_mul_f32 v[114:115], v[114:115], v[90:91]
    v_exp_f32 v108, v108
    v_exp_f32 v109, v109
    v_exp_f32 v110, v110
    v_exp_f32 v111, v111
    v_exp_f32 v112, v112
    v_exp_f32 v113, v113
    v_exp_f32 v114, v114
    v_exp_f32 v115, v115
    v_pk_add_f32 v[108:109], v[108:109], v[160:161]
    v_pk_add_f32 v[110:111], v[110:111], v[160:161]
    v_pk_add_f32 v[112:113], v[112:113], v[160:161]
    v_pk_add_f32 v[114:115], v[114:115], v[160:161]
    v_rcp_f32 v108, v108
    v_rcp_f32 v109, v109
    v_rcp_f32 v110, v110
    v_rcp_f32 v111, v111
    v_rcp_f32 v112, v112
    v_rcp_f32 v113, v113
    v_rcp_f32 v114, v114
    v_rcp_f32 v115, v115
    v_pk_mul_f32 v[72:73], v[72:73], v[108:109]
    v_pk_mul_f32 v[74:75], v[74:75], v[110:111]
    v_pk_mul_f32 v[88:89], v[88:89], v[112:113]
    v_pk_mul_f32 v[90:91], v[90:91], v[114:115]
    v_cvt_pk_bf16_f32 v104, v72, v73
    v_cvt_pk_bf16_f32 v105, v74, v75
    v_cvt_pk_bf16_f32 v106, v88, v89
    v_cvt_pk_bf16_f32 v107, v90, v91
    s_nop 1
    v_permlane16_swap_b32 v104, v106
    v_permlane16_swap_b32 v105, v107
    buffer_store_dwordx4 v[104:107], v9, s[16:19], s55 offen offset:64 sc1
    s_cmp_ge_u32 s24, 14
    s_cselect_b32 s40, 25, 24
    s_lshl_b32 s41, s25, 1
    s_add_u32 s40, s40, s41
    s_lshl_b32 s40, s40, 8
    s_add_u32 s84, s4, 0x300000
    s_addc_u32 s85, s5, 0
    s_mov_b32 s86, 0x4000
    s_mov_b32 s87, 0x20000
    v_mov_b32 v3, s40
    v_mov_b32 v4, 1
    s_waitcnt vmcnt(0)
    s_barrier
    s_cmp_lg_u32 s28, 0
    s_cbranch_scc1 g3_cin
    s_mov_b64 exec, 1
    buffer_atomic_add v4, v3, s[84:87], 0 offen sc1
    s_mov_b64 exec, -1
g3_cin:
    s_branch g4_in
g3_spare:
    s_cmp_ge_u32 s2, 256
    s_cbranch_scc1 g3_done
    s_load_dwordx2 s[4:5], s[0:1], 80
    s_load_dwordx2 s[6:7], s[0:1], 48
    s_sub_u32 s3, s2, 224
    v_lshrrev_b32 v2, 6, v0
    v_lshlrev_b32 v1, 4, v0
    v_mov_b32 v8, -1
    v_mov_b32 v9, -1
    v_mov_b32 v10, -1
    v_mov_b32 v11, -1
    v_readfirstlane_b32 s28, v2
    s_lshl_b32 s13, s3, 17
    s_waitcnt lgkmcnt(0)
    s_add_u32 s4, s4, s97
    s_addc_u32 s5, s5, 0
    s_add_u32 s8, s4, 0x1d00000
    s_addc_u32 s9, s5, 0
    s_mov_b32 s10, 0x400000
    s_mov_b32 s11, 0x20000
    buffer_store_dwordx4 v[8:11], v1, s[8:11], s13 offen sc1
    s_add_u32 s13, s13, 8192
    buffer_store_dwordx4 v[8:11], v1, s[8:11], s13 offen sc1
    s_add_u32 s13, s13, 8192
    buffer_store_dwordx4 v[8:11], v1, s[8:11], s13 offen sc1
    s_add_u32 s13, s13, 8192
    buffer_store_dwordx4 v[8:11], v1, s[8:11], s13 offen sc1
    s_add_u32 s13, s13, 8192
    buffer_store_dwordx4 v[8:11], v1, s[8:11], s13 offen sc1
    s_add_u32 s13, s13, 8192
    buffer_store_dwordx4 v[8:11], v1, s[8:11], s13 offen sc1
    s_add_u32 s13, s13, 8192
    buffer_store_dwordx4 v[8:11], v1, s[8:11], s13 offen sc1
    s_add_u32 s13, s13, 8192
    buffer_store_dwordx4 v[8:11], v1, s[8:11], s13 offen sc1
    s_add_u32 s13, s13, 8192
    buffer_store_dwordx4 v[8:11], v1, s[8:11], s13 offen sc1
    s_add_u32 s13, s13, 8192
    buffer_store_dwordx4 v[8:11], v1, s[8:11], s13 offen sc1
    s_add_u32 s13, s13, 8192
    buffer_store_dwordx4 v[8:11], v1, s[8:11], s13 offen sc1
    s_add_u32 s13, s13, 8192
    buffer_store_dwordx4 v[8:11], v1, s[8:11], s13 offen sc1
    s_add_u32 s13, s13, 8192
    buffer_store_dwordx4 v[8:11], v1, s[8:11], s13 offen sc1
    s_add_u32 s13, s13, 8192
    buffer_store_dwordx4 v[8:11], v1, s[8:11], s13 offen sc1
    s_add_u32 s13, s13, 8192
    buffer_store_dwordx4 v[8:11], v1, s[8:11], s13 offen sc1
    s_add_u32 s13, s13, 8192
    buffer_store_dwordx4 v[8:11], v1, s[8:11], s13 offen sc1
    s_add_u32 s13, s13, 8192
    s_mov_b32 s40, 14336
    s_add_u32 s84, s4, 0x300000
    s_addc_u32 s85, s5, 0
    s_mov_b32 s86, 0x4000
    s_mov_b32 s87, 0x20000
    v_mov_b32 v3, s40
    v_mov_b32 v4, 1
    s_waitcnt vmcnt(0)
    s_barrier
    s_cmp_lg_u32 s28, 0
    s_cbranch_scc1 g3_spare_cin
    s_mov_b64 exec, 1
    buffer_atomic_add v4, v3, s[84:87], 0 offen sc1
    s_mov_b64 exec, -1
g3_spare_cin:
    s_cmp_lg_u32 s96, 0
    s_cbranch_scc1 g3_spare_end
g3_spare_end:
    s_branch g4_in
.p2align 6
g4_in:
    s_cmp_ge_u32 s2, 256
    s_cbranch_scc1 g4_done
    s_load_dwordx2 s[4:5], s[0:1], 80
    s_load_dwordx2 s[6:7], s[0:1], 64
    s_load_dwordx2 s[30:31], s[0:1], 48
    s_load_dwordx2 s[34:35], s[0:1], 56
    v_lshrrev_b32 v1, 6, v0
    v_and_b32 v2, 63, v0
    s_bfe_u32 s40, s2, 0x10001
    s_lshl_b32 s40, s40, 2
    s_bfe_u32 s41, s2, 0x20003
    s_add_u32 s24, s40, s41
    s_bfe_u32 s40, s2, 0x10002
    s_lshl_b32 s40, s40, 3
    s_lshr_b32 s42, s2, 5
    s_add_u32 s25, s40, s42
    s_and_b32 s91, s2, 1
    s_add_u32 s27, s41, s42
    s_lshl_b32 s92, s24, 4
    s_add_u32 s92, s92, s25
    s_mul_i32 s26, s91, 28
    s_cmp_eq_u32 s96, 0
    s_cselect_b32 s95, 3, 1
    v_readfirstlane_b32 s28, v1
    s_nop 0
    s_cmp_lt_u32 s28, 4
    s_cbranch_scc1 g4_compute
    s_sub_u32 s28, s28, 4
    s_mov_b32 s40, 8192
    v_lshrrev_b32 v3, 3, v2
    v_mul_lo_u32 v3, v3, s40
    v_lshrrev_b32 v4, 4, v2
    v_xor_b32 v4, v4, v2
    v_and_b32 v4, 7, v4
    v_lshl_add_u32 v3, v4, 4, v3
    s_mul_i32 s41, s24, 1048576
    s_mul_i32 s42, s28, 262144
    s_add_u32 s41, s41, s42
    v_xor_b32 v4, 64, v3
    s_add_u32 s42, s41, 0
    v_add_u32 v10, s42, v3
    s_add_u32 s42, s41, 65536
    v_add_u32 v11, s42, v4
    s_add_u32 s42, s41, 131072
    v_add_u32 v12, s42, v3
    s_add_u32 s42, s41, 196608
    v_add_u32 v13, s42, v4
    s_mov_b32 s40, 4096
    v_lshrrev_b32 v4, 4, v2
    v_mul_lo_u32 v3, v4, s40
    v_lshlrev_b32 v4, 1, v4
    v_xor_b32 v4, v4, v2
    v_and_b32 v4, 15, v4
    v_lshl_add_u32 v3, v4, 4, v3
    s_mul_i32 s41, s25, 256
    s_mul_i32 s42, s28, 65536
    s_add_u32 s41, s41, s42
    v_xor_b32 v4, 128, v3
    s_add_u32 s42, s41, 0
    v_add_u32 v14, s42, v3
    s_add_u32 s42, s41, 16384
    v_add_u32 v15, s42, v3
    s_add_u32 s42, s41, 32768
    v_add_u32 v16, s42, v4
    s_add_u32 s42, s41, 49152
    v_add_u32 v17, s42, v4
    s_mul_i32 s36, s28, 4096
    s_mul_i32 s37, s28, 4096
    s_add_u32 s37, s37, 16384
    s_waitcnt lgkmcnt(0)
    s_add_u32 s4, s4, s97
    s_addc_u32 s5, s5, 0
    s_add_u32 s8, s4, 0x1100000
    s_addc_u32 s9, s5, 0
    s_mov_b32 s10, 0x800000
    s_mov_b32 s11, 0x20000
    s_mov_b32 s12, s30
    s_mov_b32 s13, s31
    s_mov_b32 s14, 0xe00000
    s_mov_b32 s15, 0x20000
    s_mov_b32 s32, 0
    s_mov_b32 s33, 0
g4_ld_pW:
    s_add_u32 s40, s32, s27
    s_and_b32 s40, s40, s95
    s_andn2_b32 s41, s32, s95
    s_or_b32 s40, s40, s41
    s_add_u32 s40, s40, s26
    s_mul_i32 s34, s40, 128
    s_mul_i32 s35, s40, 262144
    s_add_u32 s38, s33, s36
    s_add_u32 s39, s33, s37
    s_add_u32 m0, s39, 0
    s_nop 0
    buffer_load_dwordx4 v14, s[12:15], s35 offen lds
    s_add_u32 m0, s39, 1024
    s_nop 0
    buffer_load_dwordx4 v15, s[12:15], s35 offen lds
    s_add_u32 m0, s39, 2048
    s_nop 0
    buffer_load_dwordx4 v16, s[12:15], s35 offen lds
    s_add_u32 m0, s39, 3072
    s_nop 0
    buffer_load_dwordx4 v17, s[12:15], s35 offen lds
    s_add_u32 s33, s33, 32768
    s_add_u32 s32, s32, 1
    s_cmp_lt_u32 s32, 4
    s_cbranch_scc1 g4_ld_pW
    s_lshl_b32 s40, s24, 1
    s_add_u32 s40, s40, s91
    s_add_u32 s40, s40, 24
    s_lshl_b32 s40, s40, 8
    s_mov_b32 s42, 14336
    s_cmp_lg_u32 s28, 0
    s_cbranch_scc1 g4_dep_set
    s_add_u32 s84, s4, 0x300000
    s_addc_u32 s85, s5, 0
    s_mov_b32 s86, 0x4000
    s_mov_b32 s87, 0x20000
    v_cmp_eq_u32 vcc, 1, v2
    v_mov_b32 v21, s40
    v_mov_b32 v23, s42
    v_cndmask_b32 v21, v21, v23, vcc
    v_mov_b32 v22, 14
    v_mov_b32 v23, 32
    v_cndmask_b32 v22, v22, v23, vcc
    buffer_load_dword v23, v21, s[84:87], 0 offen sc1
g4_dep_set:
    s_lshl_b32 s43, s96, 2
    s_add_u32 s43, s43, 4
    s_mov_b32 s41, 0x800000
    v_mov_b32 v24, 131072
    s_cmp_lg_u32 s28, 0
    s_cbranch_scc1 g4_dep_lds
    s_mov_b32 s41, 0x40000
    s_waitcnt vmcnt(0)
g4_dep:
    v_cmp_lt_u32 vcc, v23, v22
    s_sub_u32 s41, s41, 1
    s_cmp_eq_u32 s41, 0
    s_cbranch_scc1 g4_dep_seen
    s_cbranch_vccz g4_dep_seen
    s_sleep 2
    buffer_load_dword v23, v21, s[84:87], 0 offen sc1
    s_waitcnt vmcnt(0)
    s_branch g4_dep
g4_dep_seen:
    v_mov_b32 v23, s43
    ds_write_b32 v24, v23
    s_branch g4_dep_ok
g4_dep_lds:
    ds_read_b32 v23, v24
    s_sub_u32 s41, s41, 1
    s_waitcnt lgkmcnt(0)
    v_readfirstlane_b32 s40, v23
    s_cmp_eq_u32 s41, 0
    s_cbranch_scc1 g4_dep_ok
    s_cmp_eq_u32 s40, s43
    s_cbranch_scc1 g4_dep_ok
    s_sleep 1
    s_branch g4_dep_lds
g4_dep_ok:
    s_mov_b32 s32, 0
    s_mov_b32 s33, 0
g4_ld_pA:
    s_add_u32 s40, s32, s27
    s_and_b32 s40, s40, s95
    s_andn2_b32 s41, s32, s95
    s_or_b32 s40, s40, s41
    s_add_u32 s40, s40, s26
    s_mul_i32 s34, s40, 128
    s_mul_i32 s35, s40, 262144
    s_add_u32 s38, s33, s36
    s_add_u32 s39, s33, s37
    s_add_u32 m0, s38, 0
    s_nop 0
    buffer_load_dwordx4 v10, s[8:11], s34 offen sc1 lds
    s_add_u32 m0, s38, 1024
    s_nop 0
    buffer_load_dwordx4 v11, s[8:11], s34 offen sc1 lds
    s_add_u32 m0, s38, 2048
    s_nop 0
    buffer_load_dwordx4 v12, s[8:11], s34 offen sc1 lds
    s_add_u32 m0, s38, 3072
    s_nop 0
    buffer_load_dwordx4 v13, s[8:11], s34 offen sc1 lds
    s_add_u32 s33, s33, 32768
    s_add_u32 s32, s32, 1
    s_cmp_lt_u32 s32, 3
    s_cbranch_scc1 g4_ld_pA
    s_waitcnt vmcnt(8)
    s_barrier
    s_add_u32 s40, s32, s27
    s_and_b32 s40, s40, s95
    s_andn2_b32 s41, s32, s95
    s_or_b32 s40, s40, s41
    s_add_u32 s40, s40, s26
    s_mul_i32 s34, s40, 128
    s_mul_i32 s35, s40, 262144
    s_add_u32 s38, s33, s36
    s_add_u32 s39, s33, s37
    s_add_u32 m0, s38, 0
    s_nop 0
    buffer_load_dwordx4 v10, s[8:11], s34 offen sc1 lds
    s_add_u32 m0, s38, 1024
    s_nop 0
    buffer_load_dwordx4 v11, s[8:11], s34 offen sc1 lds
    s_add_u32 m0, s38, 2048
    s_nop 0
    buffer_load_dwordx4 v12, s[8:11], s34 offen sc1 lds
    s_add_u32 m0, s38, 3072
    s_nop 0
    buffer_load_dwordx4 v13, s[8:11], s34 offen sc1 lds
    s_mov_b32 s33, 0
    s_add_u32 s32, s32, 1
g4_ld_loop:
    s_cmp_eq_u32 s32, 4
    s_cbranch_scc1 g4_ld_s4
    s_cmp_eq_u32 s32, 5
    s_cbranch_scc1 g4_ld_s5
    s_waitcnt vmcnt(16)
g4_ld_bar:
    s_barrier
    s_add_u32 s40, s32, s27
    s_and_b32 s40, s40, s95
    s_andn2_b32 s41, s32, s95
    s_or_b32 s40, s40, s41
    s_add_u32 s40, s40, s26
    s_mul_i32 s34, s40, 128
    s_mul_i32 s35, s40, 262144
    s_add_u32 s38, s33, s36
    s_add_u32 s39, s33, s37
    s_add_u32 m0, s38, 0
    s_nop 0
    buffer_load_dwordx4 v10, s[8:11], s34 offen sc1 lds
    s_add_u32 m0, s38, 1024
    s_nop 0
    buffer_load_dwordx4 v11, s[8:11], s34 offen sc1 lds
    s_add_u32 m0, s38, 2048
    s_nop 0
    buffer_load_dwordx4 v12, s[8:11], s34 offen sc1 lds
    s_add_u32 m0, s38, 3072
    s_nop 0
    buffer_load_dwordx4 v13, s[8:11], s34 offen sc1 lds
    s_add_u32 m0, s39, 0
    s_nop 0
    buffer_load_dwordx4 v14, s[12:15], s35 offen lds
    s_add_u32 m0, s39, 1024
    s_nop 0
    buffer_load_dwordx4 v15, s[12:15], s35 offen lds
    s_add_u32 m0, s39, 2048
    s_nop 0
    buffer_load_dwordx4 v16, s[12:15], s35 offen lds
    s_add_u32 m0, s39, 3072
    s_nop 0
    buffer_load_dwordx4 v17, s[12:15], s35 offen lds
    s_add_u32 s33, s33, 32768
    s_add_u32 s32, s32, 1
    s_cmp_eq_u32 s33, 131072
    s_cselect_b32 s33, 0, s33
    s_cmp_lt_u32 s32, 28
    s_cbranch_scc1 g4_ld_loop
    s_waitcnt vmcnt(16)
    s_barrier
    s_waitcnt vmcnt(8)
    s_barrier
    s_waitcnt vmcnt(0)
    s_barrier
    s_branch g4_ld_end
g4_ld_s4:
    s_waitcnt vmcnt(8)
    s_branch g4_ld_bar
g4_ld_s5:
    s_waitcnt vmcnt(12)
    s_branch g4_ld_bar
g4_ld_end:
    s_cmp_lg_u32 s96, 0
    s_cbranch_scc1 g4_done
    s_barrier
    s_mov_b32 s96, 1
    s_mov_b32 s97, 0x2800000
    s_branch g1_in
g4_done:
    s_endpgm
g4_compute:
    v_lshrrev_b32 v5, 4, v2
    v_bfe_u32 v6, v2, 2, 2
    v_and_b32 v7, 3, v2
    v_and_b32 v8, 15, v2
    s_and_b32 s44, s28, 1
    s_lshr_b32 s45, s28, 1
    s_mul_i32 s40, s25, 128
    s_mul_i32 s41, s45, 64
    s_add_u32 s40, s40, s41
    s_lshl_b32 s41, s91, 5
    s_add_u32 s40, s40, s41
    v_add_u32 v20, s40, v8
    s_mov_b32 s41, 2048
    v_mul_lo_u32 v9, v20, s41
    s_mul_i32 s40, s24, 256
    s_mul_i32 s41, s44, 128
    s_add_u32 s46, s40, s41
    v_and_b32 v3, 1, v5
    v_lshlrev_b32 v3, 5, v3
    v_lshrrev_b32 v4, 1, v5
    v_lshl_add_u32 v3, v4, 4, v3
    v_add3_u32 v9, v9, v3, s46
    s_mov_b32 s52, 0
    s_mov_b32 s53, 32768
    s_mov_b32 s54, 65536
    s_mov_b32 s55, 98304
    s_waitcnt lgkmcnt(0)
    s_add_u32 s4, s4, s97
    s_addc_u32 s5, s5, 0
    s_add_u32 s20, s4, 0x800000
    s_addc_u32 s21, s5, 0
    s_mov_b32 s22, 0x400000
    s_mov_b32 s23, 0x20000
    s_mov_b32 s56, s34
    s_mov_b32 s57, s35
    s_mov_b32 s58, 0x1000
    s_mov_b32 s59, 0x20000
    s_add_u32 s16, s4, 0x4100000
    s_addc_u32 s17, s5, 0
    s_cmp_eq_u32 s96, 0
    s_cselect_b32 s16, s16, s6
    s_cselect_b32 s17, s17, s7
    s_mov_b32 s18, 0x400000
    s_mov_b32 s19, 0x20000
    s_add_u32 s60, s4, 0x2800000
    s_addc_u32 s61, s5, 0
    s_mov_b32 s62, 0x40000
    s_mov_b32 s63, 0x20000
    s_add_u32 s84, s4, 0x1d00000
    s_addc_u32 s85, s5, 0
    s_mov_b32 s86, 0x400000
    s_mov_b32 s87, 0x20000
    s_mul_i32 s42, s44, 64
    v_lshrrev_b32 v3, 1, v8
    v_xor_b32 v3, v3, v5
    v_lshlrev_b32 v3, 4, v3
    v_lshl_add_u32 v3, v8, 7, v3
    s_lshl_b32 s40, s42, 7
    s_add_u32 s40, s40, 0
    v_add_u32 v10, s40, v3
    v_xor_b32 v11, 64, v10
    s_lshl_b32 s90, s91, 1
    s_mul_i32 s42, s45, 4
    s_mov_b32 s43, 16384
    v_and_b32 v3, 1, v5
    v_lshl_or_b32 v3, v3, 2, v6
    s_add_u32 s40, s42, 0
    s_xor_b32 s40, s40, s90
    v_xor_b32 v3, s40, v3
    v_lshlrev_b32 v3, 5, v3
    v_lshl_add_u32 v3, v7, 3, v3
    v_lshl_add_u32 v4, v5, 3, v6
    v_lshl_add_u32 v3, v4, 8, v3
    v_add_u32 v12, s43, v3
    v_and_b32 v3, 1, v5
    v_lshl_or_b32 v3, v3, 2, v6
    s_add_u32 s40, s42, 1
    s_xor_b32 s40, s40, s90
    v_xor_b32 v3, s40, v3
    v_lshlrev_b32 v3, 5, v3
    v_lshl_add_u32 v3, v7, 3, v3
    v_lshl_add_u32 v4, v5, 3, v6
    v_lshl_add_u32 v3, v4, 8, v3
    v_add_u32 v13, s43, v3
    v_and_b32 v3, 1, v5
    v_lshl_or_b32 v3, v3, 2, v6
    s_add_u32 s40, s42, 2
    s_xor_b32 s40, s40, s90
    v_xor_b32 v3, s40, v3
    v_lshlrev_b32 v3, 5, v3
    v_lshl_add_u32 v3, v7, 3, v3
    v_lshl_add_u32 v4, v5, 3, v6
    v_lshl_add_u32 v3, v4, 8, v3
    v_add_u32 v14, s43, v3
    v_and_b32 v3, 1, v5
    v_lshl_or_b32 v3, v3, 2, v6
    s_add_u32 s40, s42, 3
    s_xor_b32 s40, s40, s90
    v_xor_b32 v3, s40, v3
    v_lshlrev_b32 v3, 5, v3
    v_lshl_add_u32 v3, v7, 3, v3
    v_lshl_add_u32 v4, v5, 3, v6
    v_lshl_add_u32 v3, v4, 8, v3
    v_add_u32 v15, s43, v3
    s_mov_b32 s48, 28
    s_mov_b32 s50, 0
    s_mov_b32 s51, 32768
    s_mov_b32 s29, 0xfffe8000
    s_lshl_b32 s40, s28, 12
    v_lshl_add_u32 v21, v2, 4, s40
    s_lshl_b32 s93, s92, 1
    s_add_u32 s93, s93, s91
    s_lshl_b32 s93, s93, 14
    s_xor_b32 s94, s93, 0x4000
    v_mov_b32 v28, 0
    v_mov_b32 v29, 0
    v_mov_b32 v30, 0
    v_mov_b32 v31, 0
    v_mov_b32 v32, 0
    v_mov_b32 v33, 0
    v_mov_b32 v34, 0
    v_mov_b32 v35, 0
    v_mov_b32 v36, 0
    v_mov_b32 v37, 0
    v_mov_b32 v38, 0
    v_mov_b32 v39, 0
    v_mov_b32 v40, 0
    v_mov_b32 v41, 0
    v_mov_b32 v42, 0
    v_mov_b32 v43, 0
    v_mov_b32 v44, 0
    v_mov_b32 v45, 0
    v_mov_b32 v46, 0
    v_mov_b32 v47, 0
    v_mov_b32 v48, 0
    v_mov_b32 v49, 0
    v_mov_b32 v50, 0
    v_mov_b32 v51, 0
    v_mov_b32 v52, 0
    v_mov_b32 v53, 0
    v_mov_b32 v54, 0
    v_mov_b32 v55, 0
    v_mov_b32 v56, 0
    v_mov_b32 v57, 0
    v_mov_b32 v58, 0
    v_mov_b32 v59, 0
    v_mov_b32 v60, 0
    v_mov_b32 v61, 0
    v_mov_b32 v62, 0
    v_mov_b32 v63, 0
    v_mov_b32 v64, 0
    v_mov_b32 v65, 0
    v_mov_b32 v66, 0
    v_mov_b32 v67, 0
    v_mov_b32 v68, 0
    v_mov_b32 v69, 0
    v_mov_b32 v70, 0
    v_mov_b32 v71, 0
    v_mov_b32 v72, 0
    v_mov_b32 v73, 0
    v_mov_b32 v74, 0
    v_mov_b32 v75, 0
    v_mov_b32 v76, 0
    v_mov_b32 v77, 0
    v_mov_b32 v78, 0
    v_mov_b32 v79, 0
    v_mov_b32 v80, 0
    v_mov_b32 v81, 0
    v_mov_b32 v82, 0
    v_mov_b32 v83, 0
    v_mov_b32 v84, 0
    v_mov_b32 v85, 0
    v_mov_b32 v86, 0
    v_mov_b32 v87, 0
    v_mov_b32 v88, 0
    v_mov_b32 v89, 0
    v_mov_b32 v90, 0
    v_mov_b32 v91, 0
    s_barrier
    ds_read_b128 v[92:95], v10 offset:0
    ds_read_b64_tr_b16 v[108:109], v12 offset:0
    ds_read_b64_tr_b16 v[110:111], v12 offset:1024
    ds_read_b64_tr_b16 v[112:113], v13 offset:0
    ds_read_b64_tr_b16 v[114:115], v13 offset:1024
    ds_read_b64_tr_b16 v[116:117], v14 offset:0
    ds_read_b64_tr_b16 v[118:119], v14 offset:1024
    ds_read_b64_tr_b16 v[120:121], v15 offset:0
    ds_read_b64_tr_b16 v[122:123], v15 offset:1024
    ds_read_b128 v[96:99], v10 offset:2048
    ds_read_b128 v[100:103], v10 offset:4096
    ds_read_b128 v[104:107], v10 offset:6144
    buffer_load_dwordx4 v[188:191], v9, s[20:23], s52 offen offset:0 sc1
    buffer_load_dwordx4 v[192:195], v9, s[20:23], s52 offen offset:64 sc1
    buffer_load_dwordx4 v[196:199], v9, s[20:23], s53 offen offset:0 sc1
    buffer_load_dwordx4 v[200:203], v9, s[20:23], s53 offen offset:64 sc1
    v_lshlrev_b32 v3, 1, v20
    buffer_load_ushort v22, v3, s[56:59], 0 offen offset:0
    buffer_load_ushort v23, v3, s[56:59], 0 offen offset:32
    s_branch g4_cloop3
.p2align 3
g4_cloop:
    s_barrier
g4_cloop2:
    v_mfma_f32_16x16x32_bf16 v[28:31], v[124:127], v[140:143], v[28:31]
    ds_read_b128 v[92:95], v10 offset:0
    v_mfma_f32_16x16x32_bf16 v[32:35], v[124:127], v[144:147], v[32:35]
    ds_read_b64_tr_b16 v[108:109], v12 offset:0
    ds_read_b64_tr_b16 v[110:111], v12 offset:1024
    v_mfma_f32_16x16x32_bf16 v[36:39], v[124:127], v[148:151], v[36:39]
    ds_read_b64_tr_b16 v[112:113], v13 offset:0
    ds_read_b64_tr_b16 v[114:115], v13 offset:1024
    v_mfma_f32_16x16x32_bf16 v[40:43], v[124:127], v[152:155], v[40:43]
    ds_read_b64_tr_b16 v[116:117], v14 offset:0
    ds_read_b64_tr_b16 v[118:119], v14 offset:1024
    v_mfma_f32_16x16x32_bf16 v[56:59], v[128:131], v[152:155], v[56:59]
    ds_read_b64_tr_b16 v[120:121], v15 offset:0
    ds_read_b64_tr_b16 v[122:123], v15 offset:1024
    v_mfma_f32_16x16x32_bf16 v[52:55], v[128:131], v[148:151], v[52:55]
    ds_read_b128 v[96:99], v10 offset:2048
    v_mfma_f32_16x16x32_bf16 v[48:51], v[128:131], v[144:147], v[48:51]
    ds_read_b128 v[100:103], v10 offset:4096
    v_mfma_f32_16x16x32_bf16 v[44:47], v[128:131], v[140:143], v[44:47]
    ds_read_b128 v[104:107], v10 offset:6144
    v_mfma_f32_16x16x32_bf16 v[60:63], v[132:135], v[140:143], v[60:63]
    v_mfma_f32_16x16x32_bf16 v[64:67], v[132:135], v[144:147], v[64:67]
    v_mfma_f32_16x16x32_bf16 v[68:71], v[132:135], v[148:151], v[68:71]
    v_mfma_f32_16x16x32_bf16 v[72:75], v[132:135], v[152:155], v[72:75]
    v_mfma_f32_16x16x32_bf16 v[88:91], v[136:139], v[152:155], v[88:91]
    v_mfma_f32_16x16x32_bf16 v[84:87], v[136:139], v[148:151], v[84:87]
    v_mfma_f32_16x16x32_bf16 v[80:83], v[136:139], v[144:147], v[80:83]
    v_mfma_f32_16x16x32_bf16 v[76:79], v[136:139], v[140:143], v[76:79]
g4_cloop3:
    s_waitcnt lgkmcnt(0)
    v_mfma_f32_16x16x32_bf16 v[28:31], v[92:95], v[108:111], v[28:31]
    ds_read_b128 v[124:127], v11 offset:0
    v_mfma_f32_16x16x32_bf16 v[32:35], v[92:95], v[112:115], v[32:35]
    ds_read_b64_tr_b16 v[140:141], v12 offset:8192
    ds_read_b64_tr_b16 v[142:143], v12 offset:9216
    v_mfma_f32_16x16x32_bf16 v[36:39], v[92:95], v[116:119], v[36:39]
    ds_read_b64_tr_b16 v[144:145], v13 offset:8192
    ds_read_b64_tr_b16 v[146:147], v13 offset:9216
    v_mfma_f32_16x16x32_bf16 v[40:43], v[92:95], v[120:123], v[40:43]
    ds_read_b64_tr_b16 v[148:149], v14 offset:8192
    ds_read_b64_tr_b16 v[150:151], v14 offset:9216
    v_mfma_f32_16x16x32_bf16 v[56:59], v[96:99], v[120:123], v[56:59]
    ds_read_b64_tr_b16 v[152:153], v15 offset:8192
    ds_read_b64_tr_b16 v[154:155], v15 offset:9216
    v_mfma_f32_16x16x32_bf16 v[52:55], v[96:99], v[116:119], v[52:55]
    ds_read_b128 v[128:131], v11 offset:2048
    v_mfma_f32_16x16x32_bf16 v[48:51], v[96:99], v[112:115], v[48:51]
    ds_read_b128 v[132:135], v11 offset:4096
    v_mfma_f32_16x16x32_bf16 v[44:47], v[96:99], v[108:111], v[44:47]
    ds_read_b128 v[136:139], v11 offset:6144
    v_mfma_f32_16x16x32_bf16 v[60:63], v[100:103], v[108:111], v[60:63]
    s_add_u32 s50, s50, 1
    s_cmp_eq_u32 s50, 4
    v_mfma_f32_16x16x32_bf16 v[64:67], v[100:103], v[112:115], v[64:67]
    s_cselect_b32 s49, s29, s51
    s_cselect_b32 s50, 0, s50
    v_mfma_f32_16x16x32_bf16 v[68:71], v[100:103], v[116:119], v[68:71]
    v_add_u32 v10, s49, v10
    v_add_u32 v11, s49, v11
    v_mfma_f32_16x16x32_bf16 v[72:75], v[100:103], v[120:123], v[72:75]
    v_add_u32 v12, s49, v12
    v_add_u32 v13, s49, v13
    v_mfma_f32_16x16x32_bf16 v[88:91], v[104:107], v[120:123], v[88:91]
    v_add_u32 v14, s49, v14
    v_add_u32 v15, s49, v15
    v_mfma_f32_16x16x32_bf16 v[84:87], v[104:107], v[116:119], v[84:87]
    s_sub_u32 s48, s48, 1
    s_cmp_lg_u32 s48, 0
    v_mfma_f32_16x16x32_bf16 v[80:83], v[104:107], v[112:115], v[80:83]
    v_mfma_f32_16x16x32_bf16 v[76:79], v[104:107], v[108:111], v[76:79]
    s_waitcnt lgkmcnt(0)
    s_cbranch_scc1 g4_cloop
    v_mfma_f32_16x16x32_bf16 v[36:39], v[124:127], v[148:151], v[36:39]
    v_mfma_f32_16x16x32_bf16 v[52:55], v[128:131], v[148:151], v[52:55]
    v_mfma_f32_16x16x32_bf16 v[68:71], v[132:135], v[148:151], v[68:71]
    v_mfma_f32_16x16x32_bf16 v[84:87], v[136:139], v[148:151], v[84:87]
    v_mfma_f32_16x16x32_bf16 v[40:43], v[124:127], v[152:155], v[40:43]
    v_mfma_f32_16x16x32_bf16 v[56:59], v[128:131], v[152:155], v[56:59]
    v_mfma_f32_16x16x32_bf16 v[72:75], v[132:135], v[152:155], v[72:75]
    v_mfma_f32_16x16x32_bf16 v[88:91], v[136:139], v[152:155], v[88:91]
    v_mfma_f32_16x16x32_bf16 v[28:31], v[124:127], v[140:143], v[28:31]
    v_cvt_pk_bf16_f32 v156, v36, v37
    v_cvt_pk_bf16_f32 v157, v38, v39
    v_mfma_f32_16x16x32_bf16 v[44:47], v[128:131], v[140:143], v[44:47]
    v_cvt_pk_bf16_f32 v158, v52, v53
    v_cvt_pk_bf16_f32 v159, v54, v55
    buffer_store_dwordx4 v[156:159], v21, s[84:87], s93 offen offset:0 sc1
    v_mfma_f32_16x16x32_bf16 v[60:63], v[132:135], v[140:143], v[60:63]
    v_cvt_pk_bf16_f32 v160, v68, v69
    v_cvt_pk_bf16_f32 v161, v70, v71
    v_mfma_f32_16x16x32_bf16 v[76:79], v[136:139], v[140:143], v[76:79]
    v_cvt_pk_bf16_f32 v162, v84, v85
    v_cvt_pk_bf16_f32 v163, v86, v87
    buffer_store_dwordx4 v[160:163], v21, s[84:87], s93 offen offset:1024 sc1
    v_mfma_f32_16x16x32_bf16 v[32:35], v[124:127], v[144:147], v[32:35]
    v_cvt_pk_bf16_f32 v164, v40, v41
    v_cvt_pk_bf16_f32 v165, v42, v43
    v_mfma_f32_16x16x32_bf16 v[48:51], v[128:131], v[144:147], v[48:51]
    v_cvt_pk_bf16_f32 v166, v56, v57
    v_cvt_pk_bf16_f32 v167, v58, v59
    buffer_store_dwordx4 v[164:167], v21, s[84:87], s93 offen offset:2048 sc1
    v_mfma_f32_16x16x32_bf16 v[64:67], v[132:135], v[144:147], v[64:67]
    v_cvt_pk_bf16_f32 v168, v72, v73
    v_cvt_pk_bf16_f32 v169, v74, v75
    v_mfma_f32_16x16x32_bf16 v[80:83], v[136:139], v[144:147], v[80:83]
    s_nop 1
    v_cvt_pk_bf16_f32 v170, v88, v89
    v_cvt_pk_bf16_f32 v171, v90, v91
    buffer_store_dwordx4 v[168:171], v21, s[84:87], s93 offen offset:3072 sc1
    s_mov_b32 s48, 0x40000
    buffer_load_dwordx4 v[172:175], v21, s[84:87], s94 offen offset:0 sc1
    buffer_load_dwordx4 v[176:179], v21, s[84:87], s94 offen offset:1024 sc1
    buffer_load_dwordx4 v[180:183], v21, s[84:87], s94 offen offset:2048 sc1
    buffer_load_dwordx4 v[184:187], v21, s[84:87], s94 offen offset:3072 sc1
    s_waitcnt vmcnt(8)
    s_nop 3
    v_permlane16_swap_b32 v188, v190
    v_permlane16_swap_b32 v189, v191
    v_permlane16_swap_b32 v192, v194
    v_permlane16_swap_b32 v193, v195
    v_permlane16_swap_b32 v196, v198
    v_permlane16_swap_b32 v197, v199
    v_permlane16_swap_b32 v200, v202
    v_permlane16_swap_b32 v201, v203
    v_lshlrev_b32 v22, 16, v22
    v_lshlrev_b32 v23, 16, v23
    v_lshlrev_b32 v204, 16, v188
    v_and_b32 v205, 0xffff0000, v188
    v_lshlrev_b32 v206, 16, v189
    v_and_b32 v207, 0xffff0000, v189
    v_lshlrev_b32 v208, 16, v190
    v_and_b32 v209, 0xffff0000, v190
    v_lshlrev_b32 v210, 16, v191
    v_and_b32 v211, 0xffff0000, v191
    v_add_f32 v204, v204, v22
    v_add_f32 v205, v205, v22
    v_add_f32 v206, v206, v22
    v_add_f32 v207, v207, v22
    v_add_f32 v208, v208, v22
    v_add_f32 v209, v209, v22
    v_add_f32 v210, v210, v22
    v_add_f32 v211, v211, v22
    v_pk_add_f32 v[28:29], v[28:29], v[204:205]
    v_pk_add_f32 v[30:31], v[30:31], v[206:207]
    v_pk_add_f32 v[44:45], v[44:45], v[208:209]
    v_pk_add_f32 v[46:47], v[46:47], v[210:211]
    v_lshlrev_b32 v204, 16, v192
    v_and_b32 v205, 0xffff0000, v192
    v_lshlrev_b32 v206, 16, v193
    v_and_b32 v207, 0xffff0000, v193
    v_lshlrev_b32 v208, 16, v194
    v_and_b32 v209, 0xffff0000, v194
    v_lshlrev_b32 v210, 16, v195
    v_and_b32 v211, 0xffff0000, v195
    v_add_f32 v204, v204, v22
    v_add_f32 v205, v205, v22
    v_add_f32 v206, v206, v22
    v_add_f32 v207, v207, v22
    v_add_f32 v208, v208, v22
    v_add_f32 v209, v209, v22
    v_add_f32 v210, v210, v22
    v_add_f32 v211, v211, v22
    v_pk_add_f32 v[60:61], v[60:61], v[204:205]
    v_pk_add_f32 v[62:63], v[62:63], v[206:207]
    v_pk_add_f32 v[76:77], v[76:77], v[208:209]
    v_pk_add_f32 v[78:79], v[78:79], v[210:211]
    v_lshlrev_b32 v204, 16, v196
    v_and_b32 v205, 0xffff0000, v196
    v_lshlrev_b32 v206, 16, v197
    v_and_b32 v207, 0xffff0000, v197
    v_lshlrev_b32 v208, 16, v198
    v_and_b32 v209, 0xffff0000, v198
    v_lshlrev_b32 v210, 16, v199
    v_and_b32 v211, 0xffff0000, v199
    v_add_f32 v204, v204, v23
    v_add_f32 v205, v205, v23
    v_add_f32 v206, v206, v23
    v_add_f32 v207, v207, v23
    v_add_f32 v208, v208, v23
    v_add_f32 v209, v209, v23
    v_add_f32 v210, v210, v23
    v_add_f32 v211, v211, v23
    v_pk_add_f32 v[32:33], v[32:33], v[204:205]
    v_pk_add_f32 v[34:35], v[34:35], v[206:207]
    v_pk_add_f32 v[48:49], v[48:49], v[208:209]
    v_pk_add_f32 v[50:51], v[50:51], v[210:211]
    v_lshlrev_b32 v204, 16, v200
    v_and_b32 v205, 0xffff0000, v200
    v_lshlrev_b32 v206, 16, v201
    v_and_b32 v207, 0xffff0000, v201
    v_lshlrev_b32 v208, 16, v202
    v_and_b32 v209, 0xffff0000, v202
    v_lshlrev_b32 v210, 16, v203
    v_and_b32 v211, 0xffff0000, v203
    v_add_f32 v204, v204, v23
    v_add_f32 v205, v205, v23
    v_add_f32 v206, v206, v23
    v_add_f32 v207, v207, v23
    v_add_f32 v208, v208, v23
    v_add_f32 v209, v209, v23
    v_add_f32 v210, v210, v23
    v_add_f32 v211, v211, v23
    v_pk_add_f32 v[64:65], v[64:65], v[204:205]
    v_pk_add_f32 v[66:67], v[66:67], v[206:207]
    v_pk_add_f32 v[80:81], v[80:81], v[208:209]
    v_pk_add_f32 v[82:83], v[82:83], v[210:211]
    s_waitcnt vmcnt(0)
g4_rcv:
    v_max3_u32 v4, v172, v173, v174
    v_max3_u32 v4, v4, v175, v176
    v_max3_u32 v4, v4, v177, v178
    v_max3_u32 v4, v4, v179, v180
    v_max3_u32 v4, v4, v181, v182
    v_max3_u32 v4, v4, v183, v184
    v_max3_u32 v4, v4, v185, v186
    v_max_u32 v4, v4, v187
    v_cmp_eq_u32 vcc, -1, v4
    s_sub_u32 s48, s48, 1
    s_cmp_eq_u32 s48, 0
    s_cbranch_scc1 g4_rcvd
    s_cbranch_vccz g4_rcvd
    s_sleep 2
    buffer_load_dwordx4 v[172:175], v21, s[84:87], s94 offen offset:0 sc1
    buffer_load_dwordx4 v[176:179], v21, s[84:87], s94 offen offset:1024 sc1
    buffer_load_dwordx4 v[180:183], v21, s[84:87], s94 offen offset:2048 sc1
    buffer_load_dwordx4 v[184:187], v21, s[84:87], s94 offen offset:3072 sc1
    s_waitcnt vmcnt(0)
    s_branch g4_rcv
g4_rcvd:
    v_lshlrev_b32 v108, 16, v172
    v_and_b32 v109, 0xffff0000, v172
    v_lshlrev_b32 v110, 16, v173
    v_and_b32 v111, 0xffff0000, v173
    v_pk_add_f32 v[28:29], v[28:29], v[108:109]
    v_pk_add_f32 v[30:31], v[30:31], v[110:111]
    v_lshlrev_b32 v112, 16, v174
    v_and_b32 v113, 0xffff0000, v174
    v_lshlrev_b32 v114, 16, v175
    v_and_b32 v115, 0xffff0000, v175
    v_pk_add_f32 v[44:45], v[44:45], v[112:113]
    v_pk_add_f32 v[46:47], v[46:47], v[114:115]
    v_lshlrev_b32 v116, 16, v176
    v_and_b32 v117, 0xffff0000, v176
    v_lshlrev_b32 v118, 16, v177
    v_and_b32 v119, 0xffff0000, v177
    v_pk_add_f32 v[60:61], v[60:61], v[116:117]
    v_pk_add_f32 v[62:63], v[62:63], v[118:119]
    v_lshlrev_b32 v120, 16, v178
    v_and_b32 v121, 0xffff0000, v178
    v_lshlrev_b32 v122, 16, v179
    v_and_b32 v123, 0xffff0000, v179
    v_pk_add_f32 v[76:77], v[76:77], v[120:121]
    v_pk_add_f32 v[78:79], v[78:79], v[122:123]
    v_lshlrev_b32 v108, 16, v180
    v_and_b32 v109, 0xffff0000, v180
    v_lshlrev_b32 v110, 16, v181
    v_and_b32 v111, 0xffff0000, v181
    v_pk_add_f32 v[32:33], v[32:33], v[108:109]
    v_pk_add_f32 v[34:35], v[34:35], v[110:111]
    v_lshlrev_b32 v112, 16, v182
    v_and_b32 v113, 0xffff0000, v182
    v_lshlrev_b32 v114, 16, v183
    v_and_b32 v115, 0xffff0000, v183
    v_pk_add_f32 v[48:49], v[48:49], v[112:113]
    v_pk_add_f32 v[50:51], v[50:51], v[114:115]
    v_lshlrev_b32 v116, 16, v184
    v_and_b32 v117, 0xffff0000, v184
    v_lshlrev_b32 v118, 16, v185
    v_and_b32 v119, 0xffff0000, v185
    v_pk_add_f32 v[64:65], v[64:65], v[116:117]
    v_pk_add_f32 v[66:67], v[66:67], v[118:119]
    v_lshlrev_b32 v120, 16, v186
    v_and_b32 v121, 0xffff0000, v186
    v_lshlrev_b32 v122, 16, v187
    v_and_b32 v123, 0xffff0000, v187
    v_pk_add_f32 v[80:81], v[80:81], v[120:121]
    v_pk_add_f32 v[82:83], v[82:83], v[122:123]
    v_cvt_pk_bf16_f32 v92, v28, v29
    v_cvt_pk_bf16_f32 v93, v30, v31
    v_cvt_pk_bf16_f32 v94, v44, v45
    v_cvt_pk_bf16_f32 v95, v46, v47
    s_nop 1
    v_permlane16_swap_b32 v92, v94
    v_permlane16_swap_b32 v93, v95
    buffer_store_dwordx4 v[92:95], v9, s[16:19], s52 offen offset:0 sc1
    v_cvt_pk_bf16_f32 v96, v60, v61
    v_cvt_pk_bf16_f32 v97, v62, v63
    v_cvt_pk_bf16_f32 v98, v76, v77
    v_cvt_pk_bf16_f32 v99, v78, v79
    s_nop 1
    v_permlane16_swap_b32 v96, v98
    v_permlane16_swap_b32 v97, v99
    buffer_store_dwordx4 v[96:99], v9, s[16:19], s52 offen offset:64 sc1
    v_cvt_pk_bf16_f32 v100, v32, v33
    v_cvt_pk_bf16_f32 v101, v34, v35
    v_cvt_pk_bf16_f32 v102, v48, v49
    v_cvt_pk_bf16_f32 v103, v50, v51
    s_nop 1
    v_permlane16_swap_b32 v100, v102
    v_permlane16_swap_b32 v101, v103
    buffer_store_dwordx4 v[100:103], v9, s[16:19], s53 offen offset:0 sc1
    v_cvt_pk_bf16_f32 v104, v64, v65
    v_cvt_pk_bf16_f32 v105, v66, v67
    v_cvt_pk_bf16_f32 v106, v80, v81
    v_cvt_pk_bf16_f32 v107, v82, v83
    s_nop 1
    v_permlane16_swap_b32 v104, v106
    v_permlane16_swap_b32 v105, v107
    buffer_store_dwordx4 v[104:107], v9, s[16:19], s53 offen offset:64 sc1
    v_pk_add_f32 v[108:109], v[28:29], v[30:31]
    v_pk_mul_f32 v[110:111], v[28:29], v[28:29]
    v_pk_fma_f32 v[110:111], v[30:31], v[30:31], v[110:111]
    v_pk_add_f32 v[108:109], v[108:109], v[44:45]
    v_pk_fma_f32 v[110:111], v[44:45], v[44:45], v[110:111]
    v_pk_add_f32 v[108:109], v[108:109], v[46:47]
    v_pk_fma_f32 v[110:111], v[46:47], v[46:47], v[110:111]
    v_pk_add_f32 v[108:109], v[108:109], v[60:61]
    v_pk_fma_f32 v[110:111], v[60:61], v[60:61], v[110:111]
    v_pk_add_f32 v[108:109], v[108:109], v[62:63]
    v_pk_fma_f32 v[110:111], v[62:63], v[62:63], v[110:111]
    v_pk_add_f32 v[108:109], v[108:109], v[76:77]
    v_pk_fma_f32 v[110:111], v[76:77], v[76:77], v[110:111]
    v_pk_add_f32 v[108:109], v[108:109], v[78:79]
    v_pk_fma_f32 v[110:111], v[78:79], v[78:79], v[110:111]
    v_pk_add_f32 v[112:113], v[32:33], v[34:35]
    v_pk_mul_f32 v[114:115], v[32:33], v[32:33]
    v_pk_fma_f32 v[114:115], v[34:35], v[34:35], v[114:115]
    v_pk_add_f32 v[112:113], v[112:113], v[48:49]
    v_pk_fma_f32 v[114:115], v[48:49], v[48:49], v[114:115]
    v_pk_add_f32 v[112:113], v[112:113], v[50:51]
    v_pk_fma_f32 v[114:115], v[50:51], v[50:51], v[114:115]
    v_pk_add_f32 v[112:113], v[112:113], v[64:65]
    v_pk_fma_f32 v[114:115], v[64:65], v[64:65], v[114:115]
    v_pk_add_f32 v[112:113], v[112:113], v[66:67]
    v_pk_fma_f32 v[114:115], v[66:67], v[66:67], v[114:115]
    v_pk_add_f32 v[112:113], v[112:113], v[80:81]
    v_pk_fma_f32 v[114:115], v[80:81], v[80:81], v[114:115]
    v_pk_add_f32 v[112:113], v[112:113], v[82:83]
    v_pk_fma_f32 v[114:115], v[82:83], v[82:83], v[114:115]
    v_add_f32 v108, v108, v109
    v_add_f32 v109, v110, v111
    v_add_f32 v112, v112, v113
    v_add_f32 v113, v114, v115
    s_nop 1
    v_permlane16_swap_b32 v108, v112
    v_permlane16_swap_b32 v109, v113
    v_pk_add_f32 v[108:109], v[108:109], v[112:113]
    v_mov_b32 v116, v108
    v_mov_b32 v117, v109
    v_and_b32 v3, 16, v2
    v_add_u32 v3, v3, v20
    v_permlane32_swap_b32 v108, v116
    v_permlane32_swap_b32 v109, v117
    v_pk_add_f32 v[108:109], v[108:109], v[116:117]
    v_lshlrev_b32 v3, 3, v3
    s_mul_i32 s40, s24, 2
    s_add_u32 s40, s40, s44
    s_lshl_b32 s40, s40, 14
    s_mov_b32 exec_hi, 0
    buffer_store_dwordx2 v[108:109], v3, s[60:63], s40 offen sc1
    s_mov_b32 exec_hi, -1
    s_cmp_lg_u32 s96, 0
    s_cbranch_scc1 g4_done
    s_lshr_b32 s40, s25, 0
    s_add_u32 s40, s40, 40
    s_lshl_b32 s40, s40, 8
    s_mov_b32 s42, s40
    s_add_u32 s84, s4, 0x2b00000
    s_addc_u32 s85, s5, 0
    s_mov_b32 s86, 0x4000
    s_mov_b32 s87, 0x20000
    v_mov_b32 v3, s40
    v_mov_b32 v4, 1
    s_waitcnt vmcnt(0)
    s_barrier
    s_cmp_lg_u32 s28, 0
    s_cbranch_scc1 g4_cin
    s_mov_b64 exec, 1
    buffer_atomic_add v4, v3, s[84:87], 0 offen sc1
    s_mov_b64 exec, -1
g4_cin:
    s_mov_b32 s96, 1
    s_mov_b32 s97, 0x2800000
    s_branch g1_in
code_end:
.section .rodata,"a"
.p2align 6
.amdhsa_kernel g1a_kernel
  .amdhsa_next_free_vgpr 248
  .amdhsa_next_free_sgpr 100
  .amdhsa_accum_offset 248
  .amdhsa_group_segment_fixed_size 0
  .amdhsa_kernarg_size 88
  .amdhsa_user_sgpr_count 2
  .amdhsa_user_sgpr_kernarg_segment_ptr 1
  .amdhsa_system_sgpr_workgroup_id_x 1
.end_amdhsa_kernel
```

```asm
; @launch kernel=g1a_kernel grid=(256,1,1) block=(512,1,1) lds=131328
.amdgcn_target "amdgcn-amd-amdhsa--gfx950"
.text
.globl g1a_kernel
.p2align 8
.type g1a_kernel,@function
g1a_kernel:
    s_mov_b32 s96, 0
    s_mov_b32 s97, 0x0
    v_mov_b32 v1, 131072
    v_mov_b32 v2, 0
    ds_write_b32 v1, v2
    s_branch g1_in
.p2align 6
g1_in:
    s_cmp_ge_u32 s2, 256
    s_cbranch_scc1 g1_done
    s_load_dwordx2 s[4:5], s[0:1], 80
    s_load_dwordx2 s[6:7], s[0:1], 0
    s_xor_b32 s53, s96, 1
    s_load_dwordx2 s[30:31], s[0:1], 8
    s_load_dwordx2 s[16:17], s[0:1], 72
    s_load_dwordx2 s[18:19], s[0:1], 16
    v_lshrrev_b32 v1, 6, v0
    v_and_b32 v2, 63, v0
    s_and_b32 s40, s2, 1
    s_lshl_b32 s40, s40, 3
    s_bfe_u32 s41, s2, 0x30003
    s_add_u32 s25, s40, s41
    s_bfe_u32 s40, s2, 0x20001
    s_lshl_b32 s40, s40, 2
    s_lshr_b32 s42, s2, 6
    s_add_u32 s24, s40, s42
    s_add_u32 s27, s41, s42
    s_add_u32 s52, s24, s25
    s_and_b32 s52, s52, 15
    s_and_b32 s26, s52, 12
    s_mul_i32 s26, s26, s53
    v_readfirstlane_b32 s28, v1
    v_lshrrev_b32 v5, 4, v2
    v_bfe_u32 v6, v2, 2, 2
    v_and_b32 v7, 3, v2
    v_and_b32 v8, 15, v2
    s_cmp_lt_u32 s28, 4
    s_cbranch_scc1 g1_compute
    s_sub_u32 s28, s28, 4
    s_mov_b32 s40, 2048
    v_lshrrev_b32 v3, 3, v2
    v_mul_lo_u32 v3, v3, s40
    v_lshrrev_b32 v4, 4, v2
    v_xor_b32 v4, v4, v2
    v_and_b32 v4, 7, v4
    v_lshl_add_u32 v3, v4, 4, v3
    s_mul_i32 s41, s25, 262144
    s_mul_i32 s42, s28, 65536
    s_add_u32 s41, s41, s42
    v_xor_b32 v4, 64, v3
    s_add_u32 s42, s41, 0
    v_add_u32 v16, s42, v3
    s_add_u32 s42, s41, 16384
    v_add_u32 v17, s42, v4
    s_add_u32 s42, s41, 32768
    v_add_u32 v18, s42, v3
    s_add_u32 s42, s41, 49152
    v_add_u32 v19, s42, v4
    s_mov_b32 s40, 6144
    v_lshrrev_b32 v3, 3, v2
    v_mul_lo_u32 v3, v3, s40
    v_bfe_u32 v4, v2, 4, 1
    v_lshlrev_b32 v4, 1, v4
    v_xor_b32 v4, v4, v2
    v_and_b32 v4, 7, v4
    v_lshl_add_u32 v3, v4, 4, v3
    s_mul_i32 s41, s24, 128
    s_mul_i32 s42, s28, 98304
    s_add_u32 s41, s41, s42
    v_xor_b32 v4, 64, v3
    s_add_u32 s42, s41, 0
    v_add_u32 v10, s42, v3
    s_add_u32 s42, s41, 49152
    v_add_u32 v11, s42, v4
    s_mov_b32 s40, 6144
    v_lshrrev_b32 v3, 3, v2
    v_mul_lo_u32 v3, v3, s40
    v_bfe_u32 v4, v2, 4, 1
    v_lshlrev_b32 v4, 1, v4
    v_xor_b32 v4, v4, v2
    v_and_b32 v4, 7, v4
    v_lshl_add_u32 v3, v4, 4, v3
    s_mul_i32 s41, s24, 128
    s_mul_i32 s42, s28, 98304
    s_add_u32 s41, s41, s42
    v_xor_b32 v4, 64, v3
    s_add_u32 s42, s41, 2048
    v_add_u32 v12, s42, v3
    s_add_u32 s42, s41, 51200
    v_add_u32 v13, s42, v4
    s_mov_b32 s40, 6144
    v_lshrrev_b32 v3, 3, v2
    v_mul_lo_u32 v3, v3, s40
    v_bfe_u32 v4, v2, 4, 1
    v_lshlrev_b32 v4, 1, v4
    v_xor_b32 v4, v4, v2
    v_and_b32 v4, 7, v4
    v_lshl_add_u32 v3, v4, 4, v3
    s_mul_i32 s41, s24, 128
    s_mul_i32 s42, s28, 98304
    s_add_u32 s41, s41, s42
    v_xor_b32 v4, 64, v3
    s_add_u32 s42, s41, 4096
    v_add_u32 v14, s42, v3
    s_add_u32 s42, s41, 53248
    v_add_u32 v15, s42, v4
    v_lshrrev_b32 v3, 3, v2
    s_lshl_b32 s40, s28, 2
    v_add_u32 v3, s40, v3
    v_lshrrev_b32 v4, 1, v3
    v_xor_b32 v4, v4, v2
    v_and_b32 v4, 7, v4
    s_lshl_b32 s40, s25, 7
    s_sub_u32 s40, s40, 16
    v_add_u32 v3, s40, v3
    v_max_i32 v3, 0, v3
    v_lshlrev_b32 v3, 11, v3
    v_lshl_add_u32 v20, v4, 4, v3
    s_mul_i32 s36, s28, 2048
    s_mul_i32 s37, s28, 4096
    s_add_u32 s37, s37, 26624
    s_mul_i32 s46, s28, 512
    s_add_u32 s46, s46, 24576
    s_waitcnt lgkmcnt(0)
    s_mov_b32 s8, s30
    s_mov_b32 s9, s31
    s_mov_b32 s10, 0x600000
    s_mov_b32 s11, 0x20000
    s_add_u32 s56, s4, 0x100000
    s_addc_u32 s57, s5, 0
    s_mov_b32 s58, 0x30000
    s_mov_b32 s59, 0x20000
    s_add_u32 s4, s4, s97
    s_addc_u32 s5, s5, 0
    s_add_u32 s12, s4, 0x1900000
    s_addc_u32 s13, s5, 0
    s_cmp_eq_u32 s96, 1
    s_cselect_b32 s12, s12, s6
    s_cselect_b32 s13, s13, s7
    s_mov_b32 s14, 0x400000
    s_mov_b32 s15, 0x20000
    s_mov_b32 s20, s4
    s_mov_b32 s21, s5
    s_mov_b32 s22, 0x40000
    s_mov_b32 s23, 0x20000
    s_mov_b32 s60, s16
    s_mov_b32 s61, s17
    s_mov_b32 s62, 0x100
    s_mov_b32 s63, 0x20000
    s_sub_u32 s40, s52, s27
    s_and_b32 s40, s40, 1
    s_and_b32 s41, s52, 2
    s_or_b32 s40, s40, s41
    s_add_u32 s54, s40, 2
    s_cmp_eq_u32 s53, 0
    s_cselect_b32 s54, 0x7fff, s54
    s_add_u32 s55, s54, 3
    s_cmp_lg_u32 s28, 0
    s_cselect_b32 s55, 0x7fff, s55
    s_cmp_lt_u32 s55, 0x7fff
    s_cselect_b32 s29, 12, 0x7fff
    s_add_u32 s50, s29, 1
    s_mov_b32 s51, 14
    s_mov_b32 s32, 0
    s_mov_b32 s33, 0
g1_ld_pW:
    s_add_u32 s40, s32, s27
    s_and_b32 s40, s40, 1
    s_andn2_b32 s41, s32, 1
    s_or_b32 s40, s40, s41
    s_add_u32 s40, s40, s26
    s_and_b32 s40, s40, 15
    s_mul_i32 s34, s40, 393216
    s_mul_i32 s35, s40, 128
    s_add_u32 s38, s33, s36
    s_add_u32 s39, s33, s37
    s_add_u32 m0, s38, 0
    s_nop 0
    buffer_load_dwordx4 v10, s[8:11], s34 offen lds
    s_add_u32 m0, s38, 1024
    s_nop 0
    buffer_load_dwordx4 v11, s[8:11], s34 offen lds
    s_add_u32 m0, s38, 8192
    s_nop 0
    buffer_load_dwordx4 v12, s[8:11], s34 offen lds
    s_add_u32 m0, s38, 9216
    s_nop 0
    buffer_load_dwordx4 v13, s[8:11], s34 offen lds
    s_add_u32 m0, s38, 16384
    s_nop 0
    buffer_load_dwordx4 v14, s[8:11], s34 offen lds
    s_add_u32 m0, s38, 17408
    s_nop 0
    buffer_load_dwordx4 v15, s[8:11], s34 offen lds
    s_add_u32 s33, s33, 43008
    s_add_u32 s32, s32, 1
    s_cmp_lt_u32 s32, 2
    s_cbranch_scc1 g1_ld_pW
    s_cmp_eq_u32 s96, 0
    s_cbranch_scc1 g1_dep_ok
    s_add_u32 s40, s25, 40
    s_lshl_b32 s40, s40, 8
    s_sub_u32 s42, s40, 256
    s_max_u32 s42, s42, 10240
    s_cmp_lg_u32 s28, 0
    s_cbranch_scc1 g1_dep_set
    s_add_u32 s84, s4, 0x300000
    s_addc_u32 s85, s5, 0
    s_mov_b32 s86, 0x4000
    s_mov_b32 s87, 0x20000
    v_cmp_gt_u32 vcc, 32, v2
    v_mov_b32 v21, s40
    v_mov_b32 v23, s42
    v_cndmask_b32 v21, v23, v21, vcc
    v_mov_b32 v22, 15
    v_mov_b32 v23, 15
    v_cndmask_b32 v22, v23, v22, vcc
    v_and_b32 v23, 31, v2
    v_min_u32 v23, v23, v22
    v_lshl_add_u32 v21, v23, 2, v21
    v_mov_b32 v22, 1
    buffer_load_dword v23, v21, s[84:87], 0 offen sc1
g1_dep_set:
    s_lshl_b32 s43, s96, 2
    s_add_u32 s43, s43, 1
    s_mov_b32 s41, 0x800000
    v_mov_b32 v24, 131072
    s_cmp_lg_u32 s28, 0
    s_cbranch_scc1 g1_dep_lds
    s_mov_b32 s41, 0x40000
    s_waitcnt vmcnt(0)
g1_dep:
    v_cmp_lt_u32 vcc, v23, v22
    s_sub_u32 s41, s41, 1
    s_cmp_eq_u32 s41, 0
    s_cbranch_scc1 g1_dep_seen
    s_cbranch_vccz g1_dep_seen
    s_sleep 2
    buffer_load_dword v23, v21, s[84:87], 0 offen sc1
    s_waitcnt vmcnt(0)
    s_branch g1_dep
g1_dep_seen:
    v_mov_b32 v23, s43
    ds_write_b32 v24, v23
    s_branch g1_dep_ok
g1_dep_lds:
    ds_read_b32 v23, v24
    s_sub_u32 s41, s41, 1
    s_waitcnt lgkmcnt(0)
    v_readfirstlane_b32 s40, v23
    s_cmp_eq_u32 s41, 0
    s_cbranch_scc1 g1_dep_ok
    s_cmp_eq_u32 s40, s43
    s_cbranch_scc1 g1_dep_ok
    s_sleep 1
    s_branch g1_dep_lds
g1_dep_ok:
    s_mov_b32 s32, 0
    s_mov_b32 s33, 0
g1_ld_pA:
    s_add_u32 s40, s32, s27
    s_and_b32 s40, s40, 1
    s_andn2_b32 s41, s32, 1
    s_or_b32 s40, s40, s41
    s_add_u32 s40, s40, s26
    s_and_b32 s40, s40, 15
    s_mul_i32 s34, s40, 393216
    s_mul_i32 s35, s40, 128
    s_add_u32 s38, s33, s36
    s_add_u32 s39, s33, s37
    s_add_u32 m0, s39, 0
    s_nop 0
    buffer_load_dwordx4 v16, s[12:15], s35 offen sc1 lds
    s_add_u32 m0, s39, 1024
    s_nop 0
    buffer_load_dwordx4 v17, s[12:15], s35 offen sc1 lds
    s_add_u32 m0, s39, 2048
    s_nop 0
    buffer_load_dwordx4 v18, s[12:15], s35 offen sc1 lds
    s_add_u32 m0, s39, 3072
    s_nop 0
    buffer_load_dwordx4 v19, s[12:15], s35 offen sc1 lds
    s_add_u32 m0, s33, s46
    s_mov_b32 exec_hi, 0
    buffer_load_dwordx4 v20, s[12:15], s35 offen sc1 lds
    s_mov_b32 exec_hi, -1
    s_add_u32 s33, s33, 43008
    s_add_u32 s32, s32, 1
    s_cmp_lt_u32 s32, 2
    s_cbranch_scc1 g1_ld_pA
    s_waitcnt vmcnt(5)
    s_branch g1_ld_bar
g1_ld_loop:
    s_sub_u32 s40, s32, s54
    s_sub_u32 s40, s40, 1
    s_cmp_lt_u32 s40, 2
    s_cbranch_scc1 g1_ld_w0
    s_sub_u32 s40, s32, s55
    s_sub_u32 s40, s40, 1
    s_cmp_lt_u32 s40, 2
    s_cbranch_scc1 g1_ld_w1
    s_sub_u32 s40, s32, s29
    s_sub_u32 s40, s40, 1
    s_cmp_lt_u32 s40, 2
    s_cbranch_scc1 g1_ld_w2
    s_sub_u32 s40, s32, s51
    s_sub_u32 s40, s40, 1
    s_cmp_lt_u32 s40, 2
    s_cbranch_scc1 g1_ld_w4
    s_waitcnt vmcnt(11)
g1_ld_bar:
    s_barrier
    s_add_u32 s40, s32, s27
    s_and_b32 s40, s40, 1
    s_andn2_b32 s41, s32, 1
    s_or_b32 s40, s40, s41
    s_add_u32 s40, s40, s26
    s_and_b32 s40, s40, 15
    s_mul_i32 s34, s40, 393216
    s_mul_i32 s35, s40, 128
    s_add_u32 s38, s33, s36
    s_add_u32 s39, s33, s37
    s_add_u32 m0, s39, 0
    s_nop 0
    buffer_load_dwordx4 v16, s[12:15], s35 offen sc1 lds
    s_add_u32 m0, s39, 1024
    s_nop 0
    buffer_load_dwordx4 v17, s[12:15], s35 offen sc1 lds
    s_add_u32 m0, s39, 2048
    s_nop 0
    buffer_load_dwordx4 v18, s[12:15], s35 offen sc1 lds
    s_add_u32 m0, s39, 3072
    s_nop 0
    buffer_load_dwordx4 v19, s[12:15], s35 offen sc1 lds
    s_add_u32 m0, s38, 0
    s_nop 0
    buffer_load_dwordx4 v10, s[8:11], s34 offen lds
    s_add_u32 m0, s38, 1024
    s_nop 0
    buffer_load_dwordx4 v11, s[8:11], s34 offen lds
    s_add_u32 m0, s38, 8192
    s_nop 0
    buffer_load_dwordx4 v12, s[8:11], s34 offen lds
    s_add_u32 m0, s38, 9216
    s_nop 0
    buffer_load_dwordx4 v13, s[8:11], s34 offen lds
    s_add_u32 m0, s38, 16384
    s_nop 0
    buffer_load_dwordx4 v14, s[8:11], s34 offen lds
    s_add_u32 m0, s38, 17408
    s_nop 0
    buffer_load_dwordx4 v15, s[8:11], s34 offen lds
    s_add_u32 m0, s33, s46
    s_mov_b32 exec_hi, 0
    buffer_load_dwordx4 v20, s[12:15], s35 offen sc1 lds
    s_mov_b32 exec_hi, -1
    s_cmp_eq_u32 s32, s54
    s_cbranch_scc1 g1_ld_h0
g1_ld_c0:
    s_cmp_eq_u32 s32, s55
    s_cbranch_scc1 g1_ld_h1
g1_ld_c1:
    s_cmp_eq_u32 s32, s29
    s_cbranch_scc1 g1_ld_h2
g1_ld_c2:
    s_cmp_eq_u32 s32, s50
    s_cbranch_scc1 g1_ld_h3
g1_ld_c3:
    s_cmp_eq_u32 s32, s51
    s_cbranch_scc1 g1_ld_h4
g1_ld_c4:
    s_add_u32 s33, s33, 43008
    s_add_u32 s32, s32, 1
    s_cmp_eq_u32 s33, 129024
    s_cselect_b32 s33, 0, s33
    s_cmp_lt_u32 s32, 16
    s_cbranch_scc1 g1_ld_loop
    s_waitcnt vmcnt(43)
    s_barrier
    s_waitcnt vmcnt(0)
    v_pk_add_f32 v[24:25], v[24:25], v[40:41]
    v_add_f32 v56, v56, v64
    v_pk_add_f32 v[26:27], v[26:27], v[42:43]
    v_add_f32 v57, v57, v65
    v_pk_add_f32 v[28:29], v[28:29], v[44:45]
    v_add_f32 v58, v58, v66
    v_pk_add_f32 v[30:31], v[30:31], v[46:47]
    v_add_f32 v59, v59, v67
    v_pk_add_f32 v[32:33], v[32:33], v[48:49]
    v_add_f32 v60, v60, v68
    v_pk_add_f32 v[34:35], v[34:35], v[50:51]
    v_add_f32 v61, v61, v69
    v_pk_add_f32 v[36:37], v[36:37], v[52:53]
    v_add_f32 v62, v62, v70
    v_pk_add_f32 v[38:39], v[38:39], v[54:55]
    v_add_f32 v63, v63, v71
    v_pk_add_f32 v[24:25], v[24:25], v[32:33]
    v_add_f32 v56, v56, v60
    v_pk_add_f32 v[26:27], v[26:27], v[34:35]
    v_add_f32 v57, v57, v61
    v_pk_add_f32 v[28:29], v[28:29], v[36:37]
    v_add_f32 v58, v58, v62
    v_pk_add_f32 v[30:31], v[30:31], v[38:39]
    v_add_f32 v59, v59, v63
    v_pk_add_f32 v[24:25], v[24:25], v[28:29]
    v_add_f32 v56, v56, v58
    v_pk_add_f32 v[26:27], v[26:27], v[30:31]
    v_add_f32 v57, v57, v59
    v_pk_add_f32 v[24:25], v[24:25], v[26:27]
    v_add_f32 v56, v56, v57
    v_mul_f32 v24, 0x3a800000, v24
    v_mul_f32 v25, 0x3a800000, v25
    v_fma_f32 v25, -v24, v24, v25
    v_max_f32 v25, 0, v25
    v_cvt_pk_bf16_f32 v24, v24, v24
    v_lshlrev_b32 v24, 16, v24
    v_cvt_pk_bf16_f32 v25, v25, v25
    v_lshlrev_b32 v25, 16, v25
    v_add_f32 v25, 0x3727c5ac, v25
    v_cvt_pk_bf16_f32 v25, v25, v25
    v_lshlrev_b32 v25, 16, v25
    v_sqrt_f32 v25, v25
    s_nop 0
    v_cvt_pk_bf16_f32 v25, v25, v25
    v_lshlrev_b32 v25, 16, v25
    v_rcp_f32 v26, v25
    v_lshlrev_b32 v3, 3, v21
    v_lshlrev_b32 v4, 2, v21
    v_mul_f32 v27, -v24, v26
    v_cmp_gt_u32 vcc, 144, v21
    s_and_saveexec_b64 s[40:41], vcc
    v_add_u32 v3, 129024, v3
    ds_write_b64 v3, v[26:27]
    s_mov_b64 exec, s[40:41]
    v_cmp_gt_u32 vcc, 192, v21
    s_and_saveexec_b64 s[40:41], vcc
    v_add_u32 v4, 130304, v4
    ds_write_b32 v4, v56
    s_mov_b64 exec, s[40:41]
    s_waitcnt lgkmcnt(0)
    s_barrier
    s_add_u32 s20, s4, 0x200000
    s_addc_u32 s21, s5, 0
    s_mov_b32 s22, 0x40000
    s_mov_b32 s23, 0x20000
    s_lshl_b32 s40, s24, 4
    s_add_u32 s40, s40, s25
    s_lshl_b32 s40, s40, 10
    s_lshl_b32 s41, s28, 8
    s_add_u32 s40, s40, s41
    v_lshlrev_b32 v3, 2, v2
    v_mov_b32 v4, -1
    buffer_store_dword v4, v3, s[20:23], s40 offen sc1
    s_cmp_eq_u32 s53, 0
    s_cbranch_scc1 g1_nopf
    s_mov_b32 s20, s18
    s_mov_b32 s21, s19
    s_mov_b32 s22, 0x200000
    s_mov_b32 s23, 0x20000
    s_lshl_b32 s40, s2, 13
    s_lshl_b32 s41, s28, 11
    s_add_u32 s40, s40, s41
    v_lshlrev_b32 v3, 4, v2
    buffer_load_dwordx4 v[120:123], v3, s[20:23], s40 offen
    buffer_load_dwordx4 v[120:123], v3, s[20:23], s40 offen offset:1024
g1_nopf:
    s_branch g1_ld_end
g1_ld_w0:
    s_waitcnt vmcnt(16)
    s_branch g1_ld_bar
g1_ld_h0:
    s_add_u32 s44, s33, 43008
    s_cmp_eq_u32 s44, 129024
    s_cselect_b32 s44, 0, s44
    s_mul_i32 s42, s28, 3
    s_add_u32 s42, s42, 0
    s_lshr_b32 s43, s42, 2
    s_lshl_b32 s43, s43, 13
    s_add_u32 s43, s43, s44
    s_and_b32 s42, s42, 3
    v_and_b32 v3, 1, v5
    v_lshlrev_b32 v3, 1, v3
    v_lshrrev_b32 v4, 1, v6
    v_or_b32 v3, v3, v4
    s_add_u32 s40, s42, 0
    v_xor_b32 v3, s40, v3
    v_lshlrev_b32 v3, 5, v3
    v_lshl_add_u32 v3, v7, 3, v3
    v_lshl_add_u32 v4, v5, 3, v6
    v_lshl_add_u32 v3, v4, 7, v3
    v_add_u32 v21, s43, v3
    ds_read_b64_tr_b16 v[24:25], v21 offset:0
    ds_read_b64_tr_b16 v[26:27], v21 offset:512
    ds_read_b64_tr_b16 v[28:29], v21 offset:4096
    ds_read_b64_tr_b16 v[30:31], v21 offset:4608
    s_mul_i32 s42, s28, 3
    s_add_u32 s42, s42, 1
    s_lshr_b32 s43, s42, 2
    s_lshl_b32 s43, s43, 13
    s_add_u32 s43, s43, s44
    s_and_b32 s42, s42, 3
    v_and_b32 v3, 1, v5
    v_lshlrev_b32 v3, 1, v3
    v_lshrrev_b32 v4, 1, v6
    v_or_b32 v3, v3, v4
    s_add_u32 s40, s42, 0
    v_xor_b32 v3, s40, v3
    v_lshlrev_b32 v3, 5, v3
    v_lshl_add_u32 v3, v7, 3, v3
    v_lshl_add_u32 v4, v5, 3, v6
    v_lshl_add_u32 v3, v4, 7, v3
    v_add_u32 v21, s43, v3
    ds_read_b64_tr_b16 v[32:33], v21 offset:0
    ds_read_b64_tr_b16 v[34:35], v21 offset:512
    ds_read_b64_tr_b16 v[36:37], v21 offset:4096
    ds_read_b64_tr_b16 v[38:39], v21 offset:4608
    s_mul_i32 s42, s28, 3
    s_add_u32 s42, s42, 2
    s_lshr_b32 s43, s42, 2
    s_lshl_b32 s43, s43, 13
    s_add_u32 s43, s43, s44
    s_and_b32 s42, s42, 3
    v_and_b32 v3, 1, v5
    v_lshlrev_b32 v3, 1, v3
    v_lshrrev_b32 v4, 1, v6
    v_or_b32 v3, v3, v4
    s_add_u32 s40, s42, 0
    v_xor_b32 v3, s40, v3
    v_lshlrev_b32 v3, 5, v3
    v_lshl_add_u32 v3, v7, 3, v3
    v_lshl_add_u32 v4, v5, 3, v6
    v_lshl_add_u32 v3, v4, 7, v3
    v_add_u32 v21, s43, v3
    ds_read_b64_tr_b16 v[40:41], v21 offset:0
    ds_read_b64_tr_b16 v[42:43], v21 offset:512
    ds_read_b64_tr_b16 v[44:45], v21 offset:4096
    ds_read_b64_tr_b16 v[46:47], v21 offset:4608
    s_lshr_b32 s42, s44, 7
    s_lshl_b32 s43, s28, 5
    s_add_u32 s42, s42, s43
    s_add_u32 s42, s42, 16
    v_lshrrev_b32 v3, 1, v8
    v_xor_b32 v3, v3, v5
    v_lshlrev_b32 v3, 4, v3
    v_lshl_add_u32 v3, v8, 7, v3
    s_lshl_b32 s40, s42, 7
    s_add_u32 s40, s40, 24576
    v_add_u32 v22, s40, v3
    v_xor_b32 v23, 64, v22
    ds_read_b128 v[48:51], v22 offset:0
    ds_read_b128 v[52:55], v23 offset:0
    ds_read_b128 v[56:59], v22 offset:2048
    ds_read_b128 v[60:63], v23 offset:2048
    v_mov_b32 v64, 0x3f803f80
    v_mov_b32 v65, 0x3f803f80
    v_mov_b32 v66, 0x3f803f80
    v_mov_b32 v67, 0x3f803f80
    s_mul_i32 s42, s52, 12288
    s_lshl_b32 s43, s24, 8
    s_add_u32 s42, s42, s43
    v_lshl_add_u32 v21, v5, 4, s42
    s_lshl_b32 s42, s52, 14
    s_lshl_b32 s43, s25, 10
    s_add_u32 s42, s42, s43
    s_lshl_b32 s43, s28, 8
    s_add_u32 s42, s42, s43
    v_lshl_add_u32 v22, v8, 3, s42
    s_waitcnt lgkmcnt(0)
    v_mfma_f32_16x16x32_bf16 v[68:71], v[24:27], v[64:67], 0
    v_mfma_f32_16x16x32_bf16 v[72:75], v[32:35], v[64:67], 0
    v_mfma_f32_16x16x32_bf16 v[76:79], v[40:43], v[64:67], 0
    v_mfma_f32_16x16x32_bf16 v[80:83], v[64:67], v[48:51], 0
    v_mfma_f32_16x16x32_bf16 v[84:87], v[48:51], v[48:51], 0
    v_mfma_f32_16x16x32_bf16 v[88:91], v[64:67], v[56:59], 0
    v_mfma_f32_16x16x32_bf16 v[92:95], v[56:59], v[56:59], 0
    v_mfma_f32_16x16x32_bf16 v[68:71], v[28:31], v[64:67], v[68:71]
    v_mfma_f32_16x16x32_bf16 v[72:75], v[36:39], v[64:67], v[72:75]
    v_mfma_f32_16x16x32_bf16 v[76:79], v[44:47], v[64:67], v[76:79]
    v_mfma_f32_16x16x32_bf16 v[80:83], v[64:67], v[52:55], v[80:83]
    v_mfma_f32_16x16x32_bf16 v[84:87], v[52:55], v[52:55], v[84:87]
    v_mfma_f32_16x16x32_bf16 v[88:91], v[64:67], v[60:63], v[88:91]
    v_mfma_f32_16x16x32_bf16 v[92:95], v[60:63], v[60:63], v[92:95]
    v_cmp_eq_u32 s[40:41], 1, v7
    v_cmp_eq_u32 s[42:43], 2, v7
    v_cmp_eq_u32 vcc, 3, v7
    s_nop 7
    v_cndmask_b32 v81, v84, v85, s[40:41]
    v_cndmask_b32 v81, v81, v86, s[42:43]
    v_cndmask_b32 v81, v81, v87, vcc
    v_cndmask_b32 v89, v92, v93, s[40:41]
    v_cndmask_b32 v89, v89, v94, s[42:43]
    v_cndmask_b32 v89, v89, v95, vcc
    s_mov_b32 exec_lo, 0x00f0000f
    s_mov_b32 exec_hi, 0xf0000f00
    buffer_store_dwordx2 v[80:81], v22, s[20:23], 0 offen offset:0 sc1
    buffer_store_dwordx2 v[88:89], v22, s[20:23], 0 offen offset:128 sc1
    s_mov_b32 exec_lo, 0x00010001
    s_mov_b32 exec_hi, 0x00010001
    s_mul_i32 s42, s28, 3
    s_add_u32 s42, s42, 0
    s_lshr_b32 s43, s42, 2
    s_lshl_b32 s43, s43, 12
    s_and_b32 s42, s42, 3
    s_lshl_b32 s42, s42, 6
    s_add_u32 s42, s42, s43
    buffer_store_dwordx4 v[68:71], v21, s[56:59], s42 offen sc1
    s_mul_i32 s42, s28, 3
    s_add_u32 s42, s42, 1
    s_lshr_b32 s43, s42, 2
    s_lshl_b32 s43, s43, 12
    s_and_b32 s42, s42, 3
    s_lshl_b32 s42, s42, 6
    s_add_u32 s42, s42, s43
    buffer_store_dwordx4 v[72:75], v21, s[56:59], s42 offen sc1
    s_mul_i32 s42, s28, 3
    s_add_u32 s42, s42, 2
    s_lshr_b32 s43, s42, 2
    s_lshl_b32 s43, s43, 12
    s_and_b32 s42, s42, 3
    s_lshl_b32 s42, s42, 6
    s_add_u32 s42, s42, s43
    buffer_store_dwordx4 v[76:79], v21, s[56:59], s42 offen sc1
    s_mov_b64 exec, -1
    s_or_b32 s40, s24, s28
    s_cmp_lg_u32 s40, 0
    s_cbranch_scc1 g1_nocr
    s_lshl_b32 s40, s25, 10
    v_lshl_add_u32 v21, v2, 4, s40
    v_mov_b32 v24, 0
    v_mov_b32 v25, 0
    v_mov_b32 v26, 0
    v_mov_b32 v27, 0
    s_add_u32 s84, s4, 0x300000
    s_addc_u32 s85, s5, 0
    s_mov_b32 s86, 0x4000
    s_mov_b32 s87, 0x20000
    buffer_store_dwordx4 v[24:27], v21, s[84:87], 0 offen sc1
    s_add_u32 s84, s4, 0x2b00000
    s_addc_u32 s85, s5, 0
    s_mov_b32 s86, 0x4000
    s_mov_b32 s87, 0x20000
    buffer_store_dwordx4 v[24:27], v21, s[84:87], 0 offen sc1
g1_nocr:
    s_branch g1_ld_c0
g1_ld_w1:
    s_waitcnt vmcnt(12)
    s_branch g1_ld_bar
g1_ld_h1:
    v_mov_b32 v21, 0
    v_mov_b32 v22, 1
    s_mov_b64 exec, 1
    buffer_atomic_add v22, v21, s[60:63], 0 offen sc1
    s_mov_b64 exec, -1
    s_branch g1_ld_c1
g1_ld_w2:
    s_waitcnt vmcnt(12)
    s_branch g1_ld_bar
g1_ld_h2:
    v_mov_b32 v21, 0
    buffer_load_dword v23, v21, s[60:63], 0 offen sc1
    s_branch g1_ld_c2
g1_ld_h3:
    s_mov_b32 s41, 0x40000
    v_mov_b32 v21, 0
    s_waitcnt vmcnt(11)
g1_poll:
    v_readfirstlane_b32 s40, v23
    s_sub_u32 s41, s41, 1
    s_cmp_eq_u32 s41, 0
    s_cbranch_scc1 g1_polled
    s_cmp_ge_u32 s40, 256
    s_cbranch_scc1 g1_polled
    s_sleep 8
    buffer_load_dword v23, v21, s[60:63], 0 offen sc1
    s_waitcnt vmcnt(0)
    s_branch g1_poll
g1_polled:
    s_branch g1_ld_c3
g1_ld_w4:
    s_waitcnt vmcnt(43)
    s_branch g1_ld_bar
g1_ld_h4:
    s_lshl_b32 s40, s28, 6
    v_add_u32 v21, s40, v2
    s_lshl_b32 s41, s25, 7
    s_sub_u32 s41, s41, 16
    v_add_u32 v3, s41, v21
    v_max_i32 v3, 0, v3
    v_min_u32 v3, 2047, v3
    v_lshlrev_b32 v3, 3, v3
    s_min_u32 s40, s28, 2
    s_lshl_b32 s40, s40, 12
    s_lshl_b32 s41, s24, 8
    s_add_u32 s40, s40, s41
    v_lshl_add_u32 v4, v2, 2, s40
    s_mov_b32 s40, 0
    buffer_load_dwordx2 v[24:25], v3, s[20:23], s40 offen sc1
    s_mov_b32 s41, 0
    buffer_load_dword v56, v4, s[56:59], s41 offen sc1
    s_mov_b32 s40, 16384
    buffer_load_dwordx2 v[26:27], v3, s[20:23], s40 offen sc1
    s_mov_b32 s41, 12288
    buffer_load_dword v57, v4, s[56:59], s41 offen sc1
    s_mov_b32 s40, 32768
    buffer_load_dwordx2 v[28:29], v3, s[20:23], s40 offen sc1
    s_mov_b32 s41, 24576
    buffer_load_dword v58, v4, s[56:59], s41 offen sc1
    s_mov_b32 s40, 49152
    buffer_load_dwordx2 v[30:31], v3, s[20:23], s40 offen sc1
    s_mov_b32 s41, 36864
    buffer_load_dword v59, v4, s[56:59], s41 offen sc1
    s_mov_b32 s40, 65536
    buffer_load_dwordx2 v[32:33], v3, s[20:23], s40 offen sc1
    s_mov_b32 s41, 49152
    buffer_load_dword v60, v4, s[56:59], s41 offen sc1
    s_mov_b32 s40, 81920
    buffer_load_dwordx2 v[34:35], v3, s[20:23], s40 offen sc1
    s_mov_b32 s41, 61440
    buffer_load_dword v61, v4, s[56:59], s41 offen sc1
    s_mov_b32 s40, 98304
    buffer_load_dwordx2 v[36:37], v3, s[20:23], s40 offen sc1
    s_mov_b32 s41, 73728
    buffer_load_dword v62, v4, s[56:59], s41 offen sc1
    s_mov_b32 s40, 114688
    buffer_load_dwordx2 v[38:39], v3, s[20:23], s40 offen sc1
    s_mov_b32 s41, 86016
    buffer_load_dword v63, v4, s[56:59], s41 offen sc1
    s_mov_b32 s40, 131072
    buffer_load_dwordx2 v[40:41], v3, s[20:23], s40 offen sc1
    s_mov_b32 s41, 98304
    buffer_load_dword v64, v4, s[56:59], s41 offen sc1
    s_mov_b32 s40, 147456
    buffer_load_dwordx2 v[42:43], v3, s[20:23], s40 offen sc1
    s_mov_b32 s41, 110592
    buffer_load_dword v65, v4, s[56:59], s41 offen sc1
    s_mov_b32 s40, 163840
    buffer_load_dwordx2 v[44:45], v3, s[20:23], s40 offen sc1
    s_mov_b32 s41, 122880
    buffer_load_dword v66, v4, s[56:59], s41 offen sc1
    s_mov_b32 s40, 180224
    buffer_load_dwordx2 v[46:47], v3, s[20:23], s40 offen sc1
    s_mov_b32 s41, 135168
    buffer_load_dword v67, v4, s[56:59], s41 offen sc1
    s_mov_b32 s40, 196608
    buffer_load_dwordx2 v[48:49], v3, s[20:23], s40 offen sc1
    s_mov_b32 s41, 147456
    buffer_load_dword v68, v4, s[56:59], s41 offen sc1
    s_mov_b32 s40, 212992
    buffer_load_dwordx2 v[50:51], v3, s[20:23], s40 offen sc1
    s_mov_b32 s41, 159744
    buffer_load_dword v69, v4, s[56:59], s41 offen sc1
    s_mov_b32 s40, 229376
    buffer_load_dwordx2 v[52:53], v3, s[20:23], s40 offen sc1
    s_mov_b32 s41, 172032
    buffer_load_dword v70, v4, s[56:59], s41 offen sc1
    s_mov_b32 s40, 245760
    buffer_load_dwordx2 v[54:55], v3, s[20:23], s40 offen sc1
    s_mov_b32 s41, 184320
    buffer_load_dword v71, v4, s[56:59], s41 offen sc1
    s_branch g1_ld_c4
g1_ld_end:
    s_add_u32 s28, s28, 4
    s_add_u32 s16, s4, 0x400000
    s_addc_u32 s17, s5, 0
    s_mov_b32 s18, 0x400000
    s_mov_b32 s19, 0x20000
    s_and_b32 s44, s28, 1
    s_lshr_b32 s45, s28, 1
    s_lshl_b32 s40, s44, 2
    v_add_u32 v3, s40, v5
    v_and_b32 v4, 7, v8
    v_xor_b32 v3, v3, v4
    v_lshlrev_b32 v3, 4, v3
    v_lshl_add_u32 v3, v8, 8, v3
    s_mul_i32 s41, s45, 4096
    s_add_u32 s41, s41, 43008
    v_add_u32 v226, s41, v3
    v_lshl_add_u32 v3, v5, 2, v6
    v_and_b32 v4, 7, v3
    v_add_u32 v228, s40, v7
    v_xor_b32 v4, v4, v228
    v_lshlrev_b32 v4, 4, v4
    v_lshl_add_u32 v3, v3, 8, v4
    s_add_u32 s41, s41, 36864
    v_add_u32 v227, s41, v3
    v_and_b32 v3, 7, v8
    v_add_u32 v4, 1, v3
    s_or_b32 s40, s25, s45
    s_cmp_eq_u32 s40, 0
    s_cselect_b32 s40, 8, 0
    v_cmp_gt_u32 vcc, 8, v8
    v_mov_b32 v21, s40
    s_mov_b64 s[56:57], vcc
    v_cndmask_b32 v21, 0, v21, vcc
    v_max_u32 v4, v4, v21
    v_add_u32 v3, 8, v3
    v_sub_u32 v3, v3, v4
    v_lshlrev_b32 v21, 2, v5
    v_sub_u32 v21, v21, v4
    v_mov_b32 v22, 0xf149f2ca
    v_add_u32 v23, 0, v21
    v_cmp_ge_u32 vcc, v3, v23
    s_nop 1
    v_cndmask_b32 v228, v22, 0, vcc
    v_add_u32 v23, 1, v21
    v_cmp_ge_u32 vcc, v3, v23
    s_nop 1
    v_cndmask_b32 v229, v22, 0, vcc
    v_add_u32 v23, 2, v21
    v_cmp_ge_u32 vcc, v3, v23
    s_nop 1
    v_cndmask_b32 v230, v22, 0, vcc
    v_add_u32 v23, 3, v21
    v_cmp_ge_u32 vcc, v3, v23
    s_nop 1
    v_cndmask_b32 v231, v22, 0, vcc
    s_lshl_b32 s40, s25, 7
    s_lshl_b32 s41, s45, 5
    s_add_u32 s40, s40, s41
    s_lshl_b32 s40, s40, 11
    s_lshl_b32 s41, s24, 7
    s_add_u32 s40, s40, s41
    s_lshl_b32 s41, s44, 6
    s_add_u32 s40, s40, s41
    v_lshlrev_b32 v225, 12, v8
    v_lshl_add_u32 v225, v5, 4, v225
    v_add_u32 v225, s40, v225
    s_mov_b32 s58, 0x3e3504f3
    s_mov_b32 s59, 0x3fb8aa3b
    s_branch g1_attn
g1_compute:
    s_and_b32 s44, s28, 1
    s_lshr_b32 s45, s28, 1
    s_lshl_b32 s42, s44, 1
    s_mov_b32 s43, 0
    v_and_b32 v3, 1, v5
    v_lshlrev_b32 v3, 1, v3
    v_lshrrev_b32 v4, 1, v6
    v_or_b32 v3, v3, v4
    s_add_u32 s40, s42, 0
    v_xor_b32 v3, s40, v3
    v_lshlrev_b32 v3, 5, v3
    v_lshl_add_u32 v3, v7, 3, v3
    v_lshl_add_u32 v4, v5, 3, v6
    v_lshl_add_u32 v3, v4, 7, v3
    v_add_u32 v10, s43, v3
    v_and_b32 v3, 1, v5
    v_lshlrev_b32 v3, 1, v3
    v_lshrrev_b32 v4, 1, v6
    v_or_b32 v3, v3, v4
    s_add_u32 s40, s42, 1
    v_xor_b32 v3, s40, v3
    v_lshlrev_b32 v3, 5, v3
    v_lshl_add_u32 v3, v7, 3, v3
    v_lshl_add_u32 v4, v5, 3, v6
    v_lshl_add_u32 v3, v4, 7, v3
    v_add_u32 v11, s43, v3
    s_xor_b32 s43, s45, 1
    s_add_u32 s43, s43, 1
    s_mul_i32 s43, s43, 8192
    v_and_b32 v3, 1, v5
    v_lshlrev_b32 v3, 1, v3
    v_lshrrev_b32 v4, 1, v6
    v_or_b32 v3, v3, v4
    s_add_u32 s40, s42, 0
    v_xor_b32 v3, s40, v3
    v_lshlrev_b32 v3, 5, v3
    v_lshl_add_u32 v3, v7, 3, v3
    v_lshl_add_u32 v4, v5, 3, v6
    v_lshl_add_u32 v3, v4, 7, v3
    v_add_u32 v12, s43, v3
    v_and_b32 v3, 1, v5
    v_lshlrev_b32 v3, 1, v3
    v_lshrrev_b32 v4, 1, v6
    v_or_b32 v3, v3, v4
    s_add_u32 s40, s42, 1
    v_xor_b32 v3, s40, v3
    v_lshlrev_b32 v3, 5, v3
    v_lshl_add_u32 v3, v7, 3, v3
    v_lshl_add_u32 v4, v5, 3, v6
    v_lshl_add_u32 v3, v4, 7, v3
    v_add_u32 v13, s43, v3
    s_xor_b32 s43, s45, 0
    s_add_u32 s43, s43, 1
    s_mul_i32 s43, s43, 8192
    v_and_b32 v3, 1, v5
    v_lshlrev_b32 v3, 1, v3
    v_lshrrev_b32 v4, 1, v6
    v_or_b32 v3, v3, v4
    s_add_u32 s40, s42, 0
    v_xor_b32 v3, s40, v3
    v_lshlrev_b32 v3, 5, v3
    v_lshl_add_u32 v3, v7, 3, v3
    v_lshl_add_u32 v4, v5, 3, v6
    v_lshl_add_u32 v3, v4, 7, v3
    v_add_u32 v14, s43, v3
    v_and_b32 v3, 1, v5
    v_lshlrev_b32 v3, 1, v3
    v_lshrrev_b32 v4, 1, v6
    v_or_b32 v3, v3, v4
    s_add_u32 s40, s42, 1
    v_xor_b32 v3, s40, v3
    v_lshlrev_b32 v3, 5, v3
    v_lshl_add_u32 v3, v7, 3, v3
    v_lshl_add_u32 v4, v5, 3, v6
    v_lshl_add_u32 v3, v4, 7, v3
    v_add_u32 v15, s43, v3
    s_mul_i32 s42, s45, 64
    s_add_u32 s42, s42, 16
    v_lshrrev_b32 v3, 1, v8
    v_xor_b32 v3, v3, v5
    v_lshlrev_b32 v3, 4, v3
    v_lshl_add_u32 v3, v8, 7, v3
    s_lshl_b32 s40, s42, 7
    s_add_u32 s40, s40, 24576
    v_add_u32 v16, s40, v3
    v_xor_b32 v17, 64, v16
    v_lshrrev_b32 v3, 1, v8
    v_xor_b32 v3, v3, v5
    v_lshlrev_b32 v3, 4, v3
    v_lshl_add_u32 v3, v8, 7, v3
    v_add_u32 v18, 24576, v3
    v_xor_b32 v19, 64, v18
    v_mov_b32 v24, 0
    v_mov_b32 v25, 0
    v_mov_b32 v26, 0
    v_mov_b32 v27, 0
    v_mov_b32 v28, 0
    v_mov_b32 v29, 0
    v_mov_b32 v30, 0
    v_mov_b32 v31, 0
    v_mov_b32 v32, 0
    v_mov_b32 v33, 0
    v_mov_b32 v34, 0
    v_mov_b32 v35, 0
    v_mov_b32 v36, 0
    v_mov_b32 v37, 0
    v_mov_b32 v38, 0
    v_mov_b32 v39, 0
    v_mov_b32 v40, 0
    v_mov_b32 v41, 0
    v_mov_b32 v42, 0
    v_mov_b32 v43, 0
    v_mov_b32 v44, 0
    v_mov_b32 v45, 0
    v_mov_b32 v46, 0
    v_mov_b32 v47, 0
    v_mov_b32 v48, 0
    v_mov_b32 v49, 0
    v_mov_b32 v50, 0
    v_mov_b32 v51, 0
    v_mov_b32 v52, 0
    v_mov_b32 v53, 0
    v_mov_b32 v54, 0
    v_mov_b32 v55, 0
    v_mov_b32 v56, 0
    v_mov_b32 v57, 0
    v_mov_b32 v58, 0
    v_mov_b32 v59, 0
    v_mov_b32 v60, 0
    v_mov_b32 v61, 0
    v_mov_b32 v62, 0
    v_mov_b32 v63, 0
    v_mov_b32 v64, 0
    v_mov_b32 v65, 0
    v_mov_b32 v66, 0
    v_mov_b32 v67, 0
    v_mov_b32 v68, 0
    v_mov_b32 v69, 0
    v_mov_b32 v70, 0
    v_mov_b32 v71, 0
    v_mov_b32 v72, 0
    v_mov_b32 v73, 0
    v_mov_b32 v74, 0
    v_mov_b32 v75, 0
    v_mov_b32 v76, 0
    v_mov_b32 v77, 0
    v_mov_b32 v78, 0
    v_mov_b32 v79, 0
    v_mov_b32 v80, 0
    v_mov_b32 v81, 0
    v_mov_b32 v82, 0
    v_mov_b32 v83, 0
    v_mov_b32 v84, 0
    v_mov_b32 v85, 0
    v_mov_b32 v86, 0
    v_mov_b32 v87, 0
    v_mov_b32 v88, 0
    v_mov_b32 v89, 0
    v_mov_b32 v90, 0
    v_mov_b32 v91, 0
    v_mov_b32 v92, 0
    v_mov_b32 v93, 0
    v_mov_b32 v94, 0
    v_mov_b32 v95, 0
    v_mov_b32 v96, 0
    v_mov_b32 v97, 0
    v_mov_b32 v98, 0
    v_mov_b32 v99, 0
    v_mov_b32 v100, 0
    v_mov_b32 v101, 0
    v_mov_b32 v102, 0
    v_mov_b32 v103, 0
    v_mov_b32 v104, 0
    v_mov_b32 v105, 0
    v_mov_b32 v106, 0
    v_mov_b32 v107, 0
    v_mov_b32 v108, 0
    v_mov_b32 v109, 0
    v_mov_b32 v110, 0
    v_mov_b32 v111, 0
    v_mov_b32 v112, 0
    v_mov_b32 v113, 0
    v_mov_b32 v114, 0
    v_mov_b32 v115, 0
    v_mov_b32 v116, 0
    v_mov_b32 v117, 0
    v_mov_b32 v118, 0
    v_mov_b32 v119, 0
    v_mov_b32 v120, 0
    v_mov_b32 v121, 0
    v_mov_b32 v122, 0
    v_mov_b32 v123, 0
    v_mov_b32 v124, 0
    v_mov_b32 v125, 0
    v_mov_b32 v126, 0
    v_mov_b32 v127, 0
    s_mov_b32 s48, 16
    s_mov_b32 s50, 0
    s_mov_b32 s51, 43008
    s_mov_b32 s29, 0xfffeb000
    s_waitcnt lgkmcnt(0)
    s_add_u32 s4, s4, s97
    s_addc_u32 s5, s5, 0
    v_lshlrev_b32 v3, 3, v8
    v_add_u32 v217, 129024, v3
    s_mul_i32 s40, s45, 512
    s_add_u32 s40, s40, 129152
    v_add_u32 v216, s40, v3
    s_lshl_b32 s40, s44, 7
    s_add_u32 s40, s40, 130304
    v_lshl_add_u32 v3, v5, 4, s40
    s_mov_b32 s43, 0
    v_add_u32 v218, s43, v3
    s_xor_b32 s43, s45, 1
    s_add_u32 s43, s43, 1
    s_mul_i32 s43, s43, 256
    v_add_u32 v219, s43, v3
    s_xor_b32 s43, s45, 0
    s_add_u32 s43, s43, 1
    s_mul_i32 s43, s43, 256
    v_add_u32 v220, s43, v3
    v_and_b32 v3, 1, v5
    v_lshlrev_b32 v3, 1, v3
    v_lshrrev_b32 v4, 1, v5
    v_add_u32 v3, v3, v4
    s_lshl_b32 s40, s44, 2
    v_add_u32 v3, s40, v3
    v_lshrrev_b32 v4, 1, v8
    v_xor_b32 v3, v3, v4
    v_lshlrev_b32 v3, 4, v3
    v_lshl_add_u32 v3, v8, 7, v3
    s_mul_i32 s42, s45, 8192
    s_add_u32 s42, s42, 45056
    s_mov_b32 s43, 0
    s_add_u32 s40, s42, s43
    v_add_u32 v221, s40, v3
    s_xor_b32 s43, s45, 1
    s_add_u32 s43, s43, 1
    s_mul_i32 s43, s43, 18432
    s_add_u32 s40, s42, s43
    v_add_u32 v222, s40, v3
    s_xor_b32 s43, s45, 0
    s_add_u32 s43, s43, 1
    s_mul_i32 s43, s43, 18432
    s_add_u32 s40, s42, s43
    v_add_u32 v223, s40, v3
    s_add_u32 s40, s43, 43008
    v_add_u32 v224, s40, v3
    s_add_u32 s16, s4, 0x400000
    s_addc_u32 s17, s5, 0
    s_mov_b32 s18, 0x400000
    s_mov_b32 s19, 0x20000
    s_and_b32 s44, s28, 1
    s_lshr_b32 s45, s28, 1
    s_lshl_b32 s40, s44, 2
    v_add_u32 v3, s40, v5
    v_and_b32 v4, 7, v8
    v_xor_b32 v3, v3, v4
    v_lshlrev_b32 v3, 4, v3
    v_lshl_add_u32 v3, v8, 8, v3
    s_mul_i32 s41, s45, 4096
    s_add_u32 s41, s41, 43008
    v_add_u32 v226, s41, v3
    v_lshl_add_u32 v3, v5, 2, v6
    v_and_b32 v4, 7, v3
    v_add_u32 v228, s40, v7
    v_xor_b32 v4, v4, v228
    v_lshlrev_b32 v4, 4, v4
    v_lshl_add_u32 v3, v3, 8, v4
    s_add_u32 s41, s41, 36864
    v_add_u32 v227, s41, v3
    v_and_b32 v3, 7, v8
    v_add_u32 v4, 1, v3
    s_or_b32 s40, s25, s45
    s_cmp_eq_u32 s40, 0
    s_cselect_b32 s40, 8, 0
    v_cmp_gt_u32 vcc, 8, v8
    v_mov_b32 v21, s40
    s_mov_b64 s[56:57], vcc
    v_cndmask_b32 v21, 0, v21, vcc
    v_max_u32 v4, v4, v21
    v_add_u32 v3, 8, v3
    v_sub_u32 v3, v3, v4
    v_lshlrev_b32 v21, 2, v5
    v_sub_u32 v21, v21, v4
    v_mov_b32 v22, 0xf149f2ca
    v_add_u32 v23, 0, v21
    v_cmp_ge_u32 vcc, v3, v23
    s_nop 1
    v_cndmask_b32 v228, v22, 0, vcc
    v_add_u32 v23, 1, v21
    v_cmp_ge_u32 vcc, v3, v23
    s_nop 1
    v_cndmask_b32 v229, v22, 0, vcc
    v_add_u32 v23, 2, v21
    v_cmp_ge_u32 vcc, v3, v23
    s_nop 1
    v_cndmask_b32 v230, v22, 0, vcc
    v_add_u32 v23, 3, v21
    v_cmp_ge_u32 vcc, v3, v23
    s_nop 1
    v_cndmask_b32 v231, v22, 0, vcc
    s_lshl_b32 s40, s25, 7
    s_lshl_b32 s41, s45, 5
    s_add_u32 s40, s40, s41
    s_lshl_b32 s40, s40, 11
    s_lshl_b32 s41, s24, 7
    s_add_u32 s40, s40, s41
    s_lshl_b32 s41, s44, 6
    s_add_u32 s40, s40, s41
    v_lshlrev_b32 v225, 12, v8
    v_lshl_add_u32 v225, v5, 4, v225
    v_add_u32 v225, s40, v225
    s_mov_b32 s58, 0x3e3504f3
    s_mov_b32 s59, 0x3fb8aa3b
    s_barrier
    ds_read_b64_tr_b16 v[128:129], v10 offset:0
    ds_read_b64_tr_b16 v[130:131], v10 offset:512
    ds_read_b128 v[152:155], v16 offset:0
    ds_read_b128 v[156:159], v16 offset:2048
    ds_read_b128 v[160:163], v16 offset:4096
    ds_read_b128 v[164:167], v16 offset:6144
    ds_read_b64_tr_b16 v[132:133], v11 offset:0
    ds_read_b64_tr_b16 v[134:135], v11 offset:512
    ds_read_b64_tr_b16 v[136:137], v12 offset:0
    ds_read_b64_tr_b16 v[138:139], v12 offset:512
    ds_read_b64_tr_b16 v[140:141], v13 offset:0
    ds_read_b64_tr_b16 v[142:143], v13 offset:512
    ds_read_b64_tr_b16 v[144:145], v14 offset:0
    ds_read_b64_tr_b16 v[146:147], v14 offset:512
    ds_read_b64_tr_b16 v[148:149], v15 offset:0
    ds_read_b64_tr_b16 v[150:151], v15 offset:512
    ds_read_b128 v[168:171], v18 offset:0
    s_branch g1_cloop3
.p2align 3
g1_cloop:
    s_barrier
g1_cloop2:
    v_mfma_f32_16x16x32_bf16 v[24:27], v[172:175], v[196:199], v[24:27]
    ds_read_b64_tr_b16 v[128:129], v10 offset:0
    ds_read_b64_tr_b16 v[130:131], v10 offset:512
    v_mfma_f32_16x16x32_bf16 v[28:31], v[172:175], v[200:203], v[28:31]
    ds_read_b128 v[152:155], v16 offset:0
    v_mfma_f32_16x16x32_bf16 v[32:35], v[172:175], v[204:207], v[32:35]
    ds_read_b128 v[156:159], v16 offset:2048
    v_mfma_f32_16x16x32_bf16 v[36:39], v[172:175], v[208:211], v[36:39]
    ds_read_b128 v[160:163], v16 offset:4096
    v_mfma_f32_16x16x32_bf16 v[52:55], v[176:179], v[208:211], v[52:55]
    ds_read_b128 v[164:167], v16 offset:6144
    v_mfma_f32_16x16x32_bf16 v[48:51], v[176:179], v[204:207], v[48:51]
    ds_read_b64_tr_b16 v[132:133], v11 offset:0
    ds_read_b64_tr_b16 v[134:135], v11 offset:512
    v_mfma_f32_16x16x32_bf16 v[44:47], v[176:179], v[200:203], v[44:47]
    ds_read_b64_tr_b16 v[136:137], v12 offset:0
    ds_read_b64_tr_b16 v[138:139], v12 offset:512
    v_mfma_f32_16x16x32_bf16 v[40:43], v[176:179], v[196:199], v[40:43]
    ds_read_b64_tr_b16 v[140:141], v13 offset:0
    ds_read_b64_tr_b16 v[142:143], v13 offset:512
    v_mfma_f32_16x16x32_bf16 v[56:59], v[180:183], v[196:199], v[56:59]
    ds_read_b64_tr_b16 v[144:145], v14 offset:0
    ds_read_b64_tr_b16 v[146:147], v14 offset:512
    v_mfma_f32_16x16x32_bf16 v[60:63], v[180:183], v[200:203], v[60:63]
    ds_read_b64_tr_b16 v[148:149], v15 offset:0
    ds_read_b64_tr_b16 v[150:151], v15 offset:512
    v_mfma_f32_16x16x32_bf16 v[64:67], v[180:183], v[204:207], v[64:67]
    ds_read_b128 v[168:171], v18 offset:0
    v_mfma_f32_16x16x32_bf16 v[68:71], v[180:183], v[208:211], v[68:71]
    v_mfma_f32_16x16x32_bf16 v[84:87], v[184:187], v[208:211], v[84:87]
    v_mfma_f32_16x16x32_bf16 v[80:83], v[184:187], v[204:207], v[80:83]
    v_mfma_f32_16x16x32_bf16 v[76:79], v[184:187], v[200:203], v[76:79]
    v_mfma_f32_16x16x32_bf16 v[72:75], v[184:187], v[196:199], v[72:75]
    v_mfma_f32_16x16x32_bf16 v[88:91], v[188:191], v[196:199], v[88:91]
    v_mfma_f32_16x16x32_bf16 v[92:95], v[188:191], v[200:203], v[92:95]
    v_mfma_f32_16x16x32_bf16 v[96:99], v[188:191], v[204:207], v[96:99]
    v_mfma_f32_16x16x32_bf16 v[100:103], v[188:191], v[208:211], v[100:103]
    v_mfma_f32_16x16x32_bf16 v[120:123], v[188:191], v[212:215], v[120:123]
    v_mfma_f32_16x16x32_bf16 v[124:127], v[192:195], v[212:215], v[124:127]
    v_mfma_f32_16x16x32_bf16 v[116:119], v[192:195], v[208:211], v[116:119]
    v_mfma_f32_16x16x32_bf16 v[112:115], v[192:195], v[204:207], v[112:115]
    v_mfma_f32_16x16x32_bf16 v[108:111], v[192:195], v[200:203], v[108:111]
    v_mfma_f32_16x16x32_bf16 v[104:107], v[192:195], v[196:199], v[104:107]
g1_cloop3:
    s_waitcnt lgkmcnt(0)
    v_mfma_f32_16x16x32_bf16 v[24:27], v[128:131], v[152:155], v[24:27]
    ds_read_b64_tr_b16 v[172:173], v10 offset:4096
    ds_read_b64_tr_b16 v[174:175], v10 offset:4608
    v_mfma_f32_16x16x32_bf16 v[28:31], v[128:131], v[156:159], v[28:31]
    ds_read_b128 v[196:199], v17 offset:0
    v_mfma_f32_16x16x32_bf16 v[32:35], v[128:131], v[160:163], v[32:35]
    ds_read_b128 v[200:203], v17 offset:2048
    v_mfma_f32_16x16x32_bf16 v[36:39], v[128:131], v[164:167], v[36:39]
    ds_read_b128 v[204:207], v17 offset:4096
    v_mfma_f32_16x16x32_bf16 v[52:55], v[132:135], v[164:167], v[52:55]
    ds_read_b128 v[208:211], v17 offset:6144
    v_mfma_f32_16x16x32_bf16 v[48:51], v[132:135], v[160:163], v[48:51]
    ds_read_b64_tr_b16 v[176:177], v11 offset:4096
    ds_read_b64_tr_b16 v[178:179], v11 offset:4608
    v_mfma_f32_16x16x32_bf16 v[44:47], v[132:135], v[156:159], v[44:47]
    ds_read_b64_tr_b16 v[180:181], v12 offset:4096
    ds_read_b64_tr_b16 v[182:183], v12 offset:4608
    v_mfma_f32_16x16x32_bf16 v[40:43], v[132:135], v[152:155], v[40:43]
    ds_read_b64_tr_b16 v[184:185], v13 offset:4096
    ds_read_b64_tr_b16 v[186:187], v13 offset:4608
    v_mfma_f32_16x16x32_bf16 v[56:59], v[136:139], v[152:155], v[56:59]
    ds_read_b64_tr_b16 v[188:189], v14 offset:4096
    ds_read_b64_tr_b16 v[190:191], v14 offset:4608
    v_mfma_f32_16x16x32_bf16 v[60:63], v[136:139], v[156:159], v[60:63]
    ds_read_b64_tr_b16 v[192:193], v15 offset:4096
    ds_read_b64_tr_b16 v[194:195], v15 offset:4608
    v_mfma_f32_16x16x32_bf16 v[64:67], v[136:139], v[160:163], v[64:67]
    ds_read_b128 v[212:215], v19 offset:0
    v_mfma_f32_16x16x32_bf16 v[68:71], v[136:139], v[164:167], v[68:71]
    s_add_u32 s50, s50, 1
    s_cmp_eq_u32 s50, 3
    v_mfma_f32_16x16x32_bf16 v[84:87], v[140:143], v[164:167], v[84:87]
    s_cselect_b32 s49, s29, s51
    s_cselect_b32 s50, 0, s50
    v_mfma_f32_16x16x32_bf16 v[80:83], v[140:143], v[160:163], v[80:83]
    v_add_u32 v10, s49, v10
    v_add_u32 v11, s49, v11
    v_mfma_f32_16x16x32_bf16 v[76:79], v[140:143], v[156:159], v[76:79]
    v_add_u32 v12, s49, v12
    v_add_u32 v13, s49, v13
    v_mfma_f32_16x16x32_bf16 v[72:75], v[140:143], v[152:155], v[72:75]
    v_add_u32 v14, s49, v14
    v_add_u32 v15, s49, v15
    v_mfma_f32_16x16x32_bf16 v[88:91], v[144:147], v[152:155], v[88:91]
    v_add_u32 v16, s49, v16
    v_add_u32 v17, s49, v17
    v_mfma_f32_16x16x32_bf16 v[92:95], v[144:147], v[156:159], v[92:95]
    v_add_u32 v18, s49, v18
    v_add_u32 v19, s49, v19
    v_mfma_f32_16x16x32_bf16 v[96:99], v[144:147], v[160:163], v[96:99]
    s_sub_u32 s48, s48, 1
    s_cmp_lg_u32 s48, 0
    v_mfma_f32_16x16x32_bf16 v[100:103], v[144:147], v[164:167], v[100:103]
    v_mfma_f32_16x16x32_bf16 v[120:123], v[144:147], v[168:171], v[120:123]
    v_mfma_f32_16x16x32_bf16 v[124:127], v[148:151], v[168:171], v[124:127]
    v_mfma_f32_16x16x32_bf16 v[116:119], v[148:151], v[164:167], v[116:119]
    v_mfma_f32_16x16x32_bf16 v[112:115], v[148:151], v[160:163], v[112:115]
    v_mfma_f32_16x16x32_bf16 v[108:111], v[148:151], v[156:159], v[108:111]
    v_mfma_f32_16x16x32_bf16 v[104:107], v[148:151], v[152:155], v[104:107]
    s_waitcnt lgkmcnt(0)
    s_cbranch_scc1 g1_cloop
    ds_read_b64 v[128:129], v216 offset:0
    ds_read_b64 v[130:131], v216 offset:128
    ds_read_b64 v[132:133], v216 offset:256
    ds_read_b64 v[134:135], v216 offset:384
    ds_read_b64 v[136:137], v217
    ds_read_b128 v[140:143], v218 offset:0
    ds_read_b128 v[144:147], v218 offset:64
    ds_read_b128 v[148:151], v219 offset:0
    ds_read_b128 v[152:155], v219 offset:64
    ds_read_b128 v[156:159], v220 offset:0
    ds_read_b128 v[160:163], v220 offset:64
    v_mfma_f32_16x16x32_bf16 v[24:27], v[172:175], v[196:199], v[24:27]
    v_mfma_f32_16x16x32_bf16 v[40:43], v[176:179], v[196:199], v[40:43]
    v_mfma_f32_16x16x32_bf16 v[28:31], v[172:175], v[200:203], v[28:31]
    v_mfma_f32_16x16x32_bf16 v[44:47], v[176:179], v[200:203], v[44:47]
    v_mfma_f32_16x16x32_bf16 v[32:35], v[172:175], v[204:207], v[32:35]
    v_mfma_f32_16x16x32_bf16 v[48:51], v[176:179], v[204:207], v[48:51]
    s_waitcnt lgkmcnt(0)
    v_mfma_f32_16x16x32_bf16 v[36:39], v[172:175], v[208:211], v[36:39]
    v_pk_mul_f32 v[164:165], v[140:141], v[128:129] op_sel:[0,1] op_sel_hi:[1,1]
    v_pk_mul_f32 v[166:167], v[142:143], v[128:129] op_sel:[0,1] op_sel_hi:[1,1]
    v_pk_mul_f32 v[168:169], v[144:145], v[128:129] op_sel:[0,1] op_sel_hi:[1,1]
    v_pk_mul_f32 v[170:171], v[146:147], v[128:129] op_sel:[0,1] op_sel_hi:[1,1]
    v_pk_fma_f32 v[24:25], v[24:25], v[128:129], v[164:165] op_sel:[0,0,0] op_sel_hi:[1,0,1]
    v_pk_fma_f32 v[26:27], v[26:27], v[128:129], v[166:167] op_sel:[0,0,0] op_sel_hi:[1,0,1]
    v_pk_fma_f32 v[40:41], v[40:41], v[128:129], v[168:169] op_sel:[0,0,0] op_sel_hi:[1,0,1]
    v_pk_fma_f32 v[42:43], v[42:43], v[128:129], v[170:171] op_sel:[0,0,0] op_sel_hi:[1,0,1]
    v_mfma_f32_16x16x32_bf16 v[52:55], v[176:179], v[208:211], v[52:55]
    v_cvt_pk_bf16_f32 v232, v24, v25
    v_cvt_pk_bf16_f32 v233, v26, v27
    v_cvt_pk_bf16_f32 v234, v40, v41
    v_cvt_pk_bf16_f32 v235, v42, v43
    s_nop 1
    v_permlane16_swap_b32 v232, v234
    v_permlane16_swap_b32 v233, v235
    ds_write_b128 v221, v[232:235] offset:0
    v_mfma_f32_16x16x32_bf16 v[56:59], v[180:183], v[196:199], v[56:59]
    v_pk_mul_f32 v[164:165], v[140:141], v[130:131] op_sel:[0,1] op_sel_hi:[1,1]
    v_pk_mul_f32 v[166:167], v[142:143], v[130:131] op_sel:[0,1] op_sel_hi:[1,1]
    v_pk_mul_f32 v[168:169], v[144:145], v[130:131] op_sel:[0,1] op_sel_hi:[1,1]
    v_pk_mul_f32 v[170:171], v[146:147], v[130:131] op_sel:[0,1] op_sel_hi:[1,1]
    v_pk_fma_f32 v[28:29], v[28:29], v[130:131], v[164:165] op_sel:[0,0,0] op_sel_hi:[1,0,1]
    v_pk_fma_f32 v[30:31], v[30:31], v[130:131], v[166:167] op_sel:[0,0,0] op_sel_hi:[1,0,1]
    v_pk_fma_f32 v[44:45], v[44:45], v[130:131], v[168:169] op_sel:[0,0,0] op_sel_hi:[1,0,1]
    v_pk_fma_f32 v[46:47], v[46:47], v[130:131], v[170:171] op_sel:[0,0,0] op_sel_hi:[1,0,1]
    v_mfma_f32_16x16x32_bf16 v[72:75], v[184:187], v[196:199], v[72:75]
    v_cvt_pk_bf16_f32 v236, v28, v29
    v_cvt_pk_bf16_f32 v237, v30, v31
    v_cvt_pk_bf16_f32 v238, v44, v45
    v_cvt_pk_bf16_f32 v239, v46, v47
    s_nop 1
    v_permlane16_swap_b32 v236, v238
    v_permlane16_swap_b32 v237, v239
    ds_write_b128 v221, v[236:239] offset:2048
    v_mfma_f32_16x16x32_bf16 v[60:63], v[180:183], v[200:203], v[60:63]
    v_pk_mul_f32 v[164:165], v[140:141], v[132:133] op_sel:[0,1] op_sel_hi:[1,1]
    v_pk_mul_f32 v[166:167], v[142:143], v[132:133] op_sel:[0,1] op_sel_hi:[1,1]
    v_pk_mul_f32 v[168:169], v[144:145], v[132:133] op_sel:[0,1] op_sel_hi:[1,1]
    v_pk_mul_f32 v[170:171], v[146:147], v[132:133] op_sel:[0,1] op_sel_hi:[1,1]
    v_pk_fma_f32 v[32:33], v[32:33], v[132:133], v[164:165] op_sel:[0,0,0] op_sel_hi:[1,0,1]
    v_pk_fma_f32 v[34:35], v[34:35], v[132:133], v[166:167] op_sel:[0,0,0] op_sel_hi:[1,0,1]
    v_pk_fma_f32 v[48:49], v[48:49], v[132:133], v[168:169] op_sel:[0,0,0] op_sel_hi:[1,0,1]
    v_pk_fma_f32 v[50:51], v[50:51], v[132:133], v[170:171] op_sel:[0,0,0] op_sel_hi:[1,0,1]
    v_mfma_f32_16x16x32_bf16 v[76:79], v[184:187], v[200:203], v[76:79]
    v_cvt_pk_bf16_f32 v240, v32, v33
    v_cvt_pk_bf16_f32 v241, v34, v35
    v_cvt_pk_bf16_f32 v242, v48, v49
    v_cvt_pk_bf16_f32 v243, v50, v51
    s_nop 1
    v_permlane16_swap_b32 v240, v242
    v_permlane16_swap_b32 v241, v243
    ds_write_b128 v221, v[240:243] offset:4096
    v_mfma_f32_16x16x32_bf16 v[64:67], v[180:183], v[204:207], v[64:67]
    v_pk_mul_f32 v[164:165], v[140:141], v[134:135] op_sel:[0,1] op_sel_hi:[1,1]
    v_pk_mul_f32 v[166:167], v[142:143], v[134:135] op_sel:[0,1] op_sel_hi:[1,1]
    v_pk_mul_f32 v[168:169], v[144:145], v[134:135] op_sel:[0,1] op_sel_hi:[1,1]
    v_pk_mul_f32 v[170:171], v[146:147], v[134:135] op_sel:[0,1] op_sel_hi:[1,1]
    v_pk_fma_f32 v[36:37], v[36:37], v[134:135], v[164:165] op_sel:[0,0,0] op_sel_hi:[1,0,1]
    v_pk_fma_f32 v[38:39], v[38:39], v[134:135], v[166:167] op_sel:[0,0,0] op_sel_hi:[1,0,1]
    v_pk_fma_f32 v[52:53], v[52:53], v[134:135], v[168:169] op_sel:[0,0,0] op_sel_hi:[1,0,1]
    v_pk_fma_f32 v[54:55], v[54:55], v[134:135], v[170:171] op_sel:[0,0,0] op_sel_hi:[1,0,1]
    v_mfma_f32_16x16x32_bf16 v[80:83], v[184:187], v[204:207], v[80:83]
    v_cvt_pk_bf16_f32 v244, v36, v37
    v_cvt_pk_bf16_f32 v245, v38, v39
    v_cvt_pk_bf16_f32 v246, v52, v53
    v_cvt_pk_bf16_f32 v247, v54, v55
    s_nop 1
    v_permlane16_swap_b32 v244, v246
    v_permlane16_swap_b32 v245, v247
    ds_write_b128 v221, v[244:247] offset:6144
    v_mfma_f32_16x16x32_bf16 v[68:71], v[180:183], v[208:211], v[68:71]
    v_pk_mul_f32 v[164:165], v[148:149], v[128:129] op_sel:[0,1] op_sel_hi:[1,1]
    v_pk_mul_f32 v[166:167], v[150:151], v[128:129] op_sel:[0,1] op_sel_hi:[1,1]
    v_pk_mul_f32 v[168:169], v[152:153], v[128:129] op_sel:[0,1] op_sel_hi:[1,1]
    v_pk_mul_f32 v[170:171], v[154:155], v[128:129] op_sel:[0,1] op_sel_hi:[1,1]
    v_pk_fma_f32 v[56:57], v[56:57], v[128:129], v[164:165] op_sel:[0,0,0] op_sel_hi:[1,0,1]
    v_pk_fma_f32 v[58:59], v[58:59], v[128:129], v[166:167] op_sel:[0,0,0] op_sel_hi:[1,0,1]
    v_pk_fma_f32 v[72:73], v[72:73], v[128:129], v[168:169] op_sel:[0,0,0] op_sel_hi:[1,0,1]
    v_pk_fma_f32 v[74:75], v[74:75], v[128:129], v[170:171] op_sel:[0,0,0] op_sel_hi:[1,0,1]
    v_mfma_f32_16x16x32_bf16 v[84:87], v[184:187], v[208:211], v[84:87]
    v_cvt_pk_bf16_f32 v232, v56, v57
    v_cvt_pk_bf16_f32 v233, v58, v59
    v_cvt_pk_bf16_f32 v234, v72, v73
    v_cvt_pk_bf16_f32 v235, v74, v75
    s_nop 1
    v_permlane16_swap_b32 v232, v234
    v_permlane16_swap_b32 v233, v235
    ds_write_b128 v222, v[232:235] offset:0
    v_mfma_f32_16x16x32_bf16 v[88:91], v[188:191], v[196:199], v[88:91]
    v_pk_mul_f32 v[164:165], v[148:149], v[130:131] op_sel:[0,1] op_sel_hi:[1,1]
    v_pk_mul_f32 v[166:167], v[150:151], v[130:131] op_sel:[0,1] op_sel_hi:[1,1]
    v_pk_mul_f32 v[168:169], v[152:153], v[130:131] op_sel:[0,1] op_sel_hi:[1,1]
    v_pk_mul_f32 v[170:171], v[154:155], v[130:131] op_sel:[0,1] op_sel_hi:[1,1]
    v_pk_fma_f32 v[60:61], v[60:61], v[130:131], v[164:165] op_sel:[0,0,0] op_sel_hi:[1,0,1]
    v_pk_fma_f32 v[62:63], v[62:63], v[130:131], v[166:167] op_sel:[0,0,0] op_sel_hi:[1,0,1]
    v_pk_fma_f32 v[76:77], v[76:77], v[130:131], v[168:169] op_sel:[0,0,0] op_sel_hi:[1,0,1]
    v_pk_fma_f32 v[78:79], v[78:79], v[130:131], v[170:171] op_sel:[0,0,0] op_sel_hi:[1,0,1]
    v_mfma_f32_16x16x32_bf16 v[104:107], v[192:195], v[196:199], v[104:107]
    v_cvt_pk_bf16_f32 v236, v60, v61
    v_cvt_pk_bf16_f32 v237, v62, v63
    v_cvt_pk_bf16_f32 v238, v76, v77
    v_cvt_pk_bf16_f32 v239, v78, v79
    s_nop 1
    v_permlane16_swap_b32 v236, v238
    v_permlane16_swap_b32 v237, v239
    ds_write_b128 v222, v[236:239] offset:2048
    v_mfma_f32_16x16x32_bf16 v[92:95], v[188:191], v[200:203], v[92:95]
    v_pk_mul_f32 v[164:165], v[148:149], v[132:133] op_sel:[0,1] op_sel_hi:[1,1]
    v_pk_mul_f32 v[166:167], v[150:151], v[132:133] op_sel:[0,1] op_sel_hi:[1,1]
    v_pk_mul_f32 v[168:169], v[152:153], v[132:133] op_sel:[0,1] op_sel_hi:[1,1]
    v_pk_mul_f32 v[170:171], v[154:155], v[132:133] op_sel:[0,1] op_sel_hi:[1,1]
    v_pk_fma_f32 v[64:65], v[64:65], v[132:133], v[164:165] op_sel:[0,0,0] op_sel_hi:[1,0,1]
    v_pk_fma_f32 v[66:67], v[66:67], v[132:133], v[166:167] op_sel:[0,0,0] op_sel_hi:[1,0,1]
    v_pk_fma_f32 v[80:81], v[80:81], v[132:133], v[168:169] op_sel:[0,0,0] op_sel_hi:[1,0,1]
    v_pk_fma_f32 v[82:83], v[82:83], v[132:133], v[170:171] op_sel:[0,0,0] op_sel_hi:[1,0,1]
    v_mfma_f32_16x16x32_bf16 v[108:111], v[192:195], v[200:203], v[108:111]
    v_cvt_pk_bf16_f32 v240, v64, v65
    v_cvt_pk_bf16_f32 v241, v66, v67
    v_cvt_pk_bf16_f32 v242, v80, v81
    v_cvt_pk_bf16_f32 v243, v82, v83
    s_nop 1
    v_permlane16_swap_b32 v240, v242
    v_permlane16_swap_b32 v241, v243
    ds_write_b128 v222, v[240:243] offset:4096
    v_mfma_f32_16x16x32_bf16 v[96:99], v[188:191], v[204:207], v[96:99]
    v_pk_mul_f32 v[164:165], v[148:149], v[134:135] op_sel:[0,1] op_sel_hi:[1,1]
    v_pk_mul_f32 v[166:167], v[150:151], v[134:135] op_sel:[0,1] op_sel_hi:[1,1]
    v_pk_mul_f32 v[168:169], v[152:153], v[134:135] op_sel:[0,1] op_sel_hi:[1,1]
    v_pk_mul_f32 v[170:171], v[154:155], v[134:135] op_sel:[0,1] op_sel_hi:[1,1]
    v_pk_fma_f32 v[68:69], v[68:69], v[134:135], v[164:165] op_sel:[0,0,0] op_sel_hi:[1,0,1]
    v_pk_fma_f32 v[70:71], v[70:71], v[134:135], v[166:167] op_sel:[0,0,0] op_sel_hi:[1,0,1]
    v_pk_fma_f32 v[84:85], v[84:85], v[134:135], v[168:169] op_sel:[0,0,0] op_sel_hi:[1,0,1]
    v_pk_fma_f32 v[86:87], v[86:87], v[134:135], v[170:171] op_sel:[0,0,0] op_sel_hi:[1,0,1]
    v_mfma_f32_16x16x32_bf16 v[112:115], v[192:195], v[204:207], v[112:115]
    v_cvt_pk_bf16_f32 v244, v68, v69
    v_cvt_pk_bf16_f32 v245, v70, v71
    v_cvt_pk_bf16_f32 v246, v84, v85
    v_cvt_pk_bf16_f32 v247, v86, v87
    s_nop 1
    v_permlane16_swap_b32 v244, v246
    v_permlane16_swap_b32 v245, v247
    ds_write_b128 v222, v[244:247] offset:6144
    v_mfma_f32_16x16x32_bf16 v[100:103], v[188:191], v[208:211], v[100:103]
    v_pk_mul_f32 v[164:165], v[156:157], v[128:129] op_sel:[0,1] op_sel_hi:[1,1]
    v_pk_mul_f32 v[166:167], v[158:159], v[128:129] op_sel:[0,1] op_sel_hi:[1,1]
    v_pk_mul_f32 v[168:169], v[160:161], v[128:129] op_sel:[0,1] op_sel_hi:[1,1]
    v_pk_mul_f32 v[170:171], v[162:163], v[128:129] op_sel:[0,1] op_sel_hi:[1,1]
    v_pk_fma_f32 v[88:89], v[88:89], v[128:129], v[164:165] op_sel:[0,0,0] op_sel_hi:[1,0,1]
    v_pk_fma_f32 v[90:91], v[90:91], v[128:129], v[166:167] op_sel:[0,0,0] op_sel_hi:[1,0,1]
    v_pk_fma_f32 v[104:105], v[104:105], v[128:129], v[168:169] op_sel:[0,0,0] op_sel_hi:[1,0,1]
    v_pk_fma_f32 v[106:107], v[106:107], v[128:129], v[170:171] op_sel:[0,0,0] op_sel_hi:[1,0,1]
    v_mfma_f32_16x16x32_bf16 v[116:119], v[192:195], v[208:211], v[116:119]
    v_cvt_pk_bf16_f32 v232, v88, v89
    v_cvt_pk_bf16_f32 v233, v90, v91
    v_cvt_pk_bf16_f32 v234, v104, v105
    v_cvt_pk_bf16_f32 v235, v106, v107
    s_nop 1
    v_permlane16_swap_b32 v232, v234
    v_permlane16_swap_b32 v233, v235
    ds_write_b128 v223, v[232:235] offset:0
    v_mfma_f32_16x16x32_bf16 v[120:123], v[188:191], v[212:215], v[120:123]
    v_pk_mul_f32 v[164:165], v[156:157], v[130:131] op_sel:[0,1] op_sel_hi:[1,1]
    v_pk_mul_f32 v[166:167], v[158:159], v[130:131] op_sel:[0,1] op_sel_hi:[1,1]
    v_pk_mul_f32 v[168:169], v[160:161], v[130:131] op_sel:[0,1] op_sel_hi:[1,1]
    v_pk_mul_f32 v[170:171], v[162:163], v[130:131] op_sel:[0,1] op_sel_hi:[1,1]
    v_pk_fma_f32 v[92:93], v[92:93], v[130:131], v[164:165] op_sel:[0,0,0] op_sel_hi:[1,0,1]
    v_pk_fma_f32 v[94:95], v[94:95], v[130:131], v[166:167] op_sel:[0,0,0] op_sel_hi:[1,0,1]
    v_pk_fma_f32 v[108:109], v[108:109], v[130:131], v[168:169] op_sel:[0,0,0] op_sel_hi:[1,0,1]
    v_pk_fma_f32 v[110:111], v[110:111], v[130:131], v[170:171] op_sel:[0,0,0] op_sel_hi:[1,0,1]
    v_mfma_f32_16x16x32_bf16 v[124:127], v[192:195], v[212:215], v[124:127]
    v_cvt_pk_bf16_f32 v236, v92, v93
    v_cvt_pk_bf16_f32 v237, v94, v95
    v_cvt_pk_bf16_f32 v238, v108, v109
    v_cvt_pk_bf16_f32 v239, v110, v111
    s_nop 1
    v_permlane16_swap_b32 v236, v238
    v_permlane16_swap_b32 v237, v239
    ds_write_b128 v223, v[236:239] offset:2048
    v_pk_mul_f32 v[164:165], v[156:157], v[132:133] op_sel:[0,1] op_sel_hi:[1,1]
    v_pk_mul_f32 v[166:167], v[158:159], v[132:133] op_sel:[0,1] op_sel_hi:[1,1]
    v_pk_mul_f32 v[168:169], v[160:161], v[132:133] op_sel:[0,1] op_sel_hi:[1,1]
    v_pk_mul_f32 v[170:171], v[162:163], v[132:133] op_sel:[0,1] op_sel_hi:[1,1]
    v_pk_fma_f32 v[96:97], v[96:97], v[132:133], v[164:165] op_sel:[0,0,0] op_sel_hi:[1,0,1]
    v_pk_fma_f32 v[98:99], v[98:99], v[132:133], v[166:167] op_sel:[0,0,0] op_sel_hi:[1,0,1]
    v_pk_fma_f32 v[112:113], v[112:113], v[132:133], v[168:169] op_sel:[0,0,0] op_sel_hi:[1,0,1]
    v_pk_fma_f32 v[114:115], v[114:115], v[132:133], v[170:171] op_sel:[0,0,0] op_sel_hi:[1,0,1]
    v_cvt_pk_bf16_f32 v240, v96, v97
    v_cvt_pk_bf16_f32 v241, v98, v99
    v_cvt_pk_bf16_f32 v242, v112, v113
    v_cvt_pk_bf16_f32 v243, v114, v115
    s_nop 1
    v_permlane16_swap_b32 v240, v242
    v_permlane16_swap_b32 v241, v243
    ds_write_b128 v223, v[240:243] offset:4096
    v_pk_mul_f32 v[164:165], v[156:157], v[134:135] op_sel:[0,1] op_sel_hi:[1,1]
    v_pk_mul_f32 v[166:167], v[158:159], v[134:135] op_sel:[0,1] op_sel_hi:[1,1]
    v_pk_mul_f32 v[168:169], v[160:161], v[134:135] op_sel:[0,1] op_sel_hi:[1,1]
    v_pk_mul_f32 v[170:171], v[162:163], v[134:135] op_sel:[0,1] op_sel_hi:[1,1]
    v_pk_fma_f32 v[100:101], v[100:101], v[134:135], v[164:165] op_sel:[0,0,0] op_sel_hi:[1,0,1]
    v_pk_fma_f32 v[102:103], v[102:103], v[134:135], v[166:167] op_sel:[0,0,0] op_sel_hi:[1,0,1]
    v_pk_fma_f32 v[116:117], v[116:117], v[134:135], v[168:169] op_sel:[0,0,0] op_sel_hi:[1,0,1]
    v_pk_fma_f32 v[118:119], v[118:119], v[134:135], v[170:171] op_sel:[0,0,0] op_sel_hi:[1,0,1]
    v_cvt_pk_bf16_f32 v244, v100, v101
    v_cvt_pk_bf16_f32 v245, v102, v103
    v_cvt_pk_bf16_f32 v246, v116, v117
    v_cvt_pk_bf16_f32 v247, v118, v119
    s_nop 1
    v_permlane16_swap_b32 v244, v246
    v_permlane16_swap_b32 v245, v247
    ds_write_b128 v223, v[244:247] offset:6144
    v_pk_mul_f32 v[164:165], v[156:157], v[136:137] op_sel:[0,1] op_sel_hi:[1,1]
    v_pk_mul_f32 v[166:167], v[158:159], v[136:137] op_sel:[0,1] op_sel_hi:[1,1]
    v_pk_mul_f32 v[168:169], v[160:161], v[136:137] op_sel:[0,1] op_sel_hi:[1,1]
    v_pk_mul_f32 v[170:171], v[162:163], v[136:137] op_sel:[0,1] op_sel_hi:[1,1]
    v_pk_fma_f32 v[120:121], v[120:121], v[136:137], v[164:165] op_sel:[0,0,0] op_sel_hi:[1,0,1]
    v_pk_fma_f32 v[122:123], v[122:123], v[136:137], v[166:167] op_sel:[0,0,0] op_sel_hi:[1,0,1]
    v_pk_fma_f32 v[124:125], v[124:125], v[136:137], v[168:169] op_sel:[0,0,0] op_sel_hi:[1,0,1]
    v_pk_fma_f32 v[126:127], v[126:127], v[136:137], v[170:171] op_sel:[0,0,0] op_sel_hi:[1,0,1]
    v_cvt_pk_bf16_f32 v232, v120, v121
    v_cvt_pk_bf16_f32 v233, v122, v123
    v_cvt_pk_bf16_f32 v234, v124, v125
    v_cvt_pk_bf16_f32 v235, v126, v127
    s_nop 1
    v_permlane16_swap_b32 v232, v234
    v_permlane16_swap_b32 v233, v235
    ds_write_b128 v224, v[232:235]
    s_waitcnt lgkmcnt(0)
g1_attn:
    s_barrier
    ds_read_b128 v[24:27], v226 offset:2048
    ds_read_b128 v[28:31], v226 offset:18432
    ds_read_b128 v[32:35], v226 offset:20480
    ds_read_b128 v[72:75], v226 offset:2176
    ds_read_b128 v[76:79], v226 offset:18560
    ds_read_b128 v[80:83], v226 offset:20608
    ds_read_b64_tr_b16 v[36:37], v227 offset:0
    ds_read_b64_tr_b16 v[38:39], v227 offset:2048
    ds_read_b64_tr_b16 v[40:41], v227 offset:8
    ds_read_b64_tr_b16 v[42:43], v227 offset:2056
    ds_read_b64_tr_b16 v[84:85], v227 offset:128
    ds_read_b64_tr_b16 v[86:87], v227 offset:2176
    ds_read_b64_tr_b16 v[88:89], v227 offset:136
    ds_read_b64_tr_b16 v[90:91], v227 offset:2184
    s_waitcnt lgkmcnt(8)
    v_mfma_f32_16x16x32_bf16 v[44:47], v[28:31], v[24:27], 0
    v_mfma_f32_16x16x32_bf16 v[48:51], v[32:35], v[24:27], 0
    v_mfma_f32_16x16x32_bf16 v[92:95], v[76:79], v[72:75], 0
    v_mfma_f32_16x16x32_bf16 v[96:99], v[80:83], v[72:75], 0
    s_nop 7
    v_cndmask_b32 v44, v48, v44, s[56:57]
    v_cndmask_b32 v45, v49, v45, s[56:57]
    v_cndmask_b32 v46, v50, v46, s[56:57]
    v_cndmask_b32 v47, v51, v47, s[56:57]
    v_cndmask_b32 v92, v96, v92, s[56:57]
    v_cndmask_b32 v93, v97, v93, s[56:57]
    v_cndmask_b32 v94, v98, v94, s[56:57]
    v_cndmask_b32 v95, v99, v95, s[56:57]
    v_cvt_pk_bf16_f32 v48, v44, v45
    v_cvt_pk_bf16_f32 v49, v46, v47
    v_cvt_pk_bf16_f32 v96, v92, v93
    v_cvt_pk_bf16_f32 v97, v94, v95
    v_lshlrev_b32 v44, 16, v48
    v_and_b32 v45, 0xffff0000, v48
    v_lshlrev_b32 v46, 16, v49
    v_and_b32 v47, 0xffff0000, v49
    v_lshlrev_b32 v92, 16, v96
    v_and_b32 v93, 0xffff0000, v96
    v_lshlrev_b32 v94, 16, v97
    v_and_b32 v95, 0xffff0000, v97
    v_mul_f32 v44, s58, v44
    v_mul_f32 v45, s58, v45
    v_mul_f32 v46, s58, v46
    v_mul_f32 v47, s58, v47
    v_mul_f32 v92, s58, v92
    v_mul_f32 v93, s58, v93
    v_mul_f32 v94, s58, v94
    v_mul_f32 v95, s58, v95
    v_cvt_pk_bf16_f32 v48, v44, v45
    v_cvt_pk_bf16_f32 v49, v46, v47
    v_cvt_pk_bf16_f32 v96, v92, v93
    v_cvt_pk_bf16_f32 v97, v94, v95
    v_lshlrev_b32 v44, 16, v48
    v_and_b32 v45, 0xffff0000, v48
    v_lshlrev_b32 v46, 16, v49
    v_and_b32 v47, 0xffff0000, v49
    v_lshlrev_b32 v92, 16, v96
    v_and_b32 v93, 0xffff0000, v96
    v_lshlrev_b32 v94, 16, v97
    v_and_b32 v95, 0xffff0000, v97
    v_fma_f32 v44, v44, s59, v228
    v_fma_f32 v45, v45, s59, v229
    v_fma_f32 v46, v46, s59, v230
    v_fma_f32 v47, v47, s59, v231
    v_fma_f32 v92, v92, s59, v228
    v_fma_f32 v93, v93, s59, v229
    v_fma_f32 v94, v94, s59, v230
    v_fma_f32 v95, v95, s59, v231
    v_max3_f32 v48, v44, v45, v46
    v_max3_f32 v96, v92, v93, v94
    v_max_f32 v48, v48, v47
    v_max_f32 v96, v96, v95
    v_mov_b32 v49, v48
    v_mov_b32 v97, v96
    s_nop 1
    v_permlane16_swap_b32 v48, v49
    v_permlane16_swap_b32 v96, v97
    s_nop 0
    v_max_f32 v48, v48, v49
    v_max_f32 v96, v96, v97
    v_mov_b32 v49, v48
    v_mov_b32 v97, v96
    s_nop 1
    v_permlane32_swap_b32 v48, v49
    v_permlane32_swap_b32 v96, v97
    s_nop 0
    v_max_f32 v48, v48, v49
    v_max_f32 v96, v96, v97
    v_sub_f32 v44, v44, v48
    v_sub_f32 v45, v45, v48
    v_sub_f32 v46, v46, v48
    v_sub_f32 v47, v47, v48
    v_sub_f32 v92, v92, v96
    v_sub_f32 v93, v93, v96
    v_sub_f32 v94, v94, v96
    v_sub_f32 v95, v95, v96
    v_exp_f32 v44, v44
    v_exp_f32 v45, v45
    v_exp_f32 v46, v46
    v_exp_f32 v47, v47
    v_exp_f32 v92, v92
    v_exp_f32 v93, v93
    v_exp_f32 v94, v94
    v_exp_f32 v95, v95
    v_add_f32 v48, v44, v45
    v_add_f32 v49, v46, v47
    v_add_f32 v96, v92, v93
    v_add_f32 v97, v94, v95
    v_add_f32 v48, v48, v49
    v_add_f32 v96, v96, v97
    v_mov_b32 v49, v48
    v_mov_b32 v97, v96
    s_nop 1
    v_permlane16_swap_b32 v48, v49
    v_permlane16_swap_b32 v96, v97
    s_nop 0
    v_add_f32 v48, v48, v49
    v_add_f32 v96, v96, v97
    v_mov_b32 v49, v48
    v_mov_b32 v97, v96
    s_nop 1
    v_permlane32_swap_b32 v48, v49
    v_permlane32_swap_b32 v96, v97
    s_nop 0
    v_add_f32 v48, v48, v49
    v_add_f32 v96, v96, v97
    v_rcp_f32 v48, v48
    v_rcp_f32 v96, v96
    s_nop 0
    v_mul_f32 v44, v44, v48
    v_mul_f32 v45, v45, v48
    v_mul_f32 v46, v46, v48
    v_mul_f32 v47, v47, v48
    v_mul_f32 v92, v92, v96
    v_mul_f32 v93, v93, v96
    v_mul_f32 v94, v94, v96
    v_mul_f32 v95, v95, v96
    v_cvt_pk_bf16_f32 v48, v44, v45
    v_cvt_pk_bf16_f32 v49, v46, v47
    v_cvt_pk_bf16_f32 v96, v92, v93
    v_cvt_pk_bf16_f32 v97, v94, v95
    v_cndmask_b32 v52, 0, v48, s[56:57]
    v_cndmask_b32 v53, 0, v49, s[56:57]
    v_cndmask_b32 v54, v48, 0, s[56:57]
    v_cndmask_b32 v55, v49, 0, s[56:57]
    v_cndmask_b32 v100, 0, v96, s[56:57]
    v_cndmask_b32 v101, 0, v97, s[56:57]
    v_cndmask_b32 v102, v96, 0, s[56:57]
    v_cndmask_b32 v103, v97, 0, s[56:57]
    s_waitcnt lgkmcnt(0)
    s_nop 0
    v_mfma_f32_16x16x32_bf16 v[56:59], v[36:39], v[52:55], 0
    v_mfma_f32_16x16x32_bf16 v[60:63], v[40:43], v[52:55], 0
    v_mfma_f32_16x16x32_bf16 v[104:107], v[84:87], v[100:103], 0
    v_mfma_f32_16x16x32_bf16 v[108:111], v[88:91], v[100:103], 0
    s_nop 7
    v_cvt_pk_bf16_f32 v64, v56, v57
    v_cvt_pk_bf16_f32 v65, v58, v59
    v_cvt_pk_bf16_f32 v66, v60, v61
    v_cvt_pk_bf16_f32 v67, v62, v63
    buffer_store_dwordx4 v[64:67], v225, s[16:19], 0 offen offset:0 sc1
    v_cvt_pk_bf16_f32 v112, v104, v105
    v_cvt_pk_bf16_f32 v113, v106, v107
    v_cvt_pk_bf16_f32 v114, v108, v109
    v_cvt_pk_bf16_f32 v115, v110, v111
    buffer_store_dwordx4 v[112:115], v225, s[16:19], 0 offen offset:2048 sc1
    s_add_u32 s40, s25, 0
    s_lshl_b32 s40, s40, 8
    s_mov_b32 s41, s24
    s_add_u32 s84, s4, 0x300000
    s_addc_u32 s85, s5, 0
    s_mov_b32 s86, 0x4000
    s_mov_b32 s87, 0x20000
    s_lshl_b32 s41, s41, 2
    s_add_u32 s40, s40, s41
    v_mov_b32 v3, s40
    v_mov_b32 v4, 1
    s_waitcnt vmcnt(0)
    s_barrier
    s_cmp_lg_u32 s28, 0
    s_cbranch_scc1 g1_cin
    s_mov_b64 exec, 1
    buffer_store_dword v4, v3, s[84:87], 0 offen sc1
    s_mov_b64 exec, -1
g1_cin:
    s_branch g2_in
g1_done:
    s_endpgm
.p2align 6
g2_in:
    s_cmp_ge_u32 s2, 256
    s_cbranch_scc1 g2_done
    s_load_dwordx2 s[4:5], s[0:1], 80
    s_load_dwordx2 s[6:7], s[0:1], 0
    s_load_dwordx2 s[30:31], s[0:1], 16
    v_lshrrev_b32 v1, 6, v0
    v_and_b32 v2, 63, v0
    s_and_b32 s40, s2, 3
    s_lshl_b32 s40, s40, 2
    s_bfe_u32 s41, s2, 0x20003
    s_add_u32 s25, s40, s41
    s_bfe_u32 s40, s2, 0x10002
    s_lshl_b32 s40, s40, 3
    s_lshr_b32 s42, s2, 5
    s_add_u32 s24, s40, s42
    s_add_u32 s27, s41, s42
    s_mov_b32 s26, 0
    v_readfirstlane_b32 s28, v1
    s_nop 0
    s_cmp_lt_u32 s28, 4
    s_cbranch_scc1 g2_compute
    s_sub_u32 s28, s28, 4
    s_mov_b32 s40, 2048
    v_lshrrev_b32 v3, 3, v2
    v_mul_lo_u32 v3, v3, s40
    v_bfe_u32 v4, v2, 4, 1
    v_lshlrev_b32 v4, 1, v4
    v_xor_b32 v4, v4, v2
    v_and_b32 v4, 7, v4
    v_lshl_add_u32 v3, v4, 4, v3
    s_mul_i32 s41, s24, 128
    s_mul_i32 s42, s28, 32768
    s_add_u32 s41, s41, s42
    v_xor_b32 v4, 64, v3
    s_add_u32 s42, s41, 0
    v_add_u32 v10, s42, v3
    s_add_u32 s42, s41, 16384
    v_add_u32 v11, s42, v4
    s_mov_b32 s40, 2048
    v_lshrrev_b32 v3, 3, v2
    v_mul_lo_u32 v3, v3, s40
    v_lshrrev_b32 v4, 4, v2
    v_xor_b32 v4, v4, v2
    v_and_b32 v4, 7, v4
    v_lshl_add_u32 v3, v4, 4, v3
    s_mul_i32 s41, s25, 262144
    s_mul_i32 s42, s28, 65536
    s_add_u32 s41, s41, s42
    v_xor_b32 v4, 64, v3
    s_add_u32 s42, s41, 0
    v_add_u32 v12, s42, v3
    s_add_u32 s42, s41, 16384
    v_add_u32 v13, s42, v4
    s_add_u32 s42, s41, 32768
    v_add_u32 v14, s42, v3
    s_add_u32 s42, s41, 49152
    v_add_u32 v15, s42, v4
    s_mul_i32 s36, s28, 2048
    s_mul_i32 s37, s28, 4096
    s_add_u32 s37, s37, 8192
    s_waitcnt lgkmcnt(0)
    s_add_u32 s4, s4, s97
    s_addc_u32 s5, s5, 0
    s_mov_b32 s8, s30
    s_mov_b32 s9, s31
    s_mov_b32 s10, 0x200000
    s_mov_b32 s11, 0x20000
    s_add_u32 s12, s4, 0x400000
    s_addc_u32 s13, s5, 0
    s_mov_b32 s14, 0x400000
    s_mov_b32 s15, 0x20000
    s_mov_b32 s32, 0
    s_mov_b32 s33, 0
g2_ld_pW:
    s_add_u32 s40, s32, s27
    s_and_b32 s40, s40, 1
    s_andn2_b32 s41, s32, 1
    s_or_b32 s40, s40, s41
    s_add_u32 s40, s40, s26
    s_mul_i32 s34, s40, 131072
    s_mul_i32 s35, s40, 128
    s_add_u32 s38, s33, s36
    s_add_u32 s39, s33, s37
    s_add_u32 m0, s38, 0
    s_nop 0
    buffer_load_dwordx4 v10, s[8:11], s34 offen lds
    s_add_u32 m0, s38, 1024
    s_nop 0
    buffer_load_dwordx4 v11, s[8:11], s34 offen lds
    s_add_u32 s33, s33, 24576
    s_add_u32 s32, s32, 1
    s_cmp_lt_u32 s32, 4
    s_cbranch_scc1 g2_ld_pW
    s_lshr_b32 s40, s25, 0
    s_add_u32 s40, s40, 0
    s_lshl_b32 s40, s40, 8
    s_mov_b32 s42, s40
    s_cmp_lg_u32 s28, 0
    s_cbranch_scc1 g2_dep_set
    s_add_u32 s84, s4, 0x300000
    s_addc_u32 s85, s5, 0
    s_mov_b32 s86, 0x4000
    s_mov_b32 s87, 0x20000
    v_cmp_gt_u32 vcc, 32, v2
    v_mov_b32 v21, s40
    v_mov_b32 v23, s42
    v_cndmask_b32 v21, v23, v21, vcc
    v_mov_b32 v22, 15
    v_mov_b32 v23, 15
    v_cndmask_b32 v22, v23, v22, vcc
    v_and_b32 v23, 31, v2
    v_min_u32 v23, v23, v22
    v_lshl_add_u32 v21, v23, 2, v21
    v_mov_b32 v22, 1
    buffer_load_dword v23, v21, s[84:87], 0 offen sc1
g2_dep_set:
    s_lshl_b32 s43, s96, 2
    s_add_u32 s43, s43, 2
    s_mov_b32 s41, 0x800000
    v_mov_b32 v24, 131072
    s_cmp_lg_u32 s28, 0
    s_cbranch_scc1 g2_dep_lds
    s_mov_b32 s41, 0x40000
    s_waitcnt vmcnt(0)
g2_dep:
    v_cmp_lt_u32 vcc, v23, v22
    s_sub_u32 s41, s41, 1
    s_cmp_eq_u32 s41, 0
    s_cbranch_scc1 g2_dep_seen
    s_cbranch_vccz g2_dep_seen
    s_sleep 2
    buffer_load_dword v23, v21, s[84:87], 0 offen sc1
    s_waitcnt vmcnt(0)
    s_branch g2_dep
g2_dep_seen:
    v_mov_b32 v23, s43
    ds_write_b32 v24, v23
    s_branch g2_dep_ok
g2_dep_lds:
    ds_read_b32 v23, v24
    s_sub_u32 s41, s41, 1
    s_waitcnt lgkmcnt(0)
    v_readfirstlane_b32 s40, v23
    s_cmp_eq_u32 s41, 0
    s_cbranch_scc1 g2_dep_ok
    s_cmp_eq_u32 s40, s43
    s_cbranch_scc1 g2_dep_ok
    s_sleep 1
    s_branch g2_dep_lds
g2_dep_ok:
    s_mov_b32 s32, 0
    s_mov_b32 s33, 0
g2_ld_pA:
    s_add_u32 s40, s32, s27
    s_and_b32 s40, s40, 1
    s_andn2_b32 s41, s32, 1
    s_or_b32 s40, s40, s41
    s_add_u32 s40, s40, s26
    s_mul_i32 s34, s40, 131072
    s_mul_i32 s35, s40, 128
    s_add_u32 s38, s33, s36
    s_add_u32 s39, s33, s37
    s_add_u32 m0, s39, 0
    s_nop 0
    buffer_load_dwordx4 v12, s[12:15], s35 offen sc1 lds
    s_add_u32 m0, s39, 1024
    s_nop 0
    buffer_load_dwordx4 v13, s[12:15], s35 offen sc1 lds
    s_add_u32 m0, s39, 2048
    s_nop 0
    buffer_load_dwordx4 v14, s[12:15], s35 offen sc1 lds
    s_add_u32 m0, s39, 3072
    s_nop 0
    buffer_load_dwordx4 v15, s[12:15], s35 offen sc1 lds
    s_add_u32 s33, s33, 24576
    s_add_u32 s32, s32, 1
    s_cmp_lt_u32 s32, 3
    s_cbranch_scc1 g2_ld_pA
    s_waitcnt vmcnt(8)
    s_barrier
    s_add_u32 s40, s32, s27
    s_and_b32 s40, s40, 1
    s_andn2_b32 s41, s32, 1
    s_or_b32 s40, s40, s41
    s_add_u32 s40, s40, s26
    s_mul_i32 s34, s40, 131072
    s_mul_i32 s35, s40, 128
    s_add_u32 s38, s33, s36
    s_add_u32 s39, s33, s37
    s_add_u32 m0, s39, 0
    s_nop 0
    buffer_load_dwordx4 v12, s[12:15], s35 offen sc1 lds
    s_add_u32 m0, s39, 1024
    s_nop 0
    buffer_load_dwordx4 v13, s[12:15], s35 offen sc1 lds
    s_add_u32 m0, s39, 2048
    s_nop 0
    buffer_load_dwordx4 v14, s[12:15], s35 offen sc1 lds
    s_add_u32 m0, s39, 3072
    s_nop 0
    buffer_load_dwordx4 v15, s[12:15], s35 offen sc1 lds
    s_mov_b32 s33, 0
    s_add_u32 s32, s32, 1
g2_ld_loop:
    s_cmp_eq_u32 s32, 4
    s_cbranch_scc1 g2_ld_s4
    s_cmp_eq_u32 s32, 5
    s_cbranch_scc1 g2_ld_s5
    s_waitcnt vmcnt(12)
g2_ld_bar:
    s_barrier
    s_add_u32 s40, s32, s27
    s_and_b32 s40, s40, 1
    s_andn2_b32 s41, s32, 1
    s_or_b32 s40, s40, s41
    s_add_u32 s40, s40, s26
    s_mul_i32 s34, s40, 131072
    s_mul_i32 s35, s40, 128
    s_add_u32 s38, s33, s36
    s_add_u32 s39, s33, s37
    s_add_u32 m0, s38, 0
    s_nop 0
    buffer_load_dwordx4 v10, s[8:11], s34 offen lds
    s_add_u32 m0, s38, 1024
    s_nop 0
    buffer_load_dwordx4 v11, s[8:11], s34 offen lds
    s_add_u32 m0, s39, 0
    s_nop 0
    buffer_load_dwordx4 v12, s[12:15], s35 offen sc1 lds
    s_add_u32 m0, s39, 1024
    s_nop 0
    buffer_load_dwordx4 v13, s[12:15], s35 offen sc1 lds
    s_add_u32 m0, s39, 2048
    s_nop 0
    buffer_load_dwordx4 v14, s[12:15], s35 offen sc1 lds
    s_add_u32 m0, s39, 3072
    s_nop 0
    buffer_load_dwordx4 v15, s[12:15], s35 offen sc1 lds
    s_add_u32 s33, s33, 24576
    s_add_u32 s32, s32, 1
    s_cmp_eq_u32 s33, 98304
    s_cselect_b32 s33, 0, s33
    s_cmp_lt_u32 s32, 16
    s_cbranch_scc1 g2_ld_loop
    s_waitcnt vmcnt(12)
    s_barrier
    s_waitcnt vmcnt(6)
    s_barrier
    s_waitcnt vmcnt(0)
    s_barrier
    s_branch g2_ld_end
g2_ld_s4:
    s_waitcnt vmcnt(8)
    s_branch g2_ld_bar
g2_ld_s5:
    s_waitcnt vmcnt(10)
    s_branch g2_ld_bar
g2_ld_end:
    s_barrier
    s_branch g3_in
g2_done:
    s_endpgm
g2_compute:
    v_lshrrev_b32 v5, 4, v2
    v_bfe_u32 v6, v2, 2, 2
    v_and_b32 v7, 3, v2
    v_and_b32 v8, 15, v2
    s_and_b32 s44, s28, 0
    s_lshr_b32 s45, s28, 0
    s_mul_i32 s40, s25, 128
    s_mul_i32 s41, s45, 32
    s_add_u32 s40, s40, s41
    v_add_u32 v20, s40, v8
    s_mov_b32 s41, 2048
    v_mul_lo_u32 v9, v20, s41
    s_mul_i32 s40, s24, 128
    s_mul_i32 s41, s44, 128
    s_add_u32 s46, s40, s41
    v_and_b32 v3, 1, v5
    v_lshlrev_b32 v3, 5, v3
    v_lshrrev_b32 v4, 1, v5
    v_lshl_add_u32 v3, v4, 4, v3
    v_add3_u32 v9, v9, v3, s46
    s_mov_b32 s52, 0
    s_mov_b32 s53, 32768
    s_waitcnt lgkmcnt(0)
    s_add_u32 s4, s4, s97
    s_addc_u32 s5, s5, 0
    s_add_u32 s20, s4, 0x1900000
    s_addc_u32 s21, s5, 0
    s_cmp_eq_u32 s96, 1
    s_cselect_b32 s20, s20, s6
    s_cselect_b32 s21, s21, s7
    s_mov_b32 s22, 0x400000
    s_mov_b32 s23, 0x20000
    s_add_u32 s16, s4, 0x800000
    s_addc_u32 s17, s5, 0
    s_mov_b32 s18, 0x400000
    s_mov_b32 s19, 0x20000
    s_add_u32 s56, s4, 0xc00000
    s_addc_u32 s57, s5, 0
    s_mov_b32 s58, 0x480000
    s_mov_b32 s59, 0x20000
    s_add_u32 s60, s4, 0x200000
    s_addc_u32 s61, s5, 0
    s_mov_b32 s62, 0x40000
    s_mov_b32 s63, 0x20000
    s_mul_i32 s42, s44, 4
    s_mov_b32 s43, 0
    v_and_b32 v3, 1, v5
    v_lshlrev_b32 v3, 1, v3
    v_lshrrev_b32 v4, 1, v6
    v_or_b32 v3, v3, v4
    s_add_u32 s40, s42, 0
    v_xor_b32 v3, s40, v3
    v_lshlrev_b32 v3, 5, v3
    v_lshl_add_u32 v3, v7, 3, v3
    v_lshl_add_u32 v4, v5, 3, v6
    v_lshl_add_u32 v3, v4, 7, v3
    v_add_u32 v10, s43, v3
    v_and_b32 v3, 1, v5
    v_lshlrev_b32 v3, 1, v3
    v_lshrrev_b32 v4, 1, v6
    v_or_b32 v3, v3, v4
    s_add_u32 s40, s42, 1
    v_xor_b32 v3, s40, v3
    v_lshlrev_b32 v3, 5, v3
    v_lshl_add_u32 v3, v7, 3, v3
    v_lshl_add_u32 v4, v5, 3, v6
    v_lshl_add_u32 v3, v4, 7, v3
    v_add_u32 v11, s43, v3
    v_and_b32 v3, 1, v5
    v_lshlrev_b32 v3, 1, v3
    v_lshrrev_b32 v4, 1, v6
    v_or_b32 v3, v3, v4
    s_add_u32 s40, s42, 2
    v_xor_b32 v3, s40, v3
    v_lshlrev_b32 v3, 5, v3
    v_lshl_add_u32 v3, v7, 3, v3
    v_lshl_add_u32 v4, v5, 3, v6
    v_lshl_add_u32 v3, v4, 7, v3
    v_add_u32 v12, s43, v3
    v_and_b32 v3, 1, v5
    v_lshlrev_b32 v3, 1, v3
    v_lshrrev_b32 v4, 1, v6
    v_or_b32 v3, v3, v4
    s_add_u32 s40, s42, 3
    v_xor_b32 v3, s40, v3
    v_lshlrev_b32 v3, 5, v3
    v_lshl_add_u32 v3, v7, 3, v3
    v_lshl_add_u32 v4, v5, 3, v6
    v_lshl_add_u32 v3, v4, 7, v3
    v_add_u32 v13, s43, v3
    s_mul_i32 s42, s45, 32
    v_lshrrev_b32 v3, 1, v8
    v_xor_b32 v3, v3, v5
    v_lshlrev_b32 v3, 4, v3
    v_lshl_add_u32 v3, v8, 7, v3
    s_lshl_b32 s40, s42, 7
    s_add_u32 s40, s40, 8192
    v_add_u32 v14, s40, v3
    v_xor_b32 v15, 64, v14
    s_mov_b32 s48, 16
    s_mov_b32 s50, 0
    s_mov_b32 s51, 24576
    s_mov_b32 s29, 0xfffee000
    v_mov_b32 v28, 0
    v_mov_b32 v29, 0
    v_mov_b32 v30, 0
    v_mov_b32 v31, 0
    v_mov_b32 v32, 0
    v_mov_b32 v33, 0
    v_mov_b32 v34, 0
    v_mov_b32 v35, 0
    v_mov_b32 v36, 0
    v_mov_b32 v37, 0
    v_mov_b32 v38, 0
    v_mov_b32 v39, 0
    v_mov_b32 v40, 0
    v_mov_b32 v41, 0
    v_mov_b32 v42, 0
    v_mov_b32 v43, 0
    v_mov_b32 v44, 0
    v_mov_b32 v45, 0
    v_mov_b32 v46, 0
    v_mov_b32 v47, 0
    v_mov_b32 v48, 0
    v_mov_b32 v49, 0
    v_mov_b32 v50, 0
    v_mov_b32 v51, 0
    v_mov_b32 v52, 0
    v_mov_b32 v53, 0
    v_mov_b32 v54, 0
    v_mov_b32 v55, 0
    v_mov_b32 v56, 0
    v_mov_b32 v57, 0
    v_mov_b32 v58, 0
    v_mov_b32 v59, 0
    s_barrier
    ds_read_b64_tr_b16 v[60:61], v10 offset:0
    ds_read_b64_tr_b16 v[62:63], v10 offset:512
    ds_read_b128 v[76:79], v14 offset:0
    ds_read_b128 v[80:83], v14 offset:2048
    ds_read_b64_tr_b16 v[64:65], v11 offset:0
    ds_read_b64_tr_b16 v[66:67], v11 offset:512
    ds_read_b64_tr_b16 v[68:69], v12 offset:0
    ds_read_b64_tr_b16 v[70:71], v12 offset:512
    ds_read_b64_tr_b16 v[72:73], v13 offset:0
    ds_read_b64_tr_b16 v[74:75], v13 offset:512
    buffer_load_dwordx4 v[124:127], v9, s[20:23], s52 offen offset:0 sc1
    buffer_load_dwordx4 v[128:131], v9, s[20:23], s52 offen offset:64 sc1
    buffer_load_dwordx4 v[132:135], v9, s[20:23], s53 offen offset:0 sc1
    buffer_load_dwordx4 v[136:139], v9, s[20:23], s53 offen offset:64 sc1
    s_branch g2_cloop3
g2_mid:
    s_waitcnt vmcnt(0)
    s_nop 7
    v_permlane16_swap_b32 v124, v126
    v_permlane16_swap_b32 v125, v127
    v_permlane16_swap_b32 v128, v130
    v_permlane16_swap_b32 v129, v131
    v_permlane16_swap_b32 v132, v134
    v_permlane16_swap_b32 v133, v135
    v_permlane16_swap_b32 v136, v138
    v_permlane16_swap_b32 v137, v139
    v_lshlrev_b32 v140, 16, v124
    v_and_b32 v141, 0xffff0000, v124
    v_lshlrev_b32 v142, 16, v125
    v_and_b32 v143, 0xffff0000, v125
    v_lshlrev_b32 v144, 16, v126
    v_and_b32 v145, 0xffff0000, v126
    v_lshlrev_b32 v146, 16, v127
    v_and_b32 v147, 0xffff0000, v127
    v_pk_add_f32 v[28:29], v[28:29], v[140:141]
    v_pk_add_f32 v[30:31], v[30:31], v[142:143]
    v_pk_add_f32 v[36:37], v[36:37], v[144:145]
    v_pk_add_f32 v[38:39], v[38:39], v[146:147]
    v_lshlrev_b32 v140, 16, v128
    v_and_b32 v141, 0xffff0000, v128
    v_lshlrev_b32 v142, 16, v129
    v_and_b32 v143, 0xffff0000, v129
    v_lshlrev_b32 v144, 16, v130
    v_and_b32 v145, 0xffff0000, v130
    v_lshlrev_b32 v146, 16, v131
    v_and_b32 v147, 0xffff0000, v131
    v_pk_add_f32 v[44:45], v[44:45], v[140:141]
    v_pk_add_f32 v[46:47], v[46:47], v[142:143]
    v_pk_add_f32 v[52:53], v[52:53], v[144:145]
    v_pk_add_f32 v[54:55], v[54:55], v[146:147]
    v_lshlrev_b32 v140, 16, v132
    v_and_b32 v141, 0xffff0000, v132
    v_lshlrev_b32 v142, 16, v133
    v_and_b32 v143, 0xffff0000, v133
    v_lshlrev_b32 v144, 16, v134
    v_and_b32 v145, 0xffff0000, v134
    v_lshlrev_b32 v146, 16, v135
    v_and_b32 v147, 0xffff0000, v135
    v_pk_add_f32 v[32:33], v[32:33], v[140:141]
    v_pk_add_f32 v[34:35], v[34:35], v[142:143]
    v_pk_add_f32 v[40:41], v[40:41], v[144:145]
    v_pk_add_f32 v[42:43], v[42:43], v[146:147]
    v_lshlrev_b32 v140, 16, v136
    v_and_b32 v141, 0xffff0000, v136
    v_lshlrev_b32 v142, 16, v137
    v_and_b32 v143, 0xffff0000, v137
    v_lshlrev_b32 v144, 16, v138
    v_and_b32 v145, 0xffff0000, v138
    v_lshlrev_b32 v146, 16, v139
    v_and_b32 v147, 0xffff0000, v139
    v_pk_add_f32 v[48:49], v[48:49], v[140:141]
    v_pk_add_f32 v[50:51], v[50:51], v[142:143]
    v_pk_add_f32 v[56:57], v[56:57], v[144:145]
    v_pk_add_f32 v[58:59], v[58:59], v[146:147]
    s_nop 1
    s_branch g2_cloop2
.p2align 3
g2_cloop:
    s_barrier
    s_cmp_eq_u32 s48, 8
    s_cbranch_scc1 g2_mid
g2_cloop2:
    v_mfma_f32_16x16x32_bf16 v[28:31], v[84:87], v[100:103], v[28:31]
    ds_read_b64_tr_b16 v[60:61], v10 offset:0
    ds_read_b64_tr_b16 v[62:63], v10 offset:512
    v_mfma_f32_16x16x32_bf16 v[32:35], v[84:87], v[104:107], v[32:35]
    ds_read_b128 v[76:79], v14 offset:0
    v_mfma_f32_16x16x32_bf16 v[40:43], v[88:91], v[104:107], v[40:43]
    ds_read_b128 v[80:83], v14 offset:2048
    v_mfma_f32_16x16x32_bf16 v[36:39], v[88:91], v[100:103], v[36:39]
    ds_read_b64_tr_b16 v[64:65], v11 offset:0
    ds_read_b64_tr_b16 v[66:67], v11 offset:512
    v_mfma_f32_16x16x32_bf16 v[44:47], v[92:95], v[100:103], v[44:47]
    ds_read_b64_tr_b16 v[68:69], v12 offset:0
    ds_read_b64_tr_b16 v[70:71], v12 offset:512
    v_mfma_f32_16x16x32_bf16 v[48:51], v[92:95], v[104:107], v[48:51]
    ds_read_b64_tr_b16 v[72:73], v13 offset:0
    ds_read_b64_tr_b16 v[74:75], v13 offset:512
    v_mfma_f32_16x16x32_bf16 v[56:59], v[96:99], v[104:107], v[56:59]
    v_mfma_f32_16x16x32_bf16 v[52:55], v[96:99], v[100:103], v[52:55]
g2_cloop3:
    s_waitcnt lgkmcnt(0)
    v_mfma_f32_16x16x32_bf16 v[28:31], v[60:63], v[76:79], v[28:31]
    ds_read_b64_tr_b16 v[84:85], v10 offset:4096
    ds_read_b64_tr_b16 v[86:87], v10 offset:4608
    v_mfma_f32_16x16x32_bf16 v[32:35], v[60:63], v[80:83], v[32:35]
    ds_read_b128 v[100:103], v15 offset:0
    v_mfma_f32_16x16x32_bf16 v[40:43], v[64:67], v[80:83], v[40:43]
    ds_read_b128 v[104:107], v15 offset:2048
    v_mfma_f32_16x16x32_bf16 v[36:39], v[64:67], v[76:79], v[36:39]
    ds_read_b64_tr_b16 v[88:89], v11 offset:4096
    ds_read_b64_tr_b16 v[90:91], v11 offset:4608
    v_mfma_f32_16x16x32_bf16 v[44:47], v[68:71], v[76:79], v[44:47]
    ds_read_b64_tr_b16 v[92:93], v12 offset:4096
    ds_read_b64_tr_b16 v[94:95], v12 offset:4608
    v_mfma_f32_16x16x32_bf16 v[48:51], v[68:71], v[80:83], v[48:51]
    ds_read_b64_tr_b16 v[96:97], v13 offset:4096
    ds_read_b64_tr_b16 v[98:99], v13 offset:4608
    v_mfma_f32_16x16x32_bf16 v[56:59], v[72:75], v[80:83], v[56:59]
    s_add_u32 s50, s50, 1
    s_cmp_eq_u32 s50, 4
    v_mfma_f32_16x16x32_bf16 v[52:55], v[72:75], v[76:79], v[52:55]
    s_cselect_b32 s49, s29, s51
    s_cselect_b32 s50, 0, s50
    v_add_u32 v10, s49, v10
    v_add_u32 v11, s49, v11
    v_add_u32 v12, s49, v12
    v_add_u32 v13, s49, v13
    v_add_u32 v14, s49, v14
    v_add_u32 v15, s49, v15
    s_sub_u32 s48, s48, 1
    s_cmp_lg_u32 s48, 0
    s_waitcnt lgkmcnt(0)
    s_cbranch_scc1 g2_cloop
    v_mfma_f32_16x16x32_bf16 v[28:31], v[84:87], v[100:103], v[28:31]
    v_mfma_f32_16x16x32_bf16 v[32:35], v[84:87], v[104:107], v[32:35]
    v_mfma_f32_16x16x32_bf16 v[40:43], v[88:91], v[104:107], v[40:43]
    v_mfma_f32_16x16x32_bf16 v[36:39], v[88:91], v[100:103], v[36:39]
    v_mfma_f32_16x16x32_bf16 v[44:47], v[92:95], v[100:103], v[44:47]
    v_mfma_f32_16x16x32_bf16 v[48:51], v[92:95], v[104:107], v[48:51]
    v_mfma_f32_16x16x32_bf16 v[56:59], v[96:99], v[104:107], v[56:59]
    v_mfma_f32_16x16x32_bf16 v[52:55], v[96:99], v[100:103], v[52:55]
    s_nop 7
    v_pk_add_f32 v[76:77], v[28:29], v[30:31]
    v_pk_mul_f32 v[78:79], v[28:29], v[28:29]
    v_pk_fma_f32 v[78:79], v[30:31], v[30:31], v[78:79]
    v_pk_add_f32 v[76:77], v[76:77], v[36:37]
    v_pk_fma_f32 v[78:79], v[36:37], v[36:37], v[78:79]
    v_pk_add_f32 v[76:77], v[76:77], v[38:39]
    v_pk_fma_f32 v[78:79], v[38:39], v[38:39], v[78:79]
    v_pk_add_f32 v[76:77], v[76:77], v[44:45]
    v_pk_fma_f32 v[78:79], v[44:45], v[44:45], v[78:79]
    v_pk_add_f32 v[76:77], v[76:77], v[46:47]
    v_pk_fma_f32 v[78:79], v[46:47], v[46:47], v[78:79]
    v_pk_add_f32 v[76:77], v[76:77], v[52:53]
    v_pk_fma_f32 v[78:79], v[52:53], v[52:53], v[78:79]
    v_pk_add_f32 v[76:77], v[76:77], v[54:55]
    v_pk_fma_f32 v[78:79], v[54:55], v[54:55], v[78:79]
    v_pk_add_f32 v[80:81], v[32:33], v[34:35]
    v_pk_mul_f32 v[82:83], v[32:33], v[32:33]
    v_pk_fma_f32 v[82:83], v[34:35], v[34:35], v[82:83]
    v_pk_add_f32 v[80:81], v[80:81], v[40:41]
    v_pk_fma_f32 v[82:83], v[40:41], v[40:41], v[82:83]
    v_pk_add_f32 v[80:81], v[80:81], v[42:43]
    v_pk_fma_f32 v[82:83], v[42:43], v[42:43], v[82:83]
    v_pk_add_f32 v[80:81], v[80:81], v[48:49]
    v_pk_fma_f32 v[82:83], v[48:49], v[48:49], v[82:83]
    v_pk_add_f32 v[80:81], v[80:81], v[50:51]
    v_pk_fma_f32 v[82:83], v[50:51], v[50:51], v[82:83]
    v_pk_add_f32 v[80:81], v[80:81], v[56:57]
    v_pk_fma_f32 v[82:83], v[56:57], v[56:57], v[82:83]
    v_pk_add_f32 v[80:81], v[80:81], v[58:59]
    v_pk_fma_f32 v[82:83], v[58:59], v[58:59], v[82:83]
    v_add_f32 v76, v76, v77
    v_add_f32 v77, v78, v79
    v_add_f32 v80, v80, v81
    v_add_f32 v81, v82, v83
    s_nop 1
    v_permlane16_swap_b32 v76, v80
    v_permlane16_swap_b32 v77, v81
    v_pk_add_f32 v[76:77], v[76:77], v[80:81]
    v_mov_b32 v84, v76
    v_mov_b32 v85, v77
    v_and_b32 v3, 16, v2
    v_add_u32 v3, v3, v20
    v_permlane32_swap_b32 v76, v84
    v_permlane32_swap_b32 v77, v85
    v_pk_add_f32 v[76:77], v[76:77], v[84:85]
    v_lshlrev_b32 v3, 3, v3
    s_mul_i32 s40, s24, 1
    s_add_u32 s40, s40, s44
    s_lshl_b32 s40, s40, 14
    s_mov_b32 exec_hi, 0
    buffer_store_dwordx2 v[76:77], v3, s[60:63], s40 offen sc1
    s_mov_b32 exec_hi, -1
    v_lshrrev_b32 v4, 5, v2
    v_lshl_add_u32 v21, v4, 17, v3
    v_cvt_pk_bf16_f32 v60, v28, v29
    v_cvt_pk_bf16_f32 v61, v30, v31
    v_cvt_pk_bf16_f32 v62, v36, v37
    v_cvt_pk_bf16_f32 v63, v38, v39
    v_lshlrev_b32 v28, 16, v60
    v_and_b32 v29, 0xffff0000, v60
    v_lshlrev_b32 v30, 16, v61
    v_and_b32 v31, 0xffff0000, v61
    v_lshlrev_b32 v36, 16, v62
    v_and_b32 v37, 0xffff0000, v62
    v_lshlrev_b32 v38, 16, v63
    v_and_b32 v39, 0xffff0000, v63
    v_permlane16_swap_b32 v60, v62
    v_permlane16_swap_b32 v61, v63
    buffer_store_dwordx4 v[60:63], v9, s[16:19], s52 offen offset:0 sc1
    v_cvt_pk_bf16_f32 v64, v44, v45
    v_cvt_pk_bf16_f32 v65, v46, v47
    v_cvt_pk_bf16_f32 v66, v52, v53
    v_cvt_pk_bf16_f32 v67, v54, v55
    v_lshlrev_b32 v44, 16, v64
    v_and_b32 v45, 0xffff0000, v64
    v_lshlrev_b32 v46, 16, v65
    v_and_b32 v47, 0xffff0000, v65
    v_lshlrev_b32 v52, 16, v66
    v_and_b32 v53, 0xffff0000, v66
    v_lshlrev_b32 v54, 16, v67
    v_and_b32 v55, 0xffff0000, v67
    v_permlane16_swap_b32 v64, v66
    v_permlane16_swap_b32 v65, v67
    buffer_store_dwordx4 v[64:67], v9, s[16:19], s52 offen offset:64 sc1
    v_cvt_pk_bf16_f32 v68, v32, v33
    v_cvt_pk_bf16_f32 v69, v34, v35
    v_cvt_pk_bf16_f32 v70, v40, v41
    v_cvt_pk_bf16_f32 v71, v42, v43
    v_lshlrev_b32 v32, 16, v68
    v_and_b32 v33, 0xffff0000, v68
    v_lshlrev_b32 v34, 16, v69
    v_and_b32 v35, 0xffff0000, v69
    v_lshlrev_b32 v40, 16, v70
    v_and_b32 v41, 0xffff0000, v70
    v_lshlrev_b32 v42, 16, v71
    v_and_b32 v43, 0xffff0000, v71
    v_permlane16_swap_b32 v68, v70
    v_permlane16_swap_b32 v69, v71
    buffer_store_dwordx4 v[68:71], v9, s[16:19], s53 offen offset:0 sc1
    v_cvt_pk_bf16_f32 v72, v48, v49
    v_cvt_pk_bf16_f32 v73, v50, v51
    v_cvt_pk_bf16_f32 v74, v56, v57
    v_cvt_pk_bf16_f32 v75, v58, v59
    v_lshlrev_b32 v48, 16, v72
    v_and_b32 v49, 0xffff0000, v72
    v_lshlrev_b32 v50, 16, v73
    v_and_b32 v51, 0xffff0000, v73
    v_lshlrev_b32 v56, 16, v74
    v_and_b32 v57, 0xffff0000, v74
    v_lshlrev_b32 v58, 16, v75
    v_and_b32 v59, 0xffff0000, v75
    v_permlane16_swap_b32 v72, v74
    v_permlane16_swap_b32 v73, v75
    buffer_store_dwordx4 v[72:75], v9, s[16:19], s53 offen offset:64 sc1
    s_mov_b32 s48, 0x40000
    v_mul_u32_u24 v19, 256, v20
    v_add_u32 v19, v19, v9
    s_mov_b32 s54, 0
    s_mov_b32 s55, 36864
    s_mov_b32 s40, 0
    buffer_load_dwordx2 v[108:109], v21, s[60:63], s40 offen sc1
    s_mov_b32 s41, 16384
    buffer_load_dwordx2 v[110:111], v21, s[60:63], s41 offen sc1
    s_mov_b32 s40, 32768
    buffer_load_dwordx2 v[112:113], v21, s[60:63], s40 offen sc1
    s_mov_b32 s41, 49152
    buffer_load_dwordx2 v[114:115], v21, s[60:63], s41 offen sc1
    s_mov_b32 s40, 65536
    buffer_load_dwordx2 v[116:117], v21, s[60:63], s40 offen sc1
    s_mov_b32 s41, 81920
    buffer_load_dwordx2 v[118:119], v21, s[60:63], s41 offen sc1
    s_mov_b32 s40, 98304
    buffer_load_dwordx2 v[120:121], v21, s[60:63], s40 offen sc1
    s_mov_b32 s41, 114688
    buffer_load_dwordx2 v[122:123], v21, s[60:63], s41 offen sc1
    s_waitcnt vmcnt(0)
g2_ex:
    v_max3_u32 v4, v108, v109, v110
    v_max3_u32 v4, v4, v111, v112
    v_max3_u32 v4, v4, v113, v114
    v_max3_u32 v4, v4, v115, v116
    v_max3_u32 v4, v4, v117, v118
    v_max3_u32 v4, v4, v119, v120
    v_max3_u32 v4, v4, v121, v122
    v_max_u32 v4, v4, v123
    v_cmp_eq_u32 vcc, -1, v4
    s_sub_u32 s48, s48, 1
    s_cmp_eq_u32 s48, 0
    s_cbranch_scc1 g2_exd
    s_cbranch_vccz g2_exd
    s_sleep 2
    s_mov_b32 s40, 0
    buffer_load_dwordx2 v[108:109], v21, s[60:63], s40 offen sc1
    s_mov_b32 s41, 16384
    buffer_load_dwordx2 v[110:111], v21, s[60:63], s41 offen sc1
    s_mov_b32 s40, 32768
    buffer_load_dwordx2 v[112:113], v21, s[60:63], s40 offen sc1
    s_mov_b32 s41, 49152
    buffer_load_dwordx2 v[114:115], v21, s[60:63], s41 offen sc1
    s_mov_b32 s40, 65536
    buffer_load_dwordx2 v[116:117], v21, s[60:63], s40 offen sc1
    s_mov_b32 s41, 81920
    buffer_load_dwordx2 v[118:119], v21, s[60:63], s41 offen sc1
    s_mov_b32 s40, 98304
    buffer_load_dwordx2 v[120:121], v21, s[60:63], s40 offen sc1
    s_mov_b32 s41, 114688
    buffer_load_dwordx2 v[122:123], v21, s[60:63], s41 offen sc1
    s_waitcnt vmcnt(0)
    s_branch g2_ex
g2_exd:
    v_pk_add_f32 v[108:109], v[108:109], v[116:117]
    v_pk_add_f32 v[110:111], v[110:111], v[118:119]
    v_pk_add_f32 v[112:113], v[112:113], v[120:121]
    v_pk_add_f32 v[114:115], v[114:115], v[122:123]
    v_pk_add_f32 v[108:109], v[108:109], v[112:113]
    v_pk_add_f32 v[110:111], v[110:111], v[114:115]
    v_pk_add_f32 v[108:109], v[108:109], v[110:111]
    v_mov_b32 v110, v108
    v_mov_b32 v111, v109
    s_nop 1
    v_permlane32_swap_b32 v108, v110
    v_permlane32_swap_b32 v109, v111
    v_pk_add_f32 v[108:109], v[108:109], v[110:111]
    v_mul_f32 v108, 0x3a800000, v108
    v_mul_f32 v109, 0x3a800000, v109
    v_fma_f32 v109, -v108, v108, v109
    v_max_f32 v109, 0, v109
    v_mov_b32 v110, v108
    v_mov_b32 v111, v109
    v_cvt_pk_bf16_f32 v110, v110, v110
    v_lshlrev_b32 v110, 16, v110
    v_cvt_pk_bf16_f32 v111, v111, v111
    v_lshlrev_b32 v111, 16, v111
    v_add_f32 v111, 0x3727c5ac, v111
    v_cvt_pk_bf16_f32 v111, v111, v111
    v_lshlrev_b32 v111, 16, v111
    v_sqrt_f32 v111, v111
    s_nop 0
    v_cvt_pk_bf16_f32 v111, v111, v111
    v_lshlrev_b32 v111, 16, v111
    v_rcp_f32 v111, v111
    v_sub_f32 v112, v108, v110
    v_mul_f32 v113, v109, v111
    v_mul_f32 v112, v112, v111
    v_mul_f32 v113, v113, v111
    v_cvt_pk_bf16_f32 v112, v112, v112
    v_lshlrev_b32 v112, 16, v112
    v_cvt_pk_bf16_f32 v113, v113, v113
    v_lshlrev_b32 v113, 16, v113
    v_add_f32 v113, 0x3727c5ac, v113
    v_cvt_pk_bf16_f32 v113, v113, v113
    v_lshlrev_b32 v113, 16, v113
    v_sqrt_f32 v113, v113
    s_nop 0
    v_cvt_pk_bf16_f32 v113, v113, v113
    v_lshlrev_b32 v113, 16, v113
    v_rcp_f32 v113, v113
    v_fma_f32 v112, v110, v111, v112
    v_mul_f32 v114, v111, v113
    v_mul_f32 v115, -v112, v113
    v_mov_b32 v116, v114
    v_mov_b32 v117, v115
    s_nop 1
    v_permlane16_swap_b32 v114, v116
    v_permlane16_swap_b32 v115, v117
    v_pk_fma_f32 v[28:29], v[28:29], v[114:115], v[114:115] op_sel:[0,0,1] op_sel_hi:[1,0,1]
    v_pk_fma_f32 v[30:31], v[30:31], v[114:115], v[114:115] op_sel:[0,0,1] op_sel_hi:[1,0,1]
    v_pk_fma_f32 v[36:37], v[36:37], v[114:115], v[114:115] op_sel:[0,0,1] op_sel_hi:[1,0,1]
    v_pk_fma_f32 v[38:39], v[38:39], v[114:115], v[114:115] op_sel:[0,0,1] op_sel_hi:[1,0,1]
    v_cvt_pk_bf16_f32 v124, v28, v29
    v_cvt_pk_bf16_f32 v125, v30, v31
    v_cvt_pk_bf16_f32 v126, v36, v37
    v_cvt_pk_bf16_f32 v127, v38, v39
    s_nop 1
    v_permlane16_swap_b32 v124, v126
    v_permlane16_swap_b32 v125, v127
    buffer_store_dwordx4 v[124:127], v19, s[56:59], s54 offen offset:0 sc1
    v_pk_fma_f32 v[44:45], v[44:45], v[114:115], v[114:115] op_sel:[0,0,1] op_sel_hi:[1,0,1]
    v_pk_fma_f32 v[46:47], v[46:47], v[114:115], v[114:115] op_sel:[0,0,1] op_sel_hi:[1,0,1]
    v_pk_fma_f32 v[52:53], v[52:53], v[114:115], v[114:115] op_sel:[0,0,1] op_sel_hi:[1,0,1]
    v_pk_fma_f32 v[54:55], v[54:55], v[114:115], v[114:115] op_sel:[0,0,1] op_sel_hi:[1,0,1]
    v_cvt_pk_bf16_f32 v128, v44, v45
    v_cvt_pk_bf16_f32 v129, v46, v47
    v_cvt_pk_bf16_f32 v130, v52, v53
    v_cvt_pk_bf16_f32 v131, v54, v55
    s_nop 1
    v_permlane16_swap_b32 v128, v130
    v_permlane16_swap_b32 v129, v131
    buffer_store_dwordx4 v[128:131], v19, s[56:59], s54 offen offset:64 sc1
    v_pk_fma_f32 v[32:33], v[32:33], v[116:117], v[116:117] op_sel:[0,0,1] op_sel_hi:[1,0,1]
    v_pk_fma_f32 v[34:35], v[34:35], v[116:117], v[116:117] op_sel:[0,0,1] op_sel_hi:[1,0,1]
    v_pk_fma_f32 v[40:41], v[40:41], v[116:117], v[116:117] op_sel:[0,0,1] op_sel_hi:[1,0,1]
    v_pk_fma_f32 v[42:43], v[42:43], v[116:117], v[116:117] op_sel:[0,0,1] op_sel_hi:[1,0,1]
    v_cvt_pk_bf16_f32 v132, v32, v33
    v_cvt_pk_bf16_f32 v133, v34, v35
    v_cvt_pk_bf16_f32 v134, v40, v41
    v_cvt_pk_bf16_f32 v135, v42, v43
    s_nop 1
    v_permlane16_swap_b32 v132, v134
    v_permlane16_swap_b32 v133, v135
    buffer_store_dwordx4 v[132:135], v19, s[56:59], s55 offen offset:0 sc1
    v_pk_fma_f32 v[48:49], v[48:49], v[116:117], v[116:117] op_sel:[0,0,1] op_sel_hi:[1,0,1]
    v_pk_fma_f32 v[50:51], v[50:51], v[116:117], v[116:117] op_sel:[0,0,1] op_sel_hi:[1,0,1]
    v_pk_fma_f32 v[56:57], v[56:57], v[116:117], v[116:117] op_sel:[0,0,1] op_sel_hi:[1,0,1]
    v_pk_fma_f32 v[58:59], v[58:59], v[116:117], v[116:117] op_sel:[0,0,1] op_sel_hi:[1,0,1]
    v_cvt_pk_bf16_f32 v136, v48, v49
    v_cvt_pk_bf16_f32 v137, v50, v51
    v_cvt_pk_bf16_f32 v138, v56, v57
    v_cvt_pk_bf16_f32 v139, v58, v59
    s_nop 1
    v_permlane16_swap_b32 v136, v138
    v_permlane16_swap_b32 v137, v139
    buffer_store_dwordx4 v[136:139], v19, s[56:59], s55 offen offset:64 sc1
    s_lshr_b32 s40, s24, 1
    s_add_u32 s40, s40, 16
    s_lshl_b32 s40, s40, 8
    s_mov_b32 s42, s40
    s_and_b32 s41, s24, 1
    s_lshl_b32 s42, s25, 1
    s_add_u32 s41, s41, s42
    s_add_u32 s84, s4, 0x300000
    s_addc_u32 s85, s5, 0
    s_mov_b32 s86, 0x4000
    s_mov_b32 s87, 0x20000
    s_lshl_b32 s41, s41, 2
    s_add_u32 s40, s40, s41
    v_mov_b32 v3, s40
    v_mov_b32 v4, 1
    s_waitcnt vmcnt(0)
    s_barrier
    s_cmp_lg_u32 s28, 0
    s_cbranch_scc1 g2_cin
    s_mov_b64 exec, 1
    buffer_store_dword v4, v3, s[84:87], 0 offen sc1
    s_mov_b64 exec, -1
g2_cin:
    s_branch g3_in
.p2align 6
g3_in:
    s_cmp_ge_u32 s2, 224
    s_cbranch_scc1 g3_spare
    s_load_dwordx2 s[4:5], s[0:1], 80
    s_load_dwordx2 s[30:31], s[0:1], 32
    s_load_dwordx2 s[6:7], s[0:1], 40
    v_lshrrev_b32 v1, 6, v0
    v_and_b32 v2, 63, v0
    s_and_b32 s40, s2, 1
    s_lshl_b32 s40, s40, 2
    s_bfe_u32 s41, s2, 0x20003
    s_add_u32 s25, s40, s41
    s_bfe_u32 s40, s2, 0x20001
    s_mul_i32 s40, s40, 7
    s_lshr_b32 s42, s2, 5
    s_add_u32 s24, s40, s42
    s_add_u32 s27, s41, s42
    s_mov_b32 s26, 0
    s_cmp_eq_u32 s96, 0
    s_cselect_b32 s95, 3, 1
    v_readfirstlane_b32 s28, v1
    s_nop 0
    s_cmp_lt_u32 s28, 4
    s_cbranch_scc1 g3_compute
    s_sub_u32 s28, s28, 4
    s_mov_b32 s40, 7168
    v_lshrrev_b32 v4, 4, v2
    v_mul_lo_u32 v3, v4, s40
    v_lshlrev_b32 v4, 1, v4
    v_xor_b32 v4, v4, v2
    v_and_b32 v4, 15, v4
    v_lshl_add_u32 v3, v4, 4, v3
    s_mul_i32 s41, s24, 256
    s_mul_i32 s42, s28, 114688
    s_add_u32 s41, s41, s42
    v_xor_b32 v4, 128, v3
    s_add_u32 s42, s41, 0
    v_add_u32 v10, s42, v3
    s_add_u32 s42, s41, 28672
    v_add_u32 v11, s42, v3
    s_add_u32 s42, s41, 57344
    v_add_u32 v12, s42, v4
    s_add_u32 s42, s41, 86016
    v_add_u32 v13, s42, v4
    s_mov_b32 s40, 2304
    v_lshrrev_b32 v4, 4, v2
    v_mul_lo_u32 v3, v4, s40
    v_lshlrev_b32 v4, 1, v4
    v_xor_b32 v4, v4, v2
    v_and_b32 v4, 15, v4
    v_lshl_add_u32 v3, v4, 4, v3
    s_mul_i32 s41, s25, 256
    s_mul_i32 s42, s28, 36864
    s_add_u32 s41, s41, s42
    v_xor_b32 v4, 128, v3
    s_add_u32 s42, s41, 0
    v_add_u32 v14, s42, v3
    s_add_u32 s42, s41, 9216
    v_add_u32 v15, s42, v3
    s_add_u32 s42, s41, 18432
    v_add_u32 v16, s42, v4
    s_add_u32 s42, s41, 27648
    v_add_u32 v17, s42, v4
    s_mul_i32 s36, s28, 4096
    s_mul_i32 s37, s28, 4096
    s_add_u32 s37, s37, 16384
    s_waitcnt lgkmcnt(0)
    s_add_u32 s4, s4, s97
    s_addc_u32 s5, s5, 0
    s_mov_b32 s8, s30
    s_mov_b32 s9, s31
    s_mov_b32 s10, 0xe00000
    s_mov_b32 s11, 0x20000
    s_add_u32 s12, s4, 0xc00000
    s_addc_u32 s13, s5, 0
    s_mov_b32 s14, 0x480000
    s_mov_b32 s15, 0x20000
    s_mov_b32 s32, 0
    s_mov_b32 s33, 0
g3_ld_pW:
    s_add_u32 s40, s32, s27
    s_and_b32 s40, s40, s95
    s_andn2_b32 s41, s32, s95
    s_or_b32 s40, s40, s41
    s_add_u32 s40, s40, s26
    s_mul_i32 s34, s40, 458752
    s_mul_i32 s35, s40, 147456
    s_add_u32 s38, s33, s36
    s_add_u32 s39, s33, s37
    s_add_u32 m0, s38, 0
    s_nop 0
    buffer_load_dwordx4 v10, s[8:11], s34 offen lds
    s_add_u32 m0, s38, 1024
    s_nop 0
    buffer_load_dwordx4 v11, s[8:11], s34 offen lds
    s_add_u32 m0, s38, 2048
    s_nop 0
    buffer_load_dwordx4 v12, s[8:11], s34 offen lds
    s_add_u32 m0, s38, 3072
    s_nop 0
    buffer_load_dwordx4 v13, s[8:11], s34 offen lds
    s_add_u32 s33, s33, 32768
    s_add_u32 s32, s32, 1
    s_cmp_lt_u32 s32, 4
    s_cbranch_scc1 g3_ld_pW
    s_lshr_b32 s40, s25, 0
    s_add_u32 s40, s40, 16
    s_lshl_b32 s40, s40, 8
    s_mov_b32 s42, s40
    s_cmp_lg_u32 s28, 0
    s_cbranch_scc1 g3_dep_set
    s_add_u32 s84, s4, 0x300000
    s_addc_u32 s85, s5, 0
    s_mov_b32 s86, 0x4000
    s_mov_b32 s87, 0x20000
    v_cmp_gt_u32 vcc, 32, v2
    v_mov_b32 v21, s40
    v_mov_b32 v23, s42
    v_cndmask_b32 v21, v23, v21, vcc
    v_mov_b32 v22, 31
    v_mov_b32 v23, 31
    v_cndmask_b32 v22, v23, v22, vcc
    v_and_b32 v23, 31, v2
    v_min_u32 v23, v23, v22
    v_lshl_add_u32 v21, v23, 2, v21
    v_mov_b32 v22, 1
    buffer_load_dword v23, v21, s[84:87], 0 offen sc1
g3_dep_set:
    s_lshl_b32 s43, s96, 2
    s_add_u32 s43, s43, 3
    s_mov_b32 s41, 0x800000
    v_mov_b32 v24, 131072
    s_cmp_lg_u32 s28, 0
    s_cbranch_scc1 g3_dep_lds
    s_mov_b32 s41, 0x40000
    s_waitcnt vmcnt(0)
g3_dep:
    v_cmp_lt_u32 vcc, v23, v22
    s_sub_u32 s41, s41, 1
    s_cmp_eq_u32 s41, 0
    s_cbranch_scc1 g3_dep_seen
    s_cbranch_vccz g3_dep_seen
    s_sleep 2
    buffer_load_dword v23, v21, s[84:87], 0 offen sc1
    s_waitcnt vmcnt(0)
    s_branch g3_dep
g3_dep_seen:
    v_mov_b32 v23, s43
    ds_write_b32 v24, v23
    s_branch g3_dep_ok
g3_dep_lds:
    ds_read_b32 v23, v24
    s_sub_u32 s41, s41, 1
    s_waitcnt lgkmcnt(0)
    v_readfirstlane_b32 s40, v23
    s_cmp_eq_u32 s41, 0
    s_cbranch_scc1 g3_dep_ok
    s_cmp_eq_u32 s40, s43
    s_cbranch_scc1 g3_dep_ok
    s_sleep 1
    s_branch g3_dep_lds
g3_dep_ok:
    s_mov_b32 s32, 0
    s_mov_b32 s33, 0
g3_ld_pA:
    s_add_u32 s40, s32, s27
    s_and_b32 s40, s40, s95
    s_andn2_b32 s41, s32, s95
    s_or_b32 s40, s40, s41
    s_add_u32 s40, s40, s26
    s_mul_i32 s34, s40, 458752
    s_mul_i32 s35, s40, 147456
    s_add_u32 s38, s33, s36
    s_add_u32 s39, s33, s37
    s_add_u32 m0, s39, 0
    s_nop 0
    buffer_load_dwordx4 v14, s[12:15], s35 offen sc1 lds
    s_add_u32 m0, s39, 1024
    s_nop 0
    buffer_load_dwordx4 v15, s[12:15], s35 offen sc1 lds
    s_add_u32 m0, s39, 2048
    s_nop 0
    buffer_load_dwordx4 v16, s[12:15], s35 offen sc1 lds
    s_add_u32 m0, s39, 3072
    s_nop 0
    buffer_load_dwordx4 v17, s[12:15], s35 offen sc1 lds
    s_add_u32 s33, s33, 32768
    s_add_u32 s32, s32, 1
    s_cmp_lt_u32 s32, 3
    s_cbranch_scc1 g3_ld_pA
    s_waitcnt vmcnt(8)
    s_barrier
    s_add_u32 s40, s32, s27
    s_and_b32 s40, s40, s95
    s_andn2_b32 s41, s32, s95
    s_or_b32 s40, s40, s41
    s_add_u32 s40, s40, s26
    s_mul_i32 s34, s40, 458752
    s_mul_i32 s35, s40, 147456
    s_add_u32 s38, s33, s36
    s_add_u32 s39, s33, s37
    s_add_u32 m0, s39, 0
    s_nop 0
    buffer_load_dwordx4 v14, s[12:15], s35 offen sc1 lds
    s_add_u32 m0, s39, 1024
    s_nop 0
    buffer_load_dwordx4 v15, s[12:15], s35 offen sc1 lds
    s_add_u32 m0, s39, 2048
    s_nop 0
    buffer_load_dwordx4 v16, s[12:15], s35 offen sc1 lds
    s_add_u32 m0, s39, 3072
    s_nop 0
    buffer_load_dwordx4 v17, s[12:15], s35 offen sc1 lds
    s_mov_b32 s33, 0
    s_add_u32 s32, s32, 1
g3_ld_loop:
    s_cmp_eq_u32 s32, 4
    s_cbranch_scc1 g3_ld_s4
    s_cmp_eq_u32 s32, 5
    s_cbranch_scc1 g3_ld_s5
    s_waitcnt vmcnt(16)
g3_ld_bar:
    s_barrier
    s_add_u32 s40, s32, s27
    s_and_b32 s40, s40, s95
    s_andn2_b32 s41, s32, s95
    s_or_b32 s40, s40, s41
    s_add_u32 s40, s40, s26
    s_mul_i32 s34, s40, 458752
    s_mul_i32 s35, s40, 147456
    s_add_u32 s38, s33, s36
    s_add_u32 s39, s33, s37
    s_add_u32 m0, s38, 0
    s_nop 0
    buffer_load_dwordx4 v10, s[8:11], s34 offen lds
    s_add_u32 m0, s38, 1024
    s_nop 0
    buffer_load_dwordx4 v11, s[8:11], s34 offen lds
    s_add_u32 m0, s38, 2048
    s_nop 0
    buffer_load_dwordx4 v12, s[8:11], s34 offen lds
    s_add_u32 m0, s38, 3072
    s_nop 0
    buffer_load_dwordx4 v13, s[8:11], s34 offen lds
    s_add_u32 m0, s39, 0
    s_nop 0
    buffer_load_dwordx4 v14, s[12:15], s35 offen sc1 lds
    s_add_u32 m0, s39, 1024
    s_nop 0
    buffer_load_dwordx4 v15, s[12:15], s35 offen sc1 lds
    s_add_u32 m0, s39, 2048
    s_nop 0
    buffer_load_dwordx4 v16, s[12:15], s35 offen sc1 lds
    s_add_u32 m0, s39, 3072
    s_nop 0
    buffer_load_dwordx4 v17, s[12:15], s35 offen sc1 lds
    s_add_u32 s33, s33, 32768
    s_add_u32 s32, s32, 1
    s_cmp_eq_u32 s33, 131072
    s_cselect_b32 s33, 0, s33
    s_cmp_lt_u32 s32, 32
    s_cbranch_scc1 g3_ld_loop
    s_waitcnt vmcnt(16)
    s_barrier
    s_waitcnt vmcnt(8)
    s_barrier
    s_waitcnt vmcnt(0)
    s_barrier
    s_branch g3_ld_end
g3_ld_s4:
    s_waitcnt vmcnt(8)
    s_branch g3_ld_bar
g3_ld_s5:
    s_waitcnt vmcnt(12)
    s_branch g3_ld_bar
g3_ld_end:
    s_barrier
    s_branch g4_in
g3_done:
    s_endpgm
g3_compute:
    v_lshrrev_b32 v5, 4, v2
    v_bfe_u32 v6, v2, 2, 2
    v_and_b32 v7, 3, v2
    v_and_b32 v8, 15, v2
    s_and_b32 s44, s28, 1
    s_lshr_b32 s45, s28, 1
    s_mul_i32 s40, s25, 128
    s_mul_i32 s41, s45, 64
    s_add_u32 s40, s40, s41
    v_add_u32 v20, s40, v8
    s_mov_b32 s41, 8192
    v_mul_lo_u32 v9, v20, s41
    s_mul_i32 s40, s24, 256
    s_mul_i32 s41, s44, 128
    s_add_u32 s46, s40, s41
    v_and_b32 v3, 1, v5
    v_lshlrev_b32 v3, 5, v3
    v_lshrrev_b32 v4, 1, v5
    v_lshl_add_u32 v3, v4, 4, v3
    v_add3_u32 v9, v9, v3, s46
    s_mov_b32 s52, 0
    s_mov_b32 s53, 131072
    s_mov_b32 s54, 262144
    s_mov_b32 s55, 393216
    s_waitcnt lgkmcnt(0)
    s_add_u32 s4, s4, s97
    s_addc_u32 s5, s5, 0
    s_mov_b32 s20, s6
    s_mov_b32 s21, s7
    s_mov_b32 s22, 0x1c00
    s_mov_b32 s23, 0x20000
    s_add_u32 s16, s4, 0x1100000
    s_addc_u32 s17, s5, 0
    s_mov_b32 s18, 0x800000
    s_mov_b32 s19, 0x20000
    v_lshl_add_u32 v3, v5, 3, s46
    buffer_load_dwordx2 v[92:93], v3, s[20:23], 0 offen offset:0
    buffer_load_dwordx2 v[94:95], v3, s[20:23], 0 offen offset:32
    buffer_load_dwordx2 v[96:97], v3, s[20:23], 0 offen offset:64
    buffer_load_dwordx2 v[98:99], v3, s[20:23], 0 offen offset:96
    s_mul_i32 s42, s44, 4
    s_mov_b32 s43, 0
    v_and_b32 v3, 1, v5
    v_lshl_or_b32 v3, v3, 2, v6
    s_add_u32 s40, s42, 0
    v_xor_b32 v3, s40, v3
    v_lshlrev_b32 v3, 5, v3
    v_lshl_add_u32 v3, v7, 3, v3
    v_lshl_add_u32 v4, v5, 3, v6
    v_lshl_add_u32 v3, v4, 8, v3
    v_add_u32 v10, s43, v3
    v_and_b32 v3, 1, v5
    v_lshl_or_b32 v3, v3, 2, v6
    s_add_u32 s40, s42, 1
    v_xor_b32 v3, s40, v3
    v_lshlrev_b32 v3, 5, v3
    v_lshl_add_u32 v3, v7, 3, v3
    v_lshl_add_u32 v4, v5, 3, v6
    v_lshl_add_u32 v3, v4, 8, v3
    v_add_u32 v11, s43, v3
    v_and_b32 v3, 1, v5
    v_lshl_or_b32 v3, v3, 2, v6
    s_add_u32 s40, s42, 2
    v_xor_b32 v3, s40, v3
    v_lshlrev_b32 v3, 5, v3
    v_lshl_add_u32 v3, v7, 3, v3
    v_lshl_add_u32 v4, v5, 3, v6
    v_lshl_add_u32 v3, v4, 8, v3
    v_add_u32 v12, s43, v3
    v_and_b32 v3, 1, v5
    v_lshl_or_b32 v3, v3, 2, v6
    s_add_u32 s40, s42, 3
    v_xor_b32 v3, s40, v3
    v_lshlrev_b32 v3, 5, v3
    v_lshl_add_u32 v3, v7, 3, v3
    v_lshl_add_u32 v4, v5, 3, v6
    v_lshl_add_u32 v3, v4, 8, v3
    v_add_u32 v13, s43, v3
    s_mul_i32 s42, s45, 4
    s_mov_b32 s43, 16384
    v_and_b32 v3, 1, v5
    v_lshl_or_b32 v3, v3, 2, v6
    s_add_u32 s40, s42, 0
    v_xor_b32 v3, s40, v3
    v_lshlrev_b32 v3, 5, v3
    v_lshl_add_u32 v3, v7, 3, v3
    v_lshl_add_u32 v4, v5, 3, v6
    v_lshl_add_u32 v3, v4, 8, v3
    v_add_u32 v14, s43, v3
    v_and_b32 v3, 1, v5
    v_lshl_or_b32 v3, v3, 2, v6
    s_add_u32 s40, s42, 1
    v_xor_b32 v3, s40, v3
    v_lshlrev_b32 v3, 5, v3
    v_lshl_add_u32 v3, v7, 3, v3
    v_lshl_add_u32 v4, v5, 3, v6
    v_lshl_add_u32 v3, v4, 8, v3
    v_add_u32 v15, s43, v3
    v_and_b32 v3, 1, v5
    v_lshl_or_b32 v3, v3, 2, v6
    s_add_u32 s40, s42, 2
    v_xor_b32 v3, s40, v3
    v_lshlrev_b32 v3, 5, v3
    v_lshl_add_u32 v3, v7, 3, v3
    v_lshl_add_u32 v4, v5, 3, v6
    v_lshl_add_u32 v3, v4, 8, v3
    v_add_u32 v16, s43, v3
    v_and_b32 v3, 1, v5
    v_lshl_or_b32 v3, v3, 2, v6
    s_add_u32 s40, s42, 3
    v_xor_b32 v3, s40, v3
    v_lshlrev_b32 v3, 5, v3
    v_lshl_add_u32 v3, v7, 3, v3
    v_lshl_add_u32 v4, v5, 3, v6
    v_lshl_add_u32 v3, v4, 8, v3
    v_add_u32 v17, s43, v3
    s_mov_b32 s48, 32
    s_mov_b32 s50, 0
    s_mov_b32 s51, 32768
    s_mov_b32 s29, 0xfffe8000
    s_waitcnt vmcnt(0)
    v_lshlrev_b32 v28, 16, v92
    v_and_b32 v29, 0xffff0000, v92
    v_lshlrev_b32 v30, 16, v93
    v_and_b32 v31, 0xffff0000, v93
    v_lshlrev_b32 v32, 16, v92
    v_and_b32 v33, 0xffff0000, v92
    v_lshlrev_b32 v34, 16, v93
    v_and_b32 v35, 0xffff0000, v93
    v_lshlrev_b32 v36, 16, v92
    v_and_b32 v37, 0xffff0000, v92
    v_lshlrev_b32 v38, 16, v93
    v_and_b32 v39, 0xffff0000, v93
    v_lshlrev_b32 v40, 16, v92
    v_and_b32 v41, 0xffff0000, v92
    v_lshlrev_b32 v42, 16, v93
    v_and_b32 v43, 0xffff0000, v93
    v_lshlrev_b32 v44, 16, v94
    v_and_b32 v45, 0xffff0000, v94
    v_lshlrev_b32 v46, 16, v95
    v_and_b32 v47, 0xffff0000, v95
    v_lshlrev_b32 v48, 16, v94
    v_and_b32 v49, 0xffff0000, v94
    v_lshlrev_b32 v50, 16, v95
    v_and_b32 v51, 0xffff0000, v95
    v_lshlrev_b32 v52, 16, v94
    v_and_b32 v53, 0xffff0000, v94
    v_lshlrev_b32 v54, 16, v95
    v_and_b32 v55, 0xffff0000, v95
    v_lshlrev_b32 v56, 16, v94
    v_and_b32 v57, 0xffff0000, v94
    v_lshlrev_b32 v58, 16, v95
    v_and_b32 v59, 0xffff0000, v95
    v_lshlrev_b32 v60, 16, v96
    v_and_b32 v61, 0xffff0000, v96
    v_lshlrev_b32 v62, 16, v97
    v_and_b32 v63, 0xffff0000, v97
    v_lshlrev_b32 v64, 16, v96
    v_and_b32 v65, 0xffff0000, v96
    v_lshlrev_b32 v66, 16, v97
    v_and_b32 v67, 0xffff0000, v97
    v_lshlrev_b32 v68, 16, v96
    v_and_b32 v69, 0xffff0000, v96
    v_lshlrev_b32 v70, 16, v97
    v_and_b32 v71, 0xffff0000, v97
    v_lshlrev_b32 v72, 16, v96
    v_and_b32 v73, 0xffff0000, v96
    v_lshlrev_b32 v74, 16, v97
    v_and_b32 v75, 0xffff0000, v97
    v_lshlrev_b32 v76, 16, v98
    v_and_b32 v77, 0xffff0000, v98
    v_lshlrev_b32 v78, 16, v99
    v_and_b32 v79, 0xffff0000, v99
    v_lshlrev_b32 v80, 16, v98
    v_and_b32 v81, 0xffff0000, v98
    v_lshlrev_b32 v82, 16, v99
    v_and_b32 v83, 0xffff0000, v99
    v_lshlrev_b32 v84, 16, v98
    v_and_b32 v85, 0xffff0000, v98
    v_lshlrev_b32 v86, 16, v99
    v_and_b32 v87, 0xffff0000, v99
    v_lshlrev_b32 v88, 16, v98
    v_and_b32 v89, 0xffff0000, v98
    v_lshlrev_b32 v90, 16, v99
    v_and_b32 v91, 0xffff0000, v99
    v_mov_b32 v156, 0xbdd2d3e8
    v_mov_b32 v157, 0xbdd2d3e8
    v_mov_b32 v158, 0xc0135761
    v_mov_b32 v159, 0xc0135761
    v_mov_b32 v160, 0x3f800000
    v_mov_b32 v161, 0x3f800000
    s_barrier
    ds_read_b64_tr_b16 v[92:93], v10 offset:0
    ds_read_b64_tr_b16 v[94:95], v10 offset:1024
    ds_read_b64_tr_b16 v[108:109], v14 offset:0
    ds_read_b64_tr_b16 v[110:111], v14 offset:1024
    ds_read_b64_tr_b16 v[112:113], v15 offset:0
    ds_read_b64_tr_b16 v[114:115], v15 offset:1024
    ds_read_b64_tr_b16 v[116:117], v16 offset:0
    ds_read_b64_tr_b16 v[118:119], v16 offset:1024
    ds_read_b64_tr_b16 v[120:121], v17 offset:0
    ds_read_b64_tr_b16 v[122:123], v17 offset:1024
    ds_read_b64_tr_b16 v[96:97], v11 offset:0
    ds_read_b64_tr_b16 v[98:99], v11 offset:1024
    ds_read_b64_tr_b16 v[100:101], v12 offset:0
    ds_read_b64_tr_b16 v[102:103], v12 offset:1024
    ds_read_b64_tr_b16 v[104:105], v13 offset:0
    ds_read_b64_tr_b16 v[106:107], v13 offset:1024
    s_branch g3_cloop3
.p2align 3
g3_cloop:
    s_barrier
g3_cloop2:
    v_mfma_f32_16x16x32_bf16 v[28:31], v[124:127], v[140:143], v[28:31]
    ds_read_b64_tr_b16 v[92:93], v10 offset:0
    ds_read_b64_tr_b16 v[94:95], v10 offset:1024
    v_mfma_f32_16x16x32_bf16 v[32:35], v[124:127], v[144:147], v[32:35]
    ds_read_b64_tr_b16 v[108:109], v14 offset:0
    ds_read_b64_tr_b16 v[110:111], v14 offset:1024
    v_mfma_f32_16x16x32_bf16 v[36:39], v[124:127], v[148:151], v[36:39]
    ds_read_b64_tr_b16 v[112:113], v15 offset:0
    ds_read_b64_tr_b16 v[114:115], v15 offset:1024
    v_mfma_f32_16x16x32_bf16 v[40:43], v[124:127], v[152:155], v[40:43]
    ds_read_b64_tr_b16 v[116:117], v16 offset:0
    ds_read_b64_tr_b16 v[118:119], v16 offset:1024
    v_mfma_f32_16x16x32_bf16 v[56:59], v[128:131], v[152:155], v[56:59]
    ds_read_b64_tr_b16 v[120:121], v17 offset:0
    ds_read_b64_tr_b16 v[122:123], v17 offset:1024
    v_mfma_f32_16x16x32_bf16 v[52:55], v[128:131], v[148:151], v[52:55]
    ds_read_b64_tr_b16 v[96:97], v11 offset:0
    ds_read_b64_tr_b16 v[98:99], v11 offset:1024
    v_mfma_f32_16x16x32_bf16 v[48:51], v[128:131], v[144:147], v[48:51]
    ds_read_b64_tr_b16 v[100:101], v12 offset:0
    ds_read_b64_tr_b16 v[102:103], v12 offset:1024
    v_mfma_f32_16x16x32_bf16 v[44:47], v[128:131], v[140:143], v[44:47]
    ds_read_b64_tr_b16 v[104:105], v13 offset:0
    ds_read_b64_tr_b16 v[106:107], v13 offset:1024
    v_mfma_f32_16x16x32_bf16 v[60:63], v[132:135], v[140:143], v[60:63]
    v_mfma_f32_16x16x32_bf16 v[64:67], v[132:135], v[144:147], v[64:67]
    v_mfma_f32_16x16x32_bf16 v[68:71], v[132:135], v[148:151], v[68:71]
    v_mfma_f32_16x16x32_bf16 v[72:75], v[132:135], v[152:155], v[72:75]
    v_mfma_f32_16x16x32_bf16 v[88:91], v[136:139], v[152:155], v[88:91]
    v_mfma_f32_16x16x32_bf16 v[84:87], v[136:139], v[148:151], v[84:87]
    v_mfma_f32_16x16x32_bf16 v[80:83], v[136:139], v[144:147], v[80:83]
    v_mfma_f32_16x16x32_bf16 v[76:79], v[136:139], v[140:143], v[76:79]
g3_cloop3:
    s_waitcnt lgkmcnt(0)
    v_mfma_f32_16x16x32_bf16 v[28:31], v[92:95], v[108:111], v[28:31]
    ds_read_b64_tr_b16 v[124:125], v10 offset:8192
    ds_read_b64_tr_b16 v[126:127], v10 offset:9216
    v_mfma_f32_16x16x32_bf16 v[32:35], v[92:95], v[112:115], v[32:35]
    ds_read_b64_tr_b16 v[140:141], v14 offset:8192
    ds_read_b64_tr_b16 v[142:143], v14 offset:9216
    v_mfma_f32_16x16x32_bf16 v[36:39], v[92:95], v[116:119], v[36:39]
    ds_read_b64_tr_b16 v[144:145], v15 offset:8192
    ds_read_b64_tr_b16 v[146:147], v15 offset:9216
    v_mfma_f32_16x16x32_bf16 v[40:43], v[92:95], v[120:123], v[40:43]
    ds_read_b64_tr_b16 v[148:149], v16 offset:8192
    ds_read_b64_tr_b16 v[150:151], v16 offset:9216
    v_mfma_f32_16x16x32_bf16 v[56:59], v[96:99], v[120:123], v[56:59]
    ds_read_b64_tr_b16 v[152:153], v17 offset:8192
    ds_read_b64_tr_b16 v[154:155], v17 offset:9216
    v_mfma_f32_16x16x32_bf16 v[52:55], v[96:99], v[116:119], v[52:55]
    ds_read_b64_tr_b16 v[128:129], v11 offset:8192
    ds_read_b64_tr_b16 v[130:131], v11 offset:9216
    v_mfma_f32_16x16x32_bf16 v[48:51], v[96:99], v[112:115], v[48:51]
    ds_read_b64_tr_b16 v[132:133], v12 offset:8192
    ds_read_b64_tr_b16 v[134:135], v12 offset:9216
    v_mfma_f32_16x16x32_bf16 v[44:47], v[96:99], v[108:111], v[44:47]
    ds_read_b64_tr_b16 v[136:137], v13 offset:8192
    ds_read_b64_tr_b16 v[138:139], v13 offset:9216
    v_mfma_f32_16x16x32_bf16 v[60:63], v[100:103], v[108:111], v[60:63]
    s_add_u32 s50, s50, 1
    s_cmp_eq_u32 s50, 4
    v_mfma_f32_16x16x32_bf16 v[64:67], v[100:103], v[112:115], v[64:67]
    s_cselect_b32 s49, s29, s51
    s_cselect_b32 s50, 0, s50
    v_mfma_f32_16x16x32_bf16 v[68:71], v[100:103], v[116:119], v[68:71]
    v_add_u32 v10, s49, v10
    v_add_u32 v11, s49, v11
    v_mfma_f32_16x16x32_bf16 v[72:75], v[100:103], v[120:123], v[72:75]
    v_add_u32 v12, s49, v12
    v_add_u32 v13, s49, v13
    v_mfma_f32_16x16x32_bf16 v[88:91], v[104:107], v[120:123], v[88:91]
    v_add_u32 v14, s49, v14
    v_add_u32 v15, s49, v15
    v_mfma_f32_16x16x32_bf16 v[84:87], v[104:107], v[116:119], v[84:87]
    v_add_u32 v16, s49, v16
    v_add_u32 v17, s49, v17
    v_mfma_f32_16x16x32_bf16 v[80:83], v[104:107], v[112:115], v[80:83]
    s_sub_u32 s48, s48, 1
    s_cmp_lg_u32 s48, 0
    v_mfma_f32_16x16x32_bf16 v[76:79], v[104:107], v[108:111], v[76:79]
    s_waitcnt lgkmcnt(0)
    s_cbranch_scc1 g3_cloop
    v_mfma_f32_16x16x32_bf16 v[28:31], v[124:127], v[140:143], v[28:31]
    v_mfma_f32_16x16x32_bf16 v[44:47], v[128:131], v[140:143], v[44:47]
    v_mfma_f32_16x16x32_bf16 v[60:63], v[132:135], v[140:143], v[60:63]
    v_mfma_f32_16x16x32_bf16 v[76:79], v[136:139], v[140:143], v[76:79]
    v_mfma_f32_16x16x32_bf16 v[32:35], v[124:127], v[144:147], v[32:35]
    v_mfma_f32_16x16x32_bf16 v[48:51], v[128:131], v[144:147], v[48:51]
    v_mfma_f32_16x16x32_bf16 v[64:67], v[132:135], v[144:147], v[64:67]
    v_mfma_f32_16x16x32_bf16 v[80:83], v[136:139], v[144:147], v[80:83]
    s_nop 1
    v_mfma_f32_16x16x32_bf16 v[36:39], v[124:127], v[148:151], v[36:39]
    v_pk_mul_f32 v[108:109], v[28:29], v[28:29]
    v_pk_mul_f32 v[110:111], v[30:31], v[30:31]
    v_pk_mul_f32 v[112:113], v[44:45], v[44:45]
    v_pk_mul_f32 v[114:115], v[46:47], v[46:47]
    v_pk_fma_f32 v[108:109], v[108:109], v[156:157], v[158:159]
    v_pk_fma_f32 v[110:111], v[110:111], v[156:157], v[158:159]
    v_pk_fma_f32 v[112:113], v[112:113], v[156:157], v[158:159]
    v_pk_fma_f32 v[114:115], v[114:115], v[156:157], v[158:159]
    v_pk_mul_f32 v[108:109], v[108:109], v[28:29]
    v_pk_mul_f32 v[110:111], v[110:111], v[30:31]
    v_pk_mul_f32 v[112:113], v[112:113], v[44:45]
    v_pk_mul_f32 v[114:115], v[114:115], v[46:47]
    v_exp_f32 v108, v108
    v_exp_f32 v109, v109
    v_exp_f32 v110, v110
    v_exp_f32 v111, v111
    v_exp_f32 v112, v112
    v_exp_f32 v113, v113
    v_exp_f32 v114, v114
    v_exp_f32 v115, v115
    v_pk_add_f32 v[108:109], v[108:109], v[160:161]
    v_pk_add_f32 v[110:111], v[110:111], v[160:161]
    v_mfma_f32_16x16x32_bf16 v[52:55], v[128:131], v[148:151], v[52:55]
    v_pk_add_f32 v[112:113], v[112:113], v[160:161]
    v_pk_add_f32 v[114:115], v[114:115], v[160:161]
    v_rcp_f32 v108, v108
    v_rcp_f32 v109, v109
    v_rcp_f32 v110, v110
    v_rcp_f32 v111, v111
    v_rcp_f32 v112, v112
    v_rcp_f32 v113, v113
    v_rcp_f32 v114, v114
    v_rcp_f32 v115, v115
    v_pk_mul_f32 v[28:29], v[28:29], v[108:109]
    v_pk_mul_f32 v[30:31], v[30:31], v[110:111]
    v_pk_mul_f32 v[44:45], v[44:45], v[112:113]
    v_pk_mul_f32 v[46:47], v[46:47], v[114:115]
    v_cvt_pk_bf16_f32 v92, v28, v29
    v_cvt_pk_bf16_f32 v93, v30, v31
    v_cvt_pk_bf16_f32 v94, v44, v45
    v_cvt_pk_bf16_f32 v95, v46, v47
    s_nop 1
    v_permlane16_swap_b32 v92, v94
    v_permlane16_swap_b32 v93, v95
    buffer_store_dwordx4 v[92:95], v9, s[16:19], s52 offen offset:0 sc1
    v_mfma_f32_16x16x32_bf16 v[68:71], v[132:135], v[148:151], v[68:71]
    v_pk_mul_f32 v[108:109], v[60:61], v[60:61]
    v_pk_mul_f32 v[110:111], v[62:63], v[62:63]
    v_pk_mul_f32 v[112:113], v[76:77], v[76:77]
    v_pk_mul_f32 v[114:115], v[78:79], v[78:79]
    v_pk_fma_f32 v[108:109], v[108:109], v[156:157], v[158:159]
    v_pk_fma_f32 v[110:111], v[110:111], v[156:157], v[158:159]
    v_pk_fma_f32 v[112:113], v[112:113], v[156:157], v[158:159]
    v_pk_fma_f32 v[114:115], v[114:115], v[156:157], v[158:159]
    v_pk_mul_f32 v[108:109], v[108:109], v[60:61]
    v_pk_mul_f32 v[110:111], v[110:111], v[62:63]
    v_pk_mul_f32 v[112:113], v[112:113], v[76:77]
    v_pk_mul_f32 v[114:115], v[114:115], v[78:79]
    v_exp_f32 v108, v108
    v_exp_f32 v109, v109
    v_exp_f32 v110, v110
    v_exp_f32 v111, v111
    v_exp_f32 v112, v112
    v_exp_f32 v113, v113
    v_exp_f32 v114, v114
    v_exp_f32 v115, v115
    v_pk_add_f32 v[108:109], v[108:109], v[160:161]
    v_pk_add_f32 v[110:111], v[110:111], v[160:161]
    v_mfma_f32_16x16x32_bf16 v[84:87], v[136:139], v[148:151], v[84:87]
    v_pk_add_f32 v[112:113], v[112:113], v[160:161]
    v_pk_add_f32 v[114:115], v[114:115], v[160:161]
    v_rcp_f32 v108, v108
    v_rcp_f32 v109, v109
    v_rcp_f32 v110, v110
    v_rcp_f32 v111, v111
    v_rcp_f32 v112, v112
    v_rcp_f32 v113, v113
    v_rcp_f32 v114, v114
    v_rcp_f32 v115, v115
    v_pk_mul_f32 v[60:61], v[60:61], v[108:109]
    v_pk_mul_f32 v[62:63], v[62:63], v[110:111]
    v_pk_mul_f32 v[76:77], v[76:77], v[112:113]
    v_pk_mul_f32 v[78:79], v[78:79], v[114:115]
    v_cvt_pk_bf16_f32 v96, v60, v61
    v_cvt_pk_bf16_f32 v97, v62, v63
    v_cvt_pk_bf16_f32 v98, v76, v77
    v_cvt_pk_bf16_f32 v99, v78, v79
    s_nop 1
    v_permlane16_swap_b32 v96, v98
    v_permlane16_swap_b32 v97, v99
    buffer_store_dwordx4 v[96:99], v9, s[16:19], s52 offen offset:64 sc1
    v_mfma_f32_16x16x32_bf16 v[40:43], v[124:127], v[152:155], v[40:43]
    v_pk_mul_f32 v[108:109], v[32:33], v[32:33]
    v_pk_mul_f32 v[110:111], v[34:35], v[34:35]
    v_pk_mul_f32 v[112:113], v[48:49], v[48:49]
    v_pk_mul_f32 v[114:115], v[50:51], v[50:51]
    v_pk_fma_f32 v[108:109], v[108:109], v[156:157], v[158:159]
    v_pk_fma_f32 v[110:111], v[110:111], v[156:157], v[158:159]
    v_pk_fma_f32 v[112:113], v[112:113], v[156:157], v[158:159]
    v_pk_fma_f32 v[114:115], v[114:115], v[156:157], v[158:159]
    v_pk_mul_f32 v[108:109], v[108:109], v[32:33]
    v_pk_mul_f32 v[110:111], v[110:111], v[34:35]
    v_pk_mul_f32 v[112:113], v[112:113], v[48:49]
    v_pk_mul_f32 v[114:115], v[114:115], v[50:51]
    v_exp_f32 v108, v108
    v_exp_f32 v109, v109
    v_exp_f32 v110, v110
    v_exp_f32 v111, v111
    v_exp_f32 v112, v112
    v_exp_f32 v113, v113
    v_exp_f32 v114, v114
    v_exp_f32 v115, v115
    v_pk_add_f32 v[108:109], v[108:109], v[160:161]
    v_pk_add_f32 v[110:111], v[110:111], v[160:161]
    v_mfma_f32_16x16x32_bf16 v[56:59], v[128:131], v[152:155], v[56:59]
    v_pk_add_f32 v[112:113], v[112:113], v[160:161]
    v_pk_add_f32 v[114:115], v[114:115], v[160:161]
    v_rcp_f32 v108, v108
    v_rcp_f32 v109, v109
    v_rcp_f32 v110, v110
    v_rcp_f32 v111, v111
    v_rcp_f32 v112, v112
    v_rcp_f32 v113, v113
    v_rcp_f32 v114, v114
    v_rcp_f32 v115, v115
    v_pk_mul_f32 v[32:33], v[32:33], v[108:109]
    v_pk_mul_f32 v[34:35], v[34:35], v[110:111]
    v_pk_mul_f32 v[48:49], v[48:49], v[112:113]
    v_pk_mul_f32 v[50:51], v[50:51], v[114:115]
    v_cvt_pk_bf16_f32 v100, v32, v33
    v_cvt_pk_bf16_f32 v101, v34, v35
    v_cvt_pk_bf16_f32 v102, v48, v49
    v_cvt_pk_bf16_f32 v103, v50, v51
    s_nop 1
    v_permlane16_swap_b32 v100, v102
    v_permlane16_swap_b32 v101, v103
    buffer_store_dwordx4 v[100:103], v9, s[16:19], s53 offen offset:0 sc1
    v_mfma_f32_16x16x32_bf16 v[72:75], v[132:135], v[152:155], v[72:75]
    v_pk_mul_f32 v[108:109], v[64:65], v[64:65]
    v_pk_mul_f32 v[110:111], v[66:67], v[66:67]
    v_pk_mul_f32 v[112:113], v[80:81], v[80:81]
    v_pk_mul_f32 v[114:115], v[82:83], v[82:83]
    v_pk_fma_f32 v[108:109], v[108:109], v[156:157], v[158:159]
    v_pk_fma_f32 v[110:111], v[110:111], v[156:157], v[158:159]
    v_pk_fma_f32 v[112:113], v[112:113], v[156:157], v[158:159]
    v_pk_fma_f32 v[114:115], v[114:115], v[156:157], v[158:159]
    v_pk_mul_f32 v[108:109], v[108:109], v[64:65]
    v_pk_mul_f32 v[110:111], v[110:111], v[66:67]
    v_pk_mul_f32 v[112:113], v[112:113], v[80:81]
    v_pk_mul_f32 v[114:115], v[114:115], v[82:83]
    v_exp_f32 v108, v108
    v_exp_f32 v109, v109
    v_exp_f32 v110, v110
    v_exp_f32 v111, v111
    v_exp_f32 v112, v112
    v_exp_f32 v113, v113
    v_exp_f32 v114, v114
    v_exp_f32 v115, v115
    v_pk_add_f32 v[108:109], v[108:109], v[160:161]
    v_pk_add_f32 v[110:111], v[110:111], v[160:161]
    v_mfma_f32_16x16x32_bf16 v[88:91], v[136:139], v[152:155], v[88:91]
    v_pk_add_f32 v[112:113], v[112:113], v[160:161]
    v_pk_add_f32 v[114:115], v[114:115], v[160:161]
    v_rcp_f32 v108, v108
    v_rcp_f32 v109, v109
    v_rcp_f32 v110, v110
    v_rcp_f32 v111, v111
    v_rcp_f32 v112, v112
    v_rcp_f32 v113, v113
    v_rcp_f32 v114, v114
    v_rcp_f32 v115, v115
    v_pk_mul_f32 v[64:65], v[64:65], v[108:109]
    v_pk_mul_f32 v[66:67], v[66:67], v[110:111]
    v_pk_mul_f32 v[80:81], v[80:81], v[112:113]
    v_pk_mul_f32 v[82:83], v[82:83], v[114:115]
    v_cvt_pk_bf16_f32 v104, v64, v65
    v_cvt_pk_bf16_f32 v105, v66, v67
    v_cvt_pk_bf16_f32 v106, v80, v81
    v_cvt_pk_bf16_f32 v107, v82, v83
    s_nop 1
    v_permlane16_swap_b32 v104, v106
    v_permlane16_swap_b32 v105, v107
    buffer_store_dwordx4 v[104:107], v9, s[16:19], s53 offen offset:64 sc1
    v_pk_mul_f32 v[108:109], v[36:37], v[36:37]
    v_pk_mul_f32 v[110:111], v[38:39], v[38:39]
    v_pk_mul_f32 v[112:113], v[52:53], v[52:53]
    v_pk_mul_f32 v[114:115], v[54:55], v[54:55]
    v_pk_fma_f32 v[108:109], v[108:109], v[156:157], v[158:159]
    v_pk_fma_f32 v[110:111], v[110:111], v[156:157], v[158:159]
    v_pk_fma_f32 v[112:113], v[112:113], v[156:157], v[158:159]
    v_pk_fma_f32 v[114:115], v[114:115], v[156:157], v[158:159]
    v_pk_mul_f32 v[108:109], v[108:109], v[36:37]
    v_pk_mul_f32 v[110:111], v[110:111], v[38:39]
    v_pk_mul_f32 v[112:113], v[112:113], v[52:53]
    v_pk_mul_f32 v[114:115], v[114:115], v[54:55]
    v_exp_f32 v108, v108
    v_exp_f32 v109, v109
    v_exp_f32 v110, v110
    v_exp_f32 v111, v111
    v_exp_f32 v112, v112
    v_exp_f32 v113, v113
    v_exp_f32 v114, v114
    v_exp_f32 v115, v115
    v_pk_add_f32 v[108:109], v[108:109], v[160:161]
    v_pk_add_f32 v[110:111], v[110:111], v[160:161]
    v_pk_add_f32 v[112:113], v[112:113], v[160:161]
    v_pk_add_f32 v[114:115], v[114:115], v[160:161]
    v_rcp_f32 v108, v108
    v_rcp_f32 v109, v109
    v_rcp_f32 v110, v110
    v_rcp_f32 v111, v111
    v_rcp_f32 v112, v112
    v_rcp_f32 v113, v113
    v_rcp_f32 v114, v114
    v_rcp_f32 v115, v115
    v_pk_mul_f32 v[36:37], v[36:37], v[108:109]
    v_pk_mul_f32 v[38:39], v[38:39], v[110:111]
    v_pk_mul_f32 v[52:53], v[52:53], v[112:113]
    v_pk_mul_f32 v[54:55], v[54:55], v[114:115]
    v_cvt_pk_bf16_f32 v92, v36, v37
    v_cvt_pk_bf16_f32 v93, v38, v39
    v_cvt_pk_bf16_f32 v94, v52, v53
    v_cvt_pk_bf16_f32 v95, v54, v55
    s_nop 1
    v_permlane16_swap_b32 v92, v94
    v_permlane16_swap_b32 v93, v95
    buffer_store_dwordx4 v[92:95], v9, s[16:19], s54 offen offset:0 sc1
    v_pk_mul_f32 v[108:109], v[68:69], v[68:69]
    v_pk_mul_f32 v[110:111], v[70:71], v[70:71]
    v_pk_mul_f32 v[112:113], v[84:85], v[84:85]
    v_pk_mul_f32 v[114:115], v[86:87], v[86:87]
    v_pk_fma_f32 v[108:109], v[108:109], v[156:157], v[158:159]
    v_pk_fma_f32 v[110:111], v[110:111], v[156:157], v[158:159]
    v_pk_fma_f32 v[112:113], v[112:113], v[156:157], v[158:159]
    v_pk_fma_f32 v[114:115], v[114:115], v[156:157], v[158:159]
    v_pk_mul_f32 v[108:109], v[108:109], v[68:69]
    v_pk_mul_f32 v[110:111], v[110:111], v[70:71]
    v_pk_mul_f32 v[112:113], v[112:113], v[84:85]
    v_pk_mul_f32 v[114:115], v[114:115], v[86:87]
    v_exp_f32 v108, v108
    v_exp_f32 v109, v109
    v_exp_f32 v110, v110
    v_exp_f32 v111, v111
    v_exp_f32 v112, v112
    v_exp_f32 v113, v113
    v_exp_f32 v114, v114
    v_exp_f32 v115, v115
    v_pk_add_f32 v[108:109], v[108:109], v[160:161]
    v_pk_add_f32 v[110:111], v[110:111], v[160:161]
    v_pk_add_f32 v[112:113], v[112:113], v[160:161]
    v_pk_add_f32 v[114:115], v[114:115], v[160:161]
    v_rcp_f32 v108, v108
    v_rcp_f32 v109, v109
    v_rcp_f32 v110, v110
    v_rcp_f32 v111, v111
    v_rcp_f32 v112, v112
    v_rcp_f32 v113, v113
    v_rcp_f32 v114, v114
    v_rcp_f32 v115, v115
    v_pk_mul_f32 v[68:69], v[68:69], v[108:109]
    v_pk_mul_f32 v[70:71], v[70:71], v[110:111]
    v_pk_mul_f32 v[84:85], v[84:85], v[112:113]
    v_pk_mul_f32 v[86:87], v[86:87], v[114:115]
    v_cvt_pk_bf16_f32 v96, v68, v69
    v_cvt_pk_bf16_f32 v97, v70, v71
    v_cvt_pk_bf16_f32 v98, v84, v85
    v_cvt_pk_bf16_f32 v99, v86, v87
    s_nop 1
    v_permlane16_swap_b32 v96, v98
    v_permlane16_swap_b32 v97, v99
    buffer_store_dwordx4 v[96:99], v9, s[16:19], s54 offen offset:64 sc1
    v_pk_mul_f32 v[108:109], v[40:41], v[40:41]
    v_pk_mul_f32 v[110:111], v[42:43], v[42:43]
    v_pk_mul_f32 v[112:113], v[56:57], v[56:57]
    v_pk_mul_f32 v[114:115], v[58:59], v[58:59]
    v_pk_fma_f32 v[108:109], v[108:109], v[156:157], v[158:159]
    v_pk_fma_f32 v[110:111], v[110:111], v[156:157], v[158:159]
    v_pk_fma_f32 v[112:113], v[112:113], v[156:157], v[158:159]
    v_pk_fma_f32 v[114:115], v[114:115], v[156:157], v[158:159]
    v_pk_mul_f32 v[108:109], v[108:109], v[40:41]
    v_pk_mul_f32 v[110:111], v[110:111], v[42:43]
    v_pk_mul_f32 v[112:113], v[112:113], v[56:57]
    v_pk_mul_f32 v[114:115], v[114:115], v[58:59]
    v_exp_f32 v108, v108
    v_exp_f32 v109, v109
    v_exp_f32 v110, v110
    v_exp_f32 v111, v111
    v_exp_f32 v112, v112
    v_exp_f32 v113, v113
    v_exp_f32 v114, v114
    v_exp_f32 v115, v115
    v_pk_add_f32 v[108:109], v[108:109], v[160:161]
    v_pk_add_f32 v[110:111], v[110:111], v[160:161]
    v_pk_add_f32 v[112:113], v[112:113], v[160:161]
    v_pk_add_f32 v[114:115], v[114:115], v[160:161]
    v_rcp_f32 v108, v108
    v_rcp_f32 v109, v109
    v_rcp_f32 v110, v110
    v_rcp_f32 v111, v111
    v_rcp_f32 v112, v112
    v_rcp_f32 v113, v113
    v_rcp_f32 v114, v114
    v_rcp_f32 v115, v115
    v_pk_mul_f32 v[40:41], v[40:41], v[108:109]
    v_pk_mul_f32 v[42:43], v[42:43], v[110:111]
    v_pk_mul_f32 v[56:57], v[56:57], v[112:113]
    v_pk_mul_f32 v[58:59], v[58:59], v[114:115]
    v_cvt_pk_bf16_f32 v100, v40, v41
    v_cvt_pk_bf16_f32 v101, v42, v43
    v_cvt_pk_bf16_f32 v102, v56, v57
    v_cvt_pk_bf16_f32 v103, v58, v59
    s_nop 1
    v_permlane16_swap_b32 v100, v102
    v_permlane16_swap_b32 v101, v103
    buffer_store_dwordx4 v[100:103], v9, s[16:19], s55 offen offset:0 sc1
    v_pk_mul_f32 v[108:109], v[72:73], v[72:73]
    v_pk_mul_f32 v[110:111], v[74:75], v[74:75]
    v_pk_mul_f32 v[112:113], v[88:89], v[88:89]
    v_pk_mul_f32 v[114:115], v[90:91], v[90:91]
    v_pk_fma_f32 v[108:109], v[108:109], v[156:157], v[158:159]
    v_pk_fma_f32 v[110:111], v[110:111], v[156:157], v[158:159]
    v_pk_fma_f32 v[112:113], v[112:113], v[156:157], v[158:159]
    v_pk_fma_f32 v[114:115], v[114:115], v[156:157], v[158:159]
    v_pk_mul_f32 v[108:109], v[108:109], v[72:73]
    v_pk_mul_f32 v[110:111], v[110:111], v[74:75]
    v_pk_mul_f32 v[112:113], v[112:113], v[88:89]
    v_pk_mul_f32 v[114:115], v[114:115], v[90:91]
    v_exp_f32 v108, v108
    v_exp_f32 v109, v109
    v_exp_f32 v110, v110
    v_exp_f32 v111, v111
    v_exp_f32 v112, v112
    v_exp_f32 v113, v113
    v_exp_f32 v114, v114
    v_exp_f32 v115, v115
    v_pk_add_f32 v[108:109], v[108:109], v[160:161]
    v_pk_add_f32 v[110:111], v[110:111], v[160:161]
    v_pk_add_f32 v[112:113], v[112:113], v[160:161]
    v_pk_add_f32 v[114:115], v[114:115], v[160:161]
    v_rcp_f32 v108, v108
    v_rcp_f32 v109, v109
    v_rcp_f32 v110, v110
    v_rcp_f32 v111, v111
    v_rcp_f32 v112, v112
    v_rcp_f32 v113, v113
    v_rcp_f32 v114, v114
    v_rcp_f32 v115, v115
    v_pk_mul_f32 v[72:73], v[72:73], v[108:109]
    v_pk_mul_f32 v[74:75], v[74:75], v[110:111]
    v_pk_mul_f32 v[88:89], v[88:89], v[112:113]
    v_pk_mul_f32 v[90:91], v[90:91], v[114:115]
    v_cvt_pk_bf16_f32 v104, v72, v73
    v_cvt_pk_bf16_f32 v105, v74, v75
    v_cvt_pk_bf16_f32 v106, v88, v89
    v_cvt_pk_bf16_f32 v107, v90, v91
    s_nop 1
    v_permlane16_swap_b32 v104, v106
    v_permlane16_swap_b32 v105, v107
    buffer_store_dwordx4 v[104:107], v9, s[16:19], s55 offen offset:64 sc1
    s_cmp_ge_u32 s24, 14
    s_cselect_b32 s40, 25, 24
    s_lshl_b32 s41, s25, 1
    s_add_u32 s40, s40, s41
    s_lshl_b32 s40, s40, 8
    s_sub_u32 s41, s24, 14
    s_min_u32 s41, s41, s24
    s_add_u32 s84, s4, 0x300000
    s_addc_u32 s85, s5, 0
    s_mov_b32 s86, 0x4000
    s_mov_b32 s87, 0x20000
    s_lshl_b32 s41, s41, 2
    s_add_u32 s40, s40, s41
    v_mov_b32 v3, s40
    v_mov_b32 v4, 1
    s_waitcnt vmcnt(0)
    s_barrier
    s_cmp_lg_u32 s28, 0
    s_cbranch_scc1 g3_cin
    s_mov_b64 exec, 1
    buffer_store_dword v4, v3, s[84:87], 0 offen sc1
    s_mov_b64 exec, -1
g3_cin:
    s_branch g4_in
g3_spare:
    s_cmp_ge_u32 s2, 256
    s_cbranch_scc1 g3_done
    s_load_dwordx2 s[4:5], s[0:1], 80
    s_load_dwordx2 s[6:7], s[0:1], 48
    s_sub_u32 s3, s2, 224
    v_lshrrev_b32 v2, 6, v0
    v_lshlrev_b32 v1, 4, v0
    v_mov_b32 v8, -1
    v_mov_b32 v9, -1
    v_mov_b32 v10, -1
    v_mov_b32 v11, -1
    v_readfirstlane_b32 s28, v2
    s_lshl_b32 s13, s3, 17
    s_waitcnt lgkmcnt(0)
    s_add_u32 s4, s4, s97
    s_addc_u32 s5, s5, 0
    s_add_u32 s8, s4, 0x1d00000
    s_addc_u32 s9, s5, 0
    s_mov_b32 s10, 0x400000
    s_mov_b32 s11, 0x20000
    buffer_store_dwordx4 v[8:11], v1, s[8:11], s13 offen sc1
    s_add_u32 s13, s13, 8192
    buffer_store_dwordx4 v[8:11], v1, s[8:11], s13 offen sc1
    s_add_u32 s13, s13, 8192
    buffer_store_dwordx4 v[8:11], v1, s[8:11], s13 offen sc1
    s_add_u32 s13, s13, 8192
    buffer_store_dwordx4 v[8:11], v1, s[8:11], s13 offen sc1
    s_add_u32 s13, s13, 8192
    buffer_store_dwordx4 v[8:11], v1, s[8:11], s13 offen sc1
    s_add_u32 s13, s13, 8192
    buffer_store_dwordx4 v[8:11], v1, s[8:11], s13 offen sc1
    s_add_u32 s13, s13, 8192
    buffer_store_dwordx4 v[8:11], v1, s[8:11], s13 offen sc1
    s_add_u32 s13, s13, 8192
    buffer_store_dwordx4 v[8:11], v1, s[8:11], s13 offen sc1
    s_add_u32 s13, s13, 8192
    buffer_store_dwordx4 v[8:11], v1, s[8:11], s13 offen sc1
    s_add_u32 s13, s13, 8192
    buffer_store_dwordx4 v[8:11], v1, s[8:11], s13 offen sc1
    s_add_u32 s13, s13, 8192
    buffer_store_dwordx4 v[8:11], v1, s[8:11], s13 offen sc1
    s_add_u32 s13, s13, 8192
    buffer_store_dwordx4 v[8:11], v1, s[8:11], s13 offen sc1
    s_add_u32 s13, s13, 8192
    buffer_store_dwordx4 v[8:11], v1, s[8:11], s13 offen sc1
    s_add_u32 s13, s13, 8192
    buffer_store_dwordx4 v[8:11], v1, s[8:11], s13 offen sc1
    s_add_u32 s13, s13, 8192
    buffer_store_dwordx4 v[8:11], v1, s[8:11], s13 offen sc1
    s_add_u32 s13, s13, 8192
    buffer_store_dwordx4 v[8:11], v1, s[8:11], s13 offen sc1
    s_add_u32 s13, s13, 8192
    s_mov_b32 s40, 14336
    s_mov_b32 s41, s3
    s_add_u32 s84, s4, 0x300000
    s_addc_u32 s85, s5, 0
    s_mov_b32 s86, 0x4000
    s_mov_b32 s87, 0x20000
    s_lshl_b32 s41, s41, 2
    s_add_u32 s40, s40, s41
    v_mov_b32 v3, s40
    v_mov_b32 v4, 1
    s_waitcnt vmcnt(0)
    s_barrier
    s_cmp_lg_u32 s28, 0
    s_cbranch_scc1 g3_spare_cin
    s_mov_b64 exec, 1
    buffer_store_dword v4, v3, s[84:87], 0 offen sc1
    s_mov_b64 exec, -1
g3_spare_cin:
    s_cmp_lg_u32 s96, 0
    s_cbranch_scc1 g3_spare_end
g3_spare_end:
    s_branch g4_in
.p2align 6
g4_in:
    s_cmp_ge_u32 s2, 256
    s_cbranch_scc1 g4_done
    s_load_dwordx2 s[4:5], s[0:1], 80
    s_load_dwordx2 s[6:7], s[0:1], 64
    s_load_dwordx2 s[30:31], s[0:1], 48
    s_load_dwordx2 s[34:35], s[0:1], 56
    v_lshrrev_b32 v1, 6, v0
    v_and_b32 v2, 63, v0
    s_bfe_u32 s40, s2, 0x10001
    s_lshl_b32 s40, s40, 2
    s_bfe_u32 s41, s2, 0x20003
    s_add_u32 s24, s40, s41
    s_bfe_u32 s40, s2, 0x10002
    s_lshl_b32 s40, s40, 3
    s_lshr_b32 s42, s2, 5
    s_add_u32 s25, s40, s42
    s_and_b32 s91, s2, 1
    s_add_u32 s27, s41, s42
    s_lshl_b32 s92, s24, 4
    s_add_u32 s92, s92, s25
    s_mul_i32 s26, s91, 28
    s_cmp_eq_u32 s96, 0
    s_cselect_b32 s95, 3, 1
    v_readfirstlane_b32 s28, v1
    s_nop 0
    s_cmp_lt_u32 s28, 4
    s_cbranch_scc1 g4_compute
    s_sub_u32 s28, s28, 4
    s_mov_b32 s40, 8192
    v_lshrrev_b32 v3, 3, v2
    v_mul_lo_u32 v3, v3, s40
    v_lshrrev_b32 v4, 4, v2
    v_xor_b32 v4, v4, v2
    v_and_b32 v4, 7, v4
    v_lshl_add_u32 v3, v4, 4, v3
    s_mul_i32 s41, s24, 1048576
    s_mul_i32 s42, s28, 262144
    s_add_u32 s41, s41, s42
    v_xor_b32 v4, 64, v3
    s_add_u32 s42, s41, 0
    v_add_u32 v10, s42, v3
    s_add_u32 s42, s41, 65536
    v_add_u32 v11, s42, v4
    s_add_u32 s42, s41, 131072
    v_add_u32 v12, s42, v3
    s_add_u32 s42, s41, 196608
    v_add_u32 v13, s42, v4
    s_mov_b32 s40, 4096
    v_lshrrev_b32 v4, 4, v2
    v_mul_lo_u32 v3, v4, s40
    v_lshlrev_b32 v4, 1, v4
    v_xor_b32 v4, v4, v2
    v_and_b32 v4, 15, v4
    v_lshl_add_u32 v3, v4, 4, v3
    s_mul_i32 s41, s25, 256
    s_mul_i32 s42, s28, 65536
    s_add_u32 s41, s41, s42
    v_xor_b32 v4, 128, v3
    s_add_u32 s42, s41, 0
    v_add_u32 v14, s42, v3
    s_add_u32 s42, s41, 16384
    v_add_u32 v15, s42, v3
    s_add_u32 s42, s41, 32768
    v_add_u32 v16, s42, v4
    s_add_u32 s42, s41, 49152
    v_add_u32 v17, s42, v4
    s_mul_i32 s36, s28, 4096
    s_mul_i32 s37, s28, 4096
    s_add_u32 s37, s37, 16384
    s_waitcnt lgkmcnt(0)
    s_add_u32 s4, s4, s97
    s_addc_u32 s5, s5, 0
    s_add_u32 s8, s4, 0x1100000
    s_addc_u32 s9, s5, 0
    s_mov_b32 s10, 0x800000
    s_mov_b32 s11, 0x20000
    s_mov_b32 s12, s30
    s_mov_b32 s13, s31
    s_mov_b32 s14, 0xe00000
    s_mov_b32 s15, 0x20000
    s_mov_b32 s32, 0
    s_mov_b32 s33, 0
g4_ld_pW:
    s_add_u32 s40, s32, s27
    s_and_b32 s40, s40, s95
    s_andn2_b32 s41, s32, s95
    s_or_b32 s40, s40, s41
    s_add_u32 s40, s40, s26
    s_mul_i32 s34, s40, 128
    s_mul_i32 s35, s40, 262144
    s_add_u32 s38, s33, s36
    s_add_u32 s39, s33, s37
    s_add_u32 m0, s39, 0
    s_nop 0
    buffer_load_dwordx4 v14, s[12:15], s35 offen lds
    s_add_u32 m0, s39, 1024
    s_nop 0
    buffer_load_dwordx4 v15, s[12:15], s35 offen lds
    s_add_u32 m0, s39, 2048
    s_nop 0
    buffer_load_dwordx4 v16, s[12:15], s35 offen lds
    s_add_u32 m0, s39, 3072
    s_nop 0
    buffer_load_dwordx4 v17, s[12:15], s35 offen lds
    s_add_u32 s33, s33, 32768
    s_add_u32 s32, s32, 1
    s_cmp_lt_u32 s32, 4
    s_cbranch_scc1 g4_ld_pW
    s_lshl_b32 s40, s24, 1
    s_add_u32 s40, s40, s91
    s_add_u32 s40, s40, 24
    s_lshl_b32 s40, s40, 8
    s_mov_b32 s42, 14336
    s_cmp_lg_u32 s28, 0
    s_cbranch_scc1 g4_dep_set
    s_add_u32 s84, s4, 0x300000
    s_addc_u32 s85, s5, 0
    s_mov_b32 s86, 0x4000
    s_mov_b32 s87, 0x20000
    v_cmp_gt_u32 vcc, 32, v2
    v_mov_b32 v21, s40
    v_mov_b32 v23, s42
    v_cndmask_b32 v21, v23, v21, vcc
    v_mov_b32 v22, 13
    v_mov_b32 v23, 31
    v_cndmask_b32 v22, v23, v22, vcc
    v_and_b32 v23, 31, v2
    v_min_u32 v23, v23, v22
    v_lshl_add_u32 v21, v23, 2, v21
    v_mov_b32 v22, 1
    buffer_load_dword v23, v21, s[84:87], 0 offen sc1
g4_dep_set:
    s_lshl_b32 s43, s96, 2
    s_add_u32 s43, s43, 4
    s_mov_b32 s41, 0x800000
    v_mov_b32 v24, 131072
    s_cmp_lg_u32 s28, 0
    s_cbranch_scc1 g4_dep_lds
    s_mov_b32 s41, 0x40000
    s_waitcnt vmcnt(0)
g4_dep:
    v_cmp_lt_u32 vcc, v23, v22
    s_sub_u32 s41, s41, 1
    s_cmp_eq_u32 s41, 0
    s_cbranch_scc1 g4_dep_seen
    s_cbranch_vccz g4_dep_seen
    s_sleep 2
    buffer_load_dword v23, v21, s[84:87], 0 offen sc1
    s_waitcnt vmcnt(0)
    s_branch g4_dep
g4_dep_seen:
    v_mov_b32 v23, s43
    ds_write_b32 v24, v23
    s_branch g4_dep_ok
g4_dep_lds:
    ds_read_b32 v23, v24
    s_sub_u32 s41, s41, 1
    s_waitcnt lgkmcnt(0)
    v_readfirstlane_b32 s40, v23
    s_cmp_eq_u32 s41, 0
    s_cbranch_scc1 g4_dep_ok
    s_cmp_eq_u32 s40, s43
    s_cbranch_scc1 g4_dep_ok
    s_sleep 1
    s_branch g4_dep_lds
g4_dep_ok:
    s_mov_b32 s32, 0
    s_mov_b32 s33, 0
g4_ld_pA:
    s_add_u32 s40, s32, s27
    s_and_b32 s40, s40, s95
    s_andn2_b32 s41, s32, s95
    s_or_b32 s40, s40, s41
    s_add_u32 s40, s40, s26
    s_mul_i32 s34, s40, 128
    s_mul_i32 s35, s40, 262144
    s_add_u32 s38, s33, s36
    s_add_u32 s39, s33, s37
    s_add_u32 m0, s38, 0
    s_nop 0
    buffer_load_dwordx4 v10, s[8:11], s34 offen sc1 lds
    s_add_u32 m0, s38, 1024
    s_nop 0
    buffer_load_dwordx4 v11, s[8:11], s34 offen sc1 lds
    s_add_u32 m0, s38, 2048
    s_nop 0
    buffer_load_dwordx4 v12, s[8:11], s34 offen sc1 lds
    s_add_u32 m0, s38, 3072
    s_nop 0
    buffer_load_dwordx4 v13, s[8:11], s34 offen sc1 lds
    s_add_u32 s33, s33, 32768
    s_add_u32 s32, s32, 1
    s_cmp_lt_u32 s32, 3
    s_cbranch_scc1 g4_ld_pA
    s_waitcnt vmcnt(8)
    s_barrier
    s_add_u32 s40, s32, s27
    s_and_b32 s40, s40, s95
    s_andn2_b32 s41, s32, s95
    s_or_b32 s40, s40, s41
    s_add_u32 s40, s40, s26
    s_mul_i32 s34, s40, 128
    s_mul_i32 s35, s40, 262144
    s_add_u32 s38, s33, s36
    s_add_u32 s39, s33, s37
    s_add_u32 m0, s38, 0
    s_nop 0
    buffer_load_dwordx4 v10, s[8:11], s34 offen sc1 lds
    s_add_u32 m0, s38, 1024
    s_nop 0
    buffer_load_dwordx4 v11, s[8:11], s34 offen sc1 lds
    s_add_u32 m0, s38, 2048
    s_nop 0
    buffer_load_dwordx4 v12, s[8:11], s34 offen sc1 lds
    s_add_u32 m0, s38, 3072
    s_nop 0
    buffer_load_dwordx4 v13, s[8:11], s34 offen sc1 lds
    s_mov_b32 s33, 0
    s_add_u32 s32, s32, 1
g4_ld_loop:
    s_cmp_eq_u32 s32, 4
    s_cbranch_scc1 g4_ld_s4
    s_cmp_eq_u32 s32, 5
    s_cbranch_scc1 g4_ld_s5
    s_waitcnt vmcnt(16)
g4_ld_bar:
    s_barrier
    s_add_u32 s40, s32, s27
    s_and_b32 s40, s40, s95
    s_andn2_b32 s41, s32, s95
    s_or_b32 s40, s40, s41
    s_add_u32 s40, s40, s26
    s_mul_i32 s34, s40, 128
    s_mul_i32 s35, s40, 262144
    s_add_u32 s38, s33, s36
    s_add_u32 s39, s33, s37
    s_add_u32 m0, s38, 0
    s_nop 0
    buffer_load_dwordx4 v10, s[8:11], s34 offen sc1 lds
    s_add_u32 m0, s38, 1024
    s_nop 0
    buffer_load_dwordx4 v11, s[8:11], s34 offen sc1 lds
    s_add_u32 m0, s38, 2048
    s_nop 0
    buffer_load_dwordx4 v12, s[8:11], s34 offen sc1 lds
    s_add_u32 m0, s38, 3072
    s_nop 0
    buffer_load_dwordx4 v13, s[8:11], s34 offen sc1 lds
    s_add_u32 m0, s39, 0
    s_nop 0
    buffer_load_dwordx4 v14, s[12:15], s35 offen lds
    s_add_u32 m0, s39, 1024
    s_nop 0
    buffer_load_dwordx4 v15, s[12:15], s35 offen lds
    s_add_u32 m0, s39, 2048
    s_nop 0
    buffer_load_dwordx4 v16, s[12:15], s35 offen lds
    s_add_u32 m0, s39, 3072
    s_nop 0
    buffer_load_dwordx4 v17, s[12:15], s35 offen lds
    s_add_u32 s33, s33, 32768
    s_add_u32 s32, s32, 1
    s_cmp_eq_u32 s33, 131072
    s_cselect_b32 s33, 0, s33
    s_cmp_lt_u32 s32, 28
    s_cbranch_scc1 g4_ld_loop
    s_waitcnt vmcnt(16)
    s_barrier
    s_waitcnt vmcnt(8)
    s_barrier
    s_waitcnt vmcnt(0)
    s_barrier
    s_branch g4_ld_end
g4_ld_s4:
    s_waitcnt vmcnt(8)
    s_branch g4_ld_bar
g4_ld_s5:
    s_waitcnt vmcnt(12)
    s_branch g4_ld_bar
g4_ld_end:
    s_cmp_lg_u32 s96, 0
    s_cbranch_scc1 g4_done
    s_barrier
    s_mov_b32 s96, 1
    s_mov_b32 s97, 0x2800000
    s_branch g1_in
g4_done:
    s_endpgm
g4_compute:
    v_lshrrev_b32 v5, 4, v2
    v_bfe_u32 v6, v2, 2, 2
    v_and_b32 v7, 3, v2
    v_and_b32 v8, 15, v2
    s_and_b32 s44, s28, 1
    s_lshr_b32 s45, s28, 1
    s_mul_i32 s40, s25, 128
    s_mul_i32 s41, s45, 64
    s_add_u32 s40, s40, s41
    s_lshl_b32 s41, s91, 5
    s_add_u32 s40, s40, s41
    v_add_u32 v20, s40, v8
    s_mov_b32 s41, 2048
    v_mul_lo_u32 v9, v20, s41
    s_mul_i32 s40, s24, 256
    s_mul_i32 s41, s44, 128
    s_add_u32 s46, s40, s41
    v_and_b32 v3, 1, v5
    v_lshlrev_b32 v3, 5, v3
    v_lshrrev_b32 v4, 1, v5
    v_lshl_add_u32 v3, v4, 4, v3
    v_add3_u32 v9, v9, v3, s46
    s_mov_b32 s52, 0
    s_mov_b32 s53, 32768
    s_mov_b32 s54, 65536
    s_mov_b32 s55, 98304
    s_waitcnt lgkmcnt(0)
    s_add_u32 s4, s4, s97
    s_addc_u32 s5, s5, 0
    s_add_u32 s20, s4, 0x800000
    s_addc_u32 s21, s5, 0
    s_mov_b32 s22, 0x400000
    s_mov_b32 s23, 0x20000
    s_mov_b32 s56, s34
    s_mov_b32 s57, s35
    s_mov_b32 s58, 0x1000
    s_mov_b32 s59, 0x20000
    s_add_u32 s16, s4, 0x4100000
    s_addc_u32 s17, s5, 0
    s_cmp_eq_u32 s96, 0
    s_cselect_b32 s16, s16, s6
    s_cselect_b32 s17, s17, s7
    s_mov_b32 s18, 0x400000
    s_mov_b32 s19, 0x20000
    s_add_u32 s60, s4, 0x2800000
    s_addc_u32 s61, s5, 0
    s_mov_b32 s62, 0x40000
    s_mov_b32 s63, 0x20000
    s_add_u32 s84, s4, 0x1d00000
    s_addc_u32 s85, s5, 0
    s_mov_b32 s86, 0x400000
    s_mov_b32 s87, 0x20000
    s_mul_i32 s42, s44, 64
    v_lshrrev_b32 v3, 1, v8
    v_xor_b32 v3, v3, v5
    v_lshlrev_b32 v3, 4, v3
    v_lshl_add_u32 v3, v8, 7, v3
    s_lshl_b32 s40, s42, 7
    s_add_u32 s40, s40, 0
    v_add_u32 v10, s40, v3
    v_xor_b32 v11, 64, v10
    s_lshl_b32 s90, s91, 1
    s_mul_i32 s42, s45, 4
    s_mov_b32 s43, 16384
    v_and_b32 v3, 1, v5
    v_lshl_or_b32 v3, v3, 2, v6
    s_add_u32 s40, s42, 0
    s_xor_b32 s40, s40, s90
    v_xor_b32 v3, s40, v3
    v_lshlrev_b32 v3, 5, v3
    v_lshl_add_u32 v3, v7, 3, v3
    v_lshl_add_u32 v4, v5, 3, v6
    v_lshl_add_u32 v3, v4, 8, v3
    v_add_u32 v12, s43, v3
    v_and_b32 v3, 1, v5
    v_lshl_or_b32 v3, v3, 2, v6
    s_add_u32 s40, s42, 1
    s_xor_b32 s40, s40, s90
    v_xor_b32 v3, s40, v3
    v_lshlrev_b32 v3, 5, v3
    v_lshl_add_u32 v3, v7, 3, v3
    v_lshl_add_u32 v4, v5, 3, v6
    v_lshl_add_u32 v3, v4, 8, v3
    v_add_u32 v13, s43, v3
    v_and_b32 v3, 1, v5
    v_lshl_or_b32 v3, v3, 2, v6
    s_add_u32 s40, s42, 2
    s_xor_b32 s40, s40, s90
    v_xor_b32 v3, s40, v3
    v_lshlrev_b32 v3, 5, v3
    v_lshl_add_u32 v3, v7, 3, v3
    v_lshl_add_u32 v4, v5, 3, v6
    v_lshl_add_u32 v3, v4, 8, v3
    v_add_u32 v14, s43, v3
    v_and_b32 v3, 1, v5
    v_lshl_or_b32 v3, v3, 2, v6
    s_add_u32 s40, s42, 3
    s_xor_b32 s40, s40, s90
    v_xor_b32 v3, s40, v3
    v_lshlrev_b32 v3, 5, v3
    v_lshl_add_u32 v3, v7, 3, v3
    v_lshl_add_u32 v4, v5, 3, v6
    v_lshl_add_u32 v3, v4, 8, v3
    v_add_u32 v15, s43, v3
    s_mov_b32 s48, 28
    s_mov_b32 s50, 0
    s_mov_b32 s51, 32768
    s_mov_b32 s29, 0xfffe8000
    s_lshl_b32 s40, s28, 12
    v_lshl_add_u32 v21, v2, 4, s40
    s_lshl_b32 s93, s92, 1
    s_add_u32 s93, s93, s91
    s_lshl_b32 s93, s93, 14
    s_xor_b32 s94, s93, 0x4000
    v_mov_b32 v28, 0
    v_mov_b32 v29, 0
    v_mov_b32 v30, 0
    v_mov_b32 v31, 0
    v_mov_b32 v32, 0
    v_mov_b32 v33, 0
    v_mov_b32 v34, 0
    v_mov_b32 v35, 0
    v_mov_b32 v36, 0
    v_mov_b32 v37, 0
    v_mov_b32 v38, 0
    v_mov_b32 v39, 0
    v_mov_b32 v40, 0
    v_mov_b32 v41, 0
    v_mov_b32 v42, 0
    v_mov_b32 v43, 0
    v_mov_b32 v44, 0
    v_mov_b32 v45, 0
    v_mov_b32 v46, 0
    v_mov_b32 v47, 0
    v_mov_b32 v48, 0
    v_mov_b32 v49, 0
    v_mov_b32 v50, 0
    v_mov_b32 v51, 0
    v_mov_b32 v52, 0
    v_mov_b32 v53, 0
    v_mov_b32 v54, 0
    v_mov_b32 v55, 0
    v_mov_b32 v56, 0
    v_mov_b32 v57, 0
    v_mov_b32 v58, 0
    v_mov_b32 v59, 0
    v_mov_b32 v60, 0
    v_mov_b32 v61, 0
    v_mov_b32 v62, 0
    v_mov_b32 v63, 0
    v_mov_b32 v64, 0
    v_mov_b32 v65, 0
    v_mov_b32 v66, 0
    v_mov_b32 v67, 0
    v_mov_b32 v68, 0
    v_mov_b32 v69, 0
    v_mov_b32 v70, 0
    v_mov_b32 v71, 0
    v_mov_b32 v72, 0
    v_mov_b32 v73, 0
    v_mov_b32 v74, 0
    v_mov_b32 v75, 0
    v_mov_b32 v76, 0
    v_mov_b32 v77, 0
    v_mov_b32 v78, 0
    v_mov_b32 v79, 0
    v_mov_b32 v80, 0
    v_mov_b32 v81, 0
    v_mov_b32 v82, 0
    v_mov_b32 v83, 0
    v_mov_b32 v84, 0
    v_mov_b32 v85, 0
    v_mov_b32 v86, 0
    v_mov_b32 v87, 0
    v_mov_b32 v88, 0
    v_mov_b32 v89, 0
    v_mov_b32 v90, 0
    v_mov_b32 v91, 0
    s_barrier
    ds_read_b128 v[92:95], v10 offset:0
    ds_read_b64_tr_b16 v[108:109], v12 offset:0
    ds_read_b64_tr_b16 v[110:111], v12 offset:1024
    ds_read_b64_tr_b16 v[112:113], v13 offset:0
    ds_read_b64_tr_b16 v[114:115], v13 offset:1024
    ds_read_b64_tr_b16 v[116:117], v14 offset:0
    ds_read_b64_tr_b16 v[118:119], v14 offset:1024
    ds_read_b64_tr_b16 v[120:121], v15 offset:0
    ds_read_b64_tr_b16 v[122:123], v15 offset:1024
    ds_read_b128 v[96:99], v10 offset:2048
    ds_read_b128 v[100:103], v10 offset:4096
    ds_read_b128 v[104:107], v10 offset:6144
    buffer_load_dwordx4 v[188:191], v9, s[20:23], s52 offen offset:0 sc1
    buffer_load_dwordx4 v[192:195], v9, s[20:23], s52 offen offset:64 sc1
    buffer_load_dwordx4 v[196:199], v9, s[20:23], s53 offen offset:0 sc1
    buffer_load_dwordx4 v[200:203], v9, s[20:23], s53 offen offset:64 sc1
    v_lshlrev_b32 v3, 1, v20
    buffer_load_ushort v22, v3, s[56:59], 0 offen offset:0
    buffer_load_ushort v23, v3, s[56:59], 0 offen offset:32
    s_branch g4_cloop3
.p2align 3
g4_cloop:
    s_barrier
g4_cloop2:
    v_mfma_f32_16x16x32_bf16 v[28:31], v[124:127], v[140:143], v[28:31]
    ds_read_b128 v[92:95], v10 offset:0
    v_mfma_f32_16x16x32_bf16 v[32:35], v[124:127], v[144:147], v[32:35]
    ds_read_b64_tr_b16 v[108:109], v12 offset:0
    ds_read_b64_tr_b16 v[110:111], v12 offset:1024
    v_mfma_f32_16x16x32_bf16 v[36:39], v[124:127], v[148:151], v[36:39]
    ds_read_b64_tr_b16 v[112:113], v13 offset:0
    ds_read_b64_tr_b16 v[114:115], v13 offset:1024
    v_mfma_f32_16x16x32_bf16 v[40:43], v[124:127], v[152:155], v[40:43]
    ds_read_b64_tr_b16 v[116:117], v14 offset:0
    ds_read_b64_tr_b16 v[118:119], v14 offset:1024
    v_mfma_f32_16x16x32_bf16 v[56:59], v[128:131], v[152:155], v[56:59]
    ds_read_b64_tr_b16 v[120:121], v15 offset:0
    ds_read_b64_tr_b16 v[122:123], v15 offset:1024
    v_mfma_f32_16x16x32_bf16 v[52:55], v[128:131], v[148:151], v[52:55]
    ds_read_b128 v[96:99], v10 offset:2048
    v_mfma_f32_16x16x32_bf16 v[48:51], v[128:131], v[144:147], v[48:51]
    ds_read_b128 v[100:103], v10 offset:4096
    v_mfma_f32_16x16x32_bf16 v[44:47], v[128:131], v[140:143], v[44:47]
    ds_read_b128 v[104:107], v10 offset:6144
    v_mfma_f32_16x16x32_bf16 v[60:63], v[132:135], v[140:143], v[60:63]
    v_mfma_f32_16x16x32_bf16 v[64:67], v[132:135], v[144:147], v[64:67]
    v_mfma_f32_16x16x32_bf16 v[68:71], v[132:135], v[148:151], v[68:71]
    v_mfma_f32_16x16x32_bf16 v[72:75], v[132:135], v[152:155], v[72:75]
    v_mfma_f32_16x16x32_bf16 v[88:91], v[136:139], v[152:155], v[88:91]
    v_mfma_f32_16x16x32_bf16 v[84:87], v[136:139], v[148:151], v[84:87]
    v_mfma_f32_16x16x32_bf16 v[80:83], v[136:139], v[144:147], v[80:83]
    v_mfma_f32_16x16x32_bf16 v[76:79], v[136:139], v[140:143], v[76:79]
g4_cloop3:
    s_waitcnt lgkmcnt(0)
    v_mfma_f32_16x16x32_bf16 v[28:31], v[92:95], v[108:111], v[28:31]
    ds_read_b128 v[124:127], v11 offset:0
    v_mfma_f32_16x16x32_bf16 v[32:35], v[92:95], v[112:115], v[32:35]
    ds_read_b64_tr_b16 v[140:141], v12 offset:8192
    ds_read_b64_tr_b16 v[142:143], v12 offset:9216
    v_mfma_f32_16x16x32_bf16 v[36:39], v[92:95], v[116:119], v[36:39]
    ds_read_b64_tr_b16 v[144:145], v13 offset:8192
    ds_read_b64_tr_b16 v[146:147], v13 offset:9216
    v_mfma_f32_16x16x32_bf16 v[40:43], v[92:95], v[120:123], v[40:43]
    ds_read_b64_tr_b16 v[148:149], v14 offset:8192
    ds_read_b64_tr_b16 v[150:151], v14 offset:9216
    v_mfma_f32_16x16x32_bf16 v[56:59], v[96:99], v[120:123], v[56:59]
    ds_read_b64_tr_b16 v[152:153], v15 offset:8192
    ds_read_b64_tr_b16 v[154:155], v15 offset:9216
    v_mfma_f32_16x16x32_bf16 v[52:55], v[96:99], v[116:119], v[52:55]
    ds_read_b128 v[128:131], v11 offset:2048
    v_mfma_f32_16x16x32_bf16 v[48:51], v[96:99], v[112:115], v[48:51]
    ds_read_b128 v[132:135], v11 offset:4096
    v_mfma_f32_16x16x32_bf16 v[44:47], v[96:99], v[108:111], v[44:47]
    ds_read_b128 v[136:139], v11 offset:6144
    v_mfma_f32_16x16x32_bf16 v[60:63], v[100:103], v[108:111], v[60:63]
    s_add_u32 s50, s50, 1
    s_cmp_eq_u32 s50, 4
    v_mfma_f32_16x16x32_bf16 v[64:67], v[100:103], v[112:115], v[64:67]
    s_cselect_b32 s49, s29, s51
    s_cselect_b32 s50, 0, s50
    v_mfma_f32_16x16x32_bf16 v[68:71], v[100:103], v[116:119], v[68:71]
    v_add_u32 v10, s49, v10
    v_add_u32 v11, s49, v11
    v_mfma_f32_16x16x32_bf16 v[72:75], v[100:103], v[120:123], v[72:75]
    v_add_u32 v12, s49, v12
    v_add_u32 v13, s49, v13
    v_mfma_f32_16x16x32_bf16 v[88:91], v[104:107], v[120:123], v[88:91]
    v_add_u32 v14, s49, v14
    v_add_u32 v15, s49, v15
    v_mfma_f32_16x16x32_bf16 v[84:87], v[104:107], v[116:119], v[84:87]
    s_sub_u32 s48, s48, 1
    s_cmp_lg_u32 s48, 0
    v_mfma_f32_16x16x32_bf16 v[80:83], v[104:107], v[112:115], v[80:83]
    v_mfma_f32_16x16x32_bf16 v[76:79], v[104:107], v[108:111], v[76:79]
    s_waitcnt lgkmcnt(0)
    s_cbranch_scc1 g4_cloop
    v_mfma_f32_16x16x32_bf16 v[36:39], v[124:127], v[148:151], v[36:39]
    v_mfma_f32_16x16x32_bf16 v[52:55], v[128:131], v[148:151], v[52:55]
    v_mfma_f32_16x16x32_bf16 v[68:71], v[132:135], v[148:151], v[68:71]
    v_mfma_f32_16x16x32_bf16 v[84:87], v[136:139], v[148:151], v[84:87]
    v_mfma_f32_16x16x32_bf16 v[40:43], v[124:127], v[152:155], v[40:43]
    v_mfma_f32_16x16x32_bf16 v[56:59], v[128:131], v[152:155], v[56:59]
    v_mfma_f32_16x16x32_bf16 v[72:75], v[132:135], v[152:155], v[72:75]
    v_mfma_f32_16x16x32_bf16 v[88:91], v[136:139], v[152:155], v[88:91]
    v_mfma_f32_16x16x32_bf16 v[28:31], v[124:127], v[140:143], v[28:31]
    v_cvt_pk_bf16_f32 v156, v36, v37
    v_cvt_pk_bf16_f32 v157, v38, v39
    v_mfma_f32_16x16x32_bf16 v[44:47], v[128:131], v[140:143], v[44:47]
    v_cvt_pk_bf16_f32 v158, v52, v53
    v_cvt_pk_bf16_f32 v159, v54, v55
    buffer_store_dwordx4 v[156:159], v21, s[84:87], s93 offen offset:0 sc1
    v_mfma_f32_16x16x32_bf16 v[60:63], v[132:135], v[140:143], v[60:63]
    v_cvt_pk_bf16_f32 v160, v68, v69
    v_cvt_pk_bf16_f32 v161, v70, v71
    v_mfma_f32_16x16x32_bf16 v[76:79], v[136:139], v[140:143], v[76:79]
    v_cvt_pk_bf16_f32 v162, v84, v85
    v_cvt_pk_bf16_f32 v163, v86, v87
    buffer_store_dwordx4 v[160:163], v21, s[84:87], s93 offen offset:1024 sc1
    v_mfma_f32_16x16x32_bf16 v[32:35], v[124:127], v[144:147], v[32:35]
    v_cvt_pk_bf16_f32 v164, v40, v41
    v_cvt_pk_bf16_f32 v165, v42, v43
    v_mfma_f32_16x16x32_bf16 v[48:51], v[128:131], v[144:147], v[48:51]
    v_cvt_pk_bf16_f32 v166, v56, v57
    v_cvt_pk_bf16_f32 v167, v58, v59
    buffer_store_dwordx4 v[164:167], v21, s[84:87], s93 offen offset:2048 sc1
    v_mfma_f32_16x16x32_bf16 v[64:67], v[132:135], v[144:147], v[64:67]
    v_cvt_pk_bf16_f32 v168, v72, v73
    v_cvt_pk_bf16_f32 v169, v74, v75
    v_mfma_f32_16x16x32_bf16 v[80:83], v[136:139], v[144:147], v[80:83]
    s_nop 1
    v_cvt_pk_bf16_f32 v170, v88, v89
    v_cvt_pk_bf16_f32 v171, v90, v91
    buffer_store_dwordx4 v[168:171], v21, s[84:87], s93 offen offset:3072 sc1
    s_mov_b32 s48, 0x40000
    buffer_load_dwordx4 v[172:175], v21, s[84:87], s94 offen offset:0 sc1
    buffer_load_dwordx4 v[176:179], v21, s[84:87], s94 offen offset:1024 sc1
    buffer_load_dwordx4 v[180:183], v21, s[84:87], s94 offen offset:2048 sc1
    buffer_load_dwordx4 v[184:187], v21, s[84:87], s94 offen offset:3072 sc1
    s_waitcnt vmcnt(8)
    s_nop 3
    v_permlane16_swap_b32 v188, v190
    v_permlane16_swap_b32 v189, v191
    v_permlane16_swap_b32 v192, v194
    v_permlane16_swap_b32 v193, v195
    v_permlane16_swap_b32 v196, v198
    v_permlane16_swap_b32 v197, v199
    v_permlane16_swap_b32 v200, v202
    v_permlane16_swap_b32 v201, v203
    v_lshlrev_b32 v22, 16, v22
    v_lshlrev_b32 v23, 16, v23
    v_lshlrev_b32 v204, 16, v188
    v_and_b32 v205, 0xffff0000, v188
    v_lshlrev_b32 v206, 16, v189
    v_and_b32 v207, 0xffff0000, v189
    v_lshlrev_b32 v208, 16, v190
    v_and_b32 v209, 0xffff0000, v190
    v_lshlrev_b32 v210, 16, v191
    v_and_b32 v211, 0xffff0000, v191
    v_add_f32 v204, v204, v22
    v_add_f32 v205, v205, v22
    v_add_f32 v206, v206, v22
    v_add_f32 v207, v207, v22
    v_add_f32 v208, v208, v22
    v_add_f32 v209, v209, v22
    v_add_f32 v210, v210, v22
    v_add_f32 v211, v211, v22
    v_pk_add_f32 v[28:29], v[28:29], v[204:205]
    v_pk_add_f32 v[30:31], v[30:31], v[206:207]
    v_pk_add_f32 v[44:45], v[44:45], v[208:209]
    v_pk_add_f32 v[46:47], v[46:47], v[210:211]
    v_lshlrev_b32 v204, 16, v192
    v_and_b32 v205, 0xffff0000, v192
    v_lshlrev_b32 v206, 16, v193
    v_and_b32 v207, 0xffff0000, v193
    v_lshlrev_b32 v208, 16, v194
    v_and_b32 v209, 0xffff0000, v194
    v_lshlrev_b32 v210, 16, v195
    v_and_b32 v211, 0xffff0000, v195
    v_add_f32 v204, v204, v22
    v_add_f32 v205, v205, v22
    v_add_f32 v206, v206, v22
    v_add_f32 v207, v207, v22
    v_add_f32 v208, v208, v22
    v_add_f32 v209, v209, v22
    v_add_f32 v210, v210, v22
    v_add_f32 v211, v211, v22
    v_pk_add_f32 v[60:61], v[60:61], v[204:205]
    v_pk_add_f32 v[62:63], v[62:63], v[206:207]
    v_pk_add_f32 v[76:77], v[76:77], v[208:209]
    v_pk_add_f32 v[78:79], v[78:79], v[210:211]
    v_lshlrev_b32 v204, 16, v196
    v_and_b32 v205, 0xffff0000, v196
    v_lshlrev_b32 v206, 16, v197
    v_and_b32 v207, 0xffff0000, v197
    v_lshlrev_b32 v208, 16, v198
    v_and_b32 v209, 0xffff0000, v198
    v_lshlrev_b32 v210, 16, v199
    v_and_b32 v211, 0xffff0000, v199
    v_add_f32 v204, v204, v23
    v_add_f32 v205, v205, v23
    v_add_f32 v206, v206, v23
    v_add_f32 v207, v207, v23
    v_add_f32 v208, v208, v23
    v_add_f32 v209, v209, v23
    v_add_f32 v210, v210, v23
    v_add_f32 v211, v211, v23
    v_pk_add_f32 v[32:33], v[32:33], v[204:205]
    v_pk_add_f32 v[34:35], v[34:35], v[206:207]
    v_pk_add_f32 v[48:49], v[48:49], v[208:209]
    v_pk_add_f32 v[50:51], v[50:51], v[210:211]
    v_lshlrev_b32 v204, 16, v200
    v_and_b32 v205, 0xffff0000, v200
    v_lshlrev_b32 v206, 16, v201
    v_and_b32 v207, 0xffff0000, v201
    v_lshlrev_b32 v208, 16, v202
    v_and_b32 v209, 0xffff0000, v202
    v_lshlrev_b32 v210, 16, v203
    v_and_b32 v211, 0xffff0000, v203
    v_add_f32 v204, v204, v23
    v_add_f32 v205, v205, v23
    v_add_f32 v206, v206, v23
    v_add_f32 v207, v207, v23
    v_add_f32 v208, v208, v23
    v_add_f32 v209, v209, v23
    v_add_f32 v210, v210, v23
    v_add_f32 v211, v211, v23
    v_pk_add_f32 v[64:65], v[64:65], v[204:205]
    v_pk_add_f32 v[66:67], v[66:67], v[206:207]
    v_pk_add_f32 v[80:81], v[80:81], v[208:209]
    v_pk_add_f32 v[82:83], v[82:83], v[210:211]
    s_waitcnt vmcnt(0)
g4_rcv:
    v_max3_u32 v4, v172, v173, v174
    v_max3_u32 v4, v4, v175, v176
    v_max3_u32 v4, v4, v177, v178
    v_max3_u32 v4, v4, v179, v180
    v_max3_u32 v4, v4, v181, v182
    v_max3_u32 v4, v4, v183, v184
    v_max3_u32 v4, v4, v185, v186
    v_max_u32 v4, v4, v187
    v_cmp_eq_u32 vcc, -1, v4
    s_sub_u32 s48, s48, 1
    s_cmp_eq_u32 s48, 0
    s_cbranch_scc1 g4_rcvd
    s_cbranch_vccz g4_rcvd
    s_sleep 2
    buffer_load_dwordx4 v[172:175], v21, s[84:87], s94 offen offset:0 sc1
    buffer_load_dwordx4 v[176:179], v21, s[84:87], s94 offen offset:1024 sc1
    buffer_load_dwordx4 v[180:183], v21, s[84:87], s94 offen offset:2048 sc1
    buffer_load_dwordx4 v[184:187], v21, s[84:87], s94 offen offset:3072 sc1
    s_waitcnt vmcnt(0)
    s_branch g4_rcv
g4_rcvd:
    v_lshlrev_b32 v108, 16, v172
    v_and_b32 v109, 0xffff0000, v172
    v_lshlrev_b32 v110, 16, v173
    v_and_b32 v111, 0xffff0000, v173
    v_pk_add_f32 v[28:29], v[28:29], v[108:109]
    v_pk_add_f32 v[30:31], v[30:31], v[110:111]
    v_lshlrev_b32 v112, 16, v174
    v_and_b32 v113, 0xffff0000, v174
    v_lshlrev_b32 v114, 16, v175
    v_and_b32 v115, 0xffff0000, v175
    v_pk_add_f32 v[44:45], v[44:45], v[112:113]
    v_pk_add_f32 v[46:47], v[46:47], v[114:115]
    v_lshlrev_b32 v116, 16, v176
    v_and_b32 v117, 0xffff0000, v176
    v_lshlrev_b32 v118, 16, v177
    v_and_b32 v119, 0xffff0000, v177
    v_pk_add_f32 v[60:61], v[60:61], v[116:117]
    v_pk_add_f32 v[62:63], v[62:63], v[118:119]
    v_lshlrev_b32 v120, 16, v178
    v_and_b32 v121, 0xffff0000, v178
    v_lshlrev_b32 v122, 16, v179
    v_and_b32 v123, 0xffff0000, v179
    v_pk_add_f32 v[76:77], v[76:77], v[120:121]
    v_pk_add_f32 v[78:79], v[78:79], v[122:123]
    v_lshlrev_b32 v108, 16, v180
    v_and_b32 v109, 0xffff0000, v180
    v_lshlrev_b32 v110, 16, v181
    v_and_b32 v111, 0xffff0000, v181
    v_pk_add_f32 v[32:33], v[32:33], v[108:109]
    v_pk_add_f32 v[34:35], v[34:35], v[110:111]
    v_lshlrev_b32 v112, 16, v182
    v_and_b32 v113, 0xffff0000, v182
    v_lshlrev_b32 v114, 16, v183
    v_and_b32 v115, 0xffff0000, v183
    v_pk_add_f32 v[48:49], v[48:49], v[112:113]
    v_pk_add_f32 v[50:51], v[50:51], v[114:115]
    v_lshlrev_b32 v116, 16, v184
    v_and_b32 v117, 0xffff0000, v184
    v_lshlrev_b32 v118, 16, v185
    v_and_b32 v119, 0xffff0000, v185
    v_pk_add_f32 v[64:65], v[64:65], v[116:117]
    v_pk_add_f32 v[66:67], v[66:67], v[118:119]
    v_lshlrev_b32 v120, 16, v186
    v_and_b32 v121, 0xffff0000, v186
    v_lshlrev_b32 v122, 16, v187
    v_and_b32 v123, 0xffff0000, v187
    v_pk_add_f32 v[80:81], v[80:81], v[120:121]
    v_pk_add_f32 v[82:83], v[82:83], v[122:123]
    v_cvt_pk_bf16_f32 v92, v28, v29
    v_cvt_pk_bf16_f32 v93, v30, v31
    v_cvt_pk_bf16_f32 v94, v44, v45
    v_cvt_pk_bf16_f32 v95, v46, v47
    s_nop 1
    v_permlane16_swap_b32 v92, v94
    v_permlane16_swap_b32 v93, v95
    buffer_store_dwordx4 v[92:95], v9, s[16:19], s52 offen offset:0 sc1
    v_cvt_pk_bf16_f32 v96, v60, v61
    v_cvt_pk_bf16_f32 v97, v62, v63
    v_cvt_pk_bf16_f32 v98, v76, v77
    v_cvt_pk_bf16_f32 v99, v78, v79
    s_nop 1
    v_permlane16_swap_b32 v96, v98
    v_permlane16_swap_b32 v97, v99
    buffer_store_dwordx4 v[96:99], v9, s[16:19], s52 offen offset:64 sc1
    v_cvt_pk_bf16_f32 v100, v32, v33
    v_cvt_pk_bf16_f32 v101, v34, v35
    v_cvt_pk_bf16_f32 v102, v48, v49
    v_cvt_pk_bf16_f32 v103, v50, v51
    s_nop 1
    v_permlane16_swap_b32 v100, v102
    v_permlane16_swap_b32 v101, v103
    buffer_store_dwordx4 v[100:103], v9, s[16:19], s53 offen offset:0 sc1
    v_cvt_pk_bf16_f32 v104, v64, v65
    v_cvt_pk_bf16_f32 v105, v66, v67
    v_cvt_pk_bf16_f32 v106, v80, v81
    v_cvt_pk_bf16_f32 v107, v82, v83
    s_nop 1
    v_permlane16_swap_b32 v104, v106
    v_permlane16_swap_b32 v105, v107
    buffer_store_dwordx4 v[104:107], v9, s[16:19], s53 offen offset:64 sc1
    v_pk_add_f32 v[108:109], v[28:29], v[30:31]
    v_pk_mul_f32 v[110:111], v[28:29], v[28:29]
    v_pk_fma_f32 v[110:111], v[30:31], v[30:31], v[110:111]
    v_pk_add_f32 v[108:109], v[108:109], v[44:45]
    v_pk_fma_f32 v[110:111], v[44:45], v[44:45], v[110:111]
    v_pk_add_f32 v[108:109], v[108:109], v[46:47]
    v_pk_fma_f32 v[110:111], v[46:47], v[46:47], v[110:111]
    v_pk_add_f32 v[108:109], v[108:109], v[60:61]
    v_pk_fma_f32 v[110:111], v[60:61], v[60:61], v[110:111]
    v_pk_add_f32 v[108:109], v[108:109], v[62:63]
    v_pk_fma_f32 v[110:111], v[62:63], v[62:63], v[110:111]
    v_pk_add_f32 v[108:109], v[108:109], v[76:77]
    v_pk_fma_f32 v[110:111], v[76:77], v[76:77], v[110:111]
    v_pk_add_f32 v[108:109], v[108:109], v[78:79]
    v_pk_fma_f32 v[110:111], v[78:79], v[78:79], v[110:111]
    v_pk_add_f32 v[112:113], v[32:33], v[34:35]
    v_pk_mul_f32 v[114:115], v[32:33], v[32:33]
    v_pk_fma_f32 v[114:115], v[34:35], v[34:35], v[114:115]
    v_pk_add_f32 v[112:113], v[112:113], v[48:49]
    v_pk_fma_f32 v[114:115], v[48:49], v[48:49], v[114:115]
    v_pk_add_f32 v[112:113], v[112:113], v[50:51]
    v_pk_fma_f32 v[114:115], v[50:51], v[50:51], v[114:115]
    v_pk_add_f32 v[112:113], v[112:113], v[64:65]
    v_pk_fma_f32 v[114:115], v[64:65], v[64:65], v[114:115]
    v_pk_add_f32 v[112:113], v[112:113], v[66:67]
    v_pk_fma_f32 v[114:115], v[66:67], v[66:67], v[114:115]
    v_pk_add_f32 v[112:113], v[112:113], v[80:81]
    v_pk_fma_f32 v[114:115], v[80:81], v[80:81], v[114:115]
    v_pk_add_f32 v[112:113], v[112:113], v[82:83]
    v_pk_fma_f32 v[114:115], v[82:83], v[82:83], v[114:115]
    v_add_f32 v108, v108, v109
    v_add_f32 v109, v110, v111
    v_add_f32 v112, v112, v113
    v_add_f32 v113, v114, v115
    s_nop 1
    v_permlane16_swap_b32 v108, v112
    v_permlane16_swap_b32 v109, v113
    v_pk_add_f32 v[108:109], v[108:109], v[112:113]
    v_mov_b32 v116, v108
    v_mov_b32 v117, v109
    v_and_b32 v3, 16, v2
    v_add_u32 v3, v3, v20
    v_permlane32_swap_b32 v108, v116
    v_permlane32_swap_b32 v109, v117
    v_pk_add_f32 v[108:109], v[108:109], v[116:117]
    v_lshlrev_b32 v3, 3, v3
    s_mul_i32 s40, s24, 2
    s_add_u32 s40, s40, s44
    s_lshl_b32 s40, s40, 14
    s_mov_b32 exec_hi, 0
    buffer_store_dwordx2 v[108:109], v3, s[60:63], s40 offen sc1
    s_mov_b32 exec_hi, -1
    s_cmp_lg_u32 s96, 0
    s_cbranch_scc1 g4_done
    s_lshr_b32 s40, s25, 0
    s_add_u32 s40, s40, 40
    s_lshl_b32 s40, s40, 8
    s_mov_b32 s42, s40
    s_lshl_b32 s41, s24, 1
    s_add_u32 s41, s41, s91
    s_add_u32 s84, s4, 0x2b00000
    s_addc_u32 s85, s5, 0
    s_mov_b32 s86, 0x4000
    s_mov_b32 s87, 0x20000
    s_lshl_b32 s41, s41, 2
    s_add_u32 s40, s40, s41
    v_mov_b32 v3, s40
    v_mov_b32 v4, 1
    s_waitcnt vmcnt(0)
    s_barrier
    s_cmp_lg_u32 s28, 0
    s_cbranch_scc1 g4_cin
    s_mov_b64 exec, 1
    buffer_store_dword v4, v3, s[84:87], 0 offen sc1
    s_mov_b64 exec, -1
g4_cin:
    s_mov_b32 s96, 1
    s_mov_b32 s97, 0x2800000
    s_branch g1_in
code_end:
.section .rodata,"a"
.p2align 6
.amdhsa_kernel g1a_kernel
  .amdhsa_next_free_vgpr 248
  .amdhsa_next_free_sgpr 100
  .amdhsa_accum_offset 248
  .amdhsa_group_segment_fixed_size 0
  .amdhsa_kernarg_size 88
  .amdhsa_user_sgpr_count 2
  .amdhsa_user_sgpr_kernarg_segment_ptr 1
  .amdhsa_system_sgpr_workgroup_id_x 1
.end_amdhsa_kernel
```

```asm
; @launch kernel=g1a_kernel grid=(256,1,1) block=(512,1,1) lds=131328
.amdgcn_target "amdgcn-amd-amdhsa--gfx950"
.text
.globl g1a_kernel
.p2align 8
.type g1a_kernel,@function
g1a_kernel:
    s_mov_b32 s96, 0
    s_mov_b32 s97, 0x0
    v_mov_b32 v1, 131072
    v_mov_b32 v2, 0
    ds_write_b32 v1, v2
    s_branch g1_in
.p2align 6
g1_in:
    s_cmp_ge_u32 s2, 256
    s_cbranch_scc1 g1_done
    s_load_dwordx2 s[4:5], s[0:1], 80
    s_load_dwordx2 s[6:7], s[0:1], 0
    s_xor_b32 s53, s96, 1
    s_load_dwordx2 s[30:31], s[0:1], 8
    s_load_dwordx2 s[16:17], s[0:1], 72
    s_load_dwordx2 s[18:19], s[0:1], 16
    v_lshrrev_b32 v1, 6, v0
    v_and_b32 v2, 63, v0
    s_and_b32 s40, s2, 1
    s_lshl_b32 s40, s40, 3
    s_bfe_u32 s41, s2, 0x30003
    s_add_u32 s25, s40, s41
    s_bfe_u32 s40, s2, 0x20001
    s_lshl_b32 s40, s40, 2
    s_lshr_b32 s42, s2, 6
    s_add_u32 s24, s40, s42
    s_add_u32 s27, s41, s42
    s_add_u32 s52, s24, s25
    s_and_b32 s52, s52, 15
    s_and_b32 s26, s52, 12
    s_mul_i32 s26, s26, s53
    v_readfirstlane_b32 s28, v1
    v_lshrrev_b32 v5, 4, v2
    v_bfe_u32 v6, v2, 2, 2
    v_and_b32 v7, 3, v2
    v_and_b32 v8, 15, v2
    s_cmp_lt_u32 s28, 4
    s_cbranch_scc1 g1_compute
    s_sub_u32 s28, s28, 4
    s_mov_b32 s40, 2048
    v_lshrrev_b32 v3, 3, v2
    v_mul_lo_u32 v3, v3, s40
    v_lshrrev_b32 v4, 4, v2
    v_xor_b32 v4, v4, v2
    v_and_b32 v4, 7, v4
    v_lshl_add_u32 v3, v4, 4, v3
    s_mul_i32 s41, s25, 262144
    s_mul_i32 s42, s28, 65536
    s_add_u32 s41, s41, s42
    v_xor_b32 v4, 64, v3
    s_add_u32 s42, s41, 0
    v_add_u32 v16, s42, v3
    s_add_u32 s42, s41, 16384
    v_add_u32 v17, s42, v4
    s_add_u32 s42, s41, 32768
    v_add_u32 v18, s42, v3
    s_add_u32 s42, s41, 49152
    v_add_u32 v19, s42, v4
    s_mov_b32 s40, 6144
    v_lshrrev_b32 v3, 3, v2
    v_mul_lo_u32 v3, v3, s40
    v_bfe_u32 v4, v2, 4, 1
    v_lshlrev_b32 v4, 1, v4
    v_xor_b32 v4, v4, v2
    v_and_b32 v4, 7, v4
    v_lshl_add_u32 v3, v4, 4, v3
    s_mul_i32 s41, s24, 128
    s_mul_i32 s42, s28, 98304
    s_add_u32 s41, s41, s42
    v_xor_b32 v4, 64, v3
    s_add_u32 s42, s41, 0
    v_add_u32 v10, s42, v3
    s_add_u32 s42, s41, 49152
    v_add_u32 v11, s42, v4
    s_mov_b32 s40, 6144
    v_lshrrev_b32 v3, 3, v2
    v_mul_lo_u32 v3, v3, s40
    v_bfe_u32 v4, v2, 4, 1
    v_lshlrev_b32 v4, 1, v4
    v_xor_b32 v4, v4, v2
    v_and_b32 v4, 7, v4
    v_lshl_add_u32 v3, v4, 4, v3
    s_mul_i32 s41, s24, 128
    s_mul_i32 s42, s28, 98304
    s_add_u32 s41, s41, s42
    v_xor_b32 v4, 64, v3
    s_add_u32 s42, s41, 2048
    v_add_u32 v12, s42, v3
    s_add_u32 s42, s41, 51200
    v_add_u32 v13, s42, v4
    s_mov_b32 s40, 6144
    v_lshrrev_b32 v3, 3, v2
    v_mul_lo_u32 v3, v3, s40
    v_bfe_u32 v4, v2, 4, 1
    v_lshlrev_b32 v4, 1, v4
    v_xor_b32 v4, v4, v2
    v_and_b32 v4, 7, v4
    v_lshl_add_u32 v3, v4, 4, v3
    s_mul_i32 s41, s24, 128
    s_mul_i32 s42, s28, 98304
    s_add_u32 s41, s41, s42
    v_xor_b32 v4, 64, v3
    s_add_u32 s42, s41, 4096
    v_add_u32 v14, s42, v3
    s_add_u32 s42, s41, 53248
    v_add_u32 v15, s42, v4
    v_lshrrev_b32 v3, 3, v2
    s_lshl_b32 s40, s28, 2
    v_add_u32 v3, s40, v3
    v_lshrrev_b32 v4, 1, v3
    v_xor_b32 v4, v4, v2
    v_and_b32 v4, 7, v4
    s_lshl_b32 s40, s25, 7
    s_sub_u32 s40, s40, 16
    v_add_u32 v3, s40, v3
    v_max_i32 v3, 0, v3
    v_lshlrev_b32 v3, 11, v3
    v_lshl_add_u32 v20, v4, 4, v3
    s_mul_i32 s36, s28, 2048
    s_mul_i32 s37, s28, 4096
    s_add_u32 s37, s37, 26624
    s_mul_i32 s46, s28, 512
    s_add_u32 s46, s46, 24576
    s_waitcnt lgkmcnt(0)
    s_mov_b32 s8, s30
    s_mov_b32 s9, s31
    s_mov_b32 s10, 0x600000
    s_mov_b32 s11, 0x20000
    s_add_u32 s56, s4, 0x100000
    s_addc_u32 s57, s5, 0
    s_mov_b32 s58, 0x30000
    s_mov_b32 s59, 0x20000
    s_add_u32 s4, s4, s97
    s_addc_u32 s5, s5, 0
    s_add_u32 s12, s4, 0x1900000
    s_addc_u32 s13, s5, 0
    s_cmp_eq_u32 s96, 1
    s_cselect_b32 s12, s12, s6
    s_cselect_b32 s13, s13, s7
    s_mov_b32 s14, 0x400000
    s_mov_b32 s15, 0x20000
    s_mov_b32 s20, s4
    s_mov_b32 s21, s5
    s_mov_b32 s22, 0x40000
    s_mov_b32 s23, 0x20000
    s_mov_b32 s60, s16
    s_mov_b32 s61, s17
    s_mov_b32 s62, 0x100
    s_mov_b32 s63, 0x20000
    s_sub_u32 s40, s52, s27
    s_and_b32 s40, s40, 1
    s_and_b32 s41, s52, 2
    s_or_b32 s40, s40, s41
    s_add_u32 s54, s40, 2
    s_cmp_eq_u32 s53, 0
    s_cselect_b32 s54, 0x7fff, s54
    s_add_u32 s55, s54, 3
    s_cmp_lg_u32 s28, 0
    s_cselect_b32 s55, 0x7fff, s55
    s_cmp_lt_u32 s55, 0x7fff
    s_cselect_b32 s29, 12, 0x7fff
    s_add_u32 s50, s29, 1
    s_mov_b32 s51, 14
    s_mov_b32 s32, 0
    s_mov_b32 s33, 0
g1_ld_pW:
    s_add_u32 s40, s32, s27
    s_and_b32 s40, s40, 1
    s_andn2_b32 s41, s32, 1
    s_or_b32 s40, s40, s41
    s_add_u32 s40, s40, s26
    s_and_b32 s40, s40, 15
    s_mul_i32 s34, s40, 393216
    s_mul_i32 s35, s40, 128
    s_add_u32 s38, s33, s36
    s_add_u32 s39, s33, s37
    s_add_u32 m0, s38, 0
    s_nop 0
    buffer_load_dwordx4 v10, s[8:11], s34 offen lds
    s_add_u32 m0, s38, 1024
    s_nop 0
    buffer_load_dwordx4 v11, s[8:11], s34 offen lds
    s_add_u32 m0, s38, 8192
    s_nop 0
    buffer_load_dwordx4 v12, s[8:11], s34 offen lds
    s_add_u32 m0, s38, 9216
    s_nop 0
    buffer_load_dwordx4 v13, s[8:11], s34 offen lds
    s_add_u32 m0, s38, 16384
    s_nop 0
    buffer_load_dwordx4 v14, s[8:11], s34 offen lds
    s_add_u32 m0, s38, 17408
    s_nop 0
    buffer_load_dwordx4 v15, s[8:11], s34 offen lds
    s_add_u32 s33, s33, 43008
    s_add_u32 s32, s32, 1
    s_cmp_lt_u32 s32, 2
    s_cbranch_scc1 g1_ld_pW
    s_cmp_eq_u32 s96, 0
    s_cbranch_scc1 g1_dep_ok
    s_add_u32 s40, s25, 40
    s_lshl_b32 s40, s40, 12
    s_sub_u32 s42, s40, 4096
    s_max_u32 s42, s42, 163840
    s_lshl_b32 s41, s24, 7
    s_add_u32 s40, s40, s41
    s_add_u32 s42, s42, s41
    s_lshl_b32 s43, s96, 2
    s_add_u32 s43, s43, 1
    s_mov_b32 s41, 0x800000
    v_mov_b32 v24, 131072
    s_cmp_lg_u32 s28, 0
    s_cbranch_scc1 g1_dep_lds
    s_add_u32 s84, s4, 0x300000
    s_addc_u32 s85, s5, 0
    s_mov_b32 s86, 0x40000
    s_mov_b32 s87, 0x20000
    v_cmp_gt_u32 vcc, 32, v2
    v_mov_b32 v21, s40
    v_mov_b32 v23, s42
    v_cndmask_b32 v21, v23, v21, vcc
    v_mov_b32 v22, 15
    v_mov_b32 v23, 15
    v_cndmask_b32 v22, v23, v22, vcc
    v_and_b32 v23, 31, v2
    v_min_u32 v23, v23, v22
    v_lshl_add_u32 v21, v23, 2, v21
    s_mov_b32 s41, 0x40000
    s_mov_b32 s44, 0x3
    s_mov_b32 s45, 0x3
g1_dep:
    buffer_load_dword v23, v21, s[84:87], 0 offen sc1
    s_sub_u32 s41, s41, 1
    s_waitcnt vmcnt(0)
g1_dep_chk:
    v_cmp_eq_u32 vcc, 0, v23
    s_cmp_eq_u32 s41, 0
    s_cbranch_scc1 g1_dep_seen
    s_and_b64 vcc, vcc, s[44:45]
    s_cbranch_scc0 g1_dep_seen
    s_sleep 2
    s_branch g1_dep
g1_dep_seen:
    v_mov_b32 v22, s43
    ds_write_b32 v24, v22
    s_branch g1_dep_ok
g1_dep_lds:
    ds_read_b32 v23, v24
    s_sub_u32 s41, s41, 1
    s_waitcnt lgkmcnt(0)
    v_readfirstlane_b32 s40, v23
    s_cmp_eq_u32 s41, 0
    s_cbranch_scc1 g1_dep_ok
    s_cmp_eq_u32 s40, s43
    s_cbranch_scc1 g1_dep_ok
    s_sleep 1
    s_branch g1_dep_lds
g1_dep_ok:
    s_mov_b32 s32, 0
    s_mov_b32 s33, 0
g1_ld_pA:
    s_add_u32 s40, s32, s27
    s_and_b32 s40, s40, 1
    s_andn2_b32 s41, s32, 1
    s_or_b32 s40, s40, s41
    s_add_u32 s40, s40, s26
    s_and_b32 s40, s40, 15
    s_mul_i32 s34, s40, 393216
    s_mul_i32 s35, s40, 128
    s_add_u32 s38, s33, s36
    s_add_u32 s39, s33, s37
    s_add_u32 m0, s39, 0
    s_nop 0
    buffer_load_dwordx4 v16, s[12:15], s35 offen sc1 lds
    s_add_u32 m0, s39, 1024
    s_nop 0
    buffer_load_dwordx4 v17, s[12:15], s35 offen sc1 lds
    s_add_u32 m0, s39, 2048
    s_nop 0
    buffer_load_dwordx4 v18, s[12:15], s35 offen sc1 lds
    s_add_u32 m0, s39, 3072
    s_nop 0
    buffer_load_dwordx4 v19, s[12:15], s35 offen sc1 lds
    s_add_u32 m0, s33, s46
    s_mov_b32 exec_hi, 0
    buffer_load_dwordx4 v20, s[12:15], s35 offen sc1 lds
    s_mov_b32 exec_hi, -1
    s_add_u32 s33, s33, 43008
    s_add_u32 s32, s32, 1
    s_cmp_lt_u32 s32, 2
    s_cbranch_scc1 g1_ld_pA
    s_cmp_eq_u32 s96, 0
    s_cbranch_scc1 g1_dep_rok
    s_add_u32 s40, s25, 40
    s_lshl_b32 s40, s40, 12
    s_sub_u32 s42, s40, 4096
    s_max_u32 s42, s42, 163840
    s_lshl_b32 s41, s24, 7
    s_add_u32 s40, s40, s41
    s_add_u32 s42, s42, s41
    s_cmp_lg_u32 s28, 0
    s_cbranch_scc1 g1_dep_rok
    s_mov_b32 s41, 0x40000
    s_add_u32 s84, s4, 0x300000
    s_addc_u32 s85, s5, 0
    s_mov_b32 s86, 0x40000
    s_mov_b32 s87, 0x20000
g1_dep_r:
    v_cmp_eq_u32 vcc, 0, v23
    s_sub_u32 s41, s41, 1
    s_cmp_eq_u32 s41, 0
    s_cbranch_scc1 g1_dep_rok
    s_cbranch_vccz g1_dep_rok
    s_sleep 2
    buffer_load_dword v23, v21, s[84:87], 0 offen sc1
    s_waitcnt vmcnt(0)
    s_branch g1_dep_r
g1_dep_rok:
    s_waitcnt vmcnt(5)
    s_branch g1_ld_bar
g1_ld_loop:
    s_sub_u32 s40, s32, s54
    s_sub_u32 s40, s40, 1
    s_cmp_lt_u32 s40, 2
    s_cbranch_scc1 g1_ld_w0
    s_sub_u32 s40, s32, s55
    s_sub_u32 s40, s40, 1
    s_cmp_lt_u32 s40, 2
    s_cbranch_scc1 g1_ld_w1
    s_sub_u32 s40, s32, s29
    s_sub_u32 s40, s40, 1
    s_cmp_lt_u32 s40, 2
    s_cbranch_scc1 g1_ld_w2
    s_sub_u32 s40, s32, s51
    s_sub_u32 s40, s40, 1
    s_cmp_lt_u32 s40, 2
    s_cbranch_scc1 g1_ld_w4
    s_waitcnt vmcnt(11)
g1_ld_bar:
    s_barrier
    s_add_u32 s40, s32, s27
    s_and_b32 s40, s40, 1
    s_andn2_b32 s41, s32, 1
    s_or_b32 s40, s40, s41
    s_add_u32 s40, s40, s26
    s_and_b32 s40, s40, 15
    s_mul_i32 s34, s40, 393216
    s_mul_i32 s35, s40, 128
    s_add_u32 s38, s33, s36
    s_add_u32 s39, s33, s37
    s_add_u32 m0, s39, 0
    s_nop 0
    buffer_load_dwordx4 v16, s[12:15], s35 offen sc1 lds
    s_add_u32 m0, s39, 1024
    s_nop 0
    buffer_load_dwordx4 v17, s[12:15], s35 offen sc1 lds
    s_add_u32 m0, s39, 2048
    s_nop 0
    buffer_load_dwordx4 v18, s[12:15], s35 offen sc1 lds
    s_add_u32 m0, s39, 3072
    s_nop 0
    buffer_load_dwordx4 v19, s[12:15], s35 offen sc1 lds
    s_add_u32 m0, s38, 0
    s_nop 0
    buffer_load_dwordx4 v10, s[8:11], s34 offen lds
    s_add_u32 m0, s38, 1024
    s_nop 0
    buffer_load_dwordx4 v11, s[8:11], s34 offen lds
    s_add_u32 m0, s38, 8192
    s_nop 0
    buffer_load_dwordx4 v12, s[8:11], s34 offen lds
    s_add_u32 m0, s38, 9216
    s_nop 0
    buffer_load_dwordx4 v13, s[8:11], s34 offen lds
    s_add_u32 m0, s38, 16384
    s_nop 0
    buffer_load_dwordx4 v14, s[8:11], s34 offen lds
    s_add_u32 m0, s38, 17408
    s_nop 0
    buffer_load_dwordx4 v15, s[8:11], s34 offen lds
    s_add_u32 m0, s33, s46
    s_mov_b32 exec_hi, 0
    buffer_load_dwordx4 v20, s[12:15], s35 offen sc1 lds
    s_mov_b32 exec_hi, -1
    s_cmp_eq_u32 s32, s54
    s_cbranch_scc1 g1_ld_h0
g1_ld_c0:
    s_cmp_eq_u32 s32, s55
    s_cbranch_scc1 g1_ld_h1
g1_ld_c1:
    s_cmp_eq_u32 s32, s29
    s_cbranch_scc1 g1_ld_h2
g1_ld_c2:
    s_cmp_eq_u32 s32, s50
    s_cbranch_scc1 g1_ld_h3
g1_ld_c3:
    s_cmp_eq_u32 s32, s51
    s_cbranch_scc1 g1_ld_h4
g1_ld_c4:
    s_add_u32 s33, s33, 43008
    s_add_u32 s32, s32, 1
    s_cmp_eq_u32 s33, 129024
    s_cselect_b32 s33, 0, s33
    s_cmp_lt_u32 s32, 16
    s_cbranch_scc1 g1_ld_loop
    s_waitcnt vmcnt(43)
    s_barrier
    s_waitcnt vmcnt(0)
    v_pk_add_f32 v[24:25], v[24:25], v[40:41]
    v_add_f32 v56, v56, v64
    v_pk_add_f32 v[26:27], v[26:27], v[42:43]
    v_add_f32 v57, v57, v65
    v_pk_add_f32 v[28:29], v[28:29], v[44:45]
    v_add_f32 v58, v58, v66
    v_pk_add_f32 v[30:31], v[30:31], v[46:47]
    v_add_f32 v59, v59, v67
    v_pk_add_f32 v[32:33], v[32:33], v[48:49]
    v_add_f32 v60, v60, v68
    v_pk_add_f32 v[34:35], v[34:35], v[50:51]
    v_add_f32 v61, v61, v69
    v_pk_add_f32 v[36:37], v[36:37], v[52:53]
    v_add_f32 v62, v62, v70
    v_pk_add_f32 v[38:39], v[38:39], v[54:55]
    v_add_f32 v63, v63, v71
    v_pk_add_f32 v[24:25], v[24:25], v[32:33]
    v_add_f32 v56, v56, v60
    v_pk_add_f32 v[26:27], v[26:27], v[34:35]
    v_add_f32 v57, v57, v61
    v_pk_add_f32 v[28:29], v[28:29], v[36:37]
    v_add_f32 v58, v58, v62
    v_pk_add_f32 v[30:31], v[30:31], v[38:39]
    v_add_f32 v59, v59, v63
    v_pk_add_f32 v[24:25], v[24:25], v[28:29]
    v_add_f32 v56, v56, v58
    v_pk_add_f32 v[26:27], v[26:27], v[30:31]
    v_add_f32 v57, v57, v59
    v_pk_add_f32 v[24:25], v[24:25], v[26:27]
    v_add_f32 v56, v56, v57
    v_mul_f32 v24, 0x3a800000, v24
    v_mul_f32 v25, 0x3a800000, v25
    v_fma_f32 v25, -v24, v24, v25
    v_max_f32 v25, 0, v25
    v_cvt_pk_bf16_f32 v24, v24, v24
    v_lshlrev_b32 v24, 16, v24
    v_cvt_pk_bf16_f32 v25, v25, v25
    v_lshlrev_b32 v25, 16, v25
    v_add_f32 v25, 0x3727c5ac, v25
    v_cvt_pk_bf16_f32 v25, v25, v25
    v_lshlrev_b32 v25, 16, v25
    v_sqrt_f32 v25, v25
    s_nop 0
    v_cvt_pk_bf16_f32 v25, v25, v25
    v_lshlrev_b32 v25, 16, v25
    v_rcp_f32 v26, v25
    v_lshlrev_b32 v3, 3, v21
    v_lshlrev_b32 v4, 2, v21
    v_mul_f32 v27, -v24, v26
    v_cmp_gt_u32 vcc, 144, v21
    s_and_saveexec_b64 s[40:41], vcc
    v_add_u32 v3, 129024, v3
    ds_write_b64 v3, v[26:27]
    s_mov_b64 exec, s[40:41]
    v_cmp_gt_u32 vcc, 192, v21
    s_and_saveexec_b64 s[40:41], vcc
    v_add_u32 v4, 130304, v4
    ds_write_b32 v4, v56
    s_mov_b64 exec, s[40:41]
    s_waitcnt lgkmcnt(0)
    s_barrier
    s_add_u32 s20, s4, 0x200000
    s_addc_u32 s21, s5, 0
    s_mov_b32 s22, 0x40000
    s_mov_b32 s23, 0x20000
    s_lshl_b32 s40, s24, 4
    s_add_u32 s40, s40, s25
    s_lshl_b32 s40, s40, 10
    s_lshl_b32 s41, s28, 8
    s_add_u32 s40, s40, s41
    v_lshlrev_b32 v3, 2, v2
    v_mov_b32 v4, -1
    buffer_store_dword v4, v3, s[20:23], s40 offen sc1
    s_cmp_eq_u32 s53, 0
    s_cbranch_scc1 g1_nopf
    s_mov_b32 s20, s18
    s_mov_b32 s21, s19
    s_mov_b32 s22, 0x200000
    s_mov_b32 s23, 0x20000
    s_lshl_b32 s40, s2, 13
    s_lshl_b32 s41, s28, 11
    s_add_u32 s40, s40, s41
    v_lshlrev_b32 v3, 4, v2
    buffer_load_dwordx4 v[120:123], v3, s[20:23], s40 offen
    buffer_load_dwordx4 v[120:123], v3, s[20:23], s40 offen offset:1024
g1_nopf:
    s_branch g1_ld_end
g1_ld_w0:
    s_waitcnt vmcnt(16)
    s_branch g1_ld_bar
g1_ld_h0:
    s_add_u32 s44, s33, 43008
    s_cmp_eq_u32 s44, 129024
    s_cselect_b32 s44, 0, s44
    s_mul_i32 s42, s28, 3
    s_add_u32 s42, s42, 0
    s_lshr_b32 s43, s42, 2
    s_lshl_b32 s43, s43, 13
    s_add_u32 s43, s43, s44
    s_and_b32 s42, s42, 3
    v_and_b32 v3, 1, v5
    v_lshlrev_b32 v3, 1, v3
    v_lshrrev_b32 v4, 1, v6
    v_or_b32 v3, v3, v4
    s_add_u32 s40, s42, 0
    v_xor_b32 v3, s40, v3
    v_lshlrev_b32 v3, 5, v3
    v_lshl_add_u32 v3, v7, 3, v3
    v_lshl_add_u32 v4, v5, 3, v6
    v_lshl_add_u32 v3, v4, 7, v3
    v_add_u32 v21, s43, v3
    ds_read_b64_tr_b16 v[24:25], v21 offset:0
    ds_read_b64_tr_b16 v[26:27], v21 offset:512
    ds_read_b64_tr_b16 v[28:29], v21 offset:4096
    ds_read_b64_tr_b16 v[30:31], v21 offset:4608
    s_mul_i32 s42, s28, 3
    s_add_u32 s42, s42, 1
    s_lshr_b32 s43, s42, 2
    s_lshl_b32 s43, s43, 13
    s_add_u32 s43, s43, s44
    s_and_b32 s42, s42, 3
    v_and_b32 v3, 1, v5
    v_lshlrev_b32 v3, 1, v3
    v_lshrrev_b32 v4, 1, v6
    v_or_b32 v3, v3, v4
    s_add_u32 s40, s42, 0
    v_xor_b32 v3, s40, v3
    v_lshlrev_b32 v3, 5, v3
    v_lshl_add_u32 v3, v7, 3, v3
    v_lshl_add_u32 v4, v5, 3, v6
    v_lshl_add_u32 v3, v4, 7, v3
    v_add_u32 v21, s43, v3
    ds_read_b64_tr_b16 v[32:33], v21 offset:0
    ds_read_b64_tr_b16 v[34:35], v21 offset:512
    ds_read_b64_tr_b16 v[36:37], v21 offset:4096
    ds_read_b64_tr_b16 v[38:39], v21 offset:4608
    s_mul_i32 s42, s28, 3
    s_add_u32 s42, s42, 2
    s_lshr_b32 s43, s42, 2
    s_lshl_b32 s43, s43, 13
    s_add_u32 s43, s43, s44
    s_and_b32 s42, s42, 3
    v_and_b32 v3, 1, v5
    v_lshlrev_b32 v3, 1, v3
    v_lshrrev_b32 v4, 1, v6
    v_or_b32 v3, v3, v4
    s_add_u32 s40, s42, 0
    v_xor_b32 v3, s40, v3
    v_lshlrev_b32 v3, 5, v3
    v_lshl_add_u32 v3, v7, 3, v3
    v_lshl_add_u32 v4, v5, 3, v6
    v_lshl_add_u32 v3, v4, 7, v3
    v_add_u32 v21, s43, v3
    ds_read_b64_tr_b16 v[40:41], v21 offset:0
    ds_read_b64_tr_b16 v[42:43], v21 offset:512
    ds_read_b64_tr_b16 v[44:45], v21 offset:4096
    ds_read_b64_tr_b16 v[46:47], v21 offset:4608
    s_lshr_b32 s42, s44, 7
    s_lshl_b32 s43, s28, 5
    s_add_u32 s42, s42, s43
    s_add_u32 s42, s42, 16
    v_lshrrev_b32 v3, 1, v8
    v_xor_b32 v3, v3, v5
    v_lshlrev_b32 v3, 4, v3
    v_lshl_add_u32 v3, v8, 7, v3
    s_lshl_b32 s40, s42, 7
    s_add_u32 s40, s40, 24576
    v_add_u32 v22, s40, v3
    v_xor_b32 v23, 64, v22
    ds_read_b128 v[48:51], v22 offset:0
    ds_read_b128 v[52:55], v23 offset:0
    ds_read_b128 v[56:59], v22 offset:2048
    ds_read_b128 v[60:63], v23 offset:2048
    v_mov_b32 v64, 0x3f803f80
    v_mov_b32 v65, 0x3f803f80
    v_mov_b32 v66, 0x3f803f80
    v_mov_b32 v67, 0x3f803f80
    s_mul_i32 s42, s52, 12288
    s_lshl_b32 s43, s24, 8
    s_add_u32 s42, s42, s43
    v_lshl_add_u32 v21, v5, 4, s42
    s_lshl_b32 s42, s52, 14
    s_lshl_b32 s43, s25, 10
    s_add_u32 s42, s42, s43
    s_lshl_b32 s43, s28, 8
    s_add_u32 s42, s42, s43
    v_lshl_add_u32 v22, v8, 3, s42
    s_waitcnt lgkmcnt(0)
    v_mfma_f32_16x16x32_bf16 v[68:71], v[24:27], v[64:67], 0
    v_mfma_f32_16x16x32_bf16 v[72:75], v[32:35], v[64:67], 0
    v_mfma_f32_16x16x32_bf16 v[76:79], v[40:43], v[64:67], 0
    v_mfma_f32_16x16x32_bf16 v[80:83], v[64:67], v[48:51], 0
    v_mfma_f32_16x16x32_bf16 v[84:87], v[48:51], v[48:51], 0
    v_mfma_f32_16x16x32_bf16 v[88:91], v[64:67], v[56:59], 0
    v_mfma_f32_16x16x32_bf16 v[92:95], v[56:59], v[56:59], 0
    v_mfma_f32_16x16x32_bf16 v[68:71], v[28:31], v[64:67], v[68:71]
    v_mfma_f32_16x16x32_bf16 v[72:75], v[36:39], v[64:67], v[72:75]
    v_mfma_f32_16x16x32_bf16 v[76:79], v[44:47], v[64:67], v[76:79]
    v_mfma_f32_16x16x32_bf16 v[80:83], v[64:67], v[52:55], v[80:83]
    v_mfma_f32_16x16x32_bf16 v[84:87], v[52:55], v[52:55], v[84:87]
    v_mfma_f32_16x16x32_bf16 v[88:91], v[64:67], v[60:63], v[88:91]
    v_mfma_f32_16x16x32_bf16 v[92:95], v[60:63], v[60:63], v[92:95]
    v_cmp_eq_u32 s[40:41], 1, v7
    v_cmp_eq_u32 s[42:43], 2, v7
    v_cmp_eq_u32 vcc, 3, v7
    s_nop 7
    v_cndmask_b32 v81, v84, v85, s[40:41]
    v_cndmask_b32 v81, v81, v86, s[42:43]
    v_cndmask_b32 v81, v81, v87, vcc
    v_cndmask_b32 v89, v92, v93, s[40:41]
    v_cndmask_b32 v89, v89, v94, s[42:43]
    v_cndmask_b32 v89, v89, v95, vcc
    s_mov_b32 exec_lo, 0x00f0000f
    s_mov_b32 exec_hi, 0xf0000f00
    buffer_store_dwordx2 v[80:81], v22, s[20:23], 0 offen offset:0 sc1
    buffer_store_dwordx2 v[88:89], v22, s[20:23], 0 offen offset:128 sc1
    s_mov_b32 exec_lo, 0x00010001
    s_mov_b32 exec_hi, 0x00010001
    s_mul_i32 s42, s28, 3
    s_add_u32 s42, s42, 0
    s_lshr_b32 s43, s42, 2
    s_lshl_b32 s43, s43, 12
    s_and_b32 s42, s42, 3
    s_lshl_b32 s42, s42, 6
    s_add_u32 s42, s42, s43
    buffer_store_dwordx4 v[68:71], v21, s[56:59], s42 offen sc1
    s_mul_i32 s42, s28, 3
    s_add_u32 s42, s42, 1
    s_lshr_b32 s43, s42, 2
    s_lshl_b32 s43, s43, 12
    s_and_b32 s42, s42, 3
    s_lshl_b32 s42, s42, 6
    s_add_u32 s42, s42, s43
    buffer_store_dwordx4 v[72:75], v21, s[56:59], s42 offen sc1
    s_mul_i32 s42, s28, 3
    s_add_u32 s42, s42, 2
    s_lshr_b32 s43, s42, 2
    s_lshl_b32 s43, s43, 12
    s_and_b32 s42, s42, 3
    s_lshl_b32 s42, s42, 6
    s_add_u32 s42, s42, s43
    buffer_store_dwordx4 v[76:79], v21, s[56:59], s42 offen sc1
    s_mov_b64 exec, -1
    s_cmp_lg_u32 s28, 0
    s_cbranch_scc1 g1_nocr
    s_lshl_b32 s40, s2, 10
    v_lshl_add_u32 v21, v2, 4, s40
    v_mov_b32 v24, 0
    v_mov_b32 v25, 0
    v_mov_b32 v26, 0
    v_mov_b32 v27, 0
    s_add_u32 s84, s4, 0x300000
    s_addc_u32 s85, s5, 0
    s_mov_b32 s86, 0x40000
    s_mov_b32 s87, 0x20000
    buffer_store_dwordx4 v[24:27], v21, s[84:87], 0 offen sc1
    s_add_u32 s84, s4, 0x2b00000
    s_addc_u32 s85, s5, 0
    s_mov_b32 s86, 0x40000
    s_mov_b32 s87, 0x20000
    buffer_store_dwordx4 v[24:27], v21, s[84:87], 0 offen sc1
g1_nocr:
    s_branch g1_ld_c0
g1_ld_w1:
    s_waitcnt vmcnt(12)
    s_branch g1_ld_bar
g1_ld_h1:
    v_mov_b32 v21, 0
    v_mov_b32 v22, 1
    s_mov_b64 exec, 1
    buffer_atomic_add v22, v21, s[60:63], 0 offen sc1
    s_mov_b64 exec, -1
    s_branch g1_ld_c1
g1_ld_w2:
    s_waitcnt vmcnt(12)
    s_branch g1_ld_bar
g1_ld_h2:
    v_mov_b32 v21, 0
    buffer_load_dword v23, v21, s[60:63], 0 offen sc1
    s_branch g1_ld_c2
g1_ld_h3:
    s_mov_b32 s41, 0x40000
    v_mov_b32 v21, 0
    s_waitcnt vmcnt(11)
g1_poll:
    v_readfirstlane_b32 s40, v23
    s_sub_u32 s41, s41, 1
    s_cmp_eq_u32 s41, 0
    s_cbranch_scc1 g1_polled
    s_cmp_ge_u32 s40, 256
    s_cbranch_scc1 g1_polled
    s_sleep 8
    buffer_load_dword v23, v21, s[60:63], 0 offen sc1
    s_waitcnt vmcnt(0)
    s_branch g1_poll
g1_polled:
    s_branch g1_ld_c3
g1_ld_w4:
    s_waitcnt vmcnt(43)
    s_branch g1_ld_bar
g1_ld_h4:
    s_lshl_b32 s40, s28, 6
    v_add_u32 v21, s40, v2
    s_lshl_b32 s41, s25, 7
    s_sub_u32 s41, s41, 16
    v_add_u32 v3, s41, v21
    v_max_i32 v3, 0, v3
    v_min_u32 v3, 2047, v3
    v_lshlrev_b32 v3, 3, v3
    s_min_u32 s40, s28, 2
    s_lshl_b32 s40, s40, 12
    s_lshl_b32 s41, s24, 8
    s_add_u32 s40, s40, s41
    v_lshl_add_u32 v4, v2, 2, s40
    s_mov_b32 s40, 0
    buffer_load_dwordx2 v[24:25], v3, s[20:23], s40 offen sc1
    s_mov_b32 s41, 0
    buffer_load_dword v56, v4, s[56:59], s41 offen sc1
    s_mov_b32 s40, 16384
    buffer_load_dwordx2 v[26:27], v3, s[20:23], s40 offen sc1
    s_mov_b32 s41, 12288
    buffer_load_dword v57, v4, s[56:59], s41 offen sc1
    s_mov_b32 s40, 32768
    buffer_load_dwordx2 v[28:29], v3, s[20:23], s40 offen sc1
    s_mov_b32 s41, 24576
    buffer_load_dword v58, v4, s[56:59], s41 offen sc1
    s_mov_b32 s40, 49152
    buffer_load_dwordx2 v[30:31], v3, s[20:23], s40 offen sc1
    s_mov_b32 s41, 36864
    buffer_load_dword v59, v4, s[56:59], s41 offen sc1
    s_mov_b32 s40, 65536
    buffer_load_dwordx2 v[32:33], v3, s[20:23], s40 offen sc1
    s_mov_b32 s41, 49152
    buffer_load_dword v60, v4, s[56:59], s41 offen sc1
    s_mov_b32 s40, 81920
    buffer_load_dwordx2 v[34:35], v3, s[20:23], s40 offen sc1
    s_mov_b32 s41, 61440
    buffer_load_dword v61, v4, s[56:59], s41 offen sc1
    s_mov_b32 s40, 98304
    buffer_load_dwordx2 v[36:37], v3, s[20:23], s40 offen sc1
    s_mov_b32 s41, 73728
    buffer_load_dword v62, v4, s[56:59], s41 offen sc1
    s_mov_b32 s40, 114688
    buffer_load_dwordx2 v[38:39], v3, s[20:23], s40 offen sc1
    s_mov_b32 s41, 86016
    buffer_load_dword v63, v4, s[56:59], s41 offen sc1
    s_mov_b32 s40, 131072
    buffer_load_dwordx2 v[40:41], v3, s[20:23], s40 offen sc1
    s_mov_b32 s41, 98304
    buffer_load_dword v64, v4, s[56:59], s41 offen sc1
    s_mov_b32 s40, 147456
    buffer_load_dwordx2 v[42:43], v3, s[20:23], s40 offen sc1
    s_mov_b32 s41, 110592
    buffer_load_dword v65, v4, s[56:59], s41 offen sc1
    s_mov_b32 s40, 163840
    buffer_load_dwordx2 v[44:45], v3, s[20:23], s40 offen sc1
    s_mov_b32 s41, 122880
    buffer_load_dword v66, v4, s[56:59], s41 offen sc1
    s_mov_b32 s40, 180224
    buffer_load_dwordx2 v[46:47], v3, s[20:23], s40 offen sc1
    s_mov_b32 s41, 135168
    buffer_load_dword v67, v4, s[56:59], s41 offen sc1
    s_mov_b32 s40, 196608
    buffer_load_dwordx2 v[48:49], v3, s[20:23], s40 offen sc1
    s_mov_b32 s41, 147456
    buffer_load_dword v68, v4, s[56:59], s41 offen sc1
    s_mov_b32 s40, 212992
    buffer_load_dwordx2 v[50:51], v3, s[20:23], s40 offen sc1
    s_mov_b32 s41, 159744
    buffer_load_dword v69, v4, s[56:59], s41 offen sc1
    s_mov_b32 s40, 229376
    buffer_load_dwordx2 v[52:53], v3, s[20:23], s40 offen sc1
    s_mov_b32 s41, 172032
    buffer_load_dword v70, v4, s[56:59], s41 offen sc1
    s_mov_b32 s40, 245760
    buffer_load_dwordx2 v[54:55], v3, s[20:23], s40 offen sc1
    s_mov_b32 s41, 184320
    buffer_load_dword v71, v4, s[56:59], s41 offen sc1
    s_branch g1_ld_c4
g1_ld_end:
    s_add_u32 s28, s28, 4
    s_add_u32 s16, s4, 0x400000
    s_addc_u32 s17, s5, 0
    s_mov_b32 s18, 0x400000
    s_mov_b32 s19, 0x20000
    s_and_b32 s44, s28, 1
    s_lshr_b32 s45, s28, 1
    s_lshl_b32 s40, s44, 2
    v_add_u32 v3, s40, v5
    v_and_b32 v4, 7, v8
    v_xor_b32 v3, v3, v4
    v_lshlrev_b32 v3, 4, v3
    v_lshl_add_u32 v3, v8, 8, v3
    s_mul_i32 s41, s45, 4096
    s_add_u32 s41, s41, 43008
    v_add_u32 v226, s41, v3
    v_lshl_add_u32 v3, v5, 2, v6
    v_and_b32 v4, 7, v3
    v_add_u32 v228, s40, v7
    v_xor_b32 v4, v4, v228
    v_lshlrev_b32 v4, 4, v4
    v_lshl_add_u32 v3, v3, 8, v4
    s_add_u32 s41, s41, 36864
    v_add_u32 v227, s41, v3
    v_and_b32 v3, 7, v8
    v_add_u32 v4, 1, v3
    s_or_b32 s40, s25, s45
    s_cmp_eq_u32 s40, 0
    s_cselect_b32 s40, 8, 0
    v_cmp_gt_u32 vcc, 8, v8
    v_mov_b32 v21, s40
    s_mov_b64 s[56:57], vcc
    v_cndmask_b32 v21, 0, v21, vcc
    v_max_u32 v4, v4, v21
    v_add_u32 v3, 8, v3
    v_sub_u32 v3, v3, v4
    v_lshlrev_b32 v21, 2, v5
    v_sub_u32 v21, v21, v4
    v_mov_b32 v22, 0xf149f2ca
    v_add_u32 v23, 0, v21
    v_cmp_ge_u32 vcc, v3, v23
    s_nop 1
    v_cndmask_b32 v228, v22, 0, vcc
    v_add_u32 v23, 1, v21
    v_cmp_ge_u32 vcc, v3, v23
    s_nop 1
    v_cndmask_b32 v229, v22, 0, vcc
    v_add_u32 v23, 2, v21
    v_cmp_ge_u32 vcc, v3, v23
    s_nop 1
    v_cndmask_b32 v230, v22, 0, vcc
    v_add_u32 v23, 3, v21
    v_cmp_ge_u32 vcc, v3, v23
    s_nop 1
    v_cndmask_b32 v231, v22, 0, vcc
    s_lshl_b32 s40, s25, 7
    s_lshl_b32 s41, s45, 5
    s_add_u32 s40, s40, s41
    s_lshl_b32 s40, s40, 11
    s_lshl_b32 s41, s24, 7
    s_add_u32 s40, s40, s41
    s_lshl_b32 s41, s44, 6
    s_add_u32 s40, s40, s41
    v_lshlrev_b32 v225, 12, v8
    v_lshl_add_u32 v225, v5, 4, v225
    v_add_u32 v225, s40, v225
    s_mov_b32 s58, 0x3e3504f3
    s_mov_b32 s59, 0x3fb8aa3b
    s_branch g1_attn
g1_compute:
    s_and_b32 s44, s28, 1
    s_lshr_b32 s45, s28, 1
    s_lshl_b32 s42, s44, 1
    s_mov_b32 s43, 0
    v_and_b32 v3, 1, v5
    v_lshlrev_b32 v3, 1, v3
    v_lshrrev_b32 v4, 1, v6
    v_or_b32 v3, v3, v4
    s_add_u32 s40, s42, 0
    v_xor_b32 v3, s40, v3
    v_lshlrev_b32 v3, 5, v3
    v_lshl_add_u32 v3, v7, 3, v3
    v_lshl_add_u32 v4, v5, 3, v6
    v_lshl_add_u32 v3, v4, 7, v3
    v_add_u32 v10, s43, v3
    v_and_b32 v3, 1, v5
    v_lshlrev_b32 v3, 1, v3
    v_lshrrev_b32 v4, 1, v6
    v_or_b32 v3, v3, v4
    s_add_u32 s40, s42, 1
    v_xor_b32 v3, s40, v3
    v_lshlrev_b32 v3, 5, v3
    v_lshl_add_u32 v3, v7, 3, v3
    v_lshl_add_u32 v4, v5, 3, v6
    v_lshl_add_u32 v3, v4, 7, v3
    v_add_u32 v11, s43, v3
    s_xor_b32 s43, s45, 1
    s_add_u32 s43, s43, 1
    s_mul_i32 s43, s43, 8192
    v_and_b32 v3, 1, v5
    v_lshlrev_b32 v3, 1, v3
    v_lshrrev_b32 v4, 1, v6
    v_or_b32 v3, v3, v4
    s_add_u32 s40, s42, 0
    v_xor_b32 v3, s40, v3
    v_lshlrev_b32 v3, 5, v3
    v_lshl_add_u32 v3, v7, 3, v3
    v_lshl_add_u32 v4, v5, 3, v6
    v_lshl_add_u32 v3, v4, 7, v3
    v_add_u32 v12, s43, v3
    v_and_b32 v3, 1, v5
    v_lshlrev_b32 v3, 1, v3
    v_lshrrev_b32 v4, 1, v6
    v_or_b32 v3, v3, v4
    s_add_u32 s40, s42, 1
    v_xor_b32 v3, s40, v3
    v_lshlrev_b32 v3, 5, v3
    v_lshl_add_u32 v3, v7, 3, v3
    v_lshl_add_u32 v4, v5, 3, v6
    v_lshl_add_u32 v3, v4, 7, v3
    v_add_u32 v13, s43, v3
    s_xor_b32 s43, s45, 0
    s_add_u32 s43, s43, 1
    s_mul_i32 s43, s43, 8192
    v_and_b32 v3, 1, v5
    v_lshlrev_b32 v3, 1, v3
    v_lshrrev_b32 v4, 1, v6
    v_or_b32 v3, v3, v4
    s_add_u32 s40, s42, 0
    v_xor_b32 v3, s40, v3
    v_lshlrev_b32 v3, 5, v3
    v_lshl_add_u32 v3, v7, 3, v3
    v_lshl_add_u32 v4, v5, 3, v6
    v_lshl_add_u32 v3, v4, 7, v3
    v_add_u32 v14, s43, v3
    v_and_b32 v3, 1, v5
    v_lshlrev_b32 v3, 1, v3
    v_lshrrev_b32 v4, 1, v6
    v_or_b32 v3, v3, v4
    s_add_u32 s40, s42, 1
    v_xor_b32 v3, s40, v3
    v_lshlrev_b32 v3, 5, v3
    v_lshl_add_u32 v3, v7, 3, v3
    v_lshl_add_u32 v4, v5, 3, v6
    v_lshl_add_u32 v3, v4, 7, v3
    v_add_u32 v15, s43, v3
    s_mul_i32 s42, s45, 64
    s_add_u32 s42, s42, 16
    v_lshrrev_b32 v3, 1, v8
    v_xor_b32 v3, v3, v5
    v_lshlrev_b32 v3, 4, v3
    v_lshl_add_u32 v3, v8, 7, v3
    s_lshl_b32 s40, s42, 7
    s_add_u32 s40, s40, 24576
    v_add_u32 v16, s40, v3
    v_xor_b32 v17, 64, v16
    v_lshrrev_b32 v3, 1, v8
    v_xor_b32 v3, v3, v5
    v_lshlrev_b32 v3, 4, v3
    v_lshl_add_u32 v3, v8, 7, v3
    v_add_u32 v18, 24576, v3
    v_xor_b32 v19, 64, v18
    v_mov_b32 v24, 0
    v_mov_b32 v25, 0
    v_mov_b32 v26, 0
    v_mov_b32 v27, 0
    v_mov_b32 v28, 0
    v_mov_b32 v29, 0
    v_mov_b32 v30, 0
    v_mov_b32 v31, 0
    v_mov_b32 v32, 0
    v_mov_b32 v33, 0
    v_mov_b32 v34, 0
    v_mov_b32 v35, 0
    v_mov_b32 v36, 0
    v_mov_b32 v37, 0
    v_mov_b32 v38, 0
    v_mov_b32 v39, 0
    v_mov_b32 v40, 0
    v_mov_b32 v41, 0
    v_mov_b32 v42, 0
    v_mov_b32 v43, 0
    v_mov_b32 v44, 0
    v_mov_b32 v45, 0
    v_mov_b32 v46, 0
    v_mov_b32 v47, 0
    v_mov_b32 v48, 0
    v_mov_b32 v49, 0
    v_mov_b32 v50, 0
    v_mov_b32 v51, 0
    v_mov_b32 v52, 0
    v_mov_b32 v53, 0
    v_mov_b32 v54, 0
    v_mov_b32 v55, 0
    v_mov_b32 v56, 0
    v_mov_b32 v57, 0
    v_mov_b32 v58, 0
    v_mov_b32 v59, 0
    v_mov_b32 v60, 0
    v_mov_b32 v61, 0
    v_mov_b32 v62, 0
    v_mov_b32 v63, 0
    v_mov_b32 v64, 0
    v_mov_b32 v65, 0
    v_mov_b32 v66, 0
    v_mov_b32 v67, 0
    v_mov_b32 v68, 0
    v_mov_b32 v69, 0
    v_mov_b32 v70, 0
    v_mov_b32 v71, 0
    v_mov_b32 v72, 0
    v_mov_b32 v73, 0
    v_mov_b32 v74, 0
    v_mov_b32 v75, 0
    v_mov_b32 v76, 0
    v_mov_b32 v77, 0
    v_mov_b32 v78, 0
    v_mov_b32 v79, 0
    v_mov_b32 v80, 0
    v_mov_b32 v81, 0
    v_mov_b32 v82, 0
    v_mov_b32 v83, 0
    v_mov_b32 v84, 0
    v_mov_b32 v85, 0
    v_mov_b32 v86, 0
    v_mov_b32 v87, 0
    v_mov_b32 v88, 0
    v_mov_b32 v89, 0
    v_mov_b32 v90, 0
    v_mov_b32 v91, 0
    v_mov_b32 v92, 0
    v_mov_b32 v93, 0
    v_mov_b32 v94, 0
    v_mov_b32 v95, 0
    v_mov_b32 v96, 0
    v_mov_b32 v97, 0
    v_mov_b32 v98, 0
    v_mov_b32 v99, 0
    v_mov_b32 v100, 0
    v_mov_b32 v101, 0
    v_mov_b32 v102, 0
    v_mov_b32 v103, 0
    v_mov_b32 v104, 0
    v_mov_b32 v105, 0
    v_mov_b32 v106, 0
    v_mov_b32 v107, 0
    v_mov_b32 v108, 0
    v_mov_b32 v109, 0
    v_mov_b32 v110, 0
    v_mov_b32 v111, 0
    v_mov_b32 v112, 0
    v_mov_b32 v113, 0
    v_mov_b32 v114, 0
    v_mov_b32 v115, 0
    v_mov_b32 v116, 0
    v_mov_b32 v117, 0
    v_mov_b32 v118, 0
    v_mov_b32 v119, 0
    v_mov_b32 v120, 0
    v_mov_b32 v121, 0
    v_mov_b32 v122, 0
    v_mov_b32 v123, 0
    v_mov_b32 v124, 0
    v_mov_b32 v125, 0
    v_mov_b32 v126, 0
    v_mov_b32 v127, 0
    s_mov_b32 s48, 16
    s_mov_b32 s50, 0
    s_mov_b32 s51, 43008
    s_mov_b32 s29, 0xfffeb000
    s_waitcnt lgkmcnt(0)
    s_add_u32 s4, s4, s97
    s_addc_u32 s5, s5, 0
    v_lshlrev_b32 v3, 3, v8
    v_add_u32 v217, 129024, v3
    s_mul_i32 s40, s45, 512
    s_add_u32 s40, s40, 129152
    v_add_u32 v216, s40, v3
    s_lshl_b32 s40, s44, 7
    s_add_u32 s40, s40, 130304
    v_lshl_add_u32 v3, v5, 4, s40
    s_mov_b32 s43, 0
    v_add_u32 v218, s43, v3
    s_xor_b32 s43, s45, 1
    s_add_u32 s43, s43, 1
    s_mul_i32 s43, s43, 256
    v_add_u32 v219, s43, v3
    s_xor_b32 s43, s45, 0
    s_add_u32 s43, s43, 1
    s_mul_i32 s43, s43, 256
    v_add_u32 v220, s43, v3
    v_and_b32 v3, 1, v5
    v_lshlrev_b32 v3, 1, v3
    v_lshrrev_b32 v4, 1, v5
    v_add_u32 v3, v3, v4
    s_lshl_b32 s40, s44, 2
    v_add_u32 v3, s40, v3
    v_lshrrev_b32 v4, 1, v8
    v_xor_b32 v3, v3, v4
    v_lshlrev_b32 v3, 4, v3
    v_lshl_add_u32 v3, v8, 7, v3
    s_mul_i32 s42, s45, 8192
    s_add_u32 s42, s42, 45056
    s_mov_b32 s43, 0
    s_add_u32 s40, s42, s43
    v_add_u32 v221, s40, v3
    s_xor_b32 s43, s45, 1
    s_add_u32 s43, s43, 1
    s_mul_i32 s43, s43, 18432
    s_add_u32 s40, s42, s43
    v_add_u32 v222, s40, v3
    s_xor_b32 s43, s45, 0
    s_add_u32 s43, s43, 1
    s_mul_i32 s43, s43, 18432
    s_add_u32 s40, s42, s43
    v_add_u32 v223, s40, v3
    s_add_u32 s40, s43, 43008
    v_add_u32 v224, s40, v3
    s_add_u32 s16, s4, 0x400000
    s_addc_u32 s17, s5, 0
    s_mov_b32 s18, 0x400000
    s_mov_b32 s19, 0x20000
    s_and_b32 s44, s28, 1
    s_lshr_b32 s45, s28, 1
    s_lshl_b32 s40, s44, 2
    v_add_u32 v3, s40, v5
    v_and_b32 v4, 7, v8
    v_xor_b32 v3, v3, v4
    v_lshlrev_b32 v3, 4, v3
    v_lshl_add_u32 v3, v8, 8, v3
    s_mul_i32 s41, s45, 4096
    s_add_u32 s41, s41, 43008
    v_add_u32 v226, s41, v3
    v_lshl_add_u32 v3, v5, 2, v6
    v_and_b32 v4, 7, v3
    v_add_u32 v228, s40, v7
    v_xor_b32 v4, v4, v228
    v_lshlrev_b32 v4, 4, v4
    v_lshl_add_u32 v3, v3, 8, v4
    s_add_u32 s41, s41, 36864
    v_add_u32 v227, s41, v3
    v_and_b32 v3, 7, v8
    v_add_u32 v4, 1, v3
    s_or_b32 s40, s25, s45
    s_cmp_eq_u32 s40, 0
    s_cselect_b32 s40, 8, 0
    v_cmp_gt_u32 vcc, 8, v8
    v_mov_b32 v21, s40
    s_mov_b64 s[56:57], vcc
    v_cndmask_b32 v21, 0, v21, vcc
    v_max_u32 v4, v4, v21
    v_add_u32 v3, 8, v3
    v_sub_u32 v3, v3, v4
    v_lshlrev_b32 v21, 2, v5
    v_sub_u32 v21, v21, v4
    v_mov_b32 v22, 0xf149f2ca
    v_add_u32 v23, 0, v21
    v_cmp_ge_u32 vcc, v3, v23
    s_nop 1
    v_cndmask_b32 v228, v22, 0, vcc
    v_add_u32 v23, 1, v21
    v_cmp_ge_u32 vcc, v3, v23
    s_nop 1
    v_cndmask_b32 v229, v22, 0, vcc
    v_add_u32 v23, 2, v21
    v_cmp_ge_u32 vcc, v3, v23
    s_nop 1
    v_cndmask_b32 v230, v22, 0, vcc
    v_add_u32 v23, 3, v21
    v_cmp_ge_u32 vcc, v3, v23
    s_nop 1
    v_cndmask_b32 v231, v22, 0, vcc
    s_lshl_b32 s40, s25, 7
    s_lshl_b32 s41, s45, 5
    s_add_u32 s40, s40, s41
    s_lshl_b32 s40, s40, 11
    s_lshl_b32 s41, s24, 7
    s_add_u32 s40, s40, s41
    s_lshl_b32 s41, s44, 6
    s_add_u32 s40, s40, s41
    v_lshlrev_b32 v225, 12, v8
    v_lshl_add_u32 v225, v5, 4, v225
    v_add_u32 v225, s40, v225
    s_mov_b32 s58, 0x3e3504f3
    s_mov_b32 s59, 0x3fb8aa3b
    s_barrier
    ds_read_b64_tr_b16 v[128:129], v10 offset:0
    ds_read_b64_tr_b16 v[130:131], v10 offset:512
    ds_read_b128 v[152:155], v16 offset:0
    ds_read_b128 v[156:159], v16 offset:2048
    ds_read_b128 v[160:163], v16 offset:4096
    ds_read_b128 v[164:167], v16 offset:6144
    ds_read_b64_tr_b16 v[132:133], v11 offset:0
    ds_read_b64_tr_b16 v[134:135], v11 offset:512
    ds_read_b64_tr_b16 v[136:137], v12 offset:0
    ds_read_b64_tr_b16 v[138:139], v12 offset:512
    ds_read_b64_tr_b16 v[140:141], v13 offset:0
    ds_read_b64_tr_b16 v[142:143], v13 offset:512
    ds_read_b64_tr_b16 v[144:145], v14 offset:0
    ds_read_b64_tr_b16 v[146:147], v14 offset:512
    ds_read_b64_tr_b16 v[148:149], v15 offset:0
    ds_read_b64_tr_b16 v[150:151], v15 offset:512
    ds_read_b128 v[168:171], v18 offset:0
    s_branch g1_cloop3
.p2align 3
g1_cloop:
    s_barrier
g1_cloop2:
    v_mfma_f32_16x16x32_bf16 v[24:27], v[172:175], v[196:199], v[24:27]
    ds_read_b64_tr_b16 v[128:129], v10 offset:0
    ds_read_b64_tr_b16 v[130:131], v10 offset:512
    v_mfma_f32_16x16x32_bf16 v[28:31], v[172:175], v[200:203], v[28:31]
    ds_read_b128 v[152:155], v16 offset:0
    v_mfma_f32_16x16x32_bf16 v[32:35], v[172:175], v[204:207], v[32:35]
    ds_read_b128 v[156:159], v16 offset:2048
    v_mfma_f32_16x16x32_bf16 v[36:39], v[172:175], v[208:211], v[36:39]
    ds_read_b128 v[160:163], v16 offset:4096
    v_mfma_f32_16x16x32_bf16 v[52:55], v[176:179], v[208:211], v[52:55]
    ds_read_b128 v[164:167], v16 offset:6144
    v_mfma_f32_16x16x32_bf16 v[48:51], v[176:179], v[204:207], v[48:51]
    ds_read_b64_tr_b16 v[132:133], v11 offset:0
    ds_read_b64_tr_b16 v[134:135], v11 offset:512
    v_mfma_f32_16x16x32_bf16 v[44:47], v[176:179], v[200:203], v[44:47]
    ds_read_b64_tr_b16 v[136:137], v12 offset:0
    ds_read_b64_tr_b16 v[138:139], v12 offset:512
    v_mfma_f32_16x16x32_bf16 v[40:43], v[176:179], v[196:199], v[40:43]
    ds_read_b64_tr_b16 v[140:141], v13 offset:0
    ds_read_b64_tr_b16 v[142:143], v13 offset:512
    v_mfma_f32_16x16x32_bf16 v[56:59], v[180:183], v[196:199], v[56:59]
    ds_read_b64_tr_b16 v[144:145], v14 offset:0
    ds_read_b64_tr_b16 v[146:147], v14 offset:512
    v_mfma_f32_16x16x32_bf16 v[60:63], v[180:183], v[200:203], v[60:63]
    ds_read_b64_tr_b16 v[148:149], v15 offset:0
    ds_read_b64_tr_b16 v[150:151], v15 offset:512
    v_mfma_f32_16x16x32_bf16 v[64:67], v[180:183], v[204:207], v[64:67]
    ds_read_b128 v[168:171], v18 offset:0
    v_mfma_f32_16x16x32_bf16 v[68:71], v[180:183], v[208:211], v[68:71]
    v_mfma_f32_16x16x32_bf16 v[84:87], v[184:187], v[208:211], v[84:87]
    v_mfma_f32_16x16x32_bf16 v[80:83], v[184:187], v[204:207], v[80:83]
    v_mfma_f32_16x16x32_bf16 v[76:79], v[184:187], v[200:203], v[76:79]
    v_mfma_f32_16x16x32_bf16 v[72:75], v[184:187], v[196:199], v[72:75]
    v_mfma_f32_16x16x32_bf16 v[88:91], v[188:191], v[196:199], v[88:91]
    v_mfma_f32_16x16x32_bf16 v[92:95], v[188:191], v[200:203], v[92:95]
    v_mfma_f32_16x16x32_bf16 v[96:99], v[188:191], v[204:207], v[96:99]
    v_mfma_f32_16x16x32_bf16 v[100:103], v[188:191], v[208:211], v[100:103]
    v_mfma_f32_16x16x32_bf16 v[120:123], v[188:191], v[212:215], v[120:123]
    v_mfma_f32_16x16x32_bf16 v[124:127], v[192:195], v[212:215], v[124:127]
    v_mfma_f32_16x16x32_bf16 v[116:119], v[192:195], v[208:211], v[116:119]
    v_mfma_f32_16x16x32_bf16 v[112:115], v[192:195], v[204:207], v[112:115]
    v_mfma_f32_16x16x32_bf16 v[108:111], v[192:195], v[200:203], v[108:111]
    v_mfma_f32_16x16x32_bf16 v[104:107], v[192:195], v[196:199], v[104:107]
g1_cloop3:
    s_waitcnt lgkmcnt(0)
    v_mfma_f32_16x16x32_bf16 v[24:27], v[128:131], v[152:155], v[24:27]
    ds_read_b64_tr_b16 v[172:173], v10 offset:4096
    ds_read_b64_tr_b16 v[174:175], v10 offset:4608
    v_mfma_f32_16x16x32_bf16 v[28:31], v[128:131], v[156:159], v[28:31]
    ds_read_b128 v[196:199], v17 offset:0
    v_mfma_f32_16x16x32_bf16 v[32:35], v[128:131], v[160:163], v[32:35]
    ds_read_b128 v[200:203], v17 offset:2048
    v_mfma_f32_16x16x32_bf16 v[36:39], v[128:131], v[164:167], v[36:39]
    ds_read_b128 v[204:207], v17 offset:4096
    v_mfma_f32_16x16x32_bf16 v[52:55], v[132:135], v[164:167], v[52:55]
    ds_read_b128 v[208:211], v17 offset:6144
    v_mfma_f32_16x16x32_bf16 v[48:51], v[132:135], v[160:163], v[48:51]
    ds_read_b64_tr_b16 v[176:177], v11 offset:4096
    ds_read_b64_tr_b16 v[178:179], v11 offset:4608
    v_mfma_f32_16x16x32_bf16 v[44:47], v[132:135], v[156:159], v[44:47]
    ds_read_b64_tr_b16 v[180:181], v12 offset:4096
    ds_read_b64_tr_b16 v[182:183], v12 offset:4608
    v_mfma_f32_16x16x32_bf16 v[40:43], v[132:135], v[152:155], v[40:43]
    ds_read_b64_tr_b16 v[184:185], v13 offset:4096
    ds_read_b64_tr_b16 v[186:187], v13 offset:4608
    v_mfma_f32_16x16x32_bf16 v[56:59], v[136:139], v[152:155], v[56:59]
    ds_read_b64_tr_b16 v[188:189], v14 offset:4096
    ds_read_b64_tr_b16 v[190:191], v14 offset:4608
    v_mfma_f32_16x16x32_bf16 v[60:63], v[136:139], v[156:159], v[60:63]
    ds_read_b64_tr_b16 v[192:193], v15 offset:4096
    ds_read_b64_tr_b16 v[194:195], v15 offset:4608
    v_mfma_f32_16x16x32_bf16 v[64:67], v[136:139], v[160:163], v[64:67]
    ds_read_b128 v[212:215], v19 offset:0
    v_mfma_f32_16x16x32_bf16 v[68:71], v[136:139], v[164:167], v[68:71]
    s_add_u32 s50, s50, 1
    s_cmp_eq_u32 s50, 3
    v_mfma_f32_16x16x32_bf16 v[84:87], v[140:143], v[164:167], v[84:87]
    s_cselect_b32 s49, s29, s51
    s_cselect_b32 s50, 0, s50
    v_mfma_f32_16x16x32_bf16 v[80:83], v[140:143], v[160:163], v[80:83]
    v_add_u32 v10, s49, v10
    v_add_u32 v11, s49, v11
    v_mfma_f32_16x16x32_bf16 v[76:79], v[140:143], v[156:159], v[76:79]
    v_add_u32 v12, s49, v12
    v_add_u32 v13, s49, v13
    v_mfma_f32_16x16x32_bf16 v[72:75], v[140:143], v[152:155], v[72:75]
    v_add_u32 v14, s49, v14
    v_add_u32 v15, s49, v15
    v_mfma_f32_16x16x32_bf16 v[88:91], v[144:147], v[152:155], v[88:91]
    v_add_u32 v16, s49, v16
    v_add_u32 v17, s49, v17
    v_mfma_f32_16x16x32_bf16 v[92:95], v[144:147], v[156:159], v[92:95]
    v_add_u32 v18, s49, v18
    v_add_u32 v19, s49, v19
    v_mfma_f32_16x16x32_bf16 v[96:99], v[144:147], v[160:163], v[96:99]
    s_sub_u32 s48, s48, 1
    s_cmp_lg_u32 s48, 0
    v_mfma_f32_16x16x32_bf16 v[100:103], v[144:147], v[164:167], v[100:103]
    v_mfma_f32_16x16x32_bf16 v[120:123], v[144:147], v[168:171], v[120:123]
    v_mfma_f32_16x16x32_bf16 v[124:127], v[148:151], v[168:171], v[124:127]
    v_mfma_f32_16x16x32_bf16 v[116:119], v[148:151], v[164:167], v[116:119]
    v_mfma_f32_16x16x32_bf16 v[112:115], v[148:151], v[160:163], v[112:115]
    v_mfma_f32_16x16x32_bf16 v[108:111], v[148:151], v[156:159], v[108:111]
    v_mfma_f32_16x16x32_bf16 v[104:107], v[148:151], v[152:155], v[104:107]
    s_waitcnt lgkmcnt(0)
    s_cbranch_scc1 g1_cloop
    ds_read_b64 v[128:129], v216 offset:0
    ds_read_b64 v[130:131], v216 offset:128
    ds_read_b64 v[132:133], v216 offset:256
    ds_read_b64 v[134:135], v216 offset:384
    ds_read_b64 v[136:137], v217
    ds_read_b128 v[140:143], v218 offset:0
    ds_read_b128 v[144:147], v218 offset:64
    ds_read_b128 v[148:151], v219 offset:0
    ds_read_b128 v[152:155], v219 offset:64
    ds_read_b128 v[156:159], v220 offset:0
    ds_read_b128 v[160:163], v220 offset:64
    v_mfma_f32_16x16x32_bf16 v[24:27], v[172:175], v[196:199], v[24:27]
    v_mfma_f32_16x16x32_bf16 v[40:43], v[176:179], v[196:199], v[40:43]
    v_mfma_f32_16x16x32_bf16 v[28:31], v[172:175], v[200:203], v[28:31]
    v_mfma_f32_16x16x32_bf16 v[44:47], v[176:179], v[200:203], v[44:47]
    v_mfma_f32_16x16x32_bf16 v[32:35], v[172:175], v[204:207], v[32:35]
    v_mfma_f32_16x16x32_bf16 v[48:51], v[176:179], v[204:207], v[48:51]
    s_waitcnt lgkmcnt(0)
    v_mfma_f32_16x16x32_bf16 v[36:39], v[172:175], v[208:211], v[36:39]
    v_pk_mul_f32 v[164:165], v[140:141], v[128:129] op_sel:[0,1] op_sel_hi:[1,1]
    v_pk_mul_f32 v[166:167], v[142:143], v[128:129] op_sel:[0,1] op_sel_hi:[1,1]
    v_pk_mul_f32 v[168:169], v[144:145], v[128:129] op_sel:[0,1] op_sel_hi:[1,1]
    v_pk_mul_f32 v[170:171], v[146:147], v[128:129] op_sel:[0,1] op_sel_hi:[1,1]
    v_pk_fma_f32 v[24:25], v[24:25], v[128:129], v[164:165] op_sel:[0,0,0] op_sel_hi:[1,0,1]
    v_pk_fma_f32 v[26:27], v[26:27], v[128:129], v[166:167] op_sel:[0,0,0] op_sel_hi:[1,0,1]
    v_pk_fma_f32 v[40:41], v[40:41], v[128:129], v[168:169] op_sel:[0,0,0] op_sel_hi:[1,0,1]
    v_pk_fma_f32 v[42:43], v[42:43], v[128:129], v[170:171] op_sel:[0,0,0] op_sel_hi:[1,0,1]
    v_mfma_f32_16x16x32_bf16 v[52:55], v[176:179], v[208:211], v[52:55]
    v_cvt_pk_bf16_f32 v232, v24, v25
    v_cvt_pk_bf16_f32 v233, v26, v27
    v_cvt_pk_bf16_f32 v234, v40, v41
    v_cvt_pk_bf16_f32 v235, v42, v43
    s_nop 1
    v_permlane16_swap_b32 v232, v234
    v_permlane16_swap_b32 v233, v235
    ds_write_b128 v221, v[232:235] offset:0
    v_mfma_f32_16x16x32_bf16 v[56:59], v[180:183], v[196:199], v[56:59]
    v_pk_mul_f32 v[164:165], v[140:141], v[130:131] op_sel:[0,1] op_sel_hi:[1,1]
    v_pk_mul_f32 v[166:167], v[142:143], v[130:131] op_sel:[0,1] op_sel_hi:[1,1]
    v_pk_mul_f32 v[168:169], v[144:145], v[130:131] op_sel:[0,1] op_sel_hi:[1,1]
    v_pk_mul_f32 v[170:171], v[146:147], v[130:131] op_sel:[0,1] op_sel_hi:[1,1]
    v_pk_fma_f32 v[28:29], v[28:29], v[130:131], v[164:165] op_sel:[0,0,0] op_sel_hi:[1,0,1]
    v_pk_fma_f32 v[30:31], v[30:31], v[130:131], v[166:167] op_sel:[0,0,0] op_sel_hi:[1,0,1]
    v_pk_fma_f32 v[44:45], v[44:45], v[130:131], v[168:169] op_sel:[0,0,0] op_sel_hi:[1,0,1]
    v_pk_fma_f32 v[46:47], v[46:47], v[130:131], v[170:171] op_sel:[0,0,0] op_sel_hi:[1,0,1]
    v_mfma_f32_16x16x32_bf16 v[72:75], v[184:187], v[196:199], v[72:75]
    v_cvt_pk_bf16_f32 v236, v28, v29
    v_cvt_pk_bf16_f32 v237, v30, v31
    v_cvt_pk_bf16_f32 v238, v44, v45
    v_cvt_pk_bf16_f32 v239, v46, v47
    s_nop 1
    v_permlane16_swap_b32 v236, v238
    v_permlane16_swap_b32 v237, v239
    ds_write_b128 v221, v[236:239] offset:2048
    v_mfma_f32_16x16x32_bf16 v[60:63], v[180:183], v[200:203], v[60:63]
    v_pk_mul_f32 v[164:165], v[140:141], v[132:133] op_sel:[0,1] op_sel_hi:[1,1]
    v_pk_mul_f32 v[166:167], v[142:143], v[132:133] op_sel:[0,1] op_sel_hi:[1,1]
    v_pk_mul_f32 v[168:169], v[144:145], v[132:133] op_sel:[0,1] op_sel_hi:[1,1]
    v_pk_mul_f32 v[170:171], v[146:147], v[132:133] op_sel:[0,1] op_sel_hi:[1,1]
    v_pk_fma_f32 v[32:33], v[32:33], v[132:133], v[164:165] op_sel:[0,0,0] op_sel_hi:[1,0,1]
    v_pk_fma_f32 v[34:35], v[34:35], v[132:133], v[166:167] op_sel:[0,0,0] op_sel_hi:[1,0,1]
    v_pk_fma_f32 v[48:49], v[48:49], v[132:133], v[168:169] op_sel:[0,0,0] op_sel_hi:[1,0,1]
    v_pk_fma_f32 v[50:51], v[50:51], v[132:133], v[170:171] op_sel:[0,0,0] op_sel_hi:[1,0,1]
    v_mfma_f32_16x16x32_bf16 v[76:79], v[184:187], v[200:203], v[76:79]
    v_cvt_pk_bf16_f32 v240, v32, v33
    v_cvt_pk_bf16_f32 v241, v34, v35
    v_cvt_pk_bf16_f32 v242, v48, v49
    v_cvt_pk_bf16_f32 v243, v50, v51
    s_nop 1
    v_permlane16_swap_b32 v240, v242
    v_permlane16_swap_b32 v241, v243
    ds_write_b128 v221, v[240:243] offset:4096
    v_mfma_f32_16x16x32_bf16 v[64:67], v[180:183], v[204:207], v[64:67]
    v_pk_mul_f32 v[164:165], v[140:141], v[134:135] op_sel:[0,1] op_sel_hi:[1,1]
    v_pk_mul_f32 v[166:167], v[142:143], v[134:135] op_sel:[0,1] op_sel_hi:[1,1]
    v_pk_mul_f32 v[168:169], v[144:145], v[134:135] op_sel:[0,1] op_sel_hi:[1,1]
    v_pk_mul_f32 v[170:171], v[146:147], v[134:135] op_sel:[0,1] op_sel_hi:[1,1]
    v_pk_fma_f32 v[36:37], v[36:37], v[134:135], v[164:165] op_sel:[0,0,0] op_sel_hi:[1,0,1]
    v_pk_fma_f32 v[38:39], v[38:39], v[134:135], v[166:167] op_sel:[0,0,0] op_sel_hi:[1,0,1]
    v_pk_fma_f32 v[52:53], v[52:53], v[134:135], v[168:169] op_sel:[0,0,0] op_sel_hi:[1,0,1]
    v_pk_fma_f32 v[54:55], v[54:55], v[134:135], v[170:171] op_sel:[0,0,0] op_sel_hi:[1,0,1]
    v_mfma_f32_16x16x32_bf16 v[80:83], v[184:187], v[204:207], v[80:83]
    v_cvt_pk_bf16_f32 v244, v36, v37
    v_cvt_pk_bf16_f32 v245, v38, v39
    v_cvt_pk_bf16_f32 v246, v52, v53
    v_cvt_pk_bf16_f32 v247, v54, v55
    s_nop 1
    v_permlane16_swap_b32 v244, v246
    v_permlane16_swap_b32 v245, v247
    ds_write_b128 v221, v[244:247] offset:6144
    v_mfma_f32_16x16x32_bf16 v[68:71], v[180:183], v[208:211], v[68:71]
    v_pk_mul_f32 v[164:165], v[148:149], v[128:129] op_sel:[0,1] op_sel_hi:[1,1]
    v_pk_mul_f32 v[166:167], v[150:151], v[128:129] op_sel:[0,1] op_sel_hi:[1,1]
    v_pk_mul_f32 v[168:169], v[152:153], v[128:129] op_sel:[0,1] op_sel_hi:[1,1]
    v_pk_mul_f32 v[170:171], v[154:155], v[128:129] op_sel:[0,1] op_sel_hi:[1,1]
    v_pk_fma_f32 v[56:57], v[56:57], v[128:129], v[164:165] op_sel:[0,0,0] op_sel_hi:[1,0,1]
    v_pk_fma_f32 v[58:59], v[58:59], v[128:129], v[166:167] op_sel:[0,0,0] op_sel_hi:[1,0,1]
    v_pk_fma_f32 v[72:73], v[72:73], v[128:129], v[168:169] op_sel:[0,0,0] op_sel_hi:[1,0,1]
    v_pk_fma_f32 v[74:75], v[74:75], v[128:129], v[170:171] op_sel:[0,0,0] op_sel_hi:[1,0,1]
    v_mfma_f32_16x16x32_bf16 v[84:87], v[184:187], v[208:211], v[84:87]
    v_cvt_pk_bf16_f32 v232, v56, v57
    v_cvt_pk_bf16_f32 v233, v58, v59
    v_cvt_pk_bf16_f32 v234, v72, v73
    v_cvt_pk_bf16_f32 v235, v74, v75
    s_nop 1
    v_permlane16_swap_b32 v232, v234
    v_permlane16_swap_b32 v233, v235
    ds_write_b128 v222, v[232:235] offset:0
    v_mfma_f32_16x16x32_bf16 v[88:91], v[188:191], v[196:199], v[88:91]
    v_pk_mul_f32 v[164:165], v[148:149], v[130:131] op_sel:[0,1] op_sel_hi:[1,1]
    v_pk_mul_f32 v[166:167], v[150:151], v[130:131] op_sel:[0,1] op_sel_hi:[1,1]
    v_pk_mul_f32 v[168:169], v[152:153], v[130:131] op_sel:[0,1] op_sel_hi:[1,1]
    v_pk_mul_f32 v[170:171], v[154:155], v[130:131] op_sel:[0,1] op_sel_hi:[1,1]
    v_pk_fma_f32 v[60:61], v[60:61], v[130:131], v[164:165] op_sel:[0,0,0] op_sel_hi:[1,0,1]
    v_pk_fma_f32 v[62:63], v[62:63], v[130:131], v[166:167] op_sel:[0,0,0] op_sel_hi:[1,0,1]
    v_pk_fma_f32 v[76:77], v[76:77], v[130:131], v[168:169] op_sel:[0,0,0] op_sel_hi:[1,0,1]
    v_pk_fma_f32 v[78:79], v[78:79], v[130:131], v[170:171] op_sel:[0,0,0] op_sel_hi:[1,0,1]
    v_mfma_f32_16x16x32_bf16 v[104:107], v[192:195], v[196:199], v[104:107]
    v_cvt_pk_bf16_f32 v236, v60, v61
    v_cvt_pk_bf16_f32 v237, v62, v63
    v_cvt_pk_bf16_f32 v238, v76, v77
    v_cvt_pk_bf16_f32 v239, v78, v79
    s_nop 1
    v_permlane16_swap_b32 v236, v238
    v_permlane16_swap_b32 v237, v239
    ds_write_b128 v222, v[236:239] offset:2048
    v_mfma_f32_16x16x32_bf16 v[92:95], v[188:191], v[200:203], v[92:95]
    v_pk_mul_f32 v[164:165], v[148:149], v[132:133] op_sel:[0,1] op_sel_hi:[1,1]
    v_pk_mul_f32 v[166:167], v[150:151], v[132:133] op_sel:[0,1] op_sel_hi:[1,1]
    v_pk_mul_f32 v[168:169], v[152:153], v[132:133] op_sel:[0,1] op_sel_hi:[1,1]
    v_pk_mul_f32 v[170:171], v[154:155], v[132:133] op_sel:[0,1] op_sel_hi:[1,1]
    v_pk_fma_f32 v[64:65], v[64:65], v[132:133], v[164:165] op_sel:[0,0,0] op_sel_hi:[1,0,1]
    v_pk_fma_f32 v[66:67], v[66:67], v[132:133], v[166:167] op_sel:[0,0,0] op_sel_hi:[1,0,1]
    v_pk_fma_f32 v[80:81], v[80:81], v[132:133], v[168:169] op_sel:[0,0,0] op_sel_hi:[1,0,1]
    v_pk_fma_f32 v[82:83], v[82:83], v[132:133], v[170:171] op_sel:[0,0,0] op_sel_hi:[1,0,1]
    v_mfma_f32_16x16x32_bf16 v[108:111], v[192:195], v[200:203], v[108:111]
    v_cvt_pk_bf16_f32 v240, v64, v65
    v_cvt_pk_bf16_f32 v241, v66, v67
    v_cvt_pk_bf16_f32 v242, v80, v81
    v_cvt_pk_bf16_f32 v243, v82, v83
    s_nop 1
    v_permlane16_swap_b32 v240, v242
    v_permlane16_swap_b32 v241, v243
    ds_write_b128 v222, v[240:243] offset:4096
    v_mfma_f32_16x16x32_bf16 v[96:99], v[188:191], v[204:207], v[96:99]
    v_pk_mul_f32 v[164:165], v[148:149], v[134:135] op_sel:[0,1] op_sel_hi:[1,1]
    v_pk_mul_f32 v[166:167], v[150:151], v[134:135] op_sel:[0,1] op_sel_hi:[1,1]
    v_pk_mul_f32 v[168:169], v[152:153], v[134:135] op_sel:[0,1] op_sel_hi:[1,1]
    v_pk_mul_f32 v[170:171], v[154:155], v[134:135] op_sel:[0,1] op_sel_hi:[1,1]
    v_pk_fma_f32 v[68:69], v[68:69], v[134:135], v[164:165] op_sel:[0,0,0] op_sel_hi:[1,0,1]
    v_pk_fma_f32 v[70:71], v[70:71], v[134:135], v[166:167] op_sel:[0,0,0] op_sel_hi:[1,0,1]
    v_pk_fma_f32 v[84:85], v[84:85], v[134:135], v[168:169] op_sel:[0,0,0] op_sel_hi:[1,0,1]
    v_pk_fma_f32 v[86:87], v[86:87], v[134:135], v[170:171] op_sel:[0,0,0] op_sel_hi:[1,0,1]
    v_mfma_f32_16x16x32_bf16 v[112:115], v[192:195], v[204:207], v[112:115]
    v_cvt_pk_bf16_f32 v244, v68, v69
    v_cvt_pk_bf16_f32 v245, v70, v71
    v_cvt_pk_bf16_f32 v246, v84, v85
    v_cvt_pk_bf16_f32 v247, v86, v87
    s_nop 1
    v_permlane16_swap_b32 v244, v246
    v_permlane16_swap_b32 v245, v247
    ds_write_b128 v222, v[244:247] offset:6144
    v_mfma_f32_16x16x32_bf16 v[100:103], v[188:191], v[208:211], v[100:103]
    v_pk_mul_f32 v[164:165], v[156:157], v[128:129] op_sel:[0,1] op_sel_hi:[1,1]
    v_pk_mul_f32 v[166:167], v[158:159], v[128:129] op_sel:[0,1] op_sel_hi:[1,1]
    v_pk_mul_f32 v[168:169], v[160:161], v[128:129] op_sel:[0,1] op_sel_hi:[1,1]
    v_pk_mul_f32 v[170:171], v[162:163], v[128:129] op_sel:[0,1] op_sel_hi:[1,1]
    v_pk_fma_f32 v[88:89], v[88:89], v[128:129], v[164:165] op_sel:[0,0,0] op_sel_hi:[1,0,1]
    v_pk_fma_f32 v[90:91], v[90:91], v[128:129], v[166:167] op_sel:[0,0,0] op_sel_hi:[1,0,1]
    v_pk_fma_f32 v[104:105], v[104:105], v[128:129], v[168:169] op_sel:[0,0,0] op_sel_hi:[1,0,1]
    v_pk_fma_f32 v[106:107], v[106:107], v[128:129], v[170:171] op_sel:[0,0,0] op_sel_hi:[1,0,1]
    v_mfma_f32_16x16x32_bf16 v[116:119], v[192:195], v[208:211], v[116:119]
    v_cvt_pk_bf16_f32 v232, v88, v89
    v_cvt_pk_bf16_f32 v233, v90, v91
    v_cvt_pk_bf16_f32 v234, v104, v105
    v_cvt_pk_bf16_f32 v235, v106, v107
    s_nop 1
    v_permlane16_swap_b32 v232, v234
    v_permlane16_swap_b32 v233, v235
    ds_write_b128 v223, v[232:235] offset:0
    v_mfma_f32_16x16x32_bf16 v[120:123], v[188:191], v[212:215], v[120:123]
    v_pk_mul_f32 v[164:165], v[156:157], v[130:131] op_sel:[0,1] op_sel_hi:[1,1]
    v_pk_mul_f32 v[166:167], v[158:159], v[130:131] op_sel:[0,1] op_sel_hi:[1,1]
    v_pk_mul_f32 v[168:169], v[160:161], v[130:131] op_sel:[0,1] op_sel_hi:[1,1]
    v_pk_mul_f32 v[170:171], v[162:163], v[130:131] op_sel:[0,1] op_sel_hi:[1,1]
    v_pk_fma_f32 v[92:93], v[92:93], v[130:131], v[164:165] op_sel:[0,0,0] op_sel_hi:[1,0,1]
    v_pk_fma_f32 v[94:95], v[94:95], v[130:131], v[166:167] op_sel:[0,0,0] op_sel_hi:[1,0,1]
    v_pk_fma_f32 v[108:109], v[108:109], v[130:131], v[168:169] op_sel:[0,0,0] op_sel_hi:[1,0,1]
    v_pk_fma_f32 v[110:111], v[110:111], v[130:131], v[170:171] op_sel:[0,0,0] op_sel_hi:[1,0,1]
    v_mfma_f32_16x16x32_bf16 v[124:127], v[192:195], v[212:215], v[124:127]
    v_cvt_pk_bf16_f32 v236, v92, v93
    v_cvt_pk_bf16_f32 v237, v94, v95
    v_cvt_pk_bf16_f32 v238, v108, v109
    v_cvt_pk_bf16_f32 v239, v110, v111
    s_nop 1
    v_permlane16_swap_b32 v236, v238
    v_permlane16_swap_b32 v237, v239
    ds_write_b128 v223, v[236:239] offset:2048
    v_pk_mul_f32 v[164:165], v[156:157], v[132:133] op_sel:[0,1] op_sel_hi:[1,1]
    v_pk_mul_f32 v[166:167], v[158:159], v[132:133] op_sel:[0,1] op_sel_hi:[1,1]
    v_pk_mul_f32 v[168:169], v[160:161], v[132:133] op_sel:[0,1] op_sel_hi:[1,1]
    v_pk_mul_f32 v[170:171], v[162:163], v[132:133] op_sel:[0,1] op_sel_hi:[1,1]
    v_pk_fma_f32 v[96:97], v[96:97], v[132:133], v[164:165] op_sel:[0,0,0] op_sel_hi:[1,0,1]
    v_pk_fma_f32 v[98:99], v[98:99], v[132:133], v[166:167] op_sel:[0,0,0] op_sel_hi:[1,0,1]
    v_pk_fma_f32 v[112:113], v[112:113], v[132:133], v[168:169] op_sel:[0,0,0] op_sel_hi:[1,0,1]
    v_pk_fma_f32 v[114:115], v[114:115], v[132:133], v[170:171] op_sel:[0,0,0] op_sel_hi:[1,0,1]
    v_cvt_pk_bf16_f32 v240, v96, v97
    v_cvt_pk_bf16_f32 v241, v98, v99
    v_cvt_pk_bf16_f32 v242, v112, v113
    v_cvt_pk_bf16_f32 v243, v114, v115
    s_nop 1
    v_permlane16_swap_b32 v240, v242
    v_permlane16_swap_b32 v241, v243
    ds_write_b128 v223, v[240:243] offset:4096
    v_pk_mul_f32 v[164:165], v[156:157], v[134:135] op_sel:[0,1] op_sel_hi:[1,1]
    v_pk_mul_f32 v[166:167], v[158:159], v[134:135] op_sel:[0,1] op_sel_hi:[1,1]
    v_pk_mul_f32 v[168:169], v[160:161], v[134:135] op_sel:[0,1] op_sel_hi:[1,1]
    v_pk_mul_f32 v[170:171], v[162:163], v[134:135] op_sel:[0,1] op_sel_hi:[1,1]
    v_pk_fma_f32 v[100:101], v[100:101], v[134:135], v[164:165] op_sel:[0,0,0] op_sel_hi:[1,0,1]
    v_pk_fma_f32 v[102:103], v[102:103], v[134:135], v[166:167] op_sel:[0,0,0] op_sel_hi:[1,0,1]
    v_pk_fma_f32 v[116:117], v[116:117], v[134:135], v[168:169] op_sel:[0,0,0] op_sel_hi:[1,0,1]
    v_pk_fma_f32 v[118:119], v[118:119], v[134:135], v[170:171] op_sel:[0,0,0] op_sel_hi:[1,0,1]
    v_cvt_pk_bf16_f32 v244, v100, v101
    v_cvt_pk_bf16_f32 v245, v102, v103
    v_cvt_pk_bf16_f32 v246, v116, v117
    v_cvt_pk_bf16_f32 v247, v118, v119
    s_nop 1
    v_permlane16_swap_b32 v244, v246
    v_permlane16_swap_b32 v245, v247
    ds_write_b128 v223, v[244:247] offset:6144
    v_pk_mul_f32 v[164:165], v[156:157], v[136:137] op_sel:[0,1] op_sel_hi:[1,1]
    v_pk_mul_f32 v[166:167], v[158:159], v[136:137] op_sel:[0,1] op_sel_hi:[1,1]
    v_pk_mul_f32 v[168:169], v[160:161], v[136:137] op_sel:[0,1] op_sel_hi:[1,1]
    v_pk_mul_f32 v[170:171], v[162:163], v[136:137] op_sel:[0,1] op_sel_hi:[1,1]
    v_pk_fma_f32 v[120:121], v[120:121], v[136:137], v[164:165] op_sel:[0,0,0] op_sel_hi:[1,0,1]
    v_pk_fma_f32 v[122:123], v[122:123], v[136:137], v[166:167] op_sel:[0,0,0] op_sel_hi:[1,0,1]
    v_pk_fma_f32 v[124:125], v[124:125], v[136:137], v[168:169] op_sel:[0,0,0] op_sel_hi:[1,0,1]
    v_pk_fma_f32 v[126:127], v[126:127], v[136:137], v[170:171] op_sel:[0,0,0] op_sel_hi:[1,0,1]
    v_cvt_pk_bf16_f32 v232, v120, v121
    v_cvt_pk_bf16_f32 v233, v122, v123
    v_cvt_pk_bf16_f32 v234, v124, v125
    v_cvt_pk_bf16_f32 v235, v126, v127
    s_nop 1
    v_permlane16_swap_b32 v232, v234
    v_permlane16_swap_b32 v233, v235
    ds_write_b128 v224, v[232:235]
    s_waitcnt lgkmcnt(0)
g1_attn:
    s_barrier
    ds_read_b128 v[24:27], v226 offset:2048
    ds_read_b128 v[28:31], v226 offset:18432
    ds_read_b128 v[32:35], v226 offset:20480
    ds_read_b128 v[72:75], v226 offset:2176
    ds_read_b128 v[76:79], v226 offset:18560
    ds_read_b128 v[80:83], v226 offset:20608
    ds_read_b64_tr_b16 v[36:37], v227 offset:0
    ds_read_b64_tr_b16 v[38:39], v227 offset:2048
    ds_read_b64_tr_b16 v[40:41], v227 offset:8
    ds_read_b64_tr_b16 v[42:43], v227 offset:2056
    ds_read_b64_tr_b16 v[84:85], v227 offset:128
    ds_read_b64_tr_b16 v[86:87], v227 offset:2176
    ds_read_b64_tr_b16 v[88:89], v227 offset:136
    ds_read_b64_tr_b16 v[90:91], v227 offset:2184
    s_waitcnt lgkmcnt(8)
    v_mfma_f32_16x16x32_bf16 v[44:47], v[28:31], v[24:27], 0
    v_mfma_f32_16x16x32_bf16 v[48:51], v[32:35], v[24:27], 0
    v_mfma_f32_16x16x32_bf16 v[92:95], v[76:79], v[72:75], 0
    v_mfma_f32_16x16x32_bf16 v[96:99], v[80:83], v[72:75], 0
    s_nop 7
    v_cndmask_b32 v44, v48, v44, s[56:57]
    v_cndmask_b32 v45, v49, v45, s[56:57]
    v_cndmask_b32 v46, v50, v46, s[56:57]
    v_cndmask_b32 v47, v51, v47, s[56:57]
    v_cndmask_b32 v92, v96, v92, s[56:57]
    v_cndmask_b32 v93, v97, v93, s[56:57]
    v_cndmask_b32 v94, v98, v94, s[56:57]
    v_cndmask_b32 v95, v99, v95, s[56:57]
    v_cvt_pk_bf16_f32 v48, v44, v45
    v_cvt_pk_bf16_f32 v49, v46, v47
    v_cvt_pk_bf16_f32 v96, v92, v93
    v_cvt_pk_bf16_f32 v97, v94, v95
    v_lshlrev_b32 v44, 16, v48
    v_and_b32 v45, 0xffff0000, v48
    v_lshlrev_b32 v46, 16, v49
    v_and_b32 v47, 0xffff0000, v49
    v_lshlrev_b32 v92, 16, v96
    v_and_b32 v93, 0xffff0000, v96
    v_lshlrev_b32 v94, 16, v97
    v_and_b32 v95, 0xffff0000, v97
    v_mul_f32 v44, s58, v44
    v_mul_f32 v45, s58, v45
    v_mul_f32 v46, s58, v46
    v_mul_f32 v47, s58, v47
    v_mul_f32 v92, s58, v92
    v_mul_f32 v93, s58, v93
    v_mul_f32 v94, s58, v94
    v_mul_f32 v95, s58, v95
    v_cvt_pk_bf16_f32 v48, v44, v45
    v_cvt_pk_bf16_f32 v49, v46, v47
    v_cvt_pk_bf16_f32 v96, v92, v93
    v_cvt_pk_bf16_f32 v97, v94, v95
    v_lshlrev_b32 v44, 16, v48
    v_and_b32 v45, 0xffff0000, v48
    v_lshlrev_b32 v46, 16, v49
    v_and_b32 v47, 0xffff0000, v49
    v_lshlrev_b32 v92, 16, v96
    v_and_b32 v93, 0xffff0000, v96
    v_lshlrev_b32 v94, 16, v97
    v_and_b32 v95, 0xffff0000, v97
    v_fma_f32 v44, v44, s59, v228
    v_fma_f32 v45, v45, s59, v229
    v_fma_f32 v46, v46, s59, v230
    v_fma_f32 v47, v47, s59, v231
    v_fma_f32 v92, v92, s59, v228
    v_fma_f32 v93, v93, s59, v229
    v_fma_f32 v94, v94, s59, v230
    v_fma_f32 v95, v95, s59, v231
    v_max3_f32 v48, v44, v45, v46
    v_max3_f32 v96, v92, v93, v94
    v_max_f32 v48, v48, v47
    v_max_f32 v96, v96, v95
    v_mov_b32 v49, v48
    v_mov_b32 v97, v96
    s_nop 1
    v_permlane16_swap_b32 v48, v49
    v_permlane16_swap_b32 v96, v97
    s_nop 0
    v_max_f32 v48, v48, v49
    v_max_f32 v96, v96, v97
    v_mov_b32 v49, v48
    v_mov_b32 v97, v96
    s_nop 1
    v_permlane32_swap_b32 v48, v49
    v_permlane32_swap_b32 v96, v97
    s_nop 0
    v_max_f32 v48, v48, v49
    v_max_f32 v96, v96, v97
    v_sub_f32 v44, v44, v48
    v_sub_f32 v45, v45, v48
    v_sub_f32 v46, v46, v48
    v_sub_f32 v47, v47, v48
    v_sub_f32 v92, v92, v96
    v_sub_f32 v93, v93, v96
    v_sub_f32 v94, v94, v96
    v_sub_f32 v95, v95, v96
    v_exp_f32 v44, v44
    v_exp_f32 v45, v45
    v_exp_f32 v46, v46
    v_exp_f32 v47, v47
    v_exp_f32 v92, v92
    v_exp_f32 v93, v93
    v_exp_f32 v94, v94
    v_exp_f32 v95, v95
    v_add_f32 v48, v44, v45
    v_add_f32 v49, v46, v47
    v_add_f32 v96, v92, v93
    v_add_f32 v97, v94, v95
    v_add_f32 v48, v48, v49
    v_add_f32 v96, v96, v97
    v_mov_b32 v49, v48
    v_mov_b32 v97, v96
    s_nop 1
    v_permlane16_swap_b32 v48, v49
    v_permlane16_swap_b32 v96, v97
    s_nop 0
    v_add_f32 v48, v48, v49
    v_add_f32 v96, v96, v97
    v_mov_b32 v49, v48
    v_mov_b32 v97, v96
    s_nop 1
    v_permlane32_swap_b32 v48, v49
    v_permlane32_swap_b32 v96, v97
    s_nop 0
    v_add_f32 v48, v48, v49
    v_add_f32 v96, v96, v97
    v_rcp_f32 v48, v48
    v_rcp_f32 v96, v96
    s_nop 0
    v_mul_f32 v44, v44, v48
    v_mul_f32 v45, v45, v48
    v_mul_f32 v46, v46, v48
    v_mul_f32 v47, v47, v48
    v_mul_f32 v92, v92, v96
    v_mul_f32 v93, v93, v96
    v_mul_f32 v94, v94, v96
    v_mul_f32 v95, v95, v96
    v_cvt_pk_bf16_f32 v48, v44, v45
    v_cvt_pk_bf16_f32 v49, v46, v47
    v_cvt_pk_bf16_f32 v96, v92, v93
    v_cvt_pk_bf16_f32 v97, v94, v95
    v_cndmask_b32 v52, 0, v48, s[56:57]
    v_cndmask_b32 v53, 0, v49, s[56:57]
    v_cndmask_b32 v54, v48, 0, s[56:57]
    v_cndmask_b32 v55, v49, 0, s[56:57]
    v_cndmask_b32 v100, 0, v96, s[56:57]
    v_cndmask_b32 v101, 0, v97, s[56:57]
    v_cndmask_b32 v102, v96, 0, s[56:57]
    v_cndmask_b32 v103, v97, 0, s[56:57]
    s_waitcnt lgkmcnt(0)
    s_nop 0
    v_mfma_f32_16x16x32_bf16 v[56:59], v[36:39], v[52:55], 0
    v_mfma_f32_16x16x32_bf16 v[60:63], v[40:43], v[52:55], 0
    v_mfma_f32_16x16x32_bf16 v[104:107], v[84:87], v[100:103], 0
    v_mfma_f32_16x16x32_bf16 v[108:111], v[88:91], v[100:103], 0
    s_nop 7
    v_cvt_pk_bf16_f32 v64, v56, v57
    v_cvt_pk_bf16_f32 v65, v58, v59
    v_cvt_pk_bf16_f32 v66, v60, v61
    v_cvt_pk_bf16_f32 v67, v62, v63
    buffer_store_dwordx4 v[64:67], v225, s[16:19], 0 offen offset:0 sc1
    v_cvt_pk_bf16_f32 v112, v104, v105
    v_cvt_pk_bf16_f32 v113, v106, v107
    v_cvt_pk_bf16_f32 v114, v108, v109
    v_cvt_pk_bf16_f32 v115, v110, v111
    buffer_store_dwordx4 v[112:115], v225, s[16:19], 0 offen offset:2048 sc1
    s_add_u32 s40, s25, 0
    s_lshl_b32 s40, s40, 12
    s_mov_b32 s41, s24
    s_add_u32 s84, s4, 0x300000
    s_addc_u32 s85, s5, 0
    s_mov_b32 s86, 0x40000
    s_mov_b32 s87, 0x20000
    s_lshl_b32 s41, s41, 2
    s_add_u32 s40, s40, s41
    v_and_b32 v3, 31, v0
    v_lshl_add_u32 v3, v3, 7, s40
    v_mov_b32 v4, 1
    s_waitcnt vmcnt(0)
    s_barrier
    s_cmp_lg_u32 s28, 0
    s_cbranch_scc1 g1_cin
    s_mov_b32 exec_hi, 0
    s_mov_b32 exec_lo, 0xffff
    buffer_store_dword v4, v3, s[84:87], 0 offen sc1
    s_mov_b64 exec, -1
g1_cin:
    s_branch g2_in
g1_done:
    s_endpgm
.p2align 6
g2_in:
    s_cmp_ge_u32 s2, 256
    s_cbranch_scc1 g2_done
    s_load_dwordx2 s[4:5], s[0:1], 80
    s_load_dwordx2 s[6:7], s[0:1], 0
    s_load_dwordx2 s[30:31], s[0:1], 16
    v_lshrrev_b32 v1, 6, v0
    v_and_b32 v2, 63, v0
    s_and_b32 s40, s2, 3
    s_lshl_b32 s40, s40, 2
    s_bfe_u32 s41, s2, 0x20003
    s_add_u32 s25, s40, s41
    s_bfe_u32 s40, s2, 0x10002
    s_lshl_b32 s40, s40, 3
    s_lshr_b32 s42, s2, 5
    s_add_u32 s24, s40, s42
    s_add_u32 s27, s41, s42
    s_mov_b32 s26, 0
    v_readfirstlane_b32 s28, v1
    s_nop 0
    s_cmp_lt_u32 s28, 4
    s_cbranch_scc1 g2_compute
    s_sub_u32 s28, s28, 4
    s_mov_b32 s40, 2048
    v_lshrrev_b32 v3, 3, v2
    v_mul_lo_u32 v3, v3, s40
    v_bfe_u32 v4, v2, 4, 1
    v_lshlrev_b32 v4, 1, v4
    v_xor_b32 v4, v4, v2
    v_and_b32 v4, 7, v4
    v_lshl_add_u32 v3, v4, 4, v3
    s_mul_i32 s41, s24, 128
    s_mul_i32 s42, s28, 32768
    s_add_u32 s41, s41, s42
    v_xor_b32 v4, 64, v3
    s_add_u32 s42, s41, 0
    v_add_u32 v10, s42, v3
    s_add_u32 s42, s41, 16384
    v_add_u32 v11, s42, v4
    s_mov_b32 s40, 2048
    v_lshrrev_b32 v3, 3, v2
    v_mul_lo_u32 v3, v3, s40
    v_lshrrev_b32 v4, 4, v2
    v_xor_b32 v4, v4, v2
    v_and_b32 v4, 7, v4
    v_lshl_add_u32 v3, v4, 4, v3
    s_mul_i32 s41, s25, 262144
    s_mul_i32 s42, s28, 65536
    s_add_u32 s41, s41, s42
    v_xor_b32 v4, 64, v3
    s_add_u32 s42, s41, 0
    v_add_u32 v12, s42, v3
    s_add_u32 s42, s41, 16384
    v_add_u32 v13, s42, v4
    s_add_u32 s42, s41, 32768
    v_add_u32 v14, s42, v3
    s_add_u32 s42, s41, 49152
    v_add_u32 v15, s42, v4
    s_mul_i32 s36, s28, 2048
    s_mul_i32 s37, s28, 4096
    s_add_u32 s37, s37, 8192
    s_waitcnt lgkmcnt(0)
    s_add_u32 s4, s4, s97
    s_addc_u32 s5, s5, 0
    s_mov_b32 s8, s30
    s_mov_b32 s9, s31
    s_mov_b32 s10, 0x200000
    s_mov_b32 s11, 0x20000
    s_add_u32 s12, s4, 0x400000
    s_addc_u32 s13, s5, 0
    s_mov_b32 s14, 0x400000
    s_mov_b32 s15, 0x20000
    s_mov_b32 s32, 0
    s_mov_b32 s33, 0
g2_ld_pW:
    s_add_u32 s40, s32, s27
    s_and_b32 s40, s40, 1
    s_andn2_b32 s41, s32, 1
    s_or_b32 s40, s40, s41
    s_add_u32 s40, s40, s26
    s_mul_i32 s34, s40, 131072
    s_mul_i32 s35, s40, 128
    s_add_u32 s38, s33, s36
    s_add_u32 s39, s33, s37
    s_add_u32 m0, s38, 0
    s_nop 0
    buffer_load_dwordx4 v10, s[8:11], s34 offen lds
    s_add_u32 m0, s38, 1024
    s_nop 0
    buffer_load_dwordx4 v11, s[8:11], s34 offen lds
    s_add_u32 s33, s33, 24576
    s_add_u32 s32, s32, 1
    s_cmp_lt_u32 s32, 4
    s_cbranch_scc1 g2_ld_pW
    s_lshr_b32 s40, s25, 0
    s_add_u32 s40, s40, 0
    s_lshl_b32 s40, s40, 12
    s_mov_b32 s42, s40
    s_lshl_b32 s41, s24, 7
    s_add_u32 s40, s40, s41
    s_mov_b32 s42, s40
    s_lshl_b32 s43, s96, 2
    s_add_u32 s43, s43, 2
    s_mov_b32 s41, 0x800000
    v_mov_b32 v24, 131072
    s_cmp_lg_u32 s28, 0
    s_cbranch_scc1 g2_dep_lds
    s_add_u32 s84, s4, 0x300000
    s_addc_u32 s85, s5, 0
    s_mov_b32 s86, 0x40000
    s_mov_b32 s87, 0x20000
    v_cmp_gt_u32 vcc, 32, v2
    v_mov_b32 v21, s40
    v_mov_b32 v23, s42
    v_cndmask_b32 v21, v23, v21, vcc
    v_mov_b32 v22, 15
    v_mov_b32 v23, 15
    v_cndmask_b32 v22, v23, v22, vcc
    v_and_b32 v23, 31, v2
    v_min_u32 v23, v23, v22
    v_lshl_add_u32 v21, v23, 2, v21
    s_mov_b32 s41, 0x40000
    s_mov_b32 s44, 0xf
    s_mov_b32 s45, 0x0
g2_dep:
    buffer_load_dword v23, v21, s[84:87], 0 offen sc1
    s_sub_u32 s41, s41, 1
    s_waitcnt vmcnt(0)
g2_dep_chk:
    v_cmp_eq_u32 vcc, 0, v23
    s_cmp_eq_u32 s41, 0
    s_cbranch_scc1 g2_dep_seen
    s_and_b64 vcc, vcc, s[44:45]
    s_cbranch_scc0 g2_dep_seen
    s_sleep 2
    s_branch g2_dep
g2_dep_seen:
    v_mov_b32 v22, s43
    ds_write_b32 v24, v22
    s_branch g2_dep_ok
g2_dep_lds:
    ds_read_b32 v23, v24
    s_sub_u32 s41, s41, 1
    s_waitcnt lgkmcnt(0)
    v_readfirstlane_b32 s40, v23
    s_cmp_eq_u32 s41, 0
    s_cbranch_scc1 g2_dep_ok
    s_cmp_eq_u32 s40, s43
    s_cbranch_scc1 g2_dep_ok
    s_sleep 1
    s_branch g2_dep_lds
g2_dep_ok:
    s_mov_b32 s32, 0
    s_mov_b32 s33, 0
g2_ld_pA:
    s_add_u32 s40, s32, s27
    s_and_b32 s40, s40, 1
    s_andn2_b32 s41, s32, 1
    s_or_b32 s40, s40, s41
    s_add_u32 s40, s40, s26
    s_mul_i32 s34, s40, 131072
    s_mul_i32 s35, s40, 128
    s_add_u32 s38, s33, s36
    s_add_u32 s39, s33, s37
    s_add_u32 m0, s39, 0
    s_nop 0
    buffer_load_dwordx4 v12, s[12:15], s35 offen sc1 lds
    s_add_u32 m0, s39, 1024
    s_nop 0
    buffer_load_dwordx4 v13, s[12:15], s35 offen sc1 lds
    s_add_u32 m0, s39, 2048
    s_nop 0
    buffer_load_dwordx4 v14, s[12:15], s35 offen sc1 lds
    s_add_u32 m0, s39, 3072
    s_nop 0
    buffer_load_dwordx4 v15, s[12:15], s35 offen sc1 lds
    s_add_u32 s33, s33, 24576
    s_add_u32 s32, s32, 1
    s_cmp_lt_u32 s32, 3
    s_cbranch_scc1 g2_ld_pA
    s_lshr_b32 s40, s25, 0
    s_add_u32 s40, s40, 0
    s_lshl_b32 s40, s40, 12
    s_mov_b32 s42, s40
    s_lshl_b32 s41, s24, 7
    s_add_u32 s40, s40, s41
    s_mov_b32 s42, s40
    s_cmp_lg_u32 s28, 0
    s_cbranch_scc1 g2_dep_rok
    s_mov_b32 s41, 0x40000
    s_add_u32 s84, s4, 0x300000
    s_addc_u32 s85, s5, 0
    s_mov_b32 s86, 0x40000
    s_mov_b32 s87, 0x20000
g2_dep_r:
    v_cmp_eq_u32 vcc, 0, v23
    s_sub_u32 s41, s41, 1
    s_cmp_eq_u32 s41, 0
    s_cbranch_scc1 g2_dep_rok
    s_cbranch_vccz g2_dep_rok
    s_sleep 2
    buffer_load_dword v23, v21, s[84:87], 0 offen sc1
    s_waitcnt vmcnt(0)
    s_branch g2_dep_r
g2_dep_rok:
    s_waitcnt vmcnt(8)
    s_barrier
    s_add_u32 s40, s32, s27
    s_and_b32 s40, s40, 1
    s_andn2_b32 s41, s32, 1
    s_or_b32 s40, s40, s41
    s_add_u32 s40, s40, s26
    s_mul_i32 s34, s40, 131072
    s_mul_i32 s35, s40, 128
    s_add_u32 s38, s33, s36
    s_add_u32 s39, s33, s37
    s_add_u32 m0, s39, 0
    s_nop 0
    buffer_load_dwordx4 v12, s[12:15], s35 offen sc1 lds
    s_add_u32 m0, s39, 1024
    s_nop 0
    buffer_load_dwordx4 v13, s[12:15], s35 offen sc1 lds
    s_add_u32 m0, s39, 2048
    s_nop 0
    buffer_load_dwordx4 v14, s[12:15], s35 offen sc1 lds
    s_add_u32 m0, s39, 3072
    s_nop 0
    buffer_load_dwordx4 v15, s[12:15], s35 offen sc1 lds
    s_mov_b32 s33, 0
    s_add_u32 s32, s32, 1
g2_ld_loop:
    s_cmp_eq_u32 s32, 4
    s_cbranch_scc1 g2_ld_s4
    s_cmp_eq_u32 s32, 5
    s_cbranch_scc1 g2_ld_s5
    s_waitcnt vmcnt(12)
g2_ld_bar:
    s_barrier
    s_add_u32 s40, s32, s27
    s_and_b32 s40, s40, 1
    s_andn2_b32 s41, s32, 1
    s_or_b32 s40, s40, s41
    s_add_u32 s40, s40, s26
    s_mul_i32 s34, s40, 131072
    s_mul_i32 s35, s40, 128
    s_add_u32 s38, s33, s36
    s_add_u32 s39, s33, s37
    s_add_u32 m0, s38, 0
    s_nop 0
    buffer_load_dwordx4 v10, s[8:11], s34 offen lds
    s_add_u32 m0, s38, 1024
    s_nop 0
    buffer_load_dwordx4 v11, s[8:11], s34 offen lds
    s_add_u32 m0, s39, 0
    s_nop 0
    buffer_load_dwordx4 v12, s[12:15], s35 offen sc1 lds
    s_add_u32 m0, s39, 1024
    s_nop 0
    buffer_load_dwordx4 v13, s[12:15], s35 offen sc1 lds
    s_add_u32 m0, s39, 2048
    s_nop 0
    buffer_load_dwordx4 v14, s[12:15], s35 offen sc1 lds
    s_add_u32 m0, s39, 3072
    s_nop 0
    buffer_load_dwordx4 v15, s[12:15], s35 offen sc1 lds
    s_add_u32 s33, s33, 24576
    s_add_u32 s32, s32, 1
    s_cmp_eq_u32 s33, 98304
    s_cselect_b32 s33, 0, s33
    s_cmp_lt_u32 s32, 16
    s_cbranch_scc1 g2_ld_loop
    s_waitcnt vmcnt(12)
    s_barrier
    s_waitcnt vmcnt(6)
    s_barrier
    s_waitcnt vmcnt(0)
    s_barrier
    s_branch g2_ld_end
g2_ld_s4:
    s_waitcnt vmcnt(8)
    s_branch g2_ld_bar
g2_ld_s5:
    s_waitcnt vmcnt(10)
    s_branch g2_ld_bar
g2_ld_end:
    s_barrier
    s_branch g3_in
g2_done:
    s_endpgm
g2_compute:
    v_lshrrev_b32 v5, 4, v2
    v_bfe_u32 v6, v2, 2, 2
    v_and_b32 v7, 3, v2
    v_and_b32 v8, 15, v2
    s_and_b32 s44, s28, 0
    s_lshr_b32 s45, s28, 0
    s_mul_i32 s40, s25, 128
    s_mul_i32 s41, s45, 32
    s_add_u32 s40, s40, s41
    v_add_u32 v20, s40, v8
    s_mov_b32 s41, 2048
    v_mul_lo_u32 v9, v20, s41
    s_mul_i32 s40, s24, 128
    s_mul_i32 s41, s44, 128
    s_add_u32 s46, s40, s41
    v_and_b32 v3, 1, v5
    v_lshlrev_b32 v3, 5, v3
    v_lshrrev_b32 v4, 1, v5
    v_lshl_add_u32 v3, v4, 4, v3
    v_add3_u32 v9, v9, v3, s46
    s_mov_b32 s52, 0
    s_mov_b32 s53, 32768
    s_waitcnt lgkmcnt(0)
    s_add_u32 s4, s4, s97
    s_addc_u32 s5, s5, 0
    s_add_u32 s20, s4, 0x1900000
    s_addc_u32 s21, s5, 0
    s_cmp_eq_u32 s96, 1
    s_cselect_b32 s20, s20, s6
    s_cselect_b32 s21, s21, s7
    s_mov_b32 s22, 0x400000
    s_mov_b32 s23, 0x20000
    s_add_u32 s16, s4, 0x800000
    s_addc_u32 s17, s5, 0
    s_mov_b32 s18, 0x400000
    s_mov_b32 s19, 0x20000
    s_add_u32 s56, s4, 0xc00000
    s_addc_u32 s57, s5, 0
    s_mov_b32 s58, 0x480000
    s_mov_b32 s59, 0x20000
    s_add_u32 s60, s4, 0x200000
    s_addc_u32 s61, s5, 0
    s_mov_b32 s62, 0x40000
    s_mov_b32 s63, 0x20000
    s_mul_i32 s42, s44, 4
    s_mov_b32 s43, 0
    v_and_b32 v3, 1, v5
    v_lshlrev_b32 v3, 1, v3
    v_lshrrev_b32 v4, 1, v6
    v_or_b32 v3, v3, v4
    s_add_u32 s40, s42, 0
    v_xor_b32 v3, s40, v3
    v_lshlrev_b32 v3, 5, v3
    v_lshl_add_u32 v3, v7, 3, v3
    v_lshl_add_u32 v4, v5, 3, v6
    v_lshl_add_u32 v3, v4, 7, v3
    v_add_u32 v10, s43, v3
    v_and_b32 v3, 1, v5
    v_lshlrev_b32 v3, 1, v3
    v_lshrrev_b32 v4, 1, v6
    v_or_b32 v3, v3, v4
    s_add_u32 s40, s42, 1
    v_xor_b32 v3, s40, v3
    v_lshlrev_b32 v3, 5, v3
    v_lshl_add_u32 v3, v7, 3, v3
    v_lshl_add_u32 v4, v5, 3, v6
    v_lshl_add_u32 v3, v4, 7, v3
    v_add_u32 v11, s43, v3
    v_and_b32 v3, 1, v5
    v_lshlrev_b32 v3, 1, v3
    v_lshrrev_b32 v4, 1, v6
    v_or_b32 v3, v3, v4
    s_add_u32 s40, s42, 2
    v_xor_b32 v3, s40, v3
    v_lshlrev_b32 v3, 5, v3
    v_lshl_add_u32 v3, v7, 3, v3
    v_lshl_add_u32 v4, v5, 3, v6
    v_lshl_add_u32 v3, v4, 7, v3
    v_add_u32 v12, s43, v3
    v_and_b32 v3, 1, v5
    v_lshlrev_b32 v3, 1, v3
    v_lshrrev_b32 v4, 1, v6
    v_or_b32 v3, v3, v4
    s_add_u32 s40, s42, 3
    v_xor_b32 v3, s40, v3
    v_lshlrev_b32 v3, 5, v3
    v_lshl_add_u32 v3, v7, 3, v3
    v_lshl_add_u32 v4, v5, 3, v6
    v_lshl_add_u32 v3, v4, 7, v3
    v_add_u32 v13, s43, v3
    s_mul_i32 s42, s45, 32
    v_lshrrev_b32 v3, 1, v8
    v_xor_b32 v3, v3, v5
    v_lshlrev_b32 v3, 4, v3
    v_lshl_add_u32 v3, v8, 7, v3
    s_lshl_b32 s40, s42, 7
    s_add_u32 s40, s40, 8192
    v_add_u32 v14, s40, v3
    v_xor_b32 v15, 64, v14
    s_mov_b32 s48, 16
    s_mov_b32 s50, 0
    s_mov_b32 s51, 24576
    s_mov_b32 s29, 0xfffee000
    v_mov_b32 v28, 0
    v_mov_b32 v29, 0
    v_mov_b32 v30, 0
    v_mov_b32 v31, 0
    v_mov_b32 v32, 0
    v_mov_b32 v33, 0
    v_mov_b32 v34, 0
    v_mov_b32 v35, 0
    v_mov_b32 v36, 0
    v_mov_b32 v37, 0
    v_mov_b32 v38, 0
    v_mov_b32 v39, 0
    v_mov_b32 v40, 0
    v_mov_b32 v41, 0
    v_mov_b32 v42, 0
    v_mov_b32 v43, 0
    v_mov_b32 v44, 0
    v_mov_b32 v45, 0
    v_mov_b32 v46, 0
    v_mov_b32 v47, 0
    v_mov_b32 v48, 0
    v_mov_b32 v49, 0
    v_mov_b32 v50, 0
    v_mov_b32 v51, 0
    v_mov_b32 v52, 0
    v_mov_b32 v53, 0
    v_mov_b32 v54, 0
    v_mov_b32 v55, 0
    v_mov_b32 v56, 0
    v_mov_b32 v57, 0
    v_mov_b32 v58, 0
    v_mov_b32 v59, 0
    s_barrier
    ds_read_b64_tr_b16 v[60:61], v10 offset:0
    ds_read_b64_tr_b16 v[62:63], v10 offset:512
    ds_read_b128 v[76:79], v14 offset:0
    ds_read_b128 v[80:83], v14 offset:2048
    ds_read_b64_tr_b16 v[64:65], v11 offset:0
    ds_read_b64_tr_b16 v[66:67], v11 offset:512
    ds_read_b64_tr_b16 v[68:69], v12 offset:0
    ds_read_b64_tr_b16 v[70:71], v12 offset:512
    ds_read_b64_tr_b16 v[72:73], v13 offset:0
    ds_read_b64_tr_b16 v[74:75], v13 offset:512
    buffer_load_dwordx4 v[124:127], v9, s[20:23], s52 offen offset:0 sc1
    buffer_load_dwordx4 v[128:131], v9, s[20:23], s52 offen offset:64 sc1
    buffer_load_dwordx4 v[132:135], v9, s[20:23], s53 offen offset:0 sc1
    buffer_load_dwordx4 v[136:139], v9, s[20:23], s53 offen offset:64 sc1
    s_branch g2_cloop3
g2_mid:
    s_waitcnt vmcnt(0)
    s_nop 7
    v_permlane16_swap_b32 v124, v126
    v_permlane16_swap_b32 v125, v127
    v_permlane16_swap_b32 v128, v130
    v_permlane16_swap_b32 v129, v131
    v_permlane16_swap_b32 v132, v134
    v_permlane16_swap_b32 v133, v135
    v_permlane16_swap_b32 v136, v138
    v_permlane16_swap_b32 v137, v139
    v_lshlrev_b32 v140, 16, v124
    v_and_b32 v141, 0xffff0000, v124
    v_lshlrev_b32 v142, 16, v125
    v_and_b32 v143, 0xffff0000, v125
    v_lshlrev_b32 v144, 16, v126
    v_and_b32 v145, 0xffff0000, v126
    v_lshlrev_b32 v146, 16, v127
    v_and_b32 v147, 0xffff0000, v127
    v_pk_add_f32 v[28:29], v[28:29], v[140:141]
    v_pk_add_f32 v[30:31], v[30:31], v[142:143]
    v_pk_add_f32 v[36:37], v[36:37], v[144:145]
    v_pk_add_f32 v[38:39], v[38:39], v[146:147]
    v_lshlrev_b32 v140, 16, v128
    v_and_b32 v141, 0xffff0000, v128
    v_lshlrev_b32 v142, 16, v129
    v_and_b32 v143, 0xffff0000, v129
    v_lshlrev_b32 v144, 16, v130
    v_and_b32 v145, 0xffff0000, v130
    v_lshlrev_b32 v146, 16, v131
    v_and_b32 v147, 0xffff0000, v131
    v_pk_add_f32 v[44:45], v[44:45], v[140:141]
    v_pk_add_f32 v[46:47], v[46:47], v[142:143]
    v_pk_add_f32 v[52:53], v[52:53], v[144:145]
    v_pk_add_f32 v[54:55], v[54:55], v[146:147]
    v_lshlrev_b32 v140, 16, v132
    v_and_b32 v141, 0xffff0000, v132
    v_lshlrev_b32 v142, 16, v133
    v_and_b32 v143, 0xffff0000, v133
    v_lshlrev_b32 v144, 16, v134
    v_and_b32 v145, 0xffff0000, v134
    v_lshlrev_b32 v146, 16, v135
    v_and_b32 v147, 0xffff0000, v135
    v_pk_add_f32 v[32:33], v[32:33], v[140:141]
    v_pk_add_f32 v[34:35], v[34:35], v[142:143]
    v_pk_add_f32 v[40:41], v[40:41], v[144:145]
    v_pk_add_f32 v[42:43], v[42:43], v[146:147]
    v_lshlrev_b32 v140, 16, v136
    v_and_b32 v141, 0xffff0000, v136
    v_lshlrev_b32 v142, 16, v137
    v_and_b32 v143, 0xffff0000, v137
    v_lshlrev_b32 v144, 16, v138
    v_and_b32 v145, 0xffff0000, v138
    v_lshlrev_b32 v146, 16, v139
    v_and_b32 v147, 0xffff0000, v139
    v_pk_add_f32 v[48:49], v[48:49], v[140:141]
    v_pk_add_f32 v[50:51], v[50:51], v[142:143]
    v_pk_add_f32 v[56:57], v[56:57], v[144:145]
    v_pk_add_f32 v[58:59], v[58:59], v[146:147]
    s_nop 1
    s_branch g2_cloop2
.p2align 3
g2_cloop:
    s_barrier
    s_cmp_eq_u32 s48, 8
    s_cbranch_scc1 g2_mid
g2_cloop2:
    v_mfma_f32_16x16x32_bf16 v[28:31], v[84:87], v[100:103], v[28:31]
    ds_read_b64_tr_b16 v[60:61], v10 offset:0
    ds_read_b64_tr_b16 v[62:63], v10 offset:512
    v_mfma_f32_16x16x32_bf16 v[32:35], v[84:87], v[104:107], v[32:35]
    ds_read_b128 v[76:79], v14 offset:0
    v_mfma_f32_16x16x32_bf16 v[40:43], v[88:91], v[104:107], v[40:43]
    ds_read_b128 v[80:83], v14 offset:2048
    v_mfma_f32_16x16x32_bf16 v[36:39], v[88:91], v[100:103], v[36:39]
    ds_read_b64_tr_b16 v[64:65], v11 offset:0
    ds_read_b64_tr_b16 v[66:67], v11 offset:512
    v_mfma_f32_16x16x32_bf16 v[44:47], v[92:95], v[100:103], v[44:47]
    ds_read_b64_tr_b16 v[68:69], v12 offset:0
    ds_read_b64_tr_b16 v[70:71], v12 offset:512
    v_mfma_f32_16x16x32_bf16 v[48:51], v[92:95], v[104:107], v[48:51]
    ds_read_b64_tr_b16 v[72:73], v13 offset:0
    ds_read_b64_tr_b16 v[74:75], v13 offset:512
    v_mfma_f32_16x16x32_bf16 v[56:59], v[96:99], v[104:107], v[56:59]
    v_mfma_f32_16x16x32_bf16 v[52:55], v[96:99], v[100:103], v[52:55]
g2_cloop3:
    s_waitcnt lgkmcnt(0)
    v_mfma_f32_16x16x32_bf16 v[28:31], v[60:63], v[76:79], v[28:31]
    ds_read_b64_tr_b16 v[84:85], v10 offset:4096
    ds_read_b64_tr_b16 v[86:87], v10 offset:4608
    v_mfma_f32_16x16x32_bf16 v[32:35], v[60:63], v[80:83], v[32:35]
    ds_read_b128 v[100:103], v15 offset:0
    v_mfma_f32_16x16x32_bf16 v[40:43], v[64:67], v[80:83], v[40:43]
    ds_read_b128 v[104:107], v15 offset:2048
    v_mfma_f32_16x16x32_bf16 v[36:39], v[64:67], v[76:79], v[36:39]
    ds_read_b64_tr_b16 v[88:89], v11 offset:4096
    ds_read_b64_tr_b16 v[90:91], v11 offset:4608
    v_mfma_f32_16x16x32_bf16 v[44:47], v[68:71], v[76:79], v[44:47]
    ds_read_b64_tr_b16 v[92:93], v12 offset:4096
    ds_read_b64_tr_b16 v[94:95], v12 offset:4608
    v_mfma_f32_16x16x32_bf16 v[48:51], v[68:71], v[80:83], v[48:51]
    ds_read_b64_tr_b16 v[96:97], v13 offset:4096
    ds_read_b64_tr_b16 v[98:99], v13 offset:4608
    v_mfma_f32_16x16x32_bf16 v[56:59], v[72:75], v[80:83], v[56:59]
    s_add_u32 s50, s50, 1
    s_cmp_eq_u32 s50, 4
    v_mfma_f32_16x16x32_bf16 v[52:55], v[72:75], v[76:79], v[52:55]
    s_cselect_b32 s49, s29, s51
    s_cselect_b32 s50, 0, s50
    v_add_u32 v10, s49, v10
    v_add_u32 v11, s49, v11
    v_add_u32 v12, s49, v12
    v_add_u32 v13, s49, v13
    v_add_u32 v14, s49, v14
    v_add_u32 v15, s49, v15
    s_sub_u32 s48, s48, 1
    s_cmp_lg_u32 s48, 0
    s_waitcnt lgkmcnt(0)
    s_cbranch_scc1 g2_cloop
    v_mfma_f32_16x16x32_bf16 v[28:31], v[84:87], v[100:103], v[28:31]
    v_mfma_f32_16x16x32_bf16 v[32:35], v[84:87], v[104:107], v[32:35]
    v_mfma_f32_16x16x32_bf16 v[40:43], v[88:91], v[104:107], v[40:43]
    v_mfma_f32_16x16x32_bf16 v[36:39], v[88:91], v[100:103], v[36:39]
    v_mfma_f32_16x16x32_bf16 v[44:47], v[92:95], v[100:103], v[44:47]
    v_mfma_f32_16x16x32_bf16 v[48:51], v[92:95], v[104:107], v[48:51]
    v_mfma_f32_16x16x32_bf16 v[56:59], v[96:99], v[104:107], v[56:59]
    v_mfma_f32_16x16x32_bf16 v[52:55], v[96:99], v[100:103], v[52:55]
    s_nop 7
    v_pk_add_f32 v[76:77], v[28:29], v[30:31]
    v_pk_mul_f32 v[78:79], v[28:29], v[28:29]
    v_pk_fma_f32 v[78:79], v[30:31], v[30:31], v[78:79]
    v_pk_add_f32 v[76:77], v[76:77], v[36:37]
    v_pk_fma_f32 v[78:79], v[36:37], v[36:37], v[78:79]
    v_pk_add_f32 v[76:77], v[76:77], v[38:39]
    v_pk_fma_f32 v[78:79], v[38:39], v[38:39], v[78:79]
    v_pk_add_f32 v[76:77], v[76:77], v[44:45]
    v_pk_fma_f32 v[78:79], v[44:45], v[44:45], v[78:79]
    v_pk_add_f32 v[76:77], v[76:77], v[46:47]
    v_pk_fma_f32 v[78:79], v[46:47], v[46:47], v[78:79]
    v_pk_add_f32 v[76:77], v[76:77], v[52:53]
    v_pk_fma_f32 v[78:79], v[52:53], v[52:53], v[78:79]
    v_pk_add_f32 v[76:77], v[76:77], v[54:55]
    v_pk_fma_f32 v[78:79], v[54:55], v[54:55], v[78:79]
    v_pk_add_f32 v[80:81], v[32:33], v[34:35]
    v_pk_mul_f32 v[82:83], v[32:33], v[32:33]
    v_pk_fma_f32 v[82:83], v[34:35], v[34:35], v[82:83]
    v_pk_add_f32 v[80:81], v[80:81], v[40:41]
    v_pk_fma_f32 v[82:83], v[40:41], v[40:41], v[82:83]
    v_pk_add_f32 v[80:81], v[80:81], v[42:43]
    v_pk_fma_f32 v[82:83], v[42:43], v[42:43], v[82:83]
    v_pk_add_f32 v[80:81], v[80:81], v[48:49]
    v_pk_fma_f32 v[82:83], v[48:49], v[48:49], v[82:83]
    v_pk_add_f32 v[80:81], v[80:81], v[50:51]
    v_pk_fma_f32 v[82:83], v[50:51], v[50:51], v[82:83]
    v_pk_add_f32 v[80:81], v[80:81], v[56:57]
    v_pk_fma_f32 v[82:83], v[56:57], v[56:57], v[82:83]
    v_pk_add_f32 v[80:81], v[80:81], v[58:59]
    v_pk_fma_f32 v[82:83], v[58:59], v[58:59], v[82:83]
    v_add_f32 v76, v76, v77
    v_add_f32 v77, v78, v79
    v_add_f32 v80, v80, v81
    v_add_f32 v81, v82, v83
    s_nop 1
    v_permlane16_swap_b32 v76, v80
    v_permlane16_swap_b32 v77, v81
    v_pk_add_f32 v[76:77], v[76:77], v[80:81]
    v_mov_b32 v84, v76
    v_mov_b32 v85, v77
    v_and_b32 v3, 16, v2
    v_add_u32 v3, v3, v20
    v_permlane32_swap_b32 v76, v84
    v_permlane32_swap_b32 v77, v85
    v_pk_add_f32 v[76:77], v[76:77], v[84:85]
    v_lshlrev_b32 v3, 3, v3
    s_mul_i32 s40, s24, 1
    s_add_u32 s40, s40, s44
    s_lshl_b32 s40, s40, 14
    s_mov_b32 exec_hi, 0
    buffer_store_dwordx2 v[76:77], v3, s[60:63], s40 offen sc1
    s_mov_b32 exec_hi, -1
    v_lshrrev_b32 v4, 5, v2
    v_lshl_add_u32 v21, v4, 17, v3
    v_cvt_pk_bf16_f32 v60, v28, v29
    v_cvt_pk_bf16_f32 v61, v30, v31
    v_cvt_pk_bf16_f32 v62, v36, v37
    v_cvt_pk_bf16_f32 v63, v38, v39
    v_lshlrev_b32 v28, 16, v60
    v_and_b32 v29, 0xffff0000, v60
    v_lshlrev_b32 v30, 16, v61
    v_and_b32 v31, 0xffff0000, v61
    v_lshlrev_b32 v36, 16, v62
    v_and_b32 v37, 0xffff0000, v62
    v_lshlrev_b32 v38, 16, v63
    v_and_b32 v39, 0xffff0000, v63
    v_permlane16_swap_b32 v60, v62
    v_permlane16_swap_b32 v61, v63
    buffer_store_dwordx4 v[60:63], v9, s[16:19], s52 offen offset:0 sc1
    v_cvt_pk_bf16_f32 v64, v44, v45
    v_cvt_pk_bf16_f32 v65, v46, v47
    v_cvt_pk_bf16_f32 v66, v52, v53
    v_cvt_pk_bf16_f32 v67, v54, v55
    v_lshlrev_b32 v44, 16, v64
    v_and_b32 v45, 0xffff0000, v64
    v_lshlrev_b32 v46, 16, v65
    v_and_b32 v47, 0xffff0000, v65
    v_lshlrev_b32 v52, 16, v66
    v_and_b32 v53, 0xffff0000, v66
    v_lshlrev_b32 v54, 16, v67
    v_and_b32 v55, 0xffff0000, v67
    v_permlane16_swap_b32 v64, v66
    v_permlane16_swap_b32 v65, v67
    buffer_store_dwordx4 v[64:67], v9, s[16:19], s52 offen offset:64 sc1
    v_cvt_pk_bf16_f32 v68, v32, v33
    v_cvt_pk_bf16_f32 v69, v34, v35
    v_cvt_pk_bf16_f32 v70, v40, v41
    v_cvt_pk_bf16_f32 v71, v42, v43
    v_lshlrev_b32 v32, 16, v68
    v_and_b32 v33, 0xffff0000, v68
    v_lshlrev_b32 v34, 16, v69
    v_and_b32 v35, 0xffff0000, v69
    v_lshlrev_b32 v40, 16, v70
    v_and_b32 v41, 0xffff0000, v70
    v_lshlrev_b32 v42, 16, v71
    v_and_b32 v43, 0xffff0000, v71
    v_permlane16_swap_b32 v68, v70
    v_permlane16_swap_b32 v69, v71
    buffer_store_dwordx4 v[68:71], v9, s[16:19], s53 offen offset:0 sc1
    v_cvt_pk_bf16_f32 v72, v48, v49
    v_cvt_pk_bf16_f32 v73, v50, v51
    v_cvt_pk_bf16_f32 v74, v56, v57
    v_cvt_pk_bf16_f32 v75, v58, v59
    v_lshlrev_b32 v48, 16, v72
    v_and_b32 v49, 0xffff0000, v72
    v_lshlrev_b32 v50, 16, v73
    v_and_b32 v51, 0xffff0000, v73
    v_lshlrev_b32 v56, 16, v74
    v_and_b32 v57, 0xffff0000, v74
    v_lshlrev_b32 v58, 16, v75
    v_and_b32 v59, 0xffff0000, v75
    v_permlane16_swap_b32 v72, v74
    v_permlane16_swap_b32 v73, v75
    buffer_store_dwordx4 v[72:75], v9, s[16:19], s53 offen offset:64 sc1
    s_mov_b32 s48, 0x40000
    v_mul_u32_u24 v19, 256, v20
    v_add_u32 v19, v19, v9
    s_mov_b32 s54, 0
    s_mov_b32 s55, 36864
    s_mov_b32 s40, 0
    buffer_load_dwordx2 v[108:109], v21, s[60:63], s40 offen sc1
    s_mov_b32 s41, 16384
    buffer_load_dwordx2 v[110:111], v21, s[60:63], s41 offen sc1
    s_mov_b32 s40, 32768
    buffer_load_dwordx2 v[112:113], v21, s[60:63], s40 offen sc1
    s_mov_b32 s41, 49152
    buffer_load_dwordx2 v[114:115], v21, s[60:63], s41 offen sc1
    s_mov_b32 s40, 65536
    buffer_load_dwordx2 v[116:117], v21, s[60:63], s40 offen sc1
    s_mov_b32 s41, 81920
    buffer_load_dwordx2 v[118:119], v21, s[60:63], s41 offen sc1
    s_mov_b32 s40, 98304
    buffer_load_dwordx2 v[120:121], v21, s[60:63], s40 offen sc1
    s_mov_b32 s41, 114688
    buffer_load_dwordx2 v[122:123], v21, s[60:63], s41 offen sc1
    s_waitcnt vmcnt(0)
g2_ex:
    v_max3_u32 v4, v108, v109, v110
    v_max3_u32 v4, v4, v111, v112
    v_max3_u32 v4, v4, v113, v114
    v_max3_u32 v4, v4, v115, v116
    v_max3_u32 v4, v4, v117, v118
    v_max3_u32 v4, v4, v119, v120
    v_max3_u32 v4, v4, v121, v122
    v_max_u32 v4, v4, v123
    v_cmp_eq_u32 vcc, -1, v4
    s_sub_u32 s48, s48, 1
    s_cmp_eq_u32 s48, 0
    s_cbranch_scc1 g2_exd
    s_cbranch_vccz g2_exd
    s_sleep 2
    s_mov_b32 s40, 0
    buffer_load_dwordx2 v[108:109], v21, s[60:63], s40 offen sc1
    s_mov_b32 s41, 16384
    buffer_load_dwordx2 v[110:111], v21, s[60:63], s41 offen sc1
    s_mov_b32 s40, 32768
    buffer_load_dwordx2 v[112:113], v21, s[60:63], s40 offen sc1
    s_mov_b32 s41, 49152
    buffer_load_dwordx2 v[114:115], v21, s[60:63], s41 offen sc1
    s_mov_b32 s40, 65536
    buffer_load_dwordx2 v[116:117], v21, s[60:63], s40 offen sc1
    s_mov_b32 s41, 81920
    buffer_load_dwordx2 v[118:119], v21, s[60:63], s41 offen sc1
    s_mov_b32 s40, 98304
    buffer_load_dwordx2 v[120:121], v21, s[60:63], s40 offen sc1
    s_mov_b32 s41, 114688
    buffer_load_dwordx2 v[122:123], v21, s[60:63], s41 offen sc1
    s_waitcnt vmcnt(0)
    s_branch g2_ex
g2_exd:
    v_pk_add_f32 v[108:109], v[108:109], v[116:117]
    v_pk_add_f32 v[110:111], v[110:111], v[118:119]
    v_pk_add_f32 v[112:113], v[112:113], v[120:121]
    v_pk_add_f32 v[114:115], v[114:115], v[122:123]
    v_pk_add_f32 v[108:109], v[108:109], v[112:113]
    v_pk_add_f32 v[110:111], v[110:111], v[114:115]
    v_pk_add_f32 v[108:109], v[108:109], v[110:111]
    v_mov_b32 v110, v108
    v_mov_b32 v111, v109
    s_nop 1
    v_permlane32_swap_b32 v108, v110
    v_permlane32_swap_b32 v109, v111
    v_pk_add_f32 v[108:109], v[108:109], v[110:111]
    v_mul_f32 v108, 0x3a800000, v108
    v_mul_f32 v109, 0x3a800000, v109
    v_fma_f32 v109, -v108, v108, v109
    v_max_f32 v109, 0, v109
    v_mov_b32 v110, v108
    v_mov_b32 v111, v109
    v_cvt_pk_bf16_f32 v110, v110, v110
    v_lshlrev_b32 v110, 16, v110
    v_cvt_pk_bf16_f32 v111, v111, v111
    v_lshlrev_b32 v111, 16, v111
    v_add_f32 v111, 0x3727c5ac, v111
    v_cvt_pk_bf16_f32 v111, v111, v111
    v_lshlrev_b32 v111, 16, v111
    v_sqrt_f32 v111, v111
    s_nop 0
    v_cvt_pk_bf16_f32 v111, v111, v111
    v_lshlrev_b32 v111, 16, v111
    v_rcp_f32 v111, v111
    v_sub_f32 v112, v108, v110
    v_mul_f32 v113, v109, v111
    v_mul_f32 v112, v112, v111
    v_mul_f32 v113, v113, v111
    v_cvt_pk_bf16_f32 v112, v112, v112
    v_lshlrev_b32 v112, 16, v112
    v_cvt_pk_bf16_f32 v113, v113, v113
    v_lshlrev_b32 v113, 16, v113
    v_add_f32 v113, 0x3727c5ac, v113
    v_cvt_pk_bf16_f32 v113, v113, v113
    v_lshlrev_b32 v113, 16, v113
    v_sqrt_f32 v113, v113
    s_nop 0
    v_cvt_pk_bf16_f32 v113, v113, v113
    v_lshlrev_b32 v113, 16, v113
    v_rcp_f32 v113, v113
    v_fma_f32 v112, v110, v111, v112
    v_mul_f32 v114, v111, v113
    v_mul_f32 v115, -v112, v113
    v_mov_b32 v116, v114
    v_mov_b32 v117, v115
    s_nop 1
    v_permlane16_swap_b32 v114, v116
    v_permlane16_swap_b32 v115, v117
    v_pk_fma_f32 v[28:29], v[28:29], v[114:115], v[114:115] op_sel:[0,0,1] op_sel_hi:[1,0,1]
    v_pk_fma_f32 v[30:31], v[30:31], v[114:115], v[114:115] op_sel:[0,0,1] op_sel_hi:[1,0,1]
    v_pk_fma_f32 v[36:37], v[36:37], v[114:115], v[114:115] op_sel:[0,0,1] op_sel_hi:[1,0,1]
    v_pk_fma_f32 v[38:39], v[38:39], v[114:115], v[114:115] op_sel:[0,0,1] op_sel_hi:[1,0,1]
    v_cvt_pk_bf16_f32 v124, v28, v29
    v_cvt_pk_bf16_f32 v125, v30, v31
    v_cvt_pk_bf16_f32 v126, v36, v37
    v_cvt_pk_bf16_f32 v127, v38, v39
    s_nop 1
    v_permlane16_swap_b32 v124, v126
    v_permlane16_swap_b32 v125, v127
    buffer_store_dwordx4 v[124:127], v19, s[56:59], s54 offen offset:0 sc1
    v_pk_fma_f32 v[44:45], v[44:45], v[114:115], v[114:115] op_sel:[0,0,1] op_sel_hi:[1,0,1]
    v_pk_fma_f32 v[46:47], v[46:47], v[114:115], v[114:115] op_sel:[0,0,1] op_sel_hi:[1,0,1]
    v_pk_fma_f32 v[52:53], v[52:53], v[114:115], v[114:115] op_sel:[0,0,1] op_sel_hi:[1,0,1]
    v_pk_fma_f32 v[54:55], v[54:55], v[114:115], v[114:115] op_sel:[0,0,1] op_sel_hi:[1,0,1]
    v_cvt_pk_bf16_f32 v128, v44, v45
    v_cvt_pk_bf16_f32 v129, v46, v47
    v_cvt_pk_bf16_f32 v130, v52, v53
    v_cvt_pk_bf16_f32 v131, v54, v55
    s_nop 1
    v_permlane16_swap_b32 v128, v130
    v_permlane16_swap_b32 v129, v131
    buffer_store_dwordx4 v[128:131], v19, s[56:59], s54 offen offset:64 sc1
    v_pk_fma_f32 v[32:33], v[32:33], v[116:117], v[116:117] op_sel:[0,0,1] op_sel_hi:[1,0,1]
    v_pk_fma_f32 v[34:35], v[34:35], v[116:117], v[116:117] op_sel:[0,0,1] op_sel_hi:[1,0,1]
    v_pk_fma_f32 v[40:41], v[40:41], v[116:117], v[116:117] op_sel:[0,0,1] op_sel_hi:[1,0,1]
    v_pk_fma_f32 v[42:43], v[42:43], v[116:117], v[116:117] op_sel:[0,0,1] op_sel_hi:[1,0,1]
    v_cvt_pk_bf16_f32 v132, v32, v33
    v_cvt_pk_bf16_f32 v133, v34, v35
    v_cvt_pk_bf16_f32 v134, v40, v41
    v_cvt_pk_bf16_f32 v135, v42, v43
    s_nop 1
    v_permlane16_swap_b32 v132, v134
    v_permlane16_swap_b32 v133, v135
    buffer_store_dwordx4 v[132:135], v19, s[56:59], s55 offen offset:0 sc1
    v_pk_fma_f32 v[48:49], v[48:49], v[116:117], v[116:117] op_sel:[0,0,1] op_sel_hi:[1,0,1]
    v_pk_fma_f32 v[50:51], v[50:51], v[116:117], v[116:117] op_sel:[0,0,1] op_sel_hi:[1,0,1]
    v_pk_fma_f32 v[56:57], v[56:57], v[116:117], v[116:117] op_sel:[0,0,1] op_sel_hi:[1,0,1]
    v_pk_fma_f32 v[58:59], v[58:59], v[116:117], v[116:117] op_sel:[0,0,1] op_sel_hi:[1,0,1]
    v_cvt_pk_bf16_f32 v136, v48, v49
    v_cvt_pk_bf16_f32 v137, v50, v51
    v_cvt_pk_bf16_f32 v138, v56, v57
    v_cvt_pk_bf16_f32 v139, v58, v59
    s_nop 1
    v_permlane16_swap_b32 v136, v138
    v_permlane16_swap_b32 v137, v139
    buffer_store_dwordx4 v[136:139], v19, s[56:59], s55 offen offset:64 sc1
    s_lshr_b32 s40, s24, 1
    s_add_u32 s40, s40, 16
    s_lshl_b32 s40, s40, 12
    s_mov_b32 s42, s40
    s_and_b32 s41, s24, 1
    s_lshl_b32 s42, s25, 1
    s_add_u32 s41, s41, s42
    s_add_u32 s84, s4, 0x300000
    s_addc_u32 s85, s5, 0
    s_mov_b32 s86, 0x40000
    s_mov_b32 s87, 0x20000
    s_lshl_b32 s41, s41, 2
    s_add_u32 s40, s40, s41
    v_and_b32 v3, 31, v0
    v_lshl_add_u32 v3, v3, 7, s40
    v_mov_b32 v4, 1
    s_waitcnt vmcnt(0)
    s_barrier
    s_cmp_lg_u32 s28, 0
    s_cbranch_scc1 g2_cin
    s_mov_b32 exec_hi, 0
    buffer_store_dword v4, v3, s[84:87], 0 offen sc1
    s_mov_b64 exec, -1
g2_cin:
    s_branch g3_in
.p2align 6
g3_in:
    s_cmp_ge_u32 s2, 224
    s_cbranch_scc1 g3_spare
    s_load_dwordx2 s[4:5], s[0:1], 80
    s_load_dwordx2 s[30:31], s[0:1], 32
    s_load_dwordx2 s[6:7], s[0:1], 40
    v_lshrrev_b32 v1, 6, v0
    v_and_b32 v2, 63, v0
    s_and_b32 s40, s2, 1
    s_lshl_b32 s40, s40, 2
    s_bfe_u32 s41, s2, 0x20003
    s_add_u32 s25, s40, s41
    s_bfe_u32 s40, s2, 0x20001
    s_mul_i32 s40, s40, 7
    s_lshr_b32 s42, s2, 5
    s_add_u32 s24, s40, s42
    s_add_u32 s27, s41, s42
    s_mov_b32 s26, 0
    s_cmp_eq_u32 s96, 0
    s_cselect_b32 s95, 3, 1
    v_readfirstlane_b32 s28, v1
    s_nop 0
    s_cmp_lt_u32 s28, 4
    s_cbranch_scc1 g3_compute
    s_sub_u32 s28, s28, 4
    s_mov_b32 s40, 7168
    v_lshrrev_b32 v4, 4, v2
    v_mul_lo_u32 v3, v4, s40
    v_lshlrev_b32 v4, 1, v4
    v_xor_b32 v4, v4, v2
    v_and_b32 v4, 15, v4
    v_lshl_add_u32 v3, v4, 4, v3
    s_mul_i32 s41, s24, 256
    s_mul_i32 s42, s28, 114688
    s_add_u32 s41, s41, s42
    v_xor_b32 v4, 128, v3
    s_add_u32 s42, s41, 0
    v_add_u32 v10, s42, v3
    s_add_u32 s42, s41, 28672
    v_add_u32 v11, s42, v3
    s_add_u32 s42, s41, 57344
    v_add_u32 v12, s42, v4
    s_add_u32 s42, s41, 86016
    v_add_u32 v13, s42, v4
    s_mov_b32 s40, 2304
    v_lshrrev_b32 v4, 4, v2
    v_mul_lo_u32 v3, v4, s40
    v_lshlrev_b32 v4, 1, v4
    v_xor_b32 v4, v4, v2
    v_and_b32 v4, 15, v4
    v_lshl_add_u32 v3, v4, 4, v3
    s_mul_i32 s41, s25, 256
    s_mul_i32 s42, s28, 36864
    s_add_u32 s41, s41, s42
    v_xor_b32 v4, 128, v3
    s_add_u32 s42, s41, 0
    v_add_u32 v14, s42, v3
    s_add_u32 s42, s41, 9216
    v_add_u32 v15, s42, v3
    s_add_u32 s42, s41, 18432
    v_add_u32 v16, s42, v4
    s_add_u32 s42, s41, 27648
    v_add_u32 v17, s42, v4
    s_mul_i32 s36, s28, 4096
    s_mul_i32 s37, s28, 4096
    s_add_u32 s37, s37, 16384
    s_waitcnt lgkmcnt(0)
    s_add_u32 s4, s4, s97
    s_addc_u32 s5, s5, 0
    s_mov_b32 s8, s30
    s_mov_b32 s9, s31
    s_mov_b32 s10, 0xe00000
    s_mov_b32 s11, 0x20000
    s_add_u32 s12, s4, 0xc00000
    s_addc_u32 s13, s5, 0
    s_mov_b32 s14, 0x480000
    s_mov_b32 s15, 0x20000
    s_mov_b32 s32, 0
    s_mov_b32 s33, 0
g3_ld_pW:
    s_add_u32 s40, s32, s27
    s_and_b32 s40, s40, s95
    s_andn2_b32 s41, s32, s95
    s_or_b32 s40, s40, s41
    s_add_u32 s40, s40, s26
    s_mul_i32 s34, s40, 458752
    s_mul_i32 s35, s40, 147456
    s_add_u32 s38, s33, s36
    s_add_u32 s39, s33, s37
    s_add_u32 m0, s38, 0
    s_nop 0
    buffer_load_dwordx4 v10, s[8:11], s34 offen lds
    s_add_u32 m0, s38, 1024
    s_nop 0
    buffer_load_dwordx4 v11, s[8:11], s34 offen lds
    s_add_u32 m0, s38, 2048
    s_nop 0
    buffer_load_dwordx4 v12, s[8:11], s34 offen lds
    s_add_u32 m0, s38, 3072
    s_nop 0
    buffer_load_dwordx4 v13, s[8:11], s34 offen lds
    s_add_u32 s33, s33, 32768
    s_add_u32 s32, s32, 1
    s_cmp_lt_u32 s32, 4
    s_cbranch_scc1 g3_ld_pW
    s_lshr_b32 s40, s25, 0
    s_add_u32 s40, s40, 16
    s_lshl_b32 s40, s40, 12
    s_mov_b32 s42, s40
    s_lshl_b32 s41, s24, 7
    s_add_u32 s40, s40, s41
    s_mov_b32 s42, s40
    s_lshl_b32 s43, s96, 2
    s_add_u32 s43, s43, 3
    s_mov_b32 s41, 0x800000
    v_mov_b32 v24, 131072
    s_cmp_lg_u32 s28, 0
    s_cbranch_scc1 g3_dep_lds
    s_add_u32 s84, s4, 0x300000
    s_addc_u32 s85, s5, 0
    s_mov_b32 s86, 0x40000
    s_mov_b32 s87, 0x20000
    v_cmp_gt_u32 vcc, 32, v2
    v_mov_b32 v21, s40
    v_mov_b32 v23, s42
    v_cndmask_b32 v21, v23, v21, vcc
    v_mov_b32 v22, 31
    v_mov_b32 v23, 31
    v_cndmask_b32 v22, v23, v22, vcc
    v_and_b32 v23, 31, v2
    v_min_u32 v23, v23, v22
    v_lshl_add_u32 v21, v23, 2, v21
    s_mov_b32 s41, 0x40000
    s_mov_b32 s44, 0xf
    s_mov_b32 s45, 0x0
g3_dep:
    buffer_load_dword v23, v21, s[84:87], 0 offen sc1
    s_sub_u32 s41, s41, 1
    s_waitcnt vmcnt(0)
g3_dep_chk:
    v_cmp_eq_u32 vcc, 0, v23
    s_cmp_eq_u32 s41, 0
    s_cbranch_scc1 g3_dep_seen
    s_and_b64 vcc, vcc, s[44:45]
    s_cbranch_scc0 g3_dep_seen
    s_sleep 2
    s_branch g3_dep
g3_dep_seen:
    v_mov_b32 v22, s43
    ds_write_b32 v24, v22
    s_branch g3_dep_ok
g3_dep_lds:
    ds_read_b32 v23, v24
    s_sub_u32 s41, s41, 1
    s_waitcnt lgkmcnt(0)
    v_readfirstlane_b32 s40, v23
    s_cmp_eq_u32 s41, 0
    s_cbranch_scc1 g3_dep_ok
    s_cmp_eq_u32 s40, s43
    s_cbranch_scc1 g3_dep_ok
    s_sleep 1
    s_branch g3_dep_lds
g3_dep_ok:
    s_mov_b32 s32, 0
    s_mov_b32 s33, 0
g3_ld_pA:
    s_add_u32 s40, s32, s27
    s_and_b32 s40, s40, s95
    s_andn2_b32 s41, s32, s95
    s_or_b32 s40, s40, s41
    s_add_u32 s40, s40, s26
    s_mul_i32 s34, s40, 458752
    s_mul_i32 s35, s40, 147456
    s_add_u32 s38, s33, s36
    s_add_u32 s39, s33, s37
    s_add_u32 m0, s39, 0
    s_nop 0
    buffer_load_dwordx4 v14, s[12:15], s35 offen sc1 lds
    s_add_u32 m0, s39, 1024
    s_nop 0
    buffer_load_dwordx4 v15, s[12:15], s35 offen sc1 lds
    s_add_u32 m0, s39, 2048
    s_nop 0
    buffer_load_dwordx4 v16, s[12:15], s35 offen sc1 lds
    s_add_u32 m0, s39, 3072
    s_nop 0
    buffer_load_dwordx4 v17, s[12:15], s35 offen sc1 lds
    s_add_u32 s33, s33, 32768
    s_add_u32 s32, s32, 1
    s_cmp_lt_u32 s32, 3
    s_cbranch_scc1 g3_ld_pA
    s_lshr_b32 s40, s25, 0
    s_add_u32 s40, s40, 16
    s_lshl_b32 s40, s40, 12
    s_mov_b32 s42, s40
    s_lshl_b32 s41, s24, 7
    s_add_u32 s40, s40, s41
    s_mov_b32 s42, s40
    s_cmp_lg_u32 s28, 0
    s_cbranch_scc1 g3_dep_rok
    s_mov_b32 s41, 0x40000
    s_add_u32 s84, s4, 0x300000
    s_addc_u32 s85, s5, 0
    s_mov_b32 s86, 0x40000
    s_mov_b32 s87, 0x20000
g3_dep_r:
    v_cmp_eq_u32 vcc, 0, v23
    s_sub_u32 s41, s41, 1
    s_cmp_eq_u32 s41, 0
    s_cbranch_scc1 g3_dep_rok
    s_cbranch_vccz g3_dep_rok
    s_sleep 2
    buffer_load_dword v23, v21, s[84:87], 0 offen sc1
    s_waitcnt vmcnt(0)
    s_branch g3_dep_r
g3_dep_rok:
    s_waitcnt vmcnt(8)
    s_barrier
    s_add_u32 s40, s32, s27
    s_and_b32 s40, s40, s95
    s_andn2_b32 s41, s32, s95
    s_or_b32 s40, s40, s41
    s_add_u32 s40, s40, s26
    s_mul_i32 s34, s40, 458752
    s_mul_i32 s35, s40, 147456
    s_add_u32 s38, s33, s36
    s_add_u32 s39, s33, s37
    s_add_u32 m0, s39, 0
    s_nop 0
    buffer_load_dwordx4 v14, s[12:15], s35 offen sc1 lds
    s_add_u32 m0, s39, 1024
    s_nop 0
    buffer_load_dwordx4 v15, s[12:15], s35 offen sc1 lds
    s_add_u32 m0, s39, 2048
    s_nop 0
    buffer_load_dwordx4 v16, s[12:15], s35 offen sc1 lds
    s_add_u32 m0, s39, 3072
    s_nop 0
    buffer_load_dwordx4 v17, s[12:15], s35 offen sc1 lds
    s_mov_b32 s33, 0
    s_add_u32 s32, s32, 1
g3_ld_loop:
    s_cmp_eq_u32 s32, 4
    s_cbranch_scc1 g3_ld_s4
    s_cmp_eq_u32 s32, 5
    s_cbranch_scc1 g3_ld_s5
    s_waitcnt vmcnt(16)
g3_ld_bar:
    s_barrier
    s_add_u32 s40, s32, s27
    s_and_b32 s40, s40, s95
    s_andn2_b32 s41, s32, s95
    s_or_b32 s40, s40, s41
    s_add_u32 s40, s40, s26
    s_mul_i32 s34, s40, 458752
    s_mul_i32 s35, s40, 147456
    s_add_u32 s38, s33, s36
    s_add_u32 s39, s33, s37
    s_add_u32 m0, s38, 0
    s_nop 0
    buffer_load_dwordx4 v10, s[8:11], s34 offen lds
    s_add_u32 m0, s38, 1024
    s_nop 0
    buffer_load_dwordx4 v11, s[8:11], s34 offen lds
    s_add_u32 m0, s38, 2048
    s_nop 0
    buffer_load_dwordx4 v12, s[8:11], s34 offen lds
    s_add_u32 m0, s38, 3072
    s_nop 0
    buffer_load_dwordx4 v13, s[8:11], s34 offen lds
    s_add_u32 m0, s39, 0
    s_nop 0
    buffer_load_dwordx4 v14, s[12:15], s35 offen sc1 lds
    s_add_u32 m0, s39, 1024
    s_nop 0
    buffer_load_dwordx4 v15, s[12:15], s35 offen sc1 lds
    s_add_u32 m0, s39, 2048
    s_nop 0
    buffer_load_dwordx4 v16, s[12:15], s35 offen sc1 lds
    s_add_u32 m0, s39, 3072
    s_nop 0
    buffer_load_dwordx4 v17, s[12:15], s35 offen sc1 lds
    s_add_u32 s33, s33, 32768
    s_add_u32 s32, s32, 1
    s_cmp_eq_u32 s33, 131072
    s_cselect_b32 s33, 0, s33
    s_cmp_lt_u32 s32, 32
    s_cbranch_scc1 g3_ld_loop
    s_waitcnt vmcnt(16)
    s_barrier
    s_waitcnt vmcnt(8)
    s_barrier
    s_waitcnt vmcnt(0)
    s_barrier
    s_branch g3_ld_end
g3_ld_s4:
    s_waitcnt vmcnt(8)
    s_branch g3_ld_bar
g3_ld_s5:
    s_waitcnt vmcnt(12)
    s_branch g3_ld_bar
g3_ld_end:
    s_barrier
    s_branch g4_in
g3_done:
    s_endpgm
g3_compute:
    v_lshrrev_b32 v5, 4, v2
    v_bfe_u32 v6, v2, 2, 2
    v_and_b32 v7, 3, v2
    v_and_b32 v8, 15, v2
    s_and_b32 s44, s28, 1
    s_lshr_b32 s45, s28, 1
    s_mul_i32 s40, s25, 128
    s_mul_i32 s41, s45, 64
    s_add_u32 s40, s40, s41
    v_add_u32 v20, s40, v8
    s_mov_b32 s41, 8192
    v_mul_lo_u32 v9, v20, s41
    s_mul_i32 s40, s24, 256
    s_mul_i32 s41, s44, 128
    s_add_u32 s46, s40, s41
    v_and_b32 v3, 1, v5
    v_lshlrev_b32 v3, 5, v3
    v_lshrrev_b32 v4, 1, v5
    v_lshl_add_u32 v3, v4, 4, v3
    v_add3_u32 v9, v9, v3, s46
    s_mov_b32 s52, 0
    s_mov_b32 s53, 131072
    s_mov_b32 s54, 262144
    s_mov_b32 s55, 393216
    s_waitcnt lgkmcnt(0)
    s_add_u32 s4, s4, s97
    s_addc_u32 s5, s5, 0
    s_mov_b32 s20, s6
    s_mov_b32 s21, s7
    s_mov_b32 s22, 0x1c00
    s_mov_b32 s23, 0x20000
    s_add_u32 s16, s4, 0x1100000
    s_addc_u32 s17, s5, 0
    s_mov_b32 s18, 0x800000
    s_mov_b32 s19, 0x20000
    v_lshl_add_u32 v3, v5, 3, s46
    buffer_load_dwordx2 v[92:93], v3, s[20:23], 0 offen offset:0
    buffer_load_dwordx2 v[94:95], v3, s[20:23], 0 offen offset:32
    buffer_load_dwordx2 v[96:97], v3, s[20:23], 0 offen offset:64
    buffer_load_dwordx2 v[98:99], v3, s[20:23], 0 offen offset:96
    s_mul_i32 s42, s44, 4
    s_mov_b32 s43, 0
    v_and_b32 v3, 1, v5
    v_lshl_or_b32 v3, v3, 2, v6
    s_add_u32 s40, s42, 0
    v_xor_b32 v3, s40, v3
    v_lshlrev_b32 v3, 5, v3
    v_lshl_add_u32 v3, v7, 3, v3
    v_lshl_add_u32 v4, v5, 3, v6
    v_lshl_add_u32 v3, v4, 8, v3
    v_add_u32 v10, s43, v3
    v_and_b32 v3, 1, v5
    v_lshl_or_b32 v3, v3, 2, v6
    s_add_u32 s40, s42, 1
    v_xor_b32 v3, s40, v3
    v_lshlrev_b32 v3, 5, v3
    v_lshl_add_u32 v3, v7, 3, v3
    v_lshl_add_u32 v4, v5, 3, v6
    v_lshl_add_u32 v3, v4, 8, v3
    v_add_u32 v11, s43, v3
    v_and_b32 v3, 1, v5
    v_lshl_or_b32 v3, v3, 2, v6
    s_add_u32 s40, s42, 2
    v_xor_b32 v3, s40, v3
    v_lshlrev_b32 v3, 5, v3
    v_lshl_add_u32 v3, v7, 3, v3
    v_lshl_add_u32 v4, v5, 3, v6
    v_lshl_add_u32 v3, v4, 8, v3
    v_add_u32 v12, s43, v3
    v_and_b32 v3, 1, v5
    v_lshl_or_b32 v3, v3, 2, v6
    s_add_u32 s40, s42, 3
    v_xor_b32 v3, s40, v3
    v_lshlrev_b32 v3, 5, v3
    v_lshl_add_u32 v3, v7, 3, v3
    v_lshl_add_u32 v4, v5, 3, v6
    v_lshl_add_u32 v3, v4, 8, v3
    v_add_u32 v13, s43, v3
    s_mul_i32 s42, s45, 4
    s_mov_b32 s43, 16384
    v_and_b32 v3, 1, v5
    v_lshl_or_b32 v3, v3, 2, v6
    s_add_u32 s40, s42, 0
    v_xor_b32 v3, s40, v3
    v_lshlrev_b32 v3, 5, v3
    v_lshl_add_u32 v3, v7, 3, v3
    v_lshl_add_u32 v4, v5, 3, v6
    v_lshl_add_u32 v3, v4, 8, v3
    v_add_u32 v14, s43, v3
    v_and_b32 v3, 1, v5
    v_lshl_or_b32 v3, v3, 2, v6
    s_add_u32 s40, s42, 1
    v_xor_b32 v3, s40, v3
    v_lshlrev_b32 v3, 5, v3
    v_lshl_add_u32 v3, v7, 3, v3
    v_lshl_add_u32 v4, v5, 3, v6
    v_lshl_add_u32 v3, v4, 8, v3
    v_add_u32 v15, s43, v3
    v_and_b32 v3, 1, v5
    v_lshl_or_b32 v3, v3, 2, v6
    s_add_u32 s40, s42, 2
    v_xor_b32 v3, s40, v3
    v_lshlrev_b32 v3, 5, v3
    v_lshl_add_u32 v3, v7, 3, v3
    v_lshl_add_u32 v4, v5, 3, v6
    v_lshl_add_u32 v3, v4, 8, v3
    v_add_u32 v16, s43, v3
    v_and_b32 v3, 1, v5
    v_lshl_or_b32 v3, v3, 2, v6
    s_add_u32 s40, s42, 3
    v_xor_b32 v3, s40, v3
    v_lshlrev_b32 v3, 5, v3
    v_lshl_add_u32 v3, v7, 3, v3
    v_lshl_add_u32 v4, v5, 3, v6
    v_lshl_add_u32 v3, v4, 8, v3
    v_add_u32 v17, s43, v3
    s_mov_b32 s48, 32
    s_mov_b32 s50, 0
    s_mov_b32 s51, 32768
    s_mov_b32 s29, 0xfffe8000
    s_waitcnt vmcnt(0)
    v_lshlrev_b32 v28, 16, v92
    v_and_b32 v29, 0xffff0000, v92
    v_lshlrev_b32 v30, 16, v93
    v_and_b32 v31, 0xffff0000, v93
    v_lshlrev_b32 v32, 16, v92
    v_and_b32 v33, 0xffff0000, v92
    v_lshlrev_b32 v34, 16, v93
    v_and_b32 v35, 0xffff0000, v93
    v_lshlrev_b32 v36, 16, v92
    v_and_b32 v37, 0xffff0000, v92
    v_lshlrev_b32 v38, 16, v93
    v_and_b32 v39, 0xffff0000, v93
    v_lshlrev_b32 v40, 16, v92
    v_and_b32 v41, 0xffff0000, v92
    v_lshlrev_b32 v42, 16, v93
    v_and_b32 v43, 0xffff0000, v93
    v_lshlrev_b32 v44, 16, v94
    v_and_b32 v45, 0xffff0000, v94
    v_lshlrev_b32 v46, 16, v95
    v_and_b32 v47, 0xffff0000, v95
    v_lshlrev_b32 v48, 16, v94
    v_and_b32 v49, 0xffff0000, v94
    v_lshlrev_b32 v50, 16, v95
    v_and_b32 v51, 0xffff0000, v95
    v_lshlrev_b32 v52, 16, v94
    v_and_b32 v53, 0xffff0000, v94
    v_lshlrev_b32 v54, 16, v95
    v_and_b32 v55, 0xffff0000, v95
    v_lshlrev_b32 v56, 16, v94
    v_and_b32 v57, 0xffff0000, v94
    v_lshlrev_b32 v58, 16, v95
    v_and_b32 v59, 0xffff0000, v95
    v_lshlrev_b32 v60, 16, v96
    v_and_b32 v61, 0xffff0000, v96
    v_lshlrev_b32 v62, 16, v97
    v_and_b32 v63, 0xffff0000, v97
    v_lshlrev_b32 v64, 16, v96
    v_and_b32 v65, 0xffff0000, v96
    v_lshlrev_b32 v66, 16, v97
    v_and_b32 v67, 0xffff0000, v97
    v_lshlrev_b32 v68, 16, v96
    v_and_b32 v69, 0xffff0000, v96
    v_lshlrev_b32 v70, 16, v97
    v_and_b32 v71, 0xffff0000, v97
    v_lshlrev_b32 v72, 16, v96
    v_and_b32 v73, 0xffff0000, v96
    v_lshlrev_b32 v74, 16, v97
    v_and_b32 v75, 0xffff0000, v97
    v_lshlrev_b32 v76, 16, v98
    v_and_b32 v77, 0xffff0000, v98
    v_lshlrev_b32 v78, 16, v99
    v_and_b32 v79, 0xffff0000, v99
    v_lshlrev_b32 v80, 16, v98
    v_and_b32 v81, 0xffff0000, v98
    v_lshlrev_b32 v82, 16, v99
    v_and_b32 v83, 0xffff0000, v99
    v_lshlrev_b32 v84, 16, v98
    v_and_b32 v85, 0xffff0000, v98
    v_lshlrev_b32 v86, 16, v99
    v_and_b32 v87, 0xffff0000, v99
    v_lshlrev_b32 v88, 16, v98
    v_and_b32 v89, 0xffff0000, v98
    v_lshlrev_b32 v90, 16, v99
    v_and_b32 v91, 0xffff0000, v99
    v_mov_b32 v156, 0xbdd2d3e8
    v_mov_b32 v157, 0xbdd2d3e8
    v_mov_b32 v158, 0xc0135761
    v_mov_b32 v159, 0xc0135761
    v_mov_b32 v160, 0x3f800000
    v_mov_b32 v161, 0x3f800000
    s_barrier
    ds_read_b64_tr_b16 v[92:93], v10 offset:0
    ds_read_b64_tr_b16 v[94:95], v10 offset:1024
    ds_read_b64_tr_b16 v[108:109], v14 offset:0
    ds_read_b64_tr_b16 v[110:111], v14 offset:1024
    ds_read_b64_tr_b16 v[112:113], v15 offset:0
    ds_read_b64_tr_b16 v[114:115], v15 offset:1024
    ds_read_b64_tr_b16 v[116:117], v16 offset:0
    ds_read_b64_tr_b16 v[118:119], v16 offset:1024
    ds_read_b64_tr_b16 v[120:121], v17 offset:0
    ds_read_b64_tr_b16 v[122:123], v17 offset:1024
    ds_read_b64_tr_b16 v[96:97], v11 offset:0
    ds_read_b64_tr_b16 v[98:99], v11 offset:1024
    ds_read_b64_tr_b16 v[100:101], v12 offset:0
    ds_read_b64_tr_b16 v[102:103], v12 offset:1024
    ds_read_b64_tr_b16 v[104:105], v13 offset:0
    ds_read_b64_tr_b16 v[106:107], v13 offset:1024
    s_branch g3_cloop3
.p2align 3
g3_cloop:
    s_barrier
g3_cloop2:
    v_mfma_f32_16x16x32_bf16 v[28:31], v[124:127], v[140:143], v[28:31]
    ds_read_b64_tr_b16 v[92:93], v10 offset:0
    ds_read_b64_tr_b16 v[94:95], v10 offset:1024
    v_mfma_f32_16x16x32_bf16 v[32:35], v[124:127], v[144:147], v[32:35]
    ds_read_b64_tr_b16 v[108:109], v14 offset:0
    ds_read_b64_tr_b16 v[110:111], v14 offset:1024
    v_mfma_f32_16x16x32_bf16 v[36:39], v[124:127], v[148:151], v[36:39]
    ds_read_b64_tr_b16 v[112:113], v15 offset:0
    ds_read_b64_tr_b16 v[114:115], v15 offset:1024
    v_mfma_f32_16x16x32_bf16 v[40:43], v[124:127], v[152:155], v[40:43]
    ds_read_b64_tr_b16 v[116:117], v16 offset:0
    ds_read_b64_tr_b16 v[118:119], v16 offset:1024
    v_mfma_f32_16x16x32_bf16 v[56:59], v[128:131], v[152:155], v[56:59]
    ds_read_b64_tr_b16 v[120:121], v17 offset:0
    ds_read_b64_tr_b16 v[122:123], v17 offset:1024
    v_mfma_f32_16x16x32_bf16 v[52:55], v[128:131], v[148:151], v[52:55]
    ds_read_b64_tr_b16 v[96:97], v11 offset:0
    ds_read_b64_tr_b16 v[98:99], v11 offset:1024
    v_mfma_f32_16x16x32_bf16 v[48:51], v[128:131], v[144:147], v[48:51]
    ds_read_b64_tr_b16 v[100:101], v12 offset:0
    ds_read_b64_tr_b16 v[102:103], v12 offset:1024
    v_mfma_f32_16x16x32_bf16 v[44:47], v[128:131], v[140:143], v[44:47]
    ds_read_b64_tr_b16 v[104:105], v13 offset:0
    ds_read_b64_tr_b16 v[106:107], v13 offset:1024
    v_mfma_f32_16x16x32_bf16 v[60:63], v[132:135], v[140:143], v[60:63]
    v_mfma_f32_16x16x32_bf16 v[64:67], v[132:135], v[144:147], v[64:67]
    v_mfma_f32_16x16x32_bf16 v[68:71], v[132:135], v[148:151], v[68:71]
    v_mfma_f32_16x16x32_bf16 v[72:75], v[132:135], v[152:155], v[72:75]
    v_mfma_f32_16x16x32_bf16 v[88:91], v[136:139], v[152:155], v[88:91]
    v_mfma_f32_16x16x32_bf16 v[84:87], v[136:139], v[148:151], v[84:87]
    v_mfma_f32_16x16x32_bf16 v[80:83], v[136:139], v[144:147], v[80:83]
    v_mfma_f32_16x16x32_bf16 v[76:79], v[136:139], v[140:143], v[76:79]
g3_cloop3:
    s_waitcnt lgkmcnt(0)
    v_mfma_f32_16x16x32_bf16 v[28:31], v[92:95], v[108:111], v[28:31]
    ds_read_b64_tr_b16 v[124:125], v10 offset:8192
    ds_read_b64_tr_b16 v[126:127], v10 offset:9216
    v_mfma_f32_16x16x32_bf16 v[32:35], v[92:95], v[112:115], v[32:35]
    ds_read_b64_tr_b16 v[140:141], v14 offset:8192
    ds_read_b64_tr_b16 v[142:143], v14 offset:9216
    v_mfma_f32_16x16x32_bf16 v[36:39], v[92:95], v[116:119], v[36:39]
    ds_read_b64_tr_b16 v[144:145], v15 offset:8192
    ds_read_b64_tr_b16 v[146:147], v15 offset:9216
    v_mfma_f32_16x16x32_bf16 v[40:43], v[92:95], v[120:123], v[40:43]
    ds_read_b64_tr_b16 v[148:149], v16 offset:8192
    ds_read_b64_tr_b16 v[150:151], v16 offset:9216
    v_mfma_f32_16x16x32_bf16 v[56:59], v[96:99], v[120:123], v[56:59]
    ds_read_b64_tr_b16 v[152:153], v17 offset:8192
    ds_read_b64_tr_b16 v[154:155], v17 offset:9216
    v_mfma_f32_16x16x32_bf16 v[52:55], v[96:99], v[116:119], v[52:55]
    ds_read_b64_tr_b16 v[128:129], v11 offset:8192
    ds_read_b64_tr_b16 v[130:131], v11 offset:9216
    v_mfma_f32_16x16x32_bf16 v[48:51], v[96:99], v[112:115], v[48:51]
    ds_read_b64_tr_b16 v[132:133], v12 offset:8192
    ds_read_b64_tr_b16 v[134:135], v12 offset:9216
    v_mfma_f32_16x16x32_bf16 v[44:47], v[96:99], v[108:111], v[44:47]
    ds_read_b64_tr_b16 v[136:137], v13 offset:8192
    ds_read_b64_tr_b16 v[138:139], v13 offset:9216
    v_mfma_f32_16x16x32_bf16 v[60:63], v[100:103], v[108:111], v[60:63]
    s_add_u32 s50, s50, 1
    s_cmp_eq_u32 s50, 4
    v_mfma_f32_16x16x32_bf16 v[64:67], v[100:103], v[112:115], v[64:67]
    s_cselect_b32 s49, s29, s51
    s_cselect_b32 s50, 0, s50
    v_mfma_f32_16x16x32_bf16 v[68:71], v[100:103], v[116:119], v[68:71]
    v_add_u32 v10, s49, v10
    v_add_u32 v11, s49, v11
    v_mfma_f32_16x16x32_bf16 v[72:75], v[100:103], v[120:123], v[72:75]
    v_add_u32 v12, s49, v12
    v_add_u32 v13, s49, v13
    v_mfma_f32_16x16x32_bf16 v[88:91], v[104:107], v[120:123], v[88:91]
    v_add_u32 v14, s49, v14
    v_add_u32 v15, s49, v15
    v_mfma_f32_16x16x32_bf16 v[84:87], v[104:107], v[116:119], v[84:87]
    v_add_u32 v16, s49, v16
    v_add_u32 v17, s49, v17
    v_mfma_f32_16x16x32_bf16 v[80:83], v[104:107], v[112:115], v[80:83]
    s_sub_u32 s48, s48, 1
    s_cmp_lg_u32 s48, 0
    v_mfma_f32_16x16x32_bf16 v[76:79], v[104:107], v[108:111], v[76:79]
    s_waitcnt lgkmcnt(0)
    s_cbranch_scc1 g3_cloop
    v_mfma_f32_16x16x32_bf16 v[28:31], v[124:127], v[140:143], v[28:31]
    v_mfma_f32_16x16x32_bf16 v[44:47], v[128:131], v[140:143], v[44:47]
    v_mfma_f32_16x16x32_bf16 v[60:63], v[132:135], v[140:143], v[60:63]
    v_mfma_f32_16x16x32_bf16 v[76:79], v[136:139], v[140:143], v[76:79]
    v_mfma_f32_16x16x32_bf16 v[32:35], v[124:127], v[144:147], v[32:35]
    v_mfma_f32_16x16x32_bf16 v[48:51], v[128:131], v[144:147], v[48:51]
    v_mfma_f32_16x16x32_bf16 v[64:67], v[132:135], v[144:147], v[64:67]
    v_mfma_f32_16x16x32_bf16 v[80:83], v[136:139], v[144:147], v[80:83]
    s_nop 1
    v_mfma_f32_16x16x32_bf16 v[36:39], v[124:127], v[148:151], v[36:39]
    v_pk_mul_f32 v[108:109], v[28:29], v[28:29]
    v_pk_mul_f32 v[110:111], v[30:31], v[30:31]
    v_pk_mul_f32 v[112:113], v[44:45], v[44:45]
    v_pk_mul_f32 v[114:115], v[46:47], v[46:47]
    v_pk_fma_f32 v[108:109], v[108:109], v[156:157], v[158:159]
    v_pk_fma_f32 v[110:111], v[110:111], v[156:157], v[158:159]
    v_pk_fma_f32 v[112:113], v[112:113], v[156:157], v[158:159]
    v_pk_fma_f32 v[114:115], v[114:115], v[156:157], v[158:159]
    v_pk_mul_f32 v[108:109], v[108:109], v[28:29]
    v_pk_mul_f32 v[110:111], v[110:111], v[30:31]
    v_pk_mul_f32 v[112:113], v[112:113], v[44:45]
    v_pk_mul_f32 v[114:115], v[114:115], v[46:47]
    v_exp_f32 v108, v108
    v_exp_f32 v109, v109
    v_exp_f32 v110, v110
    v_exp_f32 v111, v111
    v_exp_f32 v112, v112
    v_exp_f32 v113, v113
    v_exp_f32 v114, v114
    v_exp_f32 v115, v115
    v_pk_add_f32 v[108:109], v[108:109], v[160:161]
    v_pk_add_f32 v[110:111], v[110:111], v[160:161]
    v_mfma_f32_16x16x32_bf16 v[52:55], v[128:131], v[148:151], v[52:55]
    v_pk_add_f32 v[112:113], v[112:113], v[160:161]
    v_pk_add_f32 v[114:115], v[114:115], v[160:161]
    v_rcp_f32 v108, v108
    v_rcp_f32 v109, v109
    v_rcp_f32 v110, v110
    v_rcp_f32 v111, v111
    v_rcp_f32 v112, v112
    v_rcp_f32 v113, v113
    v_rcp_f32 v114, v114
    v_rcp_f32 v115, v115
    v_pk_mul_f32 v[28:29], v[28:29], v[108:109]
    v_pk_mul_f32 v[30:31], v[30:31], v[110:111]
    v_pk_mul_f32 v[44:45], v[44:45], v[112:113]
    v_pk_mul_f32 v[46:47], v[46:47], v[114:115]
    v_cvt_pk_bf16_f32 v92, v28, v29
    v_cvt_pk_bf16_f32 v93, v30, v31
    v_cvt_pk_bf16_f32 v94, v44, v45
    v_cvt_pk_bf16_f32 v95, v46, v47
    s_nop 1
    v_permlane16_swap_b32 v92, v94
    v_permlane16_swap_b32 v93, v95
    buffer_store_dwordx4 v[92:95], v9, s[16:19], s52 offen offset:0 sc1
    v_mfma_f32_16x16x32_bf16 v[68:71], v[132:135], v[148:151], v[68:71]
    v_pk_mul_f32 v[108:109], v[60:61], v[60:61]
    v_pk_mul_f32 v[110:111], v[62:63], v[62:63]
    v_pk_mul_f32 v[112:113], v[76:77], v[76:77]
    v_pk_mul_f32 v[114:115], v[78:79], v[78:79]
    v_pk_fma_f32 v[108:109], v[108:109], v[156:157], v[158:159]
    v_pk_fma_f32 v[110:111], v[110:111], v[156:157], v[158:159]
    v_pk_fma_f32 v[112:113], v[112:113], v[156:157], v[158:159]
    v_pk_fma_f32 v[114:115], v[114:115], v[156:157], v[158:159]
    v_pk_mul_f32 v[108:109], v[108:109], v[60:61]
    v_pk_mul_f32 v[110:111], v[110:111], v[62:63]
    v_pk_mul_f32 v[112:113], v[112:113], v[76:77]
    v_pk_mul_f32 v[114:115], v[114:115], v[78:79]
    v_exp_f32 v108, v108
    v_exp_f32 v109, v109
    v_exp_f32 v110, v110
    v_exp_f32 v111, v111
    v_exp_f32 v112, v112
    v_exp_f32 v113, v113
    v_exp_f32 v114, v114
    v_exp_f32 v115, v115
    v_pk_add_f32 v[108:109], v[108:109], v[160:161]
    v_pk_add_f32 v[110:111], v[110:111], v[160:161]
    v_mfma_f32_16x16x32_bf16 v[84:87], v[136:139], v[148:151], v[84:87]
    v_pk_add_f32 v[112:113], v[112:113], v[160:161]
    v_pk_add_f32 v[114:115], v[114:115], v[160:161]
    v_rcp_f32 v108, v108
    v_rcp_f32 v109, v109
    v_rcp_f32 v110, v110
    v_rcp_f32 v111, v111
    v_rcp_f32 v112, v112
    v_rcp_f32 v113, v113
    v_rcp_f32 v114, v114
    v_rcp_f32 v115, v115
    v_pk_mul_f32 v[60:61], v[60:61], v[108:109]
    v_pk_mul_f32 v[62:63], v[62:63], v[110:111]
    v_pk_mul_f32 v[76:77], v[76:77], v[112:113]
    v_pk_mul_f32 v[78:79], v[78:79], v[114:115]
    v_cvt_pk_bf16_f32 v96, v60, v61
    v_cvt_pk_bf16_f32 v97, v62, v63
    v_cvt_pk_bf16_f32 v98, v76, v77
    v_cvt_pk_bf16_f32 v99, v78, v79
    s_nop 1
    v_permlane16_swap_b32 v96, v98
    v_permlane16_swap_b32 v97, v99
    buffer_store_dwordx4 v[96:99], v9, s[16:19], s52 offen offset:64 sc1
    v_mfma_f32_16x16x32_bf16 v[40:43], v[124:127], v[152:155], v[40:43]
    v_pk_mul_f32 v[108:109], v[32:33], v[32:33]
    v_pk_mul_f32 v[110:111], v[34:35], v[34:35]
    v_pk_mul_f32 v[112:113], v[48:49], v[48:49]
    v_pk_mul_f32 v[114:115], v[50:51], v[50:51]
    v_pk_fma_f32 v[108:109], v[108:109], v[156:157], v[158:159]
    v_pk_fma_f32 v[110:111], v[110:111], v[156:157], v[158:159]
    v_pk_fma_f32 v[112:113], v[112:113], v[156:157], v[158:159]
    v_pk_fma_f32 v[114:115], v[114:115], v[156:157], v[158:159]
    v_pk_mul_f32 v[108:109], v[108:109], v[32:33]
    v_pk_mul_f32 v[110:111], v[110:111], v[34:35]
    v_pk_mul_f32 v[112:113], v[112:113], v[48:49]
    v_pk_mul_f32 v[114:115], v[114:115], v[50:51]
    v_exp_f32 v108, v108
    v_exp_f32 v109, v109
    v_exp_f32 v110, v110
    v_exp_f32 v111, v111
    v_exp_f32 v112, v112
    v_exp_f32 v113, v113
    v_exp_f32 v114, v114
    v_exp_f32 v115, v115
    v_pk_add_f32 v[108:109], v[108:109], v[160:161]
    v_pk_add_f32 v[110:111], v[110:111], v[160:161]
    v_mfma_f32_16x16x32_bf16 v[56:59], v[128:131], v[152:155], v[56:59]
    v_pk_add_f32 v[112:113], v[112:113], v[160:161]
    v_pk_add_f32 v[114:115], v[114:115], v[160:161]
    v_rcp_f32 v108, v108
    v_rcp_f32 v109, v109
    v_rcp_f32 v110, v110
    v_rcp_f32 v111, v111
    v_rcp_f32 v112, v112
    v_rcp_f32 v113, v113
    v_rcp_f32 v114, v114
    v_rcp_f32 v115, v115
    v_pk_mul_f32 v[32:33], v[32:33], v[108:109]
    v_pk_mul_f32 v[34:35], v[34:35], v[110:111]
    v_pk_mul_f32 v[48:49], v[48:49], v[112:113]
    v_pk_mul_f32 v[50:51], v[50:51], v[114:115]
    v_cvt_pk_bf16_f32 v100, v32, v33
    v_cvt_pk_bf16_f32 v101, v34, v35
    v_cvt_pk_bf16_f32 v102, v48, v49
    v_cvt_pk_bf16_f32 v103, v50, v51
    s_nop 1
    v_permlane16_swap_b32 v100, v102
    v_permlane16_swap_b32 v101, v103
    buffer_store_dwordx4 v[100:103], v9, s[16:19], s53 offen offset:0 sc1
    v_mfma_f32_16x16x32_bf16 v[72:75], v[132:135], v[152:155], v[72:75]
    v_pk_mul_f32 v[108:109], v[64:65], v[64:65]
    v_pk_mul_f32 v[110:111], v[66:67], v[66:67]
    v_pk_mul_f32 v[112:113], v[80:81], v[80:81]
    v_pk_mul_f32 v[114:115], v[82:83], v[82:83]
    v_pk_fma_f32 v[108:109], v[108:109], v[156:157], v[158:159]
    v_pk_fma_f32 v[110:111], v[110:111], v[156:157], v[158:159]
    v_pk_fma_f32 v[112:113], v[112:113], v[156:157], v[158:159]
    v_pk_fma_f32 v[114:115], v[114:115], v[156:157], v[158:159]
    v_pk_mul_f32 v[108:109], v[108:109], v[64:65]
    v_pk_mul_f32 v[110:111], v[110:111], v[66:67]
    v_pk_mul_f32 v[112:113], v[112:113], v[80:81]
    v_pk_mul_f32 v[114:115], v[114:115], v[82:83]
    v_exp_f32 v108, v108
    v_exp_f32 v109, v109
    v_exp_f32 v110, v110
    v_exp_f32 v111, v111
    v_exp_f32 v112, v112
    v_exp_f32 v113, v113
    v_exp_f32 v114, v114
    v_exp_f32 v115, v115
    v_pk_add_f32 v[108:109], v[108:109], v[160:161]
    v_pk_add_f32 v[110:111], v[110:111], v[160:161]
    v_mfma_f32_16x16x32_bf16 v[88:91], v[136:139], v[152:155], v[88:91]
    v_pk_add_f32 v[112:113], v[112:113], v[160:161]
    v_pk_add_f32 v[114:115], v[114:115], v[160:161]
    v_rcp_f32 v108, v108
    v_rcp_f32 v109, v109
    v_rcp_f32 v110, v110
    v_rcp_f32 v111, v111
    v_rcp_f32 v112, v112
    v_rcp_f32 v113, v113
    v_rcp_f32 v114, v114
    v_rcp_f32 v115, v115
    v_pk_mul_f32 v[64:65], v[64:65], v[108:109]
    v_pk_mul_f32 v[66:67], v[66:67], v[110:111]
    v_pk_mul_f32 v[80:81], v[80:81], v[112:113]
    v_pk_mul_f32 v[82:83], v[82:83], v[114:115]
    v_cvt_pk_bf16_f32 v104, v64, v65
    v_cvt_pk_bf16_f32 v105, v66, v67
    v_cvt_pk_bf16_f32 v106, v80, v81
    v_cvt_pk_bf16_f32 v107, v82, v83
    s_nop 1
    v_permlane16_swap_b32 v104, v106
    v_permlane16_swap_b32 v105, v107
    buffer_store_dwordx4 v[104:107], v9, s[16:19], s53 offen offset:64 sc1
    v_pk_mul_f32 v[108:109], v[36:37], v[36:37]
    v_pk_mul_f32 v[110:111], v[38:39], v[38:39]
    v_pk_mul_f32 v[112:113], v[52:53], v[52:53]
    v_pk_mul_f32 v[114:115], v[54:55], v[54:55]
    v_pk_fma_f32 v[108:109], v[108:109], v[156:157], v[158:159]
    v_pk_fma_f32 v[110:111], v[110:111], v[156:157], v[158:159]
    v_pk_fma_f32 v[112:113], v[112:113], v[156:157], v[158:159]
    v_pk_fma_f32 v[114:115], v[114:115], v[156:157], v[158:159]
    v_pk_mul_f32 v[108:109], v[108:109], v[36:37]
    v_pk_mul_f32 v[110:111], v[110:111], v[38:39]
    v_pk_mul_f32 v[112:113], v[112:113], v[52:53]
    v_pk_mul_f32 v[114:115], v[114:115], v[54:55]
    v_exp_f32 v108, v108
    v_exp_f32 v109, v109
    v_exp_f32 v110, v110
    v_exp_f32 v111, v111
    v_exp_f32 v112, v112
    v_exp_f32 v113, v113
    v_exp_f32 v114, v114
    v_exp_f32 v115, v115
    v_pk_add_f32 v[108:109], v[108:109], v[160:161]
    v_pk_add_f32 v[110:111], v[110:111], v[160:161]
    v_pk_add_f32 v[112:113], v[112:113], v[160:161]
    v_pk_add_f32 v[114:115], v[114:115], v[160:161]
    v_rcp_f32 v108, v108
    v_rcp_f32 v109, v109
    v_rcp_f32 v110, v110
    v_rcp_f32 v111, v111
    v_rcp_f32 v112, v112
    v_rcp_f32 v113, v113
    v_rcp_f32 v114, v114
    v_rcp_f32 v115, v115
    v_pk_mul_f32 v[36:37], v[36:37], v[108:109]
    v_pk_mul_f32 v[38:39], v[38:39], v[110:111]
    v_pk_mul_f32 v[52:53], v[52:53], v[112:113]
    v_pk_mul_f32 v[54:55], v[54:55], v[114:115]
    v_cvt_pk_bf16_f32 v92, v36, v37
    v_cvt_pk_bf16_f32 v93, v38, v39
    v_cvt_pk_bf16_f32 v94, v52, v53
    v_cvt_pk_bf16_f32 v95, v54, v55
    s_nop 1
    v_permlane16_swap_b32 v92, v94
    v_permlane16_swap_b32 v93, v95
    buffer_store_dwordx4 v[92:95], v9, s[16:19], s54 offen offset:0 sc1
    v_pk_mul_f32 v[108:109], v[68:69], v[68:69]
    v_pk_mul_f32 v[110:111], v[70:71], v[70:71]
    v_pk_mul_f32 v[112:113], v[84:85], v[84:85]
    v_pk_mul_f32 v[114:115], v[86:87], v[86:87]
    v_pk_fma_f32 v[108:109], v[108:109], v[156:157], v[158:159]
    v_pk_fma_f32 v[110:111], v[110:111], v[156:157], v[158:159]
    v_pk_fma_f32 v[112:113], v[112:113], v[156:157], v[158:159]
    v_pk_fma_f32 v[114:115], v[114:115], v[156:157], v[158:159]
    v_pk_mul_f32 v[108:109], v[108:109], v[68:69]
    v_pk_mul_f32 v[110:111], v[110:111], v[70:71]
    v_pk_mul_f32 v[112:113], v[112:113], v[84:85]
    v_pk_mul_f32 v[114:115], v[114:115], v[86:87]
    v_exp_f32 v108, v108
    v_exp_f32 v109, v109
    v_exp_f32 v110, v110
    v_exp_f32 v111, v111
    v_exp_f32 v112, v112
    v_exp_f32 v113, v113
    v_exp_f32 v114, v114
    v_exp_f32 v115, v115
    v_pk_add_f32 v[108:109], v[108:109], v[160:161]
    v_pk_add_f32 v[110:111], v[110:111], v[160:161]
    v_pk_add_f32 v[112:113], v[112:113], v[160:161]
    v_pk_add_f32 v[114:115], v[114:115], v[160:161]
    v_rcp_f32 v108, v108
    v_rcp_f32 v109, v109
    v_rcp_f32 v110, v110
    v_rcp_f32 v111, v111
    v_rcp_f32 v112, v112
    v_rcp_f32 v113, v113
    v_rcp_f32 v114, v114
    v_rcp_f32 v115, v115
    v_pk_mul_f32 v[68:69], v[68:69], v[108:109]
    v_pk_mul_f32 v[70:71], v[70:71], v[110:111]
    v_pk_mul_f32 v[84:85], v[84:85], v[112:113]
    v_pk_mul_f32 v[86:87], v[86:87], v[114:115]
    v_cvt_pk_bf16_f32 v96, v68, v69
    v_cvt_pk_bf16_f32 v97, v70, v71
    v_cvt_pk_bf16_f32 v98, v84, v85
    v_cvt_pk_bf16_f32 v99, v86, v87
    s_nop 1
    v_permlane16_swap_b32 v96, v98
    v_permlane16_swap_b32 v97, v99
    buffer_store_dwordx4 v[96:99], v9, s[16:19], s54 offen offset:64 sc1
    v_pk_mul_f32 v[108:109], v[40:41], v[40:41]
    v_pk_mul_f32 v[110:111], v[42:43], v[42:43]
    v_pk_mul_f32 v[112:113], v[56:57], v[56:57]
    v_pk_mul_f32 v[114:115], v[58:59], v[58:59]
    v_pk_fma_f32 v[108:109], v[108:109], v[156:157], v[158:159]
    v_pk_fma_f32 v[110:111], v[110:111], v[156:157], v[158:159]
    v_pk_fma_f32 v[112:113], v[112:113], v[156:157], v[158:159]
    v_pk_fma_f32 v[114:115], v[114:115], v[156:157], v[158:159]
    v_pk_mul_f32 v[108:109], v[108:109], v[40:41]
    v_pk_mul_f32 v[110:111], v[110:111], v[42:43]
    v_pk_mul_f32 v[112:113], v[112:113], v[56:57]
    v_pk_mul_f32 v[114:115], v[114:115], v[58:59]
    v_exp_f32 v108, v108
    v_exp_f32 v109, v109
    v_exp_f32 v110, v110
    v_exp_f32 v111, v111
    v_exp_f32 v112, v112
    v_exp_f32 v113, v113
    v_exp_f32 v114, v114
    v_exp_f32 v115, v115
    v_pk_add_f32 v[108:109], v[108:109], v[160:161]
    v_pk_add_f32 v[110:111], v[110:111], v[160:161]
    v_pk_add_f32 v[112:113], v[112:113], v[160:161]
    v_pk_add_f32 v[114:115], v[114:115], v[160:161]
    v_rcp_f32 v108, v108
    v_rcp_f32 v109, v109
    v_rcp_f32 v110, v110
    v_rcp_f32 v111, v111
    v_rcp_f32 v112, v112
    v_rcp_f32 v113, v113
    v_rcp_f32 v114, v114
    v_rcp_f32 v115, v115
    v_pk_mul_f32 v[40:41], v[40:41], v[108:109]
    v_pk_mul_f32 v[42:43], v[42:43], v[110:111]
    v_pk_mul_f32 v[56:57], v[56:57], v[112:113]
    v_pk_mul_f32 v[58:59], v[58:59], v[114:115]
    v_cvt_pk_bf16_f32 v100, v40, v41
    v_cvt_pk_bf16_f32 v101, v42, v43
    v_cvt_pk_bf16_f32 v102, v56, v57
    v_cvt_pk_bf16_f32 v103, v58, v59
    s_nop 1
    v_permlane16_swap_b32 v100, v102
    v_permlane16_swap_b32 v101, v103
    buffer_store_dwordx4 v[100:103], v9, s[16:19], s55 offen offset:0 sc1
    v_pk_mul_f32 v[108:109], v[72:73], v[72:73]
    v_pk_mul_f32 v[110:111], v[74:75], v[74:75]
    v_pk_mul_f32 v[112:113], v[88:89], v[88:89]
    v_pk_mul_f32 v[114:115], v[90:91], v[90:91]
    v_pk_fma_f32 v[108:109], v[108:109], v[156:157], v[158:159]
    v_pk_fma_f32 v[110:111], v[110:111], v[156:157], v[158:159]
    v_pk_fma_f32 v[112:113], v[112:113], v[156:157], v[158:159]
    v_pk_fma_f32 v[114:115], v[114:115], v[156:157], v[158:159]
    v_pk_mul_f32 v[108:109], v[108:109], v[72:73]
    v_pk_mul_f32 v[110:111], v[110:111], v[74:75]
    v_pk_mul_f32 v[112:113], v[112:113], v[88:89]
    v_pk_mul_f32 v[114:115], v[114:115], v[90:91]
    v_exp_f32 v108, v108
    v_exp_f32 v109, v109
    v_exp_f32 v110, v110
    v_exp_f32 v111, v111
    v_exp_f32 v112, v112
    v_exp_f32 v113, v113
    v_exp_f32 v114, v114
    v_exp_f32 v115, v115
    v_pk_add_f32 v[108:109], v[108:109], v[160:161]
    v_pk_add_f32 v[110:111], v[110:111], v[160:161]
    v_pk_add_f32 v[112:113], v[112:113], v[160:161]
    v_pk_add_f32 v[114:115], v[114:115], v[160:161]
    v_rcp_f32 v108, v108
    v_rcp_f32 v109, v109
    v_rcp_f32 v110, v110
    v_rcp_f32 v111, v111
    v_rcp_f32 v112, v112
    v_rcp_f32 v113, v113
    v_rcp_f32 v114, v114
    v_rcp_f32 v115, v115
    v_pk_mul_f32 v[72:73], v[72:73], v[108:109]
    v_pk_mul_f32 v[74:75], v[74:75], v[110:111]
    v_pk_mul_f32 v[88:89], v[88:89], v[112:113]
    v_pk_mul_f32 v[90:91], v[90:91], v[114:115]
    v_cvt_pk_bf16_f32 v104, v72, v73
    v_cvt_pk_bf16_f32 v105, v74, v75
    v_cvt_pk_bf16_f32 v106, v88, v89
    v_cvt_pk_bf16_f32 v107, v90, v91
    s_nop 1
    v_permlane16_swap_b32 v104, v106
    v_permlane16_swap_b32 v105, v107
    buffer_store_dwordx4 v[104:107], v9, s[16:19], s55 offen offset:64 sc1
    s_cmp_ge_u32 s24, 14
    s_cselect_b32 s40, 25, 24
    s_lshl_b32 s41, s25, 1
    s_add_u32 s40, s40, s41
    s_lshl_b32 s40, s40, 12
    s_sub_u32 s41, s24, 14
    s_min_u32 s41, s41, s24
    s_add_u32 s84, s4, 0x300000
    s_addc_u32 s85, s5, 0
    s_mov_b32 s86, 0x40000
    s_mov_b32 s87, 0x20000
    s_lshl_b32 s41, s41, 2
    s_add_u32 s40, s40, s41
    v_and_b32 v3, 31, v0
    v_lshl_add_u32 v3, v3, 7, s40
    v_mov_b32 v4, 1
    s_waitcnt vmcnt(0)
    s_barrier
    s_cmp_lg_u32 s28, 0
    s_cbranch_scc1 g3_cin
    s_mov_b32 exec_hi, 0
    s_mov_b32 exec_lo, 0xffff
    buffer_store_dword v4, v3, s[84:87], 0 offen sc1
    s_mov_b64 exec, -1
g3_cin:
    s_branch g4_in
g3_spare:
    s_cmp_ge_u32 s2, 256
    s_cbranch_scc1 g3_done
    s_load_dwordx2 s[4:5], s[0:1], 80
    s_load_dwordx2 s[6:7], s[0:1], 48
    s_sub_u32 s3, s2, 224
    v_lshrrev_b32 v2, 6, v0
    v_lshlrev_b32 v1, 4, v0
    v_mov_b32 v8, -1
    v_mov_b32 v9, -1
    v_mov_b32 v10, -1
    v_mov_b32 v11, -1
    v_readfirstlane_b32 s28, v2
    s_lshl_b32 s13, s3, 17
    s_waitcnt lgkmcnt(0)
    s_add_u32 s4, s4, s97
    s_addc_u32 s5, s5, 0
    s_add_u32 s8, s4, 0x1d00000
    s_addc_u32 s9, s5, 0
    s_mov_b32 s10, 0x400000
    s_mov_b32 s11, 0x20000
    buffer_store_dwordx4 v[8:11], v1, s[8:11], s13 offen sc1
    s_add_u32 s13, s13, 8192
    buffer_store_dwordx4 v[8:11], v1, s[8:11], s13 offen sc1
    s_add_u32 s13, s13, 8192
    buffer_store_dwordx4 v[8:11], v1, s[8:11], s13 offen sc1
    s_add_u32 s13, s13, 8192
    buffer_store_dwordx4 v[8:11], v1, s[8:11], s13 offen sc1
    s_add_u32 s13, s13, 8192
    buffer_store_dwordx4 v[8:11], v1, s[8:11], s13 offen sc1
    s_add_u32 s13, s13, 8192
    buffer_store_dwordx4 v[8:11], v1, s[8:11], s13 offen sc1
    s_add_u32 s13, s13, 8192
    buffer_store_dwordx4 v[8:11], v1, s[8:11], s13 offen sc1
    s_add_u32 s13, s13, 8192
    buffer_store_dwordx4 v[8:11], v1, s[8:11], s13 offen sc1
    s_add_u32 s13, s13, 8192
    buffer_store_dwordx4 v[8:11], v1, s[8:11], s13 offen sc1
    s_add_u32 s13, s13, 8192
    buffer_store_dwordx4 v[8:11], v1, s[8:11], s13 offen sc1
    s_add_u32 s13, s13, 8192
    buffer_store_dwordx4 v[8:11], v1, s[8:11], s13 offen sc1
    s_add_u32 s13, s13, 8192
    buffer_store_dwordx4 v[8:11], v1, s[8:11], s13 offen sc1
    s_add_u32 s13, s13, 8192
    buffer_store_dwordx4 v[8:11], v1, s[8:11], s13 offen sc1
    s_add_u32 s13, s13, 8192
    buffer_store_dwordx4 v[8:11], v1, s[8:11], s13 offen sc1
    s_add_u32 s13, s13, 8192
    buffer_store_dwordx4 v[8:11], v1, s[8:11], s13 offen sc1
    s_add_u32 s13, s13, 8192
    buffer_store_dwordx4 v[8:11], v1, s[8:11], s13 offen sc1
    s_add_u32 s13, s13, 8192
    s_mov_b32 s40, 229376
    s_mov_b32 s41, s3
    s_add_u32 s84, s4, 0x300000
    s_addc_u32 s85, s5, 0
    s_mov_b32 s86, 0x40000
    s_mov_b32 s87, 0x20000
    s_lshl_b32 s41, s41, 2
    s_add_u32 s40, s40, s41
    v_and_b32 v3, 31, v0
    v_lshl_add_u32 v3, v3, 7, s40
    v_mov_b32 v4, 1
    s_waitcnt vmcnt(0)
    s_barrier
    s_cmp_lg_u32 s28, 0
    s_cbranch_scc1 g3_spare_cin
    s_mov_b32 exec_hi, 0
    buffer_store_dword v4, v3, s[84:87], 0 offen sc1
    s_mov_b64 exec, -1
g3_spare_cin:
    s_cmp_lg_u32 s96, 0
    s_cbranch_scc1 g3_spare_end
g3_spare_end:
    s_branch g4_in
.p2align 6
g4_in:
    s_cmp_ge_u32 s2, 256
    s_cbranch_scc1 g4_done
    s_load_dwordx2 s[4:5], s[0:1], 80
    s_load_dwordx2 s[6:7], s[0:1], 64
    s_load_dwordx2 s[30:31], s[0:1], 48
    s_load_dwordx2 s[34:35], s[0:1], 56
    v_lshrrev_b32 v1, 6, v0
    v_and_b32 v2, 63, v0
    s_bfe_u32 s40, s2, 0x10001
    s_lshl_b32 s40, s40, 2
    s_bfe_u32 s41, s2, 0x20003
    s_add_u32 s24, s40, s41
    s_bfe_u32 s40, s2, 0x10002
    s_lshl_b32 s40, s40, 3
    s_lshr_b32 s42, s2, 5
    s_add_u32 s25, s40, s42
    s_and_b32 s91, s2, 1
    s_add_u32 s27, s41, s42
    s_lshl_b32 s92, s24, 4
    s_add_u32 s92, s92, s25
    s_mul_i32 s26, s91, 28
    s_cmp_eq_u32 s96, 0
    s_cselect_b32 s95, 3, 1
    v_readfirstlane_b32 s28, v1
    s_nop 0
    s_cmp_lt_u32 s28, 4
    s_cbranch_scc1 g4_compute
    s_sub_u32 s28, s28, 4
    s_mov_b32 s40, 8192
    v_lshrrev_b32 v3, 3, v2
    v_mul_lo_u32 v3, v3, s40
    v_lshrrev_b32 v4, 4, v2
    v_xor_b32 v4, v4, v2
    v_and_b32 v4, 7, v4
    v_lshl_add_u32 v3, v4, 4, v3
    s_mul_i32 s41, s24, 1048576
    s_mul_i32 s42, s28, 262144
    s_add_u32 s41, s41, s42
    v_xor_b32 v4, 64, v3
    s_add_u32 s42, s41, 0
    v_add_u32 v10, s42, v3
    s_add_u32 s42, s41, 65536
    v_add_u32 v11, s42, v4
    s_add_u32 s42, s41, 131072
    v_add_u32 v12, s42, v3
    s_add_u32 s42, s41, 196608
    v_add_u32 v13, s42, v4
    s_mov_b32 s40, 4096
    v_lshrrev_b32 v4, 4, v2
    v_mul_lo_u32 v3, v4, s40
    v_lshlrev_b32 v4, 1, v4
    v_xor_b32 v4, v4, v2
    v_and_b32 v4, 15, v4
    v_lshl_add_u32 v3, v4, 4, v3
    s_mul_i32 s41, s25, 256
    s_mul_i32 s42, s28, 65536
    s_add_u32 s41, s41, s42
    v_xor_b32 v4, 128, v3
    s_add_u32 s42, s41, 0
    v_add_u32 v14, s42, v3
    s_add_u32 s42, s41, 16384
    v_add_u32 v15, s42, v3
    s_add_u32 s42, s41, 32768
    v_add_u32 v16, s42, v4
    s_add_u32 s42, s41, 49152
    v_add_u32 v17, s42, v4
    s_mul_i32 s36, s28, 4096
    s_mul_i32 s37, s28, 4096
    s_add_u32 s37, s37, 16384
    s_waitcnt lgkmcnt(0)
    s_add_u32 s4, s4, s97
    s_addc_u32 s5, s5, 0
    s_add_u32 s8, s4, 0x1100000
    s_addc_u32 s9, s5, 0
    s_mov_b32 s10, 0x800000
    s_mov_b32 s11, 0x20000
    s_mov_b32 s12, s30
    s_mov_b32 s13, s31
    s_mov_b32 s14, 0xe00000
    s_mov_b32 s15, 0x20000
    s_mov_b32 s32, 0
    s_mov_b32 s33, 0
g4_ld_pW:
    s_add_u32 s40, s32, s27
    s_and_b32 s40, s40, s95
    s_andn2_b32 s41, s32, s95
    s_or_b32 s40, s40, s41
    s_add_u32 s40, s40, s26
    s_mul_i32 s34, s40, 128
    s_mul_i32 s35, s40, 262144
    s_add_u32 s38, s33, s36
    s_add_u32 s39, s33, s37
    s_add_u32 m0, s39, 0
    s_nop 0
    buffer_load_dwordx4 v14, s[12:15], s35 offen lds
    s_add_u32 m0, s39, 1024
    s_nop 0
    buffer_load_dwordx4 v15, s[12:15], s35 offen lds
    s_add_u32 m0, s39, 2048
    s_nop 0
    buffer_load_dwordx4 v16, s[12:15], s35 offen lds
    s_add_u32 m0, s39, 3072
    s_nop 0
    buffer_load_dwordx4 v17, s[12:15], s35 offen lds
    s_add_u32 s33, s33, 32768
    s_add_u32 s32, s32, 1
    s_cmp_lt_u32 s32, 4
    s_cbranch_scc1 g4_ld_pW
    s_lshl_b32 s40, s24, 1
    s_add_u32 s40, s40, s91
    s_add_u32 s40, s40, 24
    s_lshl_b32 s40, s40, 12
    s_lshl_b32 s41, s25, 7
    s_add_u32 s40, s40, s41
    s_lshl_b32 s42, s91, 11
    s_add_u32 s42, s42, s41
    s_add_u32 s42, s42, 229376
    s_lshl_b32 s43, s96, 2
    s_add_u32 s43, s43, 4
    s_mov_b32 s41, 0x800000
    v_mov_b32 v24, 131072
    s_cmp_lg_u32 s28, 0
    s_cbranch_scc1 g4_dep_lds
    s_add_u32 s84, s4, 0x300000
    s_addc_u32 s85, s5, 0
    s_mov_b32 s86, 0x40000
    s_mov_b32 s87, 0x20000
    v_cmp_gt_u32 vcc, 32, v2
    v_mov_b32 v21, s40
    v_mov_b32 v23, s42
    v_cndmask_b32 v21, v23, v21, vcc
    v_mov_b32 v22, 13
    v_mov_b32 v23, 31
    v_cndmask_b32 v22, v23, v22, vcc
    v_and_b32 v23, 31, v2
    v_min_u32 v23, v23, v22
    v_lshl_add_u32 v21, v23, 2, v21
    s_mov_b32 s41, 0x40000
    s_mov_b32 s44, 0x3
    s_mov_b32 s45, 0x0
g4_dep:
    buffer_load_dword v23, v21, s[84:87], 0 offen sc1
    s_sub_u32 s41, s41, 1
    s_waitcnt vmcnt(0)
g4_dep_chk:
    v_cmp_eq_u32 vcc, 0, v23
    s_cmp_eq_u32 s41, 0
    s_cbranch_scc1 g4_dep_seen
    s_and_b64 vcc, vcc, s[44:45]
    s_cbranch_scc0 g4_dep_seen
    s_sleep 2
    s_branch g4_dep
g4_dep_seen:
    v_mov_b32 v22, s43
    ds_write_b32 v24, v22
    s_branch g4_dep_ok
g4_dep_lds:
    ds_read_b32 v23, v24
    s_sub_u32 s41, s41, 1
    s_waitcnt lgkmcnt(0)
    v_readfirstlane_b32 s40, v23
    s_cmp_eq_u32 s41, 0
    s_cbranch_scc1 g4_dep_ok
    s_cmp_eq_u32 s40, s43
    s_cbranch_scc1 g4_dep_ok
    s_sleep 1
    s_branch g4_dep_lds
g4_dep_ok:
    s_mov_b32 s32, 0
    s_mov_b32 s33, 0
g4_ld_pA:
    s_add_u32 s40, s32, s27
    s_and_b32 s40, s40, s95
    s_andn2_b32 s41, s32, s95
    s_or_b32 s40, s40, s41
    s_add_u32 s40, s40, s26
    s_mul_i32 s34, s40, 128
    s_mul_i32 s35, s40, 262144
    s_add_u32 s38, s33, s36
    s_add_u32 s39, s33, s37
    s_add_u32 m0, s38, 0
    s_nop 0
    buffer_load_dwordx4 v10, s[8:11], s34 offen sc1 lds
    s_add_u32 m0, s38, 1024
    s_nop 0
    buffer_load_dwordx4 v11, s[8:11], s34 offen sc1 lds
    s_add_u32 m0, s38, 2048
    s_nop 0
    buffer_load_dwordx4 v12, s[8:11], s34 offen sc1 lds
    s_add_u32 m0, s38, 3072
    s_nop 0
    buffer_load_dwordx4 v13, s[8:11], s34 offen sc1 lds
    s_add_u32 s33, s33, 32768
    s_add_u32 s32, s32, 1
    s_cmp_lt_u32 s32, 3
    s_cbranch_scc1 g4_ld_pA
    s_lshl_b32 s40, s24, 1
    s_add_u32 s40, s40, s91
    s_add_u32 s40, s40, 24
    s_lshl_b32 s40, s40, 12
    s_lshl_b32 s41, s25, 7
    s_add_u32 s40, s40, s41
    s_lshl_b32 s42, s91, 11
    s_add_u32 s42, s42, s41
    s_add_u32 s42, s42, 229376
    s_cmp_lg_u32 s28, 0
    s_cbranch_scc1 g4_dep_rok
    s_mov_b32 s41, 0x40000
    s_add_u32 s84, s4, 0x300000
    s_addc_u32 s85, s5, 0
    s_mov_b32 s86, 0x40000
    s_mov_b32 s87, 0x20000
g4_dep_r:
    v_cmp_eq_u32 vcc, 0, v23
    s_sub_u32 s41, s41, 1
    s_cmp_eq_u32 s41, 0
    s_cbranch_scc1 g4_dep_rok
    s_cbranch_vccz g4_dep_rok
    s_sleep 2
    buffer_load_dword v23, v21, s[84:87], 0 offen sc1
    s_waitcnt vmcnt(0)
    s_branch g4_dep_r
g4_dep_rok:
    s_waitcnt vmcnt(8)
    s_barrier
    s_add_u32 s40, s32, s27
    s_and_b32 s40, s40, s95
    s_andn2_b32 s41, s32, s95
    s_or_b32 s40, s40, s41
    s_add_u32 s40, s40, s26
    s_mul_i32 s34, s40, 128
    s_mul_i32 s35, s40, 262144
    s_add_u32 s38, s33, s36
    s_add_u32 s39, s33, s37
    s_add_u32 m0, s38, 0
    s_nop 0
    buffer_load_dwordx4 v10, s[8:11], s34 offen sc1 lds
    s_add_u32 m0, s38, 1024
    s_nop 0
    buffer_load_dwordx4 v11, s[8:11], s34 offen sc1 lds
    s_add_u32 m0, s38, 2048
    s_nop 0
    buffer_load_dwordx4 v12, s[8:11], s34 offen sc1 lds
    s_add_u32 m0, s38, 3072
    s_nop 0
    buffer_load_dwordx4 v13, s[8:11], s34 offen sc1 lds
    s_mov_b32 s33, 0
    s_add_u32 s32, s32, 1
g4_ld_loop:
    s_cmp_eq_u32 s32, 4
    s_cbranch_scc1 g4_ld_s4
    s_cmp_eq_u32 s32, 5
    s_cbranch_scc1 g4_ld_s5
    s_waitcnt vmcnt(16)
g4_ld_bar:
    s_barrier
    s_add_u32 s40, s32, s27
    s_and_b32 s40, s40, s95
    s_andn2_b32 s41, s32, s95
    s_or_b32 s40, s40, s41
    s_add_u32 s40, s40, s26
    s_mul_i32 s34, s40, 128
    s_mul_i32 s35, s40, 262144
    s_add_u32 s38, s33, s36
    s_add_u32 s39, s33, s37
    s_add_u32 m0, s38, 0
    s_nop 0
    buffer_load_dwordx4 v10, s[8:11], s34 offen sc1 lds
    s_add_u32 m0, s38, 1024
    s_nop 0
    buffer_load_dwordx4 v11, s[8:11], s34 offen sc1 lds
    s_add_u32 m0, s38, 2048
    s_nop 0
    buffer_load_dwordx4 v12, s[8:11], s34 offen sc1 lds
    s_add_u32 m0, s38, 3072
    s_nop 0
    buffer_load_dwordx4 v13, s[8:11], s34 offen sc1 lds
    s_add_u32 m0, s39, 0
    s_nop 0
    buffer_load_dwordx4 v14, s[12:15], s35 offen lds
    s_add_u32 m0, s39, 1024
    s_nop 0
    buffer_load_dwordx4 v15, s[12:15], s35 offen lds
    s_add_u32 m0, s39, 2048
    s_nop 0
    buffer_load_dwordx4 v16, s[12:15], s35 offen lds
    s_add_u32 m0, s39, 3072
    s_nop 0
    buffer_load_dwordx4 v17, s[12:15], s35 offen lds
    s_add_u32 s33, s33, 32768
    s_add_u32 s32, s32, 1
    s_cmp_eq_u32 s33, 131072
    s_cselect_b32 s33, 0, s33
    s_cmp_lt_u32 s32, 28
    s_cbranch_scc1 g4_ld_loop
    s_waitcnt vmcnt(16)
    s_barrier
    s_waitcnt vmcnt(8)
    s_barrier
    s_waitcnt vmcnt(0)
    s_barrier
    s_branch g4_ld_end
g4_ld_s4:
    s_waitcnt vmcnt(8)
    s_branch g4_ld_bar
g4_ld_s5:
    s_waitcnt vmcnt(12)
    s_branch g4_ld_bar
g4_ld_end:
    s_cmp_lg_u32 s96, 0
    s_cbranch_scc1 g4_done
    s_barrier
    s_mov_b32 s96, 1
    s_mov_b32 s97, 0x2800000
    s_branch g1_in
g4_done:
    s_endpgm
g4_compute:
    v_lshrrev_b32 v5, 4, v2
    v_bfe_u32 v6, v2, 2, 2
    v_and_b32 v7, 3, v2
    v_and_b32 v8, 15, v2
    s_and_b32 s44, s28, 1
    s_lshr_b32 s45, s28, 1
    s_mul_i32 s40, s25, 128
    s_mul_i32 s41, s45, 64
    s_add_u32 s40, s40, s41
    s_lshl_b32 s41, s91, 5
    s_add_u32 s40, s40, s41
    v_add_u32 v20, s40, v8
    s_mov_b32 s41, 2048
    v_mul_lo_u32 v9, v20, s41
    s_mul_i32 s40, s24, 256
    s_mul_i32 s41, s44, 128
    s_add_u32 s46, s40, s41
    v_and_b32 v3, 1, v5
    v_lshlrev_b32 v3, 5, v3
    v_lshrrev_b32 v4, 1, v5
    v_lshl_add_u32 v3, v4, 4, v3
    v_add3_u32 v9, v9, v3, s46
    s_mov_b32 s52, 0
    s_mov_b32 s53, 32768
    s_mov_b32 s54, 65536
    s_mov_b32 s55, 98304
    s_waitcnt lgkmcnt(0)
    s_add_u32 s4, s4, s97
    s_addc_u32 s5, s5, 0
    s_add_u32 s20, s4, 0x800000
    s_addc_u32 s21, s5, 0
    s_mov_b32 s22, 0x400000
    s_mov_b32 s23, 0x20000
    s_mov_b32 s56, s34
    s_mov_b32 s57, s35
    s_mov_b32 s58, 0x1000
    s_mov_b32 s59, 0x20000
    s_add_u32 s16, s4, 0x4100000
    s_addc_u32 s17, s5, 0
    s_cmp_eq_u32 s96, 0
    s_cselect_b32 s16, s16, s6
    s_cselect_b32 s17, s17, s7
    s_mov_b32 s18, 0x400000
    s_mov_b32 s19, 0x20000
    s_add_u32 s60, s4, 0x2800000
    s_addc_u32 s61, s5, 0
    s_mov_b32 s62, 0x40000
    s_mov_b32 s63, 0x20000
    s_add_u32 s84, s4, 0x1d00000
    s_addc_u32 s85, s5, 0
    s_mov_b32 s86, 0x400000
    s_mov_b32 s87, 0x20000
    s_mul_i32 s42, s44, 64
    v_lshrrev_b32 v3, 1, v8
    v_xor_b32 v3, v3, v5
    v_lshlrev_b32 v3, 4, v3
    v_lshl_add_u32 v3, v8, 7, v3
    s_lshl_b32 s40, s42, 7
    s_add_u32 s40, s40, 0
    v_add_u32 v10, s40, v3
    v_xor_b32 v11, 64, v10
    s_lshl_b32 s90, s91, 1
    s_mul_i32 s42, s45, 4
    s_mov_b32 s43, 16384
    v_and_b32 v3, 1, v5
    v_lshl_or_b32 v3, v3, 2, v6
    s_add_u32 s40, s42, 0
    s_xor_b32 s40, s40, s90
    v_xor_b32 v3, s40, v3
    v_lshlrev_b32 v3, 5, v3
    v_lshl_add_u32 v3, v7, 3, v3
    v_lshl_add_u32 v4, v5, 3, v6
    v_lshl_add_u32 v3, v4, 8, v3
    v_add_u32 v12, s43, v3
    v_and_b32 v3, 1, v5
    v_lshl_or_b32 v3, v3, 2, v6
    s_add_u32 s40, s42, 1
    s_xor_b32 s40, s40, s90
    v_xor_b32 v3, s40, v3
    v_lshlrev_b32 v3, 5, v3
    v_lshl_add_u32 v3, v7, 3, v3
    v_lshl_add_u32 v4, v5, 3, v6
    v_lshl_add_u32 v3, v4, 8, v3
    v_add_u32 v13, s43, v3
    v_and_b32 v3, 1, v5
    v_lshl_or_b32 v3, v3, 2, v6
    s_add_u32 s40, s42, 2
    s_xor_b32 s40, s40, s90
    v_xor_b32 v3, s40, v3
    v_lshlrev_b32 v3, 5, v3
    v_lshl_add_u32 v3, v7, 3, v3
    v_lshl_add_u32 v4, v5, 3, v6
    v_lshl_add_u32 v3, v4, 8, v3
    v_add_u32 v14, s43, v3
    v_and_b32 v3, 1, v5
    v_lshl_or_b32 v3, v3, 2, v6
    s_add_u32 s40, s42, 3
    s_xor_b32 s40, s40, s90
    v_xor_b32 v3, s40, v3
    v_lshlrev_b32 v3, 5, v3
    v_lshl_add_u32 v3, v7, 3, v3
    v_lshl_add_u32 v4, v5, 3, v6
    v_lshl_add_u32 v3, v4, 8, v3
    v_add_u32 v15, s43, v3
    s_mov_b32 s48, 28
    s_mov_b32 s50, 0
    s_mov_b32 s51, 32768
    s_mov_b32 s29, 0xfffe8000
    s_lshl_b32 s40, s28, 12
    v_lshl_add_u32 v21, v2, 4, s40
    s_lshl_b32 s93, s92, 1
    s_add_u32 s93, s93, s91
    s_lshl_b32 s93, s93, 14
    s_xor_b32 s94, s93, 0x4000
    v_mov_b32 v28, 0
    v_mov_b32 v29, 0
    v_mov_b32 v30, 0
    v_mov_b32 v31, 0
    v_mov_b32 v32, 0
    v_mov_b32 v33, 0
    v_mov_b32 v34, 0
    v_mov_b32 v35, 0
    v_mov_b32 v36, 0
    v_mov_b32 v37, 0
    v_mov_b32 v38, 0
    v_mov_b32 v39, 0
    v_mov_b32 v40, 0
    v_mov_b32 v41, 0
    v_mov_b32 v42, 0
    v_mov_b32 v43, 0
    v_mov_b32 v44, 0
    v_mov_b32 v45, 0
    v_mov_b32 v46, 0
    v_mov_b32 v47, 0
    v_mov_b32 v48, 0
    v_mov_b32 v49, 0
    v_mov_b32 v50, 0
    v_mov_b32 v51, 0
    v_mov_b32 v52, 0
    v_mov_b32 v53, 0
    v_mov_b32 v54, 0
    v_mov_b32 v55, 0
    v_mov_b32 v56, 0
    v_mov_b32 v57, 0
    v_mov_b32 v58, 0
    v_mov_b32 v59, 0
    v_mov_b32 v60, 0
    v_mov_b32 v61, 0
    v_mov_b32 v62, 0
    v_mov_b32 v63, 0
    v_mov_b32 v64, 0
    v_mov_b32 v65, 0
    v_mov_b32 v66, 0
    v_mov_b32 v67, 0
    v_mov_b32 v68, 0
    v_mov_b32 v69, 0
    v_mov_b32 v70, 0
    v_mov_b32 v71, 0
    v_mov_b32 v72, 0
    v_mov_b32 v73, 0
    v_mov_b32 v74, 0
    v_mov_b32 v75, 0
    v_mov_b32 v76, 0
    v_mov_b32 v77, 0
    v_mov_b32 v78, 0
    v_mov_b32 v79, 0
    v_mov_b32 v80, 0
    v_mov_b32 v81, 0
    v_mov_b32 v82, 0
    v_mov_b32 v83, 0
    v_mov_b32 v84, 0
    v_mov_b32 v85, 0
    v_mov_b32 v86, 0
    v_mov_b32 v87, 0
    v_mov_b32 v88, 0
    v_mov_b32 v89, 0
    v_mov_b32 v90, 0
    v_mov_b32 v91, 0
    s_barrier
    ds_read_b128 v[92:95], v10 offset:0
    ds_read_b64_tr_b16 v[108:109], v12 offset:0
    ds_read_b64_tr_b16 v[110:111], v12 offset:1024
    ds_read_b64_tr_b16 v[112:113], v13 offset:0
    ds_read_b64_tr_b16 v[114:115], v13 offset:1024
    ds_read_b64_tr_b16 v[116:117], v14 offset:0
    ds_read_b64_tr_b16 v[118:119], v14 offset:1024
    ds_read_b64_tr_b16 v[120:121], v15 offset:0
    ds_read_b64_tr_b16 v[122:123], v15 offset:1024
    ds_read_b128 v[96:99], v10 offset:2048
    ds_read_b128 v[100:103], v10 offset:4096
    ds_read_b128 v[104:107], v10 offset:6144
    buffer_load_dwordx4 v[188:191], v9, s[20:23], s52 offen offset:0 sc1
    buffer_load_dwordx4 v[192:195], v9, s[20:23], s52 offen offset:64 sc1
    buffer_load_dwordx4 v[196:199], v9, s[20:23], s53 offen offset:0 sc1
    buffer_load_dwordx4 v[200:203], v9, s[20:23], s53 offen offset:64 sc1
    v_lshlrev_b32 v3, 1, v20
    buffer_load_ushort v22, v3, s[56:59], 0 offen offset:0
    buffer_load_ushort v23, v3, s[56:59], 0 offen offset:32
    s_branch g4_cloop3
.p2align 3
g4_cloop:
    s_barrier
g4_cloop2:
    v_mfma_f32_16x16x32_bf16 v[28:31], v[124:127], v[140:143], v[28:31]
    ds_read_b128 v[92:95], v10 offset:0
    v_mfma_f32_16x16x32_bf16 v[32:35], v[124:127], v[144:147], v[32:35]
    ds_read_b64_tr_b16 v[108:109], v12 offset:0
    ds_read_b64_tr_b16 v[110:111], v12 offset:1024
    v_mfma_f32_16x16x32_bf16 v[36:39], v[124:127], v[148:151], v[36:39]
    ds_read_b64_tr_b16 v[112:113], v13 offset:0
    ds_read_b64_tr_b16 v[114:115], v13 offset:1024
    v_mfma_f32_16x16x32_bf16 v[40:43], v[124:127], v[152:155], v[40:43]
    ds_read_b64_tr_b16 v[116:117], v14 offset:0
    ds_read_b64_tr_b16 v[118:119], v14 offset:1024
    v_mfma_f32_16x16x32_bf16 v[56:59], v[128:131], v[152:155], v[56:59]
    ds_read_b64_tr_b16 v[120:121], v15 offset:0
    ds_read_b64_tr_b16 v[122:123], v15 offset:1024
    v_mfma_f32_16x16x32_bf16 v[52:55], v[128:131], v[148:151], v[52:55]
    ds_read_b128 v[96:99], v10 offset:2048
    v_mfma_f32_16x16x32_bf16 v[48:51], v[128:131], v[144:147], v[48:51]
    ds_read_b128 v[100:103], v10 offset:4096
    v_mfma_f32_16x16x32_bf16 v[44:47], v[128:131], v[140:143], v[44:47]
    ds_read_b128 v[104:107], v10 offset:6144
    v_mfma_f32_16x16x32_bf16 v[60:63], v[132:135], v[140:143], v[60:63]
    v_mfma_f32_16x16x32_bf16 v[64:67], v[132:135], v[144:147], v[64:67]
    v_mfma_f32_16x16x32_bf16 v[68:71], v[132:135], v[148:151], v[68:71]
    v_mfma_f32_16x16x32_bf16 v[72:75], v[132:135], v[152:155], v[72:75]
    v_mfma_f32_16x16x32_bf16 v[88:91], v[136:139], v[152:155], v[88:91]
    v_mfma_f32_16x16x32_bf16 v[84:87], v[136:139], v[148:151], v[84:87]
    v_mfma_f32_16x16x32_bf16 v[80:83], v[136:139], v[144:147], v[80:83]
    v_mfma_f32_16x16x32_bf16 v[76:79], v[136:139], v[140:143], v[76:79]
g4_cloop3:
    s_waitcnt lgkmcnt(0)
    v_mfma_f32_16x16x32_bf16 v[28:31], v[92:95], v[108:111], v[28:31]
    ds_read_b128 v[124:127], v11 offset:0
    v_mfma_f32_16x16x32_bf16 v[32:35], v[92:95], v[112:115], v[32:35]
    ds_read_b64_tr_b16 v[140:141], v12 offset:8192
    ds_read_b64_tr_b16 v[142:143], v12 offset:9216
    v_mfma_f32_16x16x32_bf16 v[36:39], v[92:95], v[116:119], v[36:39]
    ds_read_b64_tr_b16 v[144:145], v13 offset:8192
    ds_read_b64_tr_b16 v[146:147], v13 offset:9216
    v_mfma_f32_16x16x32_bf16 v[40:43], v[92:95], v[120:123], v[40:43]
    ds_read_b64_tr_b16 v[148:149], v14 offset:8192
    ds_read_b64_tr_b16 v[150:151], v14 offset:9216
    v_mfma_f32_16x16x32_bf16 v[56:59], v[96:99], v[120:123], v[56:59]
    ds_read_b64_tr_b16 v[152:153], v15 offset:8192
    ds_read_b64_tr_b16 v[154:155], v15 offset:9216
    v_mfma_f32_16x16x32_bf16 v[52:55], v[96:99], v[116:119], v[52:55]
    ds_read_b128 v[128:131], v11 offset:2048
    v_mfma_f32_16x16x32_bf16 v[48:51], v[96:99], v[112:115], v[48:51]
    ds_read_b128 v[132:135], v11 offset:4096
    v_mfma_f32_16x16x32_bf16 v[44:47], v[96:99], v[108:111], v[44:47]
    ds_read_b128 v[136:139], v11 offset:6144
    v_mfma_f32_16x16x32_bf16 v[60:63], v[100:103], v[108:111], v[60:63]
    s_add_u32 s50, s50, 1
    s_cmp_eq_u32 s50, 4
    v_mfma_f32_16x16x32_bf16 v[64:67], v[100:103], v[112:115], v[64:67]
    s_cselect_b32 s49, s29, s51
    s_cselect_b32 s50, 0, s50
    v_mfma_f32_16x16x32_bf16 v[68:71], v[100:103], v[116:119], v[68:71]
    v_add_u32 v10, s49, v10
    v_add_u32 v11, s49, v11
    v_mfma_f32_16x16x32_bf16 v[72:75], v[100:103], v[120:123], v[72:75]
    v_add_u32 v12, s49, v12
    v_add_u32 v13, s49, v13
    v_mfma_f32_16x16x32_bf16 v[88:91], v[104:107], v[120:123], v[88:91]
    v_add_u32 v14, s49, v14
    v_add_u32 v15, s49, v15
    v_mfma_f32_16x16x32_bf16 v[84:87], v[104:107], v[116:119], v[84:87]
    s_sub_u32 s48, s48, 1
    s_cmp_lg_u32 s48, 0
    v_mfma_f32_16x16x32_bf16 v[80:83], v[104:107], v[112:115], v[80:83]
    v_mfma_f32_16x16x32_bf16 v[76:79], v[104:107], v[108:111], v[76:79]
    s_waitcnt lgkmcnt(0)
    s_cbranch_scc1 g4_cloop
    v_mfma_f32_16x16x32_bf16 v[36:39], v[124:127], v[148:151], v[36:39]
    v_mfma_f32_16x16x32_bf16 v[52:55], v[128:131], v[148:151], v[52:55]
    v_mfma_f32_16x16x32_bf16 v[68:71], v[132:135], v[148:151], v[68:71]
    v_mfma_f32_16x16x32_bf16 v[84:87], v[136:139], v[148:151], v[84:87]
    v_mfma_f32_16x16x32_bf16 v[40:43], v[124:127], v[152:155], v[40:43]
    v_mfma_f32_16x16x32_bf16 v[56:59], v[128:131], v[152:155], v[56:59]
    v_mfma_f32_16x16x32_bf16 v[72:75], v[132:135], v[152:155], v[72:75]
    v_mfma_f32_16x16x32_bf16 v[88:91], v[136:139], v[152:155], v[88:91]
    v_mfma_f32_16x16x32_bf16 v[28:31], v[124:127], v[140:143], v[28:31]
    v_cvt_pk_bf16_f32 v156, v36, v37
    v_cvt_pk_bf16_f32 v157, v38, v39
    v_mfma_f32_16x16x32_bf16 v[44:47], v[128:131], v[140:143], v[44:47]
    v_cvt_pk_bf16_f32 v158, v52, v53
    v_cvt_pk_bf16_f32 v159, v54, v55
    buffer_store_dwordx4 v[156:159], v21, s[84:87], s93 offen offset:0 sc1
    v_mfma_f32_16x16x32_bf16 v[60:63], v[132:135], v[140:143], v[60:63]
    v_cvt_pk_bf16_f32 v160, v68, v69
    v_cvt_pk_bf16_f32 v161, v70, v71
    v_mfma_f32_16x16x32_bf16 v[76:79], v[136:139], v[140:143], v[76:79]
    v_cvt_pk_bf16_f32 v162, v84, v85
    v_cvt_pk_bf16_f32 v163, v86, v87
    buffer_store_dwordx4 v[160:163], v21, s[84:87], s93 offen offset:1024 sc1
    v_mfma_f32_16x16x32_bf16 v[32:35], v[124:127], v[144:147], v[32:35]
    v_cvt_pk_bf16_f32 v164, v40, v41
    v_cvt_pk_bf16_f32 v165, v42, v43
    v_mfma_f32_16x16x32_bf16 v[48:51], v[128:131], v[144:147], v[48:51]
    v_cvt_pk_bf16_f32 v166, v56, v57
    v_cvt_pk_bf16_f32 v167, v58, v59
    buffer_store_dwordx4 v[164:167], v21, s[84:87], s93 offen offset:2048 sc1
    v_mfma_f32_16x16x32_bf16 v[64:67], v[132:135], v[144:147], v[64:67]
    v_cvt_pk_bf16_f32 v168, v72, v73
    v_cvt_pk_bf16_f32 v169, v74, v75
    v_mfma_f32_16x16x32_bf16 v[80:83], v[136:139], v[144:147], v[80:83]
    s_nop 1
    v_cvt_pk_bf16_f32 v170, v88, v89
    v_cvt_pk_bf16_f32 v171, v90, v91
    buffer_store_dwordx4 v[168:171], v21, s[84:87], s93 offen offset:3072 sc1
    s_mov_b32 s48, 0x40000
    buffer_load_dwordx4 v[172:175], v21, s[84:87], s94 offen offset:0 sc1
    buffer_load_dwordx4 v[176:179], v21, s[84:87], s94 offen offset:1024 sc1
    buffer_load_dwordx4 v[180:183], v21, s[84:87], s94 offen offset:2048 sc1
    buffer_load_dwordx4 v[184:187], v21, s[84:87], s94 offen offset:3072 sc1
    s_waitcnt vmcnt(8)
    s_nop 3
    v_permlane16_swap_b32 v188, v190
    v_permlane16_swap_b32 v189, v191
    v_permlane16_swap_b32 v192, v194
    v_permlane16_swap_b32 v193, v195
    v_permlane16_swap_b32 v196, v198
    v_permlane16_swap_b32 v197, v199
    v_permlane16_swap_b32 v200, v202
    v_permlane16_swap_b32 v201, v203
    v_lshlrev_b32 v22, 16, v22
    v_lshlrev_b32 v23, 16, v23
    v_lshlrev_b32 v204, 16, v188
    v_and_b32 v205, 0xffff0000, v188
    v_lshlrev_b32 v206, 16, v189
    v_and_b32 v207, 0xffff0000, v189
    v_lshlrev_b32 v208, 16, v190
    v_and_b32 v209, 0xffff0000, v190
    v_lshlrev_b32 v210, 16, v191
    v_and_b32 v211, 0xffff0000, v191
    v_add_f32 v204, v204, v22
    v_add_f32 v205, v205, v22
    v_add_f32 v206, v206, v22
    v_add_f32 v207, v207, v22
    v_add_f32 v208, v208, v22
    v_add_f32 v209, v209, v22
    v_add_f32 v210, v210, v22
    v_add_f32 v211, v211, v22
    v_pk_add_f32 v[28:29], v[28:29], v[204:205]
    v_pk_add_f32 v[30:31], v[30:31], v[206:207]
    v_pk_add_f32 v[44:45], v[44:45], v[208:209]
    v_pk_add_f32 v[46:47], v[46:47], v[210:211]
    v_lshlrev_b32 v204, 16, v192
    v_and_b32 v205, 0xffff0000, v192
    v_lshlrev_b32 v206, 16, v193
    v_and_b32 v207, 0xffff0000, v193
    v_lshlrev_b32 v208, 16, v194
    v_and_b32 v209, 0xffff0000, v194
    v_lshlrev_b32 v210, 16, v195
    v_and_b32 v211, 0xffff0000, v195
    v_add_f32 v204, v204, v22
    v_add_f32 v205, v205, v22
    v_add_f32 v206, v206, v22
    v_add_f32 v207, v207, v22
    v_add_f32 v208, v208, v22
    v_add_f32 v209, v209, v22
    v_add_f32 v210, v210, v22
    v_add_f32 v211, v211, v22
    v_pk_add_f32 v[60:61], v[60:61], v[204:205]
    v_pk_add_f32 v[62:63], v[62:63], v[206:207]
    v_pk_add_f32 v[76:77], v[76:77], v[208:209]
    v_pk_add_f32 v[78:79], v[78:79], v[210:211]
    v_lshlrev_b32 v204, 16, v196
    v_and_b32 v205, 0xffff0000, v196
    v_lshlrev_b32 v206, 16, v197
    v_and_b32 v207, 0xffff0000, v197
    v_lshlrev_b32 v208, 16, v198
    v_and_b32 v209, 0xffff0000, v198
    v_lshlrev_b32 v210, 16, v199
    v_and_b32 v211, 0xffff0000, v199
    v_add_f32 v204, v204, v23
    v_add_f32 v205, v205, v23
    v_add_f32 v206, v206, v23
    v_add_f32 v207, v207, v23
    v_add_f32 v208, v208, v23
    v_add_f32 v209, v209, v23
    v_add_f32 v210, v210, v23
    v_add_f32 v211, v211, v23
    v_pk_add_f32 v[32:33], v[32:33], v[204:205]
    v_pk_add_f32 v[34:35], v[34:35], v[206:207]
    v_pk_add_f32 v[48:49], v[48:49], v[208:209]
    v_pk_add_f32 v[50:51], v[50:51], v[210:211]
    v_lshlrev_b32 v204, 16, v200
    v_and_b32 v205, 0xffff0000, v200
    v_lshlrev_b32 v206, 16, v201
    v_and_b32 v207, 0xffff0000, v201
    v_lshlrev_b32 v208, 16, v202
    v_and_b32 v209, 0xffff0000, v202
    v_lshlrev_b32 v210, 16, v203
    v_and_b32 v211, 0xffff0000, v203
    v_add_f32 v204, v204, v23
    v_add_f32 v205, v205, v23
    v_add_f32 v206, v206, v23
    v_add_f32 v207, v207, v23
    v_add_f32 v208, v208, v23
    v_add_f32 v209, v209, v23
    v_add_f32 v210, v210, v23
    v_add_f32 v211, v211, v23
    v_pk_add_f32 v[64:65], v[64:65], v[204:205]
    v_pk_add_f32 v[66:67], v[66:67], v[206:207]
    v_pk_add_f32 v[80:81], v[80:81], v[208:209]
    v_pk_add_f32 v[82:83], v[82:83], v[210:211]
    s_waitcnt vmcnt(0)
g4_rcv:
    v_max3_u32 v4, v172, v173, v174
    v_max3_u32 v4, v4, v175, v176
    v_max3_u32 v4, v4, v177, v178
    v_max3_u32 v4, v4, v179, v180
    v_max3_u32 v4, v4, v181, v182
    v_max3_u32 v4, v4, v183, v184
    v_max3_u32 v4, v4, v185, v186
    v_max_u32 v4, v4, v187
    v_cmp_eq_u32 vcc, -1, v4
    s_sub_u32 s48, s48, 1
    s_cmp_eq_u32 s48, 0
    s_cbranch_scc1 g4_rcvd
    s_cbranch_vccz g4_rcvd
    s_sleep 2
    buffer_load_dwordx4 v[172:175], v21, s[84:87], s94 offen offset:0 sc1
    buffer_load_dwordx4 v[176:179], v21, s[84:87], s94 offen offset:1024 sc1
    buffer_load_dwordx4 v[180:183], v21, s[84:87], s94 offen offset:2048 sc1
    buffer_load_dwordx4 v[184:187], v21, s[84:87], s94 offen offset:3072 sc1
    s_waitcnt vmcnt(0)
    s_branch g4_rcv
g4_rcvd:
    v_lshlrev_b32 v108, 16, v172
    v_and_b32 v109, 0xffff0000, v172
    v_lshlrev_b32 v110, 16, v173
    v_and_b32 v111, 0xffff0000, v173
    v_pk_add_f32 v[28:29], v[28:29], v[108:109]
    v_pk_add_f32 v[30:31], v[30:31], v[110:111]
    v_lshlrev_b32 v112, 16, v174
    v_and_b32 v113, 0xffff0000, v174
    v_lshlrev_b32 v114, 16, v175
    v_and_b32 v115, 0xffff0000, v175
    v_pk_add_f32 v[44:45], v[44:45], v[112:113]
    v_pk_add_f32 v[46:47], v[46:47], v[114:115]
    v_lshlrev_b32 v116, 16, v176
    v_and_b32 v117, 0xffff0000, v176
    v_lshlrev_b32 v118, 16, v177
    v_and_b32 v119, 0xffff0000, v177
    v_pk_add_f32 v[60:61], v[60:61], v[116:117]
    v_pk_add_f32 v[62:63], v[62:63], v[118:119]
    v_lshlrev_b32 v120, 16, v178
    v_and_b32 v121, 0xffff0000, v178
    v_lshlrev_b32 v122, 16, v179
    v_and_b32 v123, 0xffff0000, v179
    v_pk_add_f32 v[76:77], v[76:77], v[120:121]
    v_pk_add_f32 v[78:79], v[78:79], v[122:123]
    v_lshlrev_b32 v108, 16, v180
    v_and_b32 v109, 0xffff0000, v180
    v_lshlrev_b32 v110, 16, v181
    v_and_b32 v111, 0xffff0000, v181
    v_pk_add_f32 v[32:33], v[32:33], v[108:109]
    v_pk_add_f32 v[34:35], v[34:35], v[110:111]
    v_lshlrev_b32 v112, 16, v182
    v_and_b32 v113, 0xffff0000, v182
    v_lshlrev_b32 v114, 16, v183
    v_and_b32 v115, 0xffff0000, v183
    v_pk_add_f32 v[48:49], v[48:49], v[112:113]
    v_pk_add_f32 v[50:51], v[50:51], v[114:115]
    v_lshlrev_b32 v116, 16, v184
    v_and_b32 v117, 0xffff0000, v184
    v_lshlrev_b32 v118, 16, v185
    v_and_b32 v119, 0xffff0000, v185
    v_pk_add_f32 v[64:65], v[64:65], v[116:117]
    v_pk_add_f32 v[66:67], v[66:67], v[118:119]
    v_lshlrev_b32 v120, 16, v186
    v_and_b32 v121, 0xffff0000, v186
    v_lshlrev_b32 v122, 16, v187
    v_and_b32 v123, 0xffff0000, v187
    v_pk_add_f32 v[80:81], v[80:81], v[120:121]
    v_pk_add_f32 v[82:83], v[82:83], v[122:123]
    v_cvt_pk_bf16_f32 v92, v28, v29
    v_cvt_pk_bf16_f32 v93, v30, v31
    v_cvt_pk_bf16_f32 v94, v44, v45
    v_cvt_pk_bf16_f32 v95, v46, v47
    s_nop 1
    v_permlane16_swap_b32 v92, v94
    v_permlane16_swap_b32 v93, v95
    buffer_store_dwordx4 v[92:95], v9, s[16:19], s52 offen offset:0 sc1
    v_cvt_pk_bf16_f32 v96, v60, v61
    v_cvt_pk_bf16_f32 v97, v62, v63
    v_cvt_pk_bf16_f32 v98, v76, v77
    v_cvt_pk_bf16_f32 v99, v78, v79
    s_nop 1
    v_permlane16_swap_b32 v96, v98
    v_permlane16_swap_b32 v97, v99
    buffer_store_dwordx4 v[96:99], v9, s[16:19], s52 offen offset:64 sc1
    v_cvt_pk_bf16_f32 v100, v32, v33
    v_cvt_pk_bf16_f32 v101, v34, v35
    v_cvt_pk_bf16_f32 v102, v48, v49
    v_cvt_pk_bf16_f32 v103, v50, v51
    s_nop 1
    v_permlane16_swap_b32 v100, v102
    v_permlane16_swap_b32 v101, v103
    buffer_store_dwordx4 v[100:103], v9, s[16:19], s53 offen offset:0 sc1
    v_cvt_pk_bf16_f32 v104, v64, v65
    v_cvt_pk_bf16_f32 v105, v66, v67
    v_cvt_pk_bf16_f32 v106, v80, v81
    v_cvt_pk_bf16_f32 v107, v82, v83
    s_nop 1
    v_permlane16_swap_b32 v104, v106
    v_permlane16_swap_b32 v105, v107
    buffer_store_dwordx4 v[104:107], v9, s[16:19], s53 offen offset:64 sc1
    v_pk_add_f32 v[108:109], v[28:29], v[30:31]
    v_pk_mul_f32 v[110:111], v[28:29], v[28:29]
    v_pk_fma_f32 v[110:111], v[30:31], v[30:31], v[110:111]
    v_pk_add_f32 v[108:109], v[108:109], v[44:45]
    v_pk_fma_f32 v[110:111], v[44:45], v[44:45], v[110:111]
    v_pk_add_f32 v[108:109], v[108:109], v[46:47]
    v_pk_fma_f32 v[110:111], v[46:47], v[46:47], v[110:111]
    v_pk_add_f32 v[108:109], v[108:109], v[60:61]
    v_pk_fma_f32 v[110:111], v[60:61], v[60:61], v[110:111]
    v_pk_add_f32 v[108:109], v[108:109], v[62:63]
    v_pk_fma_f32 v[110:111], v[62:63], v[62:63], v[110:111]
    v_pk_add_f32 v[108:109], v[108:109], v[76:77]
    v_pk_fma_f32 v[110:111], v[76:77], v[76:77], v[110:111]
    v_pk_add_f32 v[108:109], v[108:109], v[78:79]
    v_pk_fma_f32 v[110:111], v[78:79], v[78:79], v[110:111]
    v_pk_add_f32 v[112:113], v[32:33], v[34:35]
    v_pk_mul_f32 v[114:115], v[32:33], v[32:33]
    v_pk_fma_f32 v[114:115], v[34:35], v[34:35], v[114:115]
    v_pk_add_f32 v[112:113], v[112:113], v[48:49]
    v_pk_fma_f32 v[114:115], v[48:49], v[48:49], v[114:115]
    v_pk_add_f32 v[112:113], v[112:113], v[50:51]
    v_pk_fma_f32 v[114:115], v[50:51], v[50:51], v[114:115]
    v_pk_add_f32 v[112:113], v[112:113], v[64:65]
    v_pk_fma_f32 v[114:115], v[64:65], v[64:65], v[114:115]
    v_pk_add_f32 v[112:113], v[112:113], v[66:67]
    v_pk_fma_f32 v[114:115], v[66:67], v[66:67], v[114:115]
    v_pk_add_f32 v[112:113], v[112:113], v[80:81]
    v_pk_fma_f32 v[114:115], v[80:81], v[80:81], v[114:115]
    v_pk_add_f32 v[112:113], v[112:113], v[82:83]
    v_pk_fma_f32 v[114:115], v[82:83], v[82:83], v[114:115]
    v_add_f32 v108, v108, v109
    v_add_f32 v109, v110, v111
    v_add_f32 v112, v112, v113
    v_add_f32 v113, v114, v115
    s_nop 1
    v_permlane16_swap_b32 v108, v112
    v_permlane16_swap_b32 v109, v113
    v_pk_add_f32 v[108:109], v[108:109], v[112:113]
    v_mov_b32 v116, v108
    v_mov_b32 v117, v109
    v_and_b32 v3, 16, v2
    v_add_u32 v3, v3, v20
    v_permlane32_swap_b32 v108, v116
    v_permlane32_swap_b32 v109, v117
    v_pk_add_f32 v[108:109], v[108:109], v[116:117]
    v_lshlrev_b32 v3, 3, v3
    s_mul_i32 s40, s24, 2
    s_add_u32 s40, s40, s44
    s_lshl_b32 s40, s40, 14
    s_mov_b32 exec_hi, 0
    buffer_store_dwordx2 v[108:109], v3, s[60:63], s40 offen sc1
    s_mov_b32 exec_hi, -1
    s_cmp_lg_u32 s96, 0
    s_cbranch_scc1 g4_done
    s_lshr_b32 s40, s25, 0
    s_add_u32 s40, s40, 40
    s_lshl_b32 s40, s40, 12
    s_mov_b32 s42, s40
    s_lshl_b32 s41, s24, 1
    s_add_u32 s41, s41, s91
    s_add_u32 s84, s4, 0x2b00000
    s_addc_u32 s85, s5, 0
    s_mov_b32 s86, 0x40000
    s_mov_b32 s87, 0x20000
    s_lshl_b32 s41, s41, 2
    s_add_u32 s40, s40, s41
    v_and_b32 v3, 31, v0
    v_lshl_add_u32 v3, v3, 7, s40
    v_mov_b32 v4, 1
    s_waitcnt vmcnt(0)
    s_barrier
    s_cmp_lg_u32 s28, 0
    s_cbranch_scc1 g4_cin
    s_mov_b32 exec_hi, 0
    s_mov_b32 exec_lo, 0xffff
    buffer_store_dword v4, v3, s[84:87], 0 offen sc1
    s_mov_b64 exec, -1
g4_cin:
    s_mov_b32 s96, 1
    s_mov_b32 s97, 0x2800000
    s_branch g1_in
code_end:
.section .rodata,"a"
.p2align 6
.amdhsa_kernel g1a_kernel
  .amdhsa_next_free_vgpr 248
  .amdhsa_next_free_sgpr 100
  .amdhsa_accum_offset 248
  .amdhsa_group_segment_fixed_size 0
  .amdhsa_kernarg_size 88
  .amdhsa_user_sgpr_count 2
  .amdhsa_user_sgpr_kernarg_segment_ptr 1
  .amdhsa_system_sgpr_workgroup_id_x 1
.end_amdhsa_kernel
```
